```python
import torch

def _softmax(x, axis=-1):
    return torch.softmax(x, dim=axis)
def _gelu(x):
    return torch.nn.functional.gelu(x, approximate="tanh")
def _silu(x):
    return torch.nn.functional.silu(x)
def _sigmoid(x):
    return torch.sigmoid(x)
def _layernorm(x, axis=-1, eps=1e-5):
    m = x.mean(dim=axis, keepdim=True)
    v = x.var(dim=axis, keepdim=True, unbiased=False)
    return (x - m) / torch.sqrt(v + eps)
def _scatter_add(tgt, idx, src, axis=0):
    return tgt.clone().index_add_(axis, idx, src)
def _segment_sum(src, seg, n):
    out = torch.zeros((n,) + src.shape[1:], dtype=src.dtype)
    return out.index_add_(0, seg, src)
def _pad(x, pw):
    flat = tuple(v for pair in reversed(pw) for v in pair)
    return torch.nn.functional.pad(x, flat)

kernel_name = 'interleave_layers__grouped_kv_mqa__sliding_block__prompt'

def setup_inputs():

    _w = (lambda a: (lambda t: t.to(torch.bfloat16) if t.is_floating_point() else t)(torch.as_tensor(a)))
    def _A_setup():
        B, S, D, H = 1, 2048, 640, 32
        Dh = D // H
        return {
            "x": _w((lambda *s: torch.randn(*s, dtype=torch.bfloat16) * 0.05)(B, S, D)),
            "wq": _w((lambda *s: torch.randn(*s, dtype=torch.bfloat16) * 0.05)(D, H * Dh)),
            "wk": _w((lambda *s: torch.randn(*s, dtype=torch.bfloat16) * 0.05)(D, Dh)),
            "wv": _w((lambda *s: torch.randn(*s, dtype=torch.bfloat16) * 0.05)(D, Dh)),
            "wo": _w((lambda *s: torch.randn(*s, dtype=torch.bfloat16) * 0.05)(H * Dh, D)),
        }
    _A_in = _A_setup()

    def _B_setup():
        B, S, D = 1, 2048, 640
        return {
            "x": _w((lambda *s: torch.randn(*s, dtype=torch.bfloat16) * 0.05)(B, S, D)),
            "wqkv": _w((lambda *s: torch.randn(*s, dtype=torch.bfloat16) * 0.05)(D, 3 * D)),
            "wo": _w((lambda *s: torch.randn(*s, dtype=torch.bfloat16) * 0.05)(D, D)),
        }
    _B_in = _B_setup()

    return {
        "A_x": _A_in["x"],
        "A_wq": _A_in["wq"],
        "A_wk": _A_in["wk"],
        "A_wv": _A_in["wv"],
        "A_wo": _A_in["wo"],
        "B_x": _B_in["x"],
        "B_wqkv": _B_in["wqkv"],
        "B_wo": _B_in["wo"],
    }

def reference(A_x, A_wq, A_wk, A_wv, A_wo, B_x, B_wqkv, B_wo):
    def _A_ref(x, wq, wk, wv, wo):
        B, S, D = x.shape
        H = 32
        Dh = D // H
        q = (lambda x, *d: x.permute(*d))((x @ wq).reshape(B, S, H, Dh), 0, 2, 1, 3)
        k = x @ wk
        v = x @ wv
        scores = torch.einsum("bhqd,bkd->bhqk", q, k) * (Dh ** -0.5)
        p = _softmax(scores, axis=-1)
        o = torch.einsum("bhqk,bkd->bhqd", p, v)
        return (lambda x, *d: x.permute(*d))(o, 0, 2, 1, 3).reshape(B, S, H * Dh) @ wo

    def _B_ref(x, wqkv, wo):
        B, S, D = x.shape
        H = 32; Dh = D // H; W = 256
        qkv = (lambda x, *d: x.permute(*d))((x @ wqkv).reshape(B, S, 3, H, Dh), 2, 0, 3, 1, 4)
        q, k, v = qkv[0], qkv[1], qkv[2]
        scores = torch.einsum("bhqd,bhkd->bhqk", q, k) * (Dh ** -0.5)
        idx = torch.arange(S)
        mask = (idx[:, None] - idx[None, :] >= 0) & (idx[:, None] - idx[None, :] < W)
        scores = torch.where(mask[None, None], scores, -1e9)
        p = _softmax(scores, axis=-1)
        o = torch.einsum("bhqk,bhkd->bhqd", p, v)
        return (lambda x, *d: x.permute(*d))(o, 0, 2, 1, 3).reshape(B, S, D) @ wo

    x = A_x
    x = x + _A_ref(_layernorm(x, axis=-1), A_wq, A_wk, A_wv, A_wo)
    x = x + _B_ref(_layernorm(x, axis=-1), B_wqkv, B_wo)
    x = x + _A_ref(_layernorm(x, axis=-1), A_wq, A_wk, A_wv, A_wo)
    x = x + _B_ref(_layernorm(x, axis=-1), B_wqkv, B_wo)
    return x
```

```asm
; @launch kernel=prep_kernel grid=(31,1,1) block=(256,1,1) lds=0
; @launch kernel=a1_0_kernel grid=(192,1,1) block=(256,1,1) lds=84992
; @launch kernel=attna_kernel grid=(256,1,1) block=(512,1,1) lds=65536
; @launch kernel=outa_0_kernel grid=(160,1,1) block=(256,1,1) lds=84992
; @launch kernel=b1_1_kernel grid=(256,1,1) block=(256,1,1) lds=84992
; @launch kernel=attnb_kernel grid=(256,1,1) block=(512,1,1) lds=65536
; @launch kernel=outb_1_kernel grid=(160,1,1) block=(256,1,1) lds=84992
; @launch kernel=a1_2_kernel grid=(192,1,1) block=(256,1,1) lds=84992
; @launch kernel=attna_kernel grid=(256,1,1) block=(512,1,1) lds=65536
; @launch kernel=outa_2_kernel grid=(160,1,1) block=(256,1,1) lds=84992
; @launch kernel=b1_3_kernel grid=(256,1,1) block=(256,1,1) lds=84992
; @launch kernel=attnb_kernel grid=(256,1,1) block=(512,1,1) lds=65536
; @launch kernel=outb_3_kernel grid=(160,1,1) block=(256,1,1) lds=84992
.amdgcn_target "amdgcn-amd-amdhsa--gfx950"
.text
.globl prep_kernel
.p2align 8
.type prep_kernel,@function
prep_kernel:
 v_lshrrev_b32 v1, 6, v0
 s_nop 0
 v_readfirstlane_b32 s3, v1
 s_lshl_b32 s4, s2, 2
 s_add_u32 s3, s3, s4
 s_cmp_ge_u32 s3, 122
 s_cbranch_scc1 L_prep_end
 s_load_dwordx2 s[4:5], s[0:1], 80
 s_cmp_ge_u32 s3, 20
 s_cbranch_scc1 L_prep_s1
 s_load_dwordx2 s[6:7], s[0:1], 8
 s_mov_b32 s8, 640
 s_sub_u32 s9, s3, 0
 s_mov_b32 s10, 0
 s_mov_b32 s11, 5767168
 s_branch L_prep_sel_done
L_prep_s1:
 s_cmp_ge_u32 s3, 21
 s_cbranch_scc1 L_prep_s2
 s_load_dwordx2 s[6:7], s[0:1], 16
 s_mov_b32 s8, 20
 s_sub_u32 s9, s3, 0
 s_mov_b32 s10, 0
 s_mov_b32 s11, 5767168
 s_branch L_prep_sel_done
L_prep_s2:
 s_cmp_ge_u32 s3, 22
 s_cbranch_scc1 L_prep_s3
 s_load_dwordx2 s[6:7], s[0:1], 24
 s_mov_b32 s8, 20
 s_sub_u32 s9, s3, 0
 s_mov_b32 s10, 0
 s_mov_b32 s11, 5767168
 s_branch L_prep_sel_done
L_prep_s3:
 s_cmp_ge_u32 s3, 42
 s_cbranch_scc1 L_prep_s4
 s_load_dwordx2 s[6:7], s[0:1], 32
 s_mov_b32 s8, 640
 s_sub_u32 s9, s3, 22
 s_mov_b32 s10, 1048576
 s_mov_b32 s11, -1
 s_branch L_prep_sel_done
L_prep_s4:
 s_cmp_ge_u32 s3, 102
 s_cbranch_scc1 L_prep_s5
 s_load_dwordx2 s[6:7], s[0:1], 48
 s_mov_b32 s8, 1920
 s_sub_u32 s9, s3, 42
 s_mov_b32 s10, 2097152
 s_mov_b32 s11, 5771264
 s_branch L_prep_sel_done
L_prep_s5:
 s_cmp_ge_u32 s3, 122
 s_cbranch_scc1 L_prep_s6
 s_load_dwordx2 s[6:7], s[0:1], 56
 s_mov_b32 s8, 640
 s_sub_u32 s9, s3, 102
 s_mov_b32 s10, 4718592
 s_mov_b32 s11, -1
 s_branch L_prep_sel_done
L_prep_s6:
L_prep_sel_done:
 s_waitcnt lgkmcnt(0)
 s_lshl_b32 s12, s9, 5
 s_cmp_eq_u32 s8, 20
 s_cselect_b32 s12, 0, s12
 s_mov_b32 s16, s6
 s_mov_b32 s17, s7
 s_mul_i32 s18, s8, 1280
 s_mov_b32 s19, 0x00020000
 s_mul_i32 s13, s9, 40960
 s_add_u32 s13, s13, s10
 s_add_u32 s20, s4, s13
 s_addc_u32 s21, s5, 0
 s_mov_b32 s22, 40960
 s_mov_b32 s23, 0x00020000
 v_and_b32 v1, 31, v0
 v_add_u32 v1, s12, v1
 v_bfe_u32 v2, v0, 5, 1
 v_lshlrev_b32 v2, 3, v2
 v_mul_lo_u32 v2, v2, s8
 v_add_u32 v2, v2, v1
 v_lshlrev_b32 v2, 1, v2
 v_cmp_gt_u32 vcc, s8, v1
 v_mov_b32 v3, 0x7fffff00
 s_nop 0
 v_cndmask_b32 v2, v3, v2, vcc
 s_lshl_b32 s14, s8, 1
 s_mov_b32 s15, 0
 v_and_b32 v4, 63, v0
 v_lshlrev_b32 v4, 4, v4
 v_mov_b32 v5, 0
 buffer_load_ushort v32, v2, s[16:19], s15 offen
 s_add_u32 s15, s15, s14
 buffer_load_ushort v33, v2, s[16:19], s15 offen
 s_add_u32 s15, s15, s14
 buffer_load_ushort v34, v2, s[16:19], s15 offen
 s_add_u32 s15, s15, s14
 buffer_load_ushort v35, v2, s[16:19], s15 offen
 s_add_u32 s15, s15, s14
 buffer_load_ushort v36, v2, s[16:19], s15 offen
 s_add_u32 s15, s15, s14
 buffer_load_ushort v37, v2, s[16:19], s15 offen
 s_add_u32 s15, s15, s14
 buffer_load_ushort v38, v2, s[16:19], s15 offen
 s_add_u32 s15, s15, s14
 buffer_load_ushort v39, v2, s[16:19], s15 offen
 s_add_u32 s15, s15, s14
 s_lshl_b32 s24, s14, 3
 s_add_u32 s15, s15, s24
 buffer_load_ushort v40, v2, s[16:19], s15 offen
 s_add_u32 s15, s15, s14
 buffer_load_ushort v41, v2, s[16:19], s15 offen
 s_add_u32 s15, s15, s14
 buffer_load_ushort v42, v2, s[16:19], s15 offen
 s_add_u32 s15, s15, s14
 buffer_load_ushort v43, v2, s[16:19], s15 offen
 s_add_u32 s15, s15, s14
 buffer_load_ushort v44, v2, s[16:19], s15 offen
 s_add_u32 s15, s15, s14
 buffer_load_ushort v45, v2, s[16:19], s15 offen
 s_add_u32 s15, s15, s14
 buffer_load_ushort v46, v2, s[16:19], s15 offen
 s_add_u32 s15, s15, s14
 buffer_load_ushort v47, v2, s[16:19], s15 offen
 s_add_u32 s15, s15, s14
 s_lshl_b32 s24, s14, 3
 s_add_u32 s15, s15, s24
 buffer_load_ushort v48, v2, s[16:19], s15 offen
 s_add_u32 s15, s15, s14
 buffer_load_ushort v49, v2, s[16:19], s15 offen
 s_add_u32 s15, s15, s14
 buffer_load_ushort v50, v2, s[16:19], s15 offen
 s_add_u32 s15, s15, s14
 buffer_load_ushort v51, v2, s[16:19], s15 offen
 s_add_u32 s15, s15, s14
 buffer_load_ushort v52, v2, s[16:19], s15 offen
 s_add_u32 s15, s15, s14
 buffer_load_ushort v53, v2, s[16:19], s15 offen
 s_add_u32 s15, s15, s14
 buffer_load_ushort v54, v2, s[16:19], s15 offen
 s_add_u32 s15, s15, s14
 buffer_load_ushort v55, v2, s[16:19], s15 offen
 s_add_u32 s15, s15, s14
 s_lshl_b32 s24, s14, 3
 s_add_u32 s15, s15, s24
 buffer_load_ushort v56, v2, s[16:19], s15 offen
 s_add_u32 s15, s15, s14
 buffer_load_ushort v57, v2, s[16:19], s15 offen
 s_add_u32 s15, s15, s14
 buffer_load_ushort v58, v2, s[16:19], s15 offen
 s_add_u32 s15, s15, s14
 buffer_load_ushort v59, v2, s[16:19], s15 offen
 s_add_u32 s15, s15, s14
 buffer_load_ushort v60, v2, s[16:19], s15 offen
 s_add_u32 s15, s15, s14
 buffer_load_ushort v61, v2, s[16:19], s15 offen
 s_add_u32 s15, s15, s14
 buffer_load_ushort v62, v2, s[16:19], s15 offen
 s_add_u32 s15, s15, s14
 buffer_load_ushort v63, v2, s[16:19], s15 offen
 s_add_u32 s15, s15, s14
 s_lshl_b32 s24, s14, 3
 s_add_u32 s15, s15, s24
 buffer_load_ushort v64, v2, s[16:19], s15 offen
 s_add_u32 s15, s15, s14
 buffer_load_ushort v65, v2, s[16:19], s15 offen
 s_add_u32 s15, s15, s14
 buffer_load_ushort v66, v2, s[16:19], s15 offen
 s_add_u32 s15, s15, s14
 buffer_load_ushort v67, v2, s[16:19], s15 offen
 s_add_u32 s15, s15, s14
 buffer_load_ushort v68, v2, s[16:19], s15 offen
 s_add_u32 s15, s15, s14
 buffer_load_ushort v69, v2, s[16:19], s15 offen
 s_add_u32 s15, s15, s14
 buffer_load_ushort v70, v2, s[16:19], s15 offen
 s_add_u32 s15, s15, s14
 buffer_load_ushort v71, v2, s[16:19], s15 offen
 s_add_u32 s15, s15, s14
 s_lshl_b32 s24, s14, 3
 s_add_u32 s15, s15, s24
 buffer_load_ushort v72, v2, s[16:19], s15 offen
 s_add_u32 s15, s15, s14
 buffer_load_ushort v73, v2, s[16:19], s15 offen
 s_add_u32 s15, s15, s14
 buffer_load_ushort v74, v2, s[16:19], s15 offen
 s_add_u32 s15, s15, s14
 buffer_load_ushort v75, v2, s[16:19], s15 offen
 s_add_u32 s15, s15, s14
 buffer_load_ushort v76, v2, s[16:19], s15 offen
 s_add_u32 s15, s15, s14
 buffer_load_ushort v77, v2, s[16:19], s15 offen
 s_add_u32 s15, s15, s14
 buffer_load_ushort v78, v2, s[16:19], s15 offen
 s_add_u32 s15, s15, s14
 buffer_load_ushort v79, v2, s[16:19], s15 offen
 s_add_u32 s15, s15, s14
 s_lshl_b32 s24, s14, 3
 s_add_u32 s15, s15, s24
 buffer_load_ushort v80, v2, s[16:19], s15 offen
 s_add_u32 s15, s15, s14
 buffer_load_ushort v81, v2, s[16:19], s15 offen
 s_add_u32 s15, s15, s14
 buffer_load_ushort v82, v2, s[16:19], s15 offen
 s_add_u32 s15, s15, s14
 buffer_load_ushort v83, v2, s[16:19], s15 offen
 s_add_u32 s15, s15, s14
 buffer_load_ushort v84, v2, s[16:19], s15 offen
 s_add_u32 s15, s15, s14
 buffer_load_ushort v85, v2, s[16:19], s15 offen
 s_add_u32 s15, s15, s14
 buffer_load_ushort v86, v2, s[16:19], s15 offen
 s_add_u32 s15, s15, s14
 buffer_load_ushort v87, v2, s[16:19], s15 offen
 s_add_u32 s15, s15, s14
 s_lshl_b32 s24, s14, 3
 s_add_u32 s15, s15, s24
 buffer_load_ushort v88, v2, s[16:19], s15 offen
 s_add_u32 s15, s15, s14
 buffer_load_ushort v89, v2, s[16:19], s15 offen
 s_add_u32 s15, s15, s14
 buffer_load_ushort v90, v2, s[16:19], s15 offen
 s_add_u32 s15, s15, s14
 buffer_load_ushort v91, v2, s[16:19], s15 offen
 s_add_u32 s15, s15, s14
 buffer_load_ushort v92, v2, s[16:19], s15 offen
 s_add_u32 s15, s15, s14
 buffer_load_ushort v93, v2, s[16:19], s15 offen
 s_add_u32 s15, s15, s14
 buffer_load_ushort v94, v2, s[16:19], s15 offen
 s_add_u32 s15, s15, s14
 buffer_load_ushort v95, v2, s[16:19], s15 offen
 s_add_u32 s15, s15, s14
 s_lshl_b32 s24, s14, 3
 s_add_u32 s15, s15, s24
 buffer_load_ushort v96, v2, s[16:19], s15 offen
 s_add_u32 s15, s15, s14
 buffer_load_ushort v97, v2, s[16:19], s15 offen
 s_add_u32 s15, s15, s14
 buffer_load_ushort v98, v2, s[16:19], s15 offen
 s_add_u32 s15, s15, s14
 buffer_load_ushort v99, v2, s[16:19], s15 offen
 s_add_u32 s15, s15, s14
 buffer_load_ushort v100, v2, s[16:19], s15 offen
 s_add_u32 s15, s15, s14
 buffer_load_ushort v101, v2, s[16:19], s15 offen
 s_add_u32 s15, s15, s14
 buffer_load_ushort v102, v2, s[16:19], s15 offen
 s_add_u32 s15, s15, s14
 buffer_load_ushort v103, v2, s[16:19], s15 offen
 s_add_u32 s15, s15, s14
 s_lshl_b32 s24, s14, 3
 s_add_u32 s15, s15, s24
 buffer_load_ushort v104, v2, s[16:19], s15 offen
 s_add_u32 s15, s15, s14
 buffer_load_ushort v105, v2, s[16:19], s15 offen
 s_add_u32 s15, s15, s14
 buffer_load_ushort v106, v2, s[16:19], s15 offen
 s_add_u32 s15, s15, s14
 buffer_load_ushort v107, v2, s[16:19], s15 offen
 s_add_u32 s15, s15, s14
 buffer_load_ushort v108, v2, s[16:19], s15 offen
 s_add_u32 s15, s15, s14
 buffer_load_ushort v109, v2, s[16:19], s15 offen
 s_add_u32 s15, s15, s14
 buffer_load_ushort v110, v2, s[16:19], s15 offen
 s_add_u32 s15, s15, s14
 buffer_load_ushort v111, v2, s[16:19], s15 offen
 s_add_u32 s15, s15, s14
 s_lshl_b32 s24, s14, 3
 s_add_u32 s15, s15, s24
 buffer_load_ushort v112, v2, s[16:19], s15 offen
 s_add_u32 s15, s15, s14
 buffer_load_ushort v113, v2, s[16:19], s15 offen
 s_add_u32 s15, s15, s14
 buffer_load_ushort v114, v2, s[16:19], s15 offen
 s_add_u32 s15, s15, s14
 buffer_load_ushort v115, v2, s[16:19], s15 offen
 s_add_u32 s15, s15, s14
 buffer_load_ushort v116, v2, s[16:19], s15 offen
 s_add_u32 s15, s15, s14
 buffer_load_ushort v117, v2, s[16:19], s15 offen
 s_add_u32 s15, s15, s14
 buffer_load_ushort v118, v2, s[16:19], s15 offen
 s_add_u32 s15, s15, s14
 buffer_load_ushort v119, v2, s[16:19], s15 offen
 s_add_u32 s15, s15, s14
 s_lshl_b32 s24, s14, 3
 s_add_u32 s15, s15, s24
 buffer_load_ushort v120, v2, s[16:19], s15 offen
 s_add_u32 s15, s15, s14
 buffer_load_ushort v121, v2, s[16:19], s15 offen
 s_add_u32 s15, s15, s14
 buffer_load_ushort v122, v2, s[16:19], s15 offen
 s_add_u32 s15, s15, s14
 buffer_load_ushort v123, v2, s[16:19], s15 offen
 s_add_u32 s15, s15, s14
 buffer_load_ushort v124, v2, s[16:19], s15 offen
 s_add_u32 s15, s15, s14
 buffer_load_ushort v125, v2, s[16:19], s15 offen
 s_add_u32 s15, s15, s14
 buffer_load_ushort v126, v2, s[16:19], s15 offen
 s_add_u32 s15, s15, s14
 buffer_load_ushort v127, v2, s[16:19], s15 offen
 s_add_u32 s15, s15, s14
 s_lshl_b32 s24, s14, 3
 s_add_u32 s15, s15, s24
 buffer_load_ushort v128, v2, s[16:19], s15 offen
 s_add_u32 s15, s15, s14
 buffer_load_ushort v129, v2, s[16:19], s15 offen
 s_add_u32 s15, s15, s14
 buffer_load_ushort v130, v2, s[16:19], s15 offen
 s_add_u32 s15, s15, s14
 buffer_load_ushort v131, v2, s[16:19], s15 offen
 s_add_u32 s15, s15, s14
 buffer_load_ushort v132, v2, s[16:19], s15 offen
 s_add_u32 s15, s15, s14
 buffer_load_ushort v133, v2, s[16:19], s15 offen
 s_add_u32 s15, s15, s14
 buffer_load_ushort v134, v2, s[16:19], s15 offen
 s_add_u32 s15, s15, s14
 buffer_load_ushort v135, v2, s[16:19], s15 offen
 s_add_u32 s15, s15, s14
 s_lshl_b32 s24, s14, 3
 s_add_u32 s15, s15, s24
 buffer_load_ushort v136, v2, s[16:19], s15 offen
 s_add_u32 s15, s15, s14
 buffer_load_ushort v137, v2, s[16:19], s15 offen
 s_add_u32 s15, s15, s14
 buffer_load_ushort v138, v2, s[16:19], s15 offen
 s_add_u32 s15, s15, s14
 buffer_load_ushort v139, v2, s[16:19], s15 offen
 s_add_u32 s15, s15, s14
 buffer_load_ushort v140, v2, s[16:19], s15 offen
 s_add_u32 s15, s15, s14
 buffer_load_ushort v141, v2, s[16:19], s15 offen
 s_add_u32 s15, s15, s14
 buffer_load_ushort v142, v2, s[16:19], s15 offen
 s_add_u32 s15, s15, s14
 buffer_load_ushort v143, v2, s[16:19], s15 offen
 s_add_u32 s15, s15, s14
 s_lshl_b32 s24, s14, 3
 s_add_u32 s15, s15, s24
 buffer_load_ushort v144, v2, s[16:19], s15 offen
 s_add_u32 s15, s15, s14
 buffer_load_ushort v145, v2, s[16:19], s15 offen
 s_add_u32 s15, s15, s14
 buffer_load_ushort v146, v2, s[16:19], s15 offen
 s_add_u32 s15, s15, s14
 buffer_load_ushort v147, v2, s[16:19], s15 offen
 s_add_u32 s15, s15, s14
 buffer_load_ushort v148, v2, s[16:19], s15 offen
 s_add_u32 s15, s15, s14
 buffer_load_ushort v149, v2, s[16:19], s15 offen
 s_add_u32 s15, s15, s14
 buffer_load_ushort v150, v2, s[16:19], s15 offen
 s_add_u32 s15, s15, s14
 buffer_load_ushort v151, v2, s[16:19], s15 offen
 s_add_u32 s15, s15, s14
 s_lshl_b32 s24, s14, 3
 s_add_u32 s15, s15, s24
 buffer_load_ushort v152, v2, s[16:19], s15 offen
 s_add_u32 s15, s15, s14
 buffer_load_ushort v153, v2, s[16:19], s15 offen
 s_add_u32 s15, s15, s14
 buffer_load_ushort v154, v2, s[16:19], s15 offen
 s_add_u32 s15, s15, s14
 buffer_load_ushort v155, v2, s[16:19], s15 offen
 s_add_u32 s15, s15, s14
 buffer_load_ushort v156, v2, s[16:19], s15 offen
 s_add_u32 s15, s15, s14
 buffer_load_ushort v157, v2, s[16:19], s15 offen
 s_add_u32 s15, s15, s14
 buffer_load_ushort v158, v2, s[16:19], s15 offen
 s_add_u32 s15, s15, s14
 buffer_load_ushort v159, v2, s[16:19], s15 offen
 s_add_u32 s15, s15, s14
 s_lshl_b32 s24, s14, 3
 s_add_u32 s15, s15, s24
 buffer_load_ushort v160, v2, s[16:19], s15 offen
 s_add_u32 s15, s15, s14
 buffer_load_ushort v161, v2, s[16:19], s15 offen
 s_add_u32 s15, s15, s14
 buffer_load_ushort v162, v2, s[16:19], s15 offen
 s_add_u32 s15, s15, s14
 buffer_load_ushort v163, v2, s[16:19], s15 offen
 s_add_u32 s15, s15, s14
 buffer_load_ushort v164, v2, s[16:19], s15 offen
 s_add_u32 s15, s15, s14
 buffer_load_ushort v165, v2, s[16:19], s15 offen
 s_add_u32 s15, s15, s14
 buffer_load_ushort v166, v2, s[16:19], s15 offen
 s_add_u32 s15, s15, s14
 buffer_load_ushort v167, v2, s[16:19], s15 offen
 s_add_u32 s15, s15, s14
 s_lshl_b32 s24, s14, 3
 s_add_u32 s15, s15, s24
 buffer_load_ushort v168, v2, s[16:19], s15 offen
 s_add_u32 s15, s15, s14
 buffer_load_ushort v169, v2, s[16:19], s15 offen
 s_add_u32 s15, s15, s14
 buffer_load_ushort v170, v2, s[16:19], s15 offen
 s_add_u32 s15, s15, s14
 buffer_load_ushort v171, v2, s[16:19], s15 offen
 s_add_u32 s15, s15, s14
 buffer_load_ushort v172, v2, s[16:19], s15 offen
 s_add_u32 s15, s15, s14
 buffer_load_ushort v173, v2, s[16:19], s15 offen
 s_add_u32 s15, s15, s14
 buffer_load_ushort v174, v2, s[16:19], s15 offen
 s_add_u32 s15, s15, s14
 buffer_load_ushort v175, v2, s[16:19], s15 offen
 s_add_u32 s15, s15, s14
 s_lshl_b32 s24, s14, 3
 s_add_u32 s15, s15, s24
 buffer_load_ushort v176, v2, s[16:19], s15 offen
 s_add_u32 s15, s15, s14
 buffer_load_ushort v177, v2, s[16:19], s15 offen
 s_add_u32 s15, s15, s14
 buffer_load_ushort v178, v2, s[16:19], s15 offen
 s_add_u32 s15, s15, s14
 buffer_load_ushort v179, v2, s[16:19], s15 offen
 s_add_u32 s15, s15, s14
 buffer_load_ushort v180, v2, s[16:19], s15 offen
 s_add_u32 s15, s15, s14
 buffer_load_ushort v181, v2, s[16:19], s15 offen
 s_add_u32 s15, s15, s14
 buffer_load_ushort v182, v2, s[16:19], s15 offen
 s_add_u32 s15, s15, s14
 buffer_load_ushort v183, v2, s[16:19], s15 offen
 s_add_u32 s15, s15, s14
 s_lshl_b32 s24, s14, 3
 s_add_u32 s15, s15, s24
 buffer_load_ushort v184, v2, s[16:19], s15 offen
 s_add_u32 s15, s15, s14
 buffer_load_ushort v185, v2, s[16:19], s15 offen
 s_add_u32 s15, s15, s14
 buffer_load_ushort v186, v2, s[16:19], s15 offen
 s_add_u32 s15, s15, s14
 buffer_load_ushort v187, v2, s[16:19], s15 offen
 s_add_u32 s15, s15, s14
 buffer_load_ushort v188, v2, s[16:19], s15 offen
 s_add_u32 s15, s15, s14
 buffer_load_ushort v189, v2, s[16:19], s15 offen
 s_add_u32 s15, s15, s14
 buffer_load_ushort v190, v2, s[16:19], s15 offen
 s_add_u32 s15, s15, s14
 buffer_load_ushort v191, v2, s[16:19], s15 offen
 s_add_u32 s15, s15, s14
 s_lshl_b32 s24, s14, 3
 s_add_u32 s15, s15, s24
 s_waitcnt vmcnt(63)
 v_lshlrev_b32 v6, 16, v32
 v_lshlrev_b32 v7, 16, v33
 v_add_f32 v5, v5, v6
 v_add_f32 v5, v5, v7
 v_lshl_or_b32 v8, v33, 16, v32
 v_lshlrev_b32 v6, 16, v34
 v_lshlrev_b32 v7, 16, v35
 v_add_f32 v5, v5, v6
 v_add_f32 v5, v5, v7
 v_lshl_or_b32 v9, v35, 16, v34
 v_lshlrev_b32 v6, 16, v36
 v_lshlrev_b32 v7, 16, v37
 v_add_f32 v5, v5, v6
 v_add_f32 v5, v5, v7
 v_lshl_or_b32 v10, v37, 16, v36
 v_lshlrev_b32 v6, 16, v38
 v_lshlrev_b32 v7, 16, v39
 v_add_f32 v5, v5, v6
 v_add_f32 v5, v5, v7
 v_lshl_or_b32 v11, v39, 16, v38
 buffer_store_dwordx4 v[8:11], v4, s[20:23], 0 offen
 v_add_u32 v4, 1024, v4
 s_waitcnt vmcnt(63)
 v_lshlrev_b32 v6, 16, v40
 v_lshlrev_b32 v7, 16, v41
 v_add_f32 v5, v5, v6
 v_add_f32 v5, v5, v7
 v_lshl_or_b32 v8, v41, 16, v40
 v_lshlrev_b32 v6, 16, v42
 v_lshlrev_b32 v7, 16, v43
 v_add_f32 v5, v5, v6
 v_add_f32 v5, v5, v7
 v_lshl_or_b32 v9, v43, 16, v42
 v_lshlrev_b32 v6, 16, v44
 v_lshlrev_b32 v7, 16, v45
 v_add_f32 v5, v5, v6
 v_add_f32 v5, v5, v7
 v_lshl_or_b32 v10, v45, 16, v44
 v_lshlrev_b32 v6, 16, v46
 v_lshlrev_b32 v7, 16, v47
 v_add_f32 v5, v5, v6
 v_add_f32 v5, v5, v7
 v_lshl_or_b32 v11, v47, 16, v46
 buffer_store_dwordx4 v[8:11], v4, s[20:23], 0 offen
 v_add_u32 v4, 1024, v4
 s_waitcnt vmcnt(63)
 v_lshlrev_b32 v6, 16, v48
 v_lshlrev_b32 v7, 16, v49
 v_add_f32 v5, v5, v6
 v_add_f32 v5, v5, v7
 v_lshl_or_b32 v8, v49, 16, v48
 v_lshlrev_b32 v6, 16, v50
 v_lshlrev_b32 v7, 16, v51
 v_add_f32 v5, v5, v6
 v_add_f32 v5, v5, v7
 v_lshl_or_b32 v9, v51, 16, v50
 v_lshlrev_b32 v6, 16, v52
 v_lshlrev_b32 v7, 16, v53
 v_add_f32 v5, v5, v6
 v_add_f32 v5, v5, v7
 v_lshl_or_b32 v10, v53, 16, v52
 v_lshlrev_b32 v6, 16, v54
 v_lshlrev_b32 v7, 16, v55
 v_add_f32 v5, v5, v6
 v_add_f32 v5, v5, v7
 v_lshl_or_b32 v11, v55, 16, v54
 buffer_store_dwordx4 v[8:11], v4, s[20:23], 0 offen
 v_add_u32 v4, 1024, v4
 s_waitcnt vmcnt(63)
 v_lshlrev_b32 v6, 16, v56
 v_lshlrev_b32 v7, 16, v57
 v_add_f32 v5, v5, v6
 v_add_f32 v5, v5, v7
 v_lshl_or_b32 v8, v57, 16, v56
 v_lshlrev_b32 v6, 16, v58
 v_lshlrev_b32 v7, 16, v59
 v_add_f32 v5, v5, v6
 v_add_f32 v5, v5, v7
 v_lshl_or_b32 v9, v59, 16, v58
 v_lshlrev_b32 v6, 16, v60
 v_lshlrev_b32 v7, 16, v61
 v_add_f32 v5, v5, v6
 v_add_f32 v5, v5, v7
 v_lshl_or_b32 v10, v61, 16, v60
 v_lshlrev_b32 v6, 16, v62
 v_lshlrev_b32 v7, 16, v63
 v_add_f32 v5, v5, v6
 v_add_f32 v5, v5, v7
 v_lshl_or_b32 v11, v63, 16, v62
 buffer_store_dwordx4 v[8:11], v4, s[20:23], 0 offen
 v_add_u32 v4, 1024, v4
 s_waitcnt vmcnt(63)
 v_lshlrev_b32 v6, 16, v64
 v_lshlrev_b32 v7, 16, v65
 v_add_f32 v5, v5, v6
 v_add_f32 v5, v5, v7
 v_lshl_or_b32 v8, v65, 16, v64
 v_lshlrev_b32 v6, 16, v66
 v_lshlrev_b32 v7, 16, v67
 v_add_f32 v5, v5, v6
 v_add_f32 v5, v5, v7
 v_lshl_or_b32 v9, v67, 16, v66
 v_lshlrev_b32 v6, 16, v68
 v_lshlrev_b32 v7, 16, v69
 v_add_f32 v5, v5, v6
 v_add_f32 v5, v5, v7
 v_lshl_or_b32 v10, v69, 16, v68
 v_lshlrev_b32 v6, 16, v70
 v_lshlrev_b32 v7, 16, v71
 v_add_f32 v5, v5, v6
 v_add_f32 v5, v5, v7
 v_lshl_or_b32 v11, v71, 16, v70
 buffer_store_dwordx4 v[8:11], v4, s[20:23], 0 offen
 v_add_u32 v4, 1024, v4
 s_waitcnt vmcnt(63)
 v_lshlrev_b32 v6, 16, v72
 v_lshlrev_b32 v7, 16, v73
 v_add_f32 v5, v5, v6
 v_add_f32 v5, v5, v7
 v_lshl_or_b32 v8, v73, 16, v72
 v_lshlrev_b32 v6, 16, v74
 v_lshlrev_b32 v7, 16, v75
 v_add_f32 v5, v5, v6
 v_add_f32 v5, v5, v7
 v_lshl_or_b32 v9, v75, 16, v74
 v_lshlrev_b32 v6, 16, v76
 v_lshlrev_b32 v7, 16, v77
 v_add_f32 v5, v5, v6
 v_add_f32 v5, v5, v7
 v_lshl_or_b32 v10, v77, 16, v76
 v_lshlrev_b32 v6, 16, v78
 v_lshlrev_b32 v7, 16, v79
 v_add_f32 v5, v5, v6
 v_add_f32 v5, v5, v7
 v_lshl_or_b32 v11, v79, 16, v78
 buffer_store_dwordx4 v[8:11], v4, s[20:23], 0 offen
 v_add_u32 v4, 1024, v4
 s_waitcnt vmcnt(63)
 v_lshlrev_b32 v6, 16, v80
 v_lshlrev_b32 v7, 16, v81
 v_add_f32 v5, v5, v6
 v_add_f32 v5, v5, v7
 v_lshl_or_b32 v8, v81, 16, v80
 v_lshlrev_b32 v6, 16, v82
 v_lshlrev_b32 v7, 16, v83
 v_add_f32 v5, v5, v6
 v_add_f32 v5, v5, v7
 v_lshl_or_b32 v9, v83, 16, v82
 v_lshlrev_b32 v6, 16, v84
 v_lshlrev_b32 v7, 16, v85
 v_add_f32 v5, v5, v6
 v_add_f32 v5, v5, v7
 v_lshl_or_b32 v10, v85, 16, v84
 v_lshlrev_b32 v6, 16, v86
 v_lshlrev_b32 v7, 16, v87
 v_add_f32 v5, v5, v6
 v_add_f32 v5, v5, v7
 v_lshl_or_b32 v11, v87, 16, v86
 buffer_store_dwordx4 v[8:11], v4, s[20:23], 0 offen
 v_add_u32 v4, 1024, v4
 s_waitcnt vmcnt(63)
 v_lshlrev_b32 v6, 16, v88
 v_lshlrev_b32 v7, 16, v89
 v_add_f32 v5, v5, v6
 v_add_f32 v5, v5, v7
 v_lshl_or_b32 v8, v89, 16, v88
 v_lshlrev_b32 v6, 16, v90
 v_lshlrev_b32 v7, 16, v91
 v_add_f32 v5, v5, v6
 v_add_f32 v5, v5, v7
 v_lshl_or_b32 v9, v91, 16, v90
 v_lshlrev_b32 v6, 16, v92
 v_lshlrev_b32 v7, 16, v93
 v_add_f32 v5, v5, v6
 v_add_f32 v5, v5, v7
 v_lshl_or_b32 v10, v93, 16, v92
 v_lshlrev_b32 v6, 16, v94
 v_lshlrev_b32 v7, 16, v95
 v_add_f32 v5, v5, v6
 v_add_f32 v5, v5, v7
 v_lshl_or_b32 v11, v95, 16, v94
 buffer_store_dwordx4 v[8:11], v4, s[20:23], 0 offen
 v_add_u32 v4, 1024, v4
 s_waitcnt vmcnt(63)
 v_lshlrev_b32 v6, 16, v96
 v_lshlrev_b32 v7, 16, v97
 v_add_f32 v5, v5, v6
 v_add_f32 v5, v5, v7
 v_lshl_or_b32 v8, v97, 16, v96
 v_lshlrev_b32 v6, 16, v98
 v_lshlrev_b32 v7, 16, v99
 v_add_f32 v5, v5, v6
 v_add_f32 v5, v5, v7
 v_lshl_or_b32 v9, v99, 16, v98
 v_lshlrev_b32 v6, 16, v100
 v_lshlrev_b32 v7, 16, v101
 v_add_f32 v5, v5, v6
 v_add_f32 v5, v5, v7
 v_lshl_or_b32 v10, v101, 16, v100
 v_lshlrev_b32 v6, 16, v102
 v_lshlrev_b32 v7, 16, v103
 v_add_f32 v5, v5, v6
 v_add_f32 v5, v5, v7
 v_lshl_or_b32 v11, v103, 16, v102
 buffer_store_dwordx4 v[8:11], v4, s[20:23], 0 offen
 v_add_u32 v4, 1024, v4
 s_waitcnt vmcnt(63)
 v_lshlrev_b32 v6, 16, v104
 v_lshlrev_b32 v7, 16, v105
 v_add_f32 v5, v5, v6
 v_add_f32 v5, v5, v7
 v_lshl_or_b32 v8, v105, 16, v104
 v_lshlrev_b32 v6, 16, v106
 v_lshlrev_b32 v7, 16, v107
 v_add_f32 v5, v5, v6
 v_add_f32 v5, v5, v7
 v_lshl_or_b32 v9, v107, 16, v106
 v_lshlrev_b32 v6, 16, v108
 v_lshlrev_b32 v7, 16, v109
 v_add_f32 v5, v5, v6
 v_add_f32 v5, v5, v7
 v_lshl_or_b32 v10, v109, 16, v108
 v_lshlrev_b32 v6, 16, v110
 v_lshlrev_b32 v7, 16, v111
 v_add_f32 v5, v5, v6
 v_add_f32 v5, v5, v7
 v_lshl_or_b32 v11, v111, 16, v110
 buffer_store_dwordx4 v[8:11], v4, s[20:23], 0 offen
 v_add_u32 v4, 1024, v4
 s_waitcnt vmcnt(63)
 v_lshlrev_b32 v6, 16, v112
 v_lshlrev_b32 v7, 16, v113
 v_add_f32 v5, v5, v6
 v_add_f32 v5, v5, v7
 v_lshl_or_b32 v8, v113, 16, v112
 v_lshlrev_b32 v6, 16, v114
 v_lshlrev_b32 v7, 16, v115
 v_add_f32 v5, v5, v6
 v_add_f32 v5, v5, v7
 v_lshl_or_b32 v9, v115, 16, v114
 v_lshlrev_b32 v6, 16, v116
 v_lshlrev_b32 v7, 16, v117
 v_add_f32 v5, v5, v6
 v_add_f32 v5, v5, v7
 v_lshl_or_b32 v10, v117, 16, v116
 v_lshlrev_b32 v6, 16, v118
 v_lshlrev_b32 v7, 16, v119
 v_add_f32 v5, v5, v6
 v_add_f32 v5, v5, v7
 v_lshl_or_b32 v11, v119, 16, v118
 buffer_store_dwordx4 v[8:11], v4, s[20:23], 0 offen
 v_add_u32 v4, 1024, v4
 s_waitcnt vmcnt(63)
 v_lshlrev_b32 v6, 16, v120
 v_lshlrev_b32 v7, 16, v121
 v_add_f32 v5, v5, v6
 v_add_f32 v5, v5, v7
 v_lshl_or_b32 v8, v121, 16, v120
 v_lshlrev_b32 v6, 16, v122
 v_lshlrev_b32 v7, 16, v123
 v_add_f32 v5, v5, v6
 v_add_f32 v5, v5, v7
 v_lshl_or_b32 v9, v123, 16, v122
 v_lshlrev_b32 v6, 16, v124
 v_lshlrev_b32 v7, 16, v125
 v_add_f32 v5, v5, v6
 v_add_f32 v5, v5, v7
 v_lshl_or_b32 v10, v125, 16, v124
 v_lshlrev_b32 v6, 16, v126
 v_lshlrev_b32 v7, 16, v127
 v_add_f32 v5, v5, v6
 v_add_f32 v5, v5, v7
 v_lshl_or_b32 v11, v127, 16, v126
 buffer_store_dwordx4 v[8:11], v4, s[20:23], 0 offen
 v_add_u32 v4, 1024, v4
 s_waitcnt vmcnt(63)
 v_lshlrev_b32 v6, 16, v128
 v_lshlrev_b32 v7, 16, v129
 v_add_f32 v5, v5, v6
 v_add_f32 v5, v5, v7
 v_lshl_or_b32 v8, v129, 16, v128
 v_lshlrev_b32 v6, 16, v130
 v_lshlrev_b32 v7, 16, v131
 v_add_f32 v5, v5, v6
 v_add_f32 v5, v5, v7
 v_lshl_or_b32 v9, v131, 16, v130
 v_lshlrev_b32 v6, 16, v132
 v_lshlrev_b32 v7, 16, v133
 v_add_f32 v5, v5, v6
 v_add_f32 v5, v5, v7
 v_lshl_or_b32 v10, v133, 16, v132
 v_lshlrev_b32 v6, 16, v134
 v_lshlrev_b32 v7, 16, v135
 v_add_f32 v5, v5, v6
 v_add_f32 v5, v5, v7
 v_lshl_or_b32 v11, v135, 16, v134
 buffer_store_dwordx4 v[8:11], v4, s[20:23], 0 offen
 v_add_u32 v4, 1024, v4
 s_waitcnt vmcnt(61)
 v_lshlrev_b32 v6, 16, v136
 v_lshlrev_b32 v7, 16, v137
 v_add_f32 v5, v5, v6
 v_add_f32 v5, v5, v7
 v_lshl_or_b32 v8, v137, 16, v136
 v_lshlrev_b32 v6, 16, v138
 v_lshlrev_b32 v7, 16, v139
 v_add_f32 v5, v5, v6
 v_add_f32 v5, v5, v7
 v_lshl_or_b32 v9, v139, 16, v138
 v_lshlrev_b32 v6, 16, v140
 v_lshlrev_b32 v7, 16, v141
 v_add_f32 v5, v5, v6
 v_add_f32 v5, v5, v7
 v_lshl_or_b32 v10, v141, 16, v140
 v_lshlrev_b32 v6, 16, v142
 v_lshlrev_b32 v7, 16, v143
 v_add_f32 v5, v5, v6
 v_add_f32 v5, v5, v7
 v_lshl_or_b32 v11, v143, 16, v142
 buffer_store_dwordx4 v[8:11], v4, s[20:23], 0 offen
 v_add_u32 v4, 1024, v4
 s_waitcnt vmcnt(54)
 v_lshlrev_b32 v6, 16, v144
 v_lshlrev_b32 v7, 16, v145
 v_add_f32 v5, v5, v6
 v_add_f32 v5, v5, v7
 v_lshl_or_b32 v8, v145, 16, v144
 v_lshlrev_b32 v6, 16, v146
 v_lshlrev_b32 v7, 16, v147
 v_add_f32 v5, v5, v6
 v_add_f32 v5, v5, v7
 v_lshl_or_b32 v9, v147, 16, v146
 v_lshlrev_b32 v6, 16, v148
 v_lshlrev_b32 v7, 16, v149
 v_add_f32 v5, v5, v6
 v_add_f32 v5, v5, v7
 v_lshl_or_b32 v10, v149, 16, v148
 v_lshlrev_b32 v6, 16, v150
 v_lshlrev_b32 v7, 16, v151
 v_add_f32 v5, v5, v6
 v_add_f32 v5, v5, v7
 v_lshl_or_b32 v11, v151, 16, v150
 buffer_store_dwordx4 v[8:11], v4, s[20:23], 0 offen
 v_add_u32 v4, 1024, v4
 s_waitcnt vmcnt(47)
 v_lshlrev_b32 v6, 16, v152
 v_lshlrev_b32 v7, 16, v153
 v_add_f32 v5, v5, v6
 v_add_f32 v5, v5, v7
 v_lshl_or_b32 v8, v153, 16, v152
 v_lshlrev_b32 v6, 16, v154
 v_lshlrev_b32 v7, 16, v155
 v_add_f32 v5, v5, v6
 v_add_f32 v5, v5, v7
 v_lshl_or_b32 v9, v155, 16, v154
 v_lshlrev_b32 v6, 16, v156
 v_lshlrev_b32 v7, 16, v157
 v_add_f32 v5, v5, v6
 v_add_f32 v5, v5, v7
 v_lshl_or_b32 v10, v157, 16, v156
 v_lshlrev_b32 v6, 16, v158
 v_lshlrev_b32 v7, 16, v159
 v_add_f32 v5, v5, v6
 v_add_f32 v5, v5, v7
 v_lshl_or_b32 v11, v159, 16, v158
 buffer_store_dwordx4 v[8:11], v4, s[20:23], 0 offen
 v_add_u32 v4, 1024, v4
 s_waitcnt vmcnt(40)
 v_lshlrev_b32 v6, 16, v160
 v_lshlrev_b32 v7, 16, v161
 v_add_f32 v5, v5, v6
 v_add_f32 v5, v5, v7
 v_lshl_or_b32 v8, v161, 16, v160
 v_lshlrev_b32 v6, 16, v162
 v_lshlrev_b32 v7, 16, v163
 v_add_f32 v5, v5, v6
 v_add_f32 v5, v5, v7
 v_lshl_or_b32 v9, v163, 16, v162
 v_lshlrev_b32 v6, 16, v164
 v_lshlrev_b32 v7, 16, v165
 v_add_f32 v5, v5, v6
 v_add_f32 v5, v5, v7
 v_lshl_or_b32 v10, v165, 16, v164
 v_lshlrev_b32 v6, 16, v166
 v_lshlrev_b32 v7, 16, v167
 v_add_f32 v5, v5, v6
 v_add_f32 v5, v5, v7
 v_lshl_or_b32 v11, v167, 16, v166
 buffer_store_dwordx4 v[8:11], v4, s[20:23], 0 offen
 v_add_u32 v4, 1024, v4
 s_waitcnt vmcnt(33)
 v_lshlrev_b32 v6, 16, v168
 v_lshlrev_b32 v7, 16, v169
 v_add_f32 v5, v5, v6
 v_add_f32 v5, v5, v7
 v_lshl_or_b32 v8, v169, 16, v168
 v_lshlrev_b32 v6, 16, v170
 v_lshlrev_b32 v7, 16, v171
 v_add_f32 v5, v5, v6
 v_add_f32 v5, v5, v7
 v_lshl_or_b32 v9, v171, 16, v170
 v_lshlrev_b32 v6, 16, v172
 v_lshlrev_b32 v7, 16, v173
 v_add_f32 v5, v5, v6
 v_add_f32 v5, v5, v7
 v_lshl_or_b32 v10, v173, 16, v172
 v_lshlrev_b32 v6, 16, v174
 v_lshlrev_b32 v7, 16, v175
 v_add_f32 v5, v5, v6
 v_add_f32 v5, v5, v7
 v_lshl_or_b32 v11, v175, 16, v174
 buffer_store_dwordx4 v[8:11], v4, s[20:23], 0 offen
 v_add_u32 v4, 1024, v4
 s_waitcnt vmcnt(26)
 v_lshlrev_b32 v6, 16, v176
 v_lshlrev_b32 v7, 16, v177
 v_add_f32 v5, v5, v6
 v_add_f32 v5, v5, v7
 v_lshl_or_b32 v8, v177, 16, v176
 v_lshlrev_b32 v6, 16, v178
 v_lshlrev_b32 v7, 16, v179
 v_add_f32 v5, v5, v6
 v_add_f32 v5, v5, v7
 v_lshl_or_b32 v9, v179, 16, v178
 v_lshlrev_b32 v6, 16, v180
 v_lshlrev_b32 v7, 16, v181
 v_add_f32 v5, v5, v6
 v_add_f32 v5, v5, v7
 v_lshl_or_b32 v10, v181, 16, v180
 v_lshlrev_b32 v6, 16, v182
 v_lshlrev_b32 v7, 16, v183
 v_add_f32 v5, v5, v6
 v_add_f32 v5, v5, v7
 v_lshl_or_b32 v11, v183, 16, v182
 buffer_store_dwordx4 v[8:11], v4, s[20:23], 0 offen
 v_add_u32 v4, 1024, v4
 s_waitcnt vmcnt(19)
 v_lshlrev_b32 v6, 16, v184
 v_lshlrev_b32 v7, 16, v185
 v_add_f32 v5, v5, v6
 v_add_f32 v5, v5, v7
 v_lshl_or_b32 v8, v185, 16, v184
 v_lshlrev_b32 v6, 16, v186
 v_lshlrev_b32 v7, 16, v187
 v_add_f32 v5, v5, v6
 v_add_f32 v5, v5, v7
 v_lshl_or_b32 v9, v187, 16, v186
 v_lshlrev_b32 v6, 16, v188
 v_lshlrev_b32 v7, 16, v189
 v_add_f32 v5, v5, v6
 v_add_f32 v5, v5, v7
 v_lshl_or_b32 v10, v189, 16, v188
 v_lshlrev_b32 v6, 16, v190
 v_lshlrev_b32 v7, 16, v191
 v_add_f32 v5, v5, v6
 v_add_f32 v5, v5, v7
 v_lshl_or_b32 v11, v191, 16, v190
 buffer_store_dwordx4 v[8:11], v4, s[20:23], 0 offen
 v_add_u32 v4, 1024, v4
 buffer_load_ushort v32, v2, s[16:19], s15 offen
 s_add_u32 s15, s15, s14
 buffer_load_ushort v33, v2, s[16:19], s15 offen
 s_add_u32 s15, s15, s14
 buffer_load_ushort v34, v2, s[16:19], s15 offen
 s_add_u32 s15, s15, s14
 buffer_load_ushort v35, v2, s[16:19], s15 offen
 s_add_u32 s15, s15, s14
 buffer_load_ushort v36, v2, s[16:19], s15 offen
 s_add_u32 s15, s15, s14
 buffer_load_ushort v37, v2, s[16:19], s15 offen
 s_add_u32 s15, s15, s14
 buffer_load_ushort v38, v2, s[16:19], s15 offen
 s_add_u32 s15, s15, s14
 buffer_load_ushort v39, v2, s[16:19], s15 offen
 s_add_u32 s15, s15, s14
 s_lshl_b32 s24, s14, 3
 s_add_u32 s15, s15, s24
 buffer_load_ushort v40, v2, s[16:19], s15 offen
 s_add_u32 s15, s15, s14
 buffer_load_ushort v41, v2, s[16:19], s15 offen
 s_add_u32 s15, s15, s14
 buffer_load_ushort v42, v2, s[16:19], s15 offen
 s_add_u32 s15, s15, s14
 buffer_load_ushort v43, v2, s[16:19], s15 offen
 s_add_u32 s15, s15, s14
 buffer_load_ushort v44, v2, s[16:19], s15 offen
 s_add_u32 s15, s15, s14
 buffer_load_ushort v45, v2, s[16:19], s15 offen
 s_add_u32 s15, s15, s14
 buffer_load_ushort v46, v2, s[16:19], s15 offen
 s_add_u32 s15, s15, s14
 buffer_load_ushort v47, v2, s[16:19], s15 offen
 s_add_u32 s15, s15, s14
 s_lshl_b32 s24, s14, 3
 s_add_u32 s15, s15, s24
 buffer_load_ushort v48, v2, s[16:19], s15 offen
 s_add_u32 s15, s15, s14
 buffer_load_ushort v49, v2, s[16:19], s15 offen
 s_add_u32 s15, s15, s14
 buffer_load_ushort v50, v2, s[16:19], s15 offen
 s_add_u32 s15, s15, s14
 buffer_load_ushort v51, v2, s[16:19], s15 offen
 s_add_u32 s15, s15, s14
 buffer_load_ushort v52, v2, s[16:19], s15 offen
 s_add_u32 s15, s15, s14
 buffer_load_ushort v53, v2, s[16:19], s15 offen
 s_add_u32 s15, s15, s14
 buffer_load_ushort v54, v2, s[16:19], s15 offen
 s_add_u32 s15, s15, s14
 buffer_load_ushort v55, v2, s[16:19], s15 offen
 s_add_u32 s15, s15, s14
 s_lshl_b32 s24, s14, 3
 s_add_u32 s15, s15, s24
 buffer_load_ushort v56, v2, s[16:19], s15 offen
 s_add_u32 s15, s15, s14
 buffer_load_ushort v57, v2, s[16:19], s15 offen
 s_add_u32 s15, s15, s14
 buffer_load_ushort v58, v2, s[16:19], s15 offen
 s_add_u32 s15, s15, s14
 buffer_load_ushort v59, v2, s[16:19], s15 offen
 s_add_u32 s15, s15, s14
 buffer_load_ushort v60, v2, s[16:19], s15 offen
 s_add_u32 s15, s15, s14
 buffer_load_ushort v61, v2, s[16:19], s15 offen
 s_add_u32 s15, s15, s14
 buffer_load_ushort v62, v2, s[16:19], s15 offen
 s_add_u32 s15, s15, s14
 buffer_load_ushort v63, v2, s[16:19], s15 offen
 s_add_u32 s15, s15, s14
 s_lshl_b32 s24, s14, 3
 s_add_u32 s15, s15, s24
 buffer_load_ushort v64, v2, s[16:19], s15 offen
 s_add_u32 s15, s15, s14
 buffer_load_ushort v65, v2, s[16:19], s15 offen
 s_add_u32 s15, s15, s14
 buffer_load_ushort v66, v2, s[16:19], s15 offen
 s_add_u32 s15, s15, s14
 buffer_load_ushort v67, v2, s[16:19], s15 offen
 s_add_u32 s15, s15, s14
 buffer_load_ushort v68, v2, s[16:19], s15 offen
 s_add_u32 s15, s15, s14
 buffer_load_ushort v69, v2, s[16:19], s15 offen
 s_add_u32 s15, s15, s14
 buffer_load_ushort v70, v2, s[16:19], s15 offen
 s_add_u32 s15, s15, s14
 buffer_load_ushort v71, v2, s[16:19], s15 offen
 s_add_u32 s15, s15, s14
 s_lshl_b32 s24, s14, 3
 s_add_u32 s15, s15, s24
 buffer_load_ushort v72, v2, s[16:19], s15 offen
 s_add_u32 s15, s15, s14
 buffer_load_ushort v73, v2, s[16:19], s15 offen
 s_add_u32 s15, s15, s14
 buffer_load_ushort v74, v2, s[16:19], s15 offen
 s_add_u32 s15, s15, s14
 buffer_load_ushort v75, v2, s[16:19], s15 offen
 s_add_u32 s15, s15, s14
 buffer_load_ushort v76, v2, s[16:19], s15 offen
 s_add_u32 s15, s15, s14
 buffer_load_ushort v77, v2, s[16:19], s15 offen
 s_add_u32 s15, s15, s14
 buffer_load_ushort v78, v2, s[16:19], s15 offen
 s_add_u32 s15, s15, s14
 buffer_load_ushort v79, v2, s[16:19], s15 offen
 s_add_u32 s15, s15, s14
 s_lshl_b32 s24, s14, 3
 s_add_u32 s15, s15, s24
 buffer_load_ushort v80, v2, s[16:19], s15 offen
 s_add_u32 s15, s15, s14
 buffer_load_ushort v81, v2, s[16:19], s15 offen
 s_add_u32 s15, s15, s14
 buffer_load_ushort v82, v2, s[16:19], s15 offen
 s_add_u32 s15, s15, s14
 buffer_load_ushort v83, v2, s[16:19], s15 offen
 s_add_u32 s15, s15, s14
 buffer_load_ushort v84, v2, s[16:19], s15 offen
 s_add_u32 s15, s15, s14
 buffer_load_ushort v85, v2, s[16:19], s15 offen
 s_add_u32 s15, s15, s14
 buffer_load_ushort v86, v2, s[16:19], s15 offen
 s_add_u32 s15, s15, s14
 buffer_load_ushort v87, v2, s[16:19], s15 offen
 s_add_u32 s15, s15, s14
 s_lshl_b32 s24, s14, 3
 s_add_u32 s15, s15, s24
 buffer_load_ushort v88, v2, s[16:19], s15 offen
 s_add_u32 s15, s15, s14
 buffer_load_ushort v89, v2, s[16:19], s15 offen
 s_add_u32 s15, s15, s14
 buffer_load_ushort v90, v2, s[16:19], s15 offen
 s_add_u32 s15, s15, s14
 buffer_load_ushort v91, v2, s[16:19], s15 offen
 s_add_u32 s15, s15, s14
 buffer_load_ushort v92, v2, s[16:19], s15 offen
 s_add_u32 s15, s15, s14
 buffer_load_ushort v93, v2, s[16:19], s15 offen
 s_add_u32 s15, s15, s14
 buffer_load_ushort v94, v2, s[16:19], s15 offen
 s_add_u32 s15, s15, s14
 buffer_load_ushort v95, v2, s[16:19], s15 offen
 s_add_u32 s15, s15, s14
 s_lshl_b32 s24, s14, 3
 s_add_u32 s15, s15, s24
 buffer_load_ushort v96, v2, s[16:19], s15 offen
 s_add_u32 s15, s15, s14
 buffer_load_ushort v97, v2, s[16:19], s15 offen
 s_add_u32 s15, s15, s14
 buffer_load_ushort v98, v2, s[16:19], s15 offen
 s_add_u32 s15, s15, s14
 buffer_load_ushort v99, v2, s[16:19], s15 offen
 s_add_u32 s15, s15, s14
 buffer_load_ushort v100, v2, s[16:19], s15 offen
 s_add_u32 s15, s15, s14
 buffer_load_ushort v101, v2, s[16:19], s15 offen
 s_add_u32 s15, s15, s14
 buffer_load_ushort v102, v2, s[16:19], s15 offen
 s_add_u32 s15, s15, s14
 buffer_load_ushort v103, v2, s[16:19], s15 offen
 s_add_u32 s15, s15, s14
 s_lshl_b32 s24, s14, 3
 s_add_u32 s15, s15, s24
 buffer_load_ushort v104, v2, s[16:19], s15 offen
 s_add_u32 s15, s15, s14
 buffer_load_ushort v105, v2, s[16:19], s15 offen
 s_add_u32 s15, s15, s14
 buffer_load_ushort v106, v2, s[16:19], s15 offen
 s_add_u32 s15, s15, s14
 buffer_load_ushort v107, v2, s[16:19], s15 offen
 s_add_u32 s15, s15, s14
 buffer_load_ushort v108, v2, s[16:19], s15 offen
 s_add_u32 s15, s15, s14
 buffer_load_ushort v109, v2, s[16:19], s15 offen
 s_add_u32 s15, s15, s14
 buffer_load_ushort v110, v2, s[16:19], s15 offen
 s_add_u32 s15, s15, s14
 buffer_load_ushort v111, v2, s[16:19], s15 offen
 s_add_u32 s15, s15, s14
 s_lshl_b32 s24, s14, 3
 s_add_u32 s15, s15, s24
 buffer_load_ushort v112, v2, s[16:19], s15 offen
 s_add_u32 s15, s15, s14
 buffer_load_ushort v113, v2, s[16:19], s15 offen
 s_add_u32 s15, s15, s14
 buffer_load_ushort v114, v2, s[16:19], s15 offen
 s_add_u32 s15, s15, s14
 buffer_load_ushort v115, v2, s[16:19], s15 offen
 s_add_u32 s15, s15, s14
 buffer_load_ushort v116, v2, s[16:19], s15 offen
 s_add_u32 s15, s15, s14
 buffer_load_ushort v117, v2, s[16:19], s15 offen
 s_add_u32 s15, s15, s14
 buffer_load_ushort v118, v2, s[16:19], s15 offen
 s_add_u32 s15, s15, s14
 buffer_load_ushort v119, v2, s[16:19], s15 offen
 s_add_u32 s15, s15, s14
 s_lshl_b32 s24, s14, 3
 s_add_u32 s15, s15, s24
 buffer_load_ushort v120, v2, s[16:19], s15 offen
 s_add_u32 s15, s15, s14
 buffer_load_ushort v121, v2, s[16:19], s15 offen
 s_add_u32 s15, s15, s14
 buffer_load_ushort v122, v2, s[16:19], s15 offen
 s_add_u32 s15, s15, s14
 buffer_load_ushort v123, v2, s[16:19], s15 offen
 s_add_u32 s15, s15, s14
 buffer_load_ushort v124, v2, s[16:19], s15 offen
 s_add_u32 s15, s15, s14
 buffer_load_ushort v125, v2, s[16:19], s15 offen
 s_add_u32 s15, s15, s14
 buffer_load_ushort v126, v2, s[16:19], s15 offen
 s_add_u32 s15, s15, s14
 buffer_load_ushort v127, v2, s[16:19], s15 offen
 s_add_u32 s15, s15, s14
 s_lshl_b32 s24, s14, 3
 s_add_u32 s15, s15, s24
 buffer_load_ushort v128, v2, s[16:19], s15 offen
 s_add_u32 s15, s15, s14
 buffer_load_ushort v129, v2, s[16:19], s15 offen
 s_add_u32 s15, s15, s14
 buffer_load_ushort v130, v2, s[16:19], s15 offen
 s_add_u32 s15, s15, s14
 buffer_load_ushort v131, v2, s[16:19], s15 offen
 s_add_u32 s15, s15, s14
 buffer_load_ushort v132, v2, s[16:19], s15 offen
 s_add_u32 s15, s15, s14
 buffer_load_ushort v133, v2, s[16:19], s15 offen
 s_add_u32 s15, s15, s14
 buffer_load_ushort v134, v2, s[16:19], s15 offen
 s_add_u32 s15, s15, s14
 buffer_load_ushort v135, v2, s[16:19], s15 offen
 s_add_u32 s15, s15, s14
 s_lshl_b32 s24, s14, 3
 s_add_u32 s15, s15, s24
 buffer_load_ushort v136, v2, s[16:19], s15 offen
 s_add_u32 s15, s15, s14
 buffer_load_ushort v137, v2, s[16:19], s15 offen
 s_add_u32 s15, s15, s14
 buffer_load_ushort v138, v2, s[16:19], s15 offen
 s_add_u32 s15, s15, s14
 buffer_load_ushort v139, v2, s[16:19], s15 offen
 s_add_u32 s15, s15, s14
 buffer_load_ushort v140, v2, s[16:19], s15 offen
 s_add_u32 s15, s15, s14
 buffer_load_ushort v141, v2, s[16:19], s15 offen
 s_add_u32 s15, s15, s14
 buffer_load_ushort v142, v2, s[16:19], s15 offen
 s_add_u32 s15, s15, s14
 buffer_load_ushort v143, v2, s[16:19], s15 offen
 s_add_u32 s15, s15, s14
 s_lshl_b32 s24, s14, 3
 s_add_u32 s15, s15, s24
 buffer_load_ushort v144, v2, s[16:19], s15 offen
 s_add_u32 s15, s15, s14
 buffer_load_ushort v145, v2, s[16:19], s15 offen
 s_add_u32 s15, s15, s14
 buffer_load_ushort v146, v2, s[16:19], s15 offen
 s_add_u32 s15, s15, s14
 buffer_load_ushort v147, v2, s[16:19], s15 offen
 s_add_u32 s15, s15, s14
 buffer_load_ushort v148, v2, s[16:19], s15 offen
 s_add_u32 s15, s15, s14
 buffer_load_ushort v149, v2, s[16:19], s15 offen
 s_add_u32 s15, s15, s14
 buffer_load_ushort v150, v2, s[16:19], s15 offen
 s_add_u32 s15, s15, s14
 buffer_load_ushort v151, v2, s[16:19], s15 offen
 s_add_u32 s15, s15, s14
 s_lshl_b32 s24, s14, 3
 s_add_u32 s15, s15, s24
 buffer_load_ushort v152, v2, s[16:19], s15 offen
 s_add_u32 s15, s15, s14
 buffer_load_ushort v153, v2, s[16:19], s15 offen
 s_add_u32 s15, s15, s14
 buffer_load_ushort v154, v2, s[16:19], s15 offen
 s_add_u32 s15, s15, s14
 buffer_load_ushort v155, v2, s[16:19], s15 offen
 s_add_u32 s15, s15, s14
 buffer_load_ushort v156, v2, s[16:19], s15 offen
 s_add_u32 s15, s15, s14
 buffer_load_ushort v157, v2, s[16:19], s15 offen
 s_add_u32 s15, s15, s14
 buffer_load_ushort v158, v2, s[16:19], s15 offen
 s_add_u32 s15, s15, s14
 buffer_load_ushort v159, v2, s[16:19], s15 offen
 s_add_u32 s15, s15, s14
 s_lshl_b32 s24, s14, 3
 s_add_u32 s15, s15, s24
 buffer_load_ushort v160, v2, s[16:19], s15 offen
 s_add_u32 s15, s15, s14
 buffer_load_ushort v161, v2, s[16:19], s15 offen
 s_add_u32 s15, s15, s14
 buffer_load_ushort v162, v2, s[16:19], s15 offen
 s_add_u32 s15, s15, s14
 buffer_load_ushort v163, v2, s[16:19], s15 offen
 s_add_u32 s15, s15, s14
 buffer_load_ushort v164, v2, s[16:19], s15 offen
 s_add_u32 s15, s15, s14
 buffer_load_ushort v165, v2, s[16:19], s15 offen
 s_add_u32 s15, s15, s14
 buffer_load_ushort v166, v2, s[16:19], s15 offen
 s_add_u32 s15, s15, s14
 buffer_load_ushort v167, v2, s[16:19], s15 offen
 s_add_u32 s15, s15, s14
 s_lshl_b32 s24, s14, 3
 s_add_u32 s15, s15, s24
 buffer_load_ushort v168, v2, s[16:19], s15 offen
 s_add_u32 s15, s15, s14
 buffer_load_ushort v169, v2, s[16:19], s15 offen
 s_add_u32 s15, s15, s14
 buffer_load_ushort v170, v2, s[16:19], s15 offen
 s_add_u32 s15, s15, s14
 buffer_load_ushort v171, v2, s[16:19], s15 offen
 s_add_u32 s15, s15, s14
 buffer_load_ushort v172, v2, s[16:19], s15 offen
 s_add_u32 s15, s15, s14
 buffer_load_ushort v173, v2, s[16:19], s15 offen
 s_add_u32 s15, s15, s14
 buffer_load_ushort v174, v2, s[16:19], s15 offen
 s_add_u32 s15, s15, s14
 buffer_load_ushort v175, v2, s[16:19], s15 offen
 s_add_u32 s15, s15, s14
 s_lshl_b32 s24, s14, 3
 s_add_u32 s15, s15, s24
 buffer_load_ushort v176, v2, s[16:19], s15 offen
 s_add_u32 s15, s15, s14
 buffer_load_ushort v177, v2, s[16:19], s15 offen
 s_add_u32 s15, s15, s14
 buffer_load_ushort v178, v2, s[16:19], s15 offen
 s_add_u32 s15, s15, s14
 buffer_load_ushort v179, v2, s[16:19], s15 offen
 s_add_u32 s15, s15, s14
 buffer_load_ushort v180, v2, s[16:19], s15 offen
 s_add_u32 s15, s15, s14
 buffer_load_ushort v181, v2, s[16:19], s15 offen
 s_add_u32 s15, s15, s14
 buffer_load_ushort v182, v2, s[16:19], s15 offen
 s_add_u32 s15, s15, s14
 buffer_load_ushort v183, v2, s[16:19], s15 offen
 s_add_u32 s15, s15, s14
 s_lshl_b32 s24, s14, 3
 s_add_u32 s15, s15, s24
 buffer_load_ushort v184, v2, s[16:19], s15 offen
 s_add_u32 s15, s15, s14
 buffer_load_ushort v185, v2, s[16:19], s15 offen
 s_add_u32 s15, s15, s14
 buffer_load_ushort v186, v2, s[16:19], s15 offen
 s_add_u32 s15, s15, s14
 buffer_load_ushort v187, v2, s[16:19], s15 offen
 s_add_u32 s15, s15, s14
 buffer_load_ushort v188, v2, s[16:19], s15 offen
 s_add_u32 s15, s15, s14
 buffer_load_ushort v189, v2, s[16:19], s15 offen
 s_add_u32 s15, s15, s14
 buffer_load_ushort v190, v2, s[16:19], s15 offen
 s_add_u32 s15, s15, s14
 buffer_load_ushort v191, v2, s[16:19], s15 offen
 s_add_u32 s15, s15, s14
 s_lshl_b32 s24, s14, 3
 s_add_u32 s15, s15, s24
 s_waitcnt vmcnt(63)
 v_lshlrev_b32 v6, 16, v32
 v_lshlrev_b32 v7, 16, v33
 v_add_f32 v5, v5, v6
 v_add_f32 v5, v5, v7
 v_lshl_or_b32 v8, v33, 16, v32
 v_lshlrev_b32 v6, 16, v34
 v_lshlrev_b32 v7, 16, v35
 v_add_f32 v5, v5, v6
 v_add_f32 v5, v5, v7
 v_lshl_or_b32 v9, v35, 16, v34
 v_lshlrev_b32 v6, 16, v36
 v_lshlrev_b32 v7, 16, v37
 v_add_f32 v5, v5, v6
 v_add_f32 v5, v5, v7
 v_lshl_or_b32 v10, v37, 16, v36
 v_lshlrev_b32 v6, 16, v38
 v_lshlrev_b32 v7, 16, v39
 v_add_f32 v5, v5, v6
 v_add_f32 v5, v5, v7
 v_lshl_or_b32 v11, v39, 16, v38
 buffer_store_dwordx4 v[8:11], v4, s[20:23], 0 offen
 v_add_u32 v4, 1024, v4
 s_waitcnt vmcnt(63)
 v_lshlrev_b32 v6, 16, v40
 v_lshlrev_b32 v7, 16, v41
 v_add_f32 v5, v5, v6
 v_add_f32 v5, v5, v7
 v_lshl_or_b32 v8, v41, 16, v40
 v_lshlrev_b32 v6, 16, v42
 v_lshlrev_b32 v7, 16, v43
 v_add_f32 v5, v5, v6
 v_add_f32 v5, v5, v7
 v_lshl_or_b32 v9, v43, 16, v42
 v_lshlrev_b32 v6, 16, v44
 v_lshlrev_b32 v7, 16, v45
 v_add_f32 v5, v5, v6
 v_add_f32 v5, v5, v7
 v_lshl_or_b32 v10, v45, 16, v44
 v_lshlrev_b32 v6, 16, v46
 v_lshlrev_b32 v7, 16, v47
 v_add_f32 v5, v5, v6
 v_add_f32 v5, v5, v7
 v_lshl_or_b32 v11, v47, 16, v46
 buffer_store_dwordx4 v[8:11], v4, s[20:23], 0 offen
 v_add_u32 v4, 1024, v4
 s_waitcnt vmcnt(63)
 v_lshlrev_b32 v6, 16, v48
 v_lshlrev_b32 v7, 16, v49
 v_add_f32 v5, v5, v6
 v_add_f32 v5, v5, v7
 v_lshl_or_b32 v8, v49, 16, v48
 v_lshlrev_b32 v6, 16, v50
 v_lshlrev_b32 v7, 16, v51
 v_add_f32 v5, v5, v6
 v_add_f32 v5, v5, v7
 v_lshl_or_b32 v9, v51, 16, v50
 v_lshlrev_b32 v6, 16, v52
 v_lshlrev_b32 v7, 16, v53
 v_add_f32 v5, v5, v6
 v_add_f32 v5, v5, v7
 v_lshl_or_b32 v10, v53, 16, v52
 v_lshlrev_b32 v6, 16, v54
 v_lshlrev_b32 v7, 16, v55
 v_add_f32 v5, v5, v6
 v_add_f32 v5, v5, v7
 v_lshl_or_b32 v11, v55, 16, v54
 buffer_store_dwordx4 v[8:11], v4, s[20:23], 0 offen
 v_add_u32 v4, 1024, v4
 s_waitcnt vmcnt(63)
 v_lshlrev_b32 v6, 16, v56
 v_lshlrev_b32 v7, 16, v57
 v_add_f32 v5, v5, v6
 v_add_f32 v5, v5, v7
 v_lshl_or_b32 v8, v57, 16, v56
 v_lshlrev_b32 v6, 16, v58
 v_lshlrev_b32 v7, 16, v59
 v_add_f32 v5, v5, v6
 v_add_f32 v5, v5, v7
 v_lshl_or_b32 v9, v59, 16, v58
 v_lshlrev_b32 v6, 16, v60
 v_lshlrev_b32 v7, 16, v61
 v_add_f32 v5, v5, v6
 v_add_f32 v5, v5, v7
 v_lshl_or_b32 v10, v61, 16, v60
 v_lshlrev_b32 v6, 16, v62
 v_lshlrev_b32 v7, 16, v63
 v_add_f32 v5, v5, v6
 v_add_f32 v5, v5, v7
 v_lshl_or_b32 v11, v63, 16, v62
 buffer_store_dwordx4 v[8:11], v4, s[20:23], 0 offen
 v_add_u32 v4, 1024, v4
 s_waitcnt vmcnt(63)
 v_lshlrev_b32 v6, 16, v64
 v_lshlrev_b32 v7, 16, v65
 v_add_f32 v5, v5, v6
 v_add_f32 v5, v5, v7
 v_lshl_or_b32 v8, v65, 16, v64
 v_lshlrev_b32 v6, 16, v66
 v_lshlrev_b32 v7, 16, v67
 v_add_f32 v5, v5, v6
 v_add_f32 v5, v5, v7
 v_lshl_or_b32 v9, v67, 16, v66
 v_lshlrev_b32 v6, 16, v68
 v_lshlrev_b32 v7, 16, v69
 v_add_f32 v5, v5, v6
 v_add_f32 v5, v5, v7
 v_lshl_or_b32 v10, v69, 16, v68
 v_lshlrev_b32 v6, 16, v70
 v_lshlrev_b32 v7, 16, v71
 v_add_f32 v5, v5, v6
 v_add_f32 v5, v5, v7
 v_lshl_or_b32 v11, v71, 16, v70
 buffer_store_dwordx4 v[8:11], v4, s[20:23], 0 offen
 v_add_u32 v4, 1024, v4
 s_waitcnt vmcnt(63)
 v_lshlrev_b32 v6, 16, v72
 v_lshlrev_b32 v7, 16, v73
 v_add_f32 v5, v5, v6
 v_add_f32 v5, v5, v7
 v_lshl_or_b32 v8, v73, 16, v72
 v_lshlrev_b32 v6, 16, v74
 v_lshlrev_b32 v7, 16, v75
 v_add_f32 v5, v5, v6
 v_add_f32 v5, v5, v7
 v_lshl_or_b32 v9, v75, 16, v74
 v_lshlrev_b32 v6, 16, v76
 v_lshlrev_b32 v7, 16, v77
 v_add_f32 v5, v5, v6
 v_add_f32 v5, v5, v7
 v_lshl_or_b32 v10, v77, 16, v76
 v_lshlrev_b32 v6, 16, v78
 v_lshlrev_b32 v7, 16, v79
 v_add_f32 v5, v5, v6
 v_add_f32 v5, v5, v7
 v_lshl_or_b32 v11, v79, 16, v78
 buffer_store_dwordx4 v[8:11], v4, s[20:23], 0 offen
 v_add_u32 v4, 1024, v4
 s_waitcnt vmcnt(63)
 v_lshlrev_b32 v6, 16, v80
 v_lshlrev_b32 v7, 16, v81
 v_add_f32 v5, v5, v6
 v_add_f32 v5, v5, v7
 v_lshl_or_b32 v8, v81, 16, v80
 v_lshlrev_b32 v6, 16, v82
 v_lshlrev_b32 v7, 16, v83
 v_add_f32 v5, v5, v6
 v_add_f32 v5, v5, v7
 v_lshl_or_b32 v9, v83, 16, v82
 v_lshlrev_b32 v6, 16, v84
 v_lshlrev_b32 v7, 16, v85
 v_add_f32 v5, v5, v6
 v_add_f32 v5, v5, v7
 v_lshl_or_b32 v10, v85, 16, v84
 v_lshlrev_b32 v6, 16, v86
 v_lshlrev_b32 v7, 16, v87
 v_add_f32 v5, v5, v6
 v_add_f32 v5, v5, v7
 v_lshl_or_b32 v11, v87, 16, v86
 buffer_store_dwordx4 v[8:11], v4, s[20:23], 0 offen
 v_add_u32 v4, 1024, v4
 s_waitcnt vmcnt(63)
 v_lshlrev_b32 v6, 16, v88
 v_lshlrev_b32 v7, 16, v89
 v_add_f32 v5, v5, v6
 v_add_f32 v5, v5, v7
 v_lshl_or_b32 v8, v89, 16, v88
 v_lshlrev_b32 v6, 16, v90
 v_lshlrev_b32 v7, 16, v91
 v_add_f32 v5, v5, v6
 v_add_f32 v5, v5, v7
 v_lshl_or_b32 v9, v91, 16, v90
 v_lshlrev_b32 v6, 16, v92
 v_lshlrev_b32 v7, 16, v93
 v_add_f32 v5, v5, v6
 v_add_f32 v5, v5, v7
 v_lshl_or_b32 v10, v93, 16, v92
 v_lshlrev_b32 v6, 16, v94
 v_lshlrev_b32 v7, 16, v95
 v_add_f32 v5, v5, v6
 v_add_f32 v5, v5, v7
 v_lshl_or_b32 v11, v95, 16, v94
 buffer_store_dwordx4 v[8:11], v4, s[20:23], 0 offen
 v_add_u32 v4, 1024, v4
 s_waitcnt vmcnt(63)
 v_lshlrev_b32 v6, 16, v96
 v_lshlrev_b32 v7, 16, v97
 v_add_f32 v5, v5, v6
 v_add_f32 v5, v5, v7
 v_lshl_or_b32 v8, v97, 16, v96
 v_lshlrev_b32 v6, 16, v98
 v_lshlrev_b32 v7, 16, v99
 v_add_f32 v5, v5, v6
 v_add_f32 v5, v5, v7
 v_lshl_or_b32 v9, v99, 16, v98
 v_lshlrev_b32 v6, 16, v100
 v_lshlrev_b32 v7, 16, v101
 v_add_f32 v5, v5, v6
 v_add_f32 v5, v5, v7
 v_lshl_or_b32 v10, v101, 16, v100
 v_lshlrev_b32 v6, 16, v102
 v_lshlrev_b32 v7, 16, v103
 v_add_f32 v5, v5, v6
 v_add_f32 v5, v5, v7
 v_lshl_or_b32 v11, v103, 16, v102
 buffer_store_dwordx4 v[8:11], v4, s[20:23], 0 offen
 v_add_u32 v4, 1024, v4
 s_waitcnt vmcnt(63)
 v_lshlrev_b32 v6, 16, v104
 v_lshlrev_b32 v7, 16, v105
 v_add_f32 v5, v5, v6
 v_add_f32 v5, v5, v7
 v_lshl_or_b32 v8, v105, 16, v104
 v_lshlrev_b32 v6, 16, v106
 v_lshlrev_b32 v7, 16, v107
 v_add_f32 v5, v5, v6
 v_add_f32 v5, v5, v7
 v_lshl_or_b32 v9, v107, 16, v106
 v_lshlrev_b32 v6, 16, v108
 v_lshlrev_b32 v7, 16, v109
 v_add_f32 v5, v5, v6
 v_add_f32 v5, v5, v7
 v_lshl_or_b32 v10, v109, 16, v108
 v_lshlrev_b32 v6, 16, v110
 v_lshlrev_b32 v7, 16, v111
 v_add_f32 v5, v5, v6
 v_add_f32 v5, v5, v7
 v_lshl_or_b32 v11, v111, 16, v110
 buffer_store_dwordx4 v[8:11], v4, s[20:23], 0 offen
 v_add_u32 v4, 1024, v4
 s_waitcnt vmcnt(63)
 v_lshlrev_b32 v6, 16, v112
 v_lshlrev_b32 v7, 16, v113
 v_add_f32 v5, v5, v6
 v_add_f32 v5, v5, v7
 v_lshl_or_b32 v8, v113, 16, v112
 v_lshlrev_b32 v6, 16, v114
 v_lshlrev_b32 v7, 16, v115
 v_add_f32 v5, v5, v6
 v_add_f32 v5, v5, v7
 v_lshl_or_b32 v9, v115, 16, v114
 v_lshlrev_b32 v6, 16, v116
 v_lshlrev_b32 v7, 16, v117
 v_add_f32 v5, v5, v6
 v_add_f32 v5, v5, v7
 v_lshl_or_b32 v10, v117, 16, v116
 v_lshlrev_b32 v6, 16, v118
 v_lshlrev_b32 v7, 16, v119
 v_add_f32 v5, v5, v6
 v_add_f32 v5, v5, v7
 v_lshl_or_b32 v11, v119, 16, v118
 buffer_store_dwordx4 v[8:11], v4, s[20:23], 0 offen
 v_add_u32 v4, 1024, v4
 s_waitcnt vmcnt(63)
 v_lshlrev_b32 v6, 16, v120
 v_lshlrev_b32 v7, 16, v121
 v_add_f32 v5, v5, v6
 v_add_f32 v5, v5, v7
 v_lshl_or_b32 v8, v121, 16, v120
 v_lshlrev_b32 v6, 16, v122
 v_lshlrev_b32 v7, 16, v123
 v_add_f32 v5, v5, v6
 v_add_f32 v5, v5, v7
 v_lshl_or_b32 v9, v123, 16, v122
 v_lshlrev_b32 v6, 16, v124
 v_lshlrev_b32 v7, 16, v125
 v_add_f32 v5, v5, v6
 v_add_f32 v5, v5, v7
 v_lshl_or_b32 v10, v125, 16, v124
 v_lshlrev_b32 v6, 16, v126
 v_lshlrev_b32 v7, 16, v127
 v_add_f32 v5, v5, v6
 v_add_f32 v5, v5, v7
 v_lshl_or_b32 v11, v127, 16, v126
 buffer_store_dwordx4 v[8:11], v4, s[20:23], 0 offen
 v_add_u32 v4, 1024, v4
 s_waitcnt vmcnt(63)
 v_lshlrev_b32 v6, 16, v128
 v_lshlrev_b32 v7, 16, v129
 v_add_f32 v5, v5, v6
 v_add_f32 v5, v5, v7
 v_lshl_or_b32 v8, v129, 16, v128
 v_lshlrev_b32 v6, 16, v130
 v_lshlrev_b32 v7, 16, v131
 v_add_f32 v5, v5, v6
 v_add_f32 v5, v5, v7
 v_lshl_or_b32 v9, v131, 16, v130
 v_lshlrev_b32 v6, 16, v132
 v_lshlrev_b32 v7, 16, v133
 v_add_f32 v5, v5, v6
 v_add_f32 v5, v5, v7
 v_lshl_or_b32 v10, v133, 16, v132
 v_lshlrev_b32 v6, 16, v134
 v_lshlrev_b32 v7, 16, v135
 v_add_f32 v5, v5, v6
 v_add_f32 v5, v5, v7
 v_lshl_or_b32 v11, v135, 16, v134
 buffer_store_dwordx4 v[8:11], v4, s[20:23], 0 offen
 v_add_u32 v4, 1024, v4
 s_waitcnt vmcnt(61)
 v_lshlrev_b32 v6, 16, v136
 v_lshlrev_b32 v7, 16, v137
 v_add_f32 v5, v5, v6
 v_add_f32 v5, v5, v7
 v_lshl_or_b32 v8, v137, 16, v136
 v_lshlrev_b32 v6, 16, v138
 v_lshlrev_b32 v7, 16, v139
 v_add_f32 v5, v5, v6
 v_add_f32 v5, v5, v7
 v_lshl_or_b32 v9, v139, 16, v138
 v_lshlrev_b32 v6, 16, v140
 v_lshlrev_b32 v7, 16, v141
 v_add_f32 v5, v5, v6
 v_add_f32 v5, v5, v7
 v_lshl_or_b32 v10, v141, 16, v140
 v_lshlrev_b32 v6, 16, v142
 v_lshlrev_b32 v7, 16, v143
 v_add_f32 v5, v5, v6
 v_add_f32 v5, v5, v7
 v_lshl_or_b32 v11, v143, 16, v142
 buffer_store_dwordx4 v[8:11], v4, s[20:23], 0 offen
 v_add_u32 v4, 1024, v4
 s_waitcnt vmcnt(54)
 v_lshlrev_b32 v6, 16, v144
 v_lshlrev_b32 v7, 16, v145
 v_add_f32 v5, v5, v6
 v_add_f32 v5, v5, v7
 v_lshl_or_b32 v8, v145, 16, v144
 v_lshlrev_b32 v6, 16, v146
 v_lshlrev_b32 v7, 16, v147
 v_add_f32 v5, v5, v6
 v_add_f32 v5, v5, v7
 v_lshl_or_b32 v9, v147, 16, v146
 v_lshlrev_b32 v6, 16, v148
 v_lshlrev_b32 v7, 16, v149
 v_add_f32 v5, v5, v6
 v_add_f32 v5, v5, v7
 v_lshl_or_b32 v10, v149, 16, v148
 v_lshlrev_b32 v6, 16, v150
 v_lshlrev_b32 v7, 16, v151
 v_add_f32 v5, v5, v6
 v_add_f32 v5, v5, v7
 v_lshl_or_b32 v11, v151, 16, v150
 buffer_store_dwordx4 v[8:11], v4, s[20:23], 0 offen
 v_add_u32 v4, 1024, v4
 s_waitcnt vmcnt(47)
 v_lshlrev_b32 v6, 16, v152
 v_lshlrev_b32 v7, 16, v153
 v_add_f32 v5, v5, v6
 v_add_f32 v5, v5, v7
 v_lshl_or_b32 v8, v153, 16, v152
 v_lshlrev_b32 v6, 16, v154
 v_lshlrev_b32 v7, 16, v155
 v_add_f32 v5, v5, v6
 v_add_f32 v5, v5, v7
 v_lshl_or_b32 v9, v155, 16, v154
 v_lshlrev_b32 v6, 16, v156
 v_lshlrev_b32 v7, 16, v157
 v_add_f32 v5, v5, v6
 v_add_f32 v5, v5, v7
 v_lshl_or_b32 v10, v157, 16, v156
 v_lshlrev_b32 v6, 16, v158
 v_lshlrev_b32 v7, 16, v159
 v_add_f32 v5, v5, v6
 v_add_f32 v5, v5, v7
 v_lshl_or_b32 v11, v159, 16, v158
 buffer_store_dwordx4 v[8:11], v4, s[20:23], 0 offen
 v_add_u32 v4, 1024, v4
 s_waitcnt vmcnt(40)
 v_lshlrev_b32 v6, 16, v160
 v_lshlrev_b32 v7, 16, v161
 v_add_f32 v5, v5, v6
 v_add_f32 v5, v5, v7
 v_lshl_or_b32 v8, v161, 16, v160
 v_lshlrev_b32 v6, 16, v162
 v_lshlrev_b32 v7, 16, v163
 v_add_f32 v5, v5, v6
 v_add_f32 v5, v5, v7
 v_lshl_or_b32 v9, v163, 16, v162
 v_lshlrev_b32 v6, 16, v164
 v_lshlrev_b32 v7, 16, v165
 v_add_f32 v5, v5, v6
 v_add_f32 v5, v5, v7
 v_lshl_or_b32 v10, v165, 16, v164
 v_lshlrev_b32 v6, 16, v166
 v_lshlrev_b32 v7, 16, v167
 v_add_f32 v5, v5, v6
 v_add_f32 v5, v5, v7
 v_lshl_or_b32 v11, v167, 16, v166
 buffer_store_dwordx4 v[8:11], v4, s[20:23], 0 offen
 v_add_u32 v4, 1024, v4
 s_waitcnt vmcnt(33)
 v_lshlrev_b32 v6, 16, v168
 v_lshlrev_b32 v7, 16, v169
 v_add_f32 v5, v5, v6
 v_add_f32 v5, v5, v7
 v_lshl_or_b32 v8, v169, 16, v168
 v_lshlrev_b32 v6, 16, v170
 v_lshlrev_b32 v7, 16, v171
 v_add_f32 v5, v5, v6
 v_add_f32 v5, v5, v7
 v_lshl_or_b32 v9, v171, 16, v170
 v_lshlrev_b32 v6, 16, v172
 v_lshlrev_b32 v7, 16, v173
 v_add_f32 v5, v5, v6
 v_add_f32 v5, v5, v7
 v_lshl_or_b32 v10, v173, 16, v172
 v_lshlrev_b32 v6, 16, v174
 v_lshlrev_b32 v7, 16, v175
 v_add_f32 v5, v5, v6
 v_add_f32 v5, v5, v7
 v_lshl_or_b32 v11, v175, 16, v174
 buffer_store_dwordx4 v[8:11], v4, s[20:23], 0 offen
 v_add_u32 v4, 1024, v4
 s_waitcnt vmcnt(26)
 v_lshlrev_b32 v6, 16, v176
 v_lshlrev_b32 v7, 16, v177
 v_add_f32 v5, v5, v6
 v_add_f32 v5, v5, v7
 v_lshl_or_b32 v8, v177, 16, v176
 v_lshlrev_b32 v6, 16, v178
 v_lshlrev_b32 v7, 16, v179
 v_add_f32 v5, v5, v6
 v_add_f32 v5, v5, v7
 v_lshl_or_b32 v9, v179, 16, v178
 v_lshlrev_b32 v6, 16, v180
 v_lshlrev_b32 v7, 16, v181
 v_add_f32 v5, v5, v6
 v_add_f32 v5, v5, v7
 v_lshl_or_b32 v10, v181, 16, v180
 v_lshlrev_b32 v6, 16, v182
 v_lshlrev_b32 v7, 16, v183
 v_add_f32 v5, v5, v6
 v_add_f32 v5, v5, v7
 v_lshl_or_b32 v11, v183, 16, v182
 buffer_store_dwordx4 v[8:11], v4, s[20:23], 0 offen
 v_add_u32 v4, 1024, v4
 s_waitcnt vmcnt(19)
 v_lshlrev_b32 v6, 16, v184
 v_lshlrev_b32 v7, 16, v185
 v_add_f32 v5, v5, v6
 v_add_f32 v5, v5, v7
 v_lshl_or_b32 v8, v185, 16, v184
 v_lshlrev_b32 v6, 16, v186
 v_lshlrev_b32 v7, 16, v187
 v_add_f32 v5, v5, v6
 v_add_f32 v5, v5, v7
 v_lshl_or_b32 v9, v187, 16, v186
 v_lshlrev_b32 v6, 16, v188
 v_lshlrev_b32 v7, 16, v189
 v_add_f32 v5, v5, v6
 v_add_f32 v5, v5, v7
 v_lshl_or_b32 v10, v189, 16, v188
 v_lshlrev_b32 v6, 16, v190
 v_lshlrev_b32 v7, 16, v191
 v_add_f32 v5, v5, v6
 v_add_f32 v5, v5, v7
 v_lshl_or_b32 v11, v191, 16, v190
 buffer_store_dwordx4 v[8:11], v4, s[20:23], 0 offen
 v_add_u32 v4, 1024, v4
 s_cmp_eq_u32 s11, -1
 s_cbranch_scc1 L_prep_end
 v_mov_b32 v6, v5
 s_nop 1
 v_permlane32_swap_b32 v5, v6
 v_add_f32 v5, v5, v6
 s_lshl_b32 s24, s9, 7
 s_add_u32 s24, s24, s11
 s_add_u32 s28, s4, s24
 s_addc_u32 s29, s5, 0
 s_mov_b32 s30, 128
 s_mov_b32 s31, 0x00020000
 v_and_b32 v4, 63, v0
 v_lshlrev_b32 v4, 2, v4
 buffer_store_dword v5, v4, s[28:31], 0 offen
L_prep_end:
 s_endpgm
.globl a1_0_kernel
.p2align 8
.type a1_0_kernel,@function
a1_0_kernel:
 s_cmp_ge_u32 s2, 192
 s_cbranch_scc1 L_a1_0_kernel_end
 s_load_dwordx2 s[4:5], s[0:1], 80
 s_load_dwordx2 s[6:7], s[0:1], 0
 s_and_b32 s32, s2, 31
 s_lshr_b32 s33, s2, 5
 v_lshrrev_b32 v1, 6, v0
 s_nop 0
 v_readfirstlane_b32 s34, v1
 s_waitcnt lgkmcnt(0)
 s_add_u32 s8, s6, 0
 s_addc_u32 s9, s7, 0
 s_mov_b32 s10, 2621440
 s_mov_b32 s11, 0x00020000
 s_add_u32 s12, s4, 0
 s_addc_u32 s13, s5, 0
 s_mov_b32 s14, 901120
 s_mov_b32 s15, 0x00020000
 s_mul_i32 s35, s32, 81920
 v_add_u32 v2, 0, v0
 v_lshlrev_b32 v3, 4, v2
 buffer_load_dwordx4 v[64:67], v3, s[8:11], s35 offen
 v_add_u32 v2, 256, v0
 v_lshlrev_b32 v3, 4, v2
 buffer_load_dwordx4 v[68:71], v3, s[8:11], s35 offen
 v_add_u32 v2, 512, v0
 v_lshlrev_b32 v3, 4, v2
 buffer_load_dwordx4 v[72:75], v3, s[8:11], s35 offen
 v_add_u32 v2, 768, v0
 v_lshlrev_b32 v3, 4, v2
 buffer_load_dwordx4 v[76:79], v3, s[8:11], s35 offen
 v_add_u32 v2, 1024, v0
 v_lshlrev_b32 v3, 4, v2
 buffer_load_dwordx4 v[80:83], v3, s[8:11], s35 offen
 v_add_u32 v2, 1280, v0
 v_lshlrev_b32 v3, 4, v2
 buffer_load_dwordx4 v[84:87], v3, s[8:11], s35 offen
 v_add_u32 v2, 1536, v0
 v_lshlrev_b32 v3, 4, v2
 buffer_load_dwordx4 v[88:91], v3, s[8:11], s35 offen
 v_add_u32 v2, 1792, v0
 v_lshlrev_b32 v3, 4, v2
 buffer_load_dwordx4 v[92:95], v3, s[8:11], s35 offen
 v_add_u32 v2, 2048, v0
 v_lshlrev_b32 v3, 4, v2
 buffer_load_dwordx4 v[96:99], v3, s[8:11], s35 offen
 v_add_u32 v2, 2304, v0
 v_lshlrev_b32 v3, 4, v2
 buffer_load_dwordx4 v[100:103], v3, s[8:11], s35 offen
 v_add_u32 v2, 2560, v0
 v_lshlrev_b32 v3, 4, v2
 buffer_load_dwordx4 v[104:107], v3, s[8:11], s35 offen
 v_add_u32 v2, 2816, v0
 v_lshlrev_b32 v3, 4, v2
 buffer_load_dwordx4 v[108:111], v3, s[8:11], s35 offen
 v_add_u32 v2, 3072, v0
 v_lshlrev_b32 v3, 4, v2
 buffer_load_dwordx4 v[112:115], v3, s[8:11], s35 offen
 v_add_u32 v2, 3328, v0
 v_lshlrev_b32 v3, 4, v2
 buffer_load_dwordx4 v[116:119], v3, s[8:11], s35 offen
 v_add_u32 v2, 3584, v0
 v_lshlrev_b32 v3, 4, v2
 buffer_load_dwordx4 v[120:123], v3, s[8:11], s35 offen
 v_add_u32 v2, 3840, v0
 v_lshlrev_b32 v3, 4, v2
 buffer_load_dwordx4 v[124:127], v3, s[8:11], s35 offen
 v_add_u32 v2, 4096, v0
 v_lshlrev_b32 v3, 4, v2
 buffer_load_dwordx4 v[128:131], v3, s[8:11], s35 offen
 v_add_u32 v2, 4352, v0
 v_lshlrev_b32 v3, 4, v2
 buffer_load_dwordx4 v[132:135], v3, s[8:11], s35 offen
 v_add_u32 v2, 4608, v0
 v_lshlrev_b32 v3, 4, v2
 buffer_load_dwordx4 v[136:139], v3, s[8:11], s35 offen
 v_add_u32 v2, 4864, v0
 v_lshlrev_b32 v3, 4, v2
 buffer_load_dwordx4 v[140:143], v3, s[8:11], s35 offen
 v_add_u32 v2, 0, v0
 v_mul_u32_u24 v3, 52429, v2
 v_lshrrev_b32 v3, 22, v3
 v_add_u32 v3, v3, v2
 v_lshlrev_b32 v3, 4, v3
 s_waitcnt vmcnt(19)
 ds_write_b128 v3, v[64:67]
 v_add_u32 v2, 256, v0
 v_mul_u32_u24 v3, 52429, v2
 v_lshrrev_b32 v3, 22, v3
 v_add_u32 v3, v3, v2
 v_lshlrev_b32 v3, 4, v3
 s_waitcnt vmcnt(18)
 ds_write_b128 v3, v[68:71]
 v_add_u32 v2, 512, v0
 v_mul_u32_u24 v3, 52429, v2
 v_lshrrev_b32 v3, 22, v3
 v_add_u32 v3, v3, v2
 v_lshlrev_b32 v3, 4, v3
 s_waitcnt vmcnt(17)
 ds_write_b128 v3, v[72:75]
 v_add_u32 v2, 768, v0
 v_mul_u32_u24 v3, 52429, v2
 v_lshrrev_b32 v3, 22, v3
 v_add_u32 v3, v3, v2
 v_lshlrev_b32 v3, 4, v3
 s_waitcnt vmcnt(16)
 ds_write_b128 v3, v[76:79]
 v_add_u32 v2, 1024, v0
 v_mul_u32_u24 v3, 52429, v2
 v_lshrrev_b32 v3, 22, v3
 v_add_u32 v3, v3, v2
 v_lshlrev_b32 v3, 4, v3
 s_waitcnt vmcnt(15)
 ds_write_b128 v3, v[80:83]
 v_add_u32 v2, 1280, v0
 v_mul_u32_u24 v3, 52429, v2
 v_lshrrev_b32 v3, 22, v3
 v_add_u32 v3, v3, v2
 v_lshlrev_b32 v3, 4, v3
 s_waitcnt vmcnt(14)
 ds_write_b128 v3, v[84:87]
 v_add_u32 v2, 1536, v0
 v_mul_u32_u24 v3, 52429, v2
 v_lshrrev_b32 v3, 22, v3
 v_add_u32 v3, v3, v2
 v_lshlrev_b32 v3, 4, v3
 s_waitcnt vmcnt(13)
 ds_write_b128 v3, v[88:91]
 v_add_u32 v2, 1792, v0
 v_mul_u32_u24 v3, 52429, v2
 v_lshrrev_b32 v3, 22, v3
 v_add_u32 v3, v3, v2
 v_lshlrev_b32 v3, 4, v3
 s_waitcnt vmcnt(12)
 ds_write_b128 v3, v[92:95]
 v_add_u32 v2, 2048, v0
 v_mul_u32_u24 v3, 52429, v2
 v_lshrrev_b32 v3, 22, v3
 v_add_u32 v3, v3, v2
 v_lshlrev_b32 v3, 4, v3
 s_waitcnt vmcnt(11)
 ds_write_b128 v3, v[96:99]
 v_add_u32 v2, 2304, v0
 v_mul_u32_u24 v3, 52429, v2
 v_lshrrev_b32 v3, 22, v3
 v_add_u32 v3, v3, v2
 v_lshlrev_b32 v3, 4, v3
 s_waitcnt vmcnt(10)
 ds_write_b128 v3, v[100:103]
 v_add_u32 v2, 2560, v0
 v_mul_u32_u24 v3, 52429, v2
 v_lshrrev_b32 v3, 22, v3
 v_add_u32 v3, v3, v2
 v_lshlrev_b32 v3, 4, v3
 s_waitcnt vmcnt(9)
 ds_write_b128 v3, v[104:107]
 v_add_u32 v2, 2816, v0
 v_mul_u32_u24 v3, 52429, v2
 v_lshrrev_b32 v3, 22, v3
 v_add_u32 v3, v3, v2
 v_lshlrev_b32 v3, 4, v3
 s_waitcnt vmcnt(8)
 ds_write_b128 v3, v[108:111]
 v_add_u32 v2, 3072, v0
 v_mul_u32_u24 v3, 52429, v2
 v_lshrrev_b32 v3, 22, v3
 v_add_u32 v3, v3, v2
 v_lshlrev_b32 v3, 4, v3
 s_waitcnt vmcnt(7)
 ds_write_b128 v3, v[112:115]
 v_add_u32 v2, 3328, v0
 v_mul_u32_u24 v3, 52429, v2
 v_lshrrev_b32 v3, 22, v3
 v_add_u32 v3, v3, v2
 v_lshlrev_b32 v3, 4, v3
 s_waitcnt vmcnt(6)
 ds_write_b128 v3, v[116:119]
 v_add_u32 v2, 3584, v0
 v_mul_u32_u24 v3, 52429, v2
 v_lshrrev_b32 v3, 22, v3
 v_add_u32 v3, v3, v2
 v_lshlrev_b32 v3, 4, v3
 s_waitcnt vmcnt(5)
 ds_write_b128 v3, v[120:123]
 v_add_u32 v2, 3840, v0
 v_mul_u32_u24 v3, 52429, v2
 v_lshrrev_b32 v3, 22, v3
 v_add_u32 v3, v3, v2
 v_lshlrev_b32 v3, 4, v3
 s_waitcnt vmcnt(4)
 ds_write_b128 v3, v[124:127]
 v_add_u32 v2, 4096, v0
 v_mul_u32_u24 v3, 52429, v2
 v_lshrrev_b32 v3, 22, v3
 v_add_u32 v3, v3, v2
 v_lshlrev_b32 v3, 4, v3
 s_waitcnt vmcnt(3)
 ds_write_b128 v3, v[128:131]
 v_add_u32 v2, 4352, v0
 v_mul_u32_u24 v3, 52429, v2
 v_lshrrev_b32 v3, 22, v3
 v_add_u32 v3, v3, v2
 v_lshlrev_b32 v3, 4, v3
 s_waitcnt vmcnt(2)
 ds_write_b128 v3, v[132:135]
 v_add_u32 v2, 4608, v0
 v_mul_u32_u24 v3, 52429, v2
 v_lshrrev_b32 v3, 22, v3
 v_add_u32 v3, v3, v2
 v_lshlrev_b32 v3, 4, v3
 s_waitcnt vmcnt(1)
 ds_write_b128 v3, v[136:139]
 v_add_u32 v2, 4864, v0
 v_mul_u32_u24 v3, 52429, v2
 v_lshrrev_b32 v3, 22, v3
 v_add_u32 v3, v3, v2
 v_lshlrev_b32 v3, 4, v3
 s_waitcnt vmcnt(0)
 ds_write_b128 v3, v[140:143]
 s_waitcnt lgkmcnt(0)
 s_barrier
 s_mul_i32 s40, s33, 4
 s_mul_i32 s41, s34, 1
 s_add_u32 s40, s40, s41
 s_cmp_ge_u32 s40, 22
 s_cbranch_scc1 L_a1_0_kernel_end
 s_add_u32 s41, s40, 0
 s_mul_i32 s42, s41, 40960
 v_and_b32 v2, 63, v0
 v_lshlrev_b32 v4, 4, v2
 v_and_b32 v3, 31, v0
 v_mul_u32_u24 v5, 1296, v3
 v_bfe_u32 v6, v0, 5, 1
 v_lshlrev_b32 v6, 4, v6
 v_add_u32 v5, v5, v6
 v_add_u32 v7, 41472, v5
 v_mov_b32 v64, 0
 v_mov_b32 v65, 0
 v_mov_b32 v66, 0
 v_mov_b32 v67, 0
 v_mov_b32 v68, 0
 v_mov_b32 v69, 0
 v_mov_b32 v70, 0
 v_mov_b32 v71, 0
 v_mov_b32 v72, 0
 v_mov_b32 v73, 0
 v_mov_b32 v74, 0
 v_mov_b32 v75, 0
 v_mov_b32 v76, 0
 v_mov_b32 v77, 0
 v_mov_b32 v78, 0
 v_mov_b32 v79, 0
 v_mov_b32 v80, 0
 v_mov_b32 v81, 0
 v_mov_b32 v82, 0
 v_mov_b32 v83, 0
 v_mov_b32 v84, 0
 v_mov_b32 v85, 0
 v_mov_b32 v86, 0
 v_mov_b32 v87, 0
 v_mov_b32 v88, 0
 v_mov_b32 v89, 0
 v_mov_b32 v90, 0
 v_mov_b32 v91, 0
 v_mov_b32 v92, 0
 v_mov_b32 v93, 0
 v_mov_b32 v94, 0
 v_mov_b32 v95, 0
 v_mov_b32 v176, 0
 v_mov_b32 v177, 0
 v_mov_b32 v178, 0
 v_mov_b32 v179, 0
 v_mov_b32 v180, 0x3f803f80
 s_add_u32 s16, s4, 5767168
 s_addc_u32 s17, s5, 0
 s_mov_b32 s18, 2816
 s_mov_b32 s19, 0x00020000
 s_add_u32 s20, s4, 16777216
 s_addc_u32 s21, s5, 0
 s_mov_b32 s22, 4194304
 s_mov_b32 s23, 0x00020000
 s_add_u32 s24, s4, 20971520
 s_addc_u32 s25, s5, 0
 s_mov_b32 s26, 4194304
 s_mov_b32 s27, 0x00020000
 s_add_u32 s28, s4, 25165824
 s_addc_u32 s29, s5, 0
 s_mov_b32 s30, 4194304
 s_mov_b32 s31, 0x00020000
 s_cmp_ge_u32 s40, 21
 s_cbranch_scc1 L_a1_0_kernel_vtype
 buffer_load_dwordx4 v[128:131], v4, s[12:15], s42 offen
 s_add_u32 s42, s42, 1024
 buffer_load_dwordx4 v[132:135], v4, s[12:15], s42 offen
 s_add_u32 s42, s42, 1024
 buffer_load_dwordx4 v[136:139], v4, s[12:15], s42 offen
 s_add_u32 s42, s42, 1024
 buffer_load_dwordx4 v[140:143], v4, s[12:15], s42 offen
 s_add_u32 s42, s42, 1024
 ds_read_b128 v[160:163], v5 offset:0
 ds_read_b128 v[164:167], v7 offset:0
 ds_read_b128 v[168:171], v5 offset:32
 ds_read_b128 v[172:175], v7 offset:32
 s_waitcnt vmcnt(3) lgkmcnt(2)
 v_mfma_f32_32x32x16_bf16 v[64:79], v[128:131], v[160:163], v[64:79]
 v_mfma_f32_32x32x16_bf16 v[80:95], v[128:131], v[164:167], v[80:95]
 v_dot2c_f32_bf16 v176, v160, v180
 v_dot2c_f32_bf16 v178, v160, v160
 v_dot2c_f32_bf16 v176, v161, v180
 v_dot2c_f32_bf16 v178, v161, v161
 v_dot2c_f32_bf16 v176, v162, v180
 v_dot2c_f32_bf16 v178, v162, v162
 v_dot2c_f32_bf16 v176, v163, v180
 v_dot2c_f32_bf16 v178, v163, v163
 v_dot2c_f32_bf16 v177, v164, v180
 v_dot2c_f32_bf16 v179, v164, v164
 v_dot2c_f32_bf16 v177, v165, v180
 v_dot2c_f32_bf16 v179, v165, v165
 v_dot2c_f32_bf16 v177, v166, v180
 v_dot2c_f32_bf16 v179, v166, v166
 v_dot2c_f32_bf16 v177, v167, v180
 v_dot2c_f32_bf16 v179, v167, v167
 buffer_load_dwordx4 v[128:131], v4, s[12:15], s42 offen
 s_add_u32 s42, s42, 1024
 ds_read_b128 v[160:163], v5 offset:64
 ds_read_b128 v[164:167], v7 offset:64
 s_waitcnt vmcnt(3) lgkmcnt(2)
 v_mfma_f32_32x32x16_bf16 v[64:79], v[132:135], v[168:171], v[64:79]
 v_mfma_f32_32x32x16_bf16 v[80:95], v[132:135], v[172:175], v[80:95]
 v_dot2c_f32_bf16 v176, v168, v180
 v_dot2c_f32_bf16 v178, v168, v168
 v_dot2c_f32_bf16 v176, v169, v180
 v_dot2c_f32_bf16 v178, v169, v169
 v_dot2c_f32_bf16 v176, v170, v180
 v_dot2c_f32_bf16 v178, v170, v170
 v_dot2c_f32_bf16 v176, v171, v180
 v_dot2c_f32_bf16 v178, v171, v171
 v_dot2c_f32_bf16 v177, v172, v180
 v_dot2c_f32_bf16 v179, v172, v172
 v_dot2c_f32_bf16 v177, v173, v180
 v_dot2c_f32_bf16 v179, v173, v173
 v_dot2c_f32_bf16 v177, v174, v180
 v_dot2c_f32_bf16 v179, v174, v174
 v_dot2c_f32_bf16 v177, v175, v180
 v_dot2c_f32_bf16 v179, v175, v175
 buffer_load_dwordx4 v[132:135], v4, s[12:15], s42 offen
 s_add_u32 s42, s42, 1024
 ds_read_b128 v[168:171], v5 offset:96
 ds_read_b128 v[172:175], v7 offset:96
 s_waitcnt vmcnt(3) lgkmcnt(2)
 v_mfma_f32_32x32x16_bf16 v[64:79], v[136:139], v[160:163], v[64:79]
 v_mfma_f32_32x32x16_bf16 v[80:95], v[136:139], v[164:167], v[80:95]
 v_dot2c_f32_bf16 v176, v160, v180
 v_dot2c_f32_bf16 v178, v160, v160
 v_dot2c_f32_bf16 v176, v161, v180
 v_dot2c_f32_bf16 v178, v161, v161
 v_dot2c_f32_bf16 v176, v162, v180
 v_dot2c_f32_bf16 v178, v162, v162
 v_dot2c_f32_bf16 v176, v163, v180
 v_dot2c_f32_bf16 v178, v163, v163
 v_dot2c_f32_bf16 v177, v164, v180
 v_dot2c_f32_bf16 v179, v164, v164
 v_dot2c_f32_bf16 v177, v165, v180
 v_dot2c_f32_bf16 v179, v165, v165
 v_dot2c_f32_bf16 v177, v166, v180
 v_dot2c_f32_bf16 v179, v166, v166
 v_dot2c_f32_bf16 v177, v167, v180
 v_dot2c_f32_bf16 v179, v167, v167
 buffer_load_dwordx4 v[136:139], v4, s[12:15], s42 offen
 s_add_u32 s42, s42, 1024
 ds_read_b128 v[160:163], v5 offset:128
 ds_read_b128 v[164:167], v7 offset:128
 s_waitcnt vmcnt(3) lgkmcnt(2)
 v_mfma_f32_32x32x16_bf16 v[64:79], v[140:143], v[168:171], v[64:79]
 v_mfma_f32_32x32x16_bf16 v[80:95], v[140:143], v[172:175], v[80:95]
 v_dot2c_f32_bf16 v176, v168, v180
 v_dot2c_f32_bf16 v178, v168, v168
 v_dot2c_f32_bf16 v176, v169, v180
 v_dot2c_f32_bf16 v178, v169, v169
 v_dot2c_f32_bf16 v176, v170, v180
 v_dot2c_f32_bf16 v178, v170, v170
 v_dot2c_f32_bf16 v176, v171, v180
 v_dot2c_f32_bf16 v178, v171, v171
 v_dot2c_f32_bf16 v177, v172, v180
 v_dot2c_f32_bf16 v179, v172, v172
 v_dot2c_f32_bf16 v177, v173, v180
 v_dot2c_f32_bf16 v179, v173, v173
 v_dot2c_f32_bf16 v177, v174, v180
 v_dot2c_f32_bf16 v179, v174, v174
 v_dot2c_f32_bf16 v177, v175, v180
 v_dot2c_f32_bf16 v179, v175, v175
 buffer_load_dwordx4 v[140:143], v4, s[12:15], s42 offen
 s_add_u32 s42, s42, 1024
 ds_read_b128 v[168:171], v5 offset:160
 ds_read_b128 v[172:175], v7 offset:160
 s_waitcnt vmcnt(3) lgkmcnt(2)
 v_mfma_f32_32x32x16_bf16 v[64:79], v[128:131], v[160:163], v[64:79]
 v_mfma_f32_32x32x16_bf16 v[80:95], v[128:131], v[164:167], v[80:95]
 v_dot2c_f32_bf16 v176, v160, v180
 v_dot2c_f32_bf16 v178, v160, v160
 v_dot2c_f32_bf16 v176, v161, v180
 v_dot2c_f32_bf16 v178, v161, v161
 v_dot2c_f32_bf16 v176, v162, v180
 v_dot2c_f32_bf16 v178, v162, v162
 v_dot2c_f32_bf16 v176, v163, v180
 v_dot2c_f32_bf16 v178, v163, v163
 v_dot2c_f32_bf16 v177, v164, v180
 v_dot2c_f32_bf16 v179, v164, v164
 v_dot2c_f32_bf16 v177, v165, v180
 v_dot2c_f32_bf16 v179, v165, v165
 v_dot2c_f32_bf16 v177, v166, v180
 v_dot2c_f32_bf16 v179, v166, v166
 v_dot2c_f32_bf16 v177, v167, v180
 v_dot2c_f32_bf16 v179, v167, v167
 buffer_load_dwordx4 v[128:131], v4, s[12:15], s42 offen
 s_add_u32 s42, s42, 1024
 ds_read_b128 v[160:163], v5 offset:192
 ds_read_b128 v[164:167], v7 offset:192
 s_waitcnt vmcnt(3) lgkmcnt(2)
 v_mfma_f32_32x32x16_bf16 v[64:79], v[132:135], v[168:171], v[64:79]
 v_mfma_f32_32x32x16_bf16 v[80:95], v[132:135], v[172:175], v[80:95]
 v_dot2c_f32_bf16 v176, v168, v180
 v_dot2c_f32_bf16 v178, v168, v168
 v_dot2c_f32_bf16 v176, v169, v180
 v_dot2c_f32_bf16 v178, v169, v169
 v_dot2c_f32_bf16 v176, v170, v180
 v_dot2c_f32_bf16 v178, v170, v170
 v_dot2c_f32_bf16 v176, v171, v180
 v_dot2c_f32_bf16 v178, v171, v171
 v_dot2c_f32_bf16 v177, v172, v180
 v_dot2c_f32_bf16 v179, v172, v172
 v_dot2c_f32_bf16 v177, v173, v180
 v_dot2c_f32_bf16 v179, v173, v173
 v_dot2c_f32_bf16 v177, v174, v180
 v_dot2c_f32_bf16 v179, v174, v174
 v_dot2c_f32_bf16 v177, v175, v180
 v_dot2c_f32_bf16 v179, v175, v175
 buffer_load_dwordx4 v[132:135], v4, s[12:15], s42 offen
 s_add_u32 s42, s42, 1024
 ds_read_b128 v[168:171], v5 offset:224
 ds_read_b128 v[172:175], v7 offset:224
 s_waitcnt vmcnt(3) lgkmcnt(2)
 v_mfma_f32_32x32x16_bf16 v[64:79], v[136:139], v[160:163], v[64:79]
 v_mfma_f32_32x32x16_bf16 v[80:95], v[136:139], v[164:167], v[80:95]
 v_dot2c_f32_bf16 v176, v160, v180
 v_dot2c_f32_bf16 v178, v160, v160
 v_dot2c_f32_bf16 v176, v161, v180
 v_dot2c_f32_bf16 v178, v161, v161
 v_dot2c_f32_bf16 v176, v162, v180
 v_dot2c_f32_bf16 v178, v162, v162
 v_dot2c_f32_bf16 v176, v163, v180
 v_dot2c_f32_bf16 v178, v163, v163
 v_dot2c_f32_bf16 v177, v164, v180
 v_dot2c_f32_bf16 v179, v164, v164
 v_dot2c_f32_bf16 v177, v165, v180
 v_dot2c_f32_bf16 v179, v165, v165
 v_dot2c_f32_bf16 v177, v166, v180
 v_dot2c_f32_bf16 v179, v166, v166
 v_dot2c_f32_bf16 v177, v167, v180
 v_dot2c_f32_bf16 v179, v167, v167
 buffer_load_dwordx4 v[136:139], v4, s[12:15], s42 offen
 s_add_u32 s42, s42, 1024
 ds_read_b128 v[160:163], v5 offset:256
 ds_read_b128 v[164:167], v7 offset:256
 s_waitcnt vmcnt(3) lgkmcnt(2)
 v_mfma_f32_32x32x16_bf16 v[64:79], v[140:143], v[168:171], v[64:79]
 v_mfma_f32_32x32x16_bf16 v[80:95], v[140:143], v[172:175], v[80:95]
 v_dot2c_f32_bf16 v176, v168, v180
 v_dot2c_f32_bf16 v178, v168, v168
 v_dot2c_f32_bf16 v176, v169, v180
 v_dot2c_f32_bf16 v178, v169, v169
 v_dot2c_f32_bf16 v176, v170, v180
 v_dot2c_f32_bf16 v178, v170, v170
 v_dot2c_f32_bf16 v176, v171, v180
 v_dot2c_f32_bf16 v178, v171, v171
 v_dot2c_f32_bf16 v177, v172, v180
 v_dot2c_f32_bf16 v179, v172, v172
 v_dot2c_f32_bf16 v177, v173, v180
 v_dot2c_f32_bf16 v179, v173, v173
 v_dot2c_f32_bf16 v177, v174, v180
 v_dot2c_f32_bf16 v179, v174, v174
 v_dot2c_f32_bf16 v177, v175, v180
 v_dot2c_f32_bf16 v179, v175, v175
 buffer_load_dwordx4 v[140:143], v4, s[12:15], s42 offen
 s_add_u32 s42, s42, 1024
 ds_read_b128 v[168:171], v5 offset:288
 ds_read_b128 v[172:175], v7 offset:288
 s_waitcnt vmcnt(3) lgkmcnt(2)
 v_mfma_f32_32x32x16_bf16 v[64:79], v[128:131], v[160:163], v[64:79]
 v_mfma_f32_32x32x16_bf16 v[80:95], v[128:131], v[164:167], v[80:95]
 v_dot2c_f32_bf16 v176, v160, v180
 v_dot2c_f32_bf16 v178, v160, v160
 v_dot2c_f32_bf16 v176, v161, v180
 v_dot2c_f32_bf16 v178, v161, v161
 v_dot2c_f32_bf16 v176, v162, v180
 v_dot2c_f32_bf16 v178, v162, v162
 v_dot2c_f32_bf16 v176, v163, v180
 v_dot2c_f32_bf16 v178, v163, v163
 v_dot2c_f32_bf16 v177, v164, v180
 v_dot2c_f32_bf16 v179, v164, v164
 v_dot2c_f32_bf16 v177, v165, v180
 v_dot2c_f32_bf16 v179, v165, v165
 v_dot2c_f32_bf16 v177, v166, v180
 v_dot2c_f32_bf16 v179, v166, v166
 v_dot2c_f32_bf16 v177, v167, v180
 v_dot2c_f32_bf16 v179, v167, v167
 buffer_load_dwordx4 v[128:131], v4, s[12:15], s42 offen
 s_add_u32 s42, s42, 1024
 ds_read_b128 v[160:163], v5 offset:320
 ds_read_b128 v[164:167], v7 offset:320
 s_waitcnt vmcnt(3) lgkmcnt(2)
 v_mfma_f32_32x32x16_bf16 v[64:79], v[132:135], v[168:171], v[64:79]
 v_mfma_f32_32x32x16_bf16 v[80:95], v[132:135], v[172:175], v[80:95]
 v_dot2c_f32_bf16 v176, v168, v180
 v_dot2c_f32_bf16 v178, v168, v168
 v_dot2c_f32_bf16 v176, v169, v180
 v_dot2c_f32_bf16 v178, v169, v169
 v_dot2c_f32_bf16 v176, v170, v180
 v_dot2c_f32_bf16 v178, v170, v170
 v_dot2c_f32_bf16 v176, v171, v180
 v_dot2c_f32_bf16 v178, v171, v171
 v_dot2c_f32_bf16 v177, v172, v180
 v_dot2c_f32_bf16 v179, v172, v172
 v_dot2c_f32_bf16 v177, v173, v180
 v_dot2c_f32_bf16 v179, v173, v173
 v_dot2c_f32_bf16 v177, v174, v180
 v_dot2c_f32_bf16 v179, v174, v174
 v_dot2c_f32_bf16 v177, v175, v180
 v_dot2c_f32_bf16 v179, v175, v175
 buffer_load_dwordx4 v[132:135], v4, s[12:15], s42 offen
 s_add_u32 s42, s42, 1024
 ds_read_b128 v[168:171], v5 offset:352
 ds_read_b128 v[172:175], v7 offset:352
 s_waitcnt vmcnt(3) lgkmcnt(2)
 v_mfma_f32_32x32x16_bf16 v[64:79], v[136:139], v[160:163], v[64:79]
 v_mfma_f32_32x32x16_bf16 v[80:95], v[136:139], v[164:167], v[80:95]
 v_dot2c_f32_bf16 v176, v160, v180
 v_dot2c_f32_bf16 v178, v160, v160
 v_dot2c_f32_bf16 v176, v161, v180
 v_dot2c_f32_bf16 v178, v161, v161
 v_dot2c_f32_bf16 v176, v162, v180
 v_dot2c_f32_bf16 v178, v162, v162
 v_dot2c_f32_bf16 v176, v163, v180
 v_dot2c_f32_bf16 v178, v163, v163
 v_dot2c_f32_bf16 v177, v164, v180
 v_dot2c_f32_bf16 v179, v164, v164
 v_dot2c_f32_bf16 v177, v165, v180
 v_dot2c_f32_bf16 v179, v165, v165
 v_dot2c_f32_bf16 v177, v166, v180
 v_dot2c_f32_bf16 v179, v166, v166
 v_dot2c_f32_bf16 v177, v167, v180
 v_dot2c_f32_bf16 v179, v167, v167
 buffer_load_dwordx4 v[136:139], v4, s[12:15], s42 offen
 s_add_u32 s42, s42, 1024
 ds_read_b128 v[160:163], v5 offset:384
 ds_read_b128 v[164:167], v7 offset:384
 s_waitcnt vmcnt(3) lgkmcnt(2)
 v_mfma_f32_32x32x16_bf16 v[64:79], v[140:143], v[168:171], v[64:79]
 v_mfma_f32_32x32x16_bf16 v[80:95], v[140:143], v[172:175], v[80:95]
 v_dot2c_f32_bf16 v176, v168, v180
 v_dot2c_f32_bf16 v178, v168, v168
 v_dot2c_f32_bf16 v176, v169, v180
 v_dot2c_f32_bf16 v178, v169, v169
 v_dot2c_f32_bf16 v176, v170, v180
 v_dot2c_f32_bf16 v178, v170, v170
 v_dot2c_f32_bf16 v176, v171, v180
 v_dot2c_f32_bf16 v178, v171, v171
 v_dot2c_f32_bf16 v177, v172, v180
 v_dot2c_f32_bf16 v179, v172, v172
 v_dot2c_f32_bf16 v177, v173, v180
 v_dot2c_f32_bf16 v179, v173, v173
 v_dot2c_f32_bf16 v177, v174, v180
 v_dot2c_f32_bf16 v179, v174, v174
 v_dot2c_f32_bf16 v177, v175, v180
 v_dot2c_f32_bf16 v179, v175, v175
 buffer_load_dwordx4 v[140:143], v4, s[12:15], s42 offen
 s_add_u32 s42, s42, 1024
 ds_read_b128 v[168:171], v5 offset:416
 ds_read_b128 v[172:175], v7 offset:416
 s_waitcnt vmcnt(3) lgkmcnt(2)
 v_mfma_f32_32x32x16_bf16 v[64:79], v[128:131], v[160:163], v[64:79]
 v_mfma_f32_32x32x16_bf16 v[80:95], v[128:131], v[164:167], v[80:95]
 v_dot2c_f32_bf16 v176, v160, v180
 v_dot2c_f32_bf16 v178, v160, v160
 v_dot2c_f32_bf16 v176, v161, v180
 v_dot2c_f32_bf16 v178, v161, v161
 v_dot2c_f32_bf16 v176, v162, v180
 v_dot2c_f32_bf16 v178, v162, v162
 v_dot2c_f32_bf16 v176, v163, v180
 v_dot2c_f32_bf16 v178, v163, v163
 v_dot2c_f32_bf16 v177, v164, v180
 v_dot2c_f32_bf16 v179, v164, v164
 v_dot2c_f32_bf16 v177, v165, v180
 v_dot2c_f32_bf16 v179, v165, v165
 v_dot2c_f32_bf16 v177, v166, v180
 v_dot2c_f32_bf16 v179, v166, v166
 v_dot2c_f32_bf16 v177, v167, v180
 v_dot2c_f32_bf16 v179, v167, v167
 buffer_load_dwordx4 v[128:131], v4, s[12:15], s42 offen
 s_add_u32 s42, s42, 1024
 ds_read_b128 v[160:163], v5 offset:448
 ds_read_b128 v[164:167], v7 offset:448
 s_waitcnt vmcnt(3) lgkmcnt(2)
 v_mfma_f32_32x32x16_bf16 v[64:79], v[132:135], v[168:171], v[64:79]
 v_mfma_f32_32x32x16_bf16 v[80:95], v[132:135], v[172:175], v[80:95]
 v_dot2c_f32_bf16 v176, v168, v180
 v_dot2c_f32_bf16 v178, v168, v168
 v_dot2c_f32_bf16 v176, v169, v180
 v_dot2c_f32_bf16 v178, v169, v169
 v_dot2c_f32_bf16 v176, v170, v180
 v_dot2c_f32_bf16 v178, v170, v170
 v_dot2c_f32_bf16 v176, v171, v180
 v_dot2c_f32_bf16 v178, v171, v171
 v_dot2c_f32_bf16 v177, v172, v180
 v_dot2c_f32_bf16 v179, v172, v172
 v_dot2c_f32_bf16 v177, v173, v180
 v_dot2c_f32_bf16 v179, v173, v173
 v_dot2c_f32_bf16 v177, v174, v180
 v_dot2c_f32_bf16 v179, v174, v174
 v_dot2c_f32_bf16 v177, v175, v180
 v_dot2c_f32_bf16 v179, v175, v175
 buffer_load_dwordx4 v[132:135], v4, s[12:15], s42 offen
 s_add_u32 s42, s42, 1024
 ds_read_b128 v[168:171], v5 offset:480
 ds_read_b128 v[172:175], v7 offset:480
 s_waitcnt vmcnt(3) lgkmcnt(2)
 v_mfma_f32_32x32x16_bf16 v[64:79], v[136:139], v[160:163], v[64:79]
 v_mfma_f32_32x32x16_bf16 v[80:95], v[136:139], v[164:167], v[80:95]
 v_dot2c_f32_bf16 v176, v160, v180
 v_dot2c_f32_bf16 v178, v160, v160
 v_dot2c_f32_bf16 v176, v161, v180
 v_dot2c_f32_bf16 v178, v161, v161
 v_dot2c_f32_bf16 v176, v162, v180
 v_dot2c_f32_bf16 v178, v162, v162
 v_dot2c_f32_bf16 v176, v163, v180
 v_dot2c_f32_bf16 v178, v163, v163
 v_dot2c_f32_bf16 v177, v164, v180
 v_dot2c_f32_bf16 v179, v164, v164
 v_dot2c_f32_bf16 v177, v165, v180
 v_dot2c_f32_bf16 v179, v165, v165
 v_dot2c_f32_bf16 v177, v166, v180
 v_dot2c_f32_bf16 v179, v166, v166
 v_dot2c_f32_bf16 v177, v167, v180
 v_dot2c_f32_bf16 v179, v167, v167
 buffer_load_dwordx4 v[136:139], v4, s[12:15], s42 offen
 s_add_u32 s42, s42, 1024
 ds_read_b128 v[160:163], v5 offset:512
 ds_read_b128 v[164:167], v7 offset:512
 s_waitcnt vmcnt(3) lgkmcnt(2)
 v_mfma_f32_32x32x16_bf16 v[64:79], v[140:143], v[168:171], v[64:79]
 v_mfma_f32_32x32x16_bf16 v[80:95], v[140:143], v[172:175], v[80:95]
 v_dot2c_f32_bf16 v176, v168, v180
 v_dot2c_f32_bf16 v178, v168, v168
 v_dot2c_f32_bf16 v176, v169, v180
 v_dot2c_f32_bf16 v178, v169, v169
 v_dot2c_f32_bf16 v176, v170, v180
 v_dot2c_f32_bf16 v178, v170, v170
 v_dot2c_f32_bf16 v176, v171, v180
 v_dot2c_f32_bf16 v178, v171, v171
 v_dot2c_f32_bf16 v177, v172, v180
 v_dot2c_f32_bf16 v179, v172, v172
 v_dot2c_f32_bf16 v177, v173, v180
 v_dot2c_f32_bf16 v179, v173, v173
 v_dot2c_f32_bf16 v177, v174, v180
 v_dot2c_f32_bf16 v179, v174, v174
 v_dot2c_f32_bf16 v177, v175, v180
 v_dot2c_f32_bf16 v179, v175, v175
 buffer_load_dwordx4 v[140:143], v4, s[12:15], s42 offen
 s_add_u32 s42, s42, 1024
 ds_read_b128 v[168:171], v5 offset:544
 ds_read_b128 v[172:175], v7 offset:544
 s_waitcnt vmcnt(3) lgkmcnt(2)
 v_mfma_f32_32x32x16_bf16 v[64:79], v[128:131], v[160:163], v[64:79]
 v_mfma_f32_32x32x16_bf16 v[80:95], v[128:131], v[164:167], v[80:95]
 v_dot2c_f32_bf16 v176, v160, v180
 v_dot2c_f32_bf16 v178, v160, v160
 v_dot2c_f32_bf16 v176, v161, v180
 v_dot2c_f32_bf16 v178, v161, v161
 v_dot2c_f32_bf16 v176, v162, v180
 v_dot2c_f32_bf16 v178, v162, v162
 v_dot2c_f32_bf16 v176, v163, v180
 v_dot2c_f32_bf16 v178, v163, v163
 v_dot2c_f32_bf16 v177, v164, v180
 v_dot2c_f32_bf16 v179, v164, v164
 v_dot2c_f32_bf16 v177, v165, v180
 v_dot2c_f32_bf16 v179, v165, v165
 v_dot2c_f32_bf16 v177, v166, v180
 v_dot2c_f32_bf16 v179, v166, v166
 v_dot2c_f32_bf16 v177, v167, v180
 v_dot2c_f32_bf16 v179, v167, v167
 buffer_load_dwordx4 v[128:131], v4, s[12:15], s42 offen
 s_add_u32 s42, s42, 1024
 ds_read_b128 v[160:163], v5 offset:576
 ds_read_b128 v[164:167], v7 offset:576
 s_waitcnt vmcnt(3) lgkmcnt(2)
 v_mfma_f32_32x32x16_bf16 v[64:79], v[132:135], v[168:171], v[64:79]
 v_mfma_f32_32x32x16_bf16 v[80:95], v[132:135], v[172:175], v[80:95]
 v_dot2c_f32_bf16 v176, v168, v180
 v_dot2c_f32_bf16 v178, v168, v168
 v_dot2c_f32_bf16 v176, v169, v180
 v_dot2c_f32_bf16 v178, v169, v169
 v_dot2c_f32_bf16 v176, v170, v180
 v_dot2c_f32_bf16 v178, v170, v170
 v_dot2c_f32_bf16 v176, v171, v180
 v_dot2c_f32_bf16 v178, v171, v171
 v_dot2c_f32_bf16 v177, v172, v180
 v_dot2c_f32_bf16 v179, v172, v172
 v_dot2c_f32_bf16 v177, v173, v180
 v_dot2c_f32_bf16 v179, v173, v173
 v_dot2c_f32_bf16 v177, v174, v180
 v_dot2c_f32_bf16 v179, v174, v174
 v_dot2c_f32_bf16 v177, v175, v180
 v_dot2c_f32_bf16 v179, v175, v175
 buffer_load_dwordx4 v[132:135], v4, s[12:15], s42 offen
 s_add_u32 s42, s42, 1024
 ds_read_b128 v[168:171], v5 offset:608
 ds_read_b128 v[172:175], v7 offset:608
 s_waitcnt vmcnt(3) lgkmcnt(2)
 v_mfma_f32_32x32x16_bf16 v[64:79], v[136:139], v[160:163], v[64:79]
 v_mfma_f32_32x32x16_bf16 v[80:95], v[136:139], v[164:167], v[80:95]
 v_dot2c_f32_bf16 v176, v160, v180
 v_dot2c_f32_bf16 v178, v160, v160
 v_dot2c_f32_bf16 v176, v161, v180
 v_dot2c_f32_bf16 v178, v161, v161
 v_dot2c_f32_bf16 v176, v162, v180
 v_dot2c_f32_bf16 v178, v162, v162
 v_dot2c_f32_bf16 v176, v163, v180
 v_dot2c_f32_bf16 v178, v163, v163
 v_dot2c_f32_bf16 v177, v164, v180
 v_dot2c_f32_bf16 v179, v164, v164
 v_dot2c_f32_bf16 v177, v165, v180
 v_dot2c_f32_bf16 v179, v165, v165
 v_dot2c_f32_bf16 v177, v166, v180
 v_dot2c_f32_bf16 v179, v166, v166
 v_dot2c_f32_bf16 v177, v167, v180
 v_dot2c_f32_bf16 v179, v167, v167
 buffer_load_dwordx4 v[136:139], v4, s[12:15], s42 offen
 s_add_u32 s42, s42, 1024
 ds_read_b128 v[160:163], v5 offset:640
 ds_read_b128 v[164:167], v7 offset:640
 s_waitcnt vmcnt(3) lgkmcnt(2)
 v_mfma_f32_32x32x16_bf16 v[64:79], v[140:143], v[168:171], v[64:79]
 v_mfma_f32_32x32x16_bf16 v[80:95], v[140:143], v[172:175], v[80:95]
 v_dot2c_f32_bf16 v176, v168, v180
 v_dot2c_f32_bf16 v178, v168, v168
 v_dot2c_f32_bf16 v176, v169, v180
 v_dot2c_f32_bf16 v178, v169, v169
 v_dot2c_f32_bf16 v176, v170, v180
 v_dot2c_f32_bf16 v178, v170, v170
 v_dot2c_f32_bf16 v176, v171, v180
 v_dot2c_f32_bf16 v178, v171, v171
 v_dot2c_f32_bf16 v177, v172, v180
 v_dot2c_f32_bf16 v179, v172, v172
 v_dot2c_f32_bf16 v177, v173, v180
 v_dot2c_f32_bf16 v179, v173, v173
 v_dot2c_f32_bf16 v177, v174, v180
 v_dot2c_f32_bf16 v179, v174, v174
 v_dot2c_f32_bf16 v177, v175, v180
 v_dot2c_f32_bf16 v179, v175, v175
 buffer_load_dwordx4 v[140:143], v4, s[12:15], s42 offen
 s_add_u32 s42, s42, 1024
 ds_read_b128 v[168:171], v5 offset:672
 ds_read_b128 v[172:175], v7 offset:672
 s_waitcnt vmcnt(3) lgkmcnt(2)
 v_mfma_f32_32x32x16_bf16 v[64:79], v[128:131], v[160:163], v[64:79]
 v_mfma_f32_32x32x16_bf16 v[80:95], v[128:131], v[164:167], v[80:95]
 v_dot2c_f32_bf16 v176, v160, v180
 v_dot2c_f32_bf16 v178, v160, v160
 v_dot2c_f32_bf16 v176, v161, v180
 v_dot2c_f32_bf16 v178, v161, v161
 v_dot2c_f32_bf16 v176, v162, v180
 v_dot2c_f32_bf16 v178, v162, v162
 v_dot2c_f32_bf16 v176, v163, v180
 v_dot2c_f32_bf16 v178, v163, v163
 v_dot2c_f32_bf16 v177, v164, v180
 v_dot2c_f32_bf16 v179, v164, v164
 v_dot2c_f32_bf16 v177, v165, v180
 v_dot2c_f32_bf16 v179, v165, v165
 v_dot2c_f32_bf16 v177, v166, v180
 v_dot2c_f32_bf16 v179, v166, v166
 v_dot2c_f32_bf16 v177, v167, v180
 v_dot2c_f32_bf16 v179, v167, v167
 buffer_load_dwordx4 v[128:131], v4, s[12:15], s42 offen
 s_add_u32 s42, s42, 1024
 ds_read_b128 v[160:163], v5 offset:704
 ds_read_b128 v[164:167], v7 offset:704
 s_waitcnt vmcnt(3) lgkmcnt(2)
 v_mfma_f32_32x32x16_bf16 v[64:79], v[132:135], v[168:171], v[64:79]
 v_mfma_f32_32x32x16_bf16 v[80:95], v[132:135], v[172:175], v[80:95]
 v_dot2c_f32_bf16 v176, v168, v180
 v_dot2c_f32_bf16 v178, v168, v168
 v_dot2c_f32_bf16 v176, v169, v180
 v_dot2c_f32_bf16 v178, v169, v169
 v_dot2c_f32_bf16 v176, v170, v180
 v_dot2c_f32_bf16 v178, v170, v170
 v_dot2c_f32_bf16 v176, v171, v180
 v_dot2c_f32_bf16 v178, v171, v171
 v_dot2c_f32_bf16 v177, v172, v180
 v_dot2c_f32_bf16 v179, v172, v172
 v_dot2c_f32_bf16 v177, v173, v180
 v_dot2c_f32_bf16 v179, v173, v173
 v_dot2c_f32_bf16 v177, v174, v180
 v_dot2c_f32_bf16 v179, v174, v174
 v_dot2c_f32_bf16 v177, v175, v180
 v_dot2c_f32_bf16 v179, v175, v175
 buffer_load_dwordx4 v[132:135], v4, s[12:15], s42 offen
 s_add_u32 s42, s42, 1024
 ds_read_b128 v[168:171], v5 offset:736
 ds_read_b128 v[172:175], v7 offset:736
 s_waitcnt vmcnt(3) lgkmcnt(2)
 v_mfma_f32_32x32x16_bf16 v[64:79], v[136:139], v[160:163], v[64:79]
 v_mfma_f32_32x32x16_bf16 v[80:95], v[136:139], v[164:167], v[80:95]
 v_dot2c_f32_bf16 v176, v160, v180
 v_dot2c_f32_bf16 v178, v160, v160
 v_dot2c_f32_bf16 v176, v161, v180
 v_dot2c_f32_bf16 v178, v161, v161
 v_dot2c_f32_bf16 v176, v162, v180
 v_dot2c_f32_bf16 v178, v162, v162
 v_dot2c_f32_bf16 v176, v163, v180
 v_dot2c_f32_bf16 v178, v163, v163
 v_dot2c_f32_bf16 v177, v164, v180
 v_dot2c_f32_bf16 v179, v164, v164
 v_dot2c_f32_bf16 v177, v165, v180
 v_dot2c_f32_bf16 v179, v165, v165
 v_dot2c_f32_bf16 v177, v166, v180
 v_dot2c_f32_bf16 v179, v166, v166
 v_dot2c_f32_bf16 v177, v167, v180
 v_dot2c_f32_bf16 v179, v167, v167
 buffer_load_dwordx4 v[136:139], v4, s[12:15], s42 offen
 s_add_u32 s42, s42, 1024
 ds_read_b128 v[160:163], v5 offset:768
 ds_read_b128 v[164:167], v7 offset:768
 s_waitcnt vmcnt(3) lgkmcnt(2)
 v_mfma_f32_32x32x16_bf16 v[64:79], v[140:143], v[168:171], v[64:79]
 v_mfma_f32_32x32x16_bf16 v[80:95], v[140:143], v[172:175], v[80:95]
 v_dot2c_f32_bf16 v176, v168, v180
 v_dot2c_f32_bf16 v178, v168, v168
 v_dot2c_f32_bf16 v176, v169, v180
 v_dot2c_f32_bf16 v178, v169, v169
 v_dot2c_f32_bf16 v176, v170, v180
 v_dot2c_f32_bf16 v178, v170, v170
 v_dot2c_f32_bf16 v176, v171, v180
 v_dot2c_f32_bf16 v178, v171, v171
 v_dot2c_f32_bf16 v177, v172, v180
 v_dot2c_f32_bf16 v179, v172, v172
 v_dot2c_f32_bf16 v177, v173, v180
 v_dot2c_f32_bf16 v179, v173, v173
 v_dot2c_f32_bf16 v177, v174, v180
 v_dot2c_f32_bf16 v179, v174, v174
 v_dot2c_f32_bf16 v177, v175, v180
 v_dot2c_f32_bf16 v179, v175, v175
 buffer_load_dwordx4 v[140:143], v4, s[12:15], s42 offen
 s_add_u32 s42, s42, 1024
 ds_read_b128 v[168:171], v5 offset:800
 ds_read_b128 v[172:175], v7 offset:800
 s_waitcnt vmcnt(3) lgkmcnt(2)
 v_mfma_f32_32x32x16_bf16 v[64:79], v[128:131], v[160:163], v[64:79]
 v_mfma_f32_32x32x16_bf16 v[80:95], v[128:131], v[164:167], v[80:95]
 v_dot2c_f32_bf16 v176, v160, v180
 v_dot2c_f32_bf16 v178, v160, v160
 v_dot2c_f32_bf16 v176, v161, v180
 v_dot2c_f32_bf16 v178, v161, v161
 v_dot2c_f32_bf16 v176, v162, v180
 v_dot2c_f32_bf16 v178, v162, v162
 v_dot2c_f32_bf16 v176, v163, v180
 v_dot2c_f32_bf16 v178, v163, v163
 v_dot2c_f32_bf16 v177, v164, v180
 v_dot2c_f32_bf16 v179, v164, v164
 v_dot2c_f32_bf16 v177, v165, v180
 v_dot2c_f32_bf16 v179, v165, v165
 v_dot2c_f32_bf16 v177, v166, v180
 v_dot2c_f32_bf16 v179, v166, v166
 v_dot2c_f32_bf16 v177, v167, v180
 v_dot2c_f32_bf16 v179, v167, v167
 buffer_load_dwordx4 v[128:131], v4, s[12:15], s42 offen
 s_add_u32 s42, s42, 1024
 ds_read_b128 v[160:163], v5 offset:832
 ds_read_b128 v[164:167], v7 offset:832
 s_waitcnt vmcnt(3) lgkmcnt(2)
 v_mfma_f32_32x32x16_bf16 v[64:79], v[132:135], v[168:171], v[64:79]
 v_mfma_f32_32x32x16_bf16 v[80:95], v[132:135], v[172:175], v[80:95]
 v_dot2c_f32_bf16 v176, v168, v180
 v_dot2c_f32_bf16 v178, v168, v168
 v_dot2c_f32_bf16 v176, v169, v180
 v_dot2c_f32_bf16 v178, v169, v169
 v_dot2c_f32_bf16 v176, v170, v180
 v_dot2c_f32_bf16 v178, v170, v170
 v_dot2c_f32_bf16 v176, v171, v180
 v_dot2c_f32_bf16 v178, v171, v171
 v_dot2c_f32_bf16 v177, v172, v180
 v_dot2c_f32_bf16 v179, v172, v172
 v_dot2c_f32_bf16 v177, v173, v180
 v_dot2c_f32_bf16 v179, v173, v173
 v_dot2c_f32_bf16 v177, v174, v180
 v_dot2c_f32_bf16 v179, v174, v174
 v_dot2c_f32_bf16 v177, v175, v180
 v_dot2c_f32_bf16 v179, v175, v175
 buffer_load_dwordx4 v[132:135], v4, s[12:15], s42 offen
 s_add_u32 s42, s42, 1024
 ds_read_b128 v[168:171], v5 offset:864
 ds_read_b128 v[172:175], v7 offset:864
 s_waitcnt vmcnt(3) lgkmcnt(2)
 v_mfma_f32_32x32x16_bf16 v[64:79], v[136:139], v[160:163], v[64:79]
 v_mfma_f32_32x32x16_bf16 v[80:95], v[136:139], v[164:167], v[80:95]
 v_dot2c_f32_bf16 v176, v160, v180
 v_dot2c_f32_bf16 v178, v160, v160
 v_dot2c_f32_bf16 v176, v161, v180
 v_dot2c_f32_bf16 v178, v161, v161
 v_dot2c_f32_bf16 v176, v162, v180
 v_dot2c_f32_bf16 v178, v162, v162
 v_dot2c_f32_bf16 v176, v163, v180
 v_dot2c_f32_bf16 v178, v163, v163
 v_dot2c_f32_bf16 v177, v164, v180
 v_dot2c_f32_bf16 v179, v164, v164
 v_dot2c_f32_bf16 v177, v165, v180
 v_dot2c_f32_bf16 v179, v165, v165
 v_dot2c_f32_bf16 v177, v166, v180
 v_dot2c_f32_bf16 v179, v166, v166
 v_dot2c_f32_bf16 v177, v167, v180
 v_dot2c_f32_bf16 v179, v167, v167
 buffer_load_dwordx4 v[136:139], v4, s[12:15], s42 offen
 s_add_u32 s42, s42, 1024
 ds_read_b128 v[160:163], v5 offset:896
 ds_read_b128 v[164:167], v7 offset:896
 s_waitcnt vmcnt(3) lgkmcnt(2)
 v_mfma_f32_32x32x16_bf16 v[64:79], v[140:143], v[168:171], v[64:79]
 v_mfma_f32_32x32x16_bf16 v[80:95], v[140:143], v[172:175], v[80:95]
 v_dot2c_f32_bf16 v176, v168, v180
 v_dot2c_f32_bf16 v178, v168, v168
 v_dot2c_f32_bf16 v176, v169, v180
 v_dot2c_f32_bf16 v178, v169, v169
 v_dot2c_f32_bf16 v176, v170, v180
 v_dot2c_f32_bf16 v178, v170, v170
 v_dot2c_f32_bf16 v176, v171, v180
 v_dot2c_f32_bf16 v178, v171, v171
 v_dot2c_f32_bf16 v177, v172, v180
 v_dot2c_f32_bf16 v179, v172, v172
 v_dot2c_f32_bf16 v177, v173, v180
 v_dot2c_f32_bf16 v179, v173, v173
 v_dot2c_f32_bf16 v177, v174, v180
 v_dot2c_f32_bf16 v179, v174, v174
 v_dot2c_f32_bf16 v177, v175, v180
 v_dot2c_f32_bf16 v179, v175, v175
 buffer_load_dwordx4 v[140:143], v4, s[12:15], s42 offen
 s_add_u32 s42, s42, 1024
 ds_read_b128 v[168:171], v5 offset:928
 ds_read_b128 v[172:175], v7 offset:928
 s_waitcnt vmcnt(3) lgkmcnt(2)
 v_mfma_f32_32x32x16_bf16 v[64:79], v[128:131], v[160:163], v[64:79]
 v_mfma_f32_32x32x16_bf16 v[80:95], v[128:131], v[164:167], v[80:95]
 v_dot2c_f32_bf16 v176, v160, v180
 v_dot2c_f32_bf16 v178, v160, v160
 v_dot2c_f32_bf16 v176, v161, v180
 v_dot2c_f32_bf16 v178, v161, v161
 v_dot2c_f32_bf16 v176, v162, v180
 v_dot2c_f32_bf16 v178, v162, v162
 v_dot2c_f32_bf16 v176, v163, v180
 v_dot2c_f32_bf16 v178, v163, v163
 v_dot2c_f32_bf16 v177, v164, v180
 v_dot2c_f32_bf16 v179, v164, v164
 v_dot2c_f32_bf16 v177, v165, v180
 v_dot2c_f32_bf16 v179, v165, v165
 v_dot2c_f32_bf16 v177, v166, v180
 v_dot2c_f32_bf16 v179, v166, v166
 v_dot2c_f32_bf16 v177, v167, v180
 v_dot2c_f32_bf16 v179, v167, v167
 buffer_load_dwordx4 v[128:131], v4, s[12:15], s42 offen
 s_add_u32 s42, s42, 1024
 ds_read_b128 v[160:163], v5 offset:960
 ds_read_b128 v[164:167], v7 offset:960
 s_waitcnt vmcnt(3) lgkmcnt(2)
 v_mfma_f32_32x32x16_bf16 v[64:79], v[132:135], v[168:171], v[64:79]
 v_mfma_f32_32x32x16_bf16 v[80:95], v[132:135], v[172:175], v[80:95]
 v_dot2c_f32_bf16 v176, v168, v180
 v_dot2c_f32_bf16 v178, v168, v168
 v_dot2c_f32_bf16 v176, v169, v180
 v_dot2c_f32_bf16 v178, v169, v169
 v_dot2c_f32_bf16 v176, v170, v180
 v_dot2c_f32_bf16 v178, v170, v170
 v_dot2c_f32_bf16 v176, v171, v180
 v_dot2c_f32_bf16 v178, v171, v171
 v_dot2c_f32_bf16 v177, v172, v180
 v_dot2c_f32_bf16 v179, v172, v172
 v_dot2c_f32_bf16 v177, v173, v180
 v_dot2c_f32_bf16 v179, v173, v173
 v_dot2c_f32_bf16 v177, v174, v180
 v_dot2c_f32_bf16 v179, v174, v174
 v_dot2c_f32_bf16 v177, v175, v180
 v_dot2c_f32_bf16 v179, v175, v175
 buffer_load_dwordx4 v[132:135], v4, s[12:15], s42 offen
 s_add_u32 s42, s42, 1024
 ds_read_b128 v[168:171], v5 offset:992
 ds_read_b128 v[172:175], v7 offset:992
 s_waitcnt vmcnt(3) lgkmcnt(2)
 v_mfma_f32_32x32x16_bf16 v[64:79], v[136:139], v[160:163], v[64:79]
 v_mfma_f32_32x32x16_bf16 v[80:95], v[136:139], v[164:167], v[80:95]
 v_dot2c_f32_bf16 v176, v160, v180
 v_dot2c_f32_bf16 v178, v160, v160
 v_dot2c_f32_bf16 v176, v161, v180
 v_dot2c_f32_bf16 v178, v161, v161
 v_dot2c_f32_bf16 v176, v162, v180
 v_dot2c_f32_bf16 v178, v162, v162
 v_dot2c_f32_bf16 v176, v163, v180
 v_dot2c_f32_bf16 v178, v163, v163
 v_dot2c_f32_bf16 v177, v164, v180
 v_dot2c_f32_bf16 v179, v164, v164
 v_dot2c_f32_bf16 v177, v165, v180
 v_dot2c_f32_bf16 v179, v165, v165
 v_dot2c_f32_bf16 v177, v166, v180
 v_dot2c_f32_bf16 v179, v166, v166
 v_dot2c_f32_bf16 v177, v167, v180
 v_dot2c_f32_bf16 v179, v167, v167
 buffer_load_dwordx4 v[136:139], v4, s[12:15], s42 offen
 s_add_u32 s42, s42, 1024
 ds_read_b128 v[160:163], v5 offset:1024
 ds_read_b128 v[164:167], v7 offset:1024
 s_waitcnt vmcnt(3) lgkmcnt(2)
 v_mfma_f32_32x32x16_bf16 v[64:79], v[140:143], v[168:171], v[64:79]
 v_mfma_f32_32x32x16_bf16 v[80:95], v[140:143], v[172:175], v[80:95]
 v_dot2c_f32_bf16 v176, v168, v180
 v_dot2c_f32_bf16 v178, v168, v168
 v_dot2c_f32_bf16 v176, v169, v180
 v_dot2c_f32_bf16 v178, v169, v169
 v_dot2c_f32_bf16 v176, v170, v180
 v_dot2c_f32_bf16 v178, v170, v170
 v_dot2c_f32_bf16 v176, v171, v180
 v_dot2c_f32_bf16 v178, v171, v171
 v_dot2c_f32_bf16 v177, v172, v180
 v_dot2c_f32_bf16 v179, v172, v172
 v_dot2c_f32_bf16 v177, v173, v180
 v_dot2c_f32_bf16 v179, v173, v173
 v_dot2c_f32_bf16 v177, v174, v180
 v_dot2c_f32_bf16 v179, v174, v174
 v_dot2c_f32_bf16 v177, v175, v180
 v_dot2c_f32_bf16 v179, v175, v175
 buffer_load_dwordx4 v[140:143], v4, s[12:15], s42 offen
 s_add_u32 s42, s42, 1024
 ds_read_b128 v[168:171], v5 offset:1056
 ds_read_b128 v[172:175], v7 offset:1056
 s_waitcnt vmcnt(3) lgkmcnt(2)
 v_mfma_f32_32x32x16_bf16 v[64:79], v[128:131], v[160:163], v[64:79]
 v_mfma_f32_32x32x16_bf16 v[80:95], v[128:131], v[164:167], v[80:95]
 v_dot2c_f32_bf16 v176, v160, v180
 v_dot2c_f32_bf16 v178, v160, v160
 v_dot2c_f32_bf16 v176, v161, v180
 v_dot2c_f32_bf16 v178, v161, v161
 v_dot2c_f32_bf16 v176, v162, v180
 v_dot2c_f32_bf16 v178, v162, v162
 v_dot2c_f32_bf16 v176, v163, v180
 v_dot2c_f32_bf16 v178, v163, v163
 v_dot2c_f32_bf16 v177, v164, v180
 v_dot2c_f32_bf16 v179, v164, v164
 v_dot2c_f32_bf16 v177, v165, v180
 v_dot2c_f32_bf16 v179, v165, v165
 v_dot2c_f32_bf16 v177, v166, v180
 v_dot2c_f32_bf16 v179, v166, v166
 v_dot2c_f32_bf16 v177, v167, v180
 v_dot2c_f32_bf16 v179, v167, v167
 buffer_load_dwordx4 v[128:131], v4, s[12:15], s42 offen
 s_add_u32 s42, s42, 1024
 ds_read_b128 v[160:163], v5 offset:1088
 ds_read_b128 v[164:167], v7 offset:1088
 s_waitcnt vmcnt(3) lgkmcnt(2)
 v_mfma_f32_32x32x16_bf16 v[64:79], v[132:135], v[168:171], v[64:79]
 v_mfma_f32_32x32x16_bf16 v[80:95], v[132:135], v[172:175], v[80:95]
 v_dot2c_f32_bf16 v176, v168, v180
 v_dot2c_f32_bf16 v178, v168, v168
 v_dot2c_f32_bf16 v176, v169, v180
 v_dot2c_f32_bf16 v178, v169, v169
 v_dot2c_f32_bf16 v176, v170, v180
 v_dot2c_f32_bf16 v178, v170, v170
 v_dot2c_f32_bf16 v176, v171, v180
 v_dot2c_f32_bf16 v178, v171, v171
 v_dot2c_f32_bf16 v177, v172, v180
 v_dot2c_f32_bf16 v179, v172, v172
 v_dot2c_f32_bf16 v177, v173, v180
 v_dot2c_f32_bf16 v179, v173, v173
 v_dot2c_f32_bf16 v177, v174, v180
 v_dot2c_f32_bf16 v179, v174, v174
 v_dot2c_f32_bf16 v177, v175, v180
 v_dot2c_f32_bf16 v179, v175, v175
 buffer_load_dwordx4 v[132:135], v4, s[12:15], s42 offen
 s_add_u32 s42, s42, 1024
 ds_read_b128 v[168:171], v5 offset:1120
 ds_read_b128 v[172:175], v7 offset:1120
 s_waitcnt vmcnt(3) lgkmcnt(2)
 v_mfma_f32_32x32x16_bf16 v[64:79], v[136:139], v[160:163], v[64:79]
 v_mfma_f32_32x32x16_bf16 v[80:95], v[136:139], v[164:167], v[80:95]
 v_dot2c_f32_bf16 v176, v160, v180
 v_dot2c_f32_bf16 v178, v160, v160
 v_dot2c_f32_bf16 v176, v161, v180
 v_dot2c_f32_bf16 v178, v161, v161
 v_dot2c_f32_bf16 v176, v162, v180
 v_dot2c_f32_bf16 v178, v162, v162
 v_dot2c_f32_bf16 v176, v163, v180
 v_dot2c_f32_bf16 v178, v163, v163
 v_dot2c_f32_bf16 v177, v164, v180
 v_dot2c_f32_bf16 v179, v164, v164
 v_dot2c_f32_bf16 v177, v165, v180
 v_dot2c_f32_bf16 v179, v165, v165
 v_dot2c_f32_bf16 v177, v166, v180
 v_dot2c_f32_bf16 v179, v166, v166
 v_dot2c_f32_bf16 v177, v167, v180
 v_dot2c_f32_bf16 v179, v167, v167
 buffer_load_dwordx4 v[136:139], v4, s[12:15], s42 offen
 s_add_u32 s42, s42, 1024
 ds_read_b128 v[160:163], v5 offset:1152
 ds_read_b128 v[164:167], v7 offset:1152
 s_waitcnt vmcnt(3) lgkmcnt(2)
 v_mfma_f32_32x32x16_bf16 v[64:79], v[140:143], v[168:171], v[64:79]
 v_mfma_f32_32x32x16_bf16 v[80:95], v[140:143], v[172:175], v[80:95]
 v_dot2c_f32_bf16 v176, v168, v180
 v_dot2c_f32_bf16 v178, v168, v168
 v_dot2c_f32_bf16 v176, v169, v180
 v_dot2c_f32_bf16 v178, v169, v169
 v_dot2c_f32_bf16 v176, v170, v180
 v_dot2c_f32_bf16 v178, v170, v170
 v_dot2c_f32_bf16 v176, v171, v180
 v_dot2c_f32_bf16 v178, v171, v171
 v_dot2c_f32_bf16 v177, v172, v180
 v_dot2c_f32_bf16 v179, v172, v172
 v_dot2c_f32_bf16 v177, v173, v180
 v_dot2c_f32_bf16 v179, v173, v173
 v_dot2c_f32_bf16 v177, v174, v180
 v_dot2c_f32_bf16 v179, v174, v174
 v_dot2c_f32_bf16 v177, v175, v180
 v_dot2c_f32_bf16 v179, v175, v175
 buffer_load_dwordx4 v[140:143], v4, s[12:15], s42 offen
 s_add_u32 s42, s42, 1024
 ds_read_b128 v[168:171], v5 offset:1184
 ds_read_b128 v[172:175], v7 offset:1184
 s_waitcnt vmcnt(3) lgkmcnt(2)
 v_mfma_f32_32x32x16_bf16 v[64:79], v[128:131], v[160:163], v[64:79]
 v_mfma_f32_32x32x16_bf16 v[80:95], v[128:131], v[164:167], v[80:95]
 v_dot2c_f32_bf16 v176, v160, v180
 v_dot2c_f32_bf16 v178, v160, v160
 v_dot2c_f32_bf16 v176, v161, v180
 v_dot2c_f32_bf16 v178, v161, v161
 v_dot2c_f32_bf16 v176, v162, v180
 v_dot2c_f32_bf16 v178, v162, v162
 v_dot2c_f32_bf16 v176, v163, v180
 v_dot2c_f32_bf16 v178, v163, v163
 v_dot2c_f32_bf16 v177, v164, v180
 v_dot2c_f32_bf16 v179, v164, v164
 v_dot2c_f32_bf16 v177, v165, v180
 v_dot2c_f32_bf16 v179, v165, v165
 v_dot2c_f32_bf16 v177, v166, v180
 v_dot2c_f32_bf16 v179, v166, v166
 v_dot2c_f32_bf16 v177, v167, v180
 v_dot2c_f32_bf16 v179, v167, v167
 ds_read_b128 v[160:163], v5 offset:1216
 ds_read_b128 v[164:167], v7 offset:1216
 s_waitcnt vmcnt(2) lgkmcnt(2)
 v_mfma_f32_32x32x16_bf16 v[64:79], v[132:135], v[168:171], v[64:79]
 v_mfma_f32_32x32x16_bf16 v[80:95], v[132:135], v[172:175], v[80:95]
 v_dot2c_f32_bf16 v176, v168, v180
 v_dot2c_f32_bf16 v178, v168, v168
 v_dot2c_f32_bf16 v176, v169, v180
 v_dot2c_f32_bf16 v178, v169, v169
 v_dot2c_f32_bf16 v176, v170, v180
 v_dot2c_f32_bf16 v178, v170, v170
 v_dot2c_f32_bf16 v176, v171, v180
 v_dot2c_f32_bf16 v178, v171, v171
 v_dot2c_f32_bf16 v177, v172, v180
 v_dot2c_f32_bf16 v179, v172, v172
 v_dot2c_f32_bf16 v177, v173, v180
 v_dot2c_f32_bf16 v179, v173, v173
 v_dot2c_f32_bf16 v177, v174, v180
 v_dot2c_f32_bf16 v179, v174, v174
 v_dot2c_f32_bf16 v177, v175, v180
 v_dot2c_f32_bf16 v179, v175, v175
 ds_read_b128 v[168:171], v5 offset:1248
 ds_read_b128 v[172:175], v7 offset:1248
 s_waitcnt vmcnt(1) lgkmcnt(2)
 v_mfma_f32_32x32x16_bf16 v[64:79], v[136:139], v[160:163], v[64:79]
 v_mfma_f32_32x32x16_bf16 v[80:95], v[136:139], v[164:167], v[80:95]
 v_dot2c_f32_bf16 v176, v160, v180
 v_dot2c_f32_bf16 v178, v160, v160
 v_dot2c_f32_bf16 v176, v161, v180
 v_dot2c_f32_bf16 v178, v161, v161
 v_dot2c_f32_bf16 v176, v162, v180
 v_dot2c_f32_bf16 v178, v162, v162
 v_dot2c_f32_bf16 v176, v163, v180
 v_dot2c_f32_bf16 v178, v163, v163
 v_dot2c_f32_bf16 v177, v164, v180
 v_dot2c_f32_bf16 v179, v164, v164
 v_dot2c_f32_bf16 v177, v165, v180
 v_dot2c_f32_bf16 v179, v165, v165
 v_dot2c_f32_bf16 v177, v166, v180
 v_dot2c_f32_bf16 v179, v166, v166
 v_dot2c_f32_bf16 v177, v167, v180
 v_dot2c_f32_bf16 v179, v167, v167
 s_waitcnt vmcnt(0) lgkmcnt(0)
 v_mfma_f32_32x32x16_bf16 v[64:79], v[140:143], v[168:171], v[64:79]
 v_mfma_f32_32x32x16_bf16 v[80:95], v[140:143], v[172:175], v[80:95]
 v_dot2c_f32_bf16 v176, v168, v180
 v_dot2c_f32_bf16 v178, v168, v168
 v_dot2c_f32_bf16 v176, v169, v180
 v_dot2c_f32_bf16 v178, v169, v169
 v_dot2c_f32_bf16 v176, v170, v180
 v_dot2c_f32_bf16 v178, v170, v170
 v_dot2c_f32_bf16 v176, v171, v180
 v_dot2c_f32_bf16 v178, v171, v171
 v_dot2c_f32_bf16 v177, v172, v180
 v_dot2c_f32_bf16 v179, v172, v172
 v_dot2c_f32_bf16 v177, v173, v180
 v_dot2c_f32_bf16 v179, v173, v173
 v_dot2c_f32_bf16 v177, v174, v180
 v_dot2c_f32_bf16 v179, v174, v174
 v_dot2c_f32_bf16 v177, v175, v180
 v_dot2c_f32_bf16 v179, v175, v175
 s_nop 11
 v_mov_b32 v186, v176
 s_nop 1
 v_permlane32_swap_b32 v176, v186
 v_add_f32 v176, v176, v186
 v_mov_b32 v186, v177
 s_nop 1
 v_permlane32_swap_b32 v177, v186
 v_add_f32 v177, v177, v186
 v_mov_b32 v186, v178
 s_nop 1
 v_permlane32_swap_b32 v178, v186
 v_add_f32 v178, v178, v186
 v_mov_b32 v186, v179
 s_nop 1
 v_permlane32_swap_b32 v179, v186
 v_add_f32 v179, v179, v186
 s_mov_b32 s44, 0x3acccccd
 s_mov_b32 s45, 0x3727c5ac
 v_mul_f32 v186, s44, v176
 v_mul_f32 v187, s44, v178
 v_fma_f32 v187, -v186, v186, v187
 v_add_f32 v187, s45, v187
 v_rsq_f32 v181, v187
 s_nop 0
 v_mul_f32 v183, v181, v186
 v_mul_f32 v186, s44, v177
 v_mul_f32 v187, s44, v179
 v_fma_f32 v187, -v186, v186, v187
 v_add_f32 v187, s45, v187
 v_rsq_f32 v182, v187
 s_nop 0
 v_mul_f32 v184, v182, v186
 s_cmp_ge_u32 s40, 20
 s_cbranch_scc1 L_a1_0_kernel_ktype
 s_add_u32 s49, s40, 0
 v_bfe_u32 v8, v0, 5, 1
 v_lshlrev_b32 v8, 2, v8
 v_and_b32 v9, 31, v0
 s_lshl_b32 s46, s49, 5
 v_add_u32 v8, s46, v8
 s_mov_b32 s47, 0x3ea52b5c
 v_add_u32 v10, 0, v8
 v_lshlrev_b32 v11, 2, v10
 buffer_load_dwordx4 v[12:15], v11, s[16:19], 0 offen
 v_add_u32 v10, 8, v8
 v_lshlrev_b32 v11, 2, v10
 buffer_load_dwordx4 v[16:19], v11, s[16:19], 0 offen
 v_add_u32 v10, 16, v8
 v_lshlrev_b32 v11, 2, v10
 buffer_load_dwordx4 v[20:23], v11, s[16:19], 0 offen
 v_add_u32 v10, 24, v8
 v_lshlrev_b32 v11, 2, v10
 buffer_load_dwordx4 v[24:27], v11, s[16:19], 0 offen
 v_mul_f32 v28, s47, v181
 v_mul_f32 v29, s47, v183
 s_lshl_b32 s48, s32, 1
 s_add_u32 s48, s48, 0
 s_lshl_b32 s48, s48, 11
 s_waitcnt vmcnt(3)
 v_add_u32 v10, 0, v8
 v_mul_u32_u24 v11, 3277, v10
 v_lshrrev_b32 v11, 16, v11
 v_mul_u32_u24 v30, 20, v11
 v_sub_u32 v30, v10, v30
 v_lshrrev_b32 v30, 2, v30
 v_lshlrev_b32 v11, 17, v11
 v_lshlrev_b32 v31, 4, v9
 v_add3_u32 v11, v11, v31, s48
 v_lshrrev_b32 v31, 2, v30
 v_lshl_add_u32 v11, v31, 10, v11
 v_bfe_u32 v31, v30, 1, 1
 v_lshl_add_u32 v11, v31, 9, v11
 v_and_b32 v31, 1, v30
 v_lshl_add_u32 v11, v31, 3, v11
 v_mul_f32 v32, v29, v12
 v_fma_f32 v32, v28, v64, -v32
 v_mul_f32 v33, v29, v13
 v_fma_f32 v33, v28, v65, -v33
 v_mul_f32 v34, v29, v14
 v_fma_f32 v34, v28, v66, -v34
 v_mul_f32 v35, v29, v15
 v_fma_f32 v35, v28, v67, -v35
 v_cvt_pk_bf16_f32 v36, v32, v33
 v_cvt_pk_bf16_f32 v37, v34, v35
 buffer_store_dwordx2 v[36:37], v11, s[20:23], 0 offen
 s_waitcnt vmcnt(3)
 v_add_u32 v10, 8, v8
 v_mul_u32_u24 v11, 3277, v10
 v_lshrrev_b32 v11, 16, v11
 v_mul_u32_u24 v30, 20, v11
 v_sub_u32 v30, v10, v30
 v_lshrrev_b32 v30, 2, v30
 v_lshlrev_b32 v11, 17, v11
 v_lshlrev_b32 v31, 4, v9
 v_add3_u32 v11, v11, v31, s48
 v_lshrrev_b32 v31, 2, v30
 v_lshl_add_u32 v11, v31, 10, v11
 v_bfe_u32 v31, v30, 1, 1
 v_lshl_add_u32 v11, v31, 9, v11
 v_and_b32 v31, 1, v30
 v_lshl_add_u32 v11, v31, 3, v11
 v_mul_f32 v32, v29, v16
 v_fma_f32 v32, v28, v68, -v32
 v_mul_f32 v33, v29, v17
 v_fma_f32 v33, v28, v69, -v33
 v_mul_f32 v34, v29, v18
 v_fma_f32 v34, v28, v70, -v34
 v_mul_f32 v35, v29, v19
 v_fma_f32 v35, v28, v71, -v35
 v_cvt_pk_bf16_f32 v36, v32, v33
 v_cvt_pk_bf16_f32 v37, v34, v35
 buffer_store_dwordx2 v[36:37], v11, s[20:23], 0 offen
 s_waitcnt vmcnt(3)
 v_add_u32 v10, 16, v8
 v_mul_u32_u24 v11, 3277, v10
 v_lshrrev_b32 v11, 16, v11
 v_mul_u32_u24 v30, 20, v11
 v_sub_u32 v30, v10, v30
 v_lshrrev_b32 v30, 2, v30
 v_lshlrev_b32 v11, 17, v11
 v_lshlrev_b32 v31, 4, v9
 v_add3_u32 v11, v11, v31, s48
 v_lshrrev_b32 v31, 2, v30
 v_lshl_add_u32 v11, v31, 10, v11
 v_bfe_u32 v31, v30, 1, 1
 v_lshl_add_u32 v11, v31, 9, v11
 v_and_b32 v31, 1, v30
 v_lshl_add_u32 v11, v31, 3, v11
 v_mul_f32 v32, v29, v20
 v_fma_f32 v32, v28, v72, -v32
 v_mul_f32 v33, v29, v21
 v_fma_f32 v33, v28, v73, -v33
 v_mul_f32 v34, v29, v22
 v_fma_f32 v34, v28, v74, -v34
 v_mul_f32 v35, v29, v23
 v_fma_f32 v35, v28, v75, -v35
 v_cvt_pk_bf16_f32 v36, v32, v33
 v_cvt_pk_bf16_f32 v37, v34, v35
 buffer_store_dwordx2 v[36:37], v11, s[20:23], 0 offen
 s_waitcnt vmcnt(3)
 v_add_u32 v10, 24, v8
 v_mul_u32_u24 v11, 3277, v10
 v_lshrrev_b32 v11, 16, v11
 v_mul_u32_u24 v30, 20, v11
 v_sub_u32 v30, v10, v30
 v_lshrrev_b32 v30, 2, v30
 v_lshlrev_b32 v11, 17, v11
 v_lshlrev_b32 v31, 4, v9
 v_add3_u32 v11, v11, v31, s48
 v_lshrrev_b32 v31, 2, v30
 v_lshl_add_u32 v11, v31, 10, v11
 v_bfe_u32 v31, v30, 1, 1
 v_lshl_add_u32 v11, v31, 9, v11
 v_and_b32 v31, 1, v30
 v_lshl_add_u32 v11, v31, 3, v11
 v_mul_f32 v32, v29, v24
 v_fma_f32 v32, v28, v76, -v32
 v_mul_f32 v33, v29, v25
 v_fma_f32 v33, v28, v77, -v33
 v_mul_f32 v34, v29, v26
 v_fma_f32 v34, v28, v78, -v34
 v_mul_f32 v35, v29, v27
 v_fma_f32 v35, v28, v79, -v35
 v_cvt_pk_bf16_f32 v36, v32, v33
 v_cvt_pk_bf16_f32 v37, v34, v35
 buffer_store_dwordx2 v[36:37], v11, s[20:23], 0 offen
 v_mul_f32 v28, s47, v182
 v_mul_f32 v29, s47, v184
 s_lshl_b32 s48, s32, 1
 s_add_u32 s48, s48, 1
 s_lshl_b32 s48, s48, 11
 v_add_u32 v10, 0, v8
 v_mul_u32_u24 v11, 3277, v10
 v_lshrrev_b32 v11, 16, v11
 v_mul_u32_u24 v30, 20, v11
 v_sub_u32 v30, v10, v30
 v_lshrrev_b32 v30, 2, v30
 v_lshlrev_b32 v11, 17, v11
 v_lshlrev_b32 v31, 4, v9
 v_add3_u32 v11, v11, v31, s48
 v_lshrrev_b32 v31, 2, v30
 v_lshl_add_u32 v11, v31, 10, v11
 v_bfe_u32 v31, v30, 1, 1
 v_lshl_add_u32 v11, v31, 9, v11
 v_and_b32 v31, 1, v30
 v_lshl_add_u32 v11, v31, 3, v11
 v_mul_f32 v32, v29, v12
 v_fma_f32 v32, v28, v80, -v32
 v_mul_f32 v33, v29, v13
 v_fma_f32 v33, v28, v81, -v33
 v_mul_f32 v34, v29, v14
 v_fma_f32 v34, v28, v82, -v34
 v_mul_f32 v35, v29, v15
 v_fma_f32 v35, v28, v83, -v35
 v_cvt_pk_bf16_f32 v36, v32, v33
 v_cvt_pk_bf16_f32 v37, v34, v35
 buffer_store_dwordx2 v[36:37], v11, s[20:23], 0 offen
 v_add_u32 v10, 8, v8
 v_mul_u32_u24 v11, 3277, v10
 v_lshrrev_b32 v11, 16, v11
 v_mul_u32_u24 v30, 20, v11
 v_sub_u32 v30, v10, v30
 v_lshrrev_b32 v30, 2, v30
 v_lshlrev_b32 v11, 17, v11
 v_lshlrev_b32 v31, 4, v9
 v_add3_u32 v11, v11, v31, s48
 v_lshrrev_b32 v31, 2, v30
 v_lshl_add_u32 v11, v31, 10, v11
 v_bfe_u32 v31, v30, 1, 1
 v_lshl_add_u32 v11, v31, 9, v11
 v_and_b32 v31, 1, v30
 v_lshl_add_u32 v11, v31, 3, v11
 v_mul_f32 v32, v29, v16
 v_fma_f32 v32, v28, v84, -v32
 v_mul_f32 v33, v29, v17
 v_fma_f32 v33, v28, v85, -v33
 v_mul_f32 v34, v29, v18
 v_fma_f32 v34, v28, v86, -v34
 v_mul_f32 v35, v29, v19
 v_fma_f32 v35, v28, v87, -v35
 v_cvt_pk_bf16_f32 v36, v32, v33
 v_cvt_pk_bf16_f32 v37, v34, v35
 buffer_store_dwordx2 v[36:37], v11, s[20:23], 0 offen
 v_add_u32 v10, 16, v8
 v_mul_u32_u24 v11, 3277, v10
 v_lshrrev_b32 v11, 16, v11
 v_mul_u32_u24 v30, 20, v11
 v_sub_u32 v30, v10, v30
 v_lshrrev_b32 v30, 2, v30
 v_lshlrev_b32 v11, 17, v11
 v_lshlrev_b32 v31, 4, v9
 v_add3_u32 v11, v11, v31, s48
 v_lshrrev_b32 v31, 2, v30
 v_lshl_add_u32 v11, v31, 10, v11
 v_bfe_u32 v31, v30, 1, 1
 v_lshl_add_u32 v11, v31, 9, v11
 v_and_b32 v31, 1, v30
 v_lshl_add_u32 v11, v31, 3, v11
 v_mul_f32 v32, v29, v20
 v_fma_f32 v32, v28, v88, -v32
 v_mul_f32 v33, v29, v21
 v_fma_f32 v33, v28, v89, -v33
 v_mul_f32 v34, v29, v22
 v_fma_f32 v34, v28, v90, -v34
 v_mul_f32 v35, v29, v23
 v_fma_f32 v35, v28, v91, -v35
 v_cvt_pk_bf16_f32 v36, v32, v33
 v_cvt_pk_bf16_f32 v37, v34, v35
 buffer_store_dwordx2 v[36:37], v11, s[20:23], 0 offen
 v_add_u32 v10, 24, v8
 v_mul_u32_u24 v11, 3277, v10
 v_lshrrev_b32 v11, 16, v11
 v_mul_u32_u24 v30, 20, v11
 v_sub_u32 v30, v10, v30
 v_lshrrev_b32 v30, 2, v30
 v_lshlrev_b32 v11, 17, v11
 v_lshlrev_b32 v31, 4, v9
 v_add3_u32 v11, v11, v31, s48
 v_lshrrev_b32 v31, 2, v30
 v_lshl_add_u32 v11, v31, 10, v11
 v_bfe_u32 v31, v30, 1, 1
 v_lshl_add_u32 v11, v31, 9, v11
 v_and_b32 v31, 1, v30
 v_lshl_add_u32 v11, v31, 3, v11
 v_mul_f32 v32, v29, v24
 v_fma_f32 v32, v28, v92, -v32
 v_mul_f32 v33, v29, v25
 v_fma_f32 v33, v28, v93, -v33
 v_mul_f32 v34, v29, v26
 v_fma_f32 v34, v28, v94, -v34
 v_mul_f32 v35, v29, v27
 v_fma_f32 v35, v28, v95, -v35
 v_cvt_pk_bf16_f32 v36, v32, v33
 v_cvt_pk_bf16_f32 v37, v34, v35
 buffer_store_dwordx2 v[36:37], v11, s[20:23], 0 offen
 s_branch L_a1_0_kernel_end
L_a1_0_kernel_ktype:
 s_mov_b32 s49, 20
 s_mov_b32 s52, 0
 v_bfe_u32 v8, v0, 5, 1
 v_lshlrev_b32 v8, 2, v8
 v_and_b32 v9, 31, v0
 v_add_u32 v8, s52, v8
 s_mov_b32 s47, 0x3f800000
 v_add_u32 v10, 640, v8
 v_lshlrev_b32 v11, 2, v10
 buffer_load_dwordx4 v[12:15], v11, s[16:19], 0 offen
 v_add_u32 v10, 648, v8
 v_lshlrev_b32 v11, 2, v10
 buffer_load_dwordx4 v[16:19], v11, s[16:19], 0 offen
 v_add_u32 v10, 656, v8
 v_lshlrev_b32 v11, 2, v10
 buffer_load_dwordx4 v[20:23], v11, s[16:19], 0 offen
 v_add_u32 v10, 664, v8
 v_lshlrev_b32 v11, 2, v10
 buffer_load_dwordx4 v[24:27], v11, s[16:19], 0 offen
 v_mul_f32 v28, s47, v181
 v_mul_f32 v29, s47, v183
 s_lshl_b32 s48, s32, 1
 s_add_u32 s48, s48, 0
 s_lshl_b32 s48, s48, 11
 s_waitcnt vmcnt(3)
 v_add_u32 v10, 0, v8
 v_mul_u32_u24 v11, 3277, v10
 v_lshrrev_b32 v11, 16, v11
 v_mul_u32_u24 v30, 20, v11
 v_sub_u32 v30, v10, v30
 v_lshrrev_b32 v30, 2, v30
 v_lshlrev_b32 v11, 17, v11
 v_lshlrev_b32 v31, 4, v9
 v_add3_u32 v11, v11, v31, s48
 v_lshrrev_b32 v31, 2, v30
 v_lshl_add_u32 v11, v31, 10, v11
 v_bfe_u32 v31, v30, 1, 1
 v_lshl_add_u32 v11, v31, 9, v11
 v_and_b32 v31, 1, v30
 v_lshl_add_u32 v11, v31, 3, v11
 v_mul_f32 v32, v29, v12
 v_fma_f32 v32, v28, v64, -v32
 v_mul_f32 v33, v29, v13
 v_fma_f32 v33, v28, v65, -v33
 v_mul_f32 v34, v29, v14
 v_fma_f32 v34, v28, v66, -v34
 v_mul_f32 v35, v29, v15
 v_fma_f32 v35, v28, v67, -v35
 v_cvt_pk_bf16_f32 v36, v32, v33
 v_cvt_pk_bf16_f32 v37, v34, v35
 v_cmp_gt_u32 vcc, 20, v10
 s_and_saveexec_b64 s[50:51], vcc
 buffer_store_dwordx2 v[36:37], v11, s[24:27], 0 offen
 s_mov_b64 exec, s[50:51]
 s_waitcnt vmcnt(3)
 v_add_u32 v10, 8, v8
 v_mul_u32_u24 v11, 3277, v10
 v_lshrrev_b32 v11, 16, v11
 v_mul_u32_u24 v30, 20, v11
 v_sub_u32 v30, v10, v30
 v_lshrrev_b32 v30, 2, v30
 v_lshlrev_b32 v11, 17, v11
 v_lshlrev_b32 v31, 4, v9
 v_add3_u32 v11, v11, v31, s48
 v_lshrrev_b32 v31, 2, v30
 v_lshl_add_u32 v11, v31, 10, v11
 v_bfe_u32 v31, v30, 1, 1
 v_lshl_add_u32 v11, v31, 9, v11
 v_and_b32 v31, 1, v30
 v_lshl_add_u32 v11, v31, 3, v11
 v_mul_f32 v32, v29, v16
 v_fma_f32 v32, v28, v68, -v32
 v_mul_f32 v33, v29, v17
 v_fma_f32 v33, v28, v69, -v33
 v_mul_f32 v34, v29, v18
 v_fma_f32 v34, v28, v70, -v34
 v_mul_f32 v35, v29, v19
 v_fma_f32 v35, v28, v71, -v35
 v_cvt_pk_bf16_f32 v36, v32, v33
 v_cvt_pk_bf16_f32 v37, v34, v35
 v_cmp_gt_u32 vcc, 20, v10
 s_and_saveexec_b64 s[50:51], vcc
 buffer_store_dwordx2 v[36:37], v11, s[24:27], 0 offen
 s_mov_b64 exec, s[50:51]
 s_waitcnt vmcnt(3)
 v_add_u32 v10, 16, v8
 v_mul_u32_u24 v11, 3277, v10
 v_lshrrev_b32 v11, 16, v11
 v_mul_u32_u24 v30, 20, v11
 v_sub_u32 v30, v10, v30
 v_lshrrev_b32 v30, 2, v30
 v_lshlrev_b32 v11, 17, v11
 v_lshlrev_b32 v31, 4, v9
 v_add3_u32 v11, v11, v31, s48
 v_lshrrev_b32 v31, 2, v30
 v_lshl_add_u32 v11, v31, 10, v11
 v_bfe_u32 v31, v30, 1, 1
 v_lshl_add_u32 v11, v31, 9, v11
 v_and_b32 v31, 1, v30
 v_lshl_add_u32 v11, v31, 3, v11
 v_mul_f32 v32, v29, v20
 v_fma_f32 v32, v28, v72, -v32
 v_mul_f32 v33, v29, v21
 v_fma_f32 v33, v28, v73, -v33
 v_mul_f32 v34, v29, v22
 v_fma_f32 v34, v28, v74, -v34
 v_mul_f32 v35, v29, v23
 v_fma_f32 v35, v28, v75, -v35
 v_cvt_pk_bf16_f32 v36, v32, v33
 v_cvt_pk_bf16_f32 v37, v34, v35
 v_cmp_gt_u32 vcc, 20, v10
 s_and_saveexec_b64 s[50:51], vcc
 buffer_store_dwordx2 v[36:37], v11, s[24:27], 0 offen
 s_mov_b64 exec, s[50:51]
 s_waitcnt vmcnt(3)
 v_add_u32 v10, 24, v8
 v_mul_u32_u24 v11, 3277, v10
 v_lshrrev_b32 v11, 16, v11
 v_mul_u32_u24 v30, 20, v11
 v_sub_u32 v30, v10, v30
 v_lshrrev_b32 v30, 2, v30
 v_lshlrev_b32 v11, 17, v11
 v_lshlrev_b32 v31, 4, v9
 v_add3_u32 v11, v11, v31, s48
 v_lshrrev_b32 v31, 2, v30
 v_lshl_add_u32 v11, v31, 10, v11
 v_bfe_u32 v31, v30, 1, 1
 v_lshl_add_u32 v11, v31, 9, v11
 v_and_b32 v31, 1, v30
 v_lshl_add_u32 v11, v31, 3, v11
 v_mul_f32 v32, v29, v24
 v_fma_f32 v32, v28, v76, -v32
 v_mul_f32 v33, v29, v25
 v_fma_f32 v33, v28, v77, -v33
 v_mul_f32 v34, v29, v26
 v_fma_f32 v34, v28, v78, -v34
 v_mul_f32 v35, v29, v27
 v_fma_f32 v35, v28, v79, -v35
 v_cvt_pk_bf16_f32 v36, v32, v33
 v_cvt_pk_bf16_f32 v37, v34, v35
 v_cmp_gt_u32 vcc, 20, v10
 s_and_saveexec_b64 s[50:51], vcc
 buffer_store_dwordx2 v[36:37], v11, s[24:27], 0 offen
 s_mov_b64 exec, s[50:51]
 v_mul_f32 v28, s47, v182
 v_mul_f32 v29, s47, v184
 s_lshl_b32 s48, s32, 1
 s_add_u32 s48, s48, 1
 s_lshl_b32 s48, s48, 11
 v_add_u32 v10, 0, v8
 v_mul_u32_u24 v11, 3277, v10
 v_lshrrev_b32 v11, 16, v11
 v_mul_u32_u24 v30, 20, v11
 v_sub_u32 v30, v10, v30
 v_lshrrev_b32 v30, 2, v30
 v_lshlrev_b32 v11, 17, v11
 v_lshlrev_b32 v31, 4, v9
 v_add3_u32 v11, v11, v31, s48
 v_lshrrev_b32 v31, 2, v30
 v_lshl_add_u32 v11, v31, 10, v11
 v_bfe_u32 v31, v30, 1, 1
 v_lshl_add_u32 v11, v31, 9, v11
 v_and_b32 v31, 1, v30
 v_lshl_add_u32 v11, v31, 3, v11
 v_mul_f32 v32, v29, v12
 v_fma_f32 v32, v28, v80, -v32
 v_mul_f32 v33, v29, v13
 v_fma_f32 v33, v28, v81, -v33
 v_mul_f32 v34, v29, v14
 v_fma_f32 v34, v28, v82, -v34
 v_mul_f32 v35, v29, v15
 v_fma_f32 v35, v28, v83, -v35
 v_cvt_pk_bf16_f32 v36, v32, v33
 v_cvt_pk_bf16_f32 v37, v34, v35
 v_cmp_gt_u32 vcc, 20, v10
 s_and_saveexec_b64 s[50:51], vcc
 buffer_store_dwordx2 v[36:37], v11, s[24:27], 0 offen
 s_mov_b64 exec, s[50:51]
 v_add_u32 v10, 8, v8
 v_mul_u32_u24 v11, 3277, v10
 v_lshrrev_b32 v11, 16, v11
 v_mul_u32_u24 v30, 20, v11
 v_sub_u32 v30, v10, v30
 v_lshrrev_b32 v30, 2, v30
 v_lshlrev_b32 v11, 17, v11
 v_lshlrev_b32 v31, 4, v9
 v_add3_u32 v11, v11, v31, s48
 v_lshrrev_b32 v31, 2, v30
 v_lshl_add_u32 v11, v31, 10, v11
 v_bfe_u32 v31, v30, 1, 1
 v_lshl_add_u32 v11, v31, 9, v11
 v_and_b32 v31, 1, v30
 v_lshl_add_u32 v11, v31, 3, v11
 v_mul_f32 v32, v29, v16
 v_fma_f32 v32, v28, v84, -v32
 v_mul_f32 v33, v29, v17
 v_fma_f32 v33, v28, v85, -v33
 v_mul_f32 v34, v29, v18
 v_fma_f32 v34, v28, v86, -v34
 v_mul_f32 v35, v29, v19
 v_fma_f32 v35, v28, v87, -v35
 v_cvt_pk_bf16_f32 v36, v32, v33
 v_cvt_pk_bf16_f32 v37, v34, v35
 v_cmp_gt_u32 vcc, 20, v10
 s_and_saveexec_b64 s[50:51], vcc
 buffer_store_dwordx2 v[36:37], v11, s[24:27], 0 offen
 s_mov_b64 exec, s[50:51]
 v_add_u32 v10, 16, v8
 v_mul_u32_u24 v11, 3277, v10
 v_lshrrev_b32 v11, 16, v11
 v_mul_u32_u24 v30, 20, v11
 v_sub_u32 v30, v10, v30
 v_lshrrev_b32 v30, 2, v30
 v_lshlrev_b32 v11, 17, v11
 v_lshlrev_b32 v31, 4, v9
 v_add3_u32 v11, v11, v31, s48
 v_lshrrev_b32 v31, 2, v30
 v_lshl_add_u32 v11, v31, 10, v11
 v_bfe_u32 v31, v30, 1, 1
 v_lshl_add_u32 v11, v31, 9, v11
 v_and_b32 v31, 1, v30
 v_lshl_add_u32 v11, v31, 3, v11
 v_mul_f32 v32, v29, v20
 v_fma_f32 v32, v28, v88, -v32
 v_mul_f32 v33, v29, v21
 v_fma_f32 v33, v28, v89, -v33
 v_mul_f32 v34, v29, v22
 v_fma_f32 v34, v28, v90, -v34
 v_mul_f32 v35, v29, v23
 v_fma_f32 v35, v28, v91, -v35
 v_cvt_pk_bf16_f32 v36, v32, v33
 v_cvt_pk_bf16_f32 v37, v34, v35
 v_cmp_gt_u32 vcc, 20, v10
 s_and_saveexec_b64 s[50:51], vcc
 buffer_store_dwordx2 v[36:37], v11, s[24:27], 0 offen
 s_mov_b64 exec, s[50:51]
 v_add_u32 v10, 24, v8
 v_mul_u32_u24 v11, 3277, v10
 v_lshrrev_b32 v11, 16, v11
 v_mul_u32_u24 v30, 20, v11
 v_sub_u32 v30, v10, v30
 v_lshrrev_b32 v30, 2, v30
 v_lshlrev_b32 v11, 17, v11
 v_lshlrev_b32 v31, 4, v9
 v_add3_u32 v11, v11, v31, s48
 v_lshrrev_b32 v31, 2, v30
 v_lshl_add_u32 v11, v31, 10, v11
 v_bfe_u32 v31, v30, 1, 1
 v_lshl_add_u32 v11, v31, 9, v11
 v_and_b32 v31, 1, v30
 v_lshl_add_u32 v11, v31, 3, v11
 v_mul_f32 v32, v29, v24
 v_fma_f32 v32, v28, v92, -v32
 v_mul_f32 v33, v29, v25
 v_fma_f32 v33, v28, v93, -v33
 v_mul_f32 v34, v29, v26
 v_fma_f32 v34, v28, v94, -v34
 v_mul_f32 v35, v29, v27
 v_fma_f32 v35, v28, v95, -v35
 v_cvt_pk_bf16_f32 v36, v32, v33
 v_cvt_pk_bf16_f32 v37, v34, v35
 v_cmp_gt_u32 vcc, 20, v10
 s_and_saveexec_b64 s[50:51], vcc
 buffer_store_dwordx2 v[36:37], v11, s[24:27], 0 offen
 s_mov_b64 exec, s[50:51]
 s_branch L_a1_0_kernel_end
L_a1_0_kernel_vtype:
 buffer_load_dwordx4 v[128:131], v4, s[12:15], s42 offen
 s_add_u32 s42, s42, 1024
 buffer_load_dwordx4 v[132:135], v4, s[12:15], s42 offen
 s_add_u32 s42, s42, 1024
 buffer_load_dwordx4 v[136:139], v4, s[12:15], s42 offen
 s_add_u32 s42, s42, 1024
 buffer_load_dwordx4 v[140:143], v4, s[12:15], s42 offen
 s_add_u32 s42, s42, 1024
 ds_read_b128 v[160:163], v5 offset:0
 ds_read_b128 v[164:167], v7 offset:0
 ds_read_b128 v[168:171], v5 offset:32
 ds_read_b128 v[172:175], v7 offset:32
 s_waitcnt vmcnt(3) lgkmcnt(2)
 v_mfma_f32_32x32x16_bf16 v[64:79], v[160:163], v[128:131], v[64:79]
 v_mfma_f32_32x32x16_bf16 v[80:95], v[164:167], v[128:131], v[80:95]
 v_dot2c_f32_bf16 v176, v160, v180
 v_dot2c_f32_bf16 v178, v160, v160
 v_dot2c_f32_bf16 v176, v161, v180
 v_dot2c_f32_bf16 v178, v161, v161
 v_dot2c_f32_bf16 v176, v162, v180
 v_dot2c_f32_bf16 v178, v162, v162
 v_dot2c_f32_bf16 v176, v163, v180
 v_dot2c_f32_bf16 v178, v163, v163
 v_dot2c_f32_bf16 v177, v164, v180
 v_dot2c_f32_bf16 v179, v164, v164
 v_dot2c_f32_bf16 v177, v165, v180
 v_dot2c_f32_bf16 v179, v165, v165
 v_dot2c_f32_bf16 v177, v166, v180
 v_dot2c_f32_bf16 v179, v166, v166
 v_dot2c_f32_bf16 v177, v167, v180
 v_dot2c_f32_bf16 v179, v167, v167
 buffer_load_dwordx4 v[128:131], v4, s[12:15], s42 offen
 s_add_u32 s42, s42, 1024
 ds_read_b128 v[160:163], v5 offset:64
 ds_read_b128 v[164:167], v7 offset:64
 s_waitcnt vmcnt(3) lgkmcnt(2)
 v_mfma_f32_32x32x16_bf16 v[64:79], v[168:171], v[132:135], v[64:79]
 v_mfma_f32_32x32x16_bf16 v[80:95], v[172:175], v[132:135], v[80:95]
 v_dot2c_f32_bf16 v176, v168, v180
 v_dot2c_f32_bf16 v178, v168, v168
 v_dot2c_f32_bf16 v176, v169, v180
 v_dot2c_f32_bf16 v178, v169, v169
 v_dot2c_f32_bf16 v176, v170, v180
 v_dot2c_f32_bf16 v178, v170, v170
 v_dot2c_f32_bf16 v176, v171, v180
 v_dot2c_f32_bf16 v178, v171, v171
 v_dot2c_f32_bf16 v177, v172, v180
 v_dot2c_f32_bf16 v179, v172, v172
 v_dot2c_f32_bf16 v177, v173, v180
 v_dot2c_f32_bf16 v179, v173, v173
 v_dot2c_f32_bf16 v177, v174, v180
 v_dot2c_f32_bf16 v179, v174, v174
 v_dot2c_f32_bf16 v177, v175, v180
 v_dot2c_f32_bf16 v179, v175, v175
 buffer_load_dwordx4 v[132:135], v4, s[12:15], s42 offen
 s_add_u32 s42, s42, 1024
 ds_read_b128 v[168:171], v5 offset:96
 ds_read_b128 v[172:175], v7 offset:96
 s_waitcnt vmcnt(3) lgkmcnt(2)
 v_mfma_f32_32x32x16_bf16 v[64:79], v[160:163], v[136:139], v[64:79]
 v_mfma_f32_32x32x16_bf16 v[80:95], v[164:167], v[136:139], v[80:95]
 v_dot2c_f32_bf16 v176, v160, v180
 v_dot2c_f32_bf16 v178, v160, v160
 v_dot2c_f32_bf16 v176, v161, v180
 v_dot2c_f32_bf16 v178, v161, v161
 v_dot2c_f32_bf16 v176, v162, v180
 v_dot2c_f32_bf16 v178, v162, v162
 v_dot2c_f32_bf16 v176, v163, v180
 v_dot2c_f32_bf16 v178, v163, v163
 v_dot2c_f32_bf16 v177, v164, v180
 v_dot2c_f32_bf16 v179, v164, v164
 v_dot2c_f32_bf16 v177, v165, v180
 v_dot2c_f32_bf16 v179, v165, v165
 v_dot2c_f32_bf16 v177, v166, v180
 v_dot2c_f32_bf16 v179, v166, v166
 v_dot2c_f32_bf16 v177, v167, v180
 v_dot2c_f32_bf16 v179, v167, v167
 buffer_load_dwordx4 v[136:139], v4, s[12:15], s42 offen
 s_add_u32 s42, s42, 1024
 ds_read_b128 v[160:163], v5 offset:128
 ds_read_b128 v[164:167], v7 offset:128
 s_waitcnt vmcnt(3) lgkmcnt(2)
 v_mfma_f32_32x32x16_bf16 v[64:79], v[168:171], v[140:143], v[64:79]
 v_mfma_f32_32x32x16_bf16 v[80:95], v[172:175], v[140:143], v[80:95]
 v_dot2c_f32_bf16 v176, v168, v180
 v_dot2c_f32_bf16 v178, v168, v168
 v_dot2c_f32_bf16 v176, v169, v180
 v_dot2c_f32_bf16 v178, v169, v169
 v_dot2c_f32_bf16 v176, v170, v180
 v_dot2c_f32_bf16 v178, v170, v170
 v_dot2c_f32_bf16 v176, v171, v180
 v_dot2c_f32_bf16 v178, v171, v171
 v_dot2c_f32_bf16 v177, v172, v180
 v_dot2c_f32_bf16 v179, v172, v172
 v_dot2c_f32_bf16 v177, v173, v180
 v_dot2c_f32_bf16 v179, v173, v173
 v_dot2c_f32_bf16 v177, v174, v180
 v_dot2c_f32_bf16 v179, v174, v174
 v_dot2c_f32_bf16 v177, v175, v180
 v_dot2c_f32_bf16 v179, v175, v175
 buffer_load_dwordx4 v[140:143], v4, s[12:15], s42 offen
 s_add_u32 s42, s42, 1024
 ds_read_b128 v[168:171], v5 offset:160
 ds_read_b128 v[172:175], v7 offset:160
 s_waitcnt vmcnt(3) lgkmcnt(2)
 v_mfma_f32_32x32x16_bf16 v[64:79], v[160:163], v[128:131], v[64:79]
 v_mfma_f32_32x32x16_bf16 v[80:95], v[164:167], v[128:131], v[80:95]
 v_dot2c_f32_bf16 v176, v160, v180
 v_dot2c_f32_bf16 v178, v160, v160
 v_dot2c_f32_bf16 v176, v161, v180
 v_dot2c_f32_bf16 v178, v161, v161
 v_dot2c_f32_bf16 v176, v162, v180
 v_dot2c_f32_bf16 v178, v162, v162
 v_dot2c_f32_bf16 v176, v163, v180
 v_dot2c_f32_bf16 v178, v163, v163
 v_dot2c_f32_bf16 v177, v164, v180
 v_dot2c_f32_bf16 v179, v164, v164
 v_dot2c_f32_bf16 v177, v165, v180
 v_dot2c_f32_bf16 v179, v165, v165
 v_dot2c_f32_bf16 v177, v166, v180
 v_dot2c_f32_bf16 v179, v166, v166
 v_dot2c_f32_bf16 v177, v167, v180
 v_dot2c_f32_bf16 v179, v167, v167
 buffer_load_dwordx4 v[128:131], v4, s[12:15], s42 offen
 s_add_u32 s42, s42, 1024
 ds_read_b128 v[160:163], v5 offset:192
 ds_read_b128 v[164:167], v7 offset:192
 s_waitcnt vmcnt(3) lgkmcnt(2)
 v_mfma_f32_32x32x16_bf16 v[64:79], v[168:171], v[132:135], v[64:79]
 v_mfma_f32_32x32x16_bf16 v[80:95], v[172:175], v[132:135], v[80:95]
 v_dot2c_f32_bf16 v176, v168, v180
 v_dot2c_f32_bf16 v178, v168, v168
 v_dot2c_f32_bf16 v176, v169, v180
 v_dot2c_f32_bf16 v178, v169, v169
 v_dot2c_f32_bf16 v176, v170, v180
 v_dot2c_f32_bf16 v178, v170, v170
 v_dot2c_f32_bf16 v176, v171, v180
 v_dot2c_f32_bf16 v178, v171, v171
 v_dot2c_f32_bf16 v177, v172, v180
 v_dot2c_f32_bf16 v179, v172, v172
 v_dot2c_f32_bf16 v177, v173, v180
 v_dot2c_f32_bf16 v179, v173, v173
 v_dot2c_f32_bf16 v177, v174, v180
 v_dot2c_f32_bf16 v179, v174, v174
 v_dot2c_f32_bf16 v177, v175, v180
 v_dot2c_f32_bf16 v179, v175, v175
 buffer_load_dwordx4 v[132:135], v4, s[12:15], s42 offen
 s_add_u32 s42, s42, 1024
 ds_read_b128 v[168:171], v5 offset:224
 ds_read_b128 v[172:175], v7 offset:224
 s_waitcnt vmcnt(3) lgkmcnt(2)
 v_mfma_f32_32x32x16_bf16 v[64:79], v[160:163], v[136:139], v[64:79]
 v_mfma_f32_32x32x16_bf16 v[80:95], v[164:167], v[136:139], v[80:95]
 v_dot2c_f32_bf16 v176, v160, v180
 v_dot2c_f32_bf16 v178, v160, v160
 v_dot2c_f32_bf16 v176, v161, v180
 v_dot2c_f32_bf16 v178, v161, v161
 v_dot2c_f32_bf16 v176, v162, v180
 v_dot2c_f32_bf16 v178, v162, v162
 v_dot2c_f32_bf16 v176, v163, v180
 v_dot2c_f32_bf16 v178, v163, v163
 v_dot2c_f32_bf16 v177, v164, v180
 v_dot2c_f32_bf16 v179, v164, v164
 v_dot2c_f32_bf16 v177, v165, v180
 v_dot2c_f32_bf16 v179, v165, v165
 v_dot2c_f32_bf16 v177, v166, v180
 v_dot2c_f32_bf16 v179, v166, v166
 v_dot2c_f32_bf16 v177, v167, v180
 v_dot2c_f32_bf16 v179, v167, v167
 buffer_load_dwordx4 v[136:139], v4, s[12:15], s42 offen
 s_add_u32 s42, s42, 1024
 ds_read_b128 v[160:163], v5 offset:256
 ds_read_b128 v[164:167], v7 offset:256
 s_waitcnt vmcnt(3) lgkmcnt(2)
 v_mfma_f32_32x32x16_bf16 v[64:79], v[168:171], v[140:143], v[64:79]
 v_mfma_f32_32x32x16_bf16 v[80:95], v[172:175], v[140:143], v[80:95]
 v_dot2c_f32_bf16 v176, v168, v180
 v_dot2c_f32_bf16 v178, v168, v168
 v_dot2c_f32_bf16 v176, v169, v180
 v_dot2c_f32_bf16 v178, v169, v169
 v_dot2c_f32_bf16 v176, v170, v180
 v_dot2c_f32_bf16 v178, v170, v170
 v_dot2c_f32_bf16 v176, v171, v180
 v_dot2c_f32_bf16 v178, v171, v171
 v_dot2c_f32_bf16 v177, v172, v180
 v_dot2c_f32_bf16 v179, v172, v172
 v_dot2c_f32_bf16 v177, v173, v180
 v_dot2c_f32_bf16 v179, v173, v173
 v_dot2c_f32_bf16 v177, v174, v180
 v_dot2c_f32_bf16 v179, v174, v174
 v_dot2c_f32_bf16 v177, v175, v180
 v_dot2c_f32_bf16 v179, v175, v175
 buffer_load_dwordx4 v[140:143], v4, s[12:15], s42 offen
 s_add_u32 s42, s42, 1024
 ds_read_b128 v[168:171], v5 offset:288
 ds_read_b128 v[172:175], v7 offset:288
 s_waitcnt vmcnt(3) lgkmcnt(2)
 v_mfma_f32_32x32x16_bf16 v[64:79], v[160:163], v[128:131], v[64:79]
 v_mfma_f32_32x32x16_bf16 v[80:95], v[164:167], v[128:131], v[80:95]
 v_dot2c_f32_bf16 v176, v160, v180
 v_dot2c_f32_bf16 v178, v160, v160
 v_dot2c_f32_bf16 v176, v161, v180
 v_dot2c_f32_bf16 v178, v161, v161
 v_dot2c_f32_bf16 v176, v162, v180
 v_dot2c_f32_bf16 v178, v162, v162
 v_dot2c_f32_bf16 v176, v163, v180
 v_dot2c_f32_bf16 v178, v163, v163
 v_dot2c_f32_bf16 v177, v164, v180
 v_dot2c_f32_bf16 v179, v164, v164
 v_dot2c_f32_bf16 v177, v165, v180
 v_dot2c_f32_bf16 v179, v165, v165
 v_dot2c_f32_bf16 v177, v166, v180
 v_dot2c_f32_bf16 v179, v166, v166
 v_dot2c_f32_bf16 v177, v167, v180
 v_dot2c_f32_bf16 v179, v167, v167
 buffer_load_dwordx4 v[128:131], v4, s[12:15], s42 offen
 s_add_u32 s42, s42, 1024
 ds_read_b128 v[160:163], v5 offset:320
 ds_read_b128 v[164:167], v7 offset:320
 s_waitcnt vmcnt(3) lgkmcnt(2)
 v_mfma_f32_32x32x16_bf16 v[64:79], v[168:171], v[132:135], v[64:79]
 v_mfma_f32_32x32x16_bf16 v[80:95], v[172:175], v[132:135], v[80:95]
 v_dot2c_f32_bf16 v176, v168, v180
 v_dot2c_f32_bf16 v178, v168, v168
 v_dot2c_f32_bf16 v176, v169, v180
 v_dot2c_f32_bf16 v178, v169, v169
 v_dot2c_f32_bf16 v176, v170, v180
 v_dot2c_f32_bf16 v178, v170, v170
 v_dot2c_f32_bf16 v176, v171, v180
 v_dot2c_f32_bf16 v178, v171, v171
 v_dot2c_f32_bf16 v177, v172, v180
 v_dot2c_f32_bf16 v179, v172, v172
 v_dot2c_f32_bf16 v177, v173, v180
 v_dot2c_f32_bf16 v179, v173, v173
 v_dot2c_f32_bf16 v177, v174, v180
 v_dot2c_f32_bf16 v179, v174, v174
 v_dot2c_f32_bf16 v177, v175, v180
 v_dot2c_f32_bf16 v179, v175, v175
 buffer_load_dwordx4 v[132:135], v4, s[12:15], s42 offen
 s_add_u32 s42, s42, 1024
 ds_read_b128 v[168:171], v5 offset:352
 ds_read_b128 v[172:175], v7 offset:352
 s_waitcnt vmcnt(3) lgkmcnt(2)
 v_mfma_f32_32x32x16_bf16 v[64:79], v[160:163], v[136:139], v[64:79]
 v_mfma_f32_32x32x16_bf16 v[80:95], v[164:167], v[136:139], v[80:95]
 v_dot2c_f32_bf16 v176, v160, v180
 v_dot2c_f32_bf16 v178, v160, v160
 v_dot2c_f32_bf16 v176, v161, v180
 v_dot2c_f32_bf16 v178, v161, v161
 v_dot2c_f32_bf16 v176, v162, v180
 v_dot2c_f32_bf16 v178, v162, v162
 v_dot2c_f32_bf16 v176, v163, v180
 v_dot2c_f32_bf16 v178, v163, v163
 v_dot2c_f32_bf16 v177, v164, v180
 v_dot2c_f32_bf16 v179, v164, v164
 v_dot2c_f32_bf16 v177, v165, v180
 v_dot2c_f32_bf16 v179, v165, v165
 v_dot2c_f32_bf16 v177, v166, v180
 v_dot2c_f32_bf16 v179, v166, v166
 v_dot2c_f32_bf16 v177, v167, v180
 v_dot2c_f32_bf16 v179, v167, v167
 buffer_load_dwordx4 v[136:139], v4, s[12:15], s42 offen
 s_add_u32 s42, s42, 1024
 ds_read_b128 v[160:163], v5 offset:384
 ds_read_b128 v[164:167], v7 offset:384
 s_waitcnt vmcnt(3) lgkmcnt(2)
 v_mfma_f32_32x32x16_bf16 v[64:79], v[168:171], v[140:143], v[64:79]
 v_mfma_f32_32x32x16_bf16 v[80:95], v[172:175], v[140:143], v[80:95]
 v_dot2c_f32_bf16 v176, v168, v180
 v_dot2c_f32_bf16 v178, v168, v168
 v_dot2c_f32_bf16 v176, v169, v180
 v_dot2c_f32_bf16 v178, v169, v169
 v_dot2c_f32_bf16 v176, v170, v180
 v_dot2c_f32_bf16 v178, v170, v170
 v_dot2c_f32_bf16 v176, v171, v180
 v_dot2c_f32_bf16 v178, v171, v171
 v_dot2c_f32_bf16 v177, v172, v180
 v_dot2c_f32_bf16 v179, v172, v172
 v_dot2c_f32_bf16 v177, v173, v180
 v_dot2c_f32_bf16 v179, v173, v173
 v_dot2c_f32_bf16 v177, v174, v180
 v_dot2c_f32_bf16 v179, v174, v174
 v_dot2c_f32_bf16 v177, v175, v180
 v_dot2c_f32_bf16 v179, v175, v175
 buffer_load_dwordx4 v[140:143], v4, s[12:15], s42 offen
 s_add_u32 s42, s42, 1024
 ds_read_b128 v[168:171], v5 offset:416
 ds_read_b128 v[172:175], v7 offset:416
 s_waitcnt vmcnt(3) lgkmcnt(2)
 v_mfma_f32_32x32x16_bf16 v[64:79], v[160:163], v[128:131], v[64:79]
 v_mfma_f32_32x32x16_bf16 v[80:95], v[164:167], v[128:131], v[80:95]
 v_dot2c_f32_bf16 v176, v160, v180
 v_dot2c_f32_bf16 v178, v160, v160
 v_dot2c_f32_bf16 v176, v161, v180
 v_dot2c_f32_bf16 v178, v161, v161
 v_dot2c_f32_bf16 v176, v162, v180
 v_dot2c_f32_bf16 v178, v162, v162
 v_dot2c_f32_bf16 v176, v163, v180
 v_dot2c_f32_bf16 v178, v163, v163
 v_dot2c_f32_bf16 v177, v164, v180
 v_dot2c_f32_bf16 v179, v164, v164
 v_dot2c_f32_bf16 v177, v165, v180
 v_dot2c_f32_bf16 v179, v165, v165
 v_dot2c_f32_bf16 v177, v166, v180
 v_dot2c_f32_bf16 v179, v166, v166
 v_dot2c_f32_bf16 v177, v167, v180
 v_dot2c_f32_bf16 v179, v167, v167
 buffer_load_dwordx4 v[128:131], v4, s[12:15], s42 offen
 s_add_u32 s42, s42, 1024
 ds_read_b128 v[160:163], v5 offset:448
 ds_read_b128 v[164:167], v7 offset:448
 s_waitcnt vmcnt(3) lgkmcnt(2)
 v_mfma_f32_32x32x16_bf16 v[64:79], v[168:171], v[132:135], v[64:79]
 v_mfma_f32_32x32x16_bf16 v[80:95], v[172:175], v[132:135], v[80:95]
 v_dot2c_f32_bf16 v176, v168, v180
 v_dot2c_f32_bf16 v178, v168, v168
 v_dot2c_f32_bf16 v176, v169, v180
 v_dot2c_f32_bf16 v178, v169, v169
 v_dot2c_f32_bf16 v176, v170, v180
 v_dot2c_f32_bf16 v178, v170, v170
 v_dot2c_f32_bf16 v176, v171, v180
 v_dot2c_f32_bf16 v178, v171, v171
 v_dot2c_f32_bf16 v177, v172, v180
 v_dot2c_f32_bf16 v179, v172, v172
 v_dot2c_f32_bf16 v177, v173, v180
 v_dot2c_f32_bf16 v179, v173, v173
 v_dot2c_f32_bf16 v177, v174, v180
 v_dot2c_f32_bf16 v179, v174, v174
 v_dot2c_f32_bf16 v177, v175, v180
 v_dot2c_f32_bf16 v179, v175, v175
 buffer_load_dwordx4 v[132:135], v4, s[12:15], s42 offen
 s_add_u32 s42, s42, 1024
 ds_read_b128 v[168:171], v5 offset:480
 ds_read_b128 v[172:175], v7 offset:480
 s_waitcnt vmcnt(3) lgkmcnt(2)
 v_mfma_f32_32x32x16_bf16 v[64:79], v[160:163], v[136:139], v[64:79]
 v_mfma_f32_32x32x16_bf16 v[80:95], v[164:167], v[136:139], v[80:95]
 v_dot2c_f32_bf16 v176, v160, v180
 v_dot2c_f32_bf16 v178, v160, v160
 v_dot2c_f32_bf16 v176, v161, v180
 v_dot2c_f32_bf16 v178, v161, v161
 v_dot2c_f32_bf16 v176, v162, v180
 v_dot2c_f32_bf16 v178, v162, v162
 v_dot2c_f32_bf16 v176, v163, v180
 v_dot2c_f32_bf16 v178, v163, v163
 v_dot2c_f32_bf16 v177, v164, v180
 v_dot2c_f32_bf16 v179, v164, v164
 v_dot2c_f32_bf16 v177, v165, v180
 v_dot2c_f32_bf16 v179, v165, v165
 v_dot2c_f32_bf16 v177, v166, v180
 v_dot2c_f32_bf16 v179, v166, v166
 v_dot2c_f32_bf16 v177, v167, v180
 v_dot2c_f32_bf16 v179, v167, v167
 buffer_load_dwordx4 v[136:139], v4, s[12:15], s42 offen
 s_add_u32 s42, s42, 1024
 ds_read_b128 v[160:163], v5 offset:512
 ds_read_b128 v[164:167], v7 offset:512
 s_waitcnt vmcnt(3) lgkmcnt(2)
 v_mfma_f32_32x32x16_bf16 v[64:79], v[168:171], v[140:143], v[64:79]
 v_mfma_f32_32x32x16_bf16 v[80:95], v[172:175], v[140:143], v[80:95]
 v_dot2c_f32_bf16 v176, v168, v180
 v_dot2c_f32_bf16 v178, v168, v168
 v_dot2c_f32_bf16 v176, v169, v180
 v_dot2c_f32_bf16 v178, v169, v169
 v_dot2c_f32_bf16 v176, v170, v180
 v_dot2c_f32_bf16 v178, v170, v170
 v_dot2c_f32_bf16 v176, v171, v180
 v_dot2c_f32_bf16 v178, v171, v171
 v_dot2c_f32_bf16 v177, v172, v180
 v_dot2c_f32_bf16 v179, v172, v172
 v_dot2c_f32_bf16 v177, v173, v180
 v_dot2c_f32_bf16 v179, v173, v173
 v_dot2c_f32_bf16 v177, v174, v180
 v_dot2c_f32_bf16 v179, v174, v174
 v_dot2c_f32_bf16 v177, v175, v180
 v_dot2c_f32_bf16 v179, v175, v175
 buffer_load_dwordx4 v[140:143], v4, s[12:15], s42 offen
 s_add_u32 s42, s42, 1024
 ds_read_b128 v[168:171], v5 offset:544
 ds_read_b128 v[172:175], v7 offset:544
 s_waitcnt vmcnt(3) lgkmcnt(2)
 v_mfma_f32_32x32x16_bf16 v[64:79], v[160:163], v[128:131], v[64:79]
 v_mfma_f32_32x32x16_bf16 v[80:95], v[164:167], v[128:131], v[80:95]
 v_dot2c_f32_bf16 v176, v160, v180
 v_dot2c_f32_bf16 v178, v160, v160
 v_dot2c_f32_bf16 v176, v161, v180
 v_dot2c_f32_bf16 v178, v161, v161
 v_dot2c_f32_bf16 v176, v162, v180
 v_dot2c_f32_bf16 v178, v162, v162
 v_dot2c_f32_bf16 v176, v163, v180
 v_dot2c_f32_bf16 v178, v163, v163
 v_dot2c_f32_bf16 v177, v164, v180
 v_dot2c_f32_bf16 v179, v164, v164
 v_dot2c_f32_bf16 v177, v165, v180
 v_dot2c_f32_bf16 v179, v165, v165
 v_dot2c_f32_bf16 v177, v166, v180
 v_dot2c_f32_bf16 v179, v166, v166
 v_dot2c_f32_bf16 v177, v167, v180
 v_dot2c_f32_bf16 v179, v167, v167
 buffer_load_dwordx4 v[128:131], v4, s[12:15], s42 offen
 s_add_u32 s42, s42, 1024
 ds_read_b128 v[160:163], v5 offset:576
 ds_read_b128 v[164:167], v7 offset:576
 s_waitcnt vmcnt(3) lgkmcnt(2)
 v_mfma_f32_32x32x16_bf16 v[64:79], v[168:171], v[132:135], v[64:79]
 v_mfma_f32_32x32x16_bf16 v[80:95], v[172:175], v[132:135], v[80:95]
 v_dot2c_f32_bf16 v176, v168, v180
 v_dot2c_f32_bf16 v178, v168, v168
 v_dot2c_f32_bf16 v176, v169, v180
 v_dot2c_f32_bf16 v178, v169, v169
 v_dot2c_f32_bf16 v176, v170, v180
 v_dot2c_f32_bf16 v178, v170, v170
 v_dot2c_f32_bf16 v176, v171, v180
 v_dot2c_f32_bf16 v178, v171, v171
 v_dot2c_f32_bf16 v177, v172, v180
 v_dot2c_f32_bf16 v179, v172, v172
 v_dot2c_f32_bf16 v177, v173, v180
 v_dot2c_f32_bf16 v179, v173, v173
 v_dot2c_f32_bf16 v177, v174, v180
 v_dot2c_f32_bf16 v179, v174, v174
 v_dot2c_f32_bf16 v177, v175, v180
 v_dot2c_f32_bf16 v179, v175, v175
 buffer_load_dwordx4 v[132:135], v4, s[12:15], s42 offen
 s_add_u32 s42, s42, 1024
 ds_read_b128 v[168:171], v5 offset:608
 ds_read_b128 v[172:175], v7 offset:608
 s_waitcnt vmcnt(3) lgkmcnt(2)
 v_mfma_f32_32x32x16_bf16 v[64:79], v[160:163], v[136:139], v[64:79]
 v_mfma_f32_32x32x16_bf16 v[80:95], v[164:167], v[136:139], v[80:95]
 v_dot2c_f32_bf16 v176, v160, v180
 v_dot2c_f32_bf16 v178, v160, v160
 v_dot2c_f32_bf16 v176, v161, v180
 v_dot2c_f32_bf16 v178, v161, v161
 v_dot2c_f32_bf16 v176, v162, v180
 v_dot2c_f32_bf16 v178, v162, v162
 v_dot2c_f32_bf16 v176, v163, v180
 v_dot2c_f32_bf16 v178, v163, v163
 v_dot2c_f32_bf16 v177, v164, v180
 v_dot2c_f32_bf16 v179, v164, v164
 v_dot2c_f32_bf16 v177, v165, v180
 v_dot2c_f32_bf16 v179, v165, v165
 v_dot2c_f32_bf16 v177, v166, v180
 v_dot2c_f32_bf16 v179, v166, v166
 v_dot2c_f32_bf16 v177, v167, v180
 v_dot2c_f32_bf16 v179, v167, v167
 buffer_load_dwordx4 v[136:139], v4, s[12:15], s42 offen
 s_add_u32 s42, s42, 1024
 ds_read_b128 v[160:163], v5 offset:640
 ds_read_b128 v[164:167], v7 offset:640
 s_waitcnt vmcnt(3) lgkmcnt(2)
 v_mfma_f32_32x32x16_bf16 v[64:79], v[168:171], v[140:143], v[64:79]
 v_mfma_f32_32x32x16_bf16 v[80:95], v[172:175], v[140:143], v[80:95]
 v_dot2c_f32_bf16 v176, v168, v180
 v_dot2c_f32_bf16 v178, v168, v168
 v_dot2c_f32_bf16 v176, v169, v180
 v_dot2c_f32_bf16 v178, v169, v169
 v_dot2c_f32_bf16 v176, v170, v180
 v_dot2c_f32_bf16 v178, v170, v170
 v_dot2c_f32_bf16 v176, v171, v180
 v_dot2c_f32_bf16 v178, v171, v171
 v_dot2c_f32_bf16 v177, v172, v180
 v_dot2c_f32_bf16 v179, v172, v172
 v_dot2c_f32_bf16 v177, v173, v180
 v_dot2c_f32_bf16 v179, v173, v173
 v_dot2c_f32_bf16 v177, v174, v180
 v_dot2c_f32_bf16 v179, v174, v174
 v_dot2c_f32_bf16 v177, v175, v180
 v_dot2c_f32_bf16 v179, v175, v175
 buffer_load_dwordx4 v[140:143], v4, s[12:15], s42 offen
 s_add_u32 s42, s42, 1024
 ds_read_b128 v[168:171], v5 offset:672
 ds_read_b128 v[172:175], v7 offset:672
 s_waitcnt vmcnt(3) lgkmcnt(2)
 v_mfma_f32_32x32x16_bf16 v[64:79], v[160:163], v[128:131], v[64:79]
 v_mfma_f32_32x32x16_bf16 v[80:95], v[164:167], v[128:131], v[80:95]
 v_dot2c_f32_bf16 v176, v160, v180
 v_dot2c_f32_bf16 v178, v160, v160
 v_dot2c_f32_bf16 v176, v161, v180
 v_dot2c_f32_bf16 v178, v161, v161
 v_dot2c_f32_bf16 v176, v162, v180
 v_dot2c_f32_bf16 v178, v162, v162
 v_dot2c_f32_bf16 v176, v163, v180
 v_dot2c_f32_bf16 v178, v163, v163
 v_dot2c_f32_bf16 v177, v164, v180
 v_dot2c_f32_bf16 v179, v164, v164
 v_dot2c_f32_bf16 v177, v165, v180
 v_dot2c_f32_bf16 v179, v165, v165
 v_dot2c_f32_bf16 v177, v166, v180
 v_dot2c_f32_bf16 v179, v166, v166
 v_dot2c_f32_bf16 v177, v167, v180
 v_dot2c_f32_bf16 v179, v167, v167
 buffer_load_dwordx4 v[128:131], v4, s[12:15], s42 offen
 s_add_u32 s42, s42, 1024
 ds_read_b128 v[160:163], v5 offset:704
 ds_read_b128 v[164:167], v7 offset:704
 s_waitcnt vmcnt(3) lgkmcnt(2)
 v_mfma_f32_32x32x16_bf16 v[64:79], v[168:171], v[132:135], v[64:79]
 v_mfma_f32_32x32x16_bf16 v[80:95], v[172:175], v[132:135], v[80:95]
 v_dot2c_f32_bf16 v176, v168, v180
 v_dot2c_f32_bf16 v178, v168, v168
 v_dot2c_f32_bf16 v176, v169, v180
 v_dot2c_f32_bf16 v178, v169, v169
 v_dot2c_f32_bf16 v176, v170, v180
 v_dot2c_f32_bf16 v178, v170, v170
 v_dot2c_f32_bf16 v176, v171, v180
 v_dot2c_f32_bf16 v178, v171, v171
 v_dot2c_f32_bf16 v177, v172, v180
 v_dot2c_f32_bf16 v179, v172, v172
 v_dot2c_f32_bf16 v177, v173, v180
 v_dot2c_f32_bf16 v179, v173, v173
 v_dot2c_f32_bf16 v177, v174, v180
 v_dot2c_f32_bf16 v179, v174, v174
 v_dot2c_f32_bf16 v177, v175, v180
 v_dot2c_f32_bf16 v179, v175, v175
 buffer_load_dwordx4 v[132:135], v4, s[12:15], s42 offen
 s_add_u32 s42, s42, 1024
 ds_read_b128 v[168:171], v5 offset:736
 ds_read_b128 v[172:175], v7 offset:736
 s_waitcnt vmcnt(3) lgkmcnt(2)
 v_mfma_f32_32x32x16_bf16 v[64:79], v[160:163], v[136:139], v[64:79]
 v_mfma_f32_32x32x16_bf16 v[80:95], v[164:167], v[136:139], v[80:95]
 v_dot2c_f32_bf16 v176, v160, v180
 v_dot2c_f32_bf16 v178, v160, v160
 v_dot2c_f32_bf16 v176, v161, v180
 v_dot2c_f32_bf16 v178, v161, v161
 v_dot2c_f32_bf16 v176, v162, v180
 v_dot2c_f32_bf16 v178, v162, v162
 v_dot2c_f32_bf16 v176, v163, v180
 v_dot2c_f32_bf16 v178, v163, v163
 v_dot2c_f32_bf16 v177, v164, v180
 v_dot2c_f32_bf16 v179, v164, v164
 v_dot2c_f32_bf16 v177, v165, v180
 v_dot2c_f32_bf16 v179, v165, v165
 v_dot2c_f32_bf16 v177, v166, v180
 v_dot2c_f32_bf16 v179, v166, v166
 v_dot2c_f32_bf16 v177, v167, v180
 v_dot2c_f32_bf16 v179, v167, v167
 buffer_load_dwordx4 v[136:139], v4, s[12:15], s42 offen
 s_add_u32 s42, s42, 1024
 ds_read_b128 v[160:163], v5 offset:768
 ds_read_b128 v[164:167], v7 offset:768
 s_waitcnt vmcnt(3) lgkmcnt(2)
 v_mfma_f32_32x32x16_bf16 v[64:79], v[168:171], v[140:143], v[64:79]
 v_mfma_f32_32x32x16_bf16 v[80:95], v[172:175], v[140:143], v[80:95]
 v_dot2c_f32_bf16 v176, v168, v180
 v_dot2c_f32_bf16 v178, v168, v168
 v_dot2c_f32_bf16 v176, v169, v180
 v_dot2c_f32_bf16 v178, v169, v169
 v_dot2c_f32_bf16 v176, v170, v180
 v_dot2c_f32_bf16 v178, v170, v170
 v_dot2c_f32_bf16 v176, v171, v180
 v_dot2c_f32_bf16 v178, v171, v171
 v_dot2c_f32_bf16 v177, v172, v180
 v_dot2c_f32_bf16 v179, v172, v172
 v_dot2c_f32_bf16 v177, v173, v180
 v_dot2c_f32_bf16 v179, v173, v173
 v_dot2c_f32_bf16 v177, v174, v180
 v_dot2c_f32_bf16 v179, v174, v174
 v_dot2c_f32_bf16 v177, v175, v180
 v_dot2c_f32_bf16 v179, v175, v175
 buffer_load_dwordx4 v[140:143], v4, s[12:15], s42 offen
 s_add_u32 s42, s42, 1024
 ds_read_b128 v[168:171], v5 offset:800
 ds_read_b128 v[172:175], v7 offset:800
 s_waitcnt vmcnt(3) lgkmcnt(2)
 v_mfma_f32_32x32x16_bf16 v[64:79], v[160:163], v[128:131], v[64:79]
 v_mfma_f32_32x32x16_bf16 v[80:95], v[164:167], v[128:131], v[80:95]
 v_dot2c_f32_bf16 v176, v160, v180
 v_dot2c_f32_bf16 v178, v160, v160
 v_dot2c_f32_bf16 v176, v161, v180
 v_dot2c_f32_bf16 v178, v161, v161
 v_dot2c_f32_bf16 v176, v162, v180
 v_dot2c_f32_bf16 v178, v162, v162
 v_dot2c_f32_bf16 v176, v163, v180
 v_dot2c_f32_bf16 v178, v163, v163
 v_dot2c_f32_bf16 v177, v164, v180
 v_dot2c_f32_bf16 v179, v164, v164
 v_dot2c_f32_bf16 v177, v165, v180
 v_dot2c_f32_bf16 v179, v165, v165
 v_dot2c_f32_bf16 v177, v166, v180
 v_dot2c_f32_bf16 v179, v166, v166
 v_dot2c_f32_bf16 v177, v167, v180
 v_dot2c_f32_bf16 v179, v167, v167
 buffer_load_dwordx4 v[128:131], v4, s[12:15], s42 offen
 s_add_u32 s42, s42, 1024
 ds_read_b128 v[160:163], v5 offset:832
 ds_read_b128 v[164:167], v7 offset:832
 s_waitcnt vmcnt(3) lgkmcnt(2)
 v_mfma_f32_32x32x16_bf16 v[64:79], v[168:171], v[132:135], v[64:79]
 v_mfma_f32_32x32x16_bf16 v[80:95], v[172:175], v[132:135], v[80:95]
 v_dot2c_f32_bf16 v176, v168, v180
 v_dot2c_f32_bf16 v178, v168, v168
 v_dot2c_f32_bf16 v176, v169, v180
 v_dot2c_f32_bf16 v178, v169, v169
 v_dot2c_f32_bf16 v176, v170, v180
 v_dot2c_f32_bf16 v178, v170, v170
 v_dot2c_f32_bf16 v176, v171, v180
 v_dot2c_f32_bf16 v178, v171, v171
 v_dot2c_f32_bf16 v177, v172, v180
 v_dot2c_f32_bf16 v179, v172, v172
 v_dot2c_f32_bf16 v177, v173, v180
 v_dot2c_f32_bf16 v179, v173, v173
 v_dot2c_f32_bf16 v177, v174, v180
 v_dot2c_f32_bf16 v179, v174, v174
 v_dot2c_f32_bf16 v177, v175, v180
 v_dot2c_f32_bf16 v179, v175, v175
 buffer_load_dwordx4 v[132:135], v4, s[12:15], s42 offen
 s_add_u32 s42, s42, 1024
 ds_read_b128 v[168:171], v5 offset:864
 ds_read_b128 v[172:175], v7 offset:864
 s_waitcnt vmcnt(3) lgkmcnt(2)
 v_mfma_f32_32x32x16_bf16 v[64:79], v[160:163], v[136:139], v[64:79]
 v_mfma_f32_32x32x16_bf16 v[80:95], v[164:167], v[136:139], v[80:95]
 v_dot2c_f32_bf16 v176, v160, v180
 v_dot2c_f32_bf16 v178, v160, v160
 v_dot2c_f32_bf16 v176, v161, v180
 v_dot2c_f32_bf16 v178, v161, v161
 v_dot2c_f32_bf16 v176, v162, v180
 v_dot2c_f32_bf16 v178, v162, v162
 v_dot2c_f32_bf16 v176, v163, v180
 v_dot2c_f32_bf16 v178, v163, v163
 v_dot2c_f32_bf16 v177, v164, v180
 v_dot2c_f32_bf16 v179, v164, v164
 v_dot2c_f32_bf16 v177, v165, v180
 v_dot2c_f32_bf16 v179, v165, v165
 v_dot2c_f32_bf16 v177, v166, v180
 v_dot2c_f32_bf16 v179, v166, v166
 v_dot2c_f32_bf16 v177, v167, v180
 v_dot2c_f32_bf16 v179, v167, v167
 buffer_load_dwordx4 v[136:139], v4, s[12:15], s42 offen
 s_add_u32 s42, s42, 1024
 ds_read_b128 v[160:163], v5 offset:896
 ds_read_b128 v[164:167], v7 offset:896
 s_waitcnt vmcnt(3) lgkmcnt(2)
 v_mfma_f32_32x32x16_bf16 v[64:79], v[168:171], v[140:143], v[64:79]
 v_mfma_f32_32x32x16_bf16 v[80:95], v[172:175], v[140:143], v[80:95]
 v_dot2c_f32_bf16 v176, v168, v180
 v_dot2c_f32_bf16 v178, v168, v168
 v_dot2c_f32_bf16 v176, v169, v180
 v_dot2c_f32_bf16 v178, v169, v169
 v_dot2c_f32_bf16 v176, v170, v180
 v_dot2c_f32_bf16 v178, v170, v170
 v_dot2c_f32_bf16 v176, v171, v180
 v_dot2c_f32_bf16 v178, v171, v171
 v_dot2c_f32_bf16 v177, v172, v180
 v_dot2c_f32_bf16 v179, v172, v172
 v_dot2c_f32_bf16 v177, v173, v180
 v_dot2c_f32_bf16 v179, v173, v173
 v_dot2c_f32_bf16 v177, v174, v180
 v_dot2c_f32_bf16 v179, v174, v174
 v_dot2c_f32_bf16 v177, v175, v180
 v_dot2c_f32_bf16 v179, v175, v175
 buffer_load_dwordx4 v[140:143], v4, s[12:15], s42 offen
 s_add_u32 s42, s42, 1024
 ds_read_b128 v[168:171], v5 offset:928
 ds_read_b128 v[172:175], v7 offset:928
 s_waitcnt vmcnt(3) lgkmcnt(2)
 v_mfma_f32_32x32x16_bf16 v[64:79], v[160:163], v[128:131], v[64:79]
 v_mfma_f32_32x32x16_bf16 v[80:95], v[164:167], v[128:131], v[80:95]
 v_dot2c_f32_bf16 v176, v160, v180
 v_dot2c_f32_bf16 v178, v160, v160
 v_dot2c_f32_bf16 v176, v161, v180
 v_dot2c_f32_bf16 v178, v161, v161
 v_dot2c_f32_bf16 v176, v162, v180
 v_dot2c_f32_bf16 v178, v162, v162
 v_dot2c_f32_bf16 v176, v163, v180
 v_dot2c_f32_bf16 v178, v163, v163
 v_dot2c_f32_bf16 v177, v164, v180
 v_dot2c_f32_bf16 v179, v164, v164
 v_dot2c_f32_bf16 v177, v165, v180
 v_dot2c_f32_bf16 v179, v165, v165
 v_dot2c_f32_bf16 v177, v166, v180
 v_dot2c_f32_bf16 v179, v166, v166
 v_dot2c_f32_bf16 v177, v167, v180
 v_dot2c_f32_bf16 v179, v167, v167
 buffer_load_dwordx4 v[128:131], v4, s[12:15], s42 offen
 s_add_u32 s42, s42, 1024
 ds_read_b128 v[160:163], v5 offset:960
 ds_read_b128 v[164:167], v7 offset:960
 s_waitcnt vmcnt(3) lgkmcnt(2)
 v_mfma_f32_32x32x16_bf16 v[64:79], v[168:171], v[132:135], v[64:79]
 v_mfma_f32_32x32x16_bf16 v[80:95], v[172:175], v[132:135], v[80:95]
 v_dot2c_f32_bf16 v176, v168, v180
 v_dot2c_f32_bf16 v178, v168, v168
 v_dot2c_f32_bf16 v176, v169, v180
 v_dot2c_f32_bf16 v178, v169, v169
 v_dot2c_f32_bf16 v176, v170, v180
 v_dot2c_f32_bf16 v178, v170, v170
 v_dot2c_f32_bf16 v176, v171, v180
 v_dot2c_f32_bf16 v178, v171, v171
 v_dot2c_f32_bf16 v177, v172, v180
 v_dot2c_f32_bf16 v179, v172, v172
 v_dot2c_f32_bf16 v177, v173, v180
 v_dot2c_f32_bf16 v179, v173, v173
 v_dot2c_f32_bf16 v177, v174, v180
 v_dot2c_f32_bf16 v179, v174, v174
 v_dot2c_f32_bf16 v177, v175, v180
 v_dot2c_f32_bf16 v179, v175, v175
 buffer_load_dwordx4 v[132:135], v4, s[12:15], s42 offen
 s_add_u32 s42, s42, 1024
 ds_read_b128 v[168:171], v5 offset:992
 ds_read_b128 v[172:175], v7 offset:992
 s_waitcnt vmcnt(3) lgkmcnt(2)
 v_mfma_f32_32x32x16_bf16 v[64:79], v[160:163], v[136:139], v[64:79]
 v_mfma_f32_32x32x16_bf16 v[80:95], v[164:167], v[136:139], v[80:95]
 v_dot2c_f32_bf16 v176, v160, v180
 v_dot2c_f32_bf16 v178, v160, v160
 v_dot2c_f32_bf16 v176, v161, v180
 v_dot2c_f32_bf16 v178, v161, v161
 v_dot2c_f32_bf16 v176, v162, v180
 v_dot2c_f32_bf16 v178, v162, v162
 v_dot2c_f32_bf16 v176, v163, v180
 v_dot2c_f32_bf16 v178, v163, v163
 v_dot2c_f32_bf16 v177, v164, v180
 v_dot2c_f32_bf16 v179, v164, v164
 v_dot2c_f32_bf16 v177, v165, v180
 v_dot2c_f32_bf16 v179, v165, v165
 v_dot2c_f32_bf16 v177, v166, v180
 v_dot2c_f32_bf16 v179, v166, v166
 v_dot2c_f32_bf16 v177, v167, v180
 v_dot2c_f32_bf16 v179, v167, v167
 buffer_load_dwordx4 v[136:139], v4, s[12:15], s42 offen
 s_add_u32 s42, s42, 1024
 ds_read_b128 v[160:163], v5 offset:1024
 ds_read_b128 v[164:167], v7 offset:1024
 s_waitcnt vmcnt(3) lgkmcnt(2)
 v_mfma_f32_32x32x16_bf16 v[64:79], v[168:171], v[140:143], v[64:79]
 v_mfma_f32_32x32x16_bf16 v[80:95], v[172:175], v[140:143], v[80:95]
 v_dot2c_f32_bf16 v176, v168, v180
 v_dot2c_f32_bf16 v178, v168, v168
 v_dot2c_f32_bf16 v176, v169, v180
 v_dot2c_f32_bf16 v178, v169, v169
 v_dot2c_f32_bf16 v176, v170, v180
 v_dot2c_f32_bf16 v178, v170, v170
 v_dot2c_f32_bf16 v176, v171, v180
 v_dot2c_f32_bf16 v178, v171, v171
 v_dot2c_f32_bf16 v177, v172, v180
 v_dot2c_f32_bf16 v179, v172, v172
 v_dot2c_f32_bf16 v177, v173, v180
 v_dot2c_f32_bf16 v179, v173, v173
 v_dot2c_f32_bf16 v177, v174, v180
 v_dot2c_f32_bf16 v179, v174, v174
 v_dot2c_f32_bf16 v177, v175, v180
 v_dot2c_f32_bf16 v179, v175, v175
 buffer_load_dwordx4 v[140:143], v4, s[12:15], s42 offen
 s_add_u32 s42, s42, 1024
 ds_read_b128 v[168:171], v5 offset:1056
 ds_read_b128 v[172:175], v7 offset:1056
 s_waitcnt vmcnt(3) lgkmcnt(2)
 v_mfma_f32_32x32x16_bf16 v[64:79], v[160:163], v[128:131], v[64:79]
 v_mfma_f32_32x32x16_bf16 v[80:95], v[164:167], v[128:131], v[80:95]
 v_dot2c_f32_bf16 v176, v160, v180
 v_dot2c_f32_bf16 v178, v160, v160
 v_dot2c_f32_bf16 v176, v161, v180
 v_dot2c_f32_bf16 v178, v161, v161
 v_dot2c_f32_bf16 v176, v162, v180
 v_dot2c_f32_bf16 v178, v162, v162
 v_dot2c_f32_bf16 v176, v163, v180
 v_dot2c_f32_bf16 v178, v163, v163
 v_dot2c_f32_bf16 v177, v164, v180
 v_dot2c_f32_bf16 v179, v164, v164
 v_dot2c_f32_bf16 v177, v165, v180
 v_dot2c_f32_bf16 v179, v165, v165
 v_dot2c_f32_bf16 v177, v166, v180
 v_dot2c_f32_bf16 v179, v166, v166
 v_dot2c_f32_bf16 v177, v167, v180
 v_dot2c_f32_bf16 v179, v167, v167
 buffer_load_dwordx4 v[128:131], v4, s[12:15], s42 offen
 s_add_u32 s42, s42, 1024
 ds_read_b128 v[160:163], v5 offset:1088
 ds_read_b128 v[164:167], v7 offset:1088
 s_waitcnt vmcnt(3) lgkmcnt(2)
 v_mfma_f32_32x32x16_bf16 v[64:79], v[168:171], v[132:135], v[64:79]
 v_mfma_f32_32x32x16_bf16 v[80:95], v[172:175], v[132:135], v[80:95]
 v_dot2c_f32_bf16 v176, v168, v180
 v_dot2c_f32_bf16 v178, v168, v168
 v_dot2c_f32_bf16 v176, v169, v180
 v_dot2c_f32_bf16 v178, v169, v169
 v_dot2c_f32_bf16 v176, v170, v180
 v_dot2c_f32_bf16 v178, v170, v170
 v_dot2c_f32_bf16 v176, v171, v180
 v_dot2c_f32_bf16 v178, v171, v171
 v_dot2c_f32_bf16 v177, v172, v180
 v_dot2c_f32_bf16 v179, v172, v172
 v_dot2c_f32_bf16 v177, v173, v180
 v_dot2c_f32_bf16 v179, v173, v173
 v_dot2c_f32_bf16 v177, v174, v180
 v_dot2c_f32_bf16 v179, v174, v174
 v_dot2c_f32_bf16 v177, v175, v180
 v_dot2c_f32_bf16 v179, v175, v175
 buffer_load_dwordx4 v[132:135], v4, s[12:15], s42 offen
 s_add_u32 s42, s42, 1024
 ds_read_b128 v[168:171], v5 offset:1120
 ds_read_b128 v[172:175], v7 offset:1120
 s_waitcnt vmcnt(3) lgkmcnt(2)
 v_mfma_f32_32x32x16_bf16 v[64:79], v[160:163], v[136:139], v[64:79]
 v_mfma_f32_32x32x16_bf16 v[80:95], v[164:167], v[136:139], v[80:95]
 v_dot2c_f32_bf16 v176, v160, v180
 v_dot2c_f32_bf16 v178, v160, v160
 v_dot2c_f32_bf16 v176, v161, v180
 v_dot2c_f32_bf16 v178, v161, v161
 v_dot2c_f32_bf16 v176, v162, v180
 v_dot2c_f32_bf16 v178, v162, v162
 v_dot2c_f32_bf16 v176, v163, v180
 v_dot2c_f32_bf16 v178, v163, v163
 v_dot2c_f32_bf16 v177, v164, v180
 v_dot2c_f32_bf16 v179, v164, v164
 v_dot2c_f32_bf16 v177, v165, v180
 v_dot2c_f32_bf16 v179, v165, v165
 v_dot2c_f32_bf16 v177, v166, v180
 v_dot2c_f32_bf16 v179, v166, v166
 v_dot2c_f32_bf16 v177, v167, v180
 v_dot2c_f32_bf16 v179, v167, v167
 buffer_load_dwordx4 v[136:139], v4, s[12:15], s42 offen
 s_add_u32 s42, s42, 1024
 ds_read_b128 v[160:163], v5 offset:1152
 ds_read_b128 v[164:167], v7 offset:1152
 s_waitcnt vmcnt(3) lgkmcnt(2)
 v_mfma_f32_32x32x16_bf16 v[64:79], v[168:171], v[140:143], v[64:79]
 v_mfma_f32_32x32x16_bf16 v[80:95], v[172:175], v[140:143], v[80:95]
 v_dot2c_f32_bf16 v176, v168, v180
 v_dot2c_f32_bf16 v178, v168, v168
 v_dot2c_f32_bf16 v176, v169, v180
 v_dot2c_f32_bf16 v178, v169, v169
 v_dot2c_f32_bf16 v176, v170, v180
 v_dot2c_f32_bf16 v178, v170, v170
 v_dot2c_f32_bf16 v176, v171, v180
 v_dot2c_f32_bf16 v178, v171, v171
 v_dot2c_f32_bf16 v177, v172, v180
 v_dot2c_f32_bf16 v179, v172, v172
 v_dot2c_f32_bf16 v177, v173, v180
 v_dot2c_f32_bf16 v179, v173, v173
 v_dot2c_f32_bf16 v177, v174, v180
 v_dot2c_f32_bf16 v179, v174, v174
 v_dot2c_f32_bf16 v177, v175, v180
 v_dot2c_f32_bf16 v179, v175, v175
 buffer_load_dwordx4 v[140:143], v4, s[12:15], s42 offen
 s_add_u32 s42, s42, 1024
 ds_read_b128 v[168:171], v5 offset:1184
 ds_read_b128 v[172:175], v7 offset:1184
 s_waitcnt vmcnt(3) lgkmcnt(2)
 v_mfma_f32_32x32x16_bf16 v[64:79], v[160:163], v[128:131], v[64:79]
 v_mfma_f32_32x32x16_bf16 v[80:95], v[164:167], v[128:131], v[80:95]
 v_dot2c_f32_bf16 v176, v160, v180
 v_dot2c_f32_bf16 v178, v160, v160
 v_dot2c_f32_bf16 v176, v161, v180
 v_dot2c_f32_bf16 v178, v161, v161
 v_dot2c_f32_bf16 v176, v162, v180
 v_dot2c_f32_bf16 v178, v162, v162
 v_dot2c_f32_bf16 v176, v163, v180
 v_dot2c_f32_bf16 v178, v163, v163
 v_dot2c_f32_bf16 v177, v164, v180
 v_dot2c_f32_bf16 v179, v164, v164
 v_dot2c_f32_bf16 v177, v165, v180
 v_dot2c_f32_bf16 v179, v165, v165
 v_dot2c_f32_bf16 v177, v166, v180
 v_dot2c_f32_bf16 v179, v166, v166
 v_dot2c_f32_bf16 v177, v167, v180
 v_dot2c_f32_bf16 v179, v167, v167
 ds_read_b128 v[160:163], v5 offset:1216
 ds_read_b128 v[164:167], v7 offset:1216
 s_waitcnt vmcnt(2) lgkmcnt(2)
 v_mfma_f32_32x32x16_bf16 v[64:79], v[168:171], v[132:135], v[64:79]
 v_mfma_f32_32x32x16_bf16 v[80:95], v[172:175], v[132:135], v[80:95]
 v_dot2c_f32_bf16 v176, v168, v180
 v_dot2c_f32_bf16 v178, v168, v168
 v_dot2c_f32_bf16 v176, v169, v180
 v_dot2c_f32_bf16 v178, v169, v169
 v_dot2c_f32_bf16 v176, v170, v180
 v_dot2c_f32_bf16 v178, v170, v170
 v_dot2c_f32_bf16 v176, v171, v180
 v_dot2c_f32_bf16 v178, v171, v171
 v_dot2c_f32_bf16 v177, v172, v180
 v_dot2c_f32_bf16 v179, v172, v172
 v_dot2c_f32_bf16 v177, v173, v180
 v_dot2c_f32_bf16 v179, v173, v173
 v_dot2c_f32_bf16 v177, v174, v180
 v_dot2c_f32_bf16 v179, v174, v174
 v_dot2c_f32_bf16 v177, v175, v180
 v_dot2c_f32_bf16 v179, v175, v175
 ds_read_b128 v[168:171], v5 offset:1248
 ds_read_b128 v[172:175], v7 offset:1248
 s_waitcnt vmcnt(1) lgkmcnt(2)
 v_mfma_f32_32x32x16_bf16 v[64:79], v[160:163], v[136:139], v[64:79]
 v_mfma_f32_32x32x16_bf16 v[80:95], v[164:167], v[136:139], v[80:95]
 v_dot2c_f32_bf16 v176, v160, v180
 v_dot2c_f32_bf16 v178, v160, v160
 v_dot2c_f32_bf16 v176, v161, v180
 v_dot2c_f32_bf16 v178, v161, v161
 v_dot2c_f32_bf16 v176, v162, v180
 v_dot2c_f32_bf16 v178, v162, v162
 v_dot2c_f32_bf16 v176, v163, v180
 v_dot2c_f32_bf16 v178, v163, v163
 v_dot2c_f32_bf16 v177, v164, v180
 v_dot2c_f32_bf16 v179, v164, v164
 v_dot2c_f32_bf16 v177, v165, v180
 v_dot2c_f32_bf16 v179, v165, v165
 v_dot2c_f32_bf16 v177, v166, v180
 v_dot2c_f32_bf16 v179, v166, v166
 v_dot2c_f32_bf16 v177, v167, v180
 v_dot2c_f32_bf16 v179, v167, v167
 s_waitcnt vmcnt(0) lgkmcnt(0)
 v_mfma_f32_32x32x16_bf16 v[64:79], v[168:171], v[140:143], v[64:79]
 v_mfma_f32_32x32x16_bf16 v[80:95], v[172:175], v[140:143], v[80:95]
 v_dot2c_f32_bf16 v176, v168, v180
 v_dot2c_f32_bf16 v178, v168, v168
 v_dot2c_f32_bf16 v176, v169, v180
 v_dot2c_f32_bf16 v178, v169, v169
 v_dot2c_f32_bf16 v176, v170, v180
 v_dot2c_f32_bf16 v178, v170, v170
 v_dot2c_f32_bf16 v176, v171, v180
 v_dot2c_f32_bf16 v178, v171, v171
 v_dot2c_f32_bf16 v177, v172, v180
 v_dot2c_f32_bf16 v179, v172, v172
 v_dot2c_f32_bf16 v177, v173, v180
 v_dot2c_f32_bf16 v179, v173, v173
 v_dot2c_f32_bf16 v177, v174, v180
 v_dot2c_f32_bf16 v179, v174, v174
 v_dot2c_f32_bf16 v177, v175, v180
 v_dot2c_f32_bf16 v179, v175, v175
 s_nop 11
 v_mov_b32 v186, v176
 s_nop 1
 v_permlane32_swap_b32 v176, v186
 v_add_f32 v176, v176, v186
 v_mov_b32 v186, v177
 s_nop 1
 v_permlane32_swap_b32 v177, v186
 v_add_f32 v177, v177, v186
 v_mov_b32 v186, v178
 s_nop 1
 v_permlane32_swap_b32 v178, v186
 v_add_f32 v178, v178, v186
 v_mov_b32 v186, v179
 s_nop 1
 v_permlane32_swap_b32 v179, v186
 v_add_f32 v179, v179, v186
 s_mov_b32 s44, 0x3acccccd
 s_mov_b32 s45, 0x3727c5ac
 v_mul_f32 v186, s44, v176
 v_mul_f32 v187, s44, v178
 v_fma_f32 v187, -v186, v186, v187
 v_add_f32 v187, s45, v187
 v_rsq_f32 v181, v187
 s_nop 0
 v_mul_f32 v183, v181, v186
 v_mul_f32 v186, s44, v177
 v_mul_f32 v187, s44, v179
 v_fma_f32 v187, -v186, v186, v187
 v_add_f32 v187, s45, v187
 v_rsq_f32 v182, v187
 s_nop 0
 v_mul_f32 v184, v182, v186
 s_lshl_b32 s46, s34, 9
 s_add_u32 s46, s46, 82944
 v_and_b32 v9, 31, v0
 v_lshlrev_b32 v10, 2, v9
 v_add_u32 v10, s46, v10
 ds_write_b32 v10, v181 offset:0
 ds_write_b32 v10, v183 offset:128
 ds_write_b32 v10, v182 offset:256
 ds_write_b32 v10, v184 offset:384
 v_mov_b32 v10, v9
 v_add_u32 v11, 672, v10
 v_lshlrev_b32 v11, 2, v11
 buffer_load_dword v12, v11, s[16:19], 0 offen
 v_mul_u32_u24 v11, 3277, v10
 v_lshrrev_b32 v11, 16, v11
 v_mul_u32_u24 v13, 20, v11
 v_sub_u32 v13, v10, v13
 v_lshlrev_b32 v11, 17, v11
 v_lshl_add_u32 v11, v13, 4, v11
 v_bfe_u32 v13, v0, 5, 1
 v_lshl_add_u32 v11, v13, 9, v11
 v_lshlrev_b32 v13, 4, v13
 v_add_u32 v13, s46, v13
 s_waitcnt lgkmcnt(0)
 ds_read_b128 v[16:19], v13 offset:0
 ds_read_b128 v[20:23], v13 offset:128
 ds_read_b128 v[24:27], v13 offset:32
 ds_read_b128 v[28:31], v13 offset:160
 ds_read_b128 v[32:35], v13 offset:64
 ds_read_b128 v[36:39], v13 offset:192
 ds_read_b128 v[40:43], v13 offset:96
 ds_read_b128 v[44:47], v13 offset:224
 s_lshl_b32 s48, s32, 1
 s_add_u32 s48, s48, 0
 s_lshl_b32 s48, s48, 11
 s_waitcnt vmcnt(0)
 s_waitcnt lgkmcnt(6)
 v_mul_f32 v48, v20, v12
 v_fma_f32 v64, v16, v64, -v48
 v_mul_f32 v48, v21, v12
 v_fma_f32 v65, v17, v65, -v48
 v_mul_f32 v48, v22, v12
 v_fma_f32 v66, v18, v66, -v48
 v_mul_f32 v48, v23, v12
 v_fma_f32 v67, v19, v67, -v48
 s_waitcnt lgkmcnt(4)
 v_mul_f32 v48, v28, v12
 v_fma_f32 v68, v24, v68, -v48
 v_mul_f32 v48, v29, v12
 v_fma_f32 v69, v25, v69, -v48
 v_mul_f32 v48, v30, v12
 v_fma_f32 v70, v26, v70, -v48
 v_mul_f32 v48, v31, v12
 v_fma_f32 v71, v27, v71, -v48
 s_waitcnt lgkmcnt(2)
 v_mul_f32 v48, v36, v12
 v_fma_f32 v72, v32, v72, -v48
 v_mul_f32 v48, v37, v12
 v_fma_f32 v73, v33, v73, -v48
 v_mul_f32 v48, v38, v12
 v_fma_f32 v74, v34, v74, -v48
 v_mul_f32 v48, v39, v12
 v_fma_f32 v75, v35, v75, -v48
 s_waitcnt lgkmcnt(0)
 v_mul_f32 v48, v44, v12
 v_fma_f32 v76, v40, v76, -v48
 v_mul_f32 v48, v45, v12
 v_fma_f32 v77, v41, v77, -v48
 v_mul_f32 v48, v46, v12
 v_fma_f32 v78, v42, v78, -v48
 v_mul_f32 v48, v47, v12
 v_fma_f32 v79, v43, v79, -v48
 v_cvt_pk_bf16_f32 v50, v64, v65
 v_cvt_pk_bf16_f32 v51, v66, v67
 v_cvt_pk_bf16_f32 v52, v68, v69
 v_cvt_pk_bf16_f32 v53, v70, v71
 v_cvt_pk_bf16_f32 v54, v72, v73
 v_cvt_pk_bf16_f32 v55, v74, v75
 v_cvt_pk_bf16_f32 v56, v76, v77
 v_cvt_pk_bf16_f32 v57, v78, v79
 v_cmp_gt_u32 vcc, 20, v9
 s_and_saveexec_b64 s[50:51], vcc
 buffer_store_dwordx4 v[50:53], v11, s[28:31], s48 offen
 buffer_store_dwordx4 v[54:57], v11, s[28:31], s48 offen offset:1024
 s_mov_b64 exec, s[50:51]
 ds_read_b128 v[16:19], v13 offset:256
 ds_read_b128 v[20:23], v13 offset:384
 ds_read_b128 v[24:27], v13 offset:288
 ds_read_b128 v[28:31], v13 offset:416
 ds_read_b128 v[32:35], v13 offset:320
 ds_read_b128 v[36:39], v13 offset:448
 ds_read_b128 v[40:43], v13 offset:352
 ds_read_b128 v[44:47], v13 offset:480
 s_lshl_b32 s48, s32, 1
 s_add_u32 s48, s48, 1
 s_lshl_b32 s48, s48, 11
 s_waitcnt lgkmcnt(6)
 v_mul_f32 v48, v20, v12
 v_fma_f32 v80, v16, v80, -v48
 v_mul_f32 v48, v21, v12
 v_fma_f32 v81, v17, v81, -v48
 v_mul_f32 v48, v22, v12
 v_fma_f32 v82, v18, v82, -v48
 v_mul_f32 v48, v23, v12
 v_fma_f32 v83, v19, v83, -v48
 s_waitcnt lgkmcnt(4)
 v_mul_f32 v48, v28, v12
 v_fma_f32 v84, v24, v84, -v48
 v_mul_f32 v48, v29, v12
 v_fma_f32 v85, v25, v85, -v48
 v_mul_f32 v48, v30, v12
 v_fma_f32 v86, v26, v86, -v48
 v_mul_f32 v48, v31, v12
 v_fma_f32 v87, v27, v87, -v48
 s_waitcnt lgkmcnt(2)
 v_mul_f32 v48, v36, v12
 v_fma_f32 v88, v32, v88, -v48
 v_mul_f32 v48, v37, v12
 v_fma_f32 v89, v33, v89, -v48
 v_mul_f32 v48, v38, v12
 v_fma_f32 v90, v34, v90, -v48
 v_mul_f32 v48, v39, v12
 v_fma_f32 v91, v35, v91, -v48
 s_waitcnt lgkmcnt(0)
 v_mul_f32 v48, v44, v12
 v_fma_f32 v92, v40, v92, -v48
 v_mul_f32 v48, v45, v12
 v_fma_f32 v93, v41, v93, -v48
 v_mul_f32 v48, v46, v12
 v_fma_f32 v94, v42, v94, -v48
 v_mul_f32 v48, v47, v12
 v_fma_f32 v95, v43, v95, -v48
 v_cvt_pk_bf16_f32 v50, v80, v81
 v_cvt_pk_bf16_f32 v51, v82, v83
 v_cvt_pk_bf16_f32 v52, v84, v85
 v_cvt_pk_bf16_f32 v53, v86, v87
 v_cvt_pk_bf16_f32 v54, v88, v89
 v_cvt_pk_bf16_f32 v55, v90, v91
 v_cvt_pk_bf16_f32 v56, v92, v93
 v_cvt_pk_bf16_f32 v57, v94, v95
 v_cmp_gt_u32 vcc, 20, v9
 s_and_saveexec_b64 s[50:51], vcc
 buffer_store_dwordx4 v[50:53], v11, s[28:31], s48 offen
 buffer_store_dwordx4 v[54:57], v11, s[28:31], s48 offen offset:1024
 s_mov_b64 exec, s[50:51]
L_a1_0_kernel_end:
 s_endpgm
.globl attna_kernel
.p2align 8
.type attna_kernel,@function
attna_kernel:
 s_cmp_ge_u32 s2, 256
 s_cbranch_scc1 L_attna_kernel_end
 s_load_dwordx2 s[4:5], s[0:1], 80
 v_lshrrev_b32 v1, 6, v0
 s_nop 0
 v_readfirstlane_b32 s23, v1
 s_lshr_b32 s20, s2, 3
 s_and_b32 s21, s2, 7
 s_lshl_b32 s21, s21, 3
 s_add_u32 s21, s21, s23
 s_waitcnt lgkmcnt(0)
 s_add_u32 s8, s4, 16777216
 s_addc_u32 s9, s5, 0
 s_mov_b32 s10, 4194304
 s_mov_b32 s11, 0x00020000
 s_add_u32 s12, s4, 20971520
 s_addc_u32 s13, s5, 0
 s_mov_b32 s14, 8388608
 s_mov_b32 s15, 0x00020000
 s_add_u32 s16, s4, 29360128
 s_addc_u32 s17, s5, 0
 s_mov_b32 s18, 2621440
 s_mov_b32 s19, 0x00020000
 s_lshl_b32 s22, s20, 6
 s_add_u32 s22, s22, s21
 s_lshl_b32 s22, s22, 11
 v_and_b32 v1, 63, v0
 v_lshlrev_b32 v2, 4, v1
 buffer_load_dwordx4 v[8:11], v2, s[8:11], s22 offen
 buffer_load_dwordx2 v[12:13], v2, s[8:11], s22 offen offset:1024
 v_mov_b32 v14, 0
 v_mov_b32 v15, 0
 v_lshlrev_b32 v4, 4, v0
 v_and_b32 v5, 31, v0
 v_cmp_eq_u32 s[26:27], 20, v5
 v_mov_b32 v5, 0x3f803f80
 v_add_u32 v6, 8192, v4
 s_mov_b32 s28, 0
 s_mov_b32 s29, 4194304
 buffer_load_dwordx4 v[112:115], v4, s[12:15], s28 offen offset:0
 buffer_load_dwordx4 v[116:119], v6, s[12:15], s28 offen
 buffer_load_dwordx4 v[120:123], v4, s[12:15], s29 offen
 buffer_load_dwordx4 v[124:127], v6, s[12:15], s29 offen
 s_waitcnt vmcnt(4)
 v_cmp_gt_u32 vcc, 32, v1
 s_nop 1
 v_cndmask_b32 v12, 0, v12, vcc
 v_cndmask_b32 v13, 0, v13, vcc
 v_and_b32 v1, 63, v0
 v_lshlrev_b32 v7, 4, v1
 v_and_b32 v3, 31, v0
 v_lshlrev_b32 v3, 4, v3
 v_add_u32 v2, 16384, v7
 v_mov_b32 v70, 0
 v_mov_b32 v71, 0
 v_mov_b32 v78, 0
 v_mov_b32 v79, 0
 v_mov_b32 v48, 0
 v_mov_b32 v49, 0
 v_mov_b32 v50, 0
 v_mov_b32 v51, 0
 v_mov_b32 v52, 0
 v_mov_b32 v53, 0
 v_mov_b32 v54, 0
 v_mov_b32 v55, 0
 v_mov_b32 v56, 0
 v_mov_b32 v57, 0
 v_mov_b32 v58, 0
 v_mov_b32 v59, 0
 v_mov_b32 v60, 0
 v_mov_b32 v61, 0
 v_mov_b32 v62, 0
 v_mov_b32 v63, 0
 v_mov_b32 v104, 0xf149f2ca
 s_waitcnt vmcnt(0)
 v_cndmask_b32 v120, v120, v5, s[26:27]
 v_cndmask_b32 v121, v121, v5, s[26:27]
 v_cndmask_b32 v122, v122, v5, s[26:27]
 v_cndmask_b32 v123, v123, v5, s[26:27]
 v_cndmask_b32 v124, v124, v5, s[26:27]
 v_cndmask_b32 v125, v125, v5, s[26:27]
 v_cndmask_b32 v126, v126, v5, s[26:27]
 v_cndmask_b32 v127, v127, v5, s[26:27]
 ds_write_b128 v4, v[112:115] offset:0
 ds_write_b128 v4, v[116:119] offset:8192
 ds_write_b128 v4, v[120:123] offset:16384
 ds_write_b128 v4, v[124:127] offset:24576
 s_waitcnt lgkmcnt(0)
 s_barrier
 s_mov_b32 s28, 16384
 s_mov_b32 s29, 4210688
 buffer_load_dwordx4 v[112:115], v4, s[12:15], s28 offen offset:0
 buffer_load_dwordx4 v[116:119], v6, s[12:15], s28 offen
 buffer_load_dwordx4 v[120:123], v4, s[12:15], s29 offen
 buffer_load_dwordx4 v[124:127], v6, s[12:15], s29 offen
 ds_read_b128 v[64:67], v7 offset:0
 ds_read_b64 v[68:69], v3 offset:1024
 ds_read_b128 v[80:83], v2 offset:0
 ds_read_b128 v[84:87], v2 offset:1024
 s_waitcnt lgkmcnt(2)
 v_mfma_f32_32x32x16_bf16 v[16:31], v[64:67], v[8:11], 0
 v_mfma_f32_32x32x16_bf16 v[16:31], v[68:71], v[12:15], v[16:31]
 ds_read_b128 v[72:75], v7 offset:2048
 ds_read_b64 v[76:77], v3 offset:3072
 ds_read_b128 v[88:91], v2 offset:2048
 ds_read_b128 v[92:95], v2 offset:3072
 s_waitcnt lgkmcnt(2)
 v_mfma_f32_32x32x16_bf16 v[32:47], v[72:75], v[8:11], 0
 v_mfma_f32_32x32x16_bf16 v[32:47], v[76:79], v[12:15], v[32:47]
 v_max3_f32 v106, v16, v17, v18
 v_max3_f32 v106, v106, v19, v20
 v_max3_f32 v106, v106, v21, v22
 v_max3_f32 v106, v106, v23, v24
 v_max3_f32 v106, v106, v25, v26
 v_max3_f32 v106, v106, v27, v28
 v_max3_f32 v106, v106, v29, v30
 v_max_f32 v106, v106, v31
 v_mov_b32 v107, v106
 s_nop 1
 v_permlane32_swap_b32 v106, v107
 v_max3_f32 v106, v106, v107, v104
 v_sub_f32 v107, v104, v106
 v_exp_f32 v107, v107
 v_mov_b32 v104, v106
 v_sub_f32 v16, v16, v106
 v_sub_f32 v17, v17, v106
 v_sub_f32 v18, v18, v106
 v_sub_f32 v19, v19, v106
 v_sub_f32 v20, v20, v106
 v_sub_f32 v21, v21, v106
 v_sub_f32 v22, v22, v106
 v_sub_f32 v23, v23, v106
 v_sub_f32 v24, v24, v106
 v_sub_f32 v25, v25, v106
 v_sub_f32 v26, v26, v106
 v_sub_f32 v27, v27, v106
 v_sub_f32 v28, v28, v106
 v_sub_f32 v29, v29, v106
 v_sub_f32 v30, v30, v106
 v_sub_f32 v31, v31, v106
 v_mul_f32 v48, v48, v107
 v_mul_f32 v49, v49, v107
 v_mul_f32 v50, v50, v107
 v_mul_f32 v51, v51, v107
 v_mul_f32 v52, v52, v107
 v_mul_f32 v53, v53, v107
 v_mul_f32 v54, v54, v107
 v_mul_f32 v55, v55, v107
 v_mul_f32 v56, v56, v107
 v_mul_f32 v57, v57, v107
 v_mul_f32 v58, v58, v107
 v_mul_f32 v59, v59, v107
 v_exp_f32 v16, v16
 v_exp_f32 v17, v17
 v_exp_f32 v18, v18
 v_exp_f32 v19, v19
 v_exp_f32 v20, v20
 v_exp_f32 v21, v21
 v_exp_f32 v22, v22
 v_exp_f32 v23, v23
 v_exp_f32 v24, v24
 v_exp_f32 v25, v25
 v_exp_f32 v26, v26
 v_exp_f32 v27, v27
 v_exp_f32 v28, v28
 v_exp_f32 v29, v29
 v_exp_f32 v30, v30
 v_exp_f32 v31, v31
 s_nop 0
 v_cvt_pk_bf16_f32 v96, v16, v17
 v_cvt_pk_bf16_f32 v97, v18, v19
 v_cvt_pk_bf16_f32 v98, v20, v21
 v_cvt_pk_bf16_f32 v99, v22, v23
 v_cvt_pk_bf16_f32 v100, v24, v25
 v_cvt_pk_bf16_f32 v101, v26, v27
 v_cvt_pk_bf16_f32 v102, v28, v29
 v_cvt_pk_bf16_f32 v103, v30, v31
 s_nop 0
 v_mfma_f32_32x32x16_bf16 v[48:63], v[80:83], v[96:99], v[48:63]
 v_mfma_f32_32x32x16_bf16 v[48:63], v[84:87], v[100:103], v[48:63]
 ds_read_b128 v[64:67], v7 offset:4096
 ds_read_b64 v[68:69], v3 offset:5120
 ds_read_b128 v[80:83], v2 offset:4096
 ds_read_b128 v[84:87], v2 offset:5120
 s_waitcnt lgkmcnt(2)
 v_mfma_f32_32x32x16_bf16 v[16:31], v[64:67], v[8:11], 0
 v_mfma_f32_32x32x16_bf16 v[16:31], v[68:71], v[12:15], v[16:31]
 v_max3_f32 v106, v32, v33, v34
 v_max3_f32 v106, v106, v35, v36
 v_max3_f32 v106, v106, v37, v38
 v_max3_f32 v106, v106, v39, v40
 v_max3_f32 v106, v106, v41, v42
 v_max3_f32 v106, v106, v43, v44
 v_max3_f32 v106, v106, v45, v46
 v_max_f32 v106, v106, v47
 v_mov_b32 v107, v106
 s_nop 1
 v_permlane32_swap_b32 v106, v107
 v_max3_f32 v106, v106, v107, v104
 v_sub_f32 v107, v104, v106
 v_exp_f32 v107, v107
 v_mov_b32 v104, v106
 v_sub_f32 v32, v32, v106
 v_sub_f32 v33, v33, v106
 v_sub_f32 v34, v34, v106
 v_sub_f32 v35, v35, v106
 v_sub_f32 v36, v36, v106
 v_sub_f32 v37, v37, v106
 v_sub_f32 v38, v38, v106
 v_sub_f32 v39, v39, v106
 v_sub_f32 v40, v40, v106
 v_sub_f32 v41, v41, v106
 v_sub_f32 v42, v42, v106
 v_sub_f32 v43, v43, v106
 v_sub_f32 v44, v44, v106
 v_sub_f32 v45, v45, v106
 v_sub_f32 v46, v46, v106
 v_sub_f32 v47, v47, v106
 v_mul_f32 v48, v48, v107
 v_mul_f32 v49, v49, v107
 v_mul_f32 v50, v50, v107
 v_mul_f32 v51, v51, v107
 v_mul_f32 v52, v52, v107
 v_mul_f32 v53, v53, v107
 v_mul_f32 v54, v54, v107
 v_mul_f32 v55, v55, v107
 v_mul_f32 v56, v56, v107
 v_mul_f32 v57, v57, v107
 v_mul_f32 v58, v58, v107
 v_mul_f32 v59, v59, v107
 v_exp_f32 v32, v32
 v_exp_f32 v33, v33
 v_exp_f32 v34, v34
 v_exp_f32 v35, v35
 v_exp_f32 v36, v36
 v_exp_f32 v37, v37
 v_exp_f32 v38, v38
 v_exp_f32 v39, v39
 v_exp_f32 v40, v40
 v_exp_f32 v41, v41
 v_exp_f32 v42, v42
 v_exp_f32 v43, v43
 v_exp_f32 v44, v44
 v_exp_f32 v45, v45
 v_exp_f32 v46, v46
 v_exp_f32 v47, v47
 s_nop 0
 v_cvt_pk_bf16_f32 v96, v32, v33
 v_cvt_pk_bf16_f32 v97, v34, v35
 v_cvt_pk_bf16_f32 v98, v36, v37
 v_cvt_pk_bf16_f32 v99, v38, v39
 v_cvt_pk_bf16_f32 v100, v40, v41
 v_cvt_pk_bf16_f32 v101, v42, v43
 v_cvt_pk_bf16_f32 v102, v44, v45
 v_cvt_pk_bf16_f32 v103, v46, v47
 s_nop 0
 v_mfma_f32_32x32x16_bf16 v[48:63], v[88:91], v[96:99], v[48:63]
 v_mfma_f32_32x32x16_bf16 v[48:63], v[92:95], v[100:103], v[48:63]
 ds_read_b128 v[72:75], v7 offset:6144
 ds_read_b64 v[76:77], v3 offset:7168
 ds_read_b128 v[88:91], v2 offset:6144
 ds_read_b128 v[92:95], v2 offset:7168
 s_waitcnt lgkmcnt(2)
 v_mfma_f32_32x32x16_bf16 v[32:47], v[72:75], v[8:11], 0
 v_mfma_f32_32x32x16_bf16 v[32:47], v[76:79], v[12:15], v[32:47]
 v_max3_f32 v106, v16, v17, v18
 v_max3_f32 v106, v106, v19, v20
 v_max3_f32 v106, v106, v21, v22
 v_max3_f32 v106, v106, v23, v24
 v_max3_f32 v106, v106, v25, v26
 v_max3_f32 v106, v106, v27, v28
 v_max3_f32 v106, v106, v29, v30
 v_max_f32 v106, v106, v31
 v_mov_b32 v107, v106
 s_nop 1
 v_permlane32_swap_b32 v106, v107
 v_max3_f32 v106, v106, v107, v104
 v_sub_f32 v107, v104, v106
 v_exp_f32 v107, v107
 v_mov_b32 v104, v106
 v_sub_f32 v16, v16, v106
 v_sub_f32 v17, v17, v106
 v_sub_f32 v18, v18, v106
 v_sub_f32 v19, v19, v106
 v_sub_f32 v20, v20, v106
 v_sub_f32 v21, v21, v106
 v_sub_f32 v22, v22, v106
 v_sub_f32 v23, v23, v106
 v_sub_f32 v24, v24, v106
 v_sub_f32 v25, v25, v106
 v_sub_f32 v26, v26, v106
 v_sub_f32 v27, v27, v106
 v_sub_f32 v28, v28, v106
 v_sub_f32 v29, v29, v106
 v_sub_f32 v30, v30, v106
 v_sub_f32 v31, v31, v106
 v_mul_f32 v48, v48, v107
 v_mul_f32 v49, v49, v107
 v_mul_f32 v50, v50, v107
 v_mul_f32 v51, v51, v107
 v_mul_f32 v52, v52, v107
 v_mul_f32 v53, v53, v107
 v_mul_f32 v54, v54, v107
 v_mul_f32 v55, v55, v107
 v_mul_f32 v56, v56, v107
 v_mul_f32 v57, v57, v107
 v_mul_f32 v58, v58, v107
 v_mul_f32 v59, v59, v107
 v_exp_f32 v16, v16
 v_exp_f32 v17, v17
 v_exp_f32 v18, v18
 v_exp_f32 v19, v19
 v_exp_f32 v20, v20
 v_exp_f32 v21, v21
 v_exp_f32 v22, v22
 v_exp_f32 v23, v23
 v_exp_f32 v24, v24
 v_exp_f32 v25, v25
 v_exp_f32 v26, v26
 v_exp_f32 v27, v27
 v_exp_f32 v28, v28
 v_exp_f32 v29, v29
 v_exp_f32 v30, v30
 v_exp_f32 v31, v31
 s_nop 0
 v_cvt_pk_bf16_f32 v96, v16, v17
 v_cvt_pk_bf16_f32 v97, v18, v19
 v_cvt_pk_bf16_f32 v98, v20, v21
 v_cvt_pk_bf16_f32 v99, v22, v23
 v_cvt_pk_bf16_f32 v100, v24, v25
 v_cvt_pk_bf16_f32 v101, v26, v27
 v_cvt_pk_bf16_f32 v102, v28, v29
 v_cvt_pk_bf16_f32 v103, v30, v31
 s_nop 0
 v_mfma_f32_32x32x16_bf16 v[48:63], v[80:83], v[96:99], v[48:63]
 v_mfma_f32_32x32x16_bf16 v[48:63], v[84:87], v[100:103], v[48:63]
 ds_read_b128 v[64:67], v7 offset:8192
 ds_read_b64 v[68:69], v3 offset:9216
 ds_read_b128 v[80:83], v2 offset:8192
 ds_read_b128 v[84:87], v2 offset:9216
 s_waitcnt lgkmcnt(2)
 v_mfma_f32_32x32x16_bf16 v[16:31], v[64:67], v[8:11], 0
 v_mfma_f32_32x32x16_bf16 v[16:31], v[68:71], v[12:15], v[16:31]
 v_max3_f32 v106, v32, v33, v34
 v_max3_f32 v106, v106, v35, v36
 v_max3_f32 v106, v106, v37, v38
 v_max3_f32 v106, v106, v39, v40
 v_max3_f32 v106, v106, v41, v42
 v_max3_f32 v106, v106, v43, v44
 v_max3_f32 v106, v106, v45, v46
 v_max_f32 v106, v106, v47
 v_mov_b32 v107, v106
 s_nop 1
 v_permlane32_swap_b32 v106, v107
 v_max3_f32 v106, v106, v107, v104
 v_sub_f32 v107, v104, v106
 v_exp_f32 v107, v107
 v_mov_b32 v104, v106
 v_sub_f32 v32, v32, v106
 v_sub_f32 v33, v33, v106
 v_sub_f32 v34, v34, v106
 v_sub_f32 v35, v35, v106
 v_sub_f32 v36, v36, v106
 v_sub_f32 v37, v37, v106
 v_sub_f32 v38, v38, v106
 v_sub_f32 v39, v39, v106
 v_sub_f32 v40, v40, v106
 v_sub_f32 v41, v41, v106
 v_sub_f32 v42, v42, v106
 v_sub_f32 v43, v43, v106
 v_sub_f32 v44, v44, v106
 v_sub_f32 v45, v45, v106
 v_sub_f32 v46, v46, v106
 v_sub_f32 v47, v47, v106
 v_mul_f32 v48, v48, v107
 v_mul_f32 v49, v49, v107
 v_mul_f32 v50, v50, v107
 v_mul_f32 v51, v51, v107
 v_mul_f32 v52, v52, v107
 v_mul_f32 v53, v53, v107
 v_mul_f32 v54, v54, v107
 v_mul_f32 v55, v55, v107
 v_mul_f32 v56, v56, v107
 v_mul_f32 v57, v57, v107
 v_mul_f32 v58, v58, v107
 v_mul_f32 v59, v59, v107
 v_exp_f32 v32, v32
 v_exp_f32 v33, v33
 v_exp_f32 v34, v34
 v_exp_f32 v35, v35
 v_exp_f32 v36, v36
 v_exp_f32 v37, v37
 v_exp_f32 v38, v38
 v_exp_f32 v39, v39
 v_exp_f32 v40, v40
 v_exp_f32 v41, v41
 v_exp_f32 v42, v42
 v_exp_f32 v43, v43
 v_exp_f32 v44, v44
 v_exp_f32 v45, v45
 v_exp_f32 v46, v46
 v_exp_f32 v47, v47
 s_nop 0
 v_cvt_pk_bf16_f32 v96, v32, v33
 v_cvt_pk_bf16_f32 v97, v34, v35
 v_cvt_pk_bf16_f32 v98, v36, v37
 v_cvt_pk_bf16_f32 v99, v38, v39
 v_cvt_pk_bf16_f32 v100, v40, v41
 v_cvt_pk_bf16_f32 v101, v42, v43
 v_cvt_pk_bf16_f32 v102, v44, v45
 v_cvt_pk_bf16_f32 v103, v46, v47
 s_nop 0
 v_mfma_f32_32x32x16_bf16 v[48:63], v[88:91], v[96:99], v[48:63]
 v_mfma_f32_32x32x16_bf16 v[48:63], v[92:95], v[100:103], v[48:63]
 ds_read_b128 v[72:75], v7 offset:10240
 ds_read_b64 v[76:77], v3 offset:11264
 ds_read_b128 v[88:91], v2 offset:10240
 ds_read_b128 v[92:95], v2 offset:11264
 s_waitcnt lgkmcnt(2)
 v_mfma_f32_32x32x16_bf16 v[32:47], v[72:75], v[8:11], 0
 v_mfma_f32_32x32x16_bf16 v[32:47], v[76:79], v[12:15], v[32:47]
 v_max3_f32 v106, v16, v17, v18
 v_max3_f32 v106, v106, v19, v20
 v_max3_f32 v106, v106, v21, v22
 v_max3_f32 v106, v106, v23, v24
 v_max3_f32 v106, v106, v25, v26
 v_max3_f32 v106, v106, v27, v28
 v_max3_f32 v106, v106, v29, v30
 v_max_f32 v106, v106, v31
 v_mov_b32 v107, v106
 s_nop 1
 v_permlane32_swap_b32 v106, v107
 v_max3_f32 v106, v106, v107, v104
 v_sub_f32 v107, v104, v106
 v_exp_f32 v107, v107
 v_mov_b32 v104, v106
 v_sub_f32 v16, v16, v106
 v_sub_f32 v17, v17, v106
 v_sub_f32 v18, v18, v106
 v_sub_f32 v19, v19, v106
 v_sub_f32 v20, v20, v106
 v_sub_f32 v21, v21, v106
 v_sub_f32 v22, v22, v106
 v_sub_f32 v23, v23, v106
 v_sub_f32 v24, v24, v106
 v_sub_f32 v25, v25, v106
 v_sub_f32 v26, v26, v106
 v_sub_f32 v27, v27, v106
 v_sub_f32 v28, v28, v106
 v_sub_f32 v29, v29, v106
 v_sub_f32 v30, v30, v106
 v_sub_f32 v31, v31, v106
 v_mul_f32 v48, v48, v107
 v_mul_f32 v49, v49, v107
 v_mul_f32 v50, v50, v107
 v_mul_f32 v51, v51, v107
 v_mul_f32 v52, v52, v107
 v_mul_f32 v53, v53, v107
 v_mul_f32 v54, v54, v107
 v_mul_f32 v55, v55, v107
 v_mul_f32 v56, v56, v107
 v_mul_f32 v57, v57, v107
 v_mul_f32 v58, v58, v107
 v_mul_f32 v59, v59, v107
 v_exp_f32 v16, v16
 v_exp_f32 v17, v17
 v_exp_f32 v18, v18
 v_exp_f32 v19, v19
 v_exp_f32 v20, v20
 v_exp_f32 v21, v21
 v_exp_f32 v22, v22
 v_exp_f32 v23, v23
 v_exp_f32 v24, v24
 v_exp_f32 v25, v25
 v_exp_f32 v26, v26
 v_exp_f32 v27, v27
 v_exp_f32 v28, v28
 v_exp_f32 v29, v29
 v_exp_f32 v30, v30
 v_exp_f32 v31, v31
 s_nop 0
 v_cvt_pk_bf16_f32 v96, v16, v17
 v_cvt_pk_bf16_f32 v97, v18, v19
 v_cvt_pk_bf16_f32 v98, v20, v21
 v_cvt_pk_bf16_f32 v99, v22, v23
 v_cvt_pk_bf16_f32 v100, v24, v25
 v_cvt_pk_bf16_f32 v101, v26, v27
 v_cvt_pk_bf16_f32 v102, v28, v29
 v_cvt_pk_bf16_f32 v103, v30, v31
 s_nop 0
 v_mfma_f32_32x32x16_bf16 v[48:63], v[80:83], v[96:99], v[48:63]
 v_mfma_f32_32x32x16_bf16 v[48:63], v[84:87], v[100:103], v[48:63]
 ds_read_b128 v[64:67], v7 offset:12288
 ds_read_b64 v[68:69], v3 offset:13312
 ds_read_b128 v[80:83], v2 offset:12288
 ds_read_b128 v[84:87], v2 offset:13312
 s_waitcnt lgkmcnt(2)
 v_mfma_f32_32x32x16_bf16 v[16:31], v[64:67], v[8:11], 0
 v_mfma_f32_32x32x16_bf16 v[16:31], v[68:71], v[12:15], v[16:31]
 v_max3_f32 v106, v32, v33, v34
 v_max3_f32 v106, v106, v35, v36
 v_max3_f32 v106, v106, v37, v38
 v_max3_f32 v106, v106, v39, v40
 v_max3_f32 v106, v106, v41, v42
 v_max3_f32 v106, v106, v43, v44
 v_max3_f32 v106, v106, v45, v46
 v_max_f32 v106, v106, v47
 v_mov_b32 v107, v106
 s_nop 1
 v_permlane32_swap_b32 v106, v107
 v_max3_f32 v106, v106, v107, v104
 v_sub_f32 v107, v104, v106
 v_exp_f32 v107, v107
 v_mov_b32 v104, v106
 v_sub_f32 v32, v32, v106
 v_sub_f32 v33, v33, v106
 v_sub_f32 v34, v34, v106
 v_sub_f32 v35, v35, v106
 v_sub_f32 v36, v36, v106
 v_sub_f32 v37, v37, v106
 v_sub_f32 v38, v38, v106
 v_sub_f32 v39, v39, v106
 v_sub_f32 v40, v40, v106
 v_sub_f32 v41, v41, v106
 v_sub_f32 v42, v42, v106
 v_sub_f32 v43, v43, v106
 v_sub_f32 v44, v44, v106
 v_sub_f32 v45, v45, v106
 v_sub_f32 v46, v46, v106
 v_sub_f32 v47, v47, v106
 v_mul_f32 v48, v48, v107
 v_mul_f32 v49, v49, v107
 v_mul_f32 v50, v50, v107
 v_mul_f32 v51, v51, v107
 v_mul_f32 v52, v52, v107
 v_mul_f32 v53, v53, v107
 v_mul_f32 v54, v54, v107
 v_mul_f32 v55, v55, v107
 v_mul_f32 v56, v56, v107
 v_mul_f32 v57, v57, v107
 v_mul_f32 v58, v58, v107
 v_mul_f32 v59, v59, v107
 v_exp_f32 v32, v32
 v_exp_f32 v33, v33
 v_exp_f32 v34, v34
 v_exp_f32 v35, v35
 v_exp_f32 v36, v36
 v_exp_f32 v37, v37
 v_exp_f32 v38, v38
 v_exp_f32 v39, v39
 v_exp_f32 v40, v40
 v_exp_f32 v41, v41
 v_exp_f32 v42, v42
 v_exp_f32 v43, v43
 v_exp_f32 v44, v44
 v_exp_f32 v45, v45
 v_exp_f32 v46, v46
 v_exp_f32 v47, v47
 s_nop 0
 v_cvt_pk_bf16_f32 v96, v32, v33
 v_cvt_pk_bf16_f32 v97, v34, v35
 v_cvt_pk_bf16_f32 v98, v36, v37
 v_cvt_pk_bf16_f32 v99, v38, v39
 v_cvt_pk_bf16_f32 v100, v40, v41
 v_cvt_pk_bf16_f32 v101, v42, v43
 v_cvt_pk_bf16_f32 v102, v44, v45
 v_cvt_pk_bf16_f32 v103, v46, v47
 s_nop 0
 v_mfma_f32_32x32x16_bf16 v[48:63], v[88:91], v[96:99], v[48:63]
 v_mfma_f32_32x32x16_bf16 v[48:63], v[92:95], v[100:103], v[48:63]
 ds_read_b128 v[72:75], v7 offset:14336
 ds_read_b64 v[76:77], v3 offset:15360
 ds_read_b128 v[88:91], v2 offset:14336
 ds_read_b128 v[92:95], v2 offset:15360
 s_waitcnt lgkmcnt(2)
 v_mfma_f32_32x32x16_bf16 v[32:47], v[72:75], v[8:11], 0
 v_mfma_f32_32x32x16_bf16 v[32:47], v[76:79], v[12:15], v[32:47]
 v_max3_f32 v106, v16, v17, v18
 v_max3_f32 v106, v106, v19, v20
 v_max3_f32 v106, v106, v21, v22
 v_max3_f32 v106, v106, v23, v24
 v_max3_f32 v106, v106, v25, v26
 v_max3_f32 v106, v106, v27, v28
 v_max3_f32 v106, v106, v29, v30
 v_max_f32 v106, v106, v31
 v_mov_b32 v107, v106
 s_nop 1
 v_permlane32_swap_b32 v106, v107
 v_max3_f32 v106, v106, v107, v104
 v_sub_f32 v107, v104, v106
 v_exp_f32 v107, v107
 v_mov_b32 v104, v106
 v_sub_f32 v16, v16, v106
 v_sub_f32 v17, v17, v106
 v_sub_f32 v18, v18, v106
 v_sub_f32 v19, v19, v106
 v_sub_f32 v20, v20, v106
 v_sub_f32 v21, v21, v106
 v_sub_f32 v22, v22, v106
 v_sub_f32 v23, v23, v106
 v_sub_f32 v24, v24, v106
 v_sub_f32 v25, v25, v106
 v_sub_f32 v26, v26, v106
 v_sub_f32 v27, v27, v106
 v_sub_f32 v28, v28, v106
 v_sub_f32 v29, v29, v106
 v_sub_f32 v30, v30, v106
 v_sub_f32 v31, v31, v106
 v_mul_f32 v48, v48, v107
 v_mul_f32 v49, v49, v107
 v_mul_f32 v50, v50, v107
 v_mul_f32 v51, v51, v107
 v_mul_f32 v52, v52, v107
 v_mul_f32 v53, v53, v107
 v_mul_f32 v54, v54, v107
 v_mul_f32 v55, v55, v107
 v_mul_f32 v56, v56, v107
 v_mul_f32 v57, v57, v107
 v_mul_f32 v58, v58, v107
 v_mul_f32 v59, v59, v107
 v_exp_f32 v16, v16
 v_exp_f32 v17, v17
 v_exp_f32 v18, v18
 v_exp_f32 v19, v19
 v_exp_f32 v20, v20
 v_exp_f32 v21, v21
 v_exp_f32 v22, v22
 v_exp_f32 v23, v23
 v_exp_f32 v24, v24
 v_exp_f32 v25, v25
 v_exp_f32 v26, v26
 v_exp_f32 v27, v27
 v_exp_f32 v28, v28
 v_exp_f32 v29, v29
 v_exp_f32 v30, v30
 v_exp_f32 v31, v31
 s_nop 0
 v_cvt_pk_bf16_f32 v96, v16, v17
 v_cvt_pk_bf16_f32 v97, v18, v19
 v_cvt_pk_bf16_f32 v98, v20, v21
 v_cvt_pk_bf16_f32 v99, v22, v23
 v_cvt_pk_bf16_f32 v100, v24, v25
 v_cvt_pk_bf16_f32 v101, v26, v27
 v_cvt_pk_bf16_f32 v102, v28, v29
 v_cvt_pk_bf16_f32 v103, v30, v31
 s_nop 0
 v_mfma_f32_32x32x16_bf16 v[48:63], v[80:83], v[96:99], v[48:63]
 v_mfma_f32_32x32x16_bf16 v[48:63], v[84:87], v[100:103], v[48:63]
 s_nop 7
 v_max3_f32 v106, v32, v33, v34
 v_max3_f32 v106, v106, v35, v36
 v_max3_f32 v106, v106, v37, v38
 v_max3_f32 v106, v106, v39, v40
 v_max3_f32 v106, v106, v41, v42
 v_max3_f32 v106, v106, v43, v44
 v_max3_f32 v106, v106, v45, v46
 v_max_f32 v106, v106, v47
 v_mov_b32 v107, v106
 s_nop 1
 v_permlane32_swap_b32 v106, v107
 v_max3_f32 v106, v106, v107, v104
 v_sub_f32 v107, v104, v106
 v_exp_f32 v107, v107
 v_mov_b32 v104, v106
 v_sub_f32 v32, v32, v106
 v_sub_f32 v33, v33, v106
 v_sub_f32 v34, v34, v106
 v_sub_f32 v35, v35, v106
 v_sub_f32 v36, v36, v106
 v_sub_f32 v37, v37, v106
 v_sub_f32 v38, v38, v106
 v_sub_f32 v39, v39, v106
 v_sub_f32 v40, v40, v106
 v_sub_f32 v41, v41, v106
 v_sub_f32 v42, v42, v106
 v_sub_f32 v43, v43, v106
 v_sub_f32 v44, v44, v106
 v_sub_f32 v45, v45, v106
 v_sub_f32 v46, v46, v106
 v_sub_f32 v47, v47, v106
 v_mul_f32 v48, v48, v107
 v_mul_f32 v49, v49, v107
 v_mul_f32 v50, v50, v107
 v_mul_f32 v51, v51, v107
 v_mul_f32 v52, v52, v107
 v_mul_f32 v53, v53, v107
 v_mul_f32 v54, v54, v107
 v_mul_f32 v55, v55, v107
 v_mul_f32 v56, v56, v107
 v_mul_f32 v57, v57, v107
 v_mul_f32 v58, v58, v107
 v_mul_f32 v59, v59, v107
 v_exp_f32 v32, v32
 v_exp_f32 v33, v33
 v_exp_f32 v34, v34
 v_exp_f32 v35, v35
 v_exp_f32 v36, v36
 v_exp_f32 v37, v37
 v_exp_f32 v38, v38
 v_exp_f32 v39, v39
 v_exp_f32 v40, v40
 v_exp_f32 v41, v41
 v_exp_f32 v42, v42
 v_exp_f32 v43, v43
 v_exp_f32 v44, v44
 v_exp_f32 v45, v45
 v_exp_f32 v46, v46
 v_exp_f32 v47, v47
 s_nop 0
 v_cvt_pk_bf16_f32 v96, v32, v33
 v_cvt_pk_bf16_f32 v97, v34, v35
 v_cvt_pk_bf16_f32 v98, v36, v37
 v_cvt_pk_bf16_f32 v99, v38, v39
 v_cvt_pk_bf16_f32 v100, v40, v41
 v_cvt_pk_bf16_f32 v101, v42, v43
 v_cvt_pk_bf16_f32 v102, v44, v45
 v_cvt_pk_bf16_f32 v103, v46, v47
 s_waitcnt lgkmcnt(0)
 s_nop 0
 v_mfma_f32_32x32x16_bf16 v[48:63], v[88:91], v[96:99], v[48:63]
 v_mfma_f32_32x32x16_bf16 v[48:63], v[92:95], v[100:103], v[48:63]
 s_waitcnt vmcnt(0)
 v_cndmask_b32 v120, v120, v5, s[26:27]
 v_cndmask_b32 v121, v121, v5, s[26:27]
 v_cndmask_b32 v122, v122, v5, s[26:27]
 v_cndmask_b32 v123, v123, v5, s[26:27]
 v_cndmask_b32 v124, v124, v5, s[26:27]
 v_cndmask_b32 v125, v125, v5, s[26:27]
 v_cndmask_b32 v126, v126, v5, s[26:27]
 v_cndmask_b32 v127, v127, v5, s[26:27]
 ds_write_b128 v4, v[112:115] offset:32768
 ds_write_b128 v4, v[116:119] offset:40960
 ds_write_b128 v4, v[120:123] offset:49152
 ds_write_b128 v4, v[124:127] offset:57344
 s_waitcnt lgkmcnt(0)
 s_barrier
 s_mov_b32 s28, 32768
 s_mov_b32 s29, 4227072
 buffer_load_dwordx4 v[112:115], v4, s[12:15], s28 offen offset:0
 buffer_load_dwordx4 v[116:119], v6, s[12:15], s28 offen
 buffer_load_dwordx4 v[120:123], v4, s[12:15], s29 offen
 buffer_load_dwordx4 v[124:127], v6, s[12:15], s29 offen
 ds_read_b128 v[64:67], v7 offset:32768
 ds_read_b64 v[68:69], v3 offset:33792
 ds_read_b128 v[80:83], v2 offset:32768
 ds_read_b128 v[84:87], v2 offset:33792
 s_waitcnt lgkmcnt(2)
 v_mfma_f32_32x32x16_bf16 v[16:31], v[64:67], v[8:11], 0
 v_mfma_f32_32x32x16_bf16 v[16:31], v[68:71], v[12:15], v[16:31]
 ds_read_b128 v[72:75], v7 offset:34816
 ds_read_b64 v[76:77], v3 offset:35840
 ds_read_b128 v[88:91], v2 offset:34816
 ds_read_b128 v[92:95], v2 offset:35840
 s_waitcnt lgkmcnt(2)
 v_mfma_f32_32x32x16_bf16 v[32:47], v[72:75], v[8:11], 0
 v_mfma_f32_32x32x16_bf16 v[32:47], v[76:79], v[12:15], v[32:47]
 v_max3_f32 v106, v16, v17, v18
 v_max3_f32 v106, v106, v19, v20
 v_max3_f32 v106, v106, v21, v22
 v_max3_f32 v106, v106, v23, v24
 v_max3_f32 v106, v106, v25, v26
 v_max3_f32 v106, v106, v27, v28
 v_max3_f32 v106, v106, v29, v30
 v_max_f32 v106, v106, v31
 v_mov_b32 v107, v106
 s_nop 1
 v_permlane32_swap_b32 v106, v107
 v_max3_f32 v106, v106, v107, v104
 v_sub_f32 v107, v104, v106
 v_exp_f32 v107, v107
 v_mov_b32 v104, v106
 v_sub_f32 v16, v16, v106
 v_sub_f32 v17, v17, v106
 v_sub_f32 v18, v18, v106
 v_sub_f32 v19, v19, v106
 v_sub_f32 v20, v20, v106
 v_sub_f32 v21, v21, v106
 v_sub_f32 v22, v22, v106
 v_sub_f32 v23, v23, v106
 v_sub_f32 v24, v24, v106
 v_sub_f32 v25, v25, v106
 v_sub_f32 v26, v26, v106
 v_sub_f32 v27, v27, v106
 v_sub_f32 v28, v28, v106
 v_sub_f32 v29, v29, v106
 v_sub_f32 v30, v30, v106
 v_sub_f32 v31, v31, v106
 v_mul_f32 v48, v48, v107
 v_mul_f32 v49, v49, v107
 v_mul_f32 v50, v50, v107
 v_mul_f32 v51, v51, v107
 v_mul_f32 v52, v52, v107
 v_mul_f32 v53, v53, v107
 v_mul_f32 v54, v54, v107
 v_mul_f32 v55, v55, v107
 v_mul_f32 v56, v56, v107
 v_mul_f32 v57, v57, v107
 v_mul_f32 v58, v58, v107
 v_mul_f32 v59, v59, v107
 v_exp_f32 v16, v16
 v_exp_f32 v17, v17
 v_exp_f32 v18, v18
 v_exp_f32 v19, v19
 v_exp_f32 v20, v20
 v_exp_f32 v21, v21
 v_exp_f32 v22, v22
 v_exp_f32 v23, v23
 v_exp_f32 v24, v24
 v_exp_f32 v25, v25
 v_exp_f32 v26, v26
 v_exp_f32 v27, v27
 v_exp_f32 v28, v28
 v_exp_f32 v29, v29
 v_exp_f32 v30, v30
 v_exp_f32 v31, v31
 s_nop 0
 v_cvt_pk_bf16_f32 v96, v16, v17
 v_cvt_pk_bf16_f32 v97, v18, v19
 v_cvt_pk_bf16_f32 v98, v20, v21
 v_cvt_pk_bf16_f32 v99, v22, v23
 v_cvt_pk_bf16_f32 v100, v24, v25
 v_cvt_pk_bf16_f32 v101, v26, v27
 v_cvt_pk_bf16_f32 v102, v28, v29
 v_cvt_pk_bf16_f32 v103, v30, v31
 s_nop 0
 v_mfma_f32_32x32x16_bf16 v[48:63], v[80:83], v[96:99], v[48:63]
 v_mfma_f32_32x32x16_bf16 v[48:63], v[84:87], v[100:103], v[48:63]
 ds_read_b128 v[64:67], v7 offset:36864
 ds_read_b64 v[68:69], v3 offset:37888
 ds_read_b128 v[80:83], v2 offset:36864
 ds_read_b128 v[84:87], v2 offset:37888
 s_waitcnt lgkmcnt(2)
 v_mfma_f32_32x32x16_bf16 v[16:31], v[64:67], v[8:11], 0
 v_mfma_f32_32x32x16_bf16 v[16:31], v[68:71], v[12:15], v[16:31]
 v_max3_f32 v106, v32, v33, v34
 v_max3_f32 v106, v106, v35, v36
 v_max3_f32 v106, v106, v37, v38
 v_max3_f32 v106, v106, v39, v40
 v_max3_f32 v106, v106, v41, v42
 v_max3_f32 v106, v106, v43, v44
 v_max3_f32 v106, v106, v45, v46
 v_max_f32 v106, v106, v47
 v_mov_b32 v107, v106
 s_nop 1
 v_permlane32_swap_b32 v106, v107
 v_max3_f32 v106, v106, v107, v104
 v_sub_f32 v107, v104, v106
 v_exp_f32 v107, v107
 v_mov_b32 v104, v106
 v_sub_f32 v32, v32, v106
 v_sub_f32 v33, v33, v106
 v_sub_f32 v34, v34, v106
 v_sub_f32 v35, v35, v106
 v_sub_f32 v36, v36, v106
 v_sub_f32 v37, v37, v106
 v_sub_f32 v38, v38, v106
 v_sub_f32 v39, v39, v106
 v_sub_f32 v40, v40, v106
 v_sub_f32 v41, v41, v106
 v_sub_f32 v42, v42, v106
 v_sub_f32 v43, v43, v106
 v_sub_f32 v44, v44, v106
 v_sub_f32 v45, v45, v106
 v_sub_f32 v46, v46, v106
 v_sub_f32 v47, v47, v106
 v_mul_f32 v48, v48, v107
 v_mul_f32 v49, v49, v107
 v_mul_f32 v50, v50, v107
 v_mul_f32 v51, v51, v107
 v_mul_f32 v52, v52, v107
 v_mul_f32 v53, v53, v107
 v_mul_f32 v54, v54, v107
 v_mul_f32 v55, v55, v107
 v_mul_f32 v56, v56, v107
 v_mul_f32 v57, v57, v107
 v_mul_f32 v58, v58, v107
 v_mul_f32 v59, v59, v107
 v_exp_f32 v32, v32
 v_exp_f32 v33, v33
 v_exp_f32 v34, v34
 v_exp_f32 v35, v35
 v_exp_f32 v36, v36
 v_exp_f32 v37, v37
 v_exp_f32 v38, v38
 v_exp_f32 v39, v39
 v_exp_f32 v40, v40
 v_exp_f32 v41, v41
 v_exp_f32 v42, v42
 v_exp_f32 v43, v43
 v_exp_f32 v44, v44
 v_exp_f32 v45, v45
 v_exp_f32 v46, v46
 v_exp_f32 v47, v47
 s_nop 0
 v_cvt_pk_bf16_f32 v96, v32, v33
 v_cvt_pk_bf16_f32 v97, v34, v35
 v_cvt_pk_bf16_f32 v98, v36, v37
 v_cvt_pk_bf16_f32 v99, v38, v39
 v_cvt_pk_bf16_f32 v100, v40, v41
 v_cvt_pk_bf16_f32 v101, v42, v43
 v_cvt_pk_bf16_f32 v102, v44, v45
 v_cvt_pk_bf16_f32 v103, v46, v47
 s_nop 0
 v_mfma_f32_32x32x16_bf16 v[48:63], v[88:91], v[96:99], v[48:63]
 v_mfma_f32_32x32x16_bf16 v[48:63], v[92:95], v[100:103], v[48:63]
 ds_read_b128 v[72:75], v7 offset:38912
 ds_read_b64 v[76:77], v3 offset:39936
 ds_read_b128 v[88:91], v2 offset:38912
 ds_read_b128 v[92:95], v2 offset:39936
 s_waitcnt lgkmcnt(2)
 v_mfma_f32_32x32x16_bf16 v[32:47], v[72:75], v[8:11], 0
 v_mfma_f32_32x32x16_bf16 v[32:47], v[76:79], v[12:15], v[32:47]
 v_max3_f32 v106, v16, v17, v18
 v_max3_f32 v106, v106, v19, v20
 v_max3_f32 v106, v106, v21, v22
 v_max3_f32 v106, v106, v23, v24
 v_max3_f32 v106, v106, v25, v26
 v_max3_f32 v106, v106, v27, v28
 v_max3_f32 v106, v106, v29, v30
 v_max_f32 v106, v106, v31
 v_mov_b32 v107, v106
 s_nop 1
 v_permlane32_swap_b32 v106, v107
 v_max3_f32 v106, v106, v107, v104
 v_sub_f32 v107, v104, v106
 v_exp_f32 v107, v107
 v_mov_b32 v104, v106
 v_sub_f32 v16, v16, v106
 v_sub_f32 v17, v17, v106
 v_sub_f32 v18, v18, v106
 v_sub_f32 v19, v19, v106
 v_sub_f32 v20, v20, v106
 v_sub_f32 v21, v21, v106
 v_sub_f32 v22, v22, v106
 v_sub_f32 v23, v23, v106
 v_sub_f32 v24, v24, v106
 v_sub_f32 v25, v25, v106
 v_sub_f32 v26, v26, v106
 v_sub_f32 v27, v27, v106
 v_sub_f32 v28, v28, v106
 v_sub_f32 v29, v29, v106
 v_sub_f32 v30, v30, v106
 v_sub_f32 v31, v31, v106
 v_mul_f32 v48, v48, v107
 v_mul_f32 v49, v49, v107
 v_mul_f32 v50, v50, v107
 v_mul_f32 v51, v51, v107
 v_mul_f32 v52, v52, v107
 v_mul_f32 v53, v53, v107
 v_mul_f32 v54, v54, v107
 v_mul_f32 v55, v55, v107
 v_mul_f32 v56, v56, v107
 v_mul_f32 v57, v57, v107
 v_mul_f32 v58, v58, v107
 v_mul_f32 v59, v59, v107
 v_exp_f32 v16, v16
 v_exp_f32 v17, v17
 v_exp_f32 v18, v18
 v_exp_f32 v19, v19
 v_exp_f32 v20, v20
 v_exp_f32 v21, v21
 v_exp_f32 v22, v22
 v_exp_f32 v23, v23
 v_exp_f32 v24, v24
 v_exp_f32 v25, v25
 v_exp_f32 v26, v26
 v_exp_f32 v27, v27
 v_exp_f32 v28, v28
 v_exp_f32 v29, v29
 v_exp_f32 v30, v30
 v_exp_f32 v31, v31
 s_nop 0
 v_cvt_pk_bf16_f32 v96, v16, v17
 v_cvt_pk_bf16_f32 v97, v18, v19
 v_cvt_pk_bf16_f32 v98, v20, v21
 v_cvt_pk_bf16_f32 v99, v22, v23
 v_cvt_pk_bf16_f32 v100, v24, v25
 v_cvt_pk_bf16_f32 v101, v26, v27
 v_cvt_pk_bf16_f32 v102, v28, v29
 v_cvt_pk_bf16_f32 v103, v30, v31
 s_nop 0
 v_mfma_f32_32x32x16_bf16 v[48:63], v[80:83], v[96:99], v[48:63]
 v_mfma_f32_32x32x16_bf16 v[48:63], v[84:87], v[100:103], v[48:63]
 ds_read_b128 v[64:67], v7 offset:40960
 ds_read_b64 v[68:69], v3 offset:41984
 ds_read_b128 v[80:83], v2 offset:40960
 ds_read_b128 v[84:87], v2 offset:41984
 s_waitcnt lgkmcnt(2)
 v_mfma_f32_32x32x16_bf16 v[16:31], v[64:67], v[8:11], 0
 v_mfma_f32_32x32x16_bf16 v[16:31], v[68:71], v[12:15], v[16:31]
 v_max3_f32 v106, v32, v33, v34
 v_max3_f32 v106, v106, v35, v36
 v_max3_f32 v106, v106, v37, v38
 v_max3_f32 v106, v106, v39, v40
 v_max3_f32 v106, v106, v41, v42
 v_max3_f32 v106, v106, v43, v44
 v_max3_f32 v106, v106, v45, v46
 v_max_f32 v106, v106, v47
 v_mov_b32 v107, v106
 s_nop 1
 v_permlane32_swap_b32 v106, v107
 v_max3_f32 v106, v106, v107, v104
 v_sub_f32 v107, v104, v106
 v_exp_f32 v107, v107
 v_mov_b32 v104, v106
 v_sub_f32 v32, v32, v106
 v_sub_f32 v33, v33, v106
 v_sub_f32 v34, v34, v106
 v_sub_f32 v35, v35, v106
 v_sub_f32 v36, v36, v106
 v_sub_f32 v37, v37, v106
 v_sub_f32 v38, v38, v106
 v_sub_f32 v39, v39, v106
 v_sub_f32 v40, v40, v106
 v_sub_f32 v41, v41, v106
 v_sub_f32 v42, v42, v106
 v_sub_f32 v43, v43, v106
 v_sub_f32 v44, v44, v106
 v_sub_f32 v45, v45, v106
 v_sub_f32 v46, v46, v106
 v_sub_f32 v47, v47, v106
 v_mul_f32 v48, v48, v107
 v_mul_f32 v49, v49, v107
 v_mul_f32 v50, v50, v107
 v_mul_f32 v51, v51, v107
 v_mul_f32 v52, v52, v107
 v_mul_f32 v53, v53, v107
 v_mul_f32 v54, v54, v107
 v_mul_f32 v55, v55, v107
 v_mul_f32 v56, v56, v107
 v_mul_f32 v57, v57, v107
 v_mul_f32 v58, v58, v107
 v_mul_f32 v59, v59, v107
 v_exp_f32 v32, v32
 v_exp_f32 v33, v33
 v_exp_f32 v34, v34
 v_exp_f32 v35, v35
 v_exp_f32 v36, v36
 v_exp_f32 v37, v37
 v_exp_f32 v38, v38
 v_exp_f32 v39, v39
 v_exp_f32 v40, v40
 v_exp_f32 v41, v41
 v_exp_f32 v42, v42
 v_exp_f32 v43, v43
 v_exp_f32 v44, v44
 v_exp_f32 v45, v45
 v_exp_f32 v46, v46
 v_exp_f32 v47, v47
 s_nop 0
 v_cvt_pk_bf16_f32 v96, v32, v33
 v_cvt_pk_bf16_f32 v97, v34, v35
 v_cvt_pk_bf16_f32 v98, v36, v37
 v_cvt_pk_bf16_f32 v99, v38, v39
 v_cvt_pk_bf16_f32 v100, v40, v41
 v_cvt_pk_bf16_f32 v101, v42, v43
 v_cvt_pk_bf16_f32 v102, v44, v45
 v_cvt_pk_bf16_f32 v103, v46, v47
 s_nop 0
 v_mfma_f32_32x32x16_bf16 v[48:63], v[88:91], v[96:99], v[48:63]
 v_mfma_f32_32x32x16_bf16 v[48:63], v[92:95], v[100:103], v[48:63]
 ds_read_b128 v[72:75], v7 offset:43008
 ds_read_b64 v[76:77], v3 offset:44032
 ds_read_b128 v[88:91], v2 offset:43008
 ds_read_b128 v[92:95], v2 offset:44032
 s_waitcnt lgkmcnt(2)
 v_mfma_f32_32x32x16_bf16 v[32:47], v[72:75], v[8:11], 0
 v_mfma_f32_32x32x16_bf16 v[32:47], v[76:79], v[12:15], v[32:47]
 v_max3_f32 v106, v16, v17, v18
 v_max3_f32 v106, v106, v19, v20
 v_max3_f32 v106, v106, v21, v22
 v_max3_f32 v106, v106, v23, v24
 v_max3_f32 v106, v106, v25, v26
 v_max3_f32 v106, v106, v27, v28
 v_max3_f32 v106, v106, v29, v30
 v_max_f32 v106, v106, v31
 v_mov_b32 v107, v106
 s_nop 1
 v_permlane32_swap_b32 v106, v107
 v_max3_f32 v106, v106, v107, v104
 v_sub_f32 v107, v104, v106
 v_exp_f32 v107, v107
 v_mov_b32 v104, v106
 v_sub_f32 v16, v16, v106
 v_sub_f32 v17, v17, v106
 v_sub_f32 v18, v18, v106
 v_sub_f32 v19, v19, v106
 v_sub_f32 v20, v20, v106
 v_sub_f32 v21, v21, v106
 v_sub_f32 v22, v22, v106
 v_sub_f32 v23, v23, v106
 v_sub_f32 v24, v24, v106
 v_sub_f32 v25, v25, v106
 v_sub_f32 v26, v26, v106
 v_sub_f32 v27, v27, v106
 v_sub_f32 v28, v28, v106
 v_sub_f32 v29, v29, v106
 v_sub_f32 v30, v30, v106
 v_sub_f32 v31, v31, v106
 v_mul_f32 v48, v48, v107
 v_mul_f32 v49, v49, v107
 v_mul_f32 v50, v50, v107
 v_mul_f32 v51, v51, v107
 v_mul_f32 v52, v52, v107
 v_mul_f32 v53, v53, v107
 v_mul_f32 v54, v54, v107
 v_mul_f32 v55, v55, v107
 v_mul_f32 v56, v56, v107
 v_mul_f32 v57, v57, v107
 v_mul_f32 v58, v58, v107
 v_mul_f32 v59, v59, v107
 v_exp_f32 v16, v16
 v_exp_f32 v17, v17
 v_exp_f32 v18, v18
 v_exp_f32 v19, v19
 v_exp_f32 v20, v20
 v_exp_f32 v21, v21
 v_exp_f32 v22, v22
 v_exp_f32 v23, v23
 v_exp_f32 v24, v24
 v_exp_f32 v25, v25
 v_exp_f32 v26, v26
 v_exp_f32 v27, v27
 v_exp_f32 v28, v28
 v_exp_f32 v29, v29
 v_exp_f32 v30, v30
 v_exp_f32 v31, v31
 s_nop 0
 v_cvt_pk_bf16_f32 v96, v16, v17
 v_cvt_pk_bf16_f32 v97, v18, v19
 v_cvt_pk_bf16_f32 v98, v20, v21
 v_cvt_pk_bf16_f32 v99, v22, v23
 v_cvt_pk_bf16_f32 v100, v24, v25
 v_cvt_pk_bf16_f32 v101, v26, v27
 v_cvt_pk_bf16_f32 v102, v28, v29
 v_cvt_pk_bf16_f32 v103, v30, v31
 s_nop 0
 v_mfma_f32_32x32x16_bf16 v[48:63], v[80:83], v[96:99], v[48:63]
 v_mfma_f32_32x32x16_bf16 v[48:63], v[84:87], v[100:103], v[48:63]
 ds_read_b128 v[64:67], v7 offset:45056
 ds_read_b64 v[68:69], v3 offset:46080
 ds_read_b128 v[80:83], v2 offset:45056
 ds_read_b128 v[84:87], v2 offset:46080
 s_waitcnt lgkmcnt(2)
 v_mfma_f32_32x32x16_bf16 v[16:31], v[64:67], v[8:11], 0
 v_mfma_f32_32x32x16_bf16 v[16:31], v[68:71], v[12:15], v[16:31]
 v_max3_f32 v106, v32, v33, v34
 v_max3_f32 v106, v106, v35, v36
 v_max3_f32 v106, v106, v37, v38
 v_max3_f32 v106, v106, v39, v40
 v_max3_f32 v106, v106, v41, v42
 v_max3_f32 v106, v106, v43, v44
 v_max3_f32 v106, v106, v45, v46
 v_max_f32 v106, v106, v47
 v_mov_b32 v107, v106
 s_nop 1
 v_permlane32_swap_b32 v106, v107
 v_max3_f32 v106, v106, v107, v104
 v_sub_f32 v107, v104, v106
 v_exp_f32 v107, v107
 v_mov_b32 v104, v106
 v_sub_f32 v32, v32, v106
 v_sub_f32 v33, v33, v106
 v_sub_f32 v34, v34, v106
 v_sub_f32 v35, v35, v106
 v_sub_f32 v36, v36, v106
 v_sub_f32 v37, v37, v106
 v_sub_f32 v38, v38, v106
 v_sub_f32 v39, v39, v106
 v_sub_f32 v40, v40, v106
 v_sub_f32 v41, v41, v106
 v_sub_f32 v42, v42, v106
 v_sub_f32 v43, v43, v106
 v_sub_f32 v44, v44, v106
 v_sub_f32 v45, v45, v106
 v_sub_f32 v46, v46, v106
 v_sub_f32 v47, v47, v106
 v_mul_f32 v48, v48, v107
 v_mul_f32 v49, v49, v107
 v_mul_f32 v50, v50, v107
 v_mul_f32 v51, v51, v107
 v_mul_f32 v52, v52, v107
 v_mul_f32 v53, v53, v107
 v_mul_f32 v54, v54, v107
 v_mul_f32 v55, v55, v107
 v_mul_f32 v56, v56, v107
 v_mul_f32 v57, v57, v107
 v_mul_f32 v58, v58, v107
 v_mul_f32 v59, v59, v107
 v_exp_f32 v32, v32
 v_exp_f32 v33, v33
 v_exp_f32 v34, v34
 v_exp_f32 v35, v35
 v_exp_f32 v36, v36
 v_exp_f32 v37, v37
 v_exp_f32 v38, v38
 v_exp_f32 v39, v39
 v_exp_f32 v40, v40
 v_exp_f32 v41, v41
 v_exp_f32 v42, v42
 v_exp_f32 v43, v43
 v_exp_f32 v44, v44
 v_exp_f32 v45, v45
 v_exp_f32 v46, v46
 v_exp_f32 v47, v47
 s_nop 0
 v_cvt_pk_bf16_f32 v96, v32, v33
 v_cvt_pk_bf16_f32 v97, v34, v35
 v_cvt_pk_bf16_f32 v98, v36, v37
 v_cvt_pk_bf16_f32 v99, v38, v39
 v_cvt_pk_bf16_f32 v100, v40, v41
 v_cvt_pk_bf16_f32 v101, v42, v43
 v_cvt_pk_bf16_f32 v102, v44, v45
 v_cvt_pk_bf16_f32 v103, v46, v47
 s_nop 0
 v_mfma_f32_32x32x16_bf16 v[48:63], v[88:91], v[96:99], v[48:63]
 v_mfma_f32_32x32x16_bf16 v[48:63], v[92:95], v[100:103], v[48:63]
 ds_read_b128 v[72:75], v7 offset:47104
 ds_read_b64 v[76:77], v3 offset:48128
 ds_read_b128 v[88:91], v2 offset:47104
 ds_read_b128 v[92:95], v2 offset:48128
 s_waitcnt lgkmcnt(2)
 v_mfma_f32_32x32x16_bf16 v[32:47], v[72:75], v[8:11], 0
 v_mfma_f32_32x32x16_bf16 v[32:47], v[76:79], v[12:15], v[32:47]
 v_max3_f32 v106, v16, v17, v18
 v_max3_f32 v106, v106, v19, v20
 v_max3_f32 v106, v106, v21, v22
 v_max3_f32 v106, v106, v23, v24
 v_max3_f32 v106, v106, v25, v26
 v_max3_f32 v106, v106, v27, v28
 v_max3_f32 v106, v106, v29, v30
 v_max_f32 v106, v106, v31
 v_mov_b32 v107, v106
 s_nop 1
 v_permlane32_swap_b32 v106, v107
 v_max3_f32 v106, v106, v107, v104
 v_sub_f32 v107, v104, v106
 v_exp_f32 v107, v107
 v_mov_b32 v104, v106
 v_sub_f32 v16, v16, v106
 v_sub_f32 v17, v17, v106
 v_sub_f32 v18, v18, v106
 v_sub_f32 v19, v19, v106
 v_sub_f32 v20, v20, v106
 v_sub_f32 v21, v21, v106
 v_sub_f32 v22, v22, v106
 v_sub_f32 v23, v23, v106
 v_sub_f32 v24, v24, v106
 v_sub_f32 v25, v25, v106
 v_sub_f32 v26, v26, v106
 v_sub_f32 v27, v27, v106
 v_sub_f32 v28, v28, v106
 v_sub_f32 v29, v29, v106
 v_sub_f32 v30, v30, v106
 v_sub_f32 v31, v31, v106
 v_mul_f32 v48, v48, v107
 v_mul_f32 v49, v49, v107
 v_mul_f32 v50, v50, v107
 v_mul_f32 v51, v51, v107
 v_mul_f32 v52, v52, v107
 v_mul_f32 v53, v53, v107
 v_mul_f32 v54, v54, v107
 v_mul_f32 v55, v55, v107
 v_mul_f32 v56, v56, v107
 v_mul_f32 v57, v57, v107
 v_mul_f32 v58, v58, v107
 v_mul_f32 v59, v59, v107
 v_exp_f32 v16, v16
 v_exp_f32 v17, v17
 v_exp_f32 v18, v18
 v_exp_f32 v19, v19
 v_exp_f32 v20, v20
 v_exp_f32 v21, v21
 v_exp_f32 v22, v22
 v_exp_f32 v23, v23
 v_exp_f32 v24, v24
 v_exp_f32 v25, v25
 v_exp_f32 v26, v26
 v_exp_f32 v27, v27
 v_exp_f32 v28, v28
 v_exp_f32 v29, v29
 v_exp_f32 v30, v30
 v_exp_f32 v31, v31
 s_nop 0
 v_cvt_pk_bf16_f32 v96, v16, v17
 v_cvt_pk_bf16_f32 v97, v18, v19
 v_cvt_pk_bf16_f32 v98, v20, v21
 v_cvt_pk_bf16_f32 v99, v22, v23
 v_cvt_pk_bf16_f32 v100, v24, v25
 v_cvt_pk_bf16_f32 v101, v26, v27
 v_cvt_pk_bf16_f32 v102, v28, v29
 v_cvt_pk_bf16_f32 v103, v30, v31
 s_nop 0
 v_mfma_f32_32x32x16_bf16 v[48:63], v[80:83], v[96:99], v[48:63]
 v_mfma_f32_32x32x16_bf16 v[48:63], v[84:87], v[100:103], v[48:63]
 s_nop 7
 v_max3_f32 v106, v32, v33, v34
 v_max3_f32 v106, v106, v35, v36
 v_max3_f32 v106, v106, v37, v38
 v_max3_f32 v106, v106, v39, v40
 v_max3_f32 v106, v106, v41, v42
 v_max3_f32 v106, v106, v43, v44
 v_max3_f32 v106, v106, v45, v46
 v_max_f32 v106, v106, v47
 v_mov_b32 v107, v106
 s_nop 1
 v_permlane32_swap_b32 v106, v107
 v_max3_f32 v106, v106, v107, v104
 v_sub_f32 v107, v104, v106
 v_exp_f32 v107, v107
 v_mov_b32 v104, v106
 v_sub_f32 v32, v32, v106
 v_sub_f32 v33, v33, v106
 v_sub_f32 v34, v34, v106
 v_sub_f32 v35, v35, v106
 v_sub_f32 v36, v36, v106
 v_sub_f32 v37, v37, v106
 v_sub_f32 v38, v38, v106
 v_sub_f32 v39, v39, v106
 v_sub_f32 v40, v40, v106
 v_sub_f32 v41, v41, v106
 v_sub_f32 v42, v42, v106
 v_sub_f32 v43, v43, v106
 v_sub_f32 v44, v44, v106
 v_sub_f32 v45, v45, v106
 v_sub_f32 v46, v46, v106
 v_sub_f32 v47, v47, v106
 v_mul_f32 v48, v48, v107
 v_mul_f32 v49, v49, v107
 v_mul_f32 v50, v50, v107
 v_mul_f32 v51, v51, v107
 v_mul_f32 v52, v52, v107
 v_mul_f32 v53, v53, v107
 v_mul_f32 v54, v54, v107
 v_mul_f32 v55, v55, v107
 v_mul_f32 v56, v56, v107
 v_mul_f32 v57, v57, v107
 v_mul_f32 v58, v58, v107
 v_mul_f32 v59, v59, v107
 v_exp_f32 v32, v32
 v_exp_f32 v33, v33
 v_exp_f32 v34, v34
 v_exp_f32 v35, v35
 v_exp_f32 v36, v36
 v_exp_f32 v37, v37
 v_exp_f32 v38, v38
 v_exp_f32 v39, v39
 v_exp_f32 v40, v40
 v_exp_f32 v41, v41
 v_exp_f32 v42, v42
 v_exp_f32 v43, v43
 v_exp_f32 v44, v44
 v_exp_f32 v45, v45
 v_exp_f32 v46, v46
 v_exp_f32 v47, v47
 s_nop 0
 v_cvt_pk_bf16_f32 v96, v32, v33
 v_cvt_pk_bf16_f32 v97, v34, v35
 v_cvt_pk_bf16_f32 v98, v36, v37
 v_cvt_pk_bf16_f32 v99, v38, v39
 v_cvt_pk_bf16_f32 v100, v40, v41
 v_cvt_pk_bf16_f32 v101, v42, v43
 v_cvt_pk_bf16_f32 v102, v44, v45
 v_cvt_pk_bf16_f32 v103, v46, v47
 s_waitcnt lgkmcnt(0)
 s_nop 0
 v_mfma_f32_32x32x16_bf16 v[48:63], v[88:91], v[96:99], v[48:63]
 v_mfma_f32_32x32x16_bf16 v[48:63], v[92:95], v[100:103], v[48:63]
 s_waitcnt vmcnt(0)
 v_cndmask_b32 v120, v120, v5, s[26:27]
 v_cndmask_b32 v121, v121, v5, s[26:27]
 v_cndmask_b32 v122, v122, v5, s[26:27]
 v_cndmask_b32 v123, v123, v5, s[26:27]
 v_cndmask_b32 v124, v124, v5, s[26:27]
 v_cndmask_b32 v125, v125, v5, s[26:27]
 v_cndmask_b32 v126, v126, v5, s[26:27]
 v_cndmask_b32 v127, v127, v5, s[26:27]
 ds_write_b128 v4, v[112:115] offset:0
 ds_write_b128 v4, v[116:119] offset:8192
 ds_write_b128 v4, v[120:123] offset:16384
 ds_write_b128 v4, v[124:127] offset:24576
 s_waitcnt lgkmcnt(0)
 s_barrier
 s_mov_b32 s28, 49152
 s_mov_b32 s29, 4243456
 buffer_load_dwordx4 v[112:115], v4, s[12:15], s28 offen offset:0
 buffer_load_dwordx4 v[116:119], v6, s[12:15], s28 offen
 buffer_load_dwordx4 v[120:123], v4, s[12:15], s29 offen
 buffer_load_dwordx4 v[124:127], v6, s[12:15], s29 offen
 ds_read_b128 v[64:67], v7 offset:0
 ds_read_b64 v[68:69], v3 offset:1024
 ds_read_b128 v[80:83], v2 offset:0
 ds_read_b128 v[84:87], v2 offset:1024
 s_waitcnt lgkmcnt(2)
 v_mfma_f32_32x32x16_bf16 v[16:31], v[64:67], v[8:11], 0
 v_mfma_f32_32x32x16_bf16 v[16:31], v[68:71], v[12:15], v[16:31]
 ds_read_b128 v[72:75], v7 offset:2048
 ds_read_b64 v[76:77], v3 offset:3072
 ds_read_b128 v[88:91], v2 offset:2048
 ds_read_b128 v[92:95], v2 offset:3072
 s_waitcnt lgkmcnt(2)
 v_mfma_f32_32x32x16_bf16 v[32:47], v[72:75], v[8:11], 0
 v_mfma_f32_32x32x16_bf16 v[32:47], v[76:79], v[12:15], v[32:47]
 v_max3_f32 v106, v16, v17, v18
 v_max3_f32 v106, v106, v19, v20
 v_max3_f32 v106, v106, v21, v22
 v_max3_f32 v106, v106, v23, v24
 v_max3_f32 v106, v106, v25, v26
 v_max3_f32 v106, v106, v27, v28
 v_max3_f32 v106, v106, v29, v30
 v_max_f32 v106, v106, v31
 v_mov_b32 v107, v106
 s_nop 1
 v_permlane32_swap_b32 v106, v107
 v_max3_f32 v106, v106, v107, v104
 v_sub_f32 v107, v104, v106
 v_exp_f32 v107, v107
 v_mov_b32 v104, v106
 v_sub_f32 v16, v16, v106
 v_sub_f32 v17, v17, v106
 v_sub_f32 v18, v18, v106
 v_sub_f32 v19, v19, v106
 v_sub_f32 v20, v20, v106
 v_sub_f32 v21, v21, v106
 v_sub_f32 v22, v22, v106
 v_sub_f32 v23, v23, v106
 v_sub_f32 v24, v24, v106
 v_sub_f32 v25, v25, v106
 v_sub_f32 v26, v26, v106
 v_sub_f32 v27, v27, v106
 v_sub_f32 v28, v28, v106
 v_sub_f32 v29, v29, v106
 v_sub_f32 v30, v30, v106
 v_sub_f32 v31, v31, v106
 v_mul_f32 v48, v48, v107
 v_mul_f32 v49, v49, v107
 v_mul_f32 v50, v50, v107
 v_mul_f32 v51, v51, v107
 v_mul_f32 v52, v52, v107
 v_mul_f32 v53, v53, v107
 v_mul_f32 v54, v54, v107
 v_mul_f32 v55, v55, v107
 v_mul_f32 v56, v56, v107
 v_mul_f32 v57, v57, v107
 v_mul_f32 v58, v58, v107
 v_mul_f32 v59, v59, v107
 v_exp_f32 v16, v16
 v_exp_f32 v17, v17
 v_exp_f32 v18, v18
 v_exp_f32 v19, v19
 v_exp_f32 v20, v20
 v_exp_f32 v21, v21
 v_exp_f32 v22, v22
 v_exp_f32 v23, v23
 v_exp_f32 v24, v24
 v_exp_f32 v25, v25
 v_exp_f32 v26, v26
 v_exp_f32 v27, v27
 v_exp_f32 v28, v28
 v_exp_f32 v29, v29
 v_exp_f32 v30, v30
 v_exp_f32 v31, v31
 s_nop 0
 v_cvt_pk_bf16_f32 v96, v16, v17
 v_cvt_pk_bf16_f32 v97, v18, v19
 v_cvt_pk_bf16_f32 v98, v20, v21
 v_cvt_pk_bf16_f32 v99, v22, v23
 v_cvt_pk_bf16_f32 v100, v24, v25
 v_cvt_pk_bf16_f32 v101, v26, v27
 v_cvt_pk_bf16_f32 v102, v28, v29
 v_cvt_pk_bf16_f32 v103, v30, v31
 s_nop 0
 v_mfma_f32_32x32x16_bf16 v[48:63], v[80:83], v[96:99], v[48:63]
 v_mfma_f32_32x32x16_bf16 v[48:63], v[84:87], v[100:103], v[48:63]
 ds_read_b128 v[64:67], v7 offset:4096
 ds_read_b64 v[68:69], v3 offset:5120
 ds_read_b128 v[80:83], v2 offset:4096
 ds_read_b128 v[84:87], v2 offset:5120
 s_waitcnt lgkmcnt(2)
 v_mfma_f32_32x32x16_bf16 v[16:31], v[64:67], v[8:11], 0
 v_mfma_f32_32x32x16_bf16 v[16:31], v[68:71], v[12:15], v[16:31]
 v_max3_f32 v106, v32, v33, v34
 v_max3_f32 v106, v106, v35, v36
 v_max3_f32 v106, v106, v37, v38
 v_max3_f32 v106, v106, v39, v40
 v_max3_f32 v106, v106, v41, v42
 v_max3_f32 v106, v106, v43, v44
 v_max3_f32 v106, v106, v45, v46
 v_max_f32 v106, v106, v47
 v_mov_b32 v107, v106
 s_nop 1
 v_permlane32_swap_b32 v106, v107
 v_max3_f32 v106, v106, v107, v104
 v_sub_f32 v107, v104, v106
 v_exp_f32 v107, v107
 v_mov_b32 v104, v106
 v_sub_f32 v32, v32, v106
 v_sub_f32 v33, v33, v106
 v_sub_f32 v34, v34, v106
 v_sub_f32 v35, v35, v106
 v_sub_f32 v36, v36, v106
 v_sub_f32 v37, v37, v106
 v_sub_f32 v38, v38, v106
 v_sub_f32 v39, v39, v106
 v_sub_f32 v40, v40, v106
 v_sub_f32 v41, v41, v106
 v_sub_f32 v42, v42, v106
 v_sub_f32 v43, v43, v106
 v_sub_f32 v44, v44, v106
 v_sub_f32 v45, v45, v106
 v_sub_f32 v46, v46, v106
 v_sub_f32 v47, v47, v106
 v_mul_f32 v48, v48, v107
 v_mul_f32 v49, v49, v107
 v_mul_f32 v50, v50, v107
 v_mul_f32 v51, v51, v107
 v_mul_f32 v52, v52, v107
 v_mul_f32 v53, v53, v107
 v_mul_f32 v54, v54, v107
 v_mul_f32 v55, v55, v107
 v_mul_f32 v56, v56, v107
 v_mul_f32 v57, v57, v107
 v_mul_f32 v58, v58, v107
 v_mul_f32 v59, v59, v107
 v_exp_f32 v32, v32
 v_exp_f32 v33, v33
 v_exp_f32 v34, v34
 v_exp_f32 v35, v35
 v_exp_f32 v36, v36
 v_exp_f32 v37, v37
 v_exp_f32 v38, v38
 v_exp_f32 v39, v39
 v_exp_f32 v40, v40
 v_exp_f32 v41, v41
 v_exp_f32 v42, v42
 v_exp_f32 v43, v43
 v_exp_f32 v44, v44
 v_exp_f32 v45, v45
 v_exp_f32 v46, v46
 v_exp_f32 v47, v47
 s_nop 0
 v_cvt_pk_bf16_f32 v96, v32, v33
 v_cvt_pk_bf16_f32 v97, v34, v35
 v_cvt_pk_bf16_f32 v98, v36, v37
 v_cvt_pk_bf16_f32 v99, v38, v39
 v_cvt_pk_bf16_f32 v100, v40, v41
 v_cvt_pk_bf16_f32 v101, v42, v43
 v_cvt_pk_bf16_f32 v102, v44, v45
 v_cvt_pk_bf16_f32 v103, v46, v47
 s_nop 0
 v_mfma_f32_32x32x16_bf16 v[48:63], v[88:91], v[96:99], v[48:63]
 v_mfma_f32_32x32x16_bf16 v[48:63], v[92:95], v[100:103], v[48:63]
 ds_read_b128 v[72:75], v7 offset:6144
 ds_read_b64 v[76:77], v3 offset:7168
 ds_read_b128 v[88:91], v2 offset:6144
 ds_read_b128 v[92:95], v2 offset:7168
 s_waitcnt lgkmcnt(2)
 v_mfma_f32_32x32x16_bf16 v[32:47], v[72:75], v[8:11], 0
 v_mfma_f32_32x32x16_bf16 v[32:47], v[76:79], v[12:15], v[32:47]
 v_max3_f32 v106, v16, v17, v18
 v_max3_f32 v106, v106, v19, v20
 v_max3_f32 v106, v106, v21, v22
 v_max3_f32 v106, v106, v23, v24
 v_max3_f32 v106, v106, v25, v26
 v_max3_f32 v106, v106, v27, v28
 v_max3_f32 v106, v106, v29, v30
 v_max_f32 v106, v106, v31
 v_mov_b32 v107, v106
 s_nop 1
 v_permlane32_swap_b32 v106, v107
 v_max3_f32 v106, v106, v107, v104
 v_sub_f32 v107, v104, v106
 v_exp_f32 v107, v107
 v_mov_b32 v104, v106
 v_sub_f32 v16, v16, v106
 v_sub_f32 v17, v17, v106
 v_sub_f32 v18, v18, v106
 v_sub_f32 v19, v19, v106
 v_sub_f32 v20, v20, v106
 v_sub_f32 v21, v21, v106
 v_sub_f32 v22, v22, v106
 v_sub_f32 v23, v23, v106
 v_sub_f32 v24, v24, v106
 v_sub_f32 v25, v25, v106
 v_sub_f32 v26, v26, v106
 v_sub_f32 v27, v27, v106
 v_sub_f32 v28, v28, v106
 v_sub_f32 v29, v29, v106
 v_sub_f32 v30, v30, v106
 v_sub_f32 v31, v31, v106
 v_mul_f32 v48, v48, v107
 v_mul_f32 v49, v49, v107
 v_mul_f32 v50, v50, v107
 v_mul_f32 v51, v51, v107
 v_mul_f32 v52, v52, v107
 v_mul_f32 v53, v53, v107
 v_mul_f32 v54, v54, v107
 v_mul_f32 v55, v55, v107
 v_mul_f32 v56, v56, v107
 v_mul_f32 v57, v57, v107
 v_mul_f32 v58, v58, v107
 v_mul_f32 v59, v59, v107
 v_exp_f32 v16, v16
 v_exp_f32 v17, v17
 v_exp_f32 v18, v18
 v_exp_f32 v19, v19
 v_exp_f32 v20, v20
 v_exp_f32 v21, v21
 v_exp_f32 v22, v22
 v_exp_f32 v23, v23
 v_exp_f32 v24, v24
 v_exp_f32 v25, v25
 v_exp_f32 v26, v26
 v_exp_f32 v27, v27
 v_exp_f32 v28, v28
 v_exp_f32 v29, v29
 v_exp_f32 v30, v30
 v_exp_f32 v31, v31
 s_nop 0
 v_cvt_pk_bf16_f32 v96, v16, v17
 v_cvt_pk_bf16_f32 v97, v18, v19
 v_cvt_pk_bf16_f32 v98, v20, v21
 v_cvt_pk_bf16_f32 v99, v22, v23
 v_cvt_pk_bf16_f32 v100, v24, v25
 v_cvt_pk_bf16_f32 v101, v26, v27
 v_cvt_pk_bf16_f32 v102, v28, v29
 v_cvt_pk_bf16_f32 v103, v30, v31
 s_nop 0
 v_mfma_f32_32x32x16_bf16 v[48:63], v[80:83], v[96:99], v[48:63]
 v_mfma_f32_32x32x16_bf16 v[48:63], v[84:87], v[100:103], v[48:63]
 ds_read_b128 v[64:67], v7 offset:8192
 ds_read_b64 v[68:69], v3 offset:9216
 ds_read_b128 v[80:83], v2 offset:8192
 ds_read_b128 v[84:87], v2 offset:9216
 s_waitcnt lgkmcnt(2)
 v_mfma_f32_32x32x16_bf16 v[16:31], v[64:67], v[8:11], 0
 v_mfma_f32_32x32x16_bf16 v[16:31], v[68:71], v[12:15], v[16:31]
 v_max3_f32 v106, v32, v33, v34
 v_max3_f32 v106, v106, v35, v36
 v_max3_f32 v106, v106, v37, v38
 v_max3_f32 v106, v106, v39, v40
 v_max3_f32 v106, v106, v41, v42
 v_max3_f32 v106, v106, v43, v44
 v_max3_f32 v106, v106, v45, v46
 v_max_f32 v106, v106, v47
 v_mov_b32 v107, v106
 s_nop 1
 v_permlane32_swap_b32 v106, v107
 v_max3_f32 v106, v106, v107, v104
 v_sub_f32 v107, v104, v106
 v_exp_f32 v107, v107
 v_mov_b32 v104, v106
 v_sub_f32 v32, v32, v106
 v_sub_f32 v33, v33, v106
 v_sub_f32 v34, v34, v106
 v_sub_f32 v35, v35, v106
 v_sub_f32 v36, v36, v106
 v_sub_f32 v37, v37, v106
 v_sub_f32 v38, v38, v106
 v_sub_f32 v39, v39, v106
 v_sub_f32 v40, v40, v106
 v_sub_f32 v41, v41, v106
 v_sub_f32 v42, v42, v106
 v_sub_f32 v43, v43, v106
 v_sub_f32 v44, v44, v106
 v_sub_f32 v45, v45, v106
 v_sub_f32 v46, v46, v106
 v_sub_f32 v47, v47, v106
 v_mul_f32 v48, v48, v107
 v_mul_f32 v49, v49, v107
 v_mul_f32 v50, v50, v107
 v_mul_f32 v51, v51, v107
 v_mul_f32 v52, v52, v107
 v_mul_f32 v53, v53, v107
 v_mul_f32 v54, v54, v107
 v_mul_f32 v55, v55, v107
 v_mul_f32 v56, v56, v107
 v_mul_f32 v57, v57, v107
 v_mul_f32 v58, v58, v107
 v_mul_f32 v59, v59, v107
 v_exp_f32 v32, v32
 v_exp_f32 v33, v33
 v_exp_f32 v34, v34
 v_exp_f32 v35, v35
 v_exp_f32 v36, v36
 v_exp_f32 v37, v37
 v_exp_f32 v38, v38
 v_exp_f32 v39, v39
 v_exp_f32 v40, v40
 v_exp_f32 v41, v41
 v_exp_f32 v42, v42
 v_exp_f32 v43, v43
 v_exp_f32 v44, v44
 v_exp_f32 v45, v45
 v_exp_f32 v46, v46
 v_exp_f32 v47, v47
 s_nop 0
 v_cvt_pk_bf16_f32 v96, v32, v33
 v_cvt_pk_bf16_f32 v97, v34, v35
 v_cvt_pk_bf16_f32 v98, v36, v37
 v_cvt_pk_bf16_f32 v99, v38, v39
 v_cvt_pk_bf16_f32 v100, v40, v41
 v_cvt_pk_bf16_f32 v101, v42, v43
 v_cvt_pk_bf16_f32 v102, v44, v45
 v_cvt_pk_bf16_f32 v103, v46, v47
 s_nop 0
 v_mfma_f32_32x32x16_bf16 v[48:63], v[88:91], v[96:99], v[48:63]
 v_mfma_f32_32x32x16_bf16 v[48:63], v[92:95], v[100:103], v[48:63]
 ds_read_b128 v[72:75], v7 offset:10240
 ds_read_b64 v[76:77], v3 offset:11264
 ds_read_b128 v[88:91], v2 offset:10240
 ds_read_b128 v[92:95], v2 offset:11264
 s_waitcnt lgkmcnt(2)
 v_mfma_f32_32x32x16_bf16 v[32:47], v[72:75], v[8:11], 0
 v_mfma_f32_32x32x16_bf16 v[32:47], v[76:79], v[12:15], v[32:47]
 v_max3_f32 v106, v16, v17, v18
 v_max3_f32 v106, v106, v19, v20
 v_max3_f32 v106, v106, v21, v22
 v_max3_f32 v106, v106, v23, v24
 v_max3_f32 v106, v106, v25, v26
 v_max3_f32 v106, v106, v27, v28
 v_max3_f32 v106, v106, v29, v30
 v_max_f32 v106, v106, v31
 v_mov_b32 v107, v106
 s_nop 1
 v_permlane32_swap_b32 v106, v107
 v_max3_f32 v106, v106, v107, v104
 v_sub_f32 v107, v104, v106
 v_exp_f32 v107, v107
 v_mov_b32 v104, v106
 v_sub_f32 v16, v16, v106
 v_sub_f32 v17, v17, v106
 v_sub_f32 v18, v18, v106
 v_sub_f32 v19, v19, v106
 v_sub_f32 v20, v20, v106
 v_sub_f32 v21, v21, v106
 v_sub_f32 v22, v22, v106
 v_sub_f32 v23, v23, v106
 v_sub_f32 v24, v24, v106
 v_sub_f32 v25, v25, v106
 v_sub_f32 v26, v26, v106
 v_sub_f32 v27, v27, v106
 v_sub_f32 v28, v28, v106
 v_sub_f32 v29, v29, v106
 v_sub_f32 v30, v30, v106
 v_sub_f32 v31, v31, v106
 v_mul_f32 v48, v48, v107
 v_mul_f32 v49, v49, v107
 v_mul_f32 v50, v50, v107
 v_mul_f32 v51, v51, v107
 v_mul_f32 v52, v52, v107
 v_mul_f32 v53, v53, v107
 v_mul_f32 v54, v54, v107
 v_mul_f32 v55, v55, v107
 v_mul_f32 v56, v56, v107
 v_mul_f32 v57, v57, v107
 v_mul_f32 v58, v58, v107
 v_mul_f32 v59, v59, v107
 v_exp_f32 v16, v16
 v_exp_f32 v17, v17
 v_exp_f32 v18, v18
 v_exp_f32 v19, v19
 v_exp_f32 v20, v20
 v_exp_f32 v21, v21
 v_exp_f32 v22, v22
 v_exp_f32 v23, v23
 v_exp_f32 v24, v24
 v_exp_f32 v25, v25
 v_exp_f32 v26, v26
 v_exp_f32 v27, v27
 v_exp_f32 v28, v28
 v_exp_f32 v29, v29
 v_exp_f32 v30, v30
 v_exp_f32 v31, v31
 s_nop 0
 v_cvt_pk_bf16_f32 v96, v16, v17
 v_cvt_pk_bf16_f32 v97, v18, v19
 v_cvt_pk_bf16_f32 v98, v20, v21
 v_cvt_pk_bf16_f32 v99, v22, v23
 v_cvt_pk_bf16_f32 v100, v24, v25
 v_cvt_pk_bf16_f32 v101, v26, v27
 v_cvt_pk_bf16_f32 v102, v28, v29
 v_cvt_pk_bf16_f32 v103, v30, v31
 s_nop 0
 v_mfma_f32_32x32x16_bf16 v[48:63], v[80:83], v[96:99], v[48:63]
 v_mfma_f32_32x32x16_bf16 v[48:63], v[84:87], v[100:103], v[48:63]
 ds_read_b128 v[64:67], v7 offset:12288
 ds_read_b64 v[68:69], v3 offset:13312
 ds_read_b128 v[80:83], v2 offset:12288
 ds_read_b128 v[84:87], v2 offset:13312
 s_waitcnt lgkmcnt(2)
 v_mfma_f32_32x32x16_bf16 v[16:31], v[64:67], v[8:11], 0
 v_mfma_f32_32x32x16_bf16 v[16:31], v[68:71], v[12:15], v[16:31]
 v_max3_f32 v106, v32, v33, v34
 v_max3_f32 v106, v106, v35, v36
 v_max3_f32 v106, v106, v37, v38
 v_max3_f32 v106, v106, v39, v40
 v_max3_f32 v106, v106, v41, v42
 v_max3_f32 v106, v106, v43, v44
 v_max3_f32 v106, v106, v45, v46
 v_max_f32 v106, v106, v47
 v_mov_b32 v107, v106
 s_nop 1
 v_permlane32_swap_b32 v106, v107
 v_max3_f32 v106, v106, v107, v104
 v_sub_f32 v107, v104, v106
 v_exp_f32 v107, v107
 v_mov_b32 v104, v106
 v_sub_f32 v32, v32, v106
 v_sub_f32 v33, v33, v106
 v_sub_f32 v34, v34, v106
 v_sub_f32 v35, v35, v106
 v_sub_f32 v36, v36, v106
 v_sub_f32 v37, v37, v106
 v_sub_f32 v38, v38, v106
 v_sub_f32 v39, v39, v106
 v_sub_f32 v40, v40, v106
 v_sub_f32 v41, v41, v106
 v_sub_f32 v42, v42, v106
 v_sub_f32 v43, v43, v106
 v_sub_f32 v44, v44, v106
 v_sub_f32 v45, v45, v106
 v_sub_f32 v46, v46, v106
 v_sub_f32 v47, v47, v106
 v_mul_f32 v48, v48, v107
 v_mul_f32 v49, v49, v107
 v_mul_f32 v50, v50, v107
 v_mul_f32 v51, v51, v107
 v_mul_f32 v52, v52, v107
 v_mul_f32 v53, v53, v107
 v_mul_f32 v54, v54, v107
 v_mul_f32 v55, v55, v107
 v_mul_f32 v56, v56, v107
 v_mul_f32 v57, v57, v107
 v_mul_f32 v58, v58, v107
 v_mul_f32 v59, v59, v107
 v_exp_f32 v32, v32
 v_exp_f32 v33, v33
 v_exp_f32 v34, v34
 v_exp_f32 v35, v35
 v_exp_f32 v36, v36
 v_exp_f32 v37, v37
 v_exp_f32 v38, v38
 v_exp_f32 v39, v39
 v_exp_f32 v40, v40
 v_exp_f32 v41, v41
 v_exp_f32 v42, v42
 v_exp_f32 v43, v43
 v_exp_f32 v44, v44
 v_exp_f32 v45, v45
 v_exp_f32 v46, v46
 v_exp_f32 v47, v47
 s_nop 0
 v_cvt_pk_bf16_f32 v96, v32, v33
 v_cvt_pk_bf16_f32 v97, v34, v35
 v_cvt_pk_bf16_f32 v98, v36, v37
 v_cvt_pk_bf16_f32 v99, v38, v39
 v_cvt_pk_bf16_f32 v100, v40, v41
 v_cvt_pk_bf16_f32 v101, v42, v43
 v_cvt_pk_bf16_f32 v102, v44, v45
 v_cvt_pk_bf16_f32 v103, v46, v47
 s_nop 0
 v_mfma_f32_32x32x16_bf16 v[48:63], v[88:91], v[96:99], v[48:63]
 v_mfma_f32_32x32x16_bf16 v[48:63], v[92:95], v[100:103], v[48:63]
 ds_read_b128 v[72:75], v7 offset:14336
 ds_read_b64 v[76:77], v3 offset:15360
 ds_read_b128 v[88:91], v2 offset:14336
 ds_read_b128 v[92:95], v2 offset:15360
 s_waitcnt lgkmcnt(2)
 v_mfma_f32_32x32x16_bf16 v[32:47], v[72:75], v[8:11], 0
 v_mfma_f32_32x32x16_bf16 v[32:47], v[76:79], v[12:15], v[32:47]
 v_max3_f32 v106, v16, v17, v18
 v_max3_f32 v106, v106, v19, v20
 v_max3_f32 v106, v106, v21, v22
 v_max3_f32 v106, v106, v23, v24
 v_max3_f32 v106, v106, v25, v26
 v_max3_f32 v106, v106, v27, v28
 v_max3_f32 v106, v106, v29, v30
 v_max_f32 v106, v106, v31
 v_mov_b32 v107, v106
 s_nop 1
 v_permlane32_swap_b32 v106, v107
 v_max3_f32 v106, v106, v107, v104
 v_sub_f32 v107, v104, v106
 v_exp_f32 v107, v107
 v_mov_b32 v104, v106
 v_sub_f32 v16, v16, v106
 v_sub_f32 v17, v17, v106
 v_sub_f32 v18, v18, v106
 v_sub_f32 v19, v19, v106
 v_sub_f32 v20, v20, v106
 v_sub_f32 v21, v21, v106
 v_sub_f32 v22, v22, v106
 v_sub_f32 v23, v23, v106
 v_sub_f32 v24, v24, v106
 v_sub_f32 v25, v25, v106
 v_sub_f32 v26, v26, v106
 v_sub_f32 v27, v27, v106
 v_sub_f32 v28, v28, v106
 v_sub_f32 v29, v29, v106
 v_sub_f32 v30, v30, v106
 v_sub_f32 v31, v31, v106
 v_mul_f32 v48, v48, v107
 v_mul_f32 v49, v49, v107
 v_mul_f32 v50, v50, v107
 v_mul_f32 v51, v51, v107
 v_mul_f32 v52, v52, v107
 v_mul_f32 v53, v53, v107
 v_mul_f32 v54, v54, v107
 v_mul_f32 v55, v55, v107
 v_mul_f32 v56, v56, v107
 v_mul_f32 v57, v57, v107
 v_mul_f32 v58, v58, v107
 v_mul_f32 v59, v59, v107
 v_exp_f32 v16, v16
 v_exp_f32 v17, v17
 v_exp_f32 v18, v18
 v_exp_f32 v19, v19
 v_exp_f32 v20, v20
 v_exp_f32 v21, v21
 v_exp_f32 v22, v22
 v_exp_f32 v23, v23
 v_exp_f32 v24, v24
 v_exp_f32 v25, v25
 v_exp_f32 v26, v26
 v_exp_f32 v27, v27
 v_exp_f32 v28, v28
 v_exp_f32 v29, v29
 v_exp_f32 v30, v30
 v_exp_f32 v31, v31
 s_nop 0
 v_cvt_pk_bf16_f32 v96, v16, v17
 v_cvt_pk_bf16_f32 v97, v18, v19
 v_cvt_pk_bf16_f32 v98, v20, v21
 v_cvt_pk_bf16_f32 v99, v22, v23
 v_cvt_pk_bf16_f32 v100, v24, v25
 v_cvt_pk_bf16_f32 v101, v26, v27
 v_cvt_pk_bf16_f32 v102, v28, v29
 v_cvt_pk_bf16_f32 v103, v30, v31
 s_nop 0
 v_mfma_f32_32x32x16_bf16 v[48:63], v[80:83], v[96:99], v[48:63]
 v_mfma_f32_32x32x16_bf16 v[48:63], v[84:87], v[100:103], v[48:63]
 s_nop 7
 v_max3_f32 v106, v32, v33, v34
 v_max3_f32 v106, v106, v35, v36
 v_max3_f32 v106, v106, v37, v38
 v_max3_f32 v106, v106, v39, v40
 v_max3_f32 v106, v106, v41, v42
 v_max3_f32 v106, v106, v43, v44
 v_max3_f32 v106, v106, v45, v46
 v_max_f32 v106, v106, v47
 v_mov_b32 v107, v106
 s_nop 1
 v_permlane32_swap_b32 v106, v107
 v_max3_f32 v106, v106, v107, v104
 v_sub_f32 v107, v104, v106
 v_exp_f32 v107, v107
 v_mov_b32 v104, v106
 v_sub_f32 v32, v32, v106
 v_sub_f32 v33, v33, v106
 v_sub_f32 v34, v34, v106
 v_sub_f32 v35, v35, v106
 v_sub_f32 v36, v36, v106
 v_sub_f32 v37, v37, v106
 v_sub_f32 v38, v38, v106
 v_sub_f32 v39, v39, v106
 v_sub_f32 v40, v40, v106
 v_sub_f32 v41, v41, v106
 v_sub_f32 v42, v42, v106
 v_sub_f32 v43, v43, v106
 v_sub_f32 v44, v44, v106
 v_sub_f32 v45, v45, v106
 v_sub_f32 v46, v46, v106
 v_sub_f32 v47, v47, v106
 v_mul_f32 v48, v48, v107
 v_mul_f32 v49, v49, v107
 v_mul_f32 v50, v50, v107
 v_mul_f32 v51, v51, v107
 v_mul_f32 v52, v52, v107
 v_mul_f32 v53, v53, v107
 v_mul_f32 v54, v54, v107
 v_mul_f32 v55, v55, v107
 v_mul_f32 v56, v56, v107
 v_mul_f32 v57, v57, v107
 v_mul_f32 v58, v58, v107
 v_mul_f32 v59, v59, v107
 v_exp_f32 v32, v32
 v_exp_f32 v33, v33
 v_exp_f32 v34, v34
 v_exp_f32 v35, v35
 v_exp_f32 v36, v36
 v_exp_f32 v37, v37
 v_exp_f32 v38, v38
 v_exp_f32 v39, v39
 v_exp_f32 v40, v40
 v_exp_f32 v41, v41
 v_exp_f32 v42, v42
 v_exp_f32 v43, v43
 v_exp_f32 v44, v44
 v_exp_f32 v45, v45
 v_exp_f32 v46, v46
 v_exp_f32 v47, v47
 s_nop 0
 v_cvt_pk_bf16_f32 v96, v32, v33
 v_cvt_pk_bf16_f32 v97, v34, v35
 v_cvt_pk_bf16_f32 v98, v36, v37
 v_cvt_pk_bf16_f32 v99, v38, v39
 v_cvt_pk_bf16_f32 v100, v40, v41
 v_cvt_pk_bf16_f32 v101, v42, v43
 v_cvt_pk_bf16_f32 v102, v44, v45
 v_cvt_pk_bf16_f32 v103, v46, v47
 s_waitcnt lgkmcnt(0)
 s_nop 0
 v_mfma_f32_32x32x16_bf16 v[48:63], v[88:91], v[96:99], v[48:63]
 v_mfma_f32_32x32x16_bf16 v[48:63], v[92:95], v[100:103], v[48:63]
 s_waitcnt vmcnt(0)
 v_cndmask_b32 v120, v120, v5, s[26:27]
 v_cndmask_b32 v121, v121, v5, s[26:27]
 v_cndmask_b32 v122, v122, v5, s[26:27]
 v_cndmask_b32 v123, v123, v5, s[26:27]
 v_cndmask_b32 v124, v124, v5, s[26:27]
 v_cndmask_b32 v125, v125, v5, s[26:27]
 v_cndmask_b32 v126, v126, v5, s[26:27]
 v_cndmask_b32 v127, v127, v5, s[26:27]
 ds_write_b128 v4, v[112:115] offset:32768
 ds_write_b128 v4, v[116:119] offset:40960
 ds_write_b128 v4, v[120:123] offset:49152
 ds_write_b128 v4, v[124:127] offset:57344
 s_waitcnt lgkmcnt(0)
 s_barrier
 s_mov_b32 s28, 65536
 s_mov_b32 s29, 4259840
 buffer_load_dwordx4 v[112:115], v4, s[12:15], s28 offen offset:0
 buffer_load_dwordx4 v[116:119], v6, s[12:15], s28 offen
 buffer_load_dwordx4 v[120:123], v4, s[12:15], s29 offen
 buffer_load_dwordx4 v[124:127], v6, s[12:15], s29 offen
 ds_read_b128 v[64:67], v7 offset:32768
 ds_read_b64 v[68:69], v3 offset:33792
 ds_read_b128 v[80:83], v2 offset:32768
 ds_read_b128 v[84:87], v2 offset:33792
 s_waitcnt lgkmcnt(2)
 v_mfma_f32_32x32x16_bf16 v[16:31], v[64:67], v[8:11], 0
 v_mfma_f32_32x32x16_bf16 v[16:31], v[68:71], v[12:15], v[16:31]
 ds_read_b128 v[72:75], v7 offset:34816
 ds_read_b64 v[76:77], v3 offset:35840
 ds_read_b128 v[88:91], v2 offset:34816
 ds_read_b128 v[92:95], v2 offset:35840
 s_waitcnt lgkmcnt(2)
 v_mfma_f32_32x32x16_bf16 v[32:47], v[72:75], v[8:11], 0
 v_mfma_f32_32x32x16_bf16 v[32:47], v[76:79], v[12:15], v[32:47]
 v_max3_f32 v106, v16, v17, v18
 v_max3_f32 v106, v106, v19, v20
 v_max3_f32 v106, v106, v21, v22
 v_max3_f32 v106, v106, v23, v24
 v_max3_f32 v106, v106, v25, v26
 v_max3_f32 v106, v106, v27, v28
 v_max3_f32 v106, v106, v29, v30
 v_max_f32 v106, v106, v31
 v_mov_b32 v107, v106
 s_nop 1
 v_permlane32_swap_b32 v106, v107
 v_max3_f32 v106, v106, v107, v104
 v_sub_f32 v107, v104, v106
 v_exp_f32 v107, v107
 v_mov_b32 v104, v106
 v_sub_f32 v16, v16, v106
 v_sub_f32 v17, v17, v106
 v_sub_f32 v18, v18, v106
 v_sub_f32 v19, v19, v106
 v_sub_f32 v20, v20, v106
 v_sub_f32 v21, v21, v106
 v_sub_f32 v22, v22, v106
 v_sub_f32 v23, v23, v106
 v_sub_f32 v24, v24, v106
 v_sub_f32 v25, v25, v106
 v_sub_f32 v26, v26, v106
 v_sub_f32 v27, v27, v106
 v_sub_f32 v28, v28, v106
 v_sub_f32 v29, v29, v106
 v_sub_f32 v30, v30, v106
 v_sub_f32 v31, v31, v106
 v_mul_f32 v48, v48, v107
 v_mul_f32 v49, v49, v107
 v_mul_f32 v50, v50, v107
 v_mul_f32 v51, v51, v107
 v_mul_f32 v52, v52, v107
 v_mul_f32 v53, v53, v107
 v_mul_f32 v54, v54, v107
 v_mul_f32 v55, v55, v107
 v_mul_f32 v56, v56, v107
 v_mul_f32 v57, v57, v107
 v_mul_f32 v58, v58, v107
 v_mul_f32 v59, v59, v107
 v_exp_f32 v16, v16
 v_exp_f32 v17, v17
 v_exp_f32 v18, v18
 v_exp_f32 v19, v19
 v_exp_f32 v20, v20
 v_exp_f32 v21, v21
 v_exp_f32 v22, v22
 v_exp_f32 v23, v23
 v_exp_f32 v24, v24
 v_exp_f32 v25, v25
 v_exp_f32 v26, v26
 v_exp_f32 v27, v27
 v_exp_f32 v28, v28
 v_exp_f32 v29, v29
 v_exp_f32 v30, v30
 v_exp_f32 v31, v31
 s_nop 0
 v_cvt_pk_bf16_f32 v96, v16, v17
 v_cvt_pk_bf16_f32 v97, v18, v19
 v_cvt_pk_bf16_f32 v98, v20, v21
 v_cvt_pk_bf16_f32 v99, v22, v23
 v_cvt_pk_bf16_f32 v100, v24, v25
 v_cvt_pk_bf16_f32 v101, v26, v27
 v_cvt_pk_bf16_f32 v102, v28, v29
 v_cvt_pk_bf16_f32 v103, v30, v31
 s_nop 0
 v_mfma_f32_32x32x16_bf16 v[48:63], v[80:83], v[96:99], v[48:63]
 v_mfma_f32_32x32x16_bf16 v[48:63], v[84:87], v[100:103], v[48:63]
 ds_read_b128 v[64:67], v7 offset:36864
 ds_read_b64 v[68:69], v3 offset:37888
 ds_read_b128 v[80:83], v2 offset:36864
 ds_read_b128 v[84:87], v2 offset:37888
 s_waitcnt lgkmcnt(2)
 v_mfma_f32_32x32x16_bf16 v[16:31], v[64:67], v[8:11], 0
 v_mfma_f32_32x32x16_bf16 v[16:31], v[68:71], v[12:15], v[16:31]
 v_max3_f32 v106, v32, v33, v34
 v_max3_f32 v106, v106, v35, v36
 v_max3_f32 v106, v106, v37, v38
 v_max3_f32 v106, v106, v39, v40
 v_max3_f32 v106, v106, v41, v42
 v_max3_f32 v106, v106, v43, v44
 v_max3_f32 v106, v106, v45, v46
 v_max_f32 v106, v106, v47
 v_mov_b32 v107, v106
 s_nop 1
 v_permlane32_swap_b32 v106, v107
 v_max3_f32 v106, v106, v107, v104
 v_sub_f32 v107, v104, v106
 v_exp_f32 v107, v107
 v_mov_b32 v104, v106
 v_sub_f32 v32, v32, v106
 v_sub_f32 v33, v33, v106
 v_sub_f32 v34, v34, v106
 v_sub_f32 v35, v35, v106
 v_sub_f32 v36, v36, v106
 v_sub_f32 v37, v37, v106
 v_sub_f32 v38, v38, v106
 v_sub_f32 v39, v39, v106
 v_sub_f32 v40, v40, v106
 v_sub_f32 v41, v41, v106
 v_sub_f32 v42, v42, v106
 v_sub_f32 v43, v43, v106
 v_sub_f32 v44, v44, v106
 v_sub_f32 v45, v45, v106
 v_sub_f32 v46, v46, v106
 v_sub_f32 v47, v47, v106
 v_mul_f32 v48, v48, v107
 v_mul_f32 v49, v49, v107
 v_mul_f32 v50, v50, v107
 v_mul_f32 v51, v51, v107
 v_mul_f32 v52, v52, v107
 v_mul_f32 v53, v53, v107
 v_mul_f32 v54, v54, v107
 v_mul_f32 v55, v55, v107
 v_mul_f32 v56, v56, v107
 v_mul_f32 v57, v57, v107
 v_mul_f32 v58, v58, v107
 v_mul_f32 v59, v59, v107
 v_exp_f32 v32, v32
 v_exp_f32 v33, v33
 v_exp_f32 v34, v34
 v_exp_f32 v35, v35
 v_exp_f32 v36, v36
 v_exp_f32 v37, v37
 v_exp_f32 v38, v38
 v_exp_f32 v39, v39
 v_exp_f32 v40, v40
 v_exp_f32 v41, v41
 v_exp_f32 v42, v42
 v_exp_f32 v43, v43
 v_exp_f32 v44, v44
 v_exp_f32 v45, v45
 v_exp_f32 v46, v46
 v_exp_f32 v47, v47
 s_nop 0
 v_cvt_pk_bf16_f32 v96, v32, v33
 v_cvt_pk_bf16_f32 v97, v34, v35
 v_cvt_pk_bf16_f32 v98, v36, v37
 v_cvt_pk_bf16_f32 v99, v38, v39
 v_cvt_pk_bf16_f32 v100, v40, v41
 v_cvt_pk_bf16_f32 v101, v42, v43
 v_cvt_pk_bf16_f32 v102, v44, v45
 v_cvt_pk_bf16_f32 v103, v46, v47
 s_nop 0
 v_mfma_f32_32x32x16_bf16 v[48:63], v[88:91], v[96:99], v[48:63]
 v_mfma_f32_32x32x16_bf16 v[48:63], v[92:95], v[100:103], v[48:63]
 ds_read_b128 v[72:75], v7 offset:38912
 ds_read_b64 v[76:77], v3 offset:39936
 ds_read_b128 v[88:91], v2 offset:38912
 ds_read_b128 v[92:95], v2 offset:39936
 s_waitcnt lgkmcnt(2)
 v_mfma_f32_32x32x16_bf16 v[32:47], v[72:75], v[8:11], 0
 v_mfma_f32_32x32x16_bf16 v[32:47], v[76:79], v[12:15], v[32:47]
 v_max3_f32 v106, v16, v17, v18
 v_max3_f32 v106, v106, v19, v20
 v_max3_f32 v106, v106, v21, v22
 v_max3_f32 v106, v106, v23, v24
 v_max3_f32 v106, v106, v25, v26
 v_max3_f32 v106, v106, v27, v28
 v_max3_f32 v106, v106, v29, v30
 v_max_f32 v106, v106, v31
 v_mov_b32 v107, v106
 s_nop 1
 v_permlane32_swap_b32 v106, v107
 v_max3_f32 v106, v106, v107, v104
 v_sub_f32 v107, v104, v106
 v_exp_f32 v107, v107
 v_mov_b32 v104, v106
 v_sub_f32 v16, v16, v106
 v_sub_f32 v17, v17, v106
 v_sub_f32 v18, v18, v106
 v_sub_f32 v19, v19, v106
 v_sub_f32 v20, v20, v106
 v_sub_f32 v21, v21, v106
 v_sub_f32 v22, v22, v106
 v_sub_f32 v23, v23, v106
 v_sub_f32 v24, v24, v106
 v_sub_f32 v25, v25, v106
 v_sub_f32 v26, v26, v106
 v_sub_f32 v27, v27, v106
 v_sub_f32 v28, v28, v106
 v_sub_f32 v29, v29, v106
 v_sub_f32 v30, v30, v106
 v_sub_f32 v31, v31, v106
 v_mul_f32 v48, v48, v107
 v_mul_f32 v49, v49, v107
 v_mul_f32 v50, v50, v107
 v_mul_f32 v51, v51, v107
 v_mul_f32 v52, v52, v107
 v_mul_f32 v53, v53, v107
 v_mul_f32 v54, v54, v107
 v_mul_f32 v55, v55, v107
 v_mul_f32 v56, v56, v107
 v_mul_f32 v57, v57, v107
 v_mul_f32 v58, v58, v107
 v_mul_f32 v59, v59, v107
 v_exp_f32 v16, v16
 v_exp_f32 v17, v17
 v_exp_f32 v18, v18
 v_exp_f32 v19, v19
 v_exp_f32 v20, v20
 v_exp_f32 v21, v21
 v_exp_f32 v22, v22
 v_exp_f32 v23, v23
 v_exp_f32 v24, v24
 v_exp_f32 v25, v25
 v_exp_f32 v26, v26
 v_exp_f32 v27, v27
 v_exp_f32 v28, v28
 v_exp_f32 v29, v29
 v_exp_f32 v30, v30
 v_exp_f32 v31, v31
 s_nop 0
 v_cvt_pk_bf16_f32 v96, v16, v17
 v_cvt_pk_bf16_f32 v97, v18, v19
 v_cvt_pk_bf16_f32 v98, v20, v21
 v_cvt_pk_bf16_f32 v99, v22, v23
 v_cvt_pk_bf16_f32 v100, v24, v25
 v_cvt_pk_bf16_f32 v101, v26, v27
 v_cvt_pk_bf16_f32 v102, v28, v29
 v_cvt_pk_bf16_f32 v103, v30, v31
 s_nop 0
 v_mfma_f32_32x32x16_bf16 v[48:63], v[80:83], v[96:99], v[48:63]
 v_mfma_f32_32x32x16_bf16 v[48:63], v[84:87], v[100:103], v[48:63]
 ds_read_b128 v[64:67], v7 offset:40960
 ds_read_b64 v[68:69], v3 offset:41984
 ds_read_b128 v[80:83], v2 offset:40960
 ds_read_b128 v[84:87], v2 offset:41984
 s_waitcnt lgkmcnt(2)
 v_mfma_f32_32x32x16_bf16 v[16:31], v[64:67], v[8:11], 0
 v_mfma_f32_32x32x16_bf16 v[16:31], v[68:71], v[12:15], v[16:31]
 v_max3_f32 v106, v32, v33, v34
 v_max3_f32 v106, v106, v35, v36
 v_max3_f32 v106, v106, v37, v38
 v_max3_f32 v106, v106, v39, v40
 v_max3_f32 v106, v106, v41, v42
 v_max3_f32 v106, v106, v43, v44
 v_max3_f32 v106, v106, v45, v46
 v_max_f32 v106, v106, v47
 v_mov_b32 v107, v106
 s_nop 1
 v_permlane32_swap_b32 v106, v107
 v_max3_f32 v106, v106, v107, v104
 v_sub_f32 v107, v104, v106
 v_exp_f32 v107, v107
 v_mov_b32 v104, v106
 v_sub_f32 v32, v32, v106
 v_sub_f32 v33, v33, v106
 v_sub_f32 v34, v34, v106
 v_sub_f32 v35, v35, v106
 v_sub_f32 v36, v36, v106
 v_sub_f32 v37, v37, v106
 v_sub_f32 v38, v38, v106
 v_sub_f32 v39, v39, v106
 v_sub_f32 v40, v40, v106
 v_sub_f32 v41, v41, v106
 v_sub_f32 v42, v42, v106
 v_sub_f32 v43, v43, v106
 v_sub_f32 v44, v44, v106
 v_sub_f32 v45, v45, v106
 v_sub_f32 v46, v46, v106
 v_sub_f32 v47, v47, v106
 v_mul_f32 v48, v48, v107
 v_mul_f32 v49, v49, v107
 v_mul_f32 v50, v50, v107
 v_mul_f32 v51, v51, v107
 v_mul_f32 v52, v52, v107
 v_mul_f32 v53, v53, v107
 v_mul_f32 v54, v54, v107
 v_mul_f32 v55, v55, v107
 v_mul_f32 v56, v56, v107
 v_mul_f32 v57, v57, v107
 v_mul_f32 v58, v58, v107
 v_mul_f32 v59, v59, v107
 v_exp_f32 v32, v32
 v_exp_f32 v33, v33
 v_exp_f32 v34, v34
 v_exp_f32 v35, v35
 v_exp_f32 v36, v36
 v_exp_f32 v37, v37
 v_exp_f32 v38, v38
 v_exp_f32 v39, v39
 v_exp_f32 v40, v40
 v_exp_f32 v41, v41
 v_exp_f32 v42, v42
 v_exp_f32 v43, v43
 v_exp_f32 v44, v44
 v_exp_f32 v45, v45
 v_exp_f32 v46, v46
 v_exp_f32 v47, v47
 s_nop 0
 v_cvt_pk_bf16_f32 v96, v32, v33
 v_cvt_pk_bf16_f32 v97, v34, v35
 v_cvt_pk_bf16_f32 v98, v36, v37
 v_cvt_pk_bf16_f32 v99, v38, v39
 v_cvt_pk_bf16_f32 v100, v40, v41
 v_cvt_pk_bf16_f32 v101, v42, v43
 v_cvt_pk_bf16_f32 v102, v44, v45
 v_cvt_pk_bf16_f32 v103, v46, v47
 s_nop 0
 v_mfma_f32_32x32x16_bf16 v[48:63], v[88:91], v[96:99], v[48:63]
 v_mfma_f32_32x32x16_bf16 v[48:63], v[92:95], v[100:103], v[48:63]
 ds_read_b128 v[72:75], v7 offset:43008
 ds_read_b64 v[76:77], v3 offset:44032
 ds_read_b128 v[88:91], v2 offset:43008
 ds_read_b128 v[92:95], v2 offset:44032
 s_waitcnt lgkmcnt(2)
 v_mfma_f32_32x32x16_bf16 v[32:47], v[72:75], v[8:11], 0
 v_mfma_f32_32x32x16_bf16 v[32:47], v[76:79], v[12:15], v[32:47]
 v_max3_f32 v106, v16, v17, v18
 v_max3_f32 v106, v106, v19, v20
 v_max3_f32 v106, v106, v21, v22
 v_max3_f32 v106, v106, v23, v24
 v_max3_f32 v106, v106, v25, v26
 v_max3_f32 v106, v106, v27, v28
 v_max3_f32 v106, v106, v29, v30
 v_max_f32 v106, v106, v31
 v_mov_b32 v107, v106
 s_nop 1
 v_permlane32_swap_b32 v106, v107
 v_max3_f32 v106, v106, v107, v104
 v_sub_f32 v107, v104, v106
 v_exp_f32 v107, v107
 v_mov_b32 v104, v106
 v_sub_f32 v16, v16, v106
 v_sub_f32 v17, v17, v106
 v_sub_f32 v18, v18, v106
 v_sub_f32 v19, v19, v106
 v_sub_f32 v20, v20, v106
 v_sub_f32 v21, v21, v106
 v_sub_f32 v22, v22, v106
 v_sub_f32 v23, v23, v106
 v_sub_f32 v24, v24, v106
 v_sub_f32 v25, v25, v106
 v_sub_f32 v26, v26, v106
 v_sub_f32 v27, v27, v106
 v_sub_f32 v28, v28, v106
 v_sub_f32 v29, v29, v106
 v_sub_f32 v30, v30, v106
 v_sub_f32 v31, v31, v106
 v_mul_f32 v48, v48, v107
 v_mul_f32 v49, v49, v107
 v_mul_f32 v50, v50, v107
 v_mul_f32 v51, v51, v107
 v_mul_f32 v52, v52, v107
 v_mul_f32 v53, v53, v107
 v_mul_f32 v54, v54, v107
 v_mul_f32 v55, v55, v107
 v_mul_f32 v56, v56, v107
 v_mul_f32 v57, v57, v107
 v_mul_f32 v58, v58, v107
 v_mul_f32 v59, v59, v107
 v_exp_f32 v16, v16
 v_exp_f32 v17, v17
 v_exp_f32 v18, v18
 v_exp_f32 v19, v19
 v_exp_f32 v20, v20
 v_exp_f32 v21, v21
 v_exp_f32 v22, v22
 v_exp_f32 v23, v23
 v_exp_f32 v24, v24
 v_exp_f32 v25, v25
 v_exp_f32 v26, v26
 v_exp_f32 v27, v27
 v_exp_f32 v28, v28
 v_exp_f32 v29, v29
 v_exp_f32 v30, v30
 v_exp_f32 v31, v31
 s_nop 0
 v_cvt_pk_bf16_f32 v96, v16, v17
 v_cvt_pk_bf16_f32 v97, v18, v19
 v_cvt_pk_bf16_f32 v98, v20, v21
 v_cvt_pk_bf16_f32 v99, v22, v23
 v_cvt_pk_bf16_f32 v100, v24, v25
 v_cvt_pk_bf16_f32 v101, v26, v27
 v_cvt_pk_bf16_f32 v102, v28, v29
 v_cvt_pk_bf16_f32 v103, v30, v31
 s_nop 0
 v_mfma_f32_32x32x16_bf16 v[48:63], v[80:83], v[96:99], v[48:63]
 v_mfma_f32_32x32x16_bf16 v[48:63], v[84:87], v[100:103], v[48:63]
 ds_read_b128 v[64:67], v7 offset:45056
 ds_read_b64 v[68:69], v3 offset:46080
 ds_read_b128 v[80:83], v2 offset:45056
 ds_read_b128 v[84:87], v2 offset:46080
 s_waitcnt lgkmcnt(2)
 v_mfma_f32_32x32x16_bf16 v[16:31], v[64:67], v[8:11], 0
 v_mfma_f32_32x32x16_bf16 v[16:31], v[68:71], v[12:15], v[16:31]
 v_max3_f32 v106, v32, v33, v34
 v_max3_f32 v106, v106, v35, v36
 v_max3_f32 v106, v106, v37, v38
 v_max3_f32 v106, v106, v39, v40
 v_max3_f32 v106, v106, v41, v42
 v_max3_f32 v106, v106, v43, v44
 v_max3_f32 v106, v106, v45, v46
 v_max_f32 v106, v106, v47
 v_mov_b32 v107, v106
 s_nop 1
 v_permlane32_swap_b32 v106, v107
 v_max3_f32 v106, v106, v107, v104
 v_sub_f32 v107, v104, v106
 v_exp_f32 v107, v107
 v_mov_b32 v104, v106
 v_sub_f32 v32, v32, v106
 v_sub_f32 v33, v33, v106
 v_sub_f32 v34, v34, v106
 v_sub_f32 v35, v35, v106
 v_sub_f32 v36, v36, v106
 v_sub_f32 v37, v37, v106
 v_sub_f32 v38, v38, v106
 v_sub_f32 v39, v39, v106
 v_sub_f32 v40, v40, v106
 v_sub_f32 v41, v41, v106
 v_sub_f32 v42, v42, v106
 v_sub_f32 v43, v43, v106
 v_sub_f32 v44, v44, v106
 v_sub_f32 v45, v45, v106
 v_sub_f32 v46, v46, v106
 v_sub_f32 v47, v47, v106
 v_mul_f32 v48, v48, v107
 v_mul_f32 v49, v49, v107
 v_mul_f32 v50, v50, v107
 v_mul_f32 v51, v51, v107
 v_mul_f32 v52, v52, v107
 v_mul_f32 v53, v53, v107
 v_mul_f32 v54, v54, v107
 v_mul_f32 v55, v55, v107
 v_mul_f32 v56, v56, v107
 v_mul_f32 v57, v57, v107
 v_mul_f32 v58, v58, v107
 v_mul_f32 v59, v59, v107
 v_exp_f32 v32, v32
 v_exp_f32 v33, v33
 v_exp_f32 v34, v34
 v_exp_f32 v35, v35
 v_exp_f32 v36, v36
 v_exp_f32 v37, v37
 v_exp_f32 v38, v38
 v_exp_f32 v39, v39
 v_exp_f32 v40, v40
 v_exp_f32 v41, v41
 v_exp_f32 v42, v42
 v_exp_f32 v43, v43
 v_exp_f32 v44, v44
 v_exp_f32 v45, v45
 v_exp_f32 v46, v46
 v_exp_f32 v47, v47
 s_nop 0
 v_cvt_pk_bf16_f32 v96, v32, v33
 v_cvt_pk_bf16_f32 v97, v34, v35
 v_cvt_pk_bf16_f32 v98, v36, v37
 v_cvt_pk_bf16_f32 v99, v38, v39
 v_cvt_pk_bf16_f32 v100, v40, v41
 v_cvt_pk_bf16_f32 v101, v42, v43
 v_cvt_pk_bf16_f32 v102, v44, v45
 v_cvt_pk_bf16_f32 v103, v46, v47
 s_nop 0
 v_mfma_f32_32x32x16_bf16 v[48:63], v[88:91], v[96:99], v[48:63]
 v_mfma_f32_32x32x16_bf16 v[48:63], v[92:95], v[100:103], v[48:63]
 ds_read_b128 v[72:75], v7 offset:47104
 ds_read_b64 v[76:77], v3 offset:48128
 ds_read_b128 v[88:91], v2 offset:47104
 ds_read_b128 v[92:95], v2 offset:48128
 s_waitcnt lgkmcnt(2)
 v_mfma_f32_32x32x16_bf16 v[32:47], v[72:75], v[8:11], 0
 v_mfma_f32_32x32x16_bf16 v[32:47], v[76:79], v[12:15], v[32:47]
 v_max3_f32 v106, v16, v17, v18
 v_max3_f32 v106, v106, v19, v20
 v_max3_f32 v106, v106, v21, v22
 v_max3_f32 v106, v106, v23, v24
 v_max3_f32 v106, v106, v25, v26
 v_max3_f32 v106, v106, v27, v28
 v_max3_f32 v106, v106, v29, v30
 v_max_f32 v106, v106, v31
 v_mov_b32 v107, v106
 s_nop 1
 v_permlane32_swap_b32 v106, v107
 v_max3_f32 v106, v106, v107, v104
 v_sub_f32 v107, v104, v106
 v_exp_f32 v107, v107
 v_mov_b32 v104, v106
 v_sub_f32 v16, v16, v106
 v_sub_f32 v17, v17, v106
 v_sub_f32 v18, v18, v106
 v_sub_f32 v19, v19, v106
 v_sub_f32 v20, v20, v106
 v_sub_f32 v21, v21, v106
 v_sub_f32 v22, v22, v106
 v_sub_f32 v23, v23, v106
 v_sub_f32 v24, v24, v106
 v_sub_f32 v25, v25, v106
 v_sub_f32 v26, v26, v106
 v_sub_f32 v27, v27, v106
 v_sub_f32 v28, v28, v106
 v_sub_f32 v29, v29, v106
 v_sub_f32 v30, v30, v106
 v_sub_f32 v31, v31, v106
 v_mul_f32 v48, v48, v107
 v_mul_f32 v49, v49, v107
 v_mul_f32 v50, v50, v107
 v_mul_f32 v51, v51, v107
 v_mul_f32 v52, v52, v107
 v_mul_f32 v53, v53, v107
 v_mul_f32 v54, v54, v107
 v_mul_f32 v55, v55, v107
 v_mul_f32 v56, v56, v107
 v_mul_f32 v57, v57, v107
 v_mul_f32 v58, v58, v107
 v_mul_f32 v59, v59, v107
 v_exp_f32 v16, v16
 v_exp_f32 v17, v17
 v_exp_f32 v18, v18
 v_exp_f32 v19, v19
 v_exp_f32 v20, v20
 v_exp_f32 v21, v21
 v_exp_f32 v22, v22
 v_exp_f32 v23, v23
 v_exp_f32 v24, v24
 v_exp_f32 v25, v25
 v_exp_f32 v26, v26
 v_exp_f32 v27, v27
 v_exp_f32 v28, v28
 v_exp_f32 v29, v29
 v_exp_f32 v30, v30
 v_exp_f32 v31, v31
 s_nop 0
 v_cvt_pk_bf16_f32 v96, v16, v17
 v_cvt_pk_bf16_f32 v97, v18, v19
 v_cvt_pk_bf16_f32 v98, v20, v21
 v_cvt_pk_bf16_f32 v99, v22, v23
 v_cvt_pk_bf16_f32 v100, v24, v25
 v_cvt_pk_bf16_f32 v101, v26, v27
 v_cvt_pk_bf16_f32 v102, v28, v29
 v_cvt_pk_bf16_f32 v103, v30, v31
 s_nop 0
 v_mfma_f32_32x32x16_bf16 v[48:63], v[80:83], v[96:99], v[48:63]
 v_mfma_f32_32x32x16_bf16 v[48:63], v[84:87], v[100:103], v[48:63]
 s_nop 7
 v_max3_f32 v106, v32, v33, v34
 v_max3_f32 v106, v106, v35, v36
 v_max3_f32 v106, v106, v37, v38
 v_max3_f32 v106, v106, v39, v40
 v_max3_f32 v106, v106, v41, v42
 v_max3_f32 v106, v106, v43, v44
 v_max3_f32 v106, v106, v45, v46
 v_max_f32 v106, v106, v47
 v_mov_b32 v107, v106
 s_nop 1
 v_permlane32_swap_b32 v106, v107
 v_max3_f32 v106, v106, v107, v104
 v_sub_f32 v107, v104, v106
 v_exp_f32 v107, v107
 v_mov_b32 v104, v106
 v_sub_f32 v32, v32, v106
 v_sub_f32 v33, v33, v106
 v_sub_f32 v34, v34, v106
 v_sub_f32 v35, v35, v106
 v_sub_f32 v36, v36, v106
 v_sub_f32 v37, v37, v106
 v_sub_f32 v38, v38, v106
 v_sub_f32 v39, v39, v106
 v_sub_f32 v40, v40, v106
 v_sub_f32 v41, v41, v106
 v_sub_f32 v42, v42, v106
 v_sub_f32 v43, v43, v106
 v_sub_f32 v44, v44, v106
 v_sub_f32 v45, v45, v106
 v_sub_f32 v46, v46, v106
 v_sub_f32 v47, v47, v106
 v_mul_f32 v48, v48, v107
 v_mul_f32 v49, v49, v107
 v_mul_f32 v50, v50, v107
 v_mul_f32 v51, v51, v107
 v_mul_f32 v52, v52, v107
 v_mul_f32 v53, v53, v107
 v_mul_f32 v54, v54, v107
 v_mul_f32 v55, v55, v107
 v_mul_f32 v56, v56, v107
 v_mul_f32 v57, v57, v107
 v_mul_f32 v58, v58, v107
 v_mul_f32 v59, v59, v107
 v_exp_f32 v32, v32
 v_exp_f32 v33, v33
 v_exp_f32 v34, v34
 v_exp_f32 v35, v35
 v_exp_f32 v36, v36
 v_exp_f32 v37, v37
 v_exp_f32 v38, v38
 v_exp_f32 v39, v39
 v_exp_f32 v40, v40
 v_exp_f32 v41, v41
 v_exp_f32 v42, v42
 v_exp_f32 v43, v43
 v_exp_f32 v44, v44
 v_exp_f32 v45, v45
 v_exp_f32 v46, v46
 v_exp_f32 v47, v47
 s_nop 0
 v_cvt_pk_bf16_f32 v96, v32, v33
 v_cvt_pk_bf16_f32 v97, v34, v35
 v_cvt_pk_bf16_f32 v98, v36, v37
 v_cvt_pk_bf16_f32 v99, v38, v39
 v_cvt_pk_bf16_f32 v100, v40, v41
 v_cvt_pk_bf16_f32 v101, v42, v43
 v_cvt_pk_bf16_f32 v102, v44, v45
 v_cvt_pk_bf16_f32 v103, v46, v47
 s_waitcnt lgkmcnt(0)
 s_nop 0
 v_mfma_f32_32x32x16_bf16 v[48:63], v[88:91], v[96:99], v[48:63]
 v_mfma_f32_32x32x16_bf16 v[48:63], v[92:95], v[100:103], v[48:63]
 s_waitcnt vmcnt(0)
 v_cndmask_b32 v120, v120, v5, s[26:27]
 v_cndmask_b32 v121, v121, v5, s[26:27]
 v_cndmask_b32 v122, v122, v5, s[26:27]
 v_cndmask_b32 v123, v123, v5, s[26:27]
 v_cndmask_b32 v124, v124, v5, s[26:27]
 v_cndmask_b32 v125, v125, v5, s[26:27]
 v_cndmask_b32 v126, v126, v5, s[26:27]
 v_cndmask_b32 v127, v127, v5, s[26:27]
 ds_write_b128 v4, v[112:115] offset:0
 ds_write_b128 v4, v[116:119] offset:8192
 ds_write_b128 v4, v[120:123] offset:16384
 ds_write_b128 v4, v[124:127] offset:24576
 s_waitcnt lgkmcnt(0)
 s_barrier
 s_mov_b32 s28, 81920
 s_mov_b32 s29, 4276224
 buffer_load_dwordx4 v[112:115], v4, s[12:15], s28 offen offset:0
 buffer_load_dwordx4 v[116:119], v6, s[12:15], s28 offen
 buffer_load_dwordx4 v[120:123], v4, s[12:15], s29 offen
 buffer_load_dwordx4 v[124:127], v6, s[12:15], s29 offen
 ds_read_b128 v[64:67], v7 offset:0
 ds_read_b64 v[68:69], v3 offset:1024
 ds_read_b128 v[80:83], v2 offset:0
 ds_read_b128 v[84:87], v2 offset:1024
 s_waitcnt lgkmcnt(2)
 v_mfma_f32_32x32x16_bf16 v[16:31], v[64:67], v[8:11], 0
 v_mfma_f32_32x32x16_bf16 v[16:31], v[68:71], v[12:15], v[16:31]
 ds_read_b128 v[72:75], v7 offset:2048
 ds_read_b64 v[76:77], v3 offset:3072
 ds_read_b128 v[88:91], v2 offset:2048
 ds_read_b128 v[92:95], v2 offset:3072
 s_waitcnt lgkmcnt(2)
 v_mfma_f32_32x32x16_bf16 v[32:47], v[72:75], v[8:11], 0
 v_mfma_f32_32x32x16_bf16 v[32:47], v[76:79], v[12:15], v[32:47]
 v_max3_f32 v106, v16, v17, v18
 v_max3_f32 v106, v106, v19, v20
 v_max3_f32 v106, v106, v21, v22
 v_max3_f32 v106, v106, v23, v24
 v_max3_f32 v106, v106, v25, v26
 v_max3_f32 v106, v106, v27, v28
 v_max3_f32 v106, v106, v29, v30
 v_max_f32 v106, v106, v31
 v_mov_b32 v107, v106
 s_nop 1
 v_permlane32_swap_b32 v106, v107
 v_max3_f32 v106, v106, v107, v104
 v_sub_f32 v107, v104, v106
 v_exp_f32 v107, v107
 v_mov_b32 v104, v106
 v_sub_f32 v16, v16, v106
 v_sub_f32 v17, v17, v106
 v_sub_f32 v18, v18, v106
 v_sub_f32 v19, v19, v106
 v_sub_f32 v20, v20, v106
 v_sub_f32 v21, v21, v106
 v_sub_f32 v22, v22, v106
 v_sub_f32 v23, v23, v106
 v_sub_f32 v24, v24, v106
 v_sub_f32 v25, v25, v106
 v_sub_f32 v26, v26, v106
 v_sub_f32 v27, v27, v106
 v_sub_f32 v28, v28, v106
 v_sub_f32 v29, v29, v106
 v_sub_f32 v30, v30, v106
 v_sub_f32 v31, v31, v106
 v_mul_f32 v48, v48, v107
 v_mul_f32 v49, v49, v107
 v_mul_f32 v50, v50, v107
 v_mul_f32 v51, v51, v107
 v_mul_f32 v52, v52, v107
 v_mul_f32 v53, v53, v107
 v_mul_f32 v54, v54, v107
 v_mul_f32 v55, v55, v107
 v_mul_f32 v56, v56, v107
 v_mul_f32 v57, v57, v107
 v_mul_f32 v58, v58, v107
 v_mul_f32 v59, v59, v107
 v_exp_f32 v16, v16
 v_exp_f32 v17, v17
 v_exp_f32 v18, v18
 v_exp_f32 v19, v19
 v_exp_f32 v20, v20
 v_exp_f32 v21, v21
 v_exp_f32 v22, v22
 v_exp_f32 v23, v23
 v_exp_f32 v24, v24
 v_exp_f32 v25, v25
 v_exp_f32 v26, v26
 v_exp_f32 v27, v27
 v_exp_f32 v28, v28
 v_exp_f32 v29, v29
 v_exp_f32 v30, v30
 v_exp_f32 v31, v31
 s_nop 0
 v_cvt_pk_bf16_f32 v96, v16, v17
 v_cvt_pk_bf16_f32 v97, v18, v19
 v_cvt_pk_bf16_f32 v98, v20, v21
 v_cvt_pk_bf16_f32 v99, v22, v23
 v_cvt_pk_bf16_f32 v100, v24, v25
 v_cvt_pk_bf16_f32 v101, v26, v27
 v_cvt_pk_bf16_f32 v102, v28, v29
 v_cvt_pk_bf16_f32 v103, v30, v31
 s_nop 0
 v_mfma_f32_32x32x16_bf16 v[48:63], v[80:83], v[96:99], v[48:63]
 v_mfma_f32_32x32x16_bf16 v[48:63], v[84:87], v[100:103], v[48:63]
 ds_read_b128 v[64:67], v7 offset:4096
 ds_read_b64 v[68:69], v3 offset:5120
 ds_read_b128 v[80:83], v2 offset:4096
 ds_read_b128 v[84:87], v2 offset:5120
 s_waitcnt lgkmcnt(2)
 v_mfma_f32_32x32x16_bf16 v[16:31], v[64:67], v[8:11], 0
 v_mfma_f32_32x32x16_bf16 v[16:31], v[68:71], v[12:15], v[16:31]
 v_max3_f32 v106, v32, v33, v34
 v_max3_f32 v106, v106, v35, v36
 v_max3_f32 v106, v106, v37, v38
 v_max3_f32 v106, v106, v39, v40
 v_max3_f32 v106, v106, v41, v42
 v_max3_f32 v106, v106, v43, v44
 v_max3_f32 v106, v106, v45, v46
 v_max_f32 v106, v106, v47
 v_mov_b32 v107, v106
 s_nop 1
 v_permlane32_swap_b32 v106, v107
 v_max3_f32 v106, v106, v107, v104
 v_sub_f32 v107, v104, v106
 v_exp_f32 v107, v107
 v_mov_b32 v104, v106
 v_sub_f32 v32, v32, v106
 v_sub_f32 v33, v33, v106
 v_sub_f32 v34, v34, v106
 v_sub_f32 v35, v35, v106
 v_sub_f32 v36, v36, v106
 v_sub_f32 v37, v37, v106
 v_sub_f32 v38, v38, v106
 v_sub_f32 v39, v39, v106
 v_sub_f32 v40, v40, v106
 v_sub_f32 v41, v41, v106
 v_sub_f32 v42, v42, v106
 v_sub_f32 v43, v43, v106
 v_sub_f32 v44, v44, v106
 v_sub_f32 v45, v45, v106
 v_sub_f32 v46, v46, v106
 v_sub_f32 v47, v47, v106
 v_mul_f32 v48, v48, v107
 v_mul_f32 v49, v49, v107
 v_mul_f32 v50, v50, v107
 v_mul_f32 v51, v51, v107
 v_mul_f32 v52, v52, v107
 v_mul_f32 v53, v53, v107
 v_mul_f32 v54, v54, v107
 v_mul_f32 v55, v55, v107
 v_mul_f32 v56, v56, v107
 v_mul_f32 v57, v57, v107
 v_mul_f32 v58, v58, v107
 v_mul_f32 v59, v59, v107
 v_exp_f32 v32, v32
 v_exp_f32 v33, v33
 v_exp_f32 v34, v34
 v_exp_f32 v35, v35
 v_exp_f32 v36, v36
 v_exp_f32 v37, v37
 v_exp_f32 v38, v38
 v_exp_f32 v39, v39
 v_exp_f32 v40, v40
 v_exp_f32 v41, v41
 v_exp_f32 v42, v42
 v_exp_f32 v43, v43
 v_exp_f32 v44, v44
 v_exp_f32 v45, v45
 v_exp_f32 v46, v46
 v_exp_f32 v47, v47
 s_nop 0
 v_cvt_pk_bf16_f32 v96, v32, v33
 v_cvt_pk_bf16_f32 v97, v34, v35
 v_cvt_pk_bf16_f32 v98, v36, v37
 v_cvt_pk_bf16_f32 v99, v38, v39
 v_cvt_pk_bf16_f32 v100, v40, v41
 v_cvt_pk_bf16_f32 v101, v42, v43
 v_cvt_pk_bf16_f32 v102, v44, v45
 v_cvt_pk_bf16_f32 v103, v46, v47
 s_nop 0
 v_mfma_f32_32x32x16_bf16 v[48:63], v[88:91], v[96:99], v[48:63]
 v_mfma_f32_32x32x16_bf16 v[48:63], v[92:95], v[100:103], v[48:63]
 ds_read_b128 v[72:75], v7 offset:6144
 ds_read_b64 v[76:77], v3 offset:7168
 ds_read_b128 v[88:91], v2 offset:6144
 ds_read_b128 v[92:95], v2 offset:7168
 s_waitcnt lgkmcnt(2)
 v_mfma_f32_32x32x16_bf16 v[32:47], v[72:75], v[8:11], 0
 v_mfma_f32_32x32x16_bf16 v[32:47], v[76:79], v[12:15], v[32:47]
 v_max3_f32 v106, v16, v17, v18
 v_max3_f32 v106, v106, v19, v20
 v_max3_f32 v106, v106, v21, v22
 v_max3_f32 v106, v106, v23, v24
 v_max3_f32 v106, v106, v25, v26
 v_max3_f32 v106, v106, v27, v28
 v_max3_f32 v106, v106, v29, v30
 v_max_f32 v106, v106, v31
 v_mov_b32 v107, v106
 s_nop 1
 v_permlane32_swap_b32 v106, v107
 v_max3_f32 v106, v106, v107, v104
 v_sub_f32 v107, v104, v106
 v_exp_f32 v107, v107
 v_mov_b32 v104, v106
 v_sub_f32 v16, v16, v106
 v_sub_f32 v17, v17, v106
 v_sub_f32 v18, v18, v106
 v_sub_f32 v19, v19, v106
 v_sub_f32 v20, v20, v106
 v_sub_f32 v21, v21, v106
 v_sub_f32 v22, v22, v106
 v_sub_f32 v23, v23, v106
 v_sub_f32 v24, v24, v106
 v_sub_f32 v25, v25, v106
 v_sub_f32 v26, v26, v106
 v_sub_f32 v27, v27, v106
 v_sub_f32 v28, v28, v106
 v_sub_f32 v29, v29, v106
 v_sub_f32 v30, v30, v106
 v_sub_f32 v31, v31, v106
 v_mul_f32 v48, v48, v107
 v_mul_f32 v49, v49, v107
 v_mul_f32 v50, v50, v107
 v_mul_f32 v51, v51, v107
 v_mul_f32 v52, v52, v107
 v_mul_f32 v53, v53, v107
 v_mul_f32 v54, v54, v107
 v_mul_f32 v55, v55, v107
 v_mul_f32 v56, v56, v107
 v_mul_f32 v57, v57, v107
 v_mul_f32 v58, v58, v107
 v_mul_f32 v59, v59, v107
 v_exp_f32 v16, v16
 v_exp_f32 v17, v17
 v_exp_f32 v18, v18
 v_exp_f32 v19, v19
 v_exp_f32 v20, v20
 v_exp_f32 v21, v21
 v_exp_f32 v22, v22
 v_exp_f32 v23, v23
 v_exp_f32 v24, v24
 v_exp_f32 v25, v25
 v_exp_f32 v26, v26
 v_exp_f32 v27, v27
 v_exp_f32 v28, v28
 v_exp_f32 v29, v29
 v_exp_f32 v30, v30
 v_exp_f32 v31, v31
 s_nop 0
 v_cvt_pk_bf16_f32 v96, v16, v17
 v_cvt_pk_bf16_f32 v97, v18, v19
 v_cvt_pk_bf16_f32 v98, v20, v21
 v_cvt_pk_bf16_f32 v99, v22, v23
 v_cvt_pk_bf16_f32 v100, v24, v25
 v_cvt_pk_bf16_f32 v101, v26, v27
 v_cvt_pk_bf16_f32 v102, v28, v29
 v_cvt_pk_bf16_f32 v103, v30, v31
 s_nop 0
 v_mfma_f32_32x32x16_bf16 v[48:63], v[80:83], v[96:99], v[48:63]
 v_mfma_f32_32x32x16_bf16 v[48:63], v[84:87], v[100:103], v[48:63]
 ds_read_b128 v[64:67], v7 offset:8192
 ds_read_b64 v[68:69], v3 offset:9216
 ds_read_b128 v[80:83], v2 offset:8192
 ds_read_b128 v[84:87], v2 offset:9216
 s_waitcnt lgkmcnt(2)
 v_mfma_f32_32x32x16_bf16 v[16:31], v[64:67], v[8:11], 0
 v_mfma_f32_32x32x16_bf16 v[16:31], v[68:71], v[12:15], v[16:31]
 v_max3_f32 v106, v32, v33, v34
 v_max3_f32 v106, v106, v35, v36
 v_max3_f32 v106, v106, v37, v38
 v_max3_f32 v106, v106, v39, v40
 v_max3_f32 v106, v106, v41, v42
 v_max3_f32 v106, v106, v43, v44
 v_max3_f32 v106, v106, v45, v46
 v_max_f32 v106, v106, v47
 v_mov_b32 v107, v106
 s_nop 1
 v_permlane32_swap_b32 v106, v107
 v_max3_f32 v106, v106, v107, v104
 v_sub_f32 v107, v104, v106
 v_exp_f32 v107, v107
 v_mov_b32 v104, v106
 v_sub_f32 v32, v32, v106
 v_sub_f32 v33, v33, v106
 v_sub_f32 v34, v34, v106
 v_sub_f32 v35, v35, v106
 v_sub_f32 v36, v36, v106
 v_sub_f32 v37, v37, v106
 v_sub_f32 v38, v38, v106
 v_sub_f32 v39, v39, v106
 v_sub_f32 v40, v40, v106
 v_sub_f32 v41, v41, v106
 v_sub_f32 v42, v42, v106
 v_sub_f32 v43, v43, v106
 v_sub_f32 v44, v44, v106
 v_sub_f32 v45, v45, v106
 v_sub_f32 v46, v46, v106
 v_sub_f32 v47, v47, v106
 v_mul_f32 v48, v48, v107
 v_mul_f32 v49, v49, v107
 v_mul_f32 v50, v50, v107
 v_mul_f32 v51, v51, v107
 v_mul_f32 v52, v52, v107
 v_mul_f32 v53, v53, v107
 v_mul_f32 v54, v54, v107
 v_mul_f32 v55, v55, v107
 v_mul_f32 v56, v56, v107
 v_mul_f32 v57, v57, v107
 v_mul_f32 v58, v58, v107
 v_mul_f32 v59, v59, v107
 v_exp_f32 v32, v32
 v_exp_f32 v33, v33
 v_exp_f32 v34, v34
 v_exp_f32 v35, v35
 v_exp_f32 v36, v36
 v_exp_f32 v37, v37
 v_exp_f32 v38, v38
 v_exp_f32 v39, v39
 v_exp_f32 v40, v40
 v_exp_f32 v41, v41
 v_exp_f32 v42, v42
 v_exp_f32 v43, v43
 v_exp_f32 v44, v44
 v_exp_f32 v45, v45
 v_exp_f32 v46, v46
 v_exp_f32 v47, v47
 s_nop 0
 v_cvt_pk_bf16_f32 v96, v32, v33
 v_cvt_pk_bf16_f32 v97, v34, v35
 v_cvt_pk_bf16_f32 v98, v36, v37
 v_cvt_pk_bf16_f32 v99, v38, v39
 v_cvt_pk_bf16_f32 v100, v40, v41
 v_cvt_pk_bf16_f32 v101, v42, v43
 v_cvt_pk_bf16_f32 v102, v44, v45
 v_cvt_pk_bf16_f32 v103, v46, v47
 s_nop 0
 v_mfma_f32_32x32x16_bf16 v[48:63], v[88:91], v[96:99], v[48:63]
 v_mfma_f32_32x32x16_bf16 v[48:63], v[92:95], v[100:103], v[48:63]
 ds_read_b128 v[72:75], v7 offset:10240
 ds_read_b64 v[76:77], v3 offset:11264
 ds_read_b128 v[88:91], v2 offset:10240
 ds_read_b128 v[92:95], v2 offset:11264
 s_waitcnt lgkmcnt(2)
 v_mfma_f32_32x32x16_bf16 v[32:47], v[72:75], v[8:11], 0
 v_mfma_f32_32x32x16_bf16 v[32:47], v[76:79], v[12:15], v[32:47]
 v_max3_f32 v106, v16, v17, v18
 v_max3_f32 v106, v106, v19, v20
 v_max3_f32 v106, v106, v21, v22
 v_max3_f32 v106, v106, v23, v24
 v_max3_f32 v106, v106, v25, v26
 v_max3_f32 v106, v106, v27, v28
 v_max3_f32 v106, v106, v29, v30
 v_max_f32 v106, v106, v31
 v_mov_b32 v107, v106
 s_nop 1
 v_permlane32_swap_b32 v106, v107
 v_max3_f32 v106, v106, v107, v104
 v_sub_f32 v107, v104, v106
 v_exp_f32 v107, v107
 v_mov_b32 v104, v106
 v_sub_f32 v16, v16, v106
 v_sub_f32 v17, v17, v106
 v_sub_f32 v18, v18, v106
 v_sub_f32 v19, v19, v106
 v_sub_f32 v20, v20, v106
 v_sub_f32 v21, v21, v106
 v_sub_f32 v22, v22, v106
 v_sub_f32 v23, v23, v106
 v_sub_f32 v24, v24, v106
 v_sub_f32 v25, v25, v106
 v_sub_f32 v26, v26, v106
 v_sub_f32 v27, v27, v106
 v_sub_f32 v28, v28, v106
 v_sub_f32 v29, v29, v106
 v_sub_f32 v30, v30, v106
 v_sub_f32 v31, v31, v106
 v_mul_f32 v48, v48, v107
 v_mul_f32 v49, v49, v107
 v_mul_f32 v50, v50, v107
 v_mul_f32 v51, v51, v107
 v_mul_f32 v52, v52, v107
 v_mul_f32 v53, v53, v107
 v_mul_f32 v54, v54, v107
 v_mul_f32 v55, v55, v107
 v_mul_f32 v56, v56, v107
 v_mul_f32 v57, v57, v107
 v_mul_f32 v58, v58, v107
 v_mul_f32 v59, v59, v107
 v_exp_f32 v16, v16
 v_exp_f32 v17, v17
 v_exp_f32 v18, v18
 v_exp_f32 v19, v19
 v_exp_f32 v20, v20
 v_exp_f32 v21, v21
 v_exp_f32 v22, v22
 v_exp_f32 v23, v23
 v_exp_f32 v24, v24
 v_exp_f32 v25, v25
 v_exp_f32 v26, v26
 v_exp_f32 v27, v27
 v_exp_f32 v28, v28
 v_exp_f32 v29, v29
 v_exp_f32 v30, v30
 v_exp_f32 v31, v31
 s_nop 0
 v_cvt_pk_bf16_f32 v96, v16, v17
 v_cvt_pk_bf16_f32 v97, v18, v19
 v_cvt_pk_bf16_f32 v98, v20, v21
 v_cvt_pk_bf16_f32 v99, v22, v23
 v_cvt_pk_bf16_f32 v100, v24, v25
 v_cvt_pk_bf16_f32 v101, v26, v27
 v_cvt_pk_bf16_f32 v102, v28, v29
 v_cvt_pk_bf16_f32 v103, v30, v31
 s_nop 0
 v_mfma_f32_32x32x16_bf16 v[48:63], v[80:83], v[96:99], v[48:63]
 v_mfma_f32_32x32x16_bf16 v[48:63], v[84:87], v[100:103], v[48:63]
 ds_read_b128 v[64:67], v7 offset:12288
 ds_read_b64 v[68:69], v3 offset:13312
 ds_read_b128 v[80:83], v2 offset:12288
 ds_read_b128 v[84:87], v2 offset:13312
 s_waitcnt lgkmcnt(2)
 v_mfma_f32_32x32x16_bf16 v[16:31], v[64:67], v[8:11], 0
 v_mfma_f32_32x32x16_bf16 v[16:31], v[68:71], v[12:15], v[16:31]
 v_max3_f32 v106, v32, v33, v34
 v_max3_f32 v106, v106, v35, v36
 v_max3_f32 v106, v106, v37, v38
 v_max3_f32 v106, v106, v39, v40
 v_max3_f32 v106, v106, v41, v42
 v_max3_f32 v106, v106, v43, v44
 v_max3_f32 v106, v106, v45, v46
 v_max_f32 v106, v106, v47
 v_mov_b32 v107, v106
 s_nop 1
 v_permlane32_swap_b32 v106, v107
 v_max3_f32 v106, v106, v107, v104
 v_sub_f32 v107, v104, v106
 v_exp_f32 v107, v107
 v_mov_b32 v104, v106
 v_sub_f32 v32, v32, v106
 v_sub_f32 v33, v33, v106
 v_sub_f32 v34, v34, v106
 v_sub_f32 v35, v35, v106
 v_sub_f32 v36, v36, v106
 v_sub_f32 v37, v37, v106
 v_sub_f32 v38, v38, v106
 v_sub_f32 v39, v39, v106
 v_sub_f32 v40, v40, v106
 v_sub_f32 v41, v41, v106
 v_sub_f32 v42, v42, v106
 v_sub_f32 v43, v43, v106
 v_sub_f32 v44, v44, v106
 v_sub_f32 v45, v45, v106
 v_sub_f32 v46, v46, v106
 v_sub_f32 v47, v47, v106
 v_mul_f32 v48, v48, v107
 v_mul_f32 v49, v49, v107
 v_mul_f32 v50, v50, v107
 v_mul_f32 v51, v51, v107
 v_mul_f32 v52, v52, v107
 v_mul_f32 v53, v53, v107
 v_mul_f32 v54, v54, v107
 v_mul_f32 v55, v55, v107
 v_mul_f32 v56, v56, v107
 v_mul_f32 v57, v57, v107
 v_mul_f32 v58, v58, v107
 v_mul_f32 v59, v59, v107
 v_exp_f32 v32, v32
 v_exp_f32 v33, v33
 v_exp_f32 v34, v34
 v_exp_f32 v35, v35
 v_exp_f32 v36, v36
 v_exp_f32 v37, v37
 v_exp_f32 v38, v38
 v_exp_f32 v39, v39
 v_exp_f32 v40, v40
 v_exp_f32 v41, v41
 v_exp_f32 v42, v42
 v_exp_f32 v43, v43
 v_exp_f32 v44, v44
 v_exp_f32 v45, v45
 v_exp_f32 v46, v46
 v_exp_f32 v47, v47
 s_nop 0
 v_cvt_pk_bf16_f32 v96, v32, v33
 v_cvt_pk_bf16_f32 v97, v34, v35
 v_cvt_pk_bf16_f32 v98, v36, v37
 v_cvt_pk_bf16_f32 v99, v38, v39
 v_cvt_pk_bf16_f32 v100, v40, v41
 v_cvt_pk_bf16_f32 v101, v42, v43
 v_cvt_pk_bf16_f32 v102, v44, v45
 v_cvt_pk_bf16_f32 v103, v46, v47
 s_nop 0
 v_mfma_f32_32x32x16_bf16 v[48:63], v[88:91], v[96:99], v[48:63]
 v_mfma_f32_32x32x16_bf16 v[48:63], v[92:95], v[100:103], v[48:63]
 ds_read_b128 v[72:75], v7 offset:14336
 ds_read_b64 v[76:77], v3 offset:15360
 ds_read_b128 v[88:91], v2 offset:14336
 ds_read_b128 v[92:95], v2 offset:15360
 s_waitcnt lgkmcnt(2)
 v_mfma_f32_32x32x16_bf16 v[32:47], v[72:75], v[8:11], 0
 v_mfma_f32_32x32x16_bf16 v[32:47], v[76:79], v[12:15], v[32:47]
 v_max3_f32 v106, v16, v17, v18
 v_max3_f32 v106, v106, v19, v20
 v_max3_f32 v106, v106, v21, v22
 v_max3_f32 v106, v106, v23, v24
 v_max3_f32 v106, v106, v25, v26
 v_max3_f32 v106, v106, v27, v28
 v_max3_f32 v106, v106, v29, v30
 v_max_f32 v106, v106, v31
 v_mov_b32 v107, v106
 s_nop 1
 v_permlane32_swap_b32 v106, v107
 v_max3_f32 v106, v106, v107, v104
 v_sub_f32 v107, v104, v106
 v_exp_f32 v107, v107
 v_mov_b32 v104, v106
 v_sub_f32 v16, v16, v106
 v_sub_f32 v17, v17, v106
 v_sub_f32 v18, v18, v106
 v_sub_f32 v19, v19, v106
 v_sub_f32 v20, v20, v106
 v_sub_f32 v21, v21, v106
 v_sub_f32 v22, v22, v106
 v_sub_f32 v23, v23, v106
 v_sub_f32 v24, v24, v106
 v_sub_f32 v25, v25, v106
 v_sub_f32 v26, v26, v106
 v_sub_f32 v27, v27, v106
 v_sub_f32 v28, v28, v106
 v_sub_f32 v29, v29, v106
 v_sub_f32 v30, v30, v106
 v_sub_f32 v31, v31, v106
 v_mul_f32 v48, v48, v107
 v_mul_f32 v49, v49, v107
 v_mul_f32 v50, v50, v107
 v_mul_f32 v51, v51, v107
 v_mul_f32 v52, v52, v107
 v_mul_f32 v53, v53, v107
 v_mul_f32 v54, v54, v107
 v_mul_f32 v55, v55, v107
 v_mul_f32 v56, v56, v107
 v_mul_f32 v57, v57, v107
 v_mul_f32 v58, v58, v107
 v_mul_f32 v59, v59, v107
 v_exp_f32 v16, v16
 v_exp_f32 v17, v17
 v_exp_f32 v18, v18
 v_exp_f32 v19, v19
 v_exp_f32 v20, v20
 v_exp_f32 v21, v21
 v_exp_f32 v22, v22
 v_exp_f32 v23, v23
 v_exp_f32 v24, v24
 v_exp_f32 v25, v25
 v_exp_f32 v26, v26
 v_exp_f32 v27, v27
 v_exp_f32 v28, v28
 v_exp_f32 v29, v29
 v_exp_f32 v30, v30
 v_exp_f32 v31, v31
 s_nop 0
 v_cvt_pk_bf16_f32 v96, v16, v17
 v_cvt_pk_bf16_f32 v97, v18, v19
 v_cvt_pk_bf16_f32 v98, v20, v21
 v_cvt_pk_bf16_f32 v99, v22, v23
 v_cvt_pk_bf16_f32 v100, v24, v25
 v_cvt_pk_bf16_f32 v101, v26, v27
 v_cvt_pk_bf16_f32 v102, v28, v29
 v_cvt_pk_bf16_f32 v103, v30, v31
 s_nop 0
 v_mfma_f32_32x32x16_bf16 v[48:63], v[80:83], v[96:99], v[48:63]
 v_mfma_f32_32x32x16_bf16 v[48:63], v[84:87], v[100:103], v[48:63]
 s_nop 7
 v_max3_f32 v106, v32, v33, v34
 v_max3_f32 v106, v106, v35, v36
 v_max3_f32 v106, v106, v37, v38
 v_max3_f32 v106, v106, v39, v40
 v_max3_f32 v106, v106, v41, v42
 v_max3_f32 v106, v106, v43, v44
 v_max3_f32 v106, v106, v45, v46
 v_max_f32 v106, v106, v47
 v_mov_b32 v107, v106
 s_nop 1
 v_permlane32_swap_b32 v106, v107
 v_max3_f32 v106, v106, v107, v104
 v_sub_f32 v107, v104, v106
 v_exp_f32 v107, v107
 v_mov_b32 v104, v106
 v_sub_f32 v32, v32, v106
 v_sub_f32 v33, v33, v106
 v_sub_f32 v34, v34, v106
 v_sub_f32 v35, v35, v106
 v_sub_f32 v36, v36, v106
 v_sub_f32 v37, v37, v106
 v_sub_f32 v38, v38, v106
 v_sub_f32 v39, v39, v106
 v_sub_f32 v40, v40, v106
 v_sub_f32 v41, v41, v106
 v_sub_f32 v42, v42, v106
 v_sub_f32 v43, v43, v106
 v_sub_f32 v44, v44, v106
 v_sub_f32 v45, v45, v106
 v_sub_f32 v46, v46, v106
 v_sub_f32 v47, v47, v106
 v_mul_f32 v48, v48, v107
 v_mul_f32 v49, v49, v107
 v_mul_f32 v50, v50, v107
 v_mul_f32 v51, v51, v107
 v_mul_f32 v52, v52, v107
 v_mul_f32 v53, v53, v107
 v_mul_f32 v54, v54, v107
 v_mul_f32 v55, v55, v107
 v_mul_f32 v56, v56, v107
 v_mul_f32 v57, v57, v107
 v_mul_f32 v58, v58, v107
 v_mul_f32 v59, v59, v107
 v_exp_f32 v32, v32
 v_exp_f32 v33, v33
 v_exp_f32 v34, v34
 v_exp_f32 v35, v35
 v_exp_f32 v36, v36
 v_exp_f32 v37, v37
 v_exp_f32 v38, v38
 v_exp_f32 v39, v39
 v_exp_f32 v40, v40
 v_exp_f32 v41, v41
 v_exp_f32 v42, v42
 v_exp_f32 v43, v43
 v_exp_f32 v44, v44
 v_exp_f32 v45, v45
 v_exp_f32 v46, v46
 v_exp_f32 v47, v47
 s_nop 0
 v_cvt_pk_bf16_f32 v96, v32, v33
 v_cvt_pk_bf16_f32 v97, v34, v35
 v_cvt_pk_bf16_f32 v98, v36, v37
 v_cvt_pk_bf16_f32 v99, v38, v39
 v_cvt_pk_bf16_f32 v100, v40, v41
 v_cvt_pk_bf16_f32 v101, v42, v43
 v_cvt_pk_bf16_f32 v102, v44, v45
 v_cvt_pk_bf16_f32 v103, v46, v47
 s_waitcnt lgkmcnt(0)
 s_nop 0
 v_mfma_f32_32x32x16_bf16 v[48:63], v[88:91], v[96:99], v[48:63]
 v_mfma_f32_32x32x16_bf16 v[48:63], v[92:95], v[100:103], v[48:63]
 s_waitcnt vmcnt(0)
 v_cndmask_b32 v120, v120, v5, s[26:27]
 v_cndmask_b32 v121, v121, v5, s[26:27]
 v_cndmask_b32 v122, v122, v5, s[26:27]
 v_cndmask_b32 v123, v123, v5, s[26:27]
 v_cndmask_b32 v124, v124, v5, s[26:27]
 v_cndmask_b32 v125, v125, v5, s[26:27]
 v_cndmask_b32 v126, v126, v5, s[26:27]
 v_cndmask_b32 v127, v127, v5, s[26:27]
 ds_write_b128 v4, v[112:115] offset:32768
 ds_write_b128 v4, v[116:119] offset:40960
 ds_write_b128 v4, v[120:123] offset:49152
 ds_write_b128 v4, v[124:127] offset:57344
 s_waitcnt lgkmcnt(0)
 s_barrier
 s_mov_b32 s28, 98304
 s_mov_b32 s29, 4292608
 buffer_load_dwordx4 v[112:115], v4, s[12:15], s28 offen offset:0
 buffer_load_dwordx4 v[116:119], v6, s[12:15], s28 offen
 buffer_load_dwordx4 v[120:123], v4, s[12:15], s29 offen
 buffer_load_dwordx4 v[124:127], v6, s[12:15], s29 offen
 ds_read_b128 v[64:67], v7 offset:32768
 ds_read_b64 v[68:69], v3 offset:33792
 ds_read_b128 v[80:83], v2 offset:32768
 ds_read_b128 v[84:87], v2 offset:33792
 s_waitcnt lgkmcnt(2)
 v_mfma_f32_32x32x16_bf16 v[16:31], v[64:67], v[8:11], 0
 v_mfma_f32_32x32x16_bf16 v[16:31], v[68:71], v[12:15], v[16:31]
 ds_read_b128 v[72:75], v7 offset:34816
 ds_read_b64 v[76:77], v3 offset:35840
 ds_read_b128 v[88:91], v2 offset:34816
 ds_read_b128 v[92:95], v2 offset:35840
 s_waitcnt lgkmcnt(2)
 v_mfma_f32_32x32x16_bf16 v[32:47], v[72:75], v[8:11], 0
 v_mfma_f32_32x32x16_bf16 v[32:47], v[76:79], v[12:15], v[32:47]
 v_max3_f32 v106, v16, v17, v18
 v_max3_f32 v106, v106, v19, v20
 v_max3_f32 v106, v106, v21, v22
 v_max3_f32 v106, v106, v23, v24
 v_max3_f32 v106, v106, v25, v26
 v_max3_f32 v106, v106, v27, v28
 v_max3_f32 v106, v106, v29, v30
 v_max_f32 v106, v106, v31
 v_mov_b32 v107, v106
 s_nop 1
 v_permlane32_swap_b32 v106, v107
 v_max3_f32 v106, v106, v107, v104
 v_sub_f32 v107, v104, v106
 v_exp_f32 v107, v107
 v_mov_b32 v104, v106
 v_sub_f32 v16, v16, v106
 v_sub_f32 v17, v17, v106
 v_sub_f32 v18, v18, v106
 v_sub_f32 v19, v19, v106
 v_sub_f32 v20, v20, v106
 v_sub_f32 v21, v21, v106
 v_sub_f32 v22, v22, v106
 v_sub_f32 v23, v23, v106
 v_sub_f32 v24, v24, v106
 v_sub_f32 v25, v25, v106
 v_sub_f32 v26, v26, v106
 v_sub_f32 v27, v27, v106
 v_sub_f32 v28, v28, v106
 v_sub_f32 v29, v29, v106
 v_sub_f32 v30, v30, v106
 v_sub_f32 v31, v31, v106
 v_mul_f32 v48, v48, v107
 v_mul_f32 v49, v49, v107
 v_mul_f32 v50, v50, v107
 v_mul_f32 v51, v51, v107
 v_mul_f32 v52, v52, v107
 v_mul_f32 v53, v53, v107
 v_mul_f32 v54, v54, v107
 v_mul_f32 v55, v55, v107
 v_mul_f32 v56, v56, v107
 v_mul_f32 v57, v57, v107
 v_mul_f32 v58, v58, v107
 v_mul_f32 v59, v59, v107
 v_exp_f32 v16, v16
 v_exp_f32 v17, v17
 v_exp_f32 v18, v18
 v_exp_f32 v19, v19
 v_exp_f32 v20, v20
 v_exp_f32 v21, v21
 v_exp_f32 v22, v22
 v_exp_f32 v23, v23
 v_exp_f32 v24, v24
 v_exp_f32 v25, v25
 v_exp_f32 v26, v26
 v_exp_f32 v27, v27
 v_exp_f32 v28, v28
 v_exp_f32 v29, v29
 v_exp_f32 v30, v30
 v_exp_f32 v31, v31
 s_nop 0
 v_cvt_pk_bf16_f32 v96, v16, v17
 v_cvt_pk_bf16_f32 v97, v18, v19
 v_cvt_pk_bf16_f32 v98, v20, v21
 v_cvt_pk_bf16_f32 v99, v22, v23
 v_cvt_pk_bf16_f32 v100, v24, v25
 v_cvt_pk_bf16_f32 v101, v26, v27
 v_cvt_pk_bf16_f32 v102, v28, v29
 v_cvt_pk_bf16_f32 v103, v30, v31
 s_nop 0
 v_mfma_f32_32x32x16_bf16 v[48:63], v[80:83], v[96:99], v[48:63]
 v_mfma_f32_32x32x16_bf16 v[48:63], v[84:87], v[100:103], v[48:63]
 ds_read_b128 v[64:67], v7 offset:36864
 ds_read_b64 v[68:69], v3 offset:37888
 ds_read_b128 v[80:83], v2 offset:36864
 ds_read_b128 v[84:87], v2 offset:37888
 s_waitcnt lgkmcnt(2)
 v_mfma_f32_32x32x16_bf16 v[16:31], v[64:67], v[8:11], 0
 v_mfma_f32_32x32x16_bf16 v[16:31], v[68:71], v[12:15], v[16:31]
 v_max3_f32 v106, v32, v33, v34
 v_max3_f32 v106, v106, v35, v36
 v_max3_f32 v106, v106, v37, v38
 v_max3_f32 v106, v106, v39, v40
 v_max3_f32 v106, v106, v41, v42
 v_max3_f32 v106, v106, v43, v44
 v_max3_f32 v106, v106, v45, v46
 v_max_f32 v106, v106, v47
 v_mov_b32 v107, v106
 s_nop 1
 v_permlane32_swap_b32 v106, v107
 v_max3_f32 v106, v106, v107, v104
 v_sub_f32 v107, v104, v106
 v_exp_f32 v107, v107
 v_mov_b32 v104, v106
 v_sub_f32 v32, v32, v106
 v_sub_f32 v33, v33, v106
 v_sub_f32 v34, v34, v106
 v_sub_f32 v35, v35, v106
 v_sub_f32 v36, v36, v106
 v_sub_f32 v37, v37, v106
 v_sub_f32 v38, v38, v106
 v_sub_f32 v39, v39, v106
 v_sub_f32 v40, v40, v106
 v_sub_f32 v41, v41, v106
 v_sub_f32 v42, v42, v106
 v_sub_f32 v43, v43, v106
 v_sub_f32 v44, v44, v106
 v_sub_f32 v45, v45, v106
 v_sub_f32 v46, v46, v106
 v_sub_f32 v47, v47, v106
 v_mul_f32 v48, v48, v107
 v_mul_f32 v49, v49, v107
 v_mul_f32 v50, v50, v107
 v_mul_f32 v51, v51, v107
 v_mul_f32 v52, v52, v107
 v_mul_f32 v53, v53, v107
 v_mul_f32 v54, v54, v107
 v_mul_f32 v55, v55, v107
 v_mul_f32 v56, v56, v107
 v_mul_f32 v57, v57, v107
 v_mul_f32 v58, v58, v107
 v_mul_f32 v59, v59, v107
 v_exp_f32 v32, v32
 v_exp_f32 v33, v33
 v_exp_f32 v34, v34
 v_exp_f32 v35, v35
 v_exp_f32 v36, v36
 v_exp_f32 v37, v37
 v_exp_f32 v38, v38
 v_exp_f32 v39, v39
 v_exp_f32 v40, v40
 v_exp_f32 v41, v41
 v_exp_f32 v42, v42
 v_exp_f32 v43, v43
 v_exp_f32 v44, v44
 v_exp_f32 v45, v45
 v_exp_f32 v46, v46
 v_exp_f32 v47, v47
 s_nop 0
 v_cvt_pk_bf16_f32 v96, v32, v33
 v_cvt_pk_bf16_f32 v97, v34, v35
 v_cvt_pk_bf16_f32 v98, v36, v37
 v_cvt_pk_bf16_f32 v99, v38, v39
 v_cvt_pk_bf16_f32 v100, v40, v41
 v_cvt_pk_bf16_f32 v101, v42, v43
 v_cvt_pk_bf16_f32 v102, v44, v45
 v_cvt_pk_bf16_f32 v103, v46, v47
 s_nop 0
 v_mfma_f32_32x32x16_bf16 v[48:63], v[88:91], v[96:99], v[48:63]
 v_mfma_f32_32x32x16_bf16 v[48:63], v[92:95], v[100:103], v[48:63]
 ds_read_b128 v[72:75], v7 offset:38912
 ds_read_b64 v[76:77], v3 offset:39936
 ds_read_b128 v[88:91], v2 offset:38912
 ds_read_b128 v[92:95], v2 offset:39936
 s_waitcnt lgkmcnt(2)
 v_mfma_f32_32x32x16_bf16 v[32:47], v[72:75], v[8:11], 0
 v_mfma_f32_32x32x16_bf16 v[32:47], v[76:79], v[12:15], v[32:47]
 v_max3_f32 v106, v16, v17, v18
 v_max3_f32 v106, v106, v19, v20
 v_max3_f32 v106, v106, v21, v22
 v_max3_f32 v106, v106, v23, v24
 v_max3_f32 v106, v106, v25, v26
 v_max3_f32 v106, v106, v27, v28
 v_max3_f32 v106, v106, v29, v30
 v_max_f32 v106, v106, v31
 v_mov_b32 v107, v106
 s_nop 1
 v_permlane32_swap_b32 v106, v107
 v_max3_f32 v106, v106, v107, v104
 v_sub_f32 v107, v104, v106
 v_exp_f32 v107, v107
 v_mov_b32 v104, v106
 v_sub_f32 v16, v16, v106
 v_sub_f32 v17, v17, v106
 v_sub_f32 v18, v18, v106
 v_sub_f32 v19, v19, v106
 v_sub_f32 v20, v20, v106
 v_sub_f32 v21, v21, v106
 v_sub_f32 v22, v22, v106
 v_sub_f32 v23, v23, v106
 v_sub_f32 v24, v24, v106
 v_sub_f32 v25, v25, v106
 v_sub_f32 v26, v26, v106
 v_sub_f32 v27, v27, v106
 v_sub_f32 v28, v28, v106
 v_sub_f32 v29, v29, v106
 v_sub_f32 v30, v30, v106
 v_sub_f32 v31, v31, v106
 v_mul_f32 v48, v48, v107
 v_mul_f32 v49, v49, v107
 v_mul_f32 v50, v50, v107
 v_mul_f32 v51, v51, v107
 v_mul_f32 v52, v52, v107
 v_mul_f32 v53, v53, v107
 v_mul_f32 v54, v54, v107
 v_mul_f32 v55, v55, v107
 v_mul_f32 v56, v56, v107
 v_mul_f32 v57, v57, v107
 v_mul_f32 v58, v58, v107
 v_mul_f32 v59, v59, v107
 v_exp_f32 v16, v16
 v_exp_f32 v17, v17
 v_exp_f32 v18, v18
 v_exp_f32 v19, v19
 v_exp_f32 v20, v20
 v_exp_f32 v21, v21
 v_exp_f32 v22, v22
 v_exp_f32 v23, v23
 v_exp_f32 v24, v24
 v_exp_f32 v25, v25
 v_exp_f32 v26, v26
 v_exp_f32 v27, v27
 v_exp_f32 v28, v28
 v_exp_f32 v29, v29
 v_exp_f32 v30, v30
 v_exp_f32 v31, v31
 s_nop 0
 v_cvt_pk_bf16_f32 v96, v16, v17
 v_cvt_pk_bf16_f32 v97, v18, v19
 v_cvt_pk_bf16_f32 v98, v20, v21
 v_cvt_pk_bf16_f32 v99, v22, v23
 v_cvt_pk_bf16_f32 v100, v24, v25
 v_cvt_pk_bf16_f32 v101, v26, v27
 v_cvt_pk_bf16_f32 v102, v28, v29
 v_cvt_pk_bf16_f32 v103, v30, v31
 s_nop 0
 v_mfma_f32_32x32x16_bf16 v[48:63], v[80:83], v[96:99], v[48:63]
 v_mfma_f32_32x32x16_bf16 v[48:63], v[84:87], v[100:103], v[48:63]
 ds_read_b128 v[64:67], v7 offset:40960
 ds_read_b64 v[68:69], v3 offset:41984
 ds_read_b128 v[80:83], v2 offset:40960
 ds_read_b128 v[84:87], v2 offset:41984
 s_waitcnt lgkmcnt(2)
 v_mfma_f32_32x32x16_bf16 v[16:31], v[64:67], v[8:11], 0
 v_mfma_f32_32x32x16_bf16 v[16:31], v[68:71], v[12:15], v[16:31]
 v_max3_f32 v106, v32, v33, v34
 v_max3_f32 v106, v106, v35, v36
 v_max3_f32 v106, v106, v37, v38
 v_max3_f32 v106, v106, v39, v40
 v_max3_f32 v106, v106, v41, v42
 v_max3_f32 v106, v106, v43, v44
 v_max3_f32 v106, v106, v45, v46
 v_max_f32 v106, v106, v47
 v_mov_b32 v107, v106
 s_nop 1
 v_permlane32_swap_b32 v106, v107
 v_max3_f32 v106, v106, v107, v104
 v_sub_f32 v107, v104, v106
 v_exp_f32 v107, v107
 v_mov_b32 v104, v106
 v_sub_f32 v32, v32, v106
 v_sub_f32 v33, v33, v106
 v_sub_f32 v34, v34, v106
 v_sub_f32 v35, v35, v106
 v_sub_f32 v36, v36, v106
 v_sub_f32 v37, v37, v106
 v_sub_f32 v38, v38, v106
 v_sub_f32 v39, v39, v106
 v_sub_f32 v40, v40, v106
 v_sub_f32 v41, v41, v106
 v_sub_f32 v42, v42, v106
 v_sub_f32 v43, v43, v106
 v_sub_f32 v44, v44, v106
 v_sub_f32 v45, v45, v106
 v_sub_f32 v46, v46, v106
 v_sub_f32 v47, v47, v106
 v_mul_f32 v48, v48, v107
 v_mul_f32 v49, v49, v107
 v_mul_f32 v50, v50, v107
 v_mul_f32 v51, v51, v107
 v_mul_f32 v52, v52, v107
 v_mul_f32 v53, v53, v107
 v_mul_f32 v54, v54, v107
 v_mul_f32 v55, v55, v107
 v_mul_f32 v56, v56, v107
 v_mul_f32 v57, v57, v107
 v_mul_f32 v58, v58, v107
 v_mul_f32 v59, v59, v107
 v_exp_f32 v32, v32
 v_exp_f32 v33, v33
 v_exp_f32 v34, v34
 v_exp_f32 v35, v35
 v_exp_f32 v36, v36
 v_exp_f32 v37, v37
 v_exp_f32 v38, v38
 v_exp_f32 v39, v39
 v_exp_f32 v40, v40
 v_exp_f32 v41, v41
 v_exp_f32 v42, v42
 v_exp_f32 v43, v43
 v_exp_f32 v44, v44
 v_exp_f32 v45, v45
 v_exp_f32 v46, v46
 v_exp_f32 v47, v47
 s_nop 0
 v_cvt_pk_bf16_f32 v96, v32, v33
 v_cvt_pk_bf16_f32 v97, v34, v35
 v_cvt_pk_bf16_f32 v98, v36, v37
 v_cvt_pk_bf16_f32 v99, v38, v39
 v_cvt_pk_bf16_f32 v100, v40, v41
 v_cvt_pk_bf16_f32 v101, v42, v43
 v_cvt_pk_bf16_f32 v102, v44, v45
 v_cvt_pk_bf16_f32 v103, v46, v47
 s_nop 0
 v_mfma_f32_32x32x16_bf16 v[48:63], v[88:91], v[96:99], v[48:63]
 v_mfma_f32_32x32x16_bf16 v[48:63], v[92:95], v[100:103], v[48:63]
 ds_read_b128 v[72:75], v7 offset:43008
 ds_read_b64 v[76:77], v3 offset:44032
 ds_read_b128 v[88:91], v2 offset:43008
 ds_read_b128 v[92:95], v2 offset:44032
 s_waitcnt lgkmcnt(2)
 v_mfma_f32_32x32x16_bf16 v[32:47], v[72:75], v[8:11], 0
 v_mfma_f32_32x32x16_bf16 v[32:47], v[76:79], v[12:15], v[32:47]
 v_max3_f32 v106, v16, v17, v18
 v_max3_f32 v106, v106, v19, v20
 v_max3_f32 v106, v106, v21, v22
 v_max3_f32 v106, v106, v23, v24
 v_max3_f32 v106, v106, v25, v26
 v_max3_f32 v106, v106, v27, v28
 v_max3_f32 v106, v106, v29, v30
 v_max_f32 v106, v106, v31
 v_mov_b32 v107, v106
 s_nop 1
 v_permlane32_swap_b32 v106, v107
 v_max3_f32 v106, v106, v107, v104
 v_sub_f32 v107, v104, v106
 v_exp_f32 v107, v107
 v_mov_b32 v104, v106
 v_sub_f32 v16, v16, v106
 v_sub_f32 v17, v17, v106
 v_sub_f32 v18, v18, v106
 v_sub_f32 v19, v19, v106
 v_sub_f32 v20, v20, v106
 v_sub_f32 v21, v21, v106
 v_sub_f32 v22, v22, v106
 v_sub_f32 v23, v23, v106
 v_sub_f32 v24, v24, v106
 v_sub_f32 v25, v25, v106
 v_sub_f32 v26, v26, v106
 v_sub_f32 v27, v27, v106
 v_sub_f32 v28, v28, v106
 v_sub_f32 v29, v29, v106
 v_sub_f32 v30, v30, v106
 v_sub_f32 v31, v31, v106
 v_mul_f32 v48, v48, v107
 v_mul_f32 v49, v49, v107
 v_mul_f32 v50, v50, v107
 v_mul_f32 v51, v51, v107
 v_mul_f32 v52, v52, v107
 v_mul_f32 v53, v53, v107
 v_mul_f32 v54, v54, v107
 v_mul_f32 v55, v55, v107
 v_mul_f32 v56, v56, v107
 v_mul_f32 v57, v57, v107
 v_mul_f32 v58, v58, v107
 v_mul_f32 v59, v59, v107
 v_exp_f32 v16, v16
 v_exp_f32 v17, v17
 v_exp_f32 v18, v18
 v_exp_f32 v19, v19
 v_exp_f32 v20, v20
 v_exp_f32 v21, v21
 v_exp_f32 v22, v22
 v_exp_f32 v23, v23
 v_exp_f32 v24, v24
 v_exp_f32 v25, v25
 v_exp_f32 v26, v26
 v_exp_f32 v27, v27
 v_exp_f32 v28, v28
 v_exp_f32 v29, v29
 v_exp_f32 v30, v30
 v_exp_f32 v31, v31
 s_nop 0
 v_cvt_pk_bf16_f32 v96, v16, v17
 v_cvt_pk_bf16_f32 v97, v18, v19
 v_cvt_pk_bf16_f32 v98, v20, v21
 v_cvt_pk_bf16_f32 v99, v22, v23
 v_cvt_pk_bf16_f32 v100, v24, v25
 v_cvt_pk_bf16_f32 v101, v26, v27
 v_cvt_pk_bf16_f32 v102, v28, v29
 v_cvt_pk_bf16_f32 v103, v30, v31
 s_nop 0
 v_mfma_f32_32x32x16_bf16 v[48:63], v[80:83], v[96:99], v[48:63]
 v_mfma_f32_32x32x16_bf16 v[48:63], v[84:87], v[100:103], v[48:63]
 ds_read_b128 v[64:67], v7 offset:45056
 ds_read_b64 v[68:69], v3 offset:46080
 ds_read_b128 v[80:83], v2 offset:45056
 ds_read_b128 v[84:87], v2 offset:46080
 s_waitcnt lgkmcnt(2)
 v_mfma_f32_32x32x16_bf16 v[16:31], v[64:67], v[8:11], 0
 v_mfma_f32_32x32x16_bf16 v[16:31], v[68:71], v[12:15], v[16:31]
 v_max3_f32 v106, v32, v33, v34
 v_max3_f32 v106, v106, v35, v36
 v_max3_f32 v106, v106, v37, v38
 v_max3_f32 v106, v106, v39, v40
 v_max3_f32 v106, v106, v41, v42
 v_max3_f32 v106, v106, v43, v44
 v_max3_f32 v106, v106, v45, v46
 v_max_f32 v106, v106, v47
 v_mov_b32 v107, v106
 s_nop 1
 v_permlane32_swap_b32 v106, v107
 v_max3_f32 v106, v106, v107, v104
 v_sub_f32 v107, v104, v106
 v_exp_f32 v107, v107
 v_mov_b32 v104, v106
 v_sub_f32 v32, v32, v106
 v_sub_f32 v33, v33, v106
 v_sub_f32 v34, v34, v106
 v_sub_f32 v35, v35, v106
 v_sub_f32 v36, v36, v106
 v_sub_f32 v37, v37, v106
 v_sub_f32 v38, v38, v106
 v_sub_f32 v39, v39, v106
 v_sub_f32 v40, v40, v106
 v_sub_f32 v41, v41, v106
 v_sub_f32 v42, v42, v106
 v_sub_f32 v43, v43, v106
 v_sub_f32 v44, v44, v106
 v_sub_f32 v45, v45, v106
 v_sub_f32 v46, v46, v106
 v_sub_f32 v47, v47, v106
 v_mul_f32 v48, v48, v107
 v_mul_f32 v49, v49, v107
 v_mul_f32 v50, v50, v107
 v_mul_f32 v51, v51, v107
 v_mul_f32 v52, v52, v107
 v_mul_f32 v53, v53, v107
 v_mul_f32 v54, v54, v107
 v_mul_f32 v55, v55, v107
 v_mul_f32 v56, v56, v107
 v_mul_f32 v57, v57, v107
 v_mul_f32 v58, v58, v107
 v_mul_f32 v59, v59, v107
 v_exp_f32 v32, v32
 v_exp_f32 v33, v33
 v_exp_f32 v34, v34
 v_exp_f32 v35, v35
 v_exp_f32 v36, v36
 v_exp_f32 v37, v37
 v_exp_f32 v38, v38
 v_exp_f32 v39, v39
 v_exp_f32 v40, v40
 v_exp_f32 v41, v41
 v_exp_f32 v42, v42
 v_exp_f32 v43, v43
 v_exp_f32 v44, v44
 v_exp_f32 v45, v45
 v_exp_f32 v46, v46
 v_exp_f32 v47, v47
 s_nop 0
 v_cvt_pk_bf16_f32 v96, v32, v33
 v_cvt_pk_bf16_f32 v97, v34, v35
 v_cvt_pk_bf16_f32 v98, v36, v37
 v_cvt_pk_bf16_f32 v99, v38, v39
 v_cvt_pk_bf16_f32 v100, v40, v41
 v_cvt_pk_bf16_f32 v101, v42, v43
 v_cvt_pk_bf16_f32 v102, v44, v45
 v_cvt_pk_bf16_f32 v103, v46, v47
 s_nop 0
 v_mfma_f32_32x32x16_bf16 v[48:63], v[88:91], v[96:99], v[48:63]
 v_mfma_f32_32x32x16_bf16 v[48:63], v[92:95], v[100:103], v[48:63]
 ds_read_b128 v[72:75], v7 offset:47104
 ds_read_b64 v[76:77], v3 offset:48128
 ds_read_b128 v[88:91], v2 offset:47104
 ds_read_b128 v[92:95], v2 offset:48128
 s_waitcnt lgkmcnt(2)
 v_mfma_f32_32x32x16_bf16 v[32:47], v[72:75], v[8:11], 0
 v_mfma_f32_32x32x16_bf16 v[32:47], v[76:79], v[12:15], v[32:47]
 v_max3_f32 v106, v16, v17, v18
 v_max3_f32 v106, v106, v19, v20
 v_max3_f32 v106, v106, v21, v22
 v_max3_f32 v106, v106, v23, v24
 v_max3_f32 v106, v106, v25, v26
 v_max3_f32 v106, v106, v27, v28
 v_max3_f32 v106, v106, v29, v30
 v_max_f32 v106, v106, v31
 v_mov_b32 v107, v106
 s_nop 1
 v_permlane32_swap_b32 v106, v107
 v_max3_f32 v106, v106, v107, v104
 v_sub_f32 v107, v104, v106
 v_exp_f32 v107, v107
 v_mov_b32 v104, v106
 v_sub_f32 v16, v16, v106
 v_sub_f32 v17, v17, v106
 v_sub_f32 v18, v18, v106
 v_sub_f32 v19, v19, v106
 v_sub_f32 v20, v20, v106
 v_sub_f32 v21, v21, v106
 v_sub_f32 v22, v22, v106
 v_sub_f32 v23, v23, v106
 v_sub_f32 v24, v24, v106
 v_sub_f32 v25, v25, v106
 v_sub_f32 v26, v26, v106
 v_sub_f32 v27, v27, v106
 v_sub_f32 v28, v28, v106
 v_sub_f32 v29, v29, v106
 v_sub_f32 v30, v30, v106
 v_sub_f32 v31, v31, v106
 v_mul_f32 v48, v48, v107
 v_mul_f32 v49, v49, v107
 v_mul_f32 v50, v50, v107
 v_mul_f32 v51, v51, v107
 v_mul_f32 v52, v52, v107
 v_mul_f32 v53, v53, v107
 v_mul_f32 v54, v54, v107
 v_mul_f32 v55, v55, v107
 v_mul_f32 v56, v56, v107
 v_mul_f32 v57, v57, v107
 v_mul_f32 v58, v58, v107
 v_mul_f32 v59, v59, v107
 v_exp_f32 v16, v16
 v_exp_f32 v17, v17
 v_exp_f32 v18, v18
 v_exp_f32 v19, v19
 v_exp_f32 v20, v20
 v_exp_f32 v21, v21
 v_exp_f32 v22, v22
 v_exp_f32 v23, v23
 v_exp_f32 v24, v24
 v_exp_f32 v25, v25
 v_exp_f32 v26, v26
 v_exp_f32 v27, v27
 v_exp_f32 v28, v28
 v_exp_f32 v29, v29
 v_exp_f32 v30, v30
 v_exp_f32 v31, v31
 s_nop 0
 v_cvt_pk_bf16_f32 v96, v16, v17
 v_cvt_pk_bf16_f32 v97, v18, v19
 v_cvt_pk_bf16_f32 v98, v20, v21
 v_cvt_pk_bf16_f32 v99, v22, v23
 v_cvt_pk_bf16_f32 v100, v24, v25
 v_cvt_pk_bf16_f32 v101, v26, v27
 v_cvt_pk_bf16_f32 v102, v28, v29
 v_cvt_pk_bf16_f32 v103, v30, v31
 s_nop 0
 v_mfma_f32_32x32x16_bf16 v[48:63], v[80:83], v[96:99], v[48:63]
 v_mfma_f32_32x32x16_bf16 v[48:63], v[84:87], v[100:103], v[48:63]
 s_nop 7
 v_max3_f32 v106, v32, v33, v34
 v_max3_f32 v106, v106, v35, v36
 v_max3_f32 v106, v106, v37, v38
 v_max3_f32 v106, v106, v39, v40
 v_max3_f32 v106, v106, v41, v42
 v_max3_f32 v106, v106, v43, v44
 v_max3_f32 v106, v106, v45, v46
 v_max_f32 v106, v106, v47
 v_mov_b32 v107, v106
 s_nop 1
 v_permlane32_swap_b32 v106, v107
 v_max3_f32 v106, v106, v107, v104
 v_sub_f32 v107, v104, v106
 v_exp_f32 v107, v107
 v_mov_b32 v104, v106
 v_sub_f32 v32, v32, v106
 v_sub_f32 v33, v33, v106
 v_sub_f32 v34, v34, v106
 v_sub_f32 v35, v35, v106
 v_sub_f32 v36, v36, v106
 v_sub_f32 v37, v37, v106
 v_sub_f32 v38, v38, v106
 v_sub_f32 v39, v39, v106
 v_sub_f32 v40, v40, v106
 v_sub_f32 v41, v41, v106
 v_sub_f32 v42, v42, v106
 v_sub_f32 v43, v43, v106
 v_sub_f32 v44, v44, v106
 v_sub_f32 v45, v45, v106
 v_sub_f32 v46, v46, v106
 v_sub_f32 v47, v47, v106
 v_mul_f32 v48, v48, v107
 v_mul_f32 v49, v49, v107
 v_mul_f32 v50, v50, v107
 v_mul_f32 v51, v51, v107
 v_mul_f32 v52, v52, v107
 v_mul_f32 v53, v53, v107
 v_mul_f32 v54, v54, v107
 v_mul_f32 v55, v55, v107
 v_mul_f32 v56, v56, v107
 v_mul_f32 v57, v57, v107
 v_mul_f32 v58, v58, v107
 v_mul_f32 v59, v59, v107
 v_exp_f32 v32, v32
 v_exp_f32 v33, v33
 v_exp_f32 v34, v34
 v_exp_f32 v35, v35
 v_exp_f32 v36, v36
 v_exp_f32 v37, v37
 v_exp_f32 v38, v38
 v_exp_f32 v39, v39
 v_exp_f32 v40, v40
 v_exp_f32 v41, v41
 v_exp_f32 v42, v42
 v_exp_f32 v43, v43
 v_exp_f32 v44, v44
 v_exp_f32 v45, v45
 v_exp_f32 v46, v46
 v_exp_f32 v47, v47
 s_nop 0
 v_cvt_pk_bf16_f32 v96, v32, v33
 v_cvt_pk_bf16_f32 v97, v34, v35
 v_cvt_pk_bf16_f32 v98, v36, v37
 v_cvt_pk_bf16_f32 v99, v38, v39
 v_cvt_pk_bf16_f32 v100, v40, v41
 v_cvt_pk_bf16_f32 v101, v42, v43
 v_cvt_pk_bf16_f32 v102, v44, v45
 v_cvt_pk_bf16_f32 v103, v46, v47
 s_waitcnt lgkmcnt(0)
 s_nop 0
 v_mfma_f32_32x32x16_bf16 v[48:63], v[88:91], v[96:99], v[48:63]
 v_mfma_f32_32x32x16_bf16 v[48:63], v[92:95], v[100:103], v[48:63]
 s_waitcnt vmcnt(0)
 v_cndmask_b32 v120, v120, v5, s[26:27]
 v_cndmask_b32 v121, v121, v5, s[26:27]
 v_cndmask_b32 v122, v122, v5, s[26:27]
 v_cndmask_b32 v123, v123, v5, s[26:27]
 v_cndmask_b32 v124, v124, v5, s[26:27]
 v_cndmask_b32 v125, v125, v5, s[26:27]
 v_cndmask_b32 v126, v126, v5, s[26:27]
 v_cndmask_b32 v127, v127, v5, s[26:27]
 ds_write_b128 v4, v[112:115] offset:0
 ds_write_b128 v4, v[116:119] offset:8192
 ds_write_b128 v4, v[120:123] offset:16384
 ds_write_b128 v4, v[124:127] offset:24576
 s_waitcnt lgkmcnt(0)
 s_barrier
 s_mov_b32 s28, 114688
 s_mov_b32 s29, 4308992
 buffer_load_dwordx4 v[112:115], v4, s[12:15], s28 offen offset:0
 buffer_load_dwordx4 v[116:119], v6, s[12:15], s28 offen
 buffer_load_dwordx4 v[120:123], v4, s[12:15], s29 offen
 buffer_load_dwordx4 v[124:127], v6, s[12:15], s29 offen
 ds_read_b128 v[64:67], v7 offset:0
 ds_read_b64 v[68:69], v3 offset:1024
 ds_read_b128 v[80:83], v2 offset:0
 ds_read_b128 v[84:87], v2 offset:1024
 s_waitcnt lgkmcnt(2)
 v_mfma_f32_32x32x16_bf16 v[16:31], v[64:67], v[8:11], 0
 v_mfma_f32_32x32x16_bf16 v[16:31], v[68:71], v[12:15], v[16:31]
 ds_read_b128 v[72:75], v7 offset:2048
 ds_read_b64 v[76:77], v3 offset:3072
 ds_read_b128 v[88:91], v2 offset:2048
 ds_read_b128 v[92:95], v2 offset:3072
 s_waitcnt lgkmcnt(2)
 v_mfma_f32_32x32x16_bf16 v[32:47], v[72:75], v[8:11], 0
 v_mfma_f32_32x32x16_bf16 v[32:47], v[76:79], v[12:15], v[32:47]
 v_max3_f32 v106, v16, v17, v18
 v_max3_f32 v106, v106, v19, v20
 v_max3_f32 v106, v106, v21, v22
 v_max3_f32 v106, v106, v23, v24
 v_max3_f32 v106, v106, v25, v26
 v_max3_f32 v106, v106, v27, v28
 v_max3_f32 v106, v106, v29, v30
 v_max_f32 v106, v106, v31
 v_mov_b32 v107, v106
 s_nop 1
 v_permlane32_swap_b32 v106, v107
 v_max3_f32 v106, v106, v107, v104
 v_sub_f32 v107, v104, v106
 v_exp_f32 v107, v107
 v_mov_b32 v104, v106
 v_sub_f32 v16, v16, v106
 v_sub_f32 v17, v17, v106
 v_sub_f32 v18, v18, v106
 v_sub_f32 v19, v19, v106
 v_sub_f32 v20, v20, v106
 v_sub_f32 v21, v21, v106
 v_sub_f32 v22, v22, v106
 v_sub_f32 v23, v23, v106
 v_sub_f32 v24, v24, v106
 v_sub_f32 v25, v25, v106
 v_sub_f32 v26, v26, v106
 v_sub_f32 v27, v27, v106
 v_sub_f32 v28, v28, v106
 v_sub_f32 v29, v29, v106
 v_sub_f32 v30, v30, v106
 v_sub_f32 v31, v31, v106
 v_mul_f32 v48, v48, v107
 v_mul_f32 v49, v49, v107
 v_mul_f32 v50, v50, v107
 v_mul_f32 v51, v51, v107
 v_mul_f32 v52, v52, v107
 v_mul_f32 v53, v53, v107
 v_mul_f32 v54, v54, v107
 v_mul_f32 v55, v55, v107
 v_mul_f32 v56, v56, v107
 v_mul_f32 v57, v57, v107
 v_mul_f32 v58, v58, v107
 v_mul_f32 v59, v59, v107
 v_exp_f32 v16, v16
 v_exp_f32 v17, v17
 v_exp_f32 v18, v18
 v_exp_f32 v19, v19
 v_exp_f32 v20, v20
 v_exp_f32 v21, v21
 v_exp_f32 v22, v22
 v_exp_f32 v23, v23
 v_exp_f32 v24, v24
 v_exp_f32 v25, v25
 v_exp_f32 v26, v26
 v_exp_f32 v27, v27
 v_exp_f32 v28, v28
 v_exp_f32 v29, v29
 v_exp_f32 v30, v30
 v_exp_f32 v31, v31
 s_nop 0
 v_cvt_pk_bf16_f32 v96, v16, v17
 v_cvt_pk_bf16_f32 v97, v18, v19
 v_cvt_pk_bf16_f32 v98, v20, v21
 v_cvt_pk_bf16_f32 v99, v22, v23
 v_cvt_pk_bf16_f32 v100, v24, v25
 v_cvt_pk_bf16_f32 v101, v26, v27
 v_cvt_pk_bf16_f32 v102, v28, v29
 v_cvt_pk_bf16_f32 v103, v30, v31
 s_nop 0
 v_mfma_f32_32x32x16_bf16 v[48:63], v[80:83], v[96:99], v[48:63]
 v_mfma_f32_32x32x16_bf16 v[48:63], v[84:87], v[100:103], v[48:63]
 ds_read_b128 v[64:67], v7 offset:4096
 ds_read_b64 v[68:69], v3 offset:5120
 ds_read_b128 v[80:83], v2 offset:4096
 ds_read_b128 v[84:87], v2 offset:5120
 s_waitcnt lgkmcnt(2)
 v_mfma_f32_32x32x16_bf16 v[16:31], v[64:67], v[8:11], 0
 v_mfma_f32_32x32x16_bf16 v[16:31], v[68:71], v[12:15], v[16:31]
 v_max3_f32 v106, v32, v33, v34
 v_max3_f32 v106, v106, v35, v36
 v_max3_f32 v106, v106, v37, v38
 v_max3_f32 v106, v106, v39, v40
 v_max3_f32 v106, v106, v41, v42
 v_max3_f32 v106, v106, v43, v44
 v_max3_f32 v106, v106, v45, v46
 v_max_f32 v106, v106, v47
 v_mov_b32 v107, v106
 s_nop 1
 v_permlane32_swap_b32 v106, v107
 v_max3_f32 v106, v106, v107, v104
 v_sub_f32 v107, v104, v106
 v_exp_f32 v107, v107
 v_mov_b32 v104, v106
 v_sub_f32 v32, v32, v106
 v_sub_f32 v33, v33, v106
 v_sub_f32 v34, v34, v106
 v_sub_f32 v35, v35, v106
 v_sub_f32 v36, v36, v106
 v_sub_f32 v37, v37, v106
 v_sub_f32 v38, v38, v106
 v_sub_f32 v39, v39, v106
 v_sub_f32 v40, v40, v106
 v_sub_f32 v41, v41, v106
 v_sub_f32 v42, v42, v106
 v_sub_f32 v43, v43, v106
 v_sub_f32 v44, v44, v106
 v_sub_f32 v45, v45, v106
 v_sub_f32 v46, v46, v106
 v_sub_f32 v47, v47, v106
 v_mul_f32 v48, v48, v107
 v_mul_f32 v49, v49, v107
 v_mul_f32 v50, v50, v107
 v_mul_f32 v51, v51, v107
 v_mul_f32 v52, v52, v107
 v_mul_f32 v53, v53, v107
 v_mul_f32 v54, v54, v107
 v_mul_f32 v55, v55, v107
 v_mul_f32 v56, v56, v107
 v_mul_f32 v57, v57, v107
 v_mul_f32 v58, v58, v107
 v_mul_f32 v59, v59, v107
 v_exp_f32 v32, v32
 v_exp_f32 v33, v33
 v_exp_f32 v34, v34
 v_exp_f32 v35, v35
 v_exp_f32 v36, v36
 v_exp_f32 v37, v37
 v_exp_f32 v38, v38
 v_exp_f32 v39, v39
 v_exp_f32 v40, v40
 v_exp_f32 v41, v41
 v_exp_f32 v42, v42
 v_exp_f32 v43, v43
 v_exp_f32 v44, v44
 v_exp_f32 v45, v45
 v_exp_f32 v46, v46
 v_exp_f32 v47, v47
 s_nop 0
 v_cvt_pk_bf16_f32 v96, v32, v33
 v_cvt_pk_bf16_f32 v97, v34, v35
 v_cvt_pk_bf16_f32 v98, v36, v37
 v_cvt_pk_bf16_f32 v99, v38, v39
 v_cvt_pk_bf16_f32 v100, v40, v41
 v_cvt_pk_bf16_f32 v101, v42, v43
 v_cvt_pk_bf16_f32 v102, v44, v45
 v_cvt_pk_bf16_f32 v103, v46, v47
 s_nop 0
 v_mfma_f32_32x32x16_bf16 v[48:63], v[88:91], v[96:99], v[48:63]
 v_mfma_f32_32x32x16_bf16 v[48:63], v[92:95], v[100:103], v[48:63]
 ds_read_b128 v[72:75], v7 offset:6144
 ds_read_b64 v[76:77], v3 offset:7168
 ds_read_b128 v[88:91], v2 offset:6144
 ds_read_b128 v[92:95], v2 offset:7168
 s_waitcnt lgkmcnt(2)
 v_mfma_f32_32x32x16_bf16 v[32:47], v[72:75], v[8:11], 0
 v_mfma_f32_32x32x16_bf16 v[32:47], v[76:79], v[12:15], v[32:47]
 v_max3_f32 v106, v16, v17, v18
 v_max3_f32 v106, v106, v19, v20
 v_max3_f32 v106, v106, v21, v22
 v_max3_f32 v106, v106, v23, v24
 v_max3_f32 v106, v106, v25, v26
 v_max3_f32 v106, v106, v27, v28
 v_max3_f32 v106, v106, v29, v30
 v_max_f32 v106, v106, v31
 v_mov_b32 v107, v106
 s_nop 1
 v_permlane32_swap_b32 v106, v107
 v_max3_f32 v106, v106, v107, v104
 v_sub_f32 v107, v104, v106
 v_exp_f32 v107, v107
 v_mov_b32 v104, v106
 v_sub_f32 v16, v16, v106
 v_sub_f32 v17, v17, v106
 v_sub_f32 v18, v18, v106
 v_sub_f32 v19, v19, v106
 v_sub_f32 v20, v20, v106
 v_sub_f32 v21, v21, v106
 v_sub_f32 v22, v22, v106
 v_sub_f32 v23, v23, v106
 v_sub_f32 v24, v24, v106
 v_sub_f32 v25, v25, v106
 v_sub_f32 v26, v26, v106
 v_sub_f32 v27, v27, v106
 v_sub_f32 v28, v28, v106
 v_sub_f32 v29, v29, v106
 v_sub_f32 v30, v30, v106
 v_sub_f32 v31, v31, v106
 v_mul_f32 v48, v48, v107
 v_mul_f32 v49, v49, v107
 v_mul_f32 v50, v50, v107
 v_mul_f32 v51, v51, v107
 v_mul_f32 v52, v52, v107
 v_mul_f32 v53, v53, v107
 v_mul_f32 v54, v54, v107
 v_mul_f32 v55, v55, v107
 v_mul_f32 v56, v56, v107
 v_mul_f32 v57, v57, v107
 v_mul_f32 v58, v58, v107
 v_mul_f32 v59, v59, v107
 v_exp_f32 v16, v16
 v_exp_f32 v17, v17
 v_exp_f32 v18, v18
 v_exp_f32 v19, v19
 v_exp_f32 v20, v20
 v_exp_f32 v21, v21
 v_exp_f32 v22, v22
 v_exp_f32 v23, v23
 v_exp_f32 v24, v24
 v_exp_f32 v25, v25
 v_exp_f32 v26, v26
 v_exp_f32 v27, v27
 v_exp_f32 v28, v28
 v_exp_f32 v29, v29
 v_exp_f32 v30, v30
 v_exp_f32 v31, v31
 s_nop 0
 v_cvt_pk_bf16_f32 v96, v16, v17
 v_cvt_pk_bf16_f32 v97, v18, v19
 v_cvt_pk_bf16_f32 v98, v20, v21
 v_cvt_pk_bf16_f32 v99, v22, v23
 v_cvt_pk_bf16_f32 v100, v24, v25
 v_cvt_pk_bf16_f32 v101, v26, v27
 v_cvt_pk_bf16_f32 v102, v28, v29
 v_cvt_pk_bf16_f32 v103, v30, v31
 s_nop 0
 v_mfma_f32_32x32x16_bf16 v[48:63], v[80:83], v[96:99], v[48:63]
 v_mfma_f32_32x32x16_bf16 v[48:63], v[84:87], v[100:103], v[48:63]
 ds_read_b128 v[64:67], v7 offset:8192
 ds_read_b64 v[68:69], v3 offset:9216
 ds_read_b128 v[80:83], v2 offset:8192
 ds_read_b128 v[84:87], v2 offset:9216
 s_waitcnt lgkmcnt(2)
 v_mfma_f32_32x32x16_bf16 v[16:31], v[64:67], v[8:11], 0
 v_mfma_f32_32x32x16_bf16 v[16:31], v[68:71], v[12:15], v[16:31]
 v_max3_f32 v106, v32, v33, v34
 v_max3_f32 v106, v106, v35, v36
 v_max3_f32 v106, v106, v37, v38
 v_max3_f32 v106, v106, v39, v40
 v_max3_f32 v106, v106, v41, v42
 v_max3_f32 v106, v106, v43, v44
 v_max3_f32 v106, v106, v45, v46
 v_max_f32 v106, v106, v47
 v_mov_b32 v107, v106
 s_nop 1
 v_permlane32_swap_b32 v106, v107
 v_max3_f32 v106, v106, v107, v104
 v_sub_f32 v107, v104, v106
 v_exp_f32 v107, v107
 v_mov_b32 v104, v106
 v_sub_f32 v32, v32, v106
 v_sub_f32 v33, v33, v106
 v_sub_f32 v34, v34, v106
 v_sub_f32 v35, v35, v106
 v_sub_f32 v36, v36, v106
 v_sub_f32 v37, v37, v106
 v_sub_f32 v38, v38, v106
 v_sub_f32 v39, v39, v106
 v_sub_f32 v40, v40, v106
 v_sub_f32 v41, v41, v106
 v_sub_f32 v42, v42, v106
 v_sub_f32 v43, v43, v106
 v_sub_f32 v44, v44, v106
 v_sub_f32 v45, v45, v106
 v_sub_f32 v46, v46, v106
 v_sub_f32 v47, v47, v106
 v_mul_f32 v48, v48, v107
 v_mul_f32 v49, v49, v107
 v_mul_f32 v50, v50, v107
 v_mul_f32 v51, v51, v107
 v_mul_f32 v52, v52, v107
 v_mul_f32 v53, v53, v107
 v_mul_f32 v54, v54, v107
 v_mul_f32 v55, v55, v107
 v_mul_f32 v56, v56, v107
 v_mul_f32 v57, v57, v107
 v_mul_f32 v58, v58, v107
 v_mul_f32 v59, v59, v107
 v_exp_f32 v32, v32
 v_exp_f32 v33, v33
 v_exp_f32 v34, v34
 v_exp_f32 v35, v35
 v_exp_f32 v36, v36
 v_exp_f32 v37, v37
 v_exp_f32 v38, v38
 v_exp_f32 v39, v39
 v_exp_f32 v40, v40
 v_exp_f32 v41, v41
 v_exp_f32 v42, v42
 v_exp_f32 v43, v43
 v_exp_f32 v44, v44
 v_exp_f32 v45, v45
 v_exp_f32 v46, v46
 v_exp_f32 v47, v47
 s_nop 0
 v_cvt_pk_bf16_f32 v96, v32, v33
 v_cvt_pk_bf16_f32 v97, v34, v35
 v_cvt_pk_bf16_f32 v98, v36, v37
 v_cvt_pk_bf16_f32 v99, v38, v39
 v_cvt_pk_bf16_f32 v100, v40, v41
 v_cvt_pk_bf16_f32 v101, v42, v43
 v_cvt_pk_bf16_f32 v102, v44, v45
 v_cvt_pk_bf16_f32 v103, v46, v47
 s_nop 0
 v_mfma_f32_32x32x16_bf16 v[48:63], v[88:91], v[96:99], v[48:63]
 v_mfma_f32_32x32x16_bf16 v[48:63], v[92:95], v[100:103], v[48:63]
 ds_read_b128 v[72:75], v7 offset:10240
 ds_read_b64 v[76:77], v3 offset:11264
 ds_read_b128 v[88:91], v2 offset:10240
 ds_read_b128 v[92:95], v2 offset:11264
 s_waitcnt lgkmcnt(2)
 v_mfma_f32_32x32x16_bf16 v[32:47], v[72:75], v[8:11], 0
 v_mfma_f32_32x32x16_bf16 v[32:47], v[76:79], v[12:15], v[32:47]
 v_max3_f32 v106, v16, v17, v18
 v_max3_f32 v106, v106, v19, v20
 v_max3_f32 v106, v106, v21, v22
 v_max3_f32 v106, v106, v23, v24
 v_max3_f32 v106, v106, v25, v26
 v_max3_f32 v106, v106, v27, v28
 v_max3_f32 v106, v106, v29, v30
 v_max_f32 v106, v106, v31
 v_mov_b32 v107, v106
 s_nop 1
 v_permlane32_swap_b32 v106, v107
 v_max3_f32 v106, v106, v107, v104
 v_sub_f32 v107, v104, v106
 v_exp_f32 v107, v107
 v_mov_b32 v104, v106
 v_sub_f32 v16, v16, v106
 v_sub_f32 v17, v17, v106
 v_sub_f32 v18, v18, v106
 v_sub_f32 v19, v19, v106
 v_sub_f32 v20, v20, v106
 v_sub_f32 v21, v21, v106
 v_sub_f32 v22, v22, v106
 v_sub_f32 v23, v23, v106
 v_sub_f32 v24, v24, v106
 v_sub_f32 v25, v25, v106
 v_sub_f32 v26, v26, v106
 v_sub_f32 v27, v27, v106
 v_sub_f32 v28, v28, v106
 v_sub_f32 v29, v29, v106
 v_sub_f32 v30, v30, v106
 v_sub_f32 v31, v31, v106
 v_mul_f32 v48, v48, v107
 v_mul_f32 v49, v49, v107
 v_mul_f32 v50, v50, v107
 v_mul_f32 v51, v51, v107
 v_mul_f32 v52, v52, v107
 v_mul_f32 v53, v53, v107
 v_mul_f32 v54, v54, v107
 v_mul_f32 v55, v55, v107
 v_mul_f32 v56, v56, v107
 v_mul_f32 v57, v57, v107
 v_mul_f32 v58, v58, v107
 v_mul_f32 v59, v59, v107
 v_exp_f32 v16, v16
 v_exp_f32 v17, v17
 v_exp_f32 v18, v18
 v_exp_f32 v19, v19
 v_exp_f32 v20, v20
 v_exp_f32 v21, v21
 v_exp_f32 v22, v22
 v_exp_f32 v23, v23
 v_exp_f32 v24, v24
 v_exp_f32 v25, v25
 v_exp_f32 v26, v26
 v_exp_f32 v27, v27
 v_exp_f32 v28, v28
 v_exp_f32 v29, v29
 v_exp_f32 v30, v30
 v_exp_f32 v31, v31
 s_nop 0
 v_cvt_pk_bf16_f32 v96, v16, v17
 v_cvt_pk_bf16_f32 v97, v18, v19
 v_cvt_pk_bf16_f32 v98, v20, v21
 v_cvt_pk_bf16_f32 v99, v22, v23
 v_cvt_pk_bf16_f32 v100, v24, v25
 v_cvt_pk_bf16_f32 v101, v26, v27
 v_cvt_pk_bf16_f32 v102, v28, v29
 v_cvt_pk_bf16_f32 v103, v30, v31
 s_nop 0
 v_mfma_f32_32x32x16_bf16 v[48:63], v[80:83], v[96:99], v[48:63]
 v_mfma_f32_32x32x16_bf16 v[48:63], v[84:87], v[100:103], v[48:63]
 ds_read_b128 v[64:67], v7 offset:12288
 ds_read_b64 v[68:69], v3 offset:13312
 ds_read_b128 v[80:83], v2 offset:12288
 ds_read_b128 v[84:87], v2 offset:13312
 s_waitcnt lgkmcnt(2)
 v_mfma_f32_32x32x16_bf16 v[16:31], v[64:67], v[8:11], 0
 v_mfma_f32_32x32x16_bf16 v[16:31], v[68:71], v[12:15], v[16:31]
 v_max3_f32 v106, v32, v33, v34
 v_max3_f32 v106, v106, v35, v36
 v_max3_f32 v106, v106, v37, v38
 v_max3_f32 v106, v106, v39, v40
 v_max3_f32 v106, v106, v41, v42
 v_max3_f32 v106, v106, v43, v44
 v_max3_f32 v106, v106, v45, v46
 v_max_f32 v106, v106, v47
 v_mov_b32 v107, v106
 s_nop 1
 v_permlane32_swap_b32 v106, v107
 v_max3_f32 v106, v106, v107, v104
 v_sub_f32 v107, v104, v106
 v_exp_f32 v107, v107
 v_mov_b32 v104, v106
 v_sub_f32 v32, v32, v106
 v_sub_f32 v33, v33, v106
 v_sub_f32 v34, v34, v106
 v_sub_f32 v35, v35, v106
 v_sub_f32 v36, v36, v106
 v_sub_f32 v37, v37, v106
 v_sub_f32 v38, v38, v106
 v_sub_f32 v39, v39, v106
 v_sub_f32 v40, v40, v106
 v_sub_f32 v41, v41, v106
 v_sub_f32 v42, v42, v106
 v_sub_f32 v43, v43, v106
 v_sub_f32 v44, v44, v106
 v_sub_f32 v45, v45, v106
 v_sub_f32 v46, v46, v106
 v_sub_f32 v47, v47, v106
 v_mul_f32 v48, v48, v107
 v_mul_f32 v49, v49, v107
 v_mul_f32 v50, v50, v107
 v_mul_f32 v51, v51, v107
 v_mul_f32 v52, v52, v107
 v_mul_f32 v53, v53, v107
 v_mul_f32 v54, v54, v107
 v_mul_f32 v55, v55, v107
 v_mul_f32 v56, v56, v107
 v_mul_f32 v57, v57, v107
 v_mul_f32 v58, v58, v107
 v_mul_f32 v59, v59, v107
 v_exp_f32 v32, v32
 v_exp_f32 v33, v33
 v_exp_f32 v34, v34
 v_exp_f32 v35, v35
 v_exp_f32 v36, v36
 v_exp_f32 v37, v37
 v_exp_f32 v38, v38
 v_exp_f32 v39, v39
 v_exp_f32 v40, v40
 v_exp_f32 v41, v41
 v_exp_f32 v42, v42
 v_exp_f32 v43, v43
 v_exp_f32 v44, v44
 v_exp_f32 v45, v45
 v_exp_f32 v46, v46
 v_exp_f32 v47, v47
 s_nop 0
 v_cvt_pk_bf16_f32 v96, v32, v33
 v_cvt_pk_bf16_f32 v97, v34, v35
 v_cvt_pk_bf16_f32 v98, v36, v37
 v_cvt_pk_bf16_f32 v99, v38, v39
 v_cvt_pk_bf16_f32 v100, v40, v41
 v_cvt_pk_bf16_f32 v101, v42, v43
 v_cvt_pk_bf16_f32 v102, v44, v45
 v_cvt_pk_bf16_f32 v103, v46, v47
 s_nop 0
 v_mfma_f32_32x32x16_bf16 v[48:63], v[88:91], v[96:99], v[48:63]
 v_mfma_f32_32x32x16_bf16 v[48:63], v[92:95], v[100:103], v[48:63]
 ds_read_b128 v[72:75], v7 offset:14336
 ds_read_b64 v[76:77], v3 offset:15360
 ds_read_b128 v[88:91], v2 offset:14336
 ds_read_b128 v[92:95], v2 offset:15360
 s_waitcnt lgkmcnt(2)
 v_mfma_f32_32x32x16_bf16 v[32:47], v[72:75], v[8:11], 0
 v_mfma_f32_32x32x16_bf16 v[32:47], v[76:79], v[12:15], v[32:47]
 v_max3_f32 v106, v16, v17, v18
 v_max3_f32 v106, v106, v19, v20
 v_max3_f32 v106, v106, v21, v22
 v_max3_f32 v106, v106, v23, v24
 v_max3_f32 v106, v106, v25, v26
 v_max3_f32 v106, v106, v27, v28
 v_max3_f32 v106, v106, v29, v30
 v_max_f32 v106, v106, v31
 v_mov_b32 v107, v106
 s_nop 1
 v_permlane32_swap_b32 v106, v107
 v_max3_f32 v106, v106, v107, v104
 v_sub_f32 v107, v104, v106
 v_exp_f32 v107, v107
 v_mov_b32 v104, v106
 v_sub_f32 v16, v16, v106
 v_sub_f32 v17, v17, v106
 v_sub_f32 v18, v18, v106
 v_sub_f32 v19, v19, v106
 v_sub_f32 v20, v20, v106
 v_sub_f32 v21, v21, v106
 v_sub_f32 v22, v22, v106
 v_sub_f32 v23, v23, v106
 v_sub_f32 v24, v24, v106
 v_sub_f32 v25, v25, v106
 v_sub_f32 v26, v26, v106
 v_sub_f32 v27, v27, v106
 v_sub_f32 v28, v28, v106
 v_sub_f32 v29, v29, v106
 v_sub_f32 v30, v30, v106
 v_sub_f32 v31, v31, v106
 v_mul_f32 v48, v48, v107
 v_mul_f32 v49, v49, v107
 v_mul_f32 v50, v50, v107
 v_mul_f32 v51, v51, v107
 v_mul_f32 v52, v52, v107
 v_mul_f32 v53, v53, v107
 v_mul_f32 v54, v54, v107
 v_mul_f32 v55, v55, v107
 v_mul_f32 v56, v56, v107
 v_mul_f32 v57, v57, v107
 v_mul_f32 v58, v58, v107
 v_mul_f32 v59, v59, v107
 v_exp_f32 v16, v16
 v_exp_f32 v17, v17
 v_exp_f32 v18, v18
 v_exp_f32 v19, v19
 v_exp_f32 v20, v20
 v_exp_f32 v21, v21
 v_exp_f32 v22, v22
 v_exp_f32 v23, v23
 v_exp_f32 v24, v24
 v_exp_f32 v25, v25
 v_exp_f32 v26, v26
 v_exp_f32 v27, v27
 v_exp_f32 v28, v28
 v_exp_f32 v29, v29
 v_exp_f32 v30, v30
 v_exp_f32 v31, v31
 s_nop 0
 v_cvt_pk_bf16_f32 v96, v16, v17
 v_cvt_pk_bf16_f32 v97, v18, v19
 v_cvt_pk_bf16_f32 v98, v20, v21
 v_cvt_pk_bf16_f32 v99, v22, v23
 v_cvt_pk_bf16_f32 v100, v24, v25
 v_cvt_pk_bf16_f32 v101, v26, v27
 v_cvt_pk_bf16_f32 v102, v28, v29
 v_cvt_pk_bf16_f32 v103, v30, v31
 s_nop 0
 v_mfma_f32_32x32x16_bf16 v[48:63], v[80:83], v[96:99], v[48:63]
 v_mfma_f32_32x32x16_bf16 v[48:63], v[84:87], v[100:103], v[48:63]
 s_nop 7
 v_max3_f32 v106, v32, v33, v34
 v_max3_f32 v106, v106, v35, v36
 v_max3_f32 v106, v106, v37, v38
 v_max3_f32 v106, v106, v39, v40
 v_max3_f32 v106, v106, v41, v42
 v_max3_f32 v106, v106, v43, v44
 v_max3_f32 v106, v106, v45, v46
 v_max_f32 v106, v106, v47
 v_mov_b32 v107, v106
 s_nop 1
 v_permlane32_swap_b32 v106, v107
 v_max3_f32 v106, v106, v107, v104
 v_sub_f32 v107, v104, v106
 v_exp_f32 v107, v107
 v_mov_b32 v104, v106
 v_sub_f32 v32, v32, v106
 v_sub_f32 v33, v33, v106
 v_sub_f32 v34, v34, v106
 v_sub_f32 v35, v35, v106
 v_sub_f32 v36, v36, v106
 v_sub_f32 v37, v37, v106
 v_sub_f32 v38, v38, v106
 v_sub_f32 v39, v39, v106
 v_sub_f32 v40, v40, v106
 v_sub_f32 v41, v41, v106
 v_sub_f32 v42, v42, v106
 v_sub_f32 v43, v43, v106
 v_sub_f32 v44, v44, v106
 v_sub_f32 v45, v45, v106
 v_sub_f32 v46, v46, v106
 v_sub_f32 v47, v47, v106
 v_mul_f32 v48, v48, v107
 v_mul_f32 v49, v49, v107
 v_mul_f32 v50, v50, v107
 v_mul_f32 v51, v51, v107
 v_mul_f32 v52, v52, v107
 v_mul_f32 v53, v53, v107
 v_mul_f32 v54, v54, v107
 v_mul_f32 v55, v55, v107
 v_mul_f32 v56, v56, v107
 v_mul_f32 v57, v57, v107
 v_mul_f32 v58, v58, v107
 v_mul_f32 v59, v59, v107
 v_exp_f32 v32, v32
 v_exp_f32 v33, v33
 v_exp_f32 v34, v34
 v_exp_f32 v35, v35
 v_exp_f32 v36, v36
 v_exp_f32 v37, v37
 v_exp_f32 v38, v38
 v_exp_f32 v39, v39
 v_exp_f32 v40, v40
 v_exp_f32 v41, v41
 v_exp_f32 v42, v42
 v_exp_f32 v43, v43
 v_exp_f32 v44, v44
 v_exp_f32 v45, v45
 v_exp_f32 v46, v46
 v_exp_f32 v47, v47
 s_nop 0
 v_cvt_pk_bf16_f32 v96, v32, v33
 v_cvt_pk_bf16_f32 v97, v34, v35
 v_cvt_pk_bf16_f32 v98, v36, v37
 v_cvt_pk_bf16_f32 v99, v38, v39
 v_cvt_pk_bf16_f32 v100, v40, v41
 v_cvt_pk_bf16_f32 v101, v42, v43
 v_cvt_pk_bf16_f32 v102, v44, v45
 v_cvt_pk_bf16_f32 v103, v46, v47
 s_waitcnt lgkmcnt(0)
 s_nop 0
 v_mfma_f32_32x32x16_bf16 v[48:63], v[88:91], v[96:99], v[48:63]
 v_mfma_f32_32x32x16_bf16 v[48:63], v[92:95], v[100:103], v[48:63]
 s_waitcnt vmcnt(0)
 v_cndmask_b32 v120, v120, v5, s[26:27]
 v_cndmask_b32 v121, v121, v5, s[26:27]
 v_cndmask_b32 v122, v122, v5, s[26:27]
 v_cndmask_b32 v123, v123, v5, s[26:27]
 v_cndmask_b32 v124, v124, v5, s[26:27]
 v_cndmask_b32 v125, v125, v5, s[26:27]
 v_cndmask_b32 v126, v126, v5, s[26:27]
 v_cndmask_b32 v127, v127, v5, s[26:27]
 ds_write_b128 v4, v[112:115] offset:32768
 ds_write_b128 v4, v[116:119] offset:40960
 ds_write_b128 v4, v[120:123] offset:49152
 ds_write_b128 v4, v[124:127] offset:57344
 s_waitcnt lgkmcnt(0)
 s_barrier
 ds_read_b128 v[64:67], v7 offset:32768
 ds_read_b64 v[68:69], v3 offset:33792
 ds_read_b128 v[80:83], v2 offset:32768
 ds_read_b128 v[84:87], v2 offset:33792
 s_waitcnt lgkmcnt(2)
 v_mfma_f32_32x32x16_bf16 v[16:31], v[64:67], v[8:11], 0
 v_mfma_f32_32x32x16_bf16 v[16:31], v[68:71], v[12:15], v[16:31]
 ds_read_b128 v[72:75], v7 offset:34816
 ds_read_b64 v[76:77], v3 offset:35840
 ds_read_b128 v[88:91], v2 offset:34816
 ds_read_b128 v[92:95], v2 offset:35840
 s_waitcnt lgkmcnt(2)
 v_mfma_f32_32x32x16_bf16 v[32:47], v[72:75], v[8:11], 0
 v_mfma_f32_32x32x16_bf16 v[32:47], v[76:79], v[12:15], v[32:47]
 v_max3_f32 v106, v16, v17, v18
 v_max3_f32 v106, v106, v19, v20
 v_max3_f32 v106, v106, v21, v22
 v_max3_f32 v106, v106, v23, v24
 v_max3_f32 v106, v106, v25, v26
 v_max3_f32 v106, v106, v27, v28
 v_max3_f32 v106, v106, v29, v30
 v_max_f32 v106, v106, v31
 v_mov_b32 v107, v106
 s_nop 1
 v_permlane32_swap_b32 v106, v107
 v_max3_f32 v106, v106, v107, v104
 v_sub_f32 v107, v104, v106
 v_exp_f32 v107, v107
 v_mov_b32 v104, v106
 v_sub_f32 v16, v16, v106
 v_sub_f32 v17, v17, v106
 v_sub_f32 v18, v18, v106
 v_sub_f32 v19, v19, v106
 v_sub_f32 v20, v20, v106
 v_sub_f32 v21, v21, v106
 v_sub_f32 v22, v22, v106
 v_sub_f32 v23, v23, v106
 v_sub_f32 v24, v24, v106
 v_sub_f32 v25, v25, v106
 v_sub_f32 v26, v26, v106
 v_sub_f32 v27, v27, v106
 v_sub_f32 v28, v28, v106
 v_sub_f32 v29, v29, v106
 v_sub_f32 v30, v30, v106
 v_sub_f32 v31, v31, v106
 v_mul_f32 v48, v48, v107
 v_mul_f32 v49, v49, v107
 v_mul_f32 v50, v50, v107
 v_mul_f32 v51, v51, v107
 v_mul_f32 v52, v52, v107
 v_mul_f32 v53, v53, v107
 v_mul_f32 v54, v54, v107
 v_mul_f32 v55, v55, v107
 v_mul_f32 v56, v56, v107
 v_mul_f32 v57, v57, v107
 v_mul_f32 v58, v58, v107
 v_mul_f32 v59, v59, v107
 v_exp_f32 v16, v16
 v_exp_f32 v17, v17
 v_exp_f32 v18, v18
 v_exp_f32 v19, v19
 v_exp_f32 v20, v20
 v_exp_f32 v21, v21
 v_exp_f32 v22, v22
 v_exp_f32 v23, v23
 v_exp_f32 v24, v24
 v_exp_f32 v25, v25
 v_exp_f32 v26, v26
 v_exp_f32 v27, v27
 v_exp_f32 v28, v28
 v_exp_f32 v29, v29
 v_exp_f32 v30, v30
 v_exp_f32 v31, v31
 s_nop 0
 v_cvt_pk_bf16_f32 v96, v16, v17
 v_cvt_pk_bf16_f32 v97, v18, v19
 v_cvt_pk_bf16_f32 v98, v20, v21
 v_cvt_pk_bf16_f32 v99, v22, v23
 v_cvt_pk_bf16_f32 v100, v24, v25
 v_cvt_pk_bf16_f32 v101, v26, v27
 v_cvt_pk_bf16_f32 v102, v28, v29
 v_cvt_pk_bf16_f32 v103, v30, v31
 s_nop 0
 v_mfma_f32_32x32x16_bf16 v[48:63], v[80:83], v[96:99], v[48:63]
 v_mfma_f32_32x32x16_bf16 v[48:63], v[84:87], v[100:103], v[48:63]
 ds_read_b128 v[64:67], v7 offset:36864
 ds_read_b64 v[68:69], v3 offset:37888
 ds_read_b128 v[80:83], v2 offset:36864
 ds_read_b128 v[84:87], v2 offset:37888
 s_waitcnt lgkmcnt(2)
 v_mfma_f32_32x32x16_bf16 v[16:31], v[64:67], v[8:11], 0
 v_mfma_f32_32x32x16_bf16 v[16:31], v[68:71], v[12:15], v[16:31]
 v_max3_f32 v106, v32, v33, v34
 v_max3_f32 v106, v106, v35, v36
 v_max3_f32 v106, v106, v37, v38
 v_max3_f32 v106, v106, v39, v40
 v_max3_f32 v106, v106, v41, v42
 v_max3_f32 v106, v106, v43, v44
 v_max3_f32 v106, v106, v45, v46
 v_max_f32 v106, v106, v47
 v_mov_b32 v107, v106
 s_nop 1
 v_permlane32_swap_b32 v106, v107
 v_max3_f32 v106, v106, v107, v104
 v_sub_f32 v107, v104, v106
 v_exp_f32 v107, v107
 v_mov_b32 v104, v106
 v_sub_f32 v32, v32, v106
 v_sub_f32 v33, v33, v106
 v_sub_f32 v34, v34, v106
 v_sub_f32 v35, v35, v106
 v_sub_f32 v36, v36, v106
 v_sub_f32 v37, v37, v106
 v_sub_f32 v38, v38, v106
 v_sub_f32 v39, v39, v106
 v_sub_f32 v40, v40, v106
 v_sub_f32 v41, v41, v106
 v_sub_f32 v42, v42, v106
 v_sub_f32 v43, v43, v106
 v_sub_f32 v44, v44, v106
 v_sub_f32 v45, v45, v106
 v_sub_f32 v46, v46, v106
 v_sub_f32 v47, v47, v106
 v_mul_f32 v48, v48, v107
 v_mul_f32 v49, v49, v107
 v_mul_f32 v50, v50, v107
 v_mul_f32 v51, v51, v107
 v_mul_f32 v52, v52, v107
 v_mul_f32 v53, v53, v107
 v_mul_f32 v54, v54, v107
 v_mul_f32 v55, v55, v107
 v_mul_f32 v56, v56, v107
 v_mul_f32 v57, v57, v107
 v_mul_f32 v58, v58, v107
 v_mul_f32 v59, v59, v107
 v_exp_f32 v32, v32
 v_exp_f32 v33, v33
 v_exp_f32 v34, v34
 v_exp_f32 v35, v35
 v_exp_f32 v36, v36
 v_exp_f32 v37, v37
 v_exp_f32 v38, v38
 v_exp_f32 v39, v39
 v_exp_f32 v40, v40
 v_exp_f32 v41, v41
 v_exp_f32 v42, v42
 v_exp_f32 v43, v43
 v_exp_f32 v44, v44
 v_exp_f32 v45, v45
 v_exp_f32 v46, v46
 v_exp_f32 v47, v47
 s_nop 0
 v_cvt_pk_bf16_f32 v96, v32, v33
 v_cvt_pk_bf16_f32 v97, v34, v35
 v_cvt_pk_bf16_f32 v98, v36, v37
 v_cvt_pk_bf16_f32 v99, v38, v39
 v_cvt_pk_bf16_f32 v100, v40, v41
 v_cvt_pk_bf16_f32 v101, v42, v43
 v_cvt_pk_bf16_f32 v102, v44, v45
 v_cvt_pk_bf16_f32 v103, v46, v47
 s_nop 0
 v_mfma_f32_32x32x16_bf16 v[48:63], v[88:91], v[96:99], v[48:63]
 v_mfma_f32_32x32x16_bf16 v[48:63], v[92:95], v[100:103], v[48:63]
 ds_read_b128 v[72:75], v7 offset:38912
 ds_read_b64 v[76:77], v3 offset:39936
 ds_read_b128 v[88:91], v2 offset:38912
 ds_read_b128 v[92:95], v2 offset:39936
 s_waitcnt lgkmcnt(2)
 v_mfma_f32_32x32x16_bf16 v[32:47], v[72:75], v[8:11], 0
 v_mfma_f32_32x32x16_bf16 v[32:47], v[76:79], v[12:15], v[32:47]
 v_max3_f32 v106, v16, v17, v18
 v_max3_f32 v106, v106, v19, v20
 v_max3_f32 v106, v106, v21, v22
 v_max3_f32 v106, v106, v23, v24
 v_max3_f32 v106, v106, v25, v26
 v_max3_f32 v106, v106, v27, v28
 v_max3_f32 v106, v106, v29, v30
 v_max_f32 v106, v106, v31
 v_mov_b32 v107, v106
 s_nop 1
 v_permlane32_swap_b32 v106, v107
 v_max3_f32 v106, v106, v107, v104
 v_sub_f32 v107, v104, v106
 v_exp_f32 v107, v107
 v_mov_b32 v104, v106
 v_sub_f32 v16, v16, v106
 v_sub_f32 v17, v17, v106
 v_sub_f32 v18, v18, v106
 v_sub_f32 v19, v19, v106
 v_sub_f32 v20, v20, v106
 v_sub_f32 v21, v21, v106
 v_sub_f32 v22, v22, v106
 v_sub_f32 v23, v23, v106
 v_sub_f32 v24, v24, v106
 v_sub_f32 v25, v25, v106
 v_sub_f32 v26, v26, v106
 v_sub_f32 v27, v27, v106
 v_sub_f32 v28, v28, v106
 v_sub_f32 v29, v29, v106
 v_sub_f32 v30, v30, v106
 v_sub_f32 v31, v31, v106
 v_mul_f32 v48, v48, v107
 v_mul_f32 v49, v49, v107
 v_mul_f32 v50, v50, v107
 v_mul_f32 v51, v51, v107
 v_mul_f32 v52, v52, v107
 v_mul_f32 v53, v53, v107
 v_mul_f32 v54, v54, v107
 v_mul_f32 v55, v55, v107
 v_mul_f32 v56, v56, v107
 v_mul_f32 v57, v57, v107
 v_mul_f32 v58, v58, v107
 v_mul_f32 v59, v59, v107
 v_exp_f32 v16, v16
 v_exp_f32 v17, v17
 v_exp_f32 v18, v18
 v_exp_f32 v19, v19
 v_exp_f32 v20, v20
 v_exp_f32 v21, v21
 v_exp_f32 v22, v22
 v_exp_f32 v23, v23
 v_exp_f32 v24, v24
 v_exp_f32 v25, v25
 v_exp_f32 v26, v26
 v_exp_f32 v27, v27
 v_exp_f32 v28, v28
 v_exp_f32 v29, v29
 v_exp_f32 v30, v30
 v_exp_f32 v31, v31
 s_nop 0
 v_cvt_pk_bf16_f32 v96, v16, v17
 v_cvt_pk_bf16_f32 v97, v18, v19
 v_cvt_pk_bf16_f32 v98, v20, v21
 v_cvt_pk_bf16_f32 v99, v22, v23
 v_cvt_pk_bf16_f32 v100, v24, v25
 v_cvt_pk_bf16_f32 v101, v26, v27
 v_cvt_pk_bf16_f32 v102, v28, v29
 v_cvt_pk_bf16_f32 v103, v30, v31
 s_nop 0
 v_mfma_f32_32x32x16_bf16 v[48:63], v[80:83], v[96:99], v[48:63]
 v_mfma_f32_32x32x16_bf16 v[48:63], v[84:87], v[100:103], v[48:63]
 ds_read_b128 v[64:67], v7 offset:40960
 ds_read_b64 v[68:69], v3 offset:41984
 ds_read_b128 v[80:83], v2 offset:40960
 ds_read_b128 v[84:87], v2 offset:41984
 s_waitcnt lgkmcnt(2)
 v_mfma_f32_32x32x16_bf16 v[16:31], v[64:67], v[8:11], 0
 v_mfma_f32_32x32x16_bf16 v[16:31], v[68:71], v[12:15], v[16:31]
 v_max3_f32 v106, v32, v33, v34
 v_max3_f32 v106, v106, v35, v36
 v_max3_f32 v106, v106, v37, v38
 v_max3_f32 v106, v106, v39, v40
 v_max3_f32 v106, v106, v41, v42
 v_max3_f32 v106, v106, v43, v44
 v_max3_f32 v106, v106, v45, v46
 v_max_f32 v106, v106, v47
 v_mov_b32 v107, v106
 s_nop 1
 v_permlane32_swap_b32 v106, v107
 v_max3_f32 v106, v106, v107, v104
 v_sub_f32 v107, v104, v106
 v_exp_f32 v107, v107
 v_mov_b32 v104, v106
 v_sub_f32 v32, v32, v106
 v_sub_f32 v33, v33, v106
 v_sub_f32 v34, v34, v106
 v_sub_f32 v35, v35, v106
 v_sub_f32 v36, v36, v106
 v_sub_f32 v37, v37, v106
 v_sub_f32 v38, v38, v106
 v_sub_f32 v39, v39, v106
 v_sub_f32 v40, v40, v106
 v_sub_f32 v41, v41, v106
 v_sub_f32 v42, v42, v106
 v_sub_f32 v43, v43, v106
 v_sub_f32 v44, v44, v106
 v_sub_f32 v45, v45, v106
 v_sub_f32 v46, v46, v106
 v_sub_f32 v47, v47, v106
 v_mul_f32 v48, v48, v107
 v_mul_f32 v49, v49, v107
 v_mul_f32 v50, v50, v107
 v_mul_f32 v51, v51, v107
 v_mul_f32 v52, v52, v107
 v_mul_f32 v53, v53, v107
 v_mul_f32 v54, v54, v107
 v_mul_f32 v55, v55, v107
 v_mul_f32 v56, v56, v107
 v_mul_f32 v57, v57, v107
 v_mul_f32 v58, v58, v107
 v_mul_f32 v59, v59, v107
 v_exp_f32 v32, v32
 v_exp_f32 v33, v33
 v_exp_f32 v34, v34
 v_exp_f32 v35, v35
 v_exp_f32 v36, v36
 v_exp_f32 v37, v37
 v_exp_f32 v38, v38
 v_exp_f32 v39, v39
 v_exp_f32 v40, v40
 v_exp_f32 v41, v41
 v_exp_f32 v42, v42
 v_exp_f32 v43, v43
 v_exp_f32 v44, v44
 v_exp_f32 v45, v45
 v_exp_f32 v46, v46
 v_exp_f32 v47, v47
 s_nop 0
 v_cvt_pk_bf16_f32 v96, v32, v33
 v_cvt_pk_bf16_f32 v97, v34, v35
 v_cvt_pk_bf16_f32 v98, v36, v37
 v_cvt_pk_bf16_f32 v99, v38, v39
 v_cvt_pk_bf16_f32 v100, v40, v41
 v_cvt_pk_bf16_f32 v101, v42, v43
 v_cvt_pk_bf16_f32 v102, v44, v45
 v_cvt_pk_bf16_f32 v103, v46, v47
 s_nop 0
 v_mfma_f32_32x32x16_bf16 v[48:63], v[88:91], v[96:99], v[48:63]
 v_mfma_f32_32x32x16_bf16 v[48:63], v[92:95], v[100:103], v[48:63]
 ds_read_b128 v[72:75], v7 offset:43008
 ds_read_b64 v[76:77], v3 offset:44032
 ds_read_b128 v[88:91], v2 offset:43008
 ds_read_b128 v[92:95], v2 offset:44032
 s_waitcnt lgkmcnt(2)
 v_mfma_f32_32x32x16_bf16 v[32:47], v[72:75], v[8:11], 0
 v_mfma_f32_32x32x16_bf16 v[32:47], v[76:79], v[12:15], v[32:47]
 v_max3_f32 v106, v16, v17, v18
 v_max3_f32 v106, v106, v19, v20
 v_max3_f32 v106, v106, v21, v22
 v_max3_f32 v106, v106, v23, v24
 v_max3_f32 v106, v106, v25, v26
 v_max3_f32 v106, v106, v27, v28
 v_max3_f32 v106, v106, v29, v30
 v_max_f32 v106, v106, v31
 v_mov_b32 v107, v106
 s_nop 1
 v_permlane32_swap_b32 v106, v107
 v_max3_f32 v106, v106, v107, v104
 v_sub_f32 v107, v104, v106
 v_exp_f32 v107, v107
 v_mov_b32 v104, v106
 v_sub_f32 v16, v16, v106
 v_sub_f32 v17, v17, v106
 v_sub_f32 v18, v18, v106
 v_sub_f32 v19, v19, v106
 v_sub_f32 v20, v20, v106
 v_sub_f32 v21, v21, v106
 v_sub_f32 v22, v22, v106
 v_sub_f32 v23, v23, v106
 v_sub_f32 v24, v24, v106
 v_sub_f32 v25, v25, v106
 v_sub_f32 v26, v26, v106
 v_sub_f32 v27, v27, v106
 v_sub_f32 v28, v28, v106
 v_sub_f32 v29, v29, v106
 v_sub_f32 v30, v30, v106
 v_sub_f32 v31, v31, v106
 v_mul_f32 v48, v48, v107
 v_mul_f32 v49, v49, v107
 v_mul_f32 v50, v50, v107
 v_mul_f32 v51, v51, v107
 v_mul_f32 v52, v52, v107
 v_mul_f32 v53, v53, v107
 v_mul_f32 v54, v54, v107
 v_mul_f32 v55, v55, v107
 v_mul_f32 v56, v56, v107
 v_mul_f32 v57, v57, v107
 v_mul_f32 v58, v58, v107
 v_mul_f32 v59, v59, v107
 v_exp_f32 v16, v16
 v_exp_f32 v17, v17
 v_exp_f32 v18, v18
 v_exp_f32 v19, v19
 v_exp_f32 v20, v20
 v_exp_f32 v21, v21
 v_exp_f32 v22, v22
 v_exp_f32 v23, v23
 v_exp_f32 v24, v24
 v_exp_f32 v25, v25
 v_exp_f32 v26, v26
 v_exp_f32 v27, v27
 v_exp_f32 v28, v28
 v_exp_f32 v29, v29
 v_exp_f32 v30, v30
 v_exp_f32 v31, v31
 s_nop 0
 v_cvt_pk_bf16_f32 v96, v16, v17
 v_cvt_pk_bf16_f32 v97, v18, v19
 v_cvt_pk_bf16_f32 v98, v20, v21
 v_cvt_pk_bf16_f32 v99, v22, v23
 v_cvt_pk_bf16_f32 v100, v24, v25
 v_cvt_pk_bf16_f32 v101, v26, v27
 v_cvt_pk_bf16_f32 v102, v28, v29
 v_cvt_pk_bf16_f32 v103, v30, v31
 s_nop 0
 v_mfma_f32_32x32x16_bf16 v[48:63], v[80:83], v[96:99], v[48:63]
 v_mfma_f32_32x32x16_bf16 v[48:63], v[84:87], v[100:103], v[48:63]
 ds_read_b128 v[64:67], v7 offset:45056
 ds_read_b64 v[68:69], v3 offset:46080
 ds_read_b128 v[80:83], v2 offset:45056
 ds_read_b128 v[84:87], v2 offset:46080
 s_waitcnt lgkmcnt(2)
 v_mfma_f32_32x32x16_bf16 v[16:31], v[64:67], v[8:11], 0
 v_mfma_f32_32x32x16_bf16 v[16:31], v[68:71], v[12:15], v[16:31]
 v_max3_f32 v106, v32, v33, v34
 v_max3_f32 v106, v106, v35, v36
 v_max3_f32 v106, v106, v37, v38
 v_max3_f32 v106, v106, v39, v40
 v_max3_f32 v106, v106, v41, v42
 v_max3_f32 v106, v106, v43, v44
 v_max3_f32 v106, v106, v45, v46
 v_max_f32 v106, v106, v47
 v_mov_b32 v107, v106
 s_nop 1
 v_permlane32_swap_b32 v106, v107
 v_max3_f32 v106, v106, v107, v104
 v_sub_f32 v107, v104, v106
 v_exp_f32 v107, v107
 v_mov_b32 v104, v106
 v_sub_f32 v32, v32, v106
 v_sub_f32 v33, v33, v106
 v_sub_f32 v34, v34, v106
 v_sub_f32 v35, v35, v106
 v_sub_f32 v36, v36, v106
 v_sub_f32 v37, v37, v106
 v_sub_f32 v38, v38, v106
 v_sub_f32 v39, v39, v106
 v_sub_f32 v40, v40, v106
 v_sub_f32 v41, v41, v106
 v_sub_f32 v42, v42, v106
 v_sub_f32 v43, v43, v106
 v_sub_f32 v44, v44, v106
 v_sub_f32 v45, v45, v106
 v_sub_f32 v46, v46, v106
 v_sub_f32 v47, v47, v106
 v_mul_f32 v48, v48, v107
 v_mul_f32 v49, v49, v107
 v_mul_f32 v50, v50, v107
 v_mul_f32 v51, v51, v107
 v_mul_f32 v52, v52, v107
 v_mul_f32 v53, v53, v107
 v_mul_f32 v54, v54, v107
 v_mul_f32 v55, v55, v107
 v_mul_f32 v56, v56, v107
 v_mul_f32 v57, v57, v107
 v_mul_f32 v58, v58, v107
 v_mul_f32 v59, v59, v107
 v_exp_f32 v32, v32
 v_exp_f32 v33, v33
 v_exp_f32 v34, v34
 v_exp_f32 v35, v35
 v_exp_f32 v36, v36
 v_exp_f32 v37, v37
 v_exp_f32 v38, v38
 v_exp_f32 v39, v39
 v_exp_f32 v40, v40
 v_exp_f32 v41, v41
 v_exp_f32 v42, v42
 v_exp_f32 v43, v43
 v_exp_f32 v44, v44
 v_exp_f32 v45, v45
 v_exp_f32 v46, v46
 v_exp_f32 v47, v47
 s_nop 0
 v_cvt_pk_bf16_f32 v96, v32, v33
 v_cvt_pk_bf16_f32 v97, v34, v35
 v_cvt_pk_bf16_f32 v98, v36, v37
 v_cvt_pk_bf16_f32 v99, v38, v39
 v_cvt_pk_bf16_f32 v100, v40, v41
 v_cvt_pk_bf16_f32 v101, v42, v43
 v_cvt_pk_bf16_f32 v102, v44, v45
 v_cvt_pk_bf16_f32 v103, v46, v47
 s_nop 0
 v_mfma_f32_32x32x16_bf16 v[48:63], v[88:91], v[96:99], v[48:63]
 v_mfma_f32_32x32x16_bf16 v[48:63], v[92:95], v[100:103], v[48:63]
 ds_read_b128 v[72:75], v7 offset:47104
 ds_read_b64 v[76:77], v3 offset:48128
 ds_read_b128 v[88:91], v2 offset:47104
 ds_read_b128 v[92:95], v2 offset:48128
 s_waitcnt lgkmcnt(2)
 v_mfma_f32_32x32x16_bf16 v[32:47], v[72:75], v[8:11], 0
 v_mfma_f32_32x32x16_bf16 v[32:47], v[76:79], v[12:15], v[32:47]
 v_max3_f32 v106, v16, v17, v18
 v_max3_f32 v106, v106, v19, v20
 v_max3_f32 v106, v106, v21, v22
 v_max3_f32 v106, v106, v23, v24
 v_max3_f32 v106, v106, v25, v26
 v_max3_f32 v106, v106, v27, v28
 v_max3_f32 v106, v106, v29, v30
 v_max_f32 v106, v106, v31
 v_mov_b32 v107, v106
 s_nop 1
 v_permlane32_swap_b32 v106, v107
 v_max3_f32 v106, v106, v107, v104
 v_sub_f32 v107, v104, v106
 v_exp_f32 v107, v107
 v_mov_b32 v104, v106
 v_sub_f32 v16, v16, v106
 v_sub_f32 v17, v17, v106
 v_sub_f32 v18, v18, v106
 v_sub_f32 v19, v19, v106
 v_sub_f32 v20, v20, v106
 v_sub_f32 v21, v21, v106
 v_sub_f32 v22, v22, v106
 v_sub_f32 v23, v23, v106
 v_sub_f32 v24, v24, v106
 v_sub_f32 v25, v25, v106
 v_sub_f32 v26, v26, v106
 v_sub_f32 v27, v27, v106
 v_sub_f32 v28, v28, v106
 v_sub_f32 v29, v29, v106
 v_sub_f32 v30, v30, v106
 v_sub_f32 v31, v31, v106
 v_mul_f32 v48, v48, v107
 v_mul_f32 v49, v49, v107
 v_mul_f32 v50, v50, v107
 v_mul_f32 v51, v51, v107
 v_mul_f32 v52, v52, v107
 v_mul_f32 v53, v53, v107
 v_mul_f32 v54, v54, v107
 v_mul_f32 v55, v55, v107
 v_mul_f32 v56, v56, v107
 v_mul_f32 v57, v57, v107
 v_mul_f32 v58, v58, v107
 v_mul_f32 v59, v59, v107
 v_exp_f32 v16, v16
 v_exp_f32 v17, v17
 v_exp_f32 v18, v18
 v_exp_f32 v19, v19
 v_exp_f32 v20, v20
 v_exp_f32 v21, v21
 v_exp_f32 v22, v22
 v_exp_f32 v23, v23
 v_exp_f32 v24, v24
 v_exp_f32 v25, v25
 v_exp_f32 v26, v26
 v_exp_f32 v27, v27
 v_exp_f32 v28, v28
 v_exp_f32 v29, v29
 v_exp_f32 v30, v30
 v_exp_f32 v31, v31
 s_nop 0
 v_cvt_pk_bf16_f32 v96, v16, v17
 v_cvt_pk_bf16_f32 v97, v18, v19
 v_cvt_pk_bf16_f32 v98, v20, v21
 v_cvt_pk_bf16_f32 v99, v22, v23
 v_cvt_pk_bf16_f32 v100, v24, v25
 v_cvt_pk_bf16_f32 v101, v26, v27
 v_cvt_pk_bf16_f32 v102, v28, v29
 v_cvt_pk_bf16_f32 v103, v30, v31
 s_nop 0
 v_mfma_f32_32x32x16_bf16 v[48:63], v[80:83], v[96:99], v[48:63]
 v_mfma_f32_32x32x16_bf16 v[48:63], v[84:87], v[100:103], v[48:63]
 s_nop 7
 v_max3_f32 v106, v32, v33, v34
 v_max3_f32 v106, v106, v35, v36
 v_max3_f32 v106, v106, v37, v38
 v_max3_f32 v106, v106, v39, v40
 v_max3_f32 v106, v106, v41, v42
 v_max3_f32 v106, v106, v43, v44
 v_max3_f32 v106, v106, v45, v46
 v_max_f32 v106, v106, v47
 v_mov_b32 v107, v106
 s_nop 1
 v_permlane32_swap_b32 v106, v107
 v_max3_f32 v106, v106, v107, v104
 v_sub_f32 v107, v104, v106
 v_exp_f32 v107, v107
 v_mov_b32 v104, v106
 v_sub_f32 v32, v32, v106
 v_sub_f32 v33, v33, v106
 v_sub_f32 v34, v34, v106
 v_sub_f32 v35, v35, v106
 v_sub_f32 v36, v36, v106
 v_sub_f32 v37, v37, v106
 v_sub_f32 v38, v38, v106
 v_sub_f32 v39, v39, v106
 v_sub_f32 v40, v40, v106
 v_sub_f32 v41, v41, v106
 v_sub_f32 v42, v42, v106
 v_sub_f32 v43, v43, v106
 v_sub_f32 v44, v44, v106
 v_sub_f32 v45, v45, v106
 v_sub_f32 v46, v46, v106
 v_sub_f32 v47, v47, v106
 v_mul_f32 v48, v48, v107
 v_mul_f32 v49, v49, v107
 v_mul_f32 v50, v50, v107
 v_mul_f32 v51, v51, v107
 v_mul_f32 v52, v52, v107
 v_mul_f32 v53, v53, v107
 v_mul_f32 v54, v54, v107
 v_mul_f32 v55, v55, v107
 v_mul_f32 v56, v56, v107
 v_mul_f32 v57, v57, v107
 v_mul_f32 v58, v58, v107
 v_mul_f32 v59, v59, v107
 v_exp_f32 v32, v32
 v_exp_f32 v33, v33
 v_exp_f32 v34, v34
 v_exp_f32 v35, v35
 v_exp_f32 v36, v36
 v_exp_f32 v37, v37
 v_exp_f32 v38, v38
 v_exp_f32 v39, v39
 v_exp_f32 v40, v40
 v_exp_f32 v41, v41
 v_exp_f32 v42, v42
 v_exp_f32 v43, v43
 v_exp_f32 v44, v44
 v_exp_f32 v45, v45
 v_exp_f32 v46, v46
 v_exp_f32 v47, v47
 s_nop 0
 v_cvt_pk_bf16_f32 v96, v32, v33
 v_cvt_pk_bf16_f32 v97, v34, v35
 v_cvt_pk_bf16_f32 v98, v36, v37
 v_cvt_pk_bf16_f32 v99, v38, v39
 v_cvt_pk_bf16_f32 v100, v40, v41
 v_cvt_pk_bf16_f32 v101, v42, v43
 v_cvt_pk_bf16_f32 v102, v44, v45
 v_cvt_pk_bf16_f32 v103, v46, v47
 s_waitcnt lgkmcnt(0)
 s_nop 0
 v_mfma_f32_32x32x16_bf16 v[48:63], v[88:91], v[96:99], v[48:63]
 v_mfma_f32_32x32x16_bf16 v[48:63], v[92:95], v[100:103], v[48:63]
 s_nop 11
 v_mov_b32 v106, v56
 v_mov_b32 v107, v56
 s_nop 1
 v_permlane32_swap_b32 v106, v107
 v_rcp_f32 v107, v107
 s_nop 0
 v_mul_f32 v48, v48, v107
 v_mul_f32 v49, v49, v107
 v_mul_f32 v50, v50, v107
 v_mul_f32 v51, v51, v107
 v_mul_f32 v52, v52, v107
 v_mul_f32 v53, v53, v107
 v_mul_f32 v54, v54, v107
 v_mul_f32 v55, v55, v107
 v_mul_f32 v56, v56, v107
 v_mul_f32 v57, v57, v107
 v_mul_f32 v58, v58, v107
 v_mul_f32 v59, v59, v107
 v_and_b32 v2, 31, v0
 s_lshl_b32 s22, s21, 5
 v_add_u32 v2, s22, v2
 v_mul_u32_u24 v2, 1280, v2
 v_bfe_u32 v3, v0, 5, 1
 v_lshl_add_u32 v2, v3, 3, v2
 s_mul_i32 s22, s20, 40
 v_cvt_pk_bf16_f32 v106, v48, v49
 v_cvt_pk_bf16_f32 v107, v50, v51
 buffer_store_dwordx2 v[106:107], v2, s[16:19], s22 offen offset:0
 v_cvt_pk_bf16_f32 v106, v52, v53
 v_cvt_pk_bf16_f32 v107, v54, v55
 buffer_store_dwordx2 v[106:107], v2, s[16:19], s22 offen offset:16
 v_cvt_pk_bf16_f32 v106, v56, v57
 v_cvt_pk_bf16_f32 v107, v58, v59
 v_cmp_gt_u32 vcc, 32, v1
 s_and_saveexec_b64 s[24:25], vcc
 buffer_store_dwordx2 v[106:107], v2, s[16:19], s22 offen offset:32
 s_mov_b64 exec, s[24:25]
L_attna_kernel_end:
 s_endpgm
.globl outa_0_kernel
.p2align 8
.type outa_0_kernel,@function
outa_0_kernel:
 s_cmp_ge_u32 s2, 160
 s_cbranch_scc1 L_outa_0_kernel_end
 s_load_dwordx2 s[4:5], s[0:1], 80
 s_load_dwordx2 s[36:37], s[0:1], 0
 s_and_b32 s32, s2, 31
 s_lshr_b32 s33, s2, 5
 v_lshrrev_b32 v1, 6, v0
 s_nop 0
 v_readfirstlane_b32 s34, v1
 s_waitcnt lgkmcnt(0)
 s_add_u32 s8, s4, 29360128
 s_addc_u32 s9, s5, 0
 s_mov_b32 s10, 2621440
 s_mov_b32 s11, 0x00020000
 s_add_u32 s12, s4, 1048576
 s_addc_u32 s13, s5, 0
 s_mov_b32 s14, 819200
 s_mov_b32 s15, 0x00020000
 s_mul_i32 s35, s32, 81920
 v_add_u32 v2, 0, v0
 v_lshlrev_b32 v3, 4, v2
 buffer_load_dwordx4 v[64:67], v3, s[8:11], s35 offen
 v_add_u32 v2, 256, v0
 v_lshlrev_b32 v3, 4, v2
 buffer_load_dwordx4 v[68:71], v3, s[8:11], s35 offen
 v_add_u32 v2, 512, v0
 v_lshlrev_b32 v3, 4, v2
 buffer_load_dwordx4 v[72:75], v3, s[8:11], s35 offen
 v_add_u32 v2, 768, v0
 v_lshlrev_b32 v3, 4, v2
 buffer_load_dwordx4 v[76:79], v3, s[8:11], s35 offen
 v_add_u32 v2, 1024, v0
 v_lshlrev_b32 v3, 4, v2
 buffer_load_dwordx4 v[80:83], v3, s[8:11], s35 offen
 v_add_u32 v2, 1280, v0
 v_lshlrev_b32 v3, 4, v2
 buffer_load_dwordx4 v[84:87], v3, s[8:11], s35 offen
 v_add_u32 v2, 1536, v0
 v_lshlrev_b32 v3, 4, v2
 buffer_load_dwordx4 v[88:91], v3, s[8:11], s35 offen
 v_add_u32 v2, 1792, v0
 v_lshlrev_b32 v3, 4, v2
 buffer_load_dwordx4 v[92:95], v3, s[8:11], s35 offen
 v_add_u32 v2, 2048, v0
 v_lshlrev_b32 v3, 4, v2
 buffer_load_dwordx4 v[96:99], v3, s[8:11], s35 offen
 v_add_u32 v2, 2304, v0
 v_lshlrev_b32 v3, 4, v2
 buffer_load_dwordx4 v[100:103], v3, s[8:11], s35 offen
 v_add_u32 v2, 2560, v0
 v_lshlrev_b32 v3, 4, v2
 buffer_load_dwordx4 v[104:107], v3, s[8:11], s35 offen
 v_add_u32 v2, 2816, v0
 v_lshlrev_b32 v3, 4, v2
 buffer_load_dwordx4 v[108:111], v3, s[8:11], s35 offen
 v_add_u32 v2, 3072, v0
 v_lshlrev_b32 v3, 4, v2
 buffer_load_dwordx4 v[112:115], v3, s[8:11], s35 offen
 v_add_u32 v2, 3328, v0
 v_lshlrev_b32 v3, 4, v2
 buffer_load_dwordx4 v[116:119], v3, s[8:11], s35 offen
 v_add_u32 v2, 3584, v0
 v_lshlrev_b32 v3, 4, v2
 buffer_load_dwordx4 v[120:123], v3, s[8:11], s35 offen
 v_add_u32 v2, 3840, v0
 v_lshlrev_b32 v3, 4, v2
 buffer_load_dwordx4 v[124:127], v3, s[8:11], s35 offen
 v_add_u32 v2, 4096, v0
 v_lshlrev_b32 v3, 4, v2
 buffer_load_dwordx4 v[128:131], v3, s[8:11], s35 offen
 v_add_u32 v2, 4352, v0
 v_lshlrev_b32 v3, 4, v2
 buffer_load_dwordx4 v[132:135], v3, s[8:11], s35 offen
 v_add_u32 v2, 4608, v0
 v_lshlrev_b32 v3, 4, v2
 buffer_load_dwordx4 v[136:139], v3, s[8:11], s35 offen
 v_add_u32 v2, 4864, v0
 v_lshlrev_b32 v3, 4, v2
 buffer_load_dwordx4 v[140:143], v3, s[8:11], s35 offen
 v_add_u32 v2, 0, v0
 v_mul_u32_u24 v3, 52429, v2
 v_lshrrev_b32 v3, 22, v3
 v_add_u32 v3, v3, v2
 v_lshlrev_b32 v3, 4, v3
 s_waitcnt vmcnt(19)
 ds_write_b128 v3, v[64:67]
 v_add_u32 v2, 256, v0
 v_mul_u32_u24 v3, 52429, v2
 v_lshrrev_b32 v3, 22, v3
 v_add_u32 v3, v3, v2
 v_lshlrev_b32 v3, 4, v3
 s_waitcnt vmcnt(18)
 ds_write_b128 v3, v[68:71]
 v_add_u32 v2, 512, v0
 v_mul_u32_u24 v3, 52429, v2
 v_lshrrev_b32 v3, 22, v3
 v_add_u32 v3, v3, v2
 v_lshlrev_b32 v3, 4, v3
 s_waitcnt vmcnt(17)
 ds_write_b128 v3, v[72:75]
 v_add_u32 v2, 768, v0
 v_mul_u32_u24 v3, 52429, v2
 v_lshrrev_b32 v3, 22, v3
 v_add_u32 v3, v3, v2
 v_lshlrev_b32 v3, 4, v3
 s_waitcnt vmcnt(16)
 ds_write_b128 v3, v[76:79]
 v_add_u32 v2, 1024, v0
 v_mul_u32_u24 v3, 52429, v2
 v_lshrrev_b32 v3, 22, v3
 v_add_u32 v3, v3, v2
 v_lshlrev_b32 v3, 4, v3
 s_waitcnt vmcnt(15)
 ds_write_b128 v3, v[80:83]
 v_add_u32 v2, 1280, v0
 v_mul_u32_u24 v3, 52429, v2
 v_lshrrev_b32 v3, 22, v3
 v_add_u32 v3, v3, v2
 v_lshlrev_b32 v3, 4, v3
 s_waitcnt vmcnt(14)
 ds_write_b128 v3, v[84:87]
 v_add_u32 v2, 1536, v0
 v_mul_u32_u24 v3, 52429, v2
 v_lshrrev_b32 v3, 22, v3
 v_add_u32 v3, v3, v2
 v_lshlrev_b32 v3, 4, v3
 s_waitcnt vmcnt(13)
 ds_write_b128 v3, v[88:91]
 v_add_u32 v2, 1792, v0
 v_mul_u32_u24 v3, 52429, v2
 v_lshrrev_b32 v3, 22, v3
 v_add_u32 v3, v3, v2
 v_lshlrev_b32 v3, 4, v3
 s_waitcnt vmcnt(12)
 ds_write_b128 v3, v[92:95]
 v_add_u32 v2, 2048, v0
 v_mul_u32_u24 v3, 52429, v2
 v_lshrrev_b32 v3, 22, v3
 v_add_u32 v3, v3, v2
 v_lshlrev_b32 v3, 4, v3
 s_waitcnt vmcnt(11)
 ds_write_b128 v3, v[96:99]
 v_add_u32 v2, 2304, v0
 v_mul_u32_u24 v3, 52429, v2
 v_lshrrev_b32 v3, 22, v3
 v_add_u32 v3, v3, v2
 v_lshlrev_b32 v3, 4, v3
 s_waitcnt vmcnt(10)
 ds_write_b128 v3, v[100:103]
 v_add_u32 v2, 2560, v0
 v_mul_u32_u24 v3, 52429, v2
 v_lshrrev_b32 v3, 22, v3
 v_add_u32 v3, v3, v2
 v_lshlrev_b32 v3, 4, v3
 s_waitcnt vmcnt(9)
 ds_write_b128 v3, v[104:107]
 v_add_u32 v2, 2816, v0
 v_mul_u32_u24 v3, 52429, v2
 v_lshrrev_b32 v3, 22, v3
 v_add_u32 v3, v3, v2
 v_lshlrev_b32 v3, 4, v3
 s_waitcnt vmcnt(8)
 ds_write_b128 v3, v[108:111]
 v_add_u32 v2, 3072, v0
 v_mul_u32_u24 v3, 52429, v2
 v_lshrrev_b32 v3, 22, v3
 v_add_u32 v3, v3, v2
 v_lshlrev_b32 v3, 4, v3
 s_waitcnt vmcnt(7)
 ds_write_b128 v3, v[112:115]
 v_add_u32 v2, 3328, v0
 v_mul_u32_u24 v3, 52429, v2
 v_lshrrev_b32 v3, 22, v3
 v_add_u32 v3, v3, v2
 v_lshlrev_b32 v3, 4, v3
 s_waitcnt vmcnt(6)
 ds_write_b128 v3, v[116:119]
 v_add_u32 v2, 3584, v0
 v_mul_u32_u24 v3, 52429, v2
 v_lshrrev_b32 v3, 22, v3
 v_add_u32 v3, v3, v2
 v_lshlrev_b32 v3, 4, v3
 s_waitcnt vmcnt(5)
 ds_write_b128 v3, v[120:123]
 v_add_u32 v2, 3840, v0
 v_mul_u32_u24 v3, 52429, v2
 v_lshrrev_b32 v3, 22, v3
 v_add_u32 v3, v3, v2
 v_lshlrev_b32 v3, 4, v3
 s_waitcnt vmcnt(4)
 ds_write_b128 v3, v[124:127]
 v_add_u32 v2, 4096, v0
 v_mul_u32_u24 v3, 52429, v2
 v_lshrrev_b32 v3, 22, v3
 v_add_u32 v3, v3, v2
 v_lshlrev_b32 v3, 4, v3
 s_waitcnt vmcnt(3)
 ds_write_b128 v3, v[128:131]
 v_add_u32 v2, 4352, v0
 v_mul_u32_u24 v3, 52429, v2
 v_lshrrev_b32 v3, 22, v3
 v_add_u32 v3, v3, v2
 v_lshlrev_b32 v3, 4, v3
 s_waitcnt vmcnt(2)
 ds_write_b128 v3, v[132:135]
 v_add_u32 v2, 4608, v0
 v_mul_u32_u24 v3, 52429, v2
 v_lshrrev_b32 v3, 22, v3
 v_add_u32 v3, v3, v2
 v_lshlrev_b32 v3, 4, v3
 s_waitcnt vmcnt(1)
 ds_write_b128 v3, v[136:139]
 v_add_u32 v2, 4864, v0
 v_mul_u32_u24 v3, 52429, v2
 v_lshrrev_b32 v3, 22, v3
 v_add_u32 v3, v3, v2
 v_lshlrev_b32 v3, 4, v3
 s_waitcnt vmcnt(0)
 ds_write_b128 v3, v[140:143]
 s_waitcnt lgkmcnt(0)
 s_barrier
 s_mul_i32 s40, s33, 4
 s_mul_i32 s41, s34, 1
 s_add_u32 s40, s40, s41
 s_cmp_ge_u32 s40, 20
 s_cbranch_scc1 L_outa_0_kernel_end
 s_add_u32 s41, s40, 0
 s_mul_i32 s42, s41, 40960
 v_and_b32 v2, 63, v0
 v_lshlrev_b32 v4, 4, v2
 v_and_b32 v3, 31, v0
 v_mul_u32_u24 v5, 1296, v3
 v_bfe_u32 v6, v0, 5, 1
 v_lshlrev_b32 v6, 4, v6
 v_add_u32 v5, v5, v6
 v_add_u32 v7, 41472, v5
 v_mov_b32 v64, 0
 v_mov_b32 v65, 0
 v_mov_b32 v66, 0
 v_mov_b32 v67, 0
 v_mov_b32 v68, 0
 v_mov_b32 v69, 0
 v_mov_b32 v70, 0
 v_mov_b32 v71, 0
 v_mov_b32 v72, 0
 v_mov_b32 v73, 0
 v_mov_b32 v74, 0
 v_mov_b32 v75, 0
 v_mov_b32 v76, 0
 v_mov_b32 v77, 0
 v_mov_b32 v78, 0
 v_mov_b32 v79, 0
 v_mov_b32 v80, 0
 v_mov_b32 v81, 0
 v_mov_b32 v82, 0
 v_mov_b32 v83, 0
 v_mov_b32 v84, 0
 v_mov_b32 v85, 0
 v_mov_b32 v86, 0
 v_mov_b32 v87, 0
 v_mov_b32 v88, 0
 v_mov_b32 v89, 0
 v_mov_b32 v90, 0
 v_mov_b32 v91, 0
 v_mov_b32 v92, 0
 v_mov_b32 v93, 0
 v_mov_b32 v94, 0
 v_mov_b32 v95, 0
 s_add_u32 s20, s36, 0
 s_addc_u32 s21, s37, 0
 s_mov_b32 s22, 2621440
 s_mov_b32 s23, 0x00020000
 s_add_u32 s24, s4, 6291456
 s_addc_u32 s25, s5, 0
 s_mov_b32 s26, 2621440
 s_mov_b32 s27, 0x00020000
 buffer_load_dwordx4 v[128:131], v4, s[12:15], s42 offen
 s_add_u32 s42, s42, 1024
 buffer_load_dwordx4 v[132:135], v4, s[12:15], s42 offen
 s_add_u32 s42, s42, 1024
 buffer_load_dwordx4 v[136:139], v4, s[12:15], s42 offen
 s_add_u32 s42, s42, 1024
 buffer_load_dwordx4 v[140:143], v4, s[12:15], s42 offen
 s_add_u32 s42, s42, 1024
 ds_read_b128 v[160:163], v5 offset:0
 ds_read_b128 v[164:167], v7 offset:0
 ds_read_b128 v[168:171], v5 offset:32
 ds_read_b128 v[172:175], v7 offset:32
 s_waitcnt vmcnt(3) lgkmcnt(2)
 v_mfma_f32_32x32x16_bf16 v[64:79], v[128:131], v[160:163], v[64:79]
 v_mfma_f32_32x32x16_bf16 v[80:95], v[128:131], v[164:167], v[80:95]
 buffer_load_dwordx4 v[128:131], v4, s[12:15], s42 offen
 s_add_u32 s42, s42, 1024
 ds_read_b128 v[160:163], v5 offset:64
 ds_read_b128 v[164:167], v7 offset:64
 s_waitcnt vmcnt(3) lgkmcnt(2)
 v_mfma_f32_32x32x16_bf16 v[64:79], v[132:135], v[168:171], v[64:79]
 v_mfma_f32_32x32x16_bf16 v[80:95], v[132:135], v[172:175], v[80:95]
 buffer_load_dwordx4 v[132:135], v4, s[12:15], s42 offen
 s_add_u32 s42, s42, 1024
 ds_read_b128 v[168:171], v5 offset:96
 ds_read_b128 v[172:175], v7 offset:96
 s_waitcnt vmcnt(3) lgkmcnt(2)
 v_mfma_f32_32x32x16_bf16 v[64:79], v[136:139], v[160:163], v[64:79]
 v_mfma_f32_32x32x16_bf16 v[80:95], v[136:139], v[164:167], v[80:95]
 buffer_load_dwordx4 v[136:139], v4, s[12:15], s42 offen
 s_add_u32 s42, s42, 1024
 ds_read_b128 v[160:163], v5 offset:128
 ds_read_b128 v[164:167], v7 offset:128
 s_waitcnt vmcnt(3) lgkmcnt(2)
 v_mfma_f32_32x32x16_bf16 v[64:79], v[140:143], v[168:171], v[64:79]
 v_mfma_f32_32x32x16_bf16 v[80:95], v[140:143], v[172:175], v[80:95]
 buffer_load_dwordx4 v[140:143], v4, s[12:15], s42 offen
 s_add_u32 s42, s42, 1024
 ds_read_b128 v[168:171], v5 offset:160
 ds_read_b128 v[172:175], v7 offset:160
 s_waitcnt vmcnt(3) lgkmcnt(2)
 v_mfma_f32_32x32x16_bf16 v[64:79], v[128:131], v[160:163], v[64:79]
 v_mfma_f32_32x32x16_bf16 v[80:95], v[128:131], v[164:167], v[80:95]
 buffer_load_dwordx4 v[128:131], v4, s[12:15], s42 offen
 s_add_u32 s42, s42, 1024
 ds_read_b128 v[160:163], v5 offset:192
 ds_read_b128 v[164:167], v7 offset:192
 s_waitcnt vmcnt(3) lgkmcnt(2)
 v_mfma_f32_32x32x16_bf16 v[64:79], v[132:135], v[168:171], v[64:79]
 v_mfma_f32_32x32x16_bf16 v[80:95], v[132:135], v[172:175], v[80:95]
 buffer_load_dwordx4 v[132:135], v4, s[12:15], s42 offen
 s_add_u32 s42, s42, 1024
 ds_read_b128 v[168:171], v5 offset:224
 ds_read_b128 v[172:175], v7 offset:224
 s_waitcnt vmcnt(3) lgkmcnt(2)
 v_mfma_f32_32x32x16_bf16 v[64:79], v[136:139], v[160:163], v[64:79]
 v_mfma_f32_32x32x16_bf16 v[80:95], v[136:139], v[164:167], v[80:95]
 buffer_load_dwordx4 v[136:139], v4, s[12:15], s42 offen
 s_add_u32 s42, s42, 1024
 ds_read_b128 v[160:163], v5 offset:256
 ds_read_b128 v[164:167], v7 offset:256
 s_waitcnt vmcnt(3) lgkmcnt(2)
 v_mfma_f32_32x32x16_bf16 v[64:79], v[140:143], v[168:171], v[64:79]
 v_mfma_f32_32x32x16_bf16 v[80:95], v[140:143], v[172:175], v[80:95]
 buffer_load_dwordx4 v[140:143], v4, s[12:15], s42 offen
 s_add_u32 s42, s42, 1024
 ds_read_b128 v[168:171], v5 offset:288
 ds_read_b128 v[172:175], v7 offset:288
 s_waitcnt vmcnt(3) lgkmcnt(2)
 v_mfma_f32_32x32x16_bf16 v[64:79], v[128:131], v[160:163], v[64:79]
 v_mfma_f32_32x32x16_bf16 v[80:95], v[128:131], v[164:167], v[80:95]
 buffer_load_dwordx4 v[128:131], v4, s[12:15], s42 offen
 s_add_u32 s42, s42, 1024
 ds_read_b128 v[160:163], v5 offset:320
 ds_read_b128 v[164:167], v7 offset:320
 s_waitcnt vmcnt(3) lgkmcnt(2)
 v_mfma_f32_32x32x16_bf16 v[64:79], v[132:135], v[168:171], v[64:79]
 v_mfma_f32_32x32x16_bf16 v[80:95], v[132:135], v[172:175], v[80:95]
 buffer_load_dwordx4 v[132:135], v4, s[12:15], s42 offen
 s_add_u32 s42, s42, 1024
 ds_read_b128 v[168:171], v5 offset:352
 ds_read_b128 v[172:175], v7 offset:352
 s_waitcnt vmcnt(3) lgkmcnt(2)
 v_mfma_f32_32x32x16_bf16 v[64:79], v[136:139], v[160:163], v[64:79]
 v_mfma_f32_32x32x16_bf16 v[80:95], v[136:139], v[164:167], v[80:95]
 buffer_load_dwordx4 v[136:139], v4, s[12:15], s42 offen
 s_add_u32 s42, s42, 1024
 ds_read_b128 v[160:163], v5 offset:384
 ds_read_b128 v[164:167], v7 offset:384
 s_waitcnt vmcnt(3) lgkmcnt(2)
 v_mfma_f32_32x32x16_bf16 v[64:79], v[140:143], v[168:171], v[64:79]
 v_mfma_f32_32x32x16_bf16 v[80:95], v[140:143], v[172:175], v[80:95]
 buffer_load_dwordx4 v[140:143], v4, s[12:15], s42 offen
 s_add_u32 s42, s42, 1024
 ds_read_b128 v[168:171], v5 offset:416
 ds_read_b128 v[172:175], v7 offset:416
 s_waitcnt vmcnt(3) lgkmcnt(2)
 v_mfma_f32_32x32x16_bf16 v[64:79], v[128:131], v[160:163], v[64:79]
 v_mfma_f32_32x32x16_bf16 v[80:95], v[128:131], v[164:167], v[80:95]
 buffer_load_dwordx4 v[128:131], v4, s[12:15], s42 offen
 s_add_u32 s42, s42, 1024
 ds_read_b128 v[160:163], v5 offset:448
 ds_read_b128 v[164:167], v7 offset:448
 s_waitcnt vmcnt(3) lgkmcnt(2)
 v_mfma_f32_32x32x16_bf16 v[64:79], v[132:135], v[168:171], v[64:79]
 v_mfma_f32_32x32x16_bf16 v[80:95], v[132:135], v[172:175], v[80:95]
 buffer_load_dwordx4 v[132:135], v4, s[12:15], s42 offen
 s_add_u32 s42, s42, 1024
 ds_read_b128 v[168:171], v5 offset:480
 ds_read_b128 v[172:175], v7 offset:480
 s_waitcnt vmcnt(3) lgkmcnt(2)
 v_mfma_f32_32x32x16_bf16 v[64:79], v[136:139], v[160:163], v[64:79]
 v_mfma_f32_32x32x16_bf16 v[80:95], v[136:139], v[164:167], v[80:95]
 buffer_load_dwordx4 v[136:139], v4, s[12:15], s42 offen
 s_add_u32 s42, s42, 1024
 ds_read_b128 v[160:163], v5 offset:512
 ds_read_b128 v[164:167], v7 offset:512
 s_waitcnt vmcnt(3) lgkmcnt(2)
 v_mfma_f32_32x32x16_bf16 v[64:79], v[140:143], v[168:171], v[64:79]
 v_mfma_f32_32x32x16_bf16 v[80:95], v[140:143], v[172:175], v[80:95]
 buffer_load_dwordx4 v[140:143], v4, s[12:15], s42 offen
 s_add_u32 s42, s42, 1024
 ds_read_b128 v[168:171], v5 offset:544
 ds_read_b128 v[172:175], v7 offset:544
 s_waitcnt vmcnt(3) lgkmcnt(2)
 v_mfma_f32_32x32x16_bf16 v[64:79], v[128:131], v[160:163], v[64:79]
 v_mfma_f32_32x32x16_bf16 v[80:95], v[128:131], v[164:167], v[80:95]
 buffer_load_dwordx4 v[128:131], v4, s[12:15], s42 offen
 s_add_u32 s42, s42, 1024
 ds_read_b128 v[160:163], v5 offset:576
 ds_read_b128 v[164:167], v7 offset:576
 s_waitcnt vmcnt(3) lgkmcnt(2)
 v_mfma_f32_32x32x16_bf16 v[64:79], v[132:135], v[168:171], v[64:79]
 v_mfma_f32_32x32x16_bf16 v[80:95], v[132:135], v[172:175], v[80:95]
 buffer_load_dwordx4 v[132:135], v4, s[12:15], s42 offen
 s_add_u32 s42, s42, 1024
 ds_read_b128 v[168:171], v5 offset:608
 ds_read_b128 v[172:175], v7 offset:608
 s_waitcnt vmcnt(3) lgkmcnt(2)
 v_mfma_f32_32x32x16_bf16 v[64:79], v[136:139], v[160:163], v[64:79]
 v_mfma_f32_32x32x16_bf16 v[80:95], v[136:139], v[164:167], v[80:95]
 buffer_load_dwordx4 v[136:139], v4, s[12:15], s42 offen
 s_add_u32 s42, s42, 1024
 ds_read_b128 v[160:163], v5 offset:640
 ds_read_b128 v[164:167], v7 offset:640
 s_waitcnt vmcnt(3) lgkmcnt(2)
 v_mfma_f32_32x32x16_bf16 v[64:79], v[140:143], v[168:171], v[64:79]
 v_mfma_f32_32x32x16_bf16 v[80:95], v[140:143], v[172:175], v[80:95]
 buffer_load_dwordx4 v[140:143], v4, s[12:15], s42 offen
 s_add_u32 s42, s42, 1024
 ds_read_b128 v[168:171], v5 offset:672
 ds_read_b128 v[172:175], v7 offset:672
 s_waitcnt vmcnt(3) lgkmcnt(2)
 v_mfma_f32_32x32x16_bf16 v[64:79], v[128:131], v[160:163], v[64:79]
 v_mfma_f32_32x32x16_bf16 v[80:95], v[128:131], v[164:167], v[80:95]
 buffer_load_dwordx4 v[128:131], v4, s[12:15], s42 offen
 s_add_u32 s42, s42, 1024
 ds_read_b128 v[160:163], v5 offset:704
 ds_read_b128 v[164:167], v7 offset:704
 s_waitcnt vmcnt(3) lgkmcnt(2)
 v_mfma_f32_32x32x16_bf16 v[64:79], v[132:135], v[168:171], v[64:79]
 v_mfma_f32_32x32x16_bf16 v[80:95], v[132:135], v[172:175], v[80:95]
 buffer_load_dwordx4 v[132:135], v4, s[12:15], s42 offen
 s_add_u32 s42, s42, 1024
 ds_read_b128 v[168:171], v5 offset:736
 ds_read_b128 v[172:175], v7 offset:736
 s_waitcnt vmcnt(3) lgkmcnt(2)
 v_mfma_f32_32x32x16_bf16 v[64:79], v[136:139], v[160:163], v[64:79]
 v_mfma_f32_32x32x16_bf16 v[80:95], v[136:139], v[164:167], v[80:95]
 buffer_load_dwordx4 v[136:139], v4, s[12:15], s42 offen
 s_add_u32 s42, s42, 1024
 ds_read_b128 v[160:163], v5 offset:768
 ds_read_b128 v[164:167], v7 offset:768
 s_waitcnt vmcnt(3) lgkmcnt(2)
 v_mfma_f32_32x32x16_bf16 v[64:79], v[140:143], v[168:171], v[64:79]
 v_mfma_f32_32x32x16_bf16 v[80:95], v[140:143], v[172:175], v[80:95]
 buffer_load_dwordx4 v[140:143], v4, s[12:15], s42 offen
 s_add_u32 s42, s42, 1024
 ds_read_b128 v[168:171], v5 offset:800
 ds_read_b128 v[172:175], v7 offset:800
 s_waitcnt vmcnt(3) lgkmcnt(2)
 v_mfma_f32_32x32x16_bf16 v[64:79], v[128:131], v[160:163], v[64:79]
 v_mfma_f32_32x32x16_bf16 v[80:95], v[128:131], v[164:167], v[80:95]
 buffer_load_dwordx4 v[128:131], v4, s[12:15], s42 offen
 s_add_u32 s42, s42, 1024
 ds_read_b128 v[160:163], v5 offset:832
 ds_read_b128 v[164:167], v7 offset:832
 s_waitcnt vmcnt(3) lgkmcnt(2)
 v_mfma_f32_32x32x16_bf16 v[64:79], v[132:135], v[168:171], v[64:79]
 v_mfma_f32_32x32x16_bf16 v[80:95], v[132:135], v[172:175], v[80:95]
 buffer_load_dwordx4 v[132:135], v4, s[12:15], s42 offen
 s_add_u32 s42, s42, 1024
 ds_read_b128 v[168:171], v5 offset:864
 ds_read_b128 v[172:175], v7 offset:864
 s_waitcnt vmcnt(3) lgkmcnt(2)
 v_mfma_f32_32x32x16_bf16 v[64:79], v[136:139], v[160:163], v[64:79]
 v_mfma_f32_32x32x16_bf16 v[80:95], v[136:139], v[164:167], v[80:95]
 buffer_load_dwordx4 v[136:139], v4, s[12:15], s42 offen
 s_add_u32 s42, s42, 1024
 ds_read_b128 v[160:163], v5 offset:896
 ds_read_b128 v[164:167], v7 offset:896
 s_waitcnt vmcnt(3) lgkmcnt(2)
 v_mfma_f32_32x32x16_bf16 v[64:79], v[140:143], v[168:171], v[64:79]
 v_mfma_f32_32x32x16_bf16 v[80:95], v[140:143], v[172:175], v[80:95]
 buffer_load_dwordx4 v[140:143], v4, s[12:15], s42 offen
 s_add_u32 s42, s42, 1024
 ds_read_b128 v[168:171], v5 offset:928
 ds_read_b128 v[172:175], v7 offset:928
 s_waitcnt vmcnt(3) lgkmcnt(2)
 v_mfma_f32_32x32x16_bf16 v[64:79], v[128:131], v[160:163], v[64:79]
 v_mfma_f32_32x32x16_bf16 v[80:95], v[128:131], v[164:167], v[80:95]
 buffer_load_dwordx4 v[128:131], v4, s[12:15], s42 offen
 s_add_u32 s42, s42, 1024
 ds_read_b128 v[160:163], v5 offset:960
 ds_read_b128 v[164:167], v7 offset:960
 s_waitcnt vmcnt(3) lgkmcnt(2)
 v_mfma_f32_32x32x16_bf16 v[64:79], v[132:135], v[168:171], v[64:79]
 v_mfma_f32_32x32x16_bf16 v[80:95], v[132:135], v[172:175], v[80:95]
 buffer_load_dwordx4 v[132:135], v4, s[12:15], s42 offen
 s_add_u32 s42, s42, 1024
 ds_read_b128 v[168:171], v5 offset:992
 ds_read_b128 v[172:175], v7 offset:992
 s_waitcnt vmcnt(3) lgkmcnt(2)
 v_mfma_f32_32x32x16_bf16 v[64:79], v[136:139], v[160:163], v[64:79]
 v_mfma_f32_32x32x16_bf16 v[80:95], v[136:139], v[164:167], v[80:95]
 buffer_load_dwordx4 v[136:139], v4, s[12:15], s42 offen
 s_add_u32 s42, s42, 1024
 ds_read_b128 v[160:163], v5 offset:1024
 ds_read_b128 v[164:167], v7 offset:1024
 s_waitcnt vmcnt(3) lgkmcnt(2)
 v_mfma_f32_32x32x16_bf16 v[64:79], v[140:143], v[168:171], v[64:79]
 v_mfma_f32_32x32x16_bf16 v[80:95], v[140:143], v[172:175], v[80:95]
 buffer_load_dwordx4 v[140:143], v4, s[12:15], s42 offen
 s_add_u32 s42, s42, 1024
 ds_read_b128 v[168:171], v5 offset:1056
 ds_read_b128 v[172:175], v7 offset:1056
 s_waitcnt vmcnt(3) lgkmcnt(2)
 v_mfma_f32_32x32x16_bf16 v[64:79], v[128:131], v[160:163], v[64:79]
 v_mfma_f32_32x32x16_bf16 v[80:95], v[128:131], v[164:167], v[80:95]
 buffer_load_dwordx4 v[128:131], v4, s[12:15], s42 offen
 s_add_u32 s42, s42, 1024
 ds_read_b128 v[160:163], v5 offset:1088
 ds_read_b128 v[164:167], v7 offset:1088
 s_waitcnt vmcnt(3) lgkmcnt(2)
 v_mfma_f32_32x32x16_bf16 v[64:79], v[132:135], v[168:171], v[64:79]
 v_mfma_f32_32x32x16_bf16 v[80:95], v[132:135], v[172:175], v[80:95]
 buffer_load_dwordx4 v[132:135], v4, s[12:15], s42 offen
 s_add_u32 s42, s42, 1024
 ds_read_b128 v[168:171], v5 offset:1120
 ds_read_b128 v[172:175], v7 offset:1120
 s_waitcnt vmcnt(3) lgkmcnt(2)
 v_mfma_f32_32x32x16_bf16 v[64:79], v[136:139], v[160:163], v[64:79]
 v_mfma_f32_32x32x16_bf16 v[80:95], v[136:139], v[164:167], v[80:95]
 buffer_load_dwordx4 v[136:139], v4, s[12:15], s42 offen
 s_add_u32 s42, s42, 1024
 ds_read_b128 v[160:163], v5 offset:1152
 ds_read_b128 v[164:167], v7 offset:1152
 s_waitcnt vmcnt(3) lgkmcnt(2)
 v_mfma_f32_32x32x16_bf16 v[64:79], v[140:143], v[168:171], v[64:79]
 v_mfma_f32_32x32x16_bf16 v[80:95], v[140:143], v[172:175], v[80:95]
 buffer_load_dwordx4 v[140:143], v4, s[12:15], s42 offen
 s_add_u32 s42, s42, 1024
 ds_read_b128 v[168:171], v5 offset:1184
 ds_read_b128 v[172:175], v7 offset:1184
 s_waitcnt vmcnt(3) lgkmcnt(2)
 v_mfma_f32_32x32x16_bf16 v[64:79], v[128:131], v[160:163], v[64:79]
 v_mfma_f32_32x32x16_bf16 v[80:95], v[128:131], v[164:167], v[80:95]
 ds_read_b128 v[160:163], v5 offset:1216
 ds_read_b128 v[164:167], v7 offset:1216
 s_waitcnt vmcnt(2) lgkmcnt(2)
 v_mfma_f32_32x32x16_bf16 v[64:79], v[132:135], v[168:171], v[64:79]
 v_mfma_f32_32x32x16_bf16 v[80:95], v[132:135], v[172:175], v[80:95]
 ds_read_b128 v[168:171], v5 offset:1248
 ds_read_b128 v[172:175], v7 offset:1248
 s_waitcnt vmcnt(1) lgkmcnt(2)
 v_mfma_f32_32x32x16_bf16 v[64:79], v[136:139], v[160:163], v[64:79]
 v_mfma_f32_32x32x16_bf16 v[80:95], v[136:139], v[164:167], v[80:95]
 s_waitcnt vmcnt(0) lgkmcnt(0)
 v_mfma_f32_32x32x16_bf16 v[64:79], v[140:143], v[168:171], v[64:79]
 v_mfma_f32_32x32x16_bf16 v[80:95], v[140:143], v[172:175], v[80:95]
 s_nop 11
 v_bfe_u32 v8, v0, 5, 1
 v_lshlrev_b32 v8, 3, v8
 v_and_b32 v9, 31, v0
 v_mul_u32_u24 v9, 1280, v9
 v_add_u32 v8, v8, v9
 s_lshl_b32 s46, s40, 6
 s_add_u32 s46, s46, s35
 v_add_u32 v9, 40960, v8
 buffer_load_dwordx2 v[12:13], v8, s[20:23], s46 offen offset:0
 buffer_load_dwordx2 v[14:15], v8, s[20:23], s46 offen offset:16
 buffer_load_dwordx2 v[16:17], v8, s[20:23], s46 offen offset:32
 buffer_load_dwordx2 v[18:19], v8, s[20:23], s46 offen offset:48
 buffer_load_dwordx2 v[20:21], v9, s[20:23], s46 offen offset:0
 buffer_load_dwordx2 v[22:23], v9, s[20:23], s46 offen offset:16
 buffer_load_dwordx2 v[24:25], v9, s[20:23], s46 offen offset:32
 buffer_load_dwordx2 v[26:27], v9, s[20:23], s46 offen offset:48
 s_waitcnt vmcnt(7)
 v_lshlrev_b32 v32, 16, v12
 v_and_b32 v33, 0xffff0000, v12
 v_lshlrev_b32 v34, 16, v13
 v_and_b32 v35, 0xffff0000, v13
 v_add_f32 v32, v32, v64
 v_add_f32 v33, v33, v65
 v_add_f32 v34, v34, v66
 v_add_f32 v35, v35, v67
 v_cvt_pk_bf16_f32 v36, v32, v33
 v_cvt_pk_bf16_f32 v37, v34, v35
 buffer_store_dwordx2 v[36:37], v8, s[24:27], s46 offen offset:0
 s_waitcnt vmcnt(7)
 v_lshlrev_b32 v32, 16, v14
 v_and_b32 v33, 0xffff0000, v14
 v_lshlrev_b32 v34, 16, v15
 v_and_b32 v35, 0xffff0000, v15
 v_add_f32 v32, v32, v68
 v_add_f32 v33, v33, v69
 v_add_f32 v34, v34, v70
 v_add_f32 v35, v35, v71
 v_cvt_pk_bf16_f32 v36, v32, v33
 v_cvt_pk_bf16_f32 v37, v34, v35
 buffer_store_dwordx2 v[36:37], v8, s[24:27], s46 offen offset:16
 s_waitcnt vmcnt(7)
 v_lshlrev_b32 v32, 16, v16
 v_and_b32 v33, 0xffff0000, v16
 v_lshlrev_b32 v34, 16, v17
 v_and_b32 v35, 0xffff0000, v17
 v_add_f32 v32, v32, v72
 v_add_f32 v33, v33, v73
 v_add_f32 v34, v34, v74
 v_add_f32 v35, v35, v75
 v_cvt_pk_bf16_f32 v36, v32, v33
 v_cvt_pk_bf16_f32 v37, v34, v35
 buffer_store_dwordx2 v[36:37], v8, s[24:27], s46 offen offset:32
 s_waitcnt vmcnt(7)
 v_lshlrev_b32 v32, 16, v18
 v_and_b32 v33, 0xffff0000, v18
 v_lshlrev_b32 v34, 16, v19
 v_and_b32 v35, 0xffff0000, v19
 v_add_f32 v32, v32, v76
 v_add_f32 v33, v33, v77
 v_add_f32 v34, v34, v78
 v_add_f32 v35, v35, v79
 v_cvt_pk_bf16_f32 v36, v32, v33
 v_cvt_pk_bf16_f32 v37, v34, v35
 buffer_store_dwordx2 v[36:37], v8, s[24:27], s46 offen offset:48
 s_waitcnt vmcnt(7)
 v_lshlrev_b32 v32, 16, v20
 v_and_b32 v33, 0xffff0000, v20
 v_lshlrev_b32 v34, 16, v21
 v_and_b32 v35, 0xffff0000, v21
 v_add_f32 v32, v32, v80
 v_add_f32 v33, v33, v81
 v_add_f32 v34, v34, v82
 v_add_f32 v35, v35, v83
 v_cvt_pk_bf16_f32 v36, v32, v33
 v_cvt_pk_bf16_f32 v37, v34, v35
 buffer_store_dwordx2 v[36:37], v9, s[24:27], s46 offen offset:0
 s_waitcnt vmcnt(7)
 v_lshlrev_b32 v32, 16, v22
 v_and_b32 v33, 0xffff0000, v22
 v_lshlrev_b32 v34, 16, v23
 v_and_b32 v35, 0xffff0000, v23
 v_add_f32 v32, v32, v84
 v_add_f32 v33, v33, v85
 v_add_f32 v34, v34, v86
 v_add_f32 v35, v35, v87
 v_cvt_pk_bf16_f32 v36, v32, v33
 v_cvt_pk_bf16_f32 v37, v34, v35
 buffer_store_dwordx2 v[36:37], v9, s[24:27], s46 offen offset:16
 s_waitcnt vmcnt(7)
 v_lshlrev_b32 v32, 16, v24
 v_and_b32 v33, 0xffff0000, v24
 v_lshlrev_b32 v34, 16, v25
 v_and_b32 v35, 0xffff0000, v25
 v_add_f32 v32, v32, v88
 v_add_f32 v33, v33, v89
 v_add_f32 v34, v34, v90
 v_add_f32 v35, v35, v91
 v_cvt_pk_bf16_f32 v36, v32, v33
 v_cvt_pk_bf16_f32 v37, v34, v35
 buffer_store_dwordx2 v[36:37], v9, s[24:27], s46 offen offset:32
 s_waitcnt vmcnt(7)
 v_lshlrev_b32 v32, 16, v26
 v_and_b32 v33, 0xffff0000, v26
 v_lshlrev_b32 v34, 16, v27
 v_and_b32 v35, 0xffff0000, v27
 v_add_f32 v32, v32, v92
 v_add_f32 v33, v33, v93
 v_add_f32 v34, v34, v94
 v_add_f32 v35, v35, v95
 v_cvt_pk_bf16_f32 v36, v32, v33
 v_cvt_pk_bf16_f32 v37, v34, v35
 buffer_store_dwordx2 v[36:37], v9, s[24:27], s46 offen offset:48
L_outa_0_kernel_end:
 s_endpgm
.globl b1_1_kernel
.p2align 8
.type b1_1_kernel,@function
b1_1_kernel:
 s_cmp_ge_u32 s2, 256
 s_cbranch_scc1 L_b1_1_kernel_end
 s_load_dwordx2 s[4:5], s[0:1], 80
 s_and_b32 s32, s2, 31
 s_lshr_b32 s33, s2, 5
 v_lshrrev_b32 v1, 6, v0
 s_nop 0
 v_readfirstlane_b32 s34, v1
 s_waitcnt lgkmcnt(0)
 s_add_u32 s8, s4, 6291456
 s_addc_u32 s9, s5, 0
 s_mov_b32 s10, 2621440
 s_mov_b32 s11, 0x00020000
 s_add_u32 s12, s4, 2097152
 s_addc_u32 s13, s5, 0
 s_mov_b32 s14, 2457600
 s_mov_b32 s15, 0x00020000
 s_mul_i32 s35, s32, 81920
 v_add_u32 v2, 0, v0
 v_lshlrev_b32 v3, 4, v2
 buffer_load_dwordx4 v[64:67], v3, s[8:11], s35 offen
 v_add_u32 v2, 256, v0
 v_lshlrev_b32 v3, 4, v2
 buffer_load_dwordx4 v[68:71], v3, s[8:11], s35 offen
 v_add_u32 v2, 512, v0
 v_lshlrev_b32 v3, 4, v2
 buffer_load_dwordx4 v[72:75], v3, s[8:11], s35 offen
 v_add_u32 v2, 768, v0
 v_lshlrev_b32 v3, 4, v2
 buffer_load_dwordx4 v[76:79], v3, s[8:11], s35 offen
 v_add_u32 v2, 1024, v0
 v_lshlrev_b32 v3, 4, v2
 buffer_load_dwordx4 v[80:83], v3, s[8:11], s35 offen
 v_add_u32 v2, 1280, v0
 v_lshlrev_b32 v3, 4, v2
 buffer_load_dwordx4 v[84:87], v3, s[8:11], s35 offen
 v_add_u32 v2, 1536, v0
 v_lshlrev_b32 v3, 4, v2
 buffer_load_dwordx4 v[88:91], v3, s[8:11], s35 offen
 v_add_u32 v2, 1792, v0
 v_lshlrev_b32 v3, 4, v2
 buffer_load_dwordx4 v[92:95], v3, s[8:11], s35 offen
 v_add_u32 v2, 2048, v0
 v_lshlrev_b32 v3, 4, v2
 buffer_load_dwordx4 v[96:99], v3, s[8:11], s35 offen
 v_add_u32 v2, 2304, v0
 v_lshlrev_b32 v3, 4, v2
 buffer_load_dwordx4 v[100:103], v3, s[8:11], s35 offen
 v_add_u32 v2, 2560, v0
 v_lshlrev_b32 v3, 4, v2
 buffer_load_dwordx4 v[104:107], v3, s[8:11], s35 offen
 v_add_u32 v2, 2816, v0
 v_lshlrev_b32 v3, 4, v2
 buffer_load_dwordx4 v[108:111], v3, s[8:11], s35 offen
 v_add_u32 v2, 3072, v0
 v_lshlrev_b32 v3, 4, v2
 buffer_load_dwordx4 v[112:115], v3, s[8:11], s35 offen
 v_add_u32 v2, 3328, v0
 v_lshlrev_b32 v3, 4, v2
 buffer_load_dwordx4 v[116:119], v3, s[8:11], s35 offen
 v_add_u32 v2, 3584, v0
 v_lshlrev_b32 v3, 4, v2
 buffer_load_dwordx4 v[120:123], v3, s[8:11], s35 offen
 v_add_u32 v2, 3840, v0
 v_lshlrev_b32 v3, 4, v2
 buffer_load_dwordx4 v[124:127], v3, s[8:11], s35 offen
 v_add_u32 v2, 4096, v0
 v_lshlrev_b32 v3, 4, v2
 buffer_load_dwordx4 v[128:131], v3, s[8:11], s35 offen
 v_add_u32 v2, 4352, v0
 v_lshlrev_b32 v3, 4, v2
 buffer_load_dwordx4 v[132:135], v3, s[8:11], s35 offen
 v_add_u32 v2, 4608, v0
 v_lshlrev_b32 v3, 4, v2
 buffer_load_dwordx4 v[136:139], v3, s[8:11], s35 offen
 v_add_u32 v2, 4864, v0
 v_lshlrev_b32 v3, 4, v2
 buffer_load_dwordx4 v[140:143], v3, s[8:11], s35 offen
 v_add_u32 v2, 0, v0
 v_mul_u32_u24 v3, 52429, v2
 v_lshrrev_b32 v3, 22, v3
 v_add_u32 v3, v3, v2
 v_lshlrev_b32 v3, 4, v3
 s_waitcnt vmcnt(19)
 ds_write_b128 v3, v[64:67]
 v_add_u32 v2, 256, v0
 v_mul_u32_u24 v3, 52429, v2
 v_lshrrev_b32 v3, 22, v3
 v_add_u32 v3, v3, v2
 v_lshlrev_b32 v3, 4, v3
 s_waitcnt vmcnt(18)
 ds_write_b128 v3, v[68:71]
 v_add_u32 v2, 512, v0
 v_mul_u32_u24 v3, 52429, v2
 v_lshrrev_b32 v3, 22, v3
 v_add_u32 v3, v3, v2
 v_lshlrev_b32 v3, 4, v3
 s_waitcnt vmcnt(17)
 ds_write_b128 v3, v[72:75]
 v_add_u32 v2, 768, v0
 v_mul_u32_u24 v3, 52429, v2
 v_lshrrev_b32 v3, 22, v3
 v_add_u32 v3, v3, v2
 v_lshlrev_b32 v3, 4, v3
 s_waitcnt vmcnt(16)
 ds_write_b128 v3, v[76:79]
 v_add_u32 v2, 1024, v0
 v_mul_u32_u24 v3, 52429, v2
 v_lshrrev_b32 v3, 22, v3
 v_add_u32 v3, v3, v2
 v_lshlrev_b32 v3, 4, v3
 s_waitcnt vmcnt(15)
 ds_write_b128 v3, v[80:83]
 v_add_u32 v2, 1280, v0
 v_mul_u32_u24 v3, 52429, v2
 v_lshrrev_b32 v3, 22, v3
 v_add_u32 v3, v3, v2
 v_lshlrev_b32 v3, 4, v3
 s_waitcnt vmcnt(14)
 ds_write_b128 v3, v[84:87]
 v_add_u32 v2, 1536, v0
 v_mul_u32_u24 v3, 52429, v2
 v_lshrrev_b32 v3, 22, v3
 v_add_u32 v3, v3, v2
 v_lshlrev_b32 v3, 4, v3
 s_waitcnt vmcnt(13)
 ds_write_b128 v3, v[88:91]
 v_add_u32 v2, 1792, v0
 v_mul_u32_u24 v3, 52429, v2
 v_lshrrev_b32 v3, 22, v3
 v_add_u32 v3, v3, v2
 v_lshlrev_b32 v3, 4, v3
 s_waitcnt vmcnt(12)
 ds_write_b128 v3, v[92:95]
 v_add_u32 v2, 2048, v0
 v_mul_u32_u24 v3, 52429, v2
 v_lshrrev_b32 v3, 22, v3
 v_add_u32 v3, v3, v2
 v_lshlrev_b32 v3, 4, v3
 s_waitcnt vmcnt(11)
 ds_write_b128 v3, v[96:99]
 v_add_u32 v2, 2304, v0
 v_mul_u32_u24 v3, 52429, v2
 v_lshrrev_b32 v3, 22, v3
 v_add_u32 v3, v3, v2
 v_lshlrev_b32 v3, 4, v3
 s_waitcnt vmcnt(10)
 ds_write_b128 v3, v[100:103]
 v_add_u32 v2, 2560, v0
 v_mul_u32_u24 v3, 52429, v2
 v_lshrrev_b32 v3, 22, v3
 v_add_u32 v3, v3, v2
 v_lshlrev_b32 v3, 4, v3
 s_waitcnt vmcnt(9)
 ds_write_b128 v3, v[104:107]
 v_add_u32 v2, 2816, v0
 v_mul_u32_u24 v3, 52429, v2
 v_lshrrev_b32 v3, 22, v3
 v_add_u32 v3, v3, v2
 v_lshlrev_b32 v3, 4, v3
 s_waitcnt vmcnt(8)
 ds_write_b128 v3, v[108:111]
 v_add_u32 v2, 3072, v0
 v_mul_u32_u24 v3, 52429, v2
 v_lshrrev_b32 v3, 22, v3
 v_add_u32 v3, v3, v2
 v_lshlrev_b32 v3, 4, v3
 s_waitcnt vmcnt(7)
 ds_write_b128 v3, v[112:115]
 v_add_u32 v2, 3328, v0
 v_mul_u32_u24 v3, 52429, v2
 v_lshrrev_b32 v3, 22, v3
 v_add_u32 v3, v3, v2
 v_lshlrev_b32 v3, 4, v3
 s_waitcnt vmcnt(6)
 ds_write_b128 v3, v[116:119]
 v_add_u32 v2, 3584, v0
 v_mul_u32_u24 v3, 52429, v2
 v_lshrrev_b32 v3, 22, v3
 v_add_u32 v3, v3, v2
 v_lshlrev_b32 v3, 4, v3
 s_waitcnt vmcnt(5)
 ds_write_b128 v3, v[120:123]
 v_add_u32 v2, 3840, v0
 v_mul_u32_u24 v3, 52429, v2
 v_lshrrev_b32 v3, 22, v3
 v_add_u32 v3, v3, v2
 v_lshlrev_b32 v3, 4, v3
 s_waitcnt vmcnt(4)
 ds_write_b128 v3, v[124:127]
 v_add_u32 v2, 4096, v0
 v_mul_u32_u24 v3, 52429, v2
 v_lshrrev_b32 v3, 22, v3
 v_add_u32 v3, v3, v2
 v_lshlrev_b32 v3, 4, v3
 s_waitcnt vmcnt(3)
 ds_write_b128 v3, v[128:131]
 v_add_u32 v2, 4352, v0
 v_mul_u32_u24 v3, 52429, v2
 v_lshrrev_b32 v3, 22, v3
 v_add_u32 v3, v3, v2
 v_lshlrev_b32 v3, 4, v3
 s_waitcnt vmcnt(2)
 ds_write_b128 v3, v[132:135]
 v_add_u32 v2, 4608, v0
 v_mul_u32_u24 v3, 52429, v2
 v_lshrrev_b32 v3, 22, v3
 v_add_u32 v3, v3, v2
 v_lshlrev_b32 v3, 4, v3
 s_waitcnt vmcnt(1)
 ds_write_b128 v3, v[136:139]
 v_add_u32 v2, 4864, v0
 v_mul_u32_u24 v3, 52429, v2
 v_lshrrev_b32 v3, 22, v3
 v_add_u32 v3, v3, v2
 v_lshlrev_b32 v3, 4, v3
 s_waitcnt vmcnt(0)
 ds_write_b128 v3, v[140:143]
 s_waitcnt lgkmcnt(0)
 s_barrier
 s_mul_i32 s40, s33, 8
 s_mul_i32 s41, s34, 2
 s_add_u32 s40, s40, s41
 s_cmp_ge_u32 s40, 60
 s_cbranch_scc1 L_b1_1_kernel_end
 s_add_u32 s41, s40, 0
 s_mul_i32 s42, s41, 40960
 s_add_u32 s41, s40, 1
 s_mul_i32 s43, s41, 40960
 v_and_b32 v2, 63, v0
 v_lshlrev_b32 v4, 4, v2
 v_and_b32 v3, 31, v0
 v_mul_u32_u24 v5, 1296, v3
 v_bfe_u32 v6, v0, 5, 1
 v_lshlrev_b32 v6, 4, v6
 v_add_u32 v5, v5, v6
 v_add_u32 v7, 41472, v5
 v_mov_b32 v64, 0
 v_mov_b32 v65, 0
 v_mov_b32 v66, 0
 v_mov_b32 v67, 0
 v_mov_b32 v68, 0
 v_mov_b32 v69, 0
 v_mov_b32 v70, 0
 v_mov_b32 v71, 0
 v_mov_b32 v72, 0
 v_mov_b32 v73, 0
 v_mov_b32 v74, 0
 v_mov_b32 v75, 0
 v_mov_b32 v76, 0
 v_mov_b32 v77, 0
 v_mov_b32 v78, 0
 v_mov_b32 v79, 0
 v_mov_b32 v80, 0
 v_mov_b32 v81, 0
 v_mov_b32 v82, 0
 v_mov_b32 v83, 0
 v_mov_b32 v84, 0
 v_mov_b32 v85, 0
 v_mov_b32 v86, 0
 v_mov_b32 v87, 0
 v_mov_b32 v88, 0
 v_mov_b32 v89, 0
 v_mov_b32 v90, 0
 v_mov_b32 v91, 0
 v_mov_b32 v92, 0
 v_mov_b32 v93, 0
 v_mov_b32 v94, 0
 v_mov_b32 v95, 0
 v_mov_b32 v96, 0
 v_mov_b32 v97, 0
 v_mov_b32 v98, 0
 v_mov_b32 v99, 0
 v_mov_b32 v100, 0
 v_mov_b32 v101, 0
 v_mov_b32 v102, 0
 v_mov_b32 v103, 0
 v_mov_b32 v104, 0
 v_mov_b32 v105, 0
 v_mov_b32 v106, 0
 v_mov_b32 v107, 0
 v_mov_b32 v108, 0
 v_mov_b32 v109, 0
 v_mov_b32 v110, 0
 v_mov_b32 v111, 0
 v_mov_b32 v112, 0
 v_mov_b32 v113, 0
 v_mov_b32 v114, 0
 v_mov_b32 v115, 0
 v_mov_b32 v116, 0
 v_mov_b32 v117, 0
 v_mov_b32 v118, 0
 v_mov_b32 v119, 0
 v_mov_b32 v120, 0
 v_mov_b32 v121, 0
 v_mov_b32 v122, 0
 v_mov_b32 v123, 0
 v_mov_b32 v124, 0
 v_mov_b32 v125, 0
 v_mov_b32 v126, 0
 v_mov_b32 v127, 0
 v_mov_b32 v176, 0
 v_mov_b32 v177, 0
 v_mov_b32 v178, 0
 v_mov_b32 v179, 0
 v_mov_b32 v180, 0x3f803f80
 s_add_u32 s16, s4, 5771264
 s_addc_u32 s17, s5, 0
 s_mov_b32 s18, 7680
 s_mov_b32 s19, 0x00020000
 s_add_u32 s20, s4, 16777216
 s_addc_u32 s21, s5, 0
 s_mov_b32 s22, 4194304
 s_mov_b32 s23, 0x00020000
 s_add_u32 s24, s4, 20971520
 s_addc_u32 s25, s5, 0
 s_mov_b32 s26, 4194304
 s_mov_b32 s27, 0x00020000
 s_add_u32 s28, s4, 25165824
 s_addc_u32 s29, s5, 0
 s_mov_b32 s30, 4194304
 s_mov_b32 s31, 0x00020000
 s_cmp_ge_u32 s40, 40
 s_cbranch_scc1 L_b1_1_kernel_vtype
 buffer_load_dwordx4 v[128:131], v4, s[12:15], s42 offen
 buffer_load_dwordx4 v[132:135], v4, s[12:15], s43 offen
 s_add_u32 s42, s42, 1024
 s_add_u32 s43, s43, 1024
 buffer_load_dwordx4 v[136:139], v4, s[12:15], s42 offen
 buffer_load_dwordx4 v[140:143], v4, s[12:15], s43 offen
 s_add_u32 s42, s42, 1024
 s_add_u32 s43, s43, 1024
 buffer_load_dwordx4 v[144:147], v4, s[12:15], s42 offen
 buffer_load_dwordx4 v[148:151], v4, s[12:15], s43 offen
 s_add_u32 s42, s42, 1024
 s_add_u32 s43, s43, 1024
 buffer_load_dwordx4 v[152:155], v4, s[12:15], s42 offen
 buffer_load_dwordx4 v[156:159], v4, s[12:15], s43 offen
 s_add_u32 s42, s42, 1024
 s_add_u32 s43, s43, 1024
 ds_read_b128 v[160:163], v5 offset:0
 ds_read_b128 v[164:167], v7 offset:0
 ds_read_b128 v[168:171], v5 offset:32
 ds_read_b128 v[172:175], v7 offset:32
 s_waitcnt vmcnt(6) lgkmcnt(2)
 v_mfma_f32_32x32x16_bf16 v[64:79], v[128:131], v[160:163], v[64:79]
 v_mfma_f32_32x32x16_bf16 v[80:95], v[128:131], v[164:167], v[80:95]
 v_mfma_f32_32x32x16_bf16 v[96:111], v[132:135], v[160:163], v[96:111]
 v_mfma_f32_32x32x16_bf16 v[112:127], v[132:135], v[164:167], v[112:127]
 v_dot2c_f32_bf16 v176, v160, v180
 v_dot2c_f32_bf16 v178, v160, v160
 v_dot2c_f32_bf16 v176, v161, v180
 v_dot2c_f32_bf16 v178, v161, v161
 v_dot2c_f32_bf16 v176, v162, v180
 v_dot2c_f32_bf16 v178, v162, v162
 v_dot2c_f32_bf16 v176, v163, v180
 v_dot2c_f32_bf16 v178, v163, v163
 v_dot2c_f32_bf16 v177, v164, v180
 v_dot2c_f32_bf16 v179, v164, v164
 v_dot2c_f32_bf16 v177, v165, v180
 v_dot2c_f32_bf16 v179, v165, v165
 v_dot2c_f32_bf16 v177, v166, v180
 v_dot2c_f32_bf16 v179, v166, v166
 v_dot2c_f32_bf16 v177, v167, v180
 v_dot2c_f32_bf16 v179, v167, v167
 buffer_load_dwordx4 v[128:131], v4, s[12:15], s42 offen
 buffer_load_dwordx4 v[132:135], v4, s[12:15], s43 offen
 s_add_u32 s42, s42, 1024
 s_add_u32 s43, s43, 1024
 ds_read_b128 v[160:163], v5 offset:64
 ds_read_b128 v[164:167], v7 offset:64
 s_waitcnt vmcnt(6) lgkmcnt(2)
 v_mfma_f32_32x32x16_bf16 v[64:79], v[136:139], v[168:171], v[64:79]
 v_mfma_f32_32x32x16_bf16 v[80:95], v[136:139], v[172:175], v[80:95]
 v_mfma_f32_32x32x16_bf16 v[96:111], v[140:143], v[168:171], v[96:111]
 v_mfma_f32_32x32x16_bf16 v[112:127], v[140:143], v[172:175], v[112:127]
 v_dot2c_f32_bf16 v176, v168, v180
 v_dot2c_f32_bf16 v178, v168, v168
 v_dot2c_f32_bf16 v176, v169, v180
 v_dot2c_f32_bf16 v178, v169, v169
 v_dot2c_f32_bf16 v176, v170, v180
 v_dot2c_f32_bf16 v178, v170, v170
 v_dot2c_f32_bf16 v176, v171, v180
 v_dot2c_f32_bf16 v178, v171, v171
 v_dot2c_f32_bf16 v177, v172, v180
 v_dot2c_f32_bf16 v179, v172, v172
 v_dot2c_f32_bf16 v177, v173, v180
 v_dot2c_f32_bf16 v179, v173, v173
 v_dot2c_f32_bf16 v177, v174, v180
 v_dot2c_f32_bf16 v179, v174, v174
 v_dot2c_f32_bf16 v177, v175, v180
 v_dot2c_f32_bf16 v179, v175, v175
 buffer_load_dwordx4 v[136:139], v4, s[12:15], s42 offen
 buffer_load_dwordx4 v[140:143], v4, s[12:15], s43 offen
 s_add_u32 s42, s42, 1024
 s_add_u32 s43, s43, 1024
 ds_read_b128 v[168:171], v5 offset:96
 ds_read_b128 v[172:175], v7 offset:96
 s_waitcnt vmcnt(6) lgkmcnt(2)
 v_mfma_f32_32x32x16_bf16 v[64:79], v[144:147], v[160:163], v[64:79]
 v_mfma_f32_32x32x16_bf16 v[80:95], v[144:147], v[164:167], v[80:95]
 v_mfma_f32_32x32x16_bf16 v[96:111], v[148:151], v[160:163], v[96:111]
 v_mfma_f32_32x32x16_bf16 v[112:127], v[148:151], v[164:167], v[112:127]
 v_dot2c_f32_bf16 v176, v160, v180
 v_dot2c_f32_bf16 v178, v160, v160
 v_dot2c_f32_bf16 v176, v161, v180
 v_dot2c_f32_bf16 v178, v161, v161
 v_dot2c_f32_bf16 v176, v162, v180
 v_dot2c_f32_bf16 v178, v162, v162
 v_dot2c_f32_bf16 v176, v163, v180
 v_dot2c_f32_bf16 v178, v163, v163
 v_dot2c_f32_bf16 v177, v164, v180
 v_dot2c_f32_bf16 v179, v164, v164
 v_dot2c_f32_bf16 v177, v165, v180
 v_dot2c_f32_bf16 v179, v165, v165
 v_dot2c_f32_bf16 v177, v166, v180
 v_dot2c_f32_bf16 v179, v166, v166
 v_dot2c_f32_bf16 v177, v167, v180
 v_dot2c_f32_bf16 v179, v167, v167
 buffer_load_dwordx4 v[144:147], v4, s[12:15], s42 offen
 buffer_load_dwordx4 v[148:151], v4, s[12:15], s43 offen
 s_add_u32 s42, s42, 1024
 s_add_u32 s43, s43, 1024
 ds_read_b128 v[160:163], v5 offset:128
 ds_read_b128 v[164:167], v7 offset:128
 s_waitcnt vmcnt(6) lgkmcnt(2)
 v_mfma_f32_32x32x16_bf16 v[64:79], v[152:155], v[168:171], v[64:79]
 v_mfma_f32_32x32x16_bf16 v[80:95], v[152:155], v[172:175], v[80:95]
 v_mfma_f32_32x32x16_bf16 v[96:111], v[156:159], v[168:171], v[96:111]
 v_mfma_f32_32x32x16_bf16 v[112:127], v[156:159], v[172:175], v[112:127]
 v_dot2c_f32_bf16 v176, v168, v180
 v_dot2c_f32_bf16 v178, v168, v168
 v_dot2c_f32_bf16 v176, v169, v180
 v_dot2c_f32_bf16 v178, v169, v169
 v_dot2c_f32_bf16 v176, v170, v180
 v_dot2c_f32_bf16 v178, v170, v170
 v_dot2c_f32_bf16 v176, v171, v180
 v_dot2c_f32_bf16 v178, v171, v171
 v_dot2c_f32_bf16 v177, v172, v180
 v_dot2c_f32_bf16 v179, v172, v172
 v_dot2c_f32_bf16 v177, v173, v180
 v_dot2c_f32_bf16 v179, v173, v173
 v_dot2c_f32_bf16 v177, v174, v180
 v_dot2c_f32_bf16 v179, v174, v174
 v_dot2c_f32_bf16 v177, v175, v180
 v_dot2c_f32_bf16 v179, v175, v175
 buffer_load_dwordx4 v[152:155], v4, s[12:15], s42 offen
 buffer_load_dwordx4 v[156:159], v4, s[12:15], s43 offen
 s_add_u32 s42, s42, 1024
 s_add_u32 s43, s43, 1024
 ds_read_b128 v[168:171], v5 offset:160
 ds_read_b128 v[172:175], v7 offset:160
 s_waitcnt vmcnt(6) lgkmcnt(2)
 v_mfma_f32_32x32x16_bf16 v[64:79], v[128:131], v[160:163], v[64:79]
 v_mfma_f32_32x32x16_bf16 v[80:95], v[128:131], v[164:167], v[80:95]
 v_mfma_f32_32x32x16_bf16 v[96:111], v[132:135], v[160:163], v[96:111]
 v_mfma_f32_32x32x16_bf16 v[112:127], v[132:135], v[164:167], v[112:127]
 v_dot2c_f32_bf16 v176, v160, v180
 v_dot2c_f32_bf16 v178, v160, v160
 v_dot2c_f32_bf16 v176, v161, v180
 v_dot2c_f32_bf16 v178, v161, v161
 v_dot2c_f32_bf16 v176, v162, v180
 v_dot2c_f32_bf16 v178, v162, v162
 v_dot2c_f32_bf16 v176, v163, v180
 v_dot2c_f32_bf16 v178, v163, v163
 v_dot2c_f32_bf16 v177, v164, v180
 v_dot2c_f32_bf16 v179, v164, v164
 v_dot2c_f32_bf16 v177, v165, v180
 v_dot2c_f32_bf16 v179, v165, v165
 v_dot2c_f32_bf16 v177, v166, v180
 v_dot2c_f32_bf16 v179, v166, v166
 v_dot2c_f32_bf16 v177, v167, v180
 v_dot2c_f32_bf16 v179, v167, v167
 buffer_load_dwordx4 v[128:131], v4, s[12:15], s42 offen
 buffer_load_dwordx4 v[132:135], v4, s[12:15], s43 offen
 s_add_u32 s42, s42, 1024
 s_add_u32 s43, s43, 1024
 ds_read_b128 v[160:163], v5 offset:192
 ds_read_b128 v[164:167], v7 offset:192
 s_waitcnt vmcnt(6) lgkmcnt(2)
 v_mfma_f32_32x32x16_bf16 v[64:79], v[136:139], v[168:171], v[64:79]
 v_mfma_f32_32x32x16_bf16 v[80:95], v[136:139], v[172:175], v[80:95]
 v_mfma_f32_32x32x16_bf16 v[96:111], v[140:143], v[168:171], v[96:111]
 v_mfma_f32_32x32x16_bf16 v[112:127], v[140:143], v[172:175], v[112:127]
 v_dot2c_f32_bf16 v176, v168, v180
 v_dot2c_f32_bf16 v178, v168, v168
 v_dot2c_f32_bf16 v176, v169, v180
 v_dot2c_f32_bf16 v178, v169, v169
 v_dot2c_f32_bf16 v176, v170, v180
 v_dot2c_f32_bf16 v178, v170, v170
 v_dot2c_f32_bf16 v176, v171, v180
 v_dot2c_f32_bf16 v178, v171, v171
 v_dot2c_f32_bf16 v177, v172, v180
 v_dot2c_f32_bf16 v179, v172, v172
 v_dot2c_f32_bf16 v177, v173, v180
 v_dot2c_f32_bf16 v179, v173, v173
 v_dot2c_f32_bf16 v177, v174, v180
 v_dot2c_f32_bf16 v179, v174, v174
 v_dot2c_f32_bf16 v177, v175, v180
 v_dot2c_f32_bf16 v179, v175, v175
 buffer_load_dwordx4 v[136:139], v4, s[12:15], s42 offen
 buffer_load_dwordx4 v[140:143], v4, s[12:15], s43 offen
 s_add_u32 s42, s42, 1024
 s_add_u32 s43, s43, 1024
 ds_read_b128 v[168:171], v5 offset:224
 ds_read_b128 v[172:175], v7 offset:224
 s_waitcnt vmcnt(6) lgkmcnt(2)
 v_mfma_f32_32x32x16_bf16 v[64:79], v[144:147], v[160:163], v[64:79]
 v_mfma_f32_32x32x16_bf16 v[80:95], v[144:147], v[164:167], v[80:95]
 v_mfma_f32_32x32x16_bf16 v[96:111], v[148:151], v[160:163], v[96:111]
 v_mfma_f32_32x32x16_bf16 v[112:127], v[148:151], v[164:167], v[112:127]
 v_dot2c_f32_bf16 v176, v160, v180
 v_dot2c_f32_bf16 v178, v160, v160
 v_dot2c_f32_bf16 v176, v161, v180
 v_dot2c_f32_bf16 v178, v161, v161
 v_dot2c_f32_bf16 v176, v162, v180
 v_dot2c_f32_bf16 v178, v162, v162
 v_dot2c_f32_bf16 v176, v163, v180
 v_dot2c_f32_bf16 v178, v163, v163
 v_dot2c_f32_bf16 v177, v164, v180
 v_dot2c_f32_bf16 v179, v164, v164
 v_dot2c_f32_bf16 v177, v165, v180
 v_dot2c_f32_bf16 v179, v165, v165
 v_dot2c_f32_bf16 v177, v166, v180
 v_dot2c_f32_bf16 v179, v166, v166
 v_dot2c_f32_bf16 v177, v167, v180
 v_dot2c_f32_bf16 v179, v167, v167
 buffer_load_dwordx4 v[144:147], v4, s[12:15], s42 offen
 buffer_load_dwordx4 v[148:151], v4, s[12:15], s43 offen
 s_add_u32 s42, s42, 1024
 s_add_u32 s43, s43, 1024
 ds_read_b128 v[160:163], v5 offset:256
 ds_read_b128 v[164:167], v7 offset:256
 s_waitcnt vmcnt(6) lgkmcnt(2)
 v_mfma_f32_32x32x16_bf16 v[64:79], v[152:155], v[168:171], v[64:79]
 v_mfma_f32_32x32x16_bf16 v[80:95], v[152:155], v[172:175], v[80:95]
 v_mfma_f32_32x32x16_bf16 v[96:111], v[156:159], v[168:171], v[96:111]
 v_mfma_f32_32x32x16_bf16 v[112:127], v[156:159], v[172:175], v[112:127]
 v_dot2c_f32_bf16 v176, v168, v180
 v_dot2c_f32_bf16 v178, v168, v168
 v_dot2c_f32_bf16 v176, v169, v180
 v_dot2c_f32_bf16 v178, v169, v169
 v_dot2c_f32_bf16 v176, v170, v180
 v_dot2c_f32_bf16 v178, v170, v170
 v_dot2c_f32_bf16 v176, v171, v180
 v_dot2c_f32_bf16 v178, v171, v171
 v_dot2c_f32_bf16 v177, v172, v180
 v_dot2c_f32_bf16 v179, v172, v172
 v_dot2c_f32_bf16 v177, v173, v180
 v_dot2c_f32_bf16 v179, v173, v173
 v_dot2c_f32_bf16 v177, v174, v180
 v_dot2c_f32_bf16 v179, v174, v174
 v_dot2c_f32_bf16 v177, v175, v180
 v_dot2c_f32_bf16 v179, v175, v175
 buffer_load_dwordx4 v[152:155], v4, s[12:15], s42 offen
 buffer_load_dwordx4 v[156:159], v4, s[12:15], s43 offen
 s_add_u32 s42, s42, 1024
 s_add_u32 s43, s43, 1024
 ds_read_b128 v[168:171], v5 offset:288
 ds_read_b128 v[172:175], v7 offset:288
 s_waitcnt vmcnt(6) lgkmcnt(2)
 v_mfma_f32_32x32x16_bf16 v[64:79], v[128:131], v[160:163], v[64:79]
 v_mfma_f32_32x32x16_bf16 v[80:95], v[128:131], v[164:167], v[80:95]
 v_mfma_f32_32x32x16_bf16 v[96:111], v[132:135], v[160:163], v[96:111]
 v_mfma_f32_32x32x16_bf16 v[112:127], v[132:135], v[164:167], v[112:127]
 v_dot2c_f32_bf16 v176, v160, v180
 v_dot2c_f32_bf16 v178, v160, v160
 v_dot2c_f32_bf16 v176, v161, v180
 v_dot2c_f32_bf16 v178, v161, v161
 v_dot2c_f32_bf16 v176, v162, v180
 v_dot2c_f32_bf16 v178, v162, v162
 v_dot2c_f32_bf16 v176, v163, v180
 v_dot2c_f32_bf16 v178, v163, v163
 v_dot2c_f32_bf16 v177, v164, v180
 v_dot2c_f32_bf16 v179, v164, v164
 v_dot2c_f32_bf16 v177, v165, v180
 v_dot2c_f32_bf16 v179, v165, v165
 v_dot2c_f32_bf16 v177, v166, v180
 v_dot2c_f32_bf16 v179, v166, v166
 v_dot2c_f32_bf16 v177, v167, v180
 v_dot2c_f32_bf16 v179, v167, v167
 buffer_load_dwordx4 v[128:131], v4, s[12:15], s42 offen
 buffer_load_dwordx4 v[132:135], v4, s[12:15], s43 offen
 s_add_u32 s42, s42, 1024
 s_add_u32 s43, s43, 1024
 ds_read_b128 v[160:163], v5 offset:320
 ds_read_b128 v[164:167], v7 offset:320
 s_waitcnt vmcnt(6) lgkmcnt(2)
 v_mfma_f32_32x32x16_bf16 v[64:79], v[136:139], v[168:171], v[64:79]
 v_mfma_f32_32x32x16_bf16 v[80:95], v[136:139], v[172:175], v[80:95]
 v_mfma_f32_32x32x16_bf16 v[96:111], v[140:143], v[168:171], v[96:111]
 v_mfma_f32_32x32x16_bf16 v[112:127], v[140:143], v[172:175], v[112:127]
 v_dot2c_f32_bf16 v176, v168, v180
 v_dot2c_f32_bf16 v178, v168, v168
 v_dot2c_f32_bf16 v176, v169, v180
 v_dot2c_f32_bf16 v178, v169, v169
 v_dot2c_f32_bf16 v176, v170, v180
 v_dot2c_f32_bf16 v178, v170, v170
 v_dot2c_f32_bf16 v176, v171, v180
 v_dot2c_f32_bf16 v178, v171, v171
 v_dot2c_f32_bf16 v177, v172, v180
 v_dot2c_f32_bf16 v179, v172, v172
 v_dot2c_f32_bf16 v177, v173, v180
 v_dot2c_f32_bf16 v179, v173, v173
 v_dot2c_f32_bf16 v177, v174, v180
 v_dot2c_f32_bf16 v179, v174, v174
 v_dot2c_f32_bf16 v177, v175, v180
 v_dot2c_f32_bf16 v179, v175, v175
 buffer_load_dwordx4 v[136:139], v4, s[12:15], s42 offen
 buffer_load_dwordx4 v[140:143], v4, s[12:15], s43 offen
 s_add_u32 s42, s42, 1024
 s_add_u32 s43, s43, 1024
 ds_read_b128 v[168:171], v5 offset:352
 ds_read_b128 v[172:175], v7 offset:352
 s_waitcnt vmcnt(6) lgkmcnt(2)
 v_mfma_f32_32x32x16_bf16 v[64:79], v[144:147], v[160:163], v[64:79]
 v_mfma_f32_32x32x16_bf16 v[80:95], v[144:147], v[164:167], v[80:95]
 v_mfma_f32_32x32x16_bf16 v[96:111], v[148:151], v[160:163], v[96:111]
 v_mfma_f32_32x32x16_bf16 v[112:127], v[148:151], v[164:167], v[112:127]
 v_dot2c_f32_bf16 v176, v160, v180
 v_dot2c_f32_bf16 v178, v160, v160
 v_dot2c_f32_bf16 v176, v161, v180
 v_dot2c_f32_bf16 v178, v161, v161
 v_dot2c_f32_bf16 v176, v162, v180
 v_dot2c_f32_bf16 v178, v162, v162
 v_dot2c_f32_bf16 v176, v163, v180
 v_dot2c_f32_bf16 v178, v163, v163
 v_dot2c_f32_bf16 v177, v164, v180
 v_dot2c_f32_bf16 v179, v164, v164
 v_dot2c_f32_bf16 v177, v165, v180
 v_dot2c_f32_bf16 v179, v165, v165
 v_dot2c_f32_bf16 v177, v166, v180
 v_dot2c_f32_bf16 v179, v166, v166
 v_dot2c_f32_bf16 v177, v167, v180
 v_dot2c_f32_bf16 v179, v167, v167
 buffer_load_dwordx4 v[144:147], v4, s[12:15], s42 offen
 buffer_load_dwordx4 v[148:151], v4, s[12:15], s43 offen
 s_add_u32 s42, s42, 1024
 s_add_u32 s43, s43, 1024
 ds_read_b128 v[160:163], v5 offset:384
 ds_read_b128 v[164:167], v7 offset:384
 s_waitcnt vmcnt(6) lgkmcnt(2)
 v_mfma_f32_32x32x16_bf16 v[64:79], v[152:155], v[168:171], v[64:79]
 v_mfma_f32_32x32x16_bf16 v[80:95], v[152:155], v[172:175], v[80:95]
 v_mfma_f32_32x32x16_bf16 v[96:111], v[156:159], v[168:171], v[96:111]
 v_mfma_f32_32x32x16_bf16 v[112:127], v[156:159], v[172:175], v[112:127]
 v_dot2c_f32_bf16 v176, v168, v180
 v_dot2c_f32_bf16 v178, v168, v168
 v_dot2c_f32_bf16 v176, v169, v180
 v_dot2c_f32_bf16 v178, v169, v169
 v_dot2c_f32_bf16 v176, v170, v180
 v_dot2c_f32_bf16 v178, v170, v170
 v_dot2c_f32_bf16 v176, v171, v180
 v_dot2c_f32_bf16 v178, v171, v171
 v_dot2c_f32_bf16 v177, v172, v180
 v_dot2c_f32_bf16 v179, v172, v172
 v_dot2c_f32_bf16 v177, v173, v180
 v_dot2c_f32_bf16 v179, v173, v173
 v_dot2c_f32_bf16 v177, v174, v180
 v_dot2c_f32_bf16 v179, v174, v174
 v_dot2c_f32_bf16 v177, v175, v180
 v_dot2c_f32_bf16 v179, v175, v175
 buffer_load_dwordx4 v[152:155], v4, s[12:15], s42 offen
 buffer_load_dwordx4 v[156:159], v4, s[12:15], s43 offen
 s_add_u32 s42, s42, 1024
 s_add_u32 s43, s43, 1024
 ds_read_b128 v[168:171], v5 offset:416
 ds_read_b128 v[172:175], v7 offset:416
 s_waitcnt vmcnt(6) lgkmcnt(2)
 v_mfma_f32_32x32x16_bf16 v[64:79], v[128:131], v[160:163], v[64:79]
 v_mfma_f32_32x32x16_bf16 v[80:95], v[128:131], v[164:167], v[80:95]
 v_mfma_f32_32x32x16_bf16 v[96:111], v[132:135], v[160:163], v[96:111]
 v_mfma_f32_32x32x16_bf16 v[112:127], v[132:135], v[164:167], v[112:127]
 v_dot2c_f32_bf16 v176, v160, v180
 v_dot2c_f32_bf16 v178, v160, v160
 v_dot2c_f32_bf16 v176, v161, v180
 v_dot2c_f32_bf16 v178, v161, v161
 v_dot2c_f32_bf16 v176, v162, v180
 v_dot2c_f32_bf16 v178, v162, v162
 v_dot2c_f32_bf16 v176, v163, v180
 v_dot2c_f32_bf16 v178, v163, v163
 v_dot2c_f32_bf16 v177, v164, v180
 v_dot2c_f32_bf16 v179, v164, v164
 v_dot2c_f32_bf16 v177, v165, v180
 v_dot2c_f32_bf16 v179, v165, v165
 v_dot2c_f32_bf16 v177, v166, v180
 v_dot2c_f32_bf16 v179, v166, v166
 v_dot2c_f32_bf16 v177, v167, v180
 v_dot2c_f32_bf16 v179, v167, v167
 buffer_load_dwordx4 v[128:131], v4, s[12:15], s42 offen
 buffer_load_dwordx4 v[132:135], v4, s[12:15], s43 offen
 s_add_u32 s42, s42, 1024
 s_add_u32 s43, s43, 1024
 ds_read_b128 v[160:163], v5 offset:448
 ds_read_b128 v[164:167], v7 offset:448
 s_waitcnt vmcnt(6) lgkmcnt(2)
 v_mfma_f32_32x32x16_bf16 v[64:79], v[136:139], v[168:171], v[64:79]
 v_mfma_f32_32x32x16_bf16 v[80:95], v[136:139], v[172:175], v[80:95]
 v_mfma_f32_32x32x16_bf16 v[96:111], v[140:143], v[168:171], v[96:111]
 v_mfma_f32_32x32x16_bf16 v[112:127], v[140:143], v[172:175], v[112:127]
 v_dot2c_f32_bf16 v176, v168, v180
 v_dot2c_f32_bf16 v178, v168, v168
 v_dot2c_f32_bf16 v176, v169, v180
 v_dot2c_f32_bf16 v178, v169, v169
 v_dot2c_f32_bf16 v176, v170, v180
 v_dot2c_f32_bf16 v178, v170, v170
 v_dot2c_f32_bf16 v176, v171, v180
 v_dot2c_f32_bf16 v178, v171, v171
 v_dot2c_f32_bf16 v177, v172, v180
 v_dot2c_f32_bf16 v179, v172, v172
 v_dot2c_f32_bf16 v177, v173, v180
 v_dot2c_f32_bf16 v179, v173, v173
 v_dot2c_f32_bf16 v177, v174, v180
 v_dot2c_f32_bf16 v179, v174, v174
 v_dot2c_f32_bf16 v177, v175, v180
 v_dot2c_f32_bf16 v179, v175, v175
 buffer_load_dwordx4 v[136:139], v4, s[12:15], s42 offen
 buffer_load_dwordx4 v[140:143], v4, s[12:15], s43 offen
 s_add_u32 s42, s42, 1024
 s_add_u32 s43, s43, 1024
 ds_read_b128 v[168:171], v5 offset:480
 ds_read_b128 v[172:175], v7 offset:480
 s_waitcnt vmcnt(6) lgkmcnt(2)
 v_mfma_f32_32x32x16_bf16 v[64:79], v[144:147], v[160:163], v[64:79]
 v_mfma_f32_32x32x16_bf16 v[80:95], v[144:147], v[164:167], v[80:95]
 v_mfma_f32_32x32x16_bf16 v[96:111], v[148:151], v[160:163], v[96:111]
 v_mfma_f32_32x32x16_bf16 v[112:127], v[148:151], v[164:167], v[112:127]
 v_dot2c_f32_bf16 v176, v160, v180
 v_dot2c_f32_bf16 v178, v160, v160
 v_dot2c_f32_bf16 v176, v161, v180
 v_dot2c_f32_bf16 v178, v161, v161
 v_dot2c_f32_bf16 v176, v162, v180
 v_dot2c_f32_bf16 v178, v162, v162
 v_dot2c_f32_bf16 v176, v163, v180
 v_dot2c_f32_bf16 v178, v163, v163
 v_dot2c_f32_bf16 v177, v164, v180
 v_dot2c_f32_bf16 v179, v164, v164
 v_dot2c_f32_bf16 v177, v165, v180
 v_dot2c_f32_bf16 v179, v165, v165
 v_dot2c_f32_bf16 v177, v166, v180
 v_dot2c_f32_bf16 v179, v166, v166
 v_dot2c_f32_bf16 v177, v167, v180
 v_dot2c_f32_bf16 v179, v167, v167
 buffer_load_dwordx4 v[144:147], v4, s[12:15], s42 offen
 buffer_load_dwordx4 v[148:151], v4, s[12:15], s43 offen
 s_add_u32 s42, s42, 1024
 s_add_u32 s43, s43, 1024
 ds_read_b128 v[160:163], v5 offset:512
 ds_read_b128 v[164:167], v7 offset:512
 s_waitcnt vmcnt(6) lgkmcnt(2)
 v_mfma_f32_32x32x16_bf16 v[64:79], v[152:155], v[168:171], v[64:79]
 v_mfma_f32_32x32x16_bf16 v[80:95], v[152:155], v[172:175], v[80:95]
 v_mfma_f32_32x32x16_bf16 v[96:111], v[156:159], v[168:171], v[96:111]
 v_mfma_f32_32x32x16_bf16 v[112:127], v[156:159], v[172:175], v[112:127]
 v_dot2c_f32_bf16 v176, v168, v180
 v_dot2c_f32_bf16 v178, v168, v168
 v_dot2c_f32_bf16 v176, v169, v180
 v_dot2c_f32_bf16 v178, v169, v169
 v_dot2c_f32_bf16 v176, v170, v180
 v_dot2c_f32_bf16 v178, v170, v170
 v_dot2c_f32_bf16 v176, v171, v180
 v_dot2c_f32_bf16 v178, v171, v171
 v_dot2c_f32_bf16 v177, v172, v180
 v_dot2c_f32_bf16 v179, v172, v172
 v_dot2c_f32_bf16 v177, v173, v180
 v_dot2c_f32_bf16 v179, v173, v173
 v_dot2c_f32_bf16 v177, v174, v180
 v_dot2c_f32_bf16 v179, v174, v174
 v_dot2c_f32_bf16 v177, v175, v180
 v_dot2c_f32_bf16 v179, v175, v175
 buffer_load_dwordx4 v[152:155], v4, s[12:15], s42 offen
 buffer_load_dwordx4 v[156:159], v4, s[12:15], s43 offen
 s_add_u32 s42, s42, 1024
 s_add_u32 s43, s43, 1024
 ds_read_b128 v[168:171], v5 offset:544
 ds_read_b128 v[172:175], v7 offset:544
 s_waitcnt vmcnt(6) lgkmcnt(2)
 v_mfma_f32_32x32x16_bf16 v[64:79], v[128:131], v[160:163], v[64:79]
 v_mfma_f32_32x32x16_bf16 v[80:95], v[128:131], v[164:167], v[80:95]
 v_mfma_f32_32x32x16_bf16 v[96:111], v[132:135], v[160:163], v[96:111]
 v_mfma_f32_32x32x16_bf16 v[112:127], v[132:135], v[164:167], v[112:127]
 v_dot2c_f32_bf16 v176, v160, v180
 v_dot2c_f32_bf16 v178, v160, v160
 v_dot2c_f32_bf16 v176, v161, v180
 v_dot2c_f32_bf16 v178, v161, v161
 v_dot2c_f32_bf16 v176, v162, v180
 v_dot2c_f32_bf16 v178, v162, v162
 v_dot2c_f32_bf16 v176, v163, v180
 v_dot2c_f32_bf16 v178, v163, v163
 v_dot2c_f32_bf16 v177, v164, v180
 v_dot2c_f32_bf16 v179, v164, v164
 v_dot2c_f32_bf16 v177, v165, v180
 v_dot2c_f32_bf16 v179, v165, v165
 v_dot2c_f32_bf16 v177, v166, v180
 v_dot2c_f32_bf16 v179, v166, v166
 v_dot2c_f32_bf16 v177, v167, v180
 v_dot2c_f32_bf16 v179, v167, v167
 buffer_load_dwordx4 v[128:131], v4, s[12:15], s42 offen
 buffer_load_dwordx4 v[132:135], v4, s[12:15], s43 offen
 s_add_u32 s42, s42, 1024
 s_add_u32 s43, s43, 1024
 ds_read_b128 v[160:163], v5 offset:576
 ds_read_b128 v[164:167], v7 offset:576
 s_waitcnt vmcnt(6) lgkmcnt(2)
 v_mfma_f32_32x32x16_bf16 v[64:79], v[136:139], v[168:171], v[64:79]
 v_mfma_f32_32x32x16_bf16 v[80:95], v[136:139], v[172:175], v[80:95]
 v_mfma_f32_32x32x16_bf16 v[96:111], v[140:143], v[168:171], v[96:111]
 v_mfma_f32_32x32x16_bf16 v[112:127], v[140:143], v[172:175], v[112:127]
 v_dot2c_f32_bf16 v176, v168, v180
 v_dot2c_f32_bf16 v178, v168, v168
 v_dot2c_f32_bf16 v176, v169, v180
 v_dot2c_f32_bf16 v178, v169, v169
 v_dot2c_f32_bf16 v176, v170, v180
 v_dot2c_f32_bf16 v178, v170, v170
 v_dot2c_f32_bf16 v176, v171, v180
 v_dot2c_f32_bf16 v178, v171, v171
 v_dot2c_f32_bf16 v177, v172, v180
 v_dot2c_f32_bf16 v179, v172, v172
 v_dot2c_f32_bf16 v177, v173, v180
 v_dot2c_f32_bf16 v179, v173, v173
 v_dot2c_f32_bf16 v177, v174, v180
 v_dot2c_f32_bf16 v179, v174, v174
 v_dot2c_f32_bf16 v177, v175, v180
 v_dot2c_f32_bf16 v179, v175, v175
 buffer_load_dwordx4 v[136:139], v4, s[12:15], s42 offen
 buffer_load_dwordx4 v[140:143], v4, s[12:15], s43 offen
 s_add_u32 s42, s42, 1024
 s_add_u32 s43, s43, 1024
 ds_read_b128 v[168:171], v5 offset:608
 ds_read_b128 v[172:175], v7 offset:608
 s_waitcnt vmcnt(6) lgkmcnt(2)
 v_mfma_f32_32x32x16_bf16 v[64:79], v[144:147], v[160:163], v[64:79]
 v_mfma_f32_32x32x16_bf16 v[80:95], v[144:147], v[164:167], v[80:95]
 v_mfma_f32_32x32x16_bf16 v[96:111], v[148:151], v[160:163], v[96:111]
 v_mfma_f32_32x32x16_bf16 v[112:127], v[148:151], v[164:167], v[112:127]
 v_dot2c_f32_bf16 v176, v160, v180
 v_dot2c_f32_bf16 v178, v160, v160
 v_dot2c_f32_bf16 v176, v161, v180
 v_dot2c_f32_bf16 v178, v161, v161
 v_dot2c_f32_bf16 v176, v162, v180
 v_dot2c_f32_bf16 v178, v162, v162
 v_dot2c_f32_bf16 v176, v163, v180
 v_dot2c_f32_bf16 v178, v163, v163
 v_dot2c_f32_bf16 v177, v164, v180
 v_dot2c_f32_bf16 v179, v164, v164
 v_dot2c_f32_bf16 v177, v165, v180
 v_dot2c_f32_bf16 v179, v165, v165
 v_dot2c_f32_bf16 v177, v166, v180
 v_dot2c_f32_bf16 v179, v166, v166
 v_dot2c_f32_bf16 v177, v167, v180
 v_dot2c_f32_bf16 v179, v167, v167
 buffer_load_dwordx4 v[144:147], v4, s[12:15], s42 offen
 buffer_load_dwordx4 v[148:151], v4, s[12:15], s43 offen
 s_add_u32 s42, s42, 1024
 s_add_u32 s43, s43, 1024
 ds_read_b128 v[160:163], v5 offset:640
 ds_read_b128 v[164:167], v7 offset:640
 s_waitcnt vmcnt(6) lgkmcnt(2)
 v_mfma_f32_32x32x16_bf16 v[64:79], v[152:155], v[168:171], v[64:79]
 v_mfma_f32_32x32x16_bf16 v[80:95], v[152:155], v[172:175], v[80:95]
 v_mfma_f32_32x32x16_bf16 v[96:111], v[156:159], v[168:171], v[96:111]
 v_mfma_f32_32x32x16_bf16 v[112:127], v[156:159], v[172:175], v[112:127]
 v_dot2c_f32_bf16 v176, v168, v180
 v_dot2c_f32_bf16 v178, v168, v168
 v_dot2c_f32_bf16 v176, v169, v180
 v_dot2c_f32_bf16 v178, v169, v169
 v_dot2c_f32_bf16 v176, v170, v180
 v_dot2c_f32_bf16 v178, v170, v170
 v_dot2c_f32_bf16 v176, v171, v180
 v_dot2c_f32_bf16 v178, v171, v171
 v_dot2c_f32_bf16 v177, v172, v180
 v_dot2c_f32_bf16 v179, v172, v172
 v_dot2c_f32_bf16 v177, v173, v180
 v_dot2c_f32_bf16 v179, v173, v173
 v_dot2c_f32_bf16 v177, v174, v180
 v_dot2c_f32_bf16 v179, v174, v174
 v_dot2c_f32_bf16 v177, v175, v180
 v_dot2c_f32_bf16 v179, v175, v175
 buffer_load_dwordx4 v[152:155], v4, s[12:15], s42 offen
 buffer_load_dwordx4 v[156:159], v4, s[12:15], s43 offen
 s_add_u32 s42, s42, 1024
 s_add_u32 s43, s43, 1024
 ds_read_b128 v[168:171], v5 offset:672
 ds_read_b128 v[172:175], v7 offset:672
 s_waitcnt vmcnt(6) lgkmcnt(2)
 v_mfma_f32_32x32x16_bf16 v[64:79], v[128:131], v[160:163], v[64:79]
 v_mfma_f32_32x32x16_bf16 v[80:95], v[128:131], v[164:167], v[80:95]
 v_mfma_f32_32x32x16_bf16 v[96:111], v[132:135], v[160:163], v[96:111]
 v_mfma_f32_32x32x16_bf16 v[112:127], v[132:135], v[164:167], v[112:127]
 v_dot2c_f32_bf16 v176, v160, v180
 v_dot2c_f32_bf16 v178, v160, v160
 v_dot2c_f32_bf16 v176, v161, v180
 v_dot2c_f32_bf16 v178, v161, v161
 v_dot2c_f32_bf16 v176, v162, v180
 v_dot2c_f32_bf16 v178, v162, v162
 v_dot2c_f32_bf16 v176, v163, v180
 v_dot2c_f32_bf16 v178, v163, v163
 v_dot2c_f32_bf16 v177, v164, v180
 v_dot2c_f32_bf16 v179, v164, v164
 v_dot2c_f32_bf16 v177, v165, v180
 v_dot2c_f32_bf16 v179, v165, v165
 v_dot2c_f32_bf16 v177, v166, v180
 v_dot2c_f32_bf16 v179, v166, v166
 v_dot2c_f32_bf16 v177, v167, v180
 v_dot2c_f32_bf16 v179, v167, v167
 buffer_load_dwordx4 v[128:131], v4, s[12:15], s42 offen
 buffer_load_dwordx4 v[132:135], v4, s[12:15], s43 offen
 s_add_u32 s42, s42, 1024
 s_add_u32 s43, s43, 1024
 ds_read_b128 v[160:163], v5 offset:704
 ds_read_b128 v[164:167], v7 offset:704
 s_waitcnt vmcnt(6) lgkmcnt(2)
 v_mfma_f32_32x32x16_bf16 v[64:79], v[136:139], v[168:171], v[64:79]
 v_mfma_f32_32x32x16_bf16 v[80:95], v[136:139], v[172:175], v[80:95]
 v_mfma_f32_32x32x16_bf16 v[96:111], v[140:143], v[168:171], v[96:111]
 v_mfma_f32_32x32x16_bf16 v[112:127], v[140:143], v[172:175], v[112:127]
 v_dot2c_f32_bf16 v176, v168, v180
 v_dot2c_f32_bf16 v178, v168, v168
 v_dot2c_f32_bf16 v176, v169, v180
 v_dot2c_f32_bf16 v178, v169, v169
 v_dot2c_f32_bf16 v176, v170, v180
 v_dot2c_f32_bf16 v178, v170, v170
 v_dot2c_f32_bf16 v176, v171, v180
 v_dot2c_f32_bf16 v178, v171, v171
 v_dot2c_f32_bf16 v177, v172, v180
 v_dot2c_f32_bf16 v179, v172, v172
 v_dot2c_f32_bf16 v177, v173, v180
 v_dot2c_f32_bf16 v179, v173, v173
 v_dot2c_f32_bf16 v177, v174, v180
 v_dot2c_f32_bf16 v179, v174, v174
 v_dot2c_f32_bf16 v177, v175, v180
 v_dot2c_f32_bf16 v179, v175, v175
 buffer_load_dwordx4 v[136:139], v4, s[12:15], s42 offen
 buffer_load_dwordx4 v[140:143], v4, s[12:15], s43 offen
 s_add_u32 s42, s42, 1024
 s_add_u32 s43, s43, 1024
 ds_read_b128 v[168:171], v5 offset:736
 ds_read_b128 v[172:175], v7 offset:736
 s_waitcnt vmcnt(6) lgkmcnt(2)
 v_mfma_f32_32x32x16_bf16 v[64:79], v[144:147], v[160:163], v[64:79]
 v_mfma_f32_32x32x16_bf16 v[80:95], v[144:147], v[164:167], v[80:95]
 v_mfma_f32_32x32x16_bf16 v[96:111], v[148:151], v[160:163], v[96:111]
 v_mfma_f32_32x32x16_bf16 v[112:127], v[148:151], v[164:167], v[112:127]
 v_dot2c_f32_bf16 v176, v160, v180
 v_dot2c_f32_bf16 v178, v160, v160
 v_dot2c_f32_bf16 v176, v161, v180
 v_dot2c_f32_bf16 v178, v161, v161
 v_dot2c_f32_bf16 v176, v162, v180
 v_dot2c_f32_bf16 v178, v162, v162
 v_dot2c_f32_bf16 v176, v163, v180
 v_dot2c_f32_bf16 v178, v163, v163
 v_dot2c_f32_bf16 v177, v164, v180
 v_dot2c_f32_bf16 v179, v164, v164
 v_dot2c_f32_bf16 v177, v165, v180
 v_dot2c_f32_bf16 v179, v165, v165
 v_dot2c_f32_bf16 v177, v166, v180
 v_dot2c_f32_bf16 v179, v166, v166
 v_dot2c_f32_bf16 v177, v167, v180
 v_dot2c_f32_bf16 v179, v167, v167
 buffer_load_dwordx4 v[144:147], v4, s[12:15], s42 offen
 buffer_load_dwordx4 v[148:151], v4, s[12:15], s43 offen
 s_add_u32 s42, s42, 1024
 s_add_u32 s43, s43, 1024
 ds_read_b128 v[160:163], v5 offset:768
 ds_read_b128 v[164:167], v7 offset:768
 s_waitcnt vmcnt(6) lgkmcnt(2)
 v_mfma_f32_32x32x16_bf16 v[64:79], v[152:155], v[168:171], v[64:79]
 v_mfma_f32_32x32x16_bf16 v[80:95], v[152:155], v[172:175], v[80:95]
 v_mfma_f32_32x32x16_bf16 v[96:111], v[156:159], v[168:171], v[96:111]
 v_mfma_f32_32x32x16_bf16 v[112:127], v[156:159], v[172:175], v[112:127]
 v_dot2c_f32_bf16 v176, v168, v180
 v_dot2c_f32_bf16 v178, v168, v168
 v_dot2c_f32_bf16 v176, v169, v180
 v_dot2c_f32_bf16 v178, v169, v169
 v_dot2c_f32_bf16 v176, v170, v180
 v_dot2c_f32_bf16 v178, v170, v170
 v_dot2c_f32_bf16 v176, v171, v180
 v_dot2c_f32_bf16 v178, v171, v171
 v_dot2c_f32_bf16 v177, v172, v180
 v_dot2c_f32_bf16 v179, v172, v172
 v_dot2c_f32_bf16 v177, v173, v180
 v_dot2c_f32_bf16 v179, v173, v173
 v_dot2c_f32_bf16 v177, v174, v180
 v_dot2c_f32_bf16 v179, v174, v174
 v_dot2c_f32_bf16 v177, v175, v180
 v_dot2c_f32_bf16 v179, v175, v175
 buffer_load_dwordx4 v[152:155], v4, s[12:15], s42 offen
 buffer_load_dwordx4 v[156:159], v4, s[12:15], s43 offen
 s_add_u32 s42, s42, 1024
 s_add_u32 s43, s43, 1024
 ds_read_b128 v[168:171], v5 offset:800
 ds_read_b128 v[172:175], v7 offset:800
 s_waitcnt vmcnt(6) lgkmcnt(2)
 v_mfma_f32_32x32x16_bf16 v[64:79], v[128:131], v[160:163], v[64:79]
 v_mfma_f32_32x32x16_bf16 v[80:95], v[128:131], v[164:167], v[80:95]
 v_mfma_f32_32x32x16_bf16 v[96:111], v[132:135], v[160:163], v[96:111]
 v_mfma_f32_32x32x16_bf16 v[112:127], v[132:135], v[164:167], v[112:127]
 v_dot2c_f32_bf16 v176, v160, v180
 v_dot2c_f32_bf16 v178, v160, v160
 v_dot2c_f32_bf16 v176, v161, v180
 v_dot2c_f32_bf16 v178, v161, v161
 v_dot2c_f32_bf16 v176, v162, v180
 v_dot2c_f32_bf16 v178, v162, v162
 v_dot2c_f32_bf16 v176, v163, v180
 v_dot2c_f32_bf16 v178, v163, v163
 v_dot2c_f32_bf16 v177, v164, v180
 v_dot2c_f32_bf16 v179, v164, v164
 v_dot2c_f32_bf16 v177, v165, v180
 v_dot2c_f32_bf16 v179, v165, v165
 v_dot2c_f32_bf16 v177, v166, v180
 v_dot2c_f32_bf16 v179, v166, v166
 v_dot2c_f32_bf16 v177, v167, v180
 v_dot2c_f32_bf16 v179, v167, v167
 buffer_load_dwordx4 v[128:131], v4, s[12:15], s42 offen
 buffer_load_dwordx4 v[132:135], v4, s[12:15], s43 offen
 s_add_u32 s42, s42, 1024
 s_add_u32 s43, s43, 1024
 ds_read_b128 v[160:163], v5 offset:832
 ds_read_b128 v[164:167], v7 offset:832
 s_waitcnt vmcnt(6) lgkmcnt(2)
 v_mfma_f32_32x32x16_bf16 v[64:79], v[136:139], v[168:171], v[64:79]
 v_mfma_f32_32x32x16_bf16 v[80:95], v[136:139], v[172:175], v[80:95]
 v_mfma_f32_32x32x16_bf16 v[96:111], v[140:143], v[168:171], v[96:111]
 v_mfma_f32_32x32x16_bf16 v[112:127], v[140:143], v[172:175], v[112:127]
 v_dot2c_f32_bf16 v176, v168, v180
 v_dot2c_f32_bf16 v178, v168, v168
 v_dot2c_f32_bf16 v176, v169, v180
 v_dot2c_f32_bf16 v178, v169, v169
 v_dot2c_f32_bf16 v176, v170, v180
 v_dot2c_f32_bf16 v178, v170, v170
 v_dot2c_f32_bf16 v176, v171, v180
 v_dot2c_f32_bf16 v178, v171, v171
 v_dot2c_f32_bf16 v177, v172, v180
 v_dot2c_f32_bf16 v179, v172, v172
 v_dot2c_f32_bf16 v177, v173, v180
 v_dot2c_f32_bf16 v179, v173, v173
 v_dot2c_f32_bf16 v177, v174, v180
 v_dot2c_f32_bf16 v179, v174, v174
 v_dot2c_f32_bf16 v177, v175, v180
 v_dot2c_f32_bf16 v179, v175, v175
 buffer_load_dwordx4 v[136:139], v4, s[12:15], s42 offen
 buffer_load_dwordx4 v[140:143], v4, s[12:15], s43 offen
 s_add_u32 s42, s42, 1024
 s_add_u32 s43, s43, 1024
 ds_read_b128 v[168:171], v5 offset:864
 ds_read_b128 v[172:175], v7 offset:864
 s_waitcnt vmcnt(6) lgkmcnt(2)
 v_mfma_f32_32x32x16_bf16 v[64:79], v[144:147], v[160:163], v[64:79]
 v_mfma_f32_32x32x16_bf16 v[80:95], v[144:147], v[164:167], v[80:95]
 v_mfma_f32_32x32x16_bf16 v[96:111], v[148:151], v[160:163], v[96:111]
 v_mfma_f32_32x32x16_bf16 v[112:127], v[148:151], v[164:167], v[112:127]
 v_dot2c_f32_bf16 v176, v160, v180
 v_dot2c_f32_bf16 v178, v160, v160
 v_dot2c_f32_bf16 v176, v161, v180
 v_dot2c_f32_bf16 v178, v161, v161
 v_dot2c_f32_bf16 v176, v162, v180
 v_dot2c_f32_bf16 v178, v162, v162
 v_dot2c_f32_bf16 v176, v163, v180
 v_dot2c_f32_bf16 v178, v163, v163
 v_dot2c_f32_bf16 v177, v164, v180
 v_dot2c_f32_bf16 v179, v164, v164
 v_dot2c_f32_bf16 v177, v165, v180
 v_dot2c_f32_bf16 v179, v165, v165
 v_dot2c_f32_bf16 v177, v166, v180
 v_dot2c_f32_bf16 v179, v166, v166
 v_dot2c_f32_bf16 v177, v167, v180
 v_dot2c_f32_bf16 v179, v167, v167
 buffer_load_dwordx4 v[144:147], v4, s[12:15], s42 offen
 buffer_load_dwordx4 v[148:151], v4, s[12:15], s43 offen
 s_add_u32 s42, s42, 1024
 s_add_u32 s43, s43, 1024
 ds_read_b128 v[160:163], v5 offset:896
 ds_read_b128 v[164:167], v7 offset:896
 s_waitcnt vmcnt(6) lgkmcnt(2)
 v_mfma_f32_32x32x16_bf16 v[64:79], v[152:155], v[168:171], v[64:79]
 v_mfma_f32_32x32x16_bf16 v[80:95], v[152:155], v[172:175], v[80:95]
 v_mfma_f32_32x32x16_bf16 v[96:111], v[156:159], v[168:171], v[96:111]
 v_mfma_f32_32x32x16_bf16 v[112:127], v[156:159], v[172:175], v[112:127]
 v_dot2c_f32_bf16 v176, v168, v180
 v_dot2c_f32_bf16 v178, v168, v168
 v_dot2c_f32_bf16 v176, v169, v180
 v_dot2c_f32_bf16 v178, v169, v169
 v_dot2c_f32_bf16 v176, v170, v180
 v_dot2c_f32_bf16 v178, v170, v170
 v_dot2c_f32_bf16 v176, v171, v180
 v_dot2c_f32_bf16 v178, v171, v171
 v_dot2c_f32_bf16 v177, v172, v180
 v_dot2c_f32_bf16 v179, v172, v172
 v_dot2c_f32_bf16 v177, v173, v180
 v_dot2c_f32_bf16 v179, v173, v173
 v_dot2c_f32_bf16 v177, v174, v180
 v_dot2c_f32_bf16 v179, v174, v174
 v_dot2c_f32_bf16 v177, v175, v180
 v_dot2c_f32_bf16 v179, v175, v175
 buffer_load_dwordx4 v[152:155], v4, s[12:15], s42 offen
 buffer_load_dwordx4 v[156:159], v4, s[12:15], s43 offen
 s_add_u32 s42, s42, 1024
 s_add_u32 s43, s43, 1024
 ds_read_b128 v[168:171], v5 offset:928
 ds_read_b128 v[172:175], v7 offset:928
 s_waitcnt vmcnt(6) lgkmcnt(2)
 v_mfma_f32_32x32x16_bf16 v[64:79], v[128:131], v[160:163], v[64:79]
 v_mfma_f32_32x32x16_bf16 v[80:95], v[128:131], v[164:167], v[80:95]
 v_mfma_f32_32x32x16_bf16 v[96:111], v[132:135], v[160:163], v[96:111]
 v_mfma_f32_32x32x16_bf16 v[112:127], v[132:135], v[164:167], v[112:127]
 v_dot2c_f32_bf16 v176, v160, v180
 v_dot2c_f32_bf16 v178, v160, v160
 v_dot2c_f32_bf16 v176, v161, v180
 v_dot2c_f32_bf16 v178, v161, v161
 v_dot2c_f32_bf16 v176, v162, v180
 v_dot2c_f32_bf16 v178, v162, v162
 v_dot2c_f32_bf16 v176, v163, v180
 v_dot2c_f32_bf16 v178, v163, v163
 v_dot2c_f32_bf16 v177, v164, v180
 v_dot2c_f32_bf16 v179, v164, v164
 v_dot2c_f32_bf16 v177, v165, v180
 v_dot2c_f32_bf16 v179, v165, v165
 v_dot2c_f32_bf16 v177, v166, v180
 v_dot2c_f32_bf16 v179, v166, v166
 v_dot2c_f32_bf16 v177, v167, v180
 v_dot2c_f32_bf16 v179, v167, v167
 buffer_load_dwordx4 v[128:131], v4, s[12:15], s42 offen
 buffer_load_dwordx4 v[132:135], v4, s[12:15], s43 offen
 s_add_u32 s42, s42, 1024
 s_add_u32 s43, s43, 1024
 ds_read_b128 v[160:163], v5 offset:960
 ds_read_b128 v[164:167], v7 offset:960
 s_waitcnt vmcnt(6) lgkmcnt(2)
 v_mfma_f32_32x32x16_bf16 v[64:79], v[136:139], v[168:171], v[64:79]
 v_mfma_f32_32x32x16_bf16 v[80:95], v[136:139], v[172:175], v[80:95]
 v_mfma_f32_32x32x16_bf16 v[96:111], v[140:143], v[168:171], v[96:111]
 v_mfma_f32_32x32x16_bf16 v[112:127], v[140:143], v[172:175], v[112:127]
 v_dot2c_f32_bf16 v176, v168, v180
 v_dot2c_f32_bf16 v178, v168, v168
 v_dot2c_f32_bf16 v176, v169, v180
 v_dot2c_f32_bf16 v178, v169, v169
 v_dot2c_f32_bf16 v176, v170, v180
 v_dot2c_f32_bf16 v178, v170, v170
 v_dot2c_f32_bf16 v176, v171, v180
 v_dot2c_f32_bf16 v178, v171, v171
 v_dot2c_f32_bf16 v177, v172, v180
 v_dot2c_f32_bf16 v179, v172, v172
 v_dot2c_f32_bf16 v177, v173, v180
 v_dot2c_f32_bf16 v179, v173, v173
 v_dot2c_f32_bf16 v177, v174, v180
 v_dot2c_f32_bf16 v179, v174, v174
 v_dot2c_f32_bf16 v177, v175, v180
 v_dot2c_f32_bf16 v179, v175, v175
 buffer_load_dwordx4 v[136:139], v4, s[12:15], s42 offen
 buffer_load_dwordx4 v[140:143], v4, s[12:15], s43 offen
 s_add_u32 s42, s42, 1024
 s_add_u32 s43, s43, 1024
 ds_read_b128 v[168:171], v5 offset:992
 ds_read_b128 v[172:175], v7 offset:992
 s_waitcnt vmcnt(6) lgkmcnt(2)
 v_mfma_f32_32x32x16_bf16 v[64:79], v[144:147], v[160:163], v[64:79]
 v_mfma_f32_32x32x16_bf16 v[80:95], v[144:147], v[164:167], v[80:95]
 v_mfma_f32_32x32x16_bf16 v[96:111], v[148:151], v[160:163], v[96:111]
 v_mfma_f32_32x32x16_bf16 v[112:127], v[148:151], v[164:167], v[112:127]
 v_dot2c_f32_bf16 v176, v160, v180
 v_dot2c_f32_bf16 v178, v160, v160
 v_dot2c_f32_bf16 v176, v161, v180
 v_dot2c_f32_bf16 v178, v161, v161
 v_dot2c_f32_bf16 v176, v162, v180
 v_dot2c_f32_bf16 v178, v162, v162
 v_dot2c_f32_bf16 v176, v163, v180
 v_dot2c_f32_bf16 v178, v163, v163
 v_dot2c_f32_bf16 v177, v164, v180
 v_dot2c_f32_bf16 v179, v164, v164
 v_dot2c_f32_bf16 v177, v165, v180
 v_dot2c_f32_bf16 v179, v165, v165
 v_dot2c_f32_bf16 v177, v166, v180
 v_dot2c_f32_bf16 v179, v166, v166
 v_dot2c_f32_bf16 v177, v167, v180
 v_dot2c_f32_bf16 v179, v167, v167
 buffer_load_dwordx4 v[144:147], v4, s[12:15], s42 offen
 buffer_load_dwordx4 v[148:151], v4, s[12:15], s43 offen
 s_add_u32 s42, s42, 1024
 s_add_u32 s43, s43, 1024
 ds_read_b128 v[160:163], v5 offset:1024
 ds_read_b128 v[164:167], v7 offset:1024
 s_waitcnt vmcnt(6) lgkmcnt(2)
 v_mfma_f32_32x32x16_bf16 v[64:79], v[152:155], v[168:171], v[64:79]
 v_mfma_f32_32x32x16_bf16 v[80:95], v[152:155], v[172:175], v[80:95]
 v_mfma_f32_32x32x16_bf16 v[96:111], v[156:159], v[168:171], v[96:111]
 v_mfma_f32_32x32x16_bf16 v[112:127], v[156:159], v[172:175], v[112:127]
 v_dot2c_f32_bf16 v176, v168, v180
 v_dot2c_f32_bf16 v178, v168, v168
 v_dot2c_f32_bf16 v176, v169, v180
 v_dot2c_f32_bf16 v178, v169, v169
 v_dot2c_f32_bf16 v176, v170, v180
 v_dot2c_f32_bf16 v178, v170, v170
 v_dot2c_f32_bf16 v176, v171, v180
 v_dot2c_f32_bf16 v178, v171, v171
 v_dot2c_f32_bf16 v177, v172, v180
 v_dot2c_f32_bf16 v179, v172, v172
 v_dot2c_f32_bf16 v177, v173, v180
 v_dot2c_f32_bf16 v179, v173, v173
 v_dot2c_f32_bf16 v177, v174, v180
 v_dot2c_f32_bf16 v179, v174, v174
 v_dot2c_f32_bf16 v177, v175, v180
 v_dot2c_f32_bf16 v179, v175, v175
 buffer_load_dwordx4 v[152:155], v4, s[12:15], s42 offen
 buffer_load_dwordx4 v[156:159], v4, s[12:15], s43 offen
 s_add_u32 s42, s42, 1024
 s_add_u32 s43, s43, 1024
 ds_read_b128 v[168:171], v5 offset:1056
 ds_read_b128 v[172:175], v7 offset:1056
 s_waitcnt vmcnt(6) lgkmcnt(2)
 v_mfma_f32_32x32x16_bf16 v[64:79], v[128:131], v[160:163], v[64:79]
 v_mfma_f32_32x32x16_bf16 v[80:95], v[128:131], v[164:167], v[80:95]
 v_mfma_f32_32x32x16_bf16 v[96:111], v[132:135], v[160:163], v[96:111]
 v_mfma_f32_32x32x16_bf16 v[112:127], v[132:135], v[164:167], v[112:127]
 v_dot2c_f32_bf16 v176, v160, v180
 v_dot2c_f32_bf16 v178, v160, v160
 v_dot2c_f32_bf16 v176, v161, v180
 v_dot2c_f32_bf16 v178, v161, v161
 v_dot2c_f32_bf16 v176, v162, v180
 v_dot2c_f32_bf16 v178, v162, v162
 v_dot2c_f32_bf16 v176, v163, v180
 v_dot2c_f32_bf16 v178, v163, v163
 v_dot2c_f32_bf16 v177, v164, v180
 v_dot2c_f32_bf16 v179, v164, v164
 v_dot2c_f32_bf16 v177, v165, v180
 v_dot2c_f32_bf16 v179, v165, v165
 v_dot2c_f32_bf16 v177, v166, v180
 v_dot2c_f32_bf16 v179, v166, v166
 v_dot2c_f32_bf16 v177, v167, v180
 v_dot2c_f32_bf16 v179, v167, v167
 buffer_load_dwordx4 v[128:131], v4, s[12:15], s42 offen
 buffer_load_dwordx4 v[132:135], v4, s[12:15], s43 offen
 s_add_u32 s42, s42, 1024
 s_add_u32 s43, s43, 1024
 ds_read_b128 v[160:163], v5 offset:1088
 ds_read_b128 v[164:167], v7 offset:1088
 s_waitcnt vmcnt(6) lgkmcnt(2)
 v_mfma_f32_32x32x16_bf16 v[64:79], v[136:139], v[168:171], v[64:79]
 v_mfma_f32_32x32x16_bf16 v[80:95], v[136:139], v[172:175], v[80:95]
 v_mfma_f32_32x32x16_bf16 v[96:111], v[140:143], v[168:171], v[96:111]
 v_mfma_f32_32x32x16_bf16 v[112:127], v[140:143], v[172:175], v[112:127]
 v_dot2c_f32_bf16 v176, v168, v180
 v_dot2c_f32_bf16 v178, v168, v168
 v_dot2c_f32_bf16 v176, v169, v180
 v_dot2c_f32_bf16 v178, v169, v169
 v_dot2c_f32_bf16 v176, v170, v180
 v_dot2c_f32_bf16 v178, v170, v170
 v_dot2c_f32_bf16 v176, v171, v180
 v_dot2c_f32_bf16 v178, v171, v171
 v_dot2c_f32_bf16 v177, v172, v180
 v_dot2c_f32_bf16 v179, v172, v172
 v_dot2c_f32_bf16 v177, v173, v180
 v_dot2c_f32_bf16 v179, v173, v173
 v_dot2c_f32_bf16 v177, v174, v180
 v_dot2c_f32_bf16 v179, v174, v174
 v_dot2c_f32_bf16 v177, v175, v180
 v_dot2c_f32_bf16 v179, v175, v175
 buffer_load_dwordx4 v[136:139], v4, s[12:15], s42 offen
 buffer_load_dwordx4 v[140:143], v4, s[12:15], s43 offen
 s_add_u32 s42, s42, 1024
 s_add_u32 s43, s43, 1024
 ds_read_b128 v[168:171], v5 offset:1120
 ds_read_b128 v[172:175], v7 offset:1120
 s_waitcnt vmcnt(6) lgkmcnt(2)
 v_mfma_f32_32x32x16_bf16 v[64:79], v[144:147], v[160:163], v[64:79]
 v_mfma_f32_32x32x16_bf16 v[80:95], v[144:147], v[164:167], v[80:95]
 v_mfma_f32_32x32x16_bf16 v[96:111], v[148:151], v[160:163], v[96:111]
 v_mfma_f32_32x32x16_bf16 v[112:127], v[148:151], v[164:167], v[112:127]
 v_dot2c_f32_bf16 v176, v160, v180
 v_dot2c_f32_bf16 v178, v160, v160
 v_dot2c_f32_bf16 v176, v161, v180
 v_dot2c_f32_bf16 v178, v161, v161
 v_dot2c_f32_bf16 v176, v162, v180
 v_dot2c_f32_bf16 v178, v162, v162
 v_dot2c_f32_bf16 v176, v163, v180
 v_dot2c_f32_bf16 v178, v163, v163
 v_dot2c_f32_bf16 v177, v164, v180
 v_dot2c_f32_bf16 v179, v164, v164
 v_dot2c_f32_bf16 v177, v165, v180
 v_dot2c_f32_bf16 v179, v165, v165
 v_dot2c_f32_bf16 v177, v166, v180
 v_dot2c_f32_bf16 v179, v166, v166
 v_dot2c_f32_bf16 v177, v167, v180
 v_dot2c_f32_bf16 v179, v167, v167
 buffer_load_dwordx4 v[144:147], v4, s[12:15], s42 offen
 buffer_load_dwordx4 v[148:151], v4, s[12:15], s43 offen
 s_add_u32 s42, s42, 1024
 s_add_u32 s43, s43, 1024
 ds_read_b128 v[160:163], v5 offset:1152
 ds_read_b128 v[164:167], v7 offset:1152
 s_waitcnt vmcnt(6) lgkmcnt(2)
 v_mfma_f32_32x32x16_bf16 v[64:79], v[152:155], v[168:171], v[64:79]
 v_mfma_f32_32x32x16_bf16 v[80:95], v[152:155], v[172:175], v[80:95]
 v_mfma_f32_32x32x16_bf16 v[96:111], v[156:159], v[168:171], v[96:111]
 v_mfma_f32_32x32x16_bf16 v[112:127], v[156:159], v[172:175], v[112:127]
 v_dot2c_f32_bf16 v176, v168, v180
 v_dot2c_f32_bf16 v178, v168, v168
 v_dot2c_f32_bf16 v176, v169, v180
 v_dot2c_f32_bf16 v178, v169, v169
 v_dot2c_f32_bf16 v176, v170, v180
 v_dot2c_f32_bf16 v178, v170, v170
 v_dot2c_f32_bf16 v176, v171, v180
 v_dot2c_f32_bf16 v178, v171, v171
 v_dot2c_f32_bf16 v177, v172, v180
 v_dot2c_f32_bf16 v179, v172, v172
 v_dot2c_f32_bf16 v177, v173, v180
 v_dot2c_f32_bf16 v179, v173, v173
 v_dot2c_f32_bf16 v177, v174, v180
 v_dot2c_f32_bf16 v179, v174, v174
 v_dot2c_f32_bf16 v177, v175, v180
 v_dot2c_f32_bf16 v179, v175, v175
 buffer_load_dwordx4 v[152:155], v4, s[12:15], s42 offen
 buffer_load_dwordx4 v[156:159], v4, s[12:15], s43 offen
 s_add_u32 s42, s42, 1024
 s_add_u32 s43, s43, 1024
 ds_read_b128 v[168:171], v5 offset:1184
 ds_read_b128 v[172:175], v7 offset:1184
 s_waitcnt vmcnt(6) lgkmcnt(2)
 v_mfma_f32_32x32x16_bf16 v[64:79], v[128:131], v[160:163], v[64:79]
 v_mfma_f32_32x32x16_bf16 v[80:95], v[128:131], v[164:167], v[80:95]
 v_mfma_f32_32x32x16_bf16 v[96:111], v[132:135], v[160:163], v[96:111]
 v_mfma_f32_32x32x16_bf16 v[112:127], v[132:135], v[164:167], v[112:127]
 v_dot2c_f32_bf16 v176, v160, v180
 v_dot2c_f32_bf16 v178, v160, v160
 v_dot2c_f32_bf16 v176, v161, v180
 v_dot2c_f32_bf16 v178, v161, v161
 v_dot2c_f32_bf16 v176, v162, v180
 v_dot2c_f32_bf16 v178, v162, v162
 v_dot2c_f32_bf16 v176, v163, v180
 v_dot2c_f32_bf16 v178, v163, v163
 v_dot2c_f32_bf16 v177, v164, v180
 v_dot2c_f32_bf16 v179, v164, v164
 v_dot2c_f32_bf16 v177, v165, v180
 v_dot2c_f32_bf16 v179, v165, v165
 v_dot2c_f32_bf16 v177, v166, v180
 v_dot2c_f32_bf16 v179, v166, v166
 v_dot2c_f32_bf16 v177, v167, v180
 v_dot2c_f32_bf16 v179, v167, v167
 ds_read_b128 v[160:163], v5 offset:1216
 ds_read_b128 v[164:167], v7 offset:1216
 s_waitcnt vmcnt(4) lgkmcnt(2)
 v_mfma_f32_32x32x16_bf16 v[64:79], v[136:139], v[168:171], v[64:79]
 v_mfma_f32_32x32x16_bf16 v[80:95], v[136:139], v[172:175], v[80:95]
 v_mfma_f32_32x32x16_bf16 v[96:111], v[140:143], v[168:171], v[96:111]
 v_mfma_f32_32x32x16_bf16 v[112:127], v[140:143], v[172:175], v[112:127]
 v_dot2c_f32_bf16 v176, v168, v180
 v_dot2c_f32_bf16 v178, v168, v168
 v_dot2c_f32_bf16 v176, v169, v180
 v_dot2c_f32_bf16 v178, v169, v169
 v_dot2c_f32_bf16 v176, v170, v180
 v_dot2c_f32_bf16 v178, v170, v170
 v_dot2c_f32_bf16 v176, v171, v180
 v_dot2c_f32_bf16 v178, v171, v171
 v_dot2c_f32_bf16 v177, v172, v180
 v_dot2c_f32_bf16 v179, v172, v172
 v_dot2c_f32_bf16 v177, v173, v180
 v_dot2c_f32_bf16 v179, v173, v173
 v_dot2c_f32_bf16 v177, v174, v180
 v_dot2c_f32_bf16 v179, v174, v174
 v_dot2c_f32_bf16 v177, v175, v180
 v_dot2c_f32_bf16 v179, v175, v175
 ds_read_b128 v[168:171], v5 offset:1248
 ds_read_b128 v[172:175], v7 offset:1248
 s_waitcnt vmcnt(2) lgkmcnt(2)
 v_mfma_f32_32x32x16_bf16 v[64:79], v[144:147], v[160:163], v[64:79]
 v_mfma_f32_32x32x16_bf16 v[80:95], v[144:147], v[164:167], v[80:95]
 v_mfma_f32_32x32x16_bf16 v[96:111], v[148:151], v[160:163], v[96:111]
 v_mfma_f32_32x32x16_bf16 v[112:127], v[148:151], v[164:167], v[112:127]
 v_dot2c_f32_bf16 v176, v160, v180
 v_dot2c_f32_bf16 v178, v160, v160
 v_dot2c_f32_bf16 v176, v161, v180
 v_dot2c_f32_bf16 v178, v161, v161
 v_dot2c_f32_bf16 v176, v162, v180
 v_dot2c_f32_bf16 v178, v162, v162
 v_dot2c_f32_bf16 v176, v163, v180
 v_dot2c_f32_bf16 v178, v163, v163
 v_dot2c_f32_bf16 v177, v164, v180
 v_dot2c_f32_bf16 v179, v164, v164
 v_dot2c_f32_bf16 v177, v165, v180
 v_dot2c_f32_bf16 v179, v165, v165
 v_dot2c_f32_bf16 v177, v166, v180
 v_dot2c_f32_bf16 v179, v166, v166
 v_dot2c_f32_bf16 v177, v167, v180
 v_dot2c_f32_bf16 v179, v167, v167
 s_waitcnt vmcnt(0) lgkmcnt(0)
 v_mfma_f32_32x32x16_bf16 v[64:79], v[152:155], v[168:171], v[64:79]
 v_mfma_f32_32x32x16_bf16 v[80:95], v[152:155], v[172:175], v[80:95]
 v_mfma_f32_32x32x16_bf16 v[96:111], v[156:159], v[168:171], v[96:111]
 v_mfma_f32_32x32x16_bf16 v[112:127], v[156:159], v[172:175], v[112:127]
 v_dot2c_f32_bf16 v176, v168, v180
 v_dot2c_f32_bf16 v178, v168, v168
 v_dot2c_f32_bf16 v176, v169, v180
 v_dot2c_f32_bf16 v178, v169, v169
 v_dot2c_f32_bf16 v176, v170, v180
 v_dot2c_f32_bf16 v178, v170, v170
 v_dot2c_f32_bf16 v176, v171, v180
 v_dot2c_f32_bf16 v178, v171, v171
 v_dot2c_f32_bf16 v177, v172, v180
 v_dot2c_f32_bf16 v179, v172, v172
 v_dot2c_f32_bf16 v177, v173, v180
 v_dot2c_f32_bf16 v179, v173, v173
 v_dot2c_f32_bf16 v177, v174, v180
 v_dot2c_f32_bf16 v179, v174, v174
 v_dot2c_f32_bf16 v177, v175, v180
 v_dot2c_f32_bf16 v179, v175, v175
 s_nop 11
 v_mov_b32 v186, v176
 s_nop 1
 v_permlane32_swap_b32 v176, v186
 v_add_f32 v176, v176, v186
 v_mov_b32 v186, v177
 s_nop 1
 v_permlane32_swap_b32 v177, v186
 v_add_f32 v177, v177, v186
 v_mov_b32 v186, v178
 s_nop 1
 v_permlane32_swap_b32 v178, v186
 v_add_f32 v178, v178, v186
 v_mov_b32 v186, v179
 s_nop 1
 v_permlane32_swap_b32 v179, v186
 v_add_f32 v179, v179, v186
 s_mov_b32 s44, 0x3acccccd
 s_mov_b32 s45, 0x3727c5ac
 v_mul_f32 v186, s44, v176
 v_mul_f32 v187, s44, v178
 v_fma_f32 v187, -v186, v186, v187
 v_add_f32 v187, s45, v187
 v_rsq_f32 v181, v187
 s_nop 0
 v_mul_f32 v183, v181, v186
 v_mul_f32 v186, s44, v177
 v_mul_f32 v187, s44, v179
 v_fma_f32 v187, -v186, v186, v187
 v_add_f32 v187, s45, v187
 v_rsq_f32 v182, v187
 s_nop 0
 v_mul_f32 v184, v182, v186
 s_cmp_ge_u32 s40, 20
 s_cbranch_scc1 L_b1_1_kernel_ktype
 s_add_u32 s49, s40, 0
 v_bfe_u32 v8, v0, 5, 1
 v_lshlrev_b32 v8, 2, v8
 v_and_b32 v9, 31, v0
 s_lshl_b32 s46, s49, 5
 v_add_u32 v8, s46, v8
 s_mov_b32 s47, 0x3ea52b5c
 v_add_u32 v10, 0, v8
 v_lshlrev_b32 v11, 2, v10
 buffer_load_dwordx4 v[12:15], v11, s[16:19], 0 offen
 v_add_u32 v10, 8, v8
 v_lshlrev_b32 v11, 2, v10
 buffer_load_dwordx4 v[16:19], v11, s[16:19], 0 offen
 v_add_u32 v10, 16, v8
 v_lshlrev_b32 v11, 2, v10
 buffer_load_dwordx4 v[20:23], v11, s[16:19], 0 offen
 v_add_u32 v10, 24, v8
 v_lshlrev_b32 v11, 2, v10
 buffer_load_dwordx4 v[24:27], v11, s[16:19], 0 offen
 v_mul_f32 v28, s47, v181
 v_mul_f32 v29, s47, v183
 s_lshl_b32 s48, s32, 1
 s_add_u32 s48, s48, 0
 s_lshl_b32 s48, s48, 11
 s_waitcnt vmcnt(3)
 v_add_u32 v10, 0, v8
 v_mul_u32_u24 v11, 3277, v10
 v_lshrrev_b32 v11, 16, v11
 v_mul_u32_u24 v30, 20, v11
 v_sub_u32 v30, v10, v30
 v_lshrrev_b32 v30, 2, v30
 v_lshlrev_b32 v11, 17, v11
 v_lshlrev_b32 v31, 4, v9
 v_add3_u32 v11, v11, v31, s48
 v_lshrrev_b32 v31, 2, v30
 v_lshl_add_u32 v11, v31, 10, v11
 v_bfe_u32 v31, v30, 1, 1
 v_lshl_add_u32 v11, v31, 9, v11
 v_and_b32 v31, 1, v30
 v_lshl_add_u32 v11, v31, 3, v11
 v_mul_f32 v32, v29, v12
 v_fma_f32 v32, v28, v64, -v32
 v_mul_f32 v33, v29, v13
 v_fma_f32 v33, v28, v65, -v33
 v_mul_f32 v34, v29, v14
 v_fma_f32 v34, v28, v66, -v34
 v_mul_f32 v35, v29, v15
 v_fma_f32 v35, v28, v67, -v35
 v_cvt_pk_bf16_f32 v36, v32, v33
 v_cvt_pk_bf16_f32 v37, v34, v35
 buffer_store_dwordx2 v[36:37], v11, s[20:23], 0 offen
 s_waitcnt vmcnt(3)
 v_add_u32 v10, 8, v8
 v_mul_u32_u24 v11, 3277, v10
 v_lshrrev_b32 v11, 16, v11
 v_mul_u32_u24 v30, 20, v11
 v_sub_u32 v30, v10, v30
 v_lshrrev_b32 v30, 2, v30
 v_lshlrev_b32 v11, 17, v11
 v_lshlrev_b32 v31, 4, v9
 v_add3_u32 v11, v11, v31, s48
 v_lshrrev_b32 v31, 2, v30
 v_lshl_add_u32 v11, v31, 10, v11
 v_bfe_u32 v31, v30, 1, 1
 v_lshl_add_u32 v11, v31, 9, v11
 v_and_b32 v31, 1, v30
 v_lshl_add_u32 v11, v31, 3, v11
 v_mul_f32 v32, v29, v16
 v_fma_f32 v32, v28, v68, -v32
 v_mul_f32 v33, v29, v17
 v_fma_f32 v33, v28, v69, -v33
 v_mul_f32 v34, v29, v18
 v_fma_f32 v34, v28, v70, -v34
 v_mul_f32 v35, v29, v19
 v_fma_f32 v35, v28, v71, -v35
 v_cvt_pk_bf16_f32 v36, v32, v33
 v_cvt_pk_bf16_f32 v37, v34, v35
 buffer_store_dwordx2 v[36:37], v11, s[20:23], 0 offen
 s_waitcnt vmcnt(3)
 v_add_u32 v10, 16, v8
 v_mul_u32_u24 v11, 3277, v10
 v_lshrrev_b32 v11, 16, v11
 v_mul_u32_u24 v30, 20, v11
 v_sub_u32 v30, v10, v30
 v_lshrrev_b32 v30, 2, v30
 v_lshlrev_b32 v11, 17, v11
 v_lshlrev_b32 v31, 4, v9
 v_add3_u32 v11, v11, v31, s48
 v_lshrrev_b32 v31, 2, v30
 v_lshl_add_u32 v11, v31, 10, v11
 v_bfe_u32 v31, v30, 1, 1
 v_lshl_add_u32 v11, v31, 9, v11
 v_and_b32 v31, 1, v30
 v_lshl_add_u32 v11, v31, 3, v11
 v_mul_f32 v32, v29, v20
 v_fma_f32 v32, v28, v72, -v32
 v_mul_f32 v33, v29, v21
 v_fma_f32 v33, v28, v73, -v33
 v_mul_f32 v34, v29, v22
 v_fma_f32 v34, v28, v74, -v34
 v_mul_f32 v35, v29, v23
 v_fma_f32 v35, v28, v75, -v35
 v_cvt_pk_bf16_f32 v36, v32, v33
 v_cvt_pk_bf16_f32 v37, v34, v35
 buffer_store_dwordx2 v[36:37], v11, s[20:23], 0 offen
 s_waitcnt vmcnt(3)
 v_add_u32 v10, 24, v8
 v_mul_u32_u24 v11, 3277, v10
 v_lshrrev_b32 v11, 16, v11
 v_mul_u32_u24 v30, 20, v11
 v_sub_u32 v30, v10, v30
 v_lshrrev_b32 v30, 2, v30
 v_lshlrev_b32 v11, 17, v11
 v_lshlrev_b32 v31, 4, v9
 v_add3_u32 v11, v11, v31, s48
 v_lshrrev_b32 v31, 2, v30
 v_lshl_add_u32 v11, v31, 10, v11
 v_bfe_u32 v31, v30, 1, 1
 v_lshl_add_u32 v11, v31, 9, v11
 v_and_b32 v31, 1, v30
 v_lshl_add_u32 v11, v31, 3, v11
 v_mul_f32 v32, v29, v24
 v_fma_f32 v32, v28, v76, -v32
 v_mul_f32 v33, v29, v25
 v_fma_f32 v33, v28, v77, -v33
 v_mul_f32 v34, v29, v26
 v_fma_f32 v34, v28, v78, -v34
 v_mul_f32 v35, v29, v27
 v_fma_f32 v35, v28, v79, -v35
 v_cvt_pk_bf16_f32 v36, v32, v33
 v_cvt_pk_bf16_f32 v37, v34, v35
 buffer_store_dwordx2 v[36:37], v11, s[20:23], 0 offen
 v_mul_f32 v28, s47, v182
 v_mul_f32 v29, s47, v184
 s_lshl_b32 s48, s32, 1
 s_add_u32 s48, s48, 1
 s_lshl_b32 s48, s48, 11
 v_add_u32 v10, 0, v8
 v_mul_u32_u24 v11, 3277, v10
 v_lshrrev_b32 v11, 16, v11
 v_mul_u32_u24 v30, 20, v11
 v_sub_u32 v30, v10, v30
 v_lshrrev_b32 v30, 2, v30
 v_lshlrev_b32 v11, 17, v11
 v_lshlrev_b32 v31, 4, v9
 v_add3_u32 v11, v11, v31, s48
 v_lshrrev_b32 v31, 2, v30
 v_lshl_add_u32 v11, v31, 10, v11
 v_bfe_u32 v31, v30, 1, 1
 v_lshl_add_u32 v11, v31, 9, v11
 v_and_b32 v31, 1, v30
 v_lshl_add_u32 v11, v31, 3, v11
 v_mul_f32 v32, v29, v12
 v_fma_f32 v32, v28, v80, -v32
 v_mul_f32 v33, v29, v13
 v_fma_f32 v33, v28, v81, -v33
 v_mul_f32 v34, v29, v14
 v_fma_f32 v34, v28, v82, -v34
 v_mul_f32 v35, v29, v15
 v_fma_f32 v35, v28, v83, -v35
 v_cvt_pk_bf16_f32 v36, v32, v33
 v_cvt_pk_bf16_f32 v37, v34, v35
 buffer_store_dwordx2 v[36:37], v11, s[20:23], 0 offen
 v_add_u32 v10, 8, v8
 v_mul_u32_u24 v11, 3277, v10
 v_lshrrev_b32 v11, 16, v11
 v_mul_u32_u24 v30, 20, v11
 v_sub_u32 v30, v10, v30
 v_lshrrev_b32 v30, 2, v30
 v_lshlrev_b32 v11, 17, v11
 v_lshlrev_b32 v31, 4, v9
 v_add3_u32 v11, v11, v31, s48
 v_lshrrev_b32 v31, 2, v30
 v_lshl_add_u32 v11, v31, 10, v11
 v_bfe_u32 v31, v30, 1, 1
 v_lshl_add_u32 v11, v31, 9, v11
 v_and_b32 v31, 1, v30
 v_lshl_add_u32 v11, v31, 3, v11
 v_mul_f32 v32, v29, v16
 v_fma_f32 v32, v28, v84, -v32
 v_mul_f32 v33, v29, v17
 v_fma_f32 v33, v28, v85, -v33
 v_mul_f32 v34, v29, v18
 v_fma_f32 v34, v28, v86, -v34
 v_mul_f32 v35, v29, v19
 v_fma_f32 v35, v28, v87, -v35
 v_cvt_pk_bf16_f32 v36, v32, v33
 v_cvt_pk_bf16_f32 v37, v34, v35
 buffer_store_dwordx2 v[36:37], v11, s[20:23], 0 offen
 v_add_u32 v10, 16, v8
 v_mul_u32_u24 v11, 3277, v10
 v_lshrrev_b32 v11, 16, v11
 v_mul_u32_u24 v30, 20, v11
 v_sub_u32 v30, v10, v30
 v_lshrrev_b32 v30, 2, v30
 v_lshlrev_b32 v11, 17, v11
 v_lshlrev_b32 v31, 4, v9
 v_add3_u32 v11, v11, v31, s48
 v_lshrrev_b32 v31, 2, v30
 v_lshl_add_u32 v11, v31, 10, v11
 v_bfe_u32 v31, v30, 1, 1
 v_lshl_add_u32 v11, v31, 9, v11
 v_and_b32 v31, 1, v30
 v_lshl_add_u32 v11, v31, 3, v11
 v_mul_f32 v32, v29, v20
 v_fma_f32 v32, v28, v88, -v32
 v_mul_f32 v33, v29, v21
 v_fma_f32 v33, v28, v89, -v33
 v_mul_f32 v34, v29, v22
 v_fma_f32 v34, v28, v90, -v34
 v_mul_f32 v35, v29, v23
 v_fma_f32 v35, v28, v91, -v35
 v_cvt_pk_bf16_f32 v36, v32, v33
 v_cvt_pk_bf16_f32 v37, v34, v35
 buffer_store_dwordx2 v[36:37], v11, s[20:23], 0 offen
 v_add_u32 v10, 24, v8
 v_mul_u32_u24 v11, 3277, v10
 v_lshrrev_b32 v11, 16, v11
 v_mul_u32_u24 v30, 20, v11
 v_sub_u32 v30, v10, v30
 v_lshrrev_b32 v30, 2, v30
 v_lshlrev_b32 v11, 17, v11
 v_lshlrev_b32 v31, 4, v9
 v_add3_u32 v11, v11, v31, s48
 v_lshrrev_b32 v31, 2, v30
 v_lshl_add_u32 v11, v31, 10, v11
 v_bfe_u32 v31, v30, 1, 1
 v_lshl_add_u32 v11, v31, 9, v11
 v_and_b32 v31, 1, v30
 v_lshl_add_u32 v11, v31, 3, v11
 v_mul_f32 v32, v29, v24
 v_fma_f32 v32, v28, v92, -v32
 v_mul_f32 v33, v29, v25
 v_fma_f32 v33, v28, v93, -v33
 v_mul_f32 v34, v29, v26
 v_fma_f32 v34, v28, v94, -v34
 v_mul_f32 v35, v29, v27
 v_fma_f32 v35, v28, v95, -v35
 v_cvt_pk_bf16_f32 v36, v32, v33
 v_cvt_pk_bf16_f32 v37, v34, v35
 buffer_store_dwordx2 v[36:37], v11, s[20:23], 0 offen
 s_add_u32 s49, s40, 1
 v_bfe_u32 v8, v0, 5, 1
 v_lshlrev_b32 v8, 2, v8
 v_and_b32 v9, 31, v0
 s_lshl_b32 s46, s49, 5
 v_add_u32 v8, s46, v8
 s_mov_b32 s47, 0x3ea52b5c
 v_add_u32 v10, 0, v8
 v_lshlrev_b32 v11, 2, v10
 buffer_load_dwordx4 v[12:15], v11, s[16:19], 0 offen
 v_add_u32 v10, 8, v8
 v_lshlrev_b32 v11, 2, v10
 buffer_load_dwordx4 v[16:19], v11, s[16:19], 0 offen
 v_add_u32 v10, 16, v8
 v_lshlrev_b32 v11, 2, v10
 buffer_load_dwordx4 v[20:23], v11, s[16:19], 0 offen
 v_add_u32 v10, 24, v8
 v_lshlrev_b32 v11, 2, v10
 buffer_load_dwordx4 v[24:27], v11, s[16:19], 0 offen
 v_mul_f32 v28, s47, v181
 v_mul_f32 v29, s47, v183
 s_lshl_b32 s48, s32, 1
 s_add_u32 s48, s48, 0
 s_lshl_b32 s48, s48, 11
 s_waitcnt vmcnt(3)
 v_add_u32 v10, 0, v8
 v_mul_u32_u24 v11, 3277, v10
 v_lshrrev_b32 v11, 16, v11
 v_mul_u32_u24 v30, 20, v11
 v_sub_u32 v30, v10, v30
 v_lshrrev_b32 v30, 2, v30
 v_lshlrev_b32 v11, 17, v11
 v_lshlrev_b32 v31, 4, v9
 v_add3_u32 v11, v11, v31, s48
 v_lshrrev_b32 v31, 2, v30
 v_lshl_add_u32 v11, v31, 10, v11
 v_bfe_u32 v31, v30, 1, 1
 v_lshl_add_u32 v11, v31, 9, v11
 v_and_b32 v31, 1, v30
 v_lshl_add_u32 v11, v31, 3, v11
 v_mul_f32 v32, v29, v12
 v_fma_f32 v32, v28, v96, -v32
 v_mul_f32 v33, v29, v13
 v_fma_f32 v33, v28, v97, -v33
 v_mul_f32 v34, v29, v14
 v_fma_f32 v34, v28, v98, -v34
 v_mul_f32 v35, v29, v15
 v_fma_f32 v35, v28, v99, -v35
 v_cvt_pk_bf16_f32 v36, v32, v33
 v_cvt_pk_bf16_f32 v37, v34, v35
 buffer_store_dwordx2 v[36:37], v11, s[20:23], 0 offen
 s_waitcnt vmcnt(3)
 v_add_u32 v10, 8, v8
 v_mul_u32_u24 v11, 3277, v10
 v_lshrrev_b32 v11, 16, v11
 v_mul_u32_u24 v30, 20, v11
 v_sub_u32 v30, v10, v30
 v_lshrrev_b32 v30, 2, v30
 v_lshlrev_b32 v11, 17, v11
 v_lshlrev_b32 v31, 4, v9
 v_add3_u32 v11, v11, v31, s48
 v_lshrrev_b32 v31, 2, v30
 v_lshl_add_u32 v11, v31, 10, v11
 v_bfe_u32 v31, v30, 1, 1
 v_lshl_add_u32 v11, v31, 9, v11
 v_and_b32 v31, 1, v30
 v_lshl_add_u32 v11, v31, 3, v11
 v_mul_f32 v32, v29, v16
 v_fma_f32 v32, v28, v100, -v32
 v_mul_f32 v33, v29, v17
 v_fma_f32 v33, v28, v101, -v33
 v_mul_f32 v34, v29, v18
 v_fma_f32 v34, v28, v102, -v34
 v_mul_f32 v35, v29, v19
 v_fma_f32 v35, v28, v103, -v35
 v_cvt_pk_bf16_f32 v36, v32, v33
 v_cvt_pk_bf16_f32 v37, v34, v35
 buffer_store_dwordx2 v[36:37], v11, s[20:23], 0 offen
 s_waitcnt vmcnt(3)
 v_add_u32 v10, 16, v8
 v_mul_u32_u24 v11, 3277, v10
 v_lshrrev_b32 v11, 16, v11
 v_mul_u32_u24 v30, 20, v11
 v_sub_u32 v30, v10, v30
 v_lshrrev_b32 v30, 2, v30
 v_lshlrev_b32 v11, 17, v11
 v_lshlrev_b32 v31, 4, v9
 v_add3_u32 v11, v11, v31, s48
 v_lshrrev_b32 v31, 2, v30
 v_lshl_add_u32 v11, v31, 10, v11
 v_bfe_u32 v31, v30, 1, 1
 v_lshl_add_u32 v11, v31, 9, v11
 v_and_b32 v31, 1, v30
 v_lshl_add_u32 v11, v31, 3, v11
 v_mul_f32 v32, v29, v20
 v_fma_f32 v32, v28, v104, -v32
 v_mul_f32 v33, v29, v21
 v_fma_f32 v33, v28, v105, -v33
 v_mul_f32 v34, v29, v22
 v_fma_f32 v34, v28, v106, -v34
 v_mul_f32 v35, v29, v23
 v_fma_f32 v35, v28, v107, -v35
 v_cvt_pk_bf16_f32 v36, v32, v33
 v_cvt_pk_bf16_f32 v37, v34, v35
 buffer_store_dwordx2 v[36:37], v11, s[20:23], 0 offen
 s_waitcnt vmcnt(3)
 v_add_u32 v10, 24, v8
 v_mul_u32_u24 v11, 3277, v10
 v_lshrrev_b32 v11, 16, v11
 v_mul_u32_u24 v30, 20, v11
 v_sub_u32 v30, v10, v30
 v_lshrrev_b32 v30, 2, v30
 v_lshlrev_b32 v11, 17, v11
 v_lshlrev_b32 v31, 4, v9
 v_add3_u32 v11, v11, v31, s48
 v_lshrrev_b32 v31, 2, v30
 v_lshl_add_u32 v11, v31, 10, v11
 v_bfe_u32 v31, v30, 1, 1
 v_lshl_add_u32 v11, v31, 9, v11
 v_and_b32 v31, 1, v30
 v_lshl_add_u32 v11, v31, 3, v11
 v_mul_f32 v32, v29, v24
 v_fma_f32 v32, v28, v108, -v32
 v_mul_f32 v33, v29, v25
 v_fma_f32 v33, v28, v109, -v33
 v_mul_f32 v34, v29, v26
 v_fma_f32 v34, v28, v110, -v34
 v_mul_f32 v35, v29, v27
 v_fma_f32 v35, v28, v111, -v35
 v_cvt_pk_bf16_f32 v36, v32, v33
 v_cvt_pk_bf16_f32 v37, v34, v35
 buffer_store_dwordx2 v[36:37], v11, s[20:23], 0 offen
 v_mul_f32 v28, s47, v182
 v_mul_f32 v29, s47, v184
 s_lshl_b32 s48, s32, 1
 s_add_u32 s48, s48, 1
 s_lshl_b32 s48, s48, 11
 v_add_u32 v10, 0, v8
 v_mul_u32_u24 v11, 3277, v10
 v_lshrrev_b32 v11, 16, v11
 v_mul_u32_u24 v30, 20, v11
 v_sub_u32 v30, v10, v30
 v_lshrrev_b32 v30, 2, v30
 v_lshlrev_b32 v11, 17, v11
 v_lshlrev_b32 v31, 4, v9
 v_add3_u32 v11, v11, v31, s48
 v_lshrrev_b32 v31, 2, v30
 v_lshl_add_u32 v11, v31, 10, v11
 v_bfe_u32 v31, v30, 1, 1
 v_lshl_add_u32 v11, v31, 9, v11
 v_and_b32 v31, 1, v30
 v_lshl_add_u32 v11, v31, 3, v11
 v_mul_f32 v32, v29, v12
 v_fma_f32 v32, v28, v112, -v32
 v_mul_f32 v33, v29, v13
 v_fma_f32 v33, v28, v113, -v33
 v_mul_f32 v34, v29, v14
 v_fma_f32 v34, v28, v114, -v34
 v_mul_f32 v35, v29, v15
 v_fma_f32 v35, v28, v115, -v35
 v_cvt_pk_bf16_f32 v36, v32, v33
 v_cvt_pk_bf16_f32 v37, v34, v35
 buffer_store_dwordx2 v[36:37], v11, s[20:23], 0 offen
 v_add_u32 v10, 8, v8
 v_mul_u32_u24 v11, 3277, v10
 v_lshrrev_b32 v11, 16, v11
 v_mul_u32_u24 v30, 20, v11
 v_sub_u32 v30, v10, v30
 v_lshrrev_b32 v30, 2, v30
 v_lshlrev_b32 v11, 17, v11
 v_lshlrev_b32 v31, 4, v9
 v_add3_u32 v11, v11, v31, s48
 v_lshrrev_b32 v31, 2, v30
 v_lshl_add_u32 v11, v31, 10, v11
 v_bfe_u32 v31, v30, 1, 1
 v_lshl_add_u32 v11, v31, 9, v11
 v_and_b32 v31, 1, v30
 v_lshl_add_u32 v11, v31, 3, v11
 v_mul_f32 v32, v29, v16
 v_fma_f32 v32, v28, v116, -v32
 v_mul_f32 v33, v29, v17
 v_fma_f32 v33, v28, v117, -v33
 v_mul_f32 v34, v29, v18
 v_fma_f32 v34, v28, v118, -v34
 v_mul_f32 v35, v29, v19
 v_fma_f32 v35, v28, v119, -v35
 v_cvt_pk_bf16_f32 v36, v32, v33
 v_cvt_pk_bf16_f32 v37, v34, v35
 buffer_store_dwordx2 v[36:37], v11, s[20:23], 0 offen
 v_add_u32 v10, 16, v8
 v_mul_u32_u24 v11, 3277, v10
 v_lshrrev_b32 v11, 16, v11
 v_mul_u32_u24 v30, 20, v11
 v_sub_u32 v30, v10, v30
 v_lshrrev_b32 v30, 2, v30
 v_lshlrev_b32 v11, 17, v11
 v_lshlrev_b32 v31, 4, v9
 v_add3_u32 v11, v11, v31, s48
 v_lshrrev_b32 v31, 2, v30
 v_lshl_add_u32 v11, v31, 10, v11
 v_bfe_u32 v31, v30, 1, 1
 v_lshl_add_u32 v11, v31, 9, v11
 v_and_b32 v31, 1, v30
 v_lshl_add_u32 v11, v31, 3, v11
 v_mul_f32 v32, v29, v20
 v_fma_f32 v32, v28, v120, -v32
 v_mul_f32 v33, v29, v21
 v_fma_f32 v33, v28, v121, -v33
 v_mul_f32 v34, v29, v22
 v_fma_f32 v34, v28, v122, -v34
 v_mul_f32 v35, v29, v23
 v_fma_f32 v35, v28, v123, -v35
 v_cvt_pk_bf16_f32 v36, v32, v33
 v_cvt_pk_bf16_f32 v37, v34, v35
 buffer_store_dwordx2 v[36:37], v11, s[20:23], 0 offen
 v_add_u32 v10, 24, v8
 v_mul_u32_u24 v11, 3277, v10
 v_lshrrev_b32 v11, 16, v11
 v_mul_u32_u24 v30, 20, v11
 v_sub_u32 v30, v10, v30
 v_lshrrev_b32 v30, 2, v30
 v_lshlrev_b32 v11, 17, v11
 v_lshlrev_b32 v31, 4, v9
 v_add3_u32 v11, v11, v31, s48
 v_lshrrev_b32 v31, 2, v30
 v_lshl_add_u32 v11, v31, 10, v11
 v_bfe_u32 v31, v30, 1, 1
 v_lshl_add_u32 v11, v31, 9, v11
 v_and_b32 v31, 1, v30
 v_lshl_add_u32 v11, v31, 3, v11
 v_mul_f32 v32, v29, v24
 v_fma_f32 v32, v28, v124, -v32
 v_mul_f32 v33, v29, v25
 v_fma_f32 v33, v28, v125, -v33
 v_mul_f32 v34, v29, v26
 v_fma_f32 v34, v28, v126, -v34
 v_mul_f32 v35, v29, v27
 v_fma_f32 v35, v28, v127, -v35
 v_cvt_pk_bf16_f32 v36, v32, v33
 v_cvt_pk_bf16_f32 v37, v34, v35
 buffer_store_dwordx2 v[36:37], v11, s[20:23], 0 offen
 s_branch L_b1_1_kernel_end
L_b1_1_kernel_ktype:
 s_add_u32 s49, s40, -20
 s_lshl_b32 s52, s49, 5
 v_bfe_u32 v8, v0, 5, 1
 v_lshlrev_b32 v8, 2, v8
 v_and_b32 v9, 31, v0
 v_add_u32 v8, s52, v8
 s_mov_b32 s47, 0x3f800000
 v_add_u32 v10, 640, v8
 v_lshlrev_b32 v11, 2, v10
 buffer_load_dwordx4 v[12:15], v11, s[16:19], 0 offen
 v_add_u32 v10, 648, v8
 v_lshlrev_b32 v11, 2, v10
 buffer_load_dwordx4 v[16:19], v11, s[16:19], 0 offen
 v_add_u32 v10, 656, v8
 v_lshlrev_b32 v11, 2, v10
 buffer_load_dwordx4 v[20:23], v11, s[16:19], 0 offen
 v_add_u32 v10, 664, v8
 v_lshlrev_b32 v11, 2, v10
 buffer_load_dwordx4 v[24:27], v11, s[16:19], 0 offen
 v_mul_f32 v28, s47, v181
 v_mul_f32 v29, s47, v183
 s_lshl_b32 s48, s32, 1
 s_add_u32 s48, s48, 0
 s_lshl_b32 s48, s48, 11
 s_waitcnt vmcnt(3)
 v_add_u32 v10, 0, v8
 v_mul_u32_u24 v11, 3277, v10
 v_lshrrev_b32 v11, 16, v11
 v_mul_u32_u24 v30, 20, v11
 v_sub_u32 v30, v10, v30
 v_lshrrev_b32 v30, 2, v30
 v_lshlrev_b32 v11, 17, v11
 v_lshlrev_b32 v31, 4, v9
 v_add3_u32 v11, v11, v31, s48
 v_lshrrev_b32 v31, 2, v30
 v_lshl_add_u32 v11, v31, 10, v11
 v_bfe_u32 v31, v30, 1, 1
 v_lshl_add_u32 v11, v31, 9, v11
 v_and_b32 v31, 1, v30
 v_lshl_add_u32 v11, v31, 3, v11
 v_mul_f32 v32, v29, v12
 v_fma_f32 v32, v28, v64, -v32
 v_mul_f32 v33, v29, v13
 v_fma_f32 v33, v28, v65, -v33
 v_mul_f32 v34, v29, v14
 v_fma_f32 v34, v28, v66, -v34
 v_mul_f32 v35, v29, v15
 v_fma_f32 v35, v28, v67, -v35
 v_cvt_pk_bf16_f32 v36, v32, v33
 v_cvt_pk_bf16_f32 v37, v34, v35
 buffer_store_dwordx2 v[36:37], v11, s[24:27], 0 offen
 s_waitcnt vmcnt(3)
 v_add_u32 v10, 8, v8
 v_mul_u32_u24 v11, 3277, v10
 v_lshrrev_b32 v11, 16, v11
 v_mul_u32_u24 v30, 20, v11
 v_sub_u32 v30, v10, v30
 v_lshrrev_b32 v30, 2, v30
 v_lshlrev_b32 v11, 17, v11
 v_lshlrev_b32 v31, 4, v9
 v_add3_u32 v11, v11, v31, s48
 v_lshrrev_b32 v31, 2, v30
 v_lshl_add_u32 v11, v31, 10, v11
 v_bfe_u32 v31, v30, 1, 1
 v_lshl_add_u32 v11, v31, 9, v11
 v_and_b32 v31, 1, v30
 v_lshl_add_u32 v11, v31, 3, v11
 v_mul_f32 v32, v29, v16
 v_fma_f32 v32, v28, v68, -v32
 v_mul_f32 v33, v29, v17
 v_fma_f32 v33, v28, v69, -v33
 v_mul_f32 v34, v29, v18
 v_fma_f32 v34, v28, v70, -v34
 v_mul_f32 v35, v29, v19
 v_fma_f32 v35, v28, v71, -v35
 v_cvt_pk_bf16_f32 v36, v32, v33
 v_cvt_pk_bf16_f32 v37, v34, v35
 buffer_store_dwordx2 v[36:37], v11, s[24:27], 0 offen
 s_waitcnt vmcnt(3)
 v_add_u32 v10, 16, v8
 v_mul_u32_u24 v11, 3277, v10
 v_lshrrev_b32 v11, 16, v11
 v_mul_u32_u24 v30, 20, v11
 v_sub_u32 v30, v10, v30
 v_lshrrev_b32 v30, 2, v30
 v_lshlrev_b32 v11, 17, v11
 v_lshlrev_b32 v31, 4, v9
 v_add3_u32 v11, v11, v31, s48
 v_lshrrev_b32 v31, 2, v30
 v_lshl_add_u32 v11, v31, 10, v11
 v_bfe_u32 v31, v30, 1, 1
 v_lshl_add_u32 v11, v31, 9, v11
 v_and_b32 v31, 1, v30
 v_lshl_add_u32 v11, v31, 3, v11
 v_mul_f32 v32, v29, v20
 v_fma_f32 v32, v28, v72, -v32
 v_mul_f32 v33, v29, v21
 v_fma_f32 v33, v28, v73, -v33
 v_mul_f32 v34, v29, v22
 v_fma_f32 v34, v28, v74, -v34
 v_mul_f32 v35, v29, v23
 v_fma_f32 v35, v28, v75, -v35
 v_cvt_pk_bf16_f32 v36, v32, v33
 v_cvt_pk_bf16_f32 v37, v34, v35
 buffer_store_dwordx2 v[36:37], v11, s[24:27], 0 offen
 s_waitcnt vmcnt(3)
 v_add_u32 v10, 24, v8
 v_mul_u32_u24 v11, 3277, v10
 v_lshrrev_b32 v11, 16, v11
 v_mul_u32_u24 v30, 20, v11
 v_sub_u32 v30, v10, v30
 v_lshrrev_b32 v30, 2, v30
 v_lshlrev_b32 v11, 17, v11
 v_lshlrev_b32 v31, 4, v9
 v_add3_u32 v11, v11, v31, s48
 v_lshrrev_b32 v31, 2, v30
 v_lshl_add_u32 v11, v31, 10, v11
 v_bfe_u32 v31, v30, 1, 1
 v_lshl_add_u32 v11, v31, 9, v11
 v_and_b32 v31, 1, v30
 v_lshl_add_u32 v11, v31, 3, v11
 v_mul_f32 v32, v29, v24
 v_fma_f32 v32, v28, v76, -v32
 v_mul_f32 v33, v29, v25
 v_fma_f32 v33, v28, v77, -v33
 v_mul_f32 v34, v29, v26
 v_fma_f32 v34, v28, v78, -v34
 v_mul_f32 v35, v29, v27
 v_fma_f32 v35, v28, v79, -v35
 v_cvt_pk_bf16_f32 v36, v32, v33
 v_cvt_pk_bf16_f32 v37, v34, v35
 buffer_store_dwordx2 v[36:37], v11, s[24:27], 0 offen
 v_mul_f32 v28, s47, v182
 v_mul_f32 v29, s47, v184
 s_lshl_b32 s48, s32, 1
 s_add_u32 s48, s48, 1
 s_lshl_b32 s48, s48, 11
 v_add_u32 v10, 0, v8
 v_mul_u32_u24 v11, 3277, v10
 v_lshrrev_b32 v11, 16, v11
 v_mul_u32_u24 v30, 20, v11
 v_sub_u32 v30, v10, v30
 v_lshrrev_b32 v30, 2, v30
 v_lshlrev_b32 v11, 17, v11
 v_lshlrev_b32 v31, 4, v9
 v_add3_u32 v11, v11, v31, s48
 v_lshrrev_b32 v31, 2, v30
 v_lshl_add_u32 v11, v31, 10, v11
 v_bfe_u32 v31, v30, 1, 1
 v_lshl_add_u32 v11, v31, 9, v11
 v_and_b32 v31, 1, v30
 v_lshl_add_u32 v11, v31, 3, v11
 v_mul_f32 v32, v29, v12
 v_fma_f32 v32, v28, v80, -v32
 v_mul_f32 v33, v29, v13
 v_fma_f32 v33, v28, v81, -v33
 v_mul_f32 v34, v29, v14
 v_fma_f32 v34, v28, v82, -v34
 v_mul_f32 v35, v29, v15
 v_fma_f32 v35, v28, v83, -v35
 v_cvt_pk_bf16_f32 v36, v32, v33
 v_cvt_pk_bf16_f32 v37, v34, v35
 buffer_store_dwordx2 v[36:37], v11, s[24:27], 0 offen
 v_add_u32 v10, 8, v8
 v_mul_u32_u24 v11, 3277, v10
 v_lshrrev_b32 v11, 16, v11
 v_mul_u32_u24 v30, 20, v11
 v_sub_u32 v30, v10, v30
 v_lshrrev_b32 v30, 2, v30
 v_lshlrev_b32 v11, 17, v11
 v_lshlrev_b32 v31, 4, v9
 v_add3_u32 v11, v11, v31, s48
 v_lshrrev_b32 v31, 2, v30
 v_lshl_add_u32 v11, v31, 10, v11
 v_bfe_u32 v31, v30, 1, 1
 v_lshl_add_u32 v11, v31, 9, v11
 v_and_b32 v31, 1, v30
 v_lshl_add_u32 v11, v31, 3, v11
 v_mul_f32 v32, v29, v16
 v_fma_f32 v32, v28, v84, -v32
 v_mul_f32 v33, v29, v17
 v_fma_f32 v33, v28, v85, -v33
 v_mul_f32 v34, v29, v18
 v_fma_f32 v34, v28, v86, -v34
 v_mul_f32 v35, v29, v19
 v_fma_f32 v35, v28, v87, -v35
 v_cvt_pk_bf16_f32 v36, v32, v33
 v_cvt_pk_bf16_f32 v37, v34, v35
 buffer_store_dwordx2 v[36:37], v11, s[24:27], 0 offen
 v_add_u32 v10, 16, v8
 v_mul_u32_u24 v11, 3277, v10
 v_lshrrev_b32 v11, 16, v11
 v_mul_u32_u24 v30, 20, v11
 v_sub_u32 v30, v10, v30
 v_lshrrev_b32 v30, 2, v30
 v_lshlrev_b32 v11, 17, v11
 v_lshlrev_b32 v31, 4, v9
 v_add3_u32 v11, v11, v31, s48
 v_lshrrev_b32 v31, 2, v30
 v_lshl_add_u32 v11, v31, 10, v11
 v_bfe_u32 v31, v30, 1, 1
 v_lshl_add_u32 v11, v31, 9, v11
 v_and_b32 v31, 1, v30
 v_lshl_add_u32 v11, v31, 3, v11
 v_mul_f32 v32, v29, v20
 v_fma_f32 v32, v28, v88, -v32
 v_mul_f32 v33, v29, v21
 v_fma_f32 v33, v28, v89, -v33
 v_mul_f32 v34, v29, v22
 v_fma_f32 v34, v28, v90, -v34
 v_mul_f32 v35, v29, v23
 v_fma_f32 v35, v28, v91, -v35
 v_cvt_pk_bf16_f32 v36, v32, v33
 v_cvt_pk_bf16_f32 v37, v34, v35
 buffer_store_dwordx2 v[36:37], v11, s[24:27], 0 offen
 v_add_u32 v10, 24, v8
 v_mul_u32_u24 v11, 3277, v10
 v_lshrrev_b32 v11, 16, v11
 v_mul_u32_u24 v30, 20, v11
 v_sub_u32 v30, v10, v30
 v_lshrrev_b32 v30, 2, v30
 v_lshlrev_b32 v11, 17, v11
 v_lshlrev_b32 v31, 4, v9
 v_add3_u32 v11, v11, v31, s48
 v_lshrrev_b32 v31, 2, v30
 v_lshl_add_u32 v11, v31, 10, v11
 v_bfe_u32 v31, v30, 1, 1
 v_lshl_add_u32 v11, v31, 9, v11
 v_and_b32 v31, 1, v30
 v_lshl_add_u32 v11, v31, 3, v11
 v_mul_f32 v32, v29, v24
 v_fma_f32 v32, v28, v92, -v32
 v_mul_f32 v33, v29, v25
 v_fma_f32 v33, v28, v93, -v33
 v_mul_f32 v34, v29, v26
 v_fma_f32 v34, v28, v94, -v34
 v_mul_f32 v35, v29, v27
 v_fma_f32 v35, v28, v95, -v35
 v_cvt_pk_bf16_f32 v36, v32, v33
 v_cvt_pk_bf16_f32 v37, v34, v35
 buffer_store_dwordx2 v[36:37], v11, s[24:27], 0 offen
 s_add_u32 s49, s40, -19
 s_lshl_b32 s52, s49, 5
 v_bfe_u32 v8, v0, 5, 1
 v_lshlrev_b32 v8, 2, v8
 v_and_b32 v9, 31, v0
 v_add_u32 v8, s52, v8
 s_mov_b32 s47, 0x3f800000
 v_add_u32 v10, 640, v8
 v_lshlrev_b32 v11, 2, v10
 buffer_load_dwordx4 v[12:15], v11, s[16:19], 0 offen
 v_add_u32 v10, 648, v8
 v_lshlrev_b32 v11, 2, v10
 buffer_load_dwordx4 v[16:19], v11, s[16:19], 0 offen
 v_add_u32 v10, 656, v8
 v_lshlrev_b32 v11, 2, v10
 buffer_load_dwordx4 v[20:23], v11, s[16:19], 0 offen
 v_add_u32 v10, 664, v8
 v_lshlrev_b32 v11, 2, v10
 buffer_load_dwordx4 v[24:27], v11, s[16:19], 0 offen
 v_mul_f32 v28, s47, v181
 v_mul_f32 v29, s47, v183
 s_lshl_b32 s48, s32, 1
 s_add_u32 s48, s48, 0
 s_lshl_b32 s48, s48, 11
 s_waitcnt vmcnt(3)
 v_add_u32 v10, 0, v8
 v_mul_u32_u24 v11, 3277, v10
 v_lshrrev_b32 v11, 16, v11
 v_mul_u32_u24 v30, 20, v11
 v_sub_u32 v30, v10, v30
 v_lshrrev_b32 v30, 2, v30
 v_lshlrev_b32 v11, 17, v11
 v_lshlrev_b32 v31, 4, v9
 v_add3_u32 v11, v11, v31, s48
 v_lshrrev_b32 v31, 2, v30
 v_lshl_add_u32 v11, v31, 10, v11
 v_bfe_u32 v31, v30, 1, 1
 v_lshl_add_u32 v11, v31, 9, v11
 v_and_b32 v31, 1, v30
 v_lshl_add_u32 v11, v31, 3, v11
 v_mul_f32 v32, v29, v12
 v_fma_f32 v32, v28, v96, -v32
 v_mul_f32 v33, v29, v13
 v_fma_f32 v33, v28, v97, -v33
 v_mul_f32 v34, v29, v14
 v_fma_f32 v34, v28, v98, -v34
 v_mul_f32 v35, v29, v15
 v_fma_f32 v35, v28, v99, -v35
 v_cvt_pk_bf16_f32 v36, v32, v33
 v_cvt_pk_bf16_f32 v37, v34, v35
 buffer_store_dwordx2 v[36:37], v11, s[24:27], 0 offen
 s_waitcnt vmcnt(3)
 v_add_u32 v10, 8, v8
 v_mul_u32_u24 v11, 3277, v10
 v_lshrrev_b32 v11, 16, v11
 v_mul_u32_u24 v30, 20, v11
 v_sub_u32 v30, v10, v30
 v_lshrrev_b32 v30, 2, v30
 v_lshlrev_b32 v11, 17, v11
 v_lshlrev_b32 v31, 4, v9
 v_add3_u32 v11, v11, v31, s48
 v_lshrrev_b32 v31, 2, v30
 v_lshl_add_u32 v11, v31, 10, v11
 v_bfe_u32 v31, v30, 1, 1
 v_lshl_add_u32 v11, v31, 9, v11
 v_and_b32 v31, 1, v30
 v_lshl_add_u32 v11, v31, 3, v11
 v_mul_f32 v32, v29, v16
 v_fma_f32 v32, v28, v100, -v32
 v_mul_f32 v33, v29, v17
 v_fma_f32 v33, v28, v101, -v33
 v_mul_f32 v34, v29, v18
 v_fma_f32 v34, v28, v102, -v34
 v_mul_f32 v35, v29, v19
 v_fma_f32 v35, v28, v103, -v35
 v_cvt_pk_bf16_f32 v36, v32, v33
 v_cvt_pk_bf16_f32 v37, v34, v35
 buffer_store_dwordx2 v[36:37], v11, s[24:27], 0 offen
 s_waitcnt vmcnt(3)
 v_add_u32 v10, 16, v8
 v_mul_u32_u24 v11, 3277, v10
 v_lshrrev_b32 v11, 16, v11
 v_mul_u32_u24 v30, 20, v11
 v_sub_u32 v30, v10, v30
 v_lshrrev_b32 v30, 2, v30
 v_lshlrev_b32 v11, 17, v11
 v_lshlrev_b32 v31, 4, v9
 v_add3_u32 v11, v11, v31, s48
 v_lshrrev_b32 v31, 2, v30
 v_lshl_add_u32 v11, v31, 10, v11
 v_bfe_u32 v31, v30, 1, 1
 v_lshl_add_u32 v11, v31, 9, v11
 v_and_b32 v31, 1, v30
 v_lshl_add_u32 v11, v31, 3, v11
 v_mul_f32 v32, v29, v20
 v_fma_f32 v32, v28, v104, -v32
 v_mul_f32 v33, v29, v21
 v_fma_f32 v33, v28, v105, -v33
 v_mul_f32 v34, v29, v22
 v_fma_f32 v34, v28, v106, -v34
 v_mul_f32 v35, v29, v23
 v_fma_f32 v35, v28, v107, -v35
 v_cvt_pk_bf16_f32 v36, v32, v33
 v_cvt_pk_bf16_f32 v37, v34, v35
 buffer_store_dwordx2 v[36:37], v11, s[24:27], 0 offen
 s_waitcnt vmcnt(3)
 v_add_u32 v10, 24, v8
 v_mul_u32_u24 v11, 3277, v10
 v_lshrrev_b32 v11, 16, v11
 v_mul_u32_u24 v30, 20, v11
 v_sub_u32 v30, v10, v30
 v_lshrrev_b32 v30, 2, v30
 v_lshlrev_b32 v11, 17, v11
 v_lshlrev_b32 v31, 4, v9
 v_add3_u32 v11, v11, v31, s48
 v_lshrrev_b32 v31, 2, v30
 v_lshl_add_u32 v11, v31, 10, v11
 v_bfe_u32 v31, v30, 1, 1
 v_lshl_add_u32 v11, v31, 9, v11
 v_and_b32 v31, 1, v30
 v_lshl_add_u32 v11, v31, 3, v11
 v_mul_f32 v32, v29, v24
 v_fma_f32 v32, v28, v108, -v32
 v_mul_f32 v33, v29, v25
 v_fma_f32 v33, v28, v109, -v33
 v_mul_f32 v34, v29, v26
 v_fma_f32 v34, v28, v110, -v34
 v_mul_f32 v35, v29, v27
 v_fma_f32 v35, v28, v111, -v35
 v_cvt_pk_bf16_f32 v36, v32, v33
 v_cvt_pk_bf16_f32 v37, v34, v35
 buffer_store_dwordx2 v[36:37], v11, s[24:27], 0 offen
 v_mul_f32 v28, s47, v182
 v_mul_f32 v29, s47, v184
 s_lshl_b32 s48, s32, 1
 s_add_u32 s48, s48, 1
 s_lshl_b32 s48, s48, 11
 v_add_u32 v10, 0, v8
 v_mul_u32_u24 v11, 3277, v10
 v_lshrrev_b32 v11, 16, v11
 v_mul_u32_u24 v30, 20, v11
 v_sub_u32 v30, v10, v30
 v_lshrrev_b32 v30, 2, v30
 v_lshlrev_b32 v11, 17, v11
 v_lshlrev_b32 v31, 4, v9
 v_add3_u32 v11, v11, v31, s48
 v_lshrrev_b32 v31, 2, v30
 v_lshl_add_u32 v11, v31, 10, v11
 v_bfe_u32 v31, v30, 1, 1
 v_lshl_add_u32 v11, v31, 9, v11
 v_and_b32 v31, 1, v30
 v_lshl_add_u32 v11, v31, 3, v11
 v_mul_f32 v32, v29, v12
 v_fma_f32 v32, v28, v112, -v32
 v_mul_f32 v33, v29, v13
 v_fma_f32 v33, v28, v113, -v33
 v_mul_f32 v34, v29, v14
 v_fma_f32 v34, v28, v114, -v34
 v_mul_f32 v35, v29, v15
 v_fma_f32 v35, v28, v115, -v35
 v_cvt_pk_bf16_f32 v36, v32, v33
 v_cvt_pk_bf16_f32 v37, v34, v35
 buffer_store_dwordx2 v[36:37], v11, s[24:27], 0 offen
 v_add_u32 v10, 8, v8
 v_mul_u32_u24 v11, 3277, v10
 v_lshrrev_b32 v11, 16, v11
 v_mul_u32_u24 v30, 20, v11
 v_sub_u32 v30, v10, v30
 v_lshrrev_b32 v30, 2, v30
 v_lshlrev_b32 v11, 17, v11
 v_lshlrev_b32 v31, 4, v9
 v_add3_u32 v11, v11, v31, s48
 v_lshrrev_b32 v31, 2, v30
 v_lshl_add_u32 v11, v31, 10, v11
 v_bfe_u32 v31, v30, 1, 1
 v_lshl_add_u32 v11, v31, 9, v11
 v_and_b32 v31, 1, v30
 v_lshl_add_u32 v11, v31, 3, v11
 v_mul_f32 v32, v29, v16
 v_fma_f32 v32, v28, v116, -v32
 v_mul_f32 v33, v29, v17
 v_fma_f32 v33, v28, v117, -v33
 v_mul_f32 v34, v29, v18
 v_fma_f32 v34, v28, v118, -v34
 v_mul_f32 v35, v29, v19
 v_fma_f32 v35, v28, v119, -v35
 v_cvt_pk_bf16_f32 v36, v32, v33
 v_cvt_pk_bf16_f32 v37, v34, v35
 buffer_store_dwordx2 v[36:37], v11, s[24:27], 0 offen
 v_add_u32 v10, 16, v8
 v_mul_u32_u24 v11, 3277, v10
 v_lshrrev_b32 v11, 16, v11
 v_mul_u32_u24 v30, 20, v11
 v_sub_u32 v30, v10, v30
 v_lshrrev_b32 v30, 2, v30
 v_lshlrev_b32 v11, 17, v11
 v_lshlrev_b32 v31, 4, v9
 v_add3_u32 v11, v11, v31, s48
 v_lshrrev_b32 v31, 2, v30
 v_lshl_add_u32 v11, v31, 10, v11
 v_bfe_u32 v31, v30, 1, 1
 v_lshl_add_u32 v11, v31, 9, v11
 v_and_b32 v31, 1, v30
 v_lshl_add_u32 v11, v31, 3, v11
 v_mul_f32 v32, v29, v20
 v_fma_f32 v32, v28, v120, -v32
 v_mul_f32 v33, v29, v21
 v_fma_f32 v33, v28, v121, -v33
 v_mul_f32 v34, v29, v22
 v_fma_f32 v34, v28, v122, -v34
 v_mul_f32 v35, v29, v23
 v_fma_f32 v35, v28, v123, -v35
 v_cvt_pk_bf16_f32 v36, v32, v33
 v_cvt_pk_bf16_f32 v37, v34, v35
 buffer_store_dwordx2 v[36:37], v11, s[24:27], 0 offen
 v_add_u32 v10, 24, v8
 v_mul_u32_u24 v11, 3277, v10
 v_lshrrev_b32 v11, 16, v11
 v_mul_u32_u24 v30, 20, v11
 v_sub_u32 v30, v10, v30
 v_lshrrev_b32 v30, 2, v30
 v_lshlrev_b32 v11, 17, v11
 v_lshlrev_b32 v31, 4, v9
 v_add3_u32 v11, v11, v31, s48
 v_lshrrev_b32 v31, 2, v30
 v_lshl_add_u32 v11, v31, 10, v11
 v_bfe_u32 v31, v30, 1, 1
 v_lshl_add_u32 v11, v31, 9, v11
 v_and_b32 v31, 1, v30
 v_lshl_add_u32 v11, v31, 3, v11
 v_mul_f32 v32, v29, v24
 v_fma_f32 v32, v28, v124, -v32
 v_mul_f32 v33, v29, v25
 v_fma_f32 v33, v28, v125, -v33
 v_mul_f32 v34, v29, v26
 v_fma_f32 v34, v28, v126, -v34
 v_mul_f32 v35, v29, v27
 v_fma_f32 v35, v28, v127, -v35
 v_cvt_pk_bf16_f32 v36, v32, v33
 v_cvt_pk_bf16_f32 v37, v34, v35
 buffer_store_dwordx2 v[36:37], v11, s[24:27], 0 offen
 s_branch L_b1_1_kernel_end
L_b1_1_kernel_vtype:
 buffer_load_dwordx4 v[128:131], v4, s[12:15], s42 offen
 buffer_load_dwordx4 v[132:135], v4, s[12:15], s43 offen
 s_add_u32 s42, s42, 1024
 s_add_u32 s43, s43, 1024
 buffer_load_dwordx4 v[136:139], v4, s[12:15], s42 offen
 buffer_load_dwordx4 v[140:143], v4, s[12:15], s43 offen
 s_add_u32 s42, s42, 1024
 s_add_u32 s43, s43, 1024
 buffer_load_dwordx4 v[144:147], v4, s[12:15], s42 offen
 buffer_load_dwordx4 v[148:151], v4, s[12:15], s43 offen
 s_add_u32 s42, s42, 1024
 s_add_u32 s43, s43, 1024
 buffer_load_dwordx4 v[152:155], v4, s[12:15], s42 offen
 buffer_load_dwordx4 v[156:159], v4, s[12:15], s43 offen
 s_add_u32 s42, s42, 1024
 s_add_u32 s43, s43, 1024
 ds_read_b128 v[160:163], v5 offset:0
 ds_read_b128 v[164:167], v7 offset:0
 ds_read_b128 v[168:171], v5 offset:32
 ds_read_b128 v[172:175], v7 offset:32
 s_waitcnt vmcnt(6) lgkmcnt(2)
 v_mfma_f32_32x32x16_bf16 v[64:79], v[160:163], v[128:131], v[64:79]
 v_mfma_f32_32x32x16_bf16 v[80:95], v[164:167], v[128:131], v[80:95]
 v_mfma_f32_32x32x16_bf16 v[96:111], v[160:163], v[132:135], v[96:111]
 v_mfma_f32_32x32x16_bf16 v[112:127], v[164:167], v[132:135], v[112:127]
 v_dot2c_f32_bf16 v176, v160, v180
 v_dot2c_f32_bf16 v178, v160, v160
 v_dot2c_f32_bf16 v176, v161, v180
 v_dot2c_f32_bf16 v178, v161, v161
 v_dot2c_f32_bf16 v176, v162, v180
 v_dot2c_f32_bf16 v178, v162, v162
 v_dot2c_f32_bf16 v176, v163, v180
 v_dot2c_f32_bf16 v178, v163, v163
 v_dot2c_f32_bf16 v177, v164, v180
 v_dot2c_f32_bf16 v179, v164, v164
 v_dot2c_f32_bf16 v177, v165, v180
 v_dot2c_f32_bf16 v179, v165, v165
 v_dot2c_f32_bf16 v177, v166, v180
 v_dot2c_f32_bf16 v179, v166, v166
 v_dot2c_f32_bf16 v177, v167, v180
 v_dot2c_f32_bf16 v179, v167, v167
 buffer_load_dwordx4 v[128:131], v4, s[12:15], s42 offen
 buffer_load_dwordx4 v[132:135], v4, s[12:15], s43 offen
 s_add_u32 s42, s42, 1024
 s_add_u32 s43, s43, 1024
 ds_read_b128 v[160:163], v5 offset:64
 ds_read_b128 v[164:167], v7 offset:64
 s_waitcnt vmcnt(6) lgkmcnt(2)
 v_mfma_f32_32x32x16_bf16 v[64:79], v[168:171], v[136:139], v[64:79]
 v_mfma_f32_32x32x16_bf16 v[80:95], v[172:175], v[136:139], v[80:95]
 v_mfma_f32_32x32x16_bf16 v[96:111], v[168:171], v[140:143], v[96:111]
 v_mfma_f32_32x32x16_bf16 v[112:127], v[172:175], v[140:143], v[112:127]
 v_dot2c_f32_bf16 v176, v168, v180
 v_dot2c_f32_bf16 v178, v168, v168
 v_dot2c_f32_bf16 v176, v169, v180
 v_dot2c_f32_bf16 v178, v169, v169
 v_dot2c_f32_bf16 v176, v170, v180
 v_dot2c_f32_bf16 v178, v170, v170
 v_dot2c_f32_bf16 v176, v171, v180
 v_dot2c_f32_bf16 v178, v171, v171
 v_dot2c_f32_bf16 v177, v172, v180
 v_dot2c_f32_bf16 v179, v172, v172
 v_dot2c_f32_bf16 v177, v173, v180
 v_dot2c_f32_bf16 v179, v173, v173
 v_dot2c_f32_bf16 v177, v174, v180
 v_dot2c_f32_bf16 v179, v174, v174
 v_dot2c_f32_bf16 v177, v175, v180
 v_dot2c_f32_bf16 v179, v175, v175
 buffer_load_dwordx4 v[136:139], v4, s[12:15], s42 offen
 buffer_load_dwordx4 v[140:143], v4, s[12:15], s43 offen
 s_add_u32 s42, s42, 1024
 s_add_u32 s43, s43, 1024
 ds_read_b128 v[168:171], v5 offset:96
 ds_read_b128 v[172:175], v7 offset:96
 s_waitcnt vmcnt(6) lgkmcnt(2)
 v_mfma_f32_32x32x16_bf16 v[64:79], v[160:163], v[144:147], v[64:79]
 v_mfma_f32_32x32x16_bf16 v[80:95], v[164:167], v[144:147], v[80:95]
 v_mfma_f32_32x32x16_bf16 v[96:111], v[160:163], v[148:151], v[96:111]
 v_mfma_f32_32x32x16_bf16 v[112:127], v[164:167], v[148:151], v[112:127]
 v_dot2c_f32_bf16 v176, v160, v180
 v_dot2c_f32_bf16 v178, v160, v160
 v_dot2c_f32_bf16 v176, v161, v180
 v_dot2c_f32_bf16 v178, v161, v161
 v_dot2c_f32_bf16 v176, v162, v180
 v_dot2c_f32_bf16 v178, v162, v162
 v_dot2c_f32_bf16 v176, v163, v180
 v_dot2c_f32_bf16 v178, v163, v163
 v_dot2c_f32_bf16 v177, v164, v180
 v_dot2c_f32_bf16 v179, v164, v164
 v_dot2c_f32_bf16 v177, v165, v180
 v_dot2c_f32_bf16 v179, v165, v165
 v_dot2c_f32_bf16 v177, v166, v180
 v_dot2c_f32_bf16 v179, v166, v166
 v_dot2c_f32_bf16 v177, v167, v180
 v_dot2c_f32_bf16 v179, v167, v167
 buffer_load_dwordx4 v[144:147], v4, s[12:15], s42 offen
 buffer_load_dwordx4 v[148:151], v4, s[12:15], s43 offen
 s_add_u32 s42, s42, 1024
 s_add_u32 s43, s43, 1024
 ds_read_b128 v[160:163], v5 offset:128
 ds_read_b128 v[164:167], v7 offset:128
 s_waitcnt vmcnt(6) lgkmcnt(2)
 v_mfma_f32_32x32x16_bf16 v[64:79], v[168:171], v[152:155], v[64:79]
 v_mfma_f32_32x32x16_bf16 v[80:95], v[172:175], v[152:155], v[80:95]
 v_mfma_f32_32x32x16_bf16 v[96:111], v[168:171], v[156:159], v[96:111]
 v_mfma_f32_32x32x16_bf16 v[112:127], v[172:175], v[156:159], v[112:127]
 v_dot2c_f32_bf16 v176, v168, v180
 v_dot2c_f32_bf16 v178, v168, v168
 v_dot2c_f32_bf16 v176, v169, v180
 v_dot2c_f32_bf16 v178, v169, v169
 v_dot2c_f32_bf16 v176, v170, v180
 v_dot2c_f32_bf16 v178, v170, v170
 v_dot2c_f32_bf16 v176, v171, v180
 v_dot2c_f32_bf16 v178, v171, v171
 v_dot2c_f32_bf16 v177, v172, v180
 v_dot2c_f32_bf16 v179, v172, v172
 v_dot2c_f32_bf16 v177, v173, v180
 v_dot2c_f32_bf16 v179, v173, v173
 v_dot2c_f32_bf16 v177, v174, v180
 v_dot2c_f32_bf16 v179, v174, v174
 v_dot2c_f32_bf16 v177, v175, v180
 v_dot2c_f32_bf16 v179, v175, v175
 buffer_load_dwordx4 v[152:155], v4, s[12:15], s42 offen
 buffer_load_dwordx4 v[156:159], v4, s[12:15], s43 offen
 s_add_u32 s42, s42, 1024
 s_add_u32 s43, s43, 1024
 ds_read_b128 v[168:171], v5 offset:160
 ds_read_b128 v[172:175], v7 offset:160
 s_waitcnt vmcnt(6) lgkmcnt(2)
 v_mfma_f32_32x32x16_bf16 v[64:79], v[160:163], v[128:131], v[64:79]
 v_mfma_f32_32x32x16_bf16 v[80:95], v[164:167], v[128:131], v[80:95]
 v_mfma_f32_32x32x16_bf16 v[96:111], v[160:163], v[132:135], v[96:111]
 v_mfma_f32_32x32x16_bf16 v[112:127], v[164:167], v[132:135], v[112:127]
 v_dot2c_f32_bf16 v176, v160, v180
 v_dot2c_f32_bf16 v178, v160, v160
 v_dot2c_f32_bf16 v176, v161, v180
 v_dot2c_f32_bf16 v178, v161, v161
 v_dot2c_f32_bf16 v176, v162, v180
 v_dot2c_f32_bf16 v178, v162, v162
 v_dot2c_f32_bf16 v176, v163, v180
 v_dot2c_f32_bf16 v178, v163, v163
 v_dot2c_f32_bf16 v177, v164, v180
 v_dot2c_f32_bf16 v179, v164, v164
 v_dot2c_f32_bf16 v177, v165, v180
 v_dot2c_f32_bf16 v179, v165, v165
 v_dot2c_f32_bf16 v177, v166, v180
 v_dot2c_f32_bf16 v179, v166, v166
 v_dot2c_f32_bf16 v177, v167, v180
 v_dot2c_f32_bf16 v179, v167, v167
 buffer_load_dwordx4 v[128:131], v4, s[12:15], s42 offen
 buffer_load_dwordx4 v[132:135], v4, s[12:15], s43 offen
 s_add_u32 s42, s42, 1024
 s_add_u32 s43, s43, 1024
 ds_read_b128 v[160:163], v5 offset:192
 ds_read_b128 v[164:167], v7 offset:192
 s_waitcnt vmcnt(6) lgkmcnt(2)
 v_mfma_f32_32x32x16_bf16 v[64:79], v[168:171], v[136:139], v[64:79]
 v_mfma_f32_32x32x16_bf16 v[80:95], v[172:175], v[136:139], v[80:95]
 v_mfma_f32_32x32x16_bf16 v[96:111], v[168:171], v[140:143], v[96:111]
 v_mfma_f32_32x32x16_bf16 v[112:127], v[172:175], v[140:143], v[112:127]
 v_dot2c_f32_bf16 v176, v168, v180
 v_dot2c_f32_bf16 v178, v168, v168
 v_dot2c_f32_bf16 v176, v169, v180
 v_dot2c_f32_bf16 v178, v169, v169
 v_dot2c_f32_bf16 v176, v170, v180
 v_dot2c_f32_bf16 v178, v170, v170
 v_dot2c_f32_bf16 v176, v171, v180
 v_dot2c_f32_bf16 v178, v171, v171
 v_dot2c_f32_bf16 v177, v172, v180
 v_dot2c_f32_bf16 v179, v172, v172
 v_dot2c_f32_bf16 v177, v173, v180
 v_dot2c_f32_bf16 v179, v173, v173
 v_dot2c_f32_bf16 v177, v174, v180
 v_dot2c_f32_bf16 v179, v174, v174
 v_dot2c_f32_bf16 v177, v175, v180
 v_dot2c_f32_bf16 v179, v175, v175
 buffer_load_dwordx4 v[136:139], v4, s[12:15], s42 offen
 buffer_load_dwordx4 v[140:143], v4, s[12:15], s43 offen
 s_add_u32 s42, s42, 1024
 s_add_u32 s43, s43, 1024
 ds_read_b128 v[168:171], v5 offset:224
 ds_read_b128 v[172:175], v7 offset:224
 s_waitcnt vmcnt(6) lgkmcnt(2)
 v_mfma_f32_32x32x16_bf16 v[64:79], v[160:163], v[144:147], v[64:79]
 v_mfma_f32_32x32x16_bf16 v[80:95], v[164:167], v[144:147], v[80:95]
 v_mfma_f32_32x32x16_bf16 v[96:111], v[160:163], v[148:151], v[96:111]
 v_mfma_f32_32x32x16_bf16 v[112:127], v[164:167], v[148:151], v[112:127]
 v_dot2c_f32_bf16 v176, v160, v180
 v_dot2c_f32_bf16 v178, v160, v160
 v_dot2c_f32_bf16 v176, v161, v180
 v_dot2c_f32_bf16 v178, v161, v161
 v_dot2c_f32_bf16 v176, v162, v180
 v_dot2c_f32_bf16 v178, v162, v162
 v_dot2c_f32_bf16 v176, v163, v180
 v_dot2c_f32_bf16 v178, v163, v163
 v_dot2c_f32_bf16 v177, v164, v180
 v_dot2c_f32_bf16 v179, v164, v164
 v_dot2c_f32_bf16 v177, v165, v180
 v_dot2c_f32_bf16 v179, v165, v165
 v_dot2c_f32_bf16 v177, v166, v180
 v_dot2c_f32_bf16 v179, v166, v166
 v_dot2c_f32_bf16 v177, v167, v180
 v_dot2c_f32_bf16 v179, v167, v167
 buffer_load_dwordx4 v[144:147], v4, s[12:15], s42 offen
 buffer_load_dwordx4 v[148:151], v4, s[12:15], s43 offen
 s_add_u32 s42, s42, 1024
 s_add_u32 s43, s43, 1024
 ds_read_b128 v[160:163], v5 offset:256
 ds_read_b128 v[164:167], v7 offset:256
 s_waitcnt vmcnt(6) lgkmcnt(2)
 v_mfma_f32_32x32x16_bf16 v[64:79], v[168:171], v[152:155], v[64:79]
 v_mfma_f32_32x32x16_bf16 v[80:95], v[172:175], v[152:155], v[80:95]
 v_mfma_f32_32x32x16_bf16 v[96:111], v[168:171], v[156:159], v[96:111]
 v_mfma_f32_32x32x16_bf16 v[112:127], v[172:175], v[156:159], v[112:127]
 v_dot2c_f32_bf16 v176, v168, v180
 v_dot2c_f32_bf16 v178, v168, v168
 v_dot2c_f32_bf16 v176, v169, v180
 v_dot2c_f32_bf16 v178, v169, v169
 v_dot2c_f32_bf16 v176, v170, v180
 v_dot2c_f32_bf16 v178, v170, v170
 v_dot2c_f32_bf16 v176, v171, v180
 v_dot2c_f32_bf16 v178, v171, v171
 v_dot2c_f32_bf16 v177, v172, v180
 v_dot2c_f32_bf16 v179, v172, v172
 v_dot2c_f32_bf16 v177, v173, v180
 v_dot2c_f32_bf16 v179, v173, v173
 v_dot2c_f32_bf16 v177, v174, v180
 v_dot2c_f32_bf16 v179, v174, v174
 v_dot2c_f32_bf16 v177, v175, v180
 v_dot2c_f32_bf16 v179, v175, v175
 buffer_load_dwordx4 v[152:155], v4, s[12:15], s42 offen
 buffer_load_dwordx4 v[156:159], v4, s[12:15], s43 offen
 s_add_u32 s42, s42, 1024
 s_add_u32 s43, s43, 1024
 ds_read_b128 v[168:171], v5 offset:288
 ds_read_b128 v[172:175], v7 offset:288
 s_waitcnt vmcnt(6) lgkmcnt(2)
 v_mfma_f32_32x32x16_bf16 v[64:79], v[160:163], v[128:131], v[64:79]
 v_mfma_f32_32x32x16_bf16 v[80:95], v[164:167], v[128:131], v[80:95]
 v_mfma_f32_32x32x16_bf16 v[96:111], v[160:163], v[132:135], v[96:111]
 v_mfma_f32_32x32x16_bf16 v[112:127], v[164:167], v[132:135], v[112:127]
 v_dot2c_f32_bf16 v176, v160, v180
 v_dot2c_f32_bf16 v178, v160, v160
 v_dot2c_f32_bf16 v176, v161, v180
 v_dot2c_f32_bf16 v178, v161, v161
 v_dot2c_f32_bf16 v176, v162, v180
 v_dot2c_f32_bf16 v178, v162, v162
 v_dot2c_f32_bf16 v176, v163, v180
 v_dot2c_f32_bf16 v178, v163, v163
 v_dot2c_f32_bf16 v177, v164, v180
 v_dot2c_f32_bf16 v179, v164, v164
 v_dot2c_f32_bf16 v177, v165, v180
 v_dot2c_f32_bf16 v179, v165, v165
 v_dot2c_f32_bf16 v177, v166, v180
 v_dot2c_f32_bf16 v179, v166, v166
 v_dot2c_f32_bf16 v177, v167, v180
 v_dot2c_f32_bf16 v179, v167, v167
 buffer_load_dwordx4 v[128:131], v4, s[12:15], s42 offen
 buffer_load_dwordx4 v[132:135], v4, s[12:15], s43 offen
 s_add_u32 s42, s42, 1024
 s_add_u32 s43, s43, 1024
 ds_read_b128 v[160:163], v5 offset:320
 ds_read_b128 v[164:167], v7 offset:320
 s_waitcnt vmcnt(6) lgkmcnt(2)
 v_mfma_f32_32x32x16_bf16 v[64:79], v[168:171], v[136:139], v[64:79]
 v_mfma_f32_32x32x16_bf16 v[80:95], v[172:175], v[136:139], v[80:95]
 v_mfma_f32_32x32x16_bf16 v[96:111], v[168:171], v[140:143], v[96:111]
 v_mfma_f32_32x32x16_bf16 v[112:127], v[172:175], v[140:143], v[112:127]
 v_dot2c_f32_bf16 v176, v168, v180
 v_dot2c_f32_bf16 v178, v168, v168
 v_dot2c_f32_bf16 v176, v169, v180
 v_dot2c_f32_bf16 v178, v169, v169
 v_dot2c_f32_bf16 v176, v170, v180
 v_dot2c_f32_bf16 v178, v170, v170
 v_dot2c_f32_bf16 v176, v171, v180
 v_dot2c_f32_bf16 v178, v171, v171
 v_dot2c_f32_bf16 v177, v172, v180
 v_dot2c_f32_bf16 v179, v172, v172
 v_dot2c_f32_bf16 v177, v173, v180
 v_dot2c_f32_bf16 v179, v173, v173
 v_dot2c_f32_bf16 v177, v174, v180
 v_dot2c_f32_bf16 v179, v174, v174
 v_dot2c_f32_bf16 v177, v175, v180
 v_dot2c_f32_bf16 v179, v175, v175
 buffer_load_dwordx4 v[136:139], v4, s[12:15], s42 offen
 buffer_load_dwordx4 v[140:143], v4, s[12:15], s43 offen
 s_add_u32 s42, s42, 1024
 s_add_u32 s43, s43, 1024
 ds_read_b128 v[168:171], v5 offset:352
 ds_read_b128 v[172:175], v7 offset:352
 s_waitcnt vmcnt(6) lgkmcnt(2)
 v_mfma_f32_32x32x16_bf16 v[64:79], v[160:163], v[144:147], v[64:79]
 v_mfma_f32_32x32x16_bf16 v[80:95], v[164:167], v[144:147], v[80:95]
 v_mfma_f32_32x32x16_bf16 v[96:111], v[160:163], v[148:151], v[96:111]
 v_mfma_f32_32x32x16_bf16 v[112:127], v[164:167], v[148:151], v[112:127]
 v_dot2c_f32_bf16 v176, v160, v180
 v_dot2c_f32_bf16 v178, v160, v160
 v_dot2c_f32_bf16 v176, v161, v180
 v_dot2c_f32_bf16 v178, v161, v161
 v_dot2c_f32_bf16 v176, v162, v180
 v_dot2c_f32_bf16 v178, v162, v162
 v_dot2c_f32_bf16 v176, v163, v180
 v_dot2c_f32_bf16 v178, v163, v163
 v_dot2c_f32_bf16 v177, v164, v180
 v_dot2c_f32_bf16 v179, v164, v164
 v_dot2c_f32_bf16 v177, v165, v180
 v_dot2c_f32_bf16 v179, v165, v165
 v_dot2c_f32_bf16 v177, v166, v180
 v_dot2c_f32_bf16 v179, v166, v166
 v_dot2c_f32_bf16 v177, v167, v180
 v_dot2c_f32_bf16 v179, v167, v167
 buffer_load_dwordx4 v[144:147], v4, s[12:15], s42 offen
 buffer_load_dwordx4 v[148:151], v4, s[12:15], s43 offen
 s_add_u32 s42, s42, 1024
 s_add_u32 s43, s43, 1024
 ds_read_b128 v[160:163], v5 offset:384
 ds_read_b128 v[164:167], v7 offset:384
 s_waitcnt vmcnt(6) lgkmcnt(2)
 v_mfma_f32_32x32x16_bf16 v[64:79], v[168:171], v[152:155], v[64:79]
 v_mfma_f32_32x32x16_bf16 v[80:95], v[172:175], v[152:155], v[80:95]
 v_mfma_f32_32x32x16_bf16 v[96:111], v[168:171], v[156:159], v[96:111]
 v_mfma_f32_32x32x16_bf16 v[112:127], v[172:175], v[156:159], v[112:127]
 v_dot2c_f32_bf16 v176, v168, v180
 v_dot2c_f32_bf16 v178, v168, v168
 v_dot2c_f32_bf16 v176, v169, v180
 v_dot2c_f32_bf16 v178, v169, v169
 v_dot2c_f32_bf16 v176, v170, v180
 v_dot2c_f32_bf16 v178, v170, v170
 v_dot2c_f32_bf16 v176, v171, v180
 v_dot2c_f32_bf16 v178, v171, v171
 v_dot2c_f32_bf16 v177, v172, v180
 v_dot2c_f32_bf16 v179, v172, v172
 v_dot2c_f32_bf16 v177, v173, v180
 v_dot2c_f32_bf16 v179, v173, v173
 v_dot2c_f32_bf16 v177, v174, v180
 v_dot2c_f32_bf16 v179, v174, v174
 v_dot2c_f32_bf16 v177, v175, v180
 v_dot2c_f32_bf16 v179, v175, v175
 buffer_load_dwordx4 v[152:155], v4, s[12:15], s42 offen
 buffer_load_dwordx4 v[156:159], v4, s[12:15], s43 offen
 s_add_u32 s42, s42, 1024
 s_add_u32 s43, s43, 1024
 ds_read_b128 v[168:171], v5 offset:416
 ds_read_b128 v[172:175], v7 offset:416
 s_waitcnt vmcnt(6) lgkmcnt(2)
 v_mfma_f32_32x32x16_bf16 v[64:79], v[160:163], v[128:131], v[64:79]
 v_mfma_f32_32x32x16_bf16 v[80:95], v[164:167], v[128:131], v[80:95]
 v_mfma_f32_32x32x16_bf16 v[96:111], v[160:163], v[132:135], v[96:111]
 v_mfma_f32_32x32x16_bf16 v[112:127], v[164:167], v[132:135], v[112:127]
 v_dot2c_f32_bf16 v176, v160, v180
 v_dot2c_f32_bf16 v178, v160, v160
 v_dot2c_f32_bf16 v176, v161, v180
 v_dot2c_f32_bf16 v178, v161, v161
 v_dot2c_f32_bf16 v176, v162, v180
 v_dot2c_f32_bf16 v178, v162, v162
 v_dot2c_f32_bf16 v176, v163, v180
 v_dot2c_f32_bf16 v178, v163, v163
 v_dot2c_f32_bf16 v177, v164, v180
 v_dot2c_f32_bf16 v179, v164, v164
 v_dot2c_f32_bf16 v177, v165, v180
 v_dot2c_f32_bf16 v179, v165, v165
 v_dot2c_f32_bf16 v177, v166, v180
 v_dot2c_f32_bf16 v179, v166, v166
 v_dot2c_f32_bf16 v177, v167, v180
 v_dot2c_f32_bf16 v179, v167, v167
 buffer_load_dwordx4 v[128:131], v4, s[12:15], s42 offen
 buffer_load_dwordx4 v[132:135], v4, s[12:15], s43 offen
 s_add_u32 s42, s42, 1024
 s_add_u32 s43, s43, 1024
 ds_read_b128 v[160:163], v5 offset:448
 ds_read_b128 v[164:167], v7 offset:448
 s_waitcnt vmcnt(6) lgkmcnt(2)
 v_mfma_f32_32x32x16_bf16 v[64:79], v[168:171], v[136:139], v[64:79]
 v_mfma_f32_32x32x16_bf16 v[80:95], v[172:175], v[136:139], v[80:95]
 v_mfma_f32_32x32x16_bf16 v[96:111], v[168:171], v[140:143], v[96:111]
 v_mfma_f32_32x32x16_bf16 v[112:127], v[172:175], v[140:143], v[112:127]
 v_dot2c_f32_bf16 v176, v168, v180
 v_dot2c_f32_bf16 v178, v168, v168
 v_dot2c_f32_bf16 v176, v169, v180
 v_dot2c_f32_bf16 v178, v169, v169
 v_dot2c_f32_bf16 v176, v170, v180
 v_dot2c_f32_bf16 v178, v170, v170
 v_dot2c_f32_bf16 v176, v171, v180
 v_dot2c_f32_bf16 v178, v171, v171
 v_dot2c_f32_bf16 v177, v172, v180
 v_dot2c_f32_bf16 v179, v172, v172
 v_dot2c_f32_bf16 v177, v173, v180
 v_dot2c_f32_bf16 v179, v173, v173
 v_dot2c_f32_bf16 v177, v174, v180
 v_dot2c_f32_bf16 v179, v174, v174
 v_dot2c_f32_bf16 v177, v175, v180
 v_dot2c_f32_bf16 v179, v175, v175
 buffer_load_dwordx4 v[136:139], v4, s[12:15], s42 offen
 buffer_load_dwordx4 v[140:143], v4, s[12:15], s43 offen
 s_add_u32 s42, s42, 1024
 s_add_u32 s43, s43, 1024
 ds_read_b128 v[168:171], v5 offset:480
 ds_read_b128 v[172:175], v7 offset:480
 s_waitcnt vmcnt(6) lgkmcnt(2)
 v_mfma_f32_32x32x16_bf16 v[64:79], v[160:163], v[144:147], v[64:79]
 v_mfma_f32_32x32x16_bf16 v[80:95], v[164:167], v[144:147], v[80:95]
 v_mfma_f32_32x32x16_bf16 v[96:111], v[160:163], v[148:151], v[96:111]
 v_mfma_f32_32x32x16_bf16 v[112:127], v[164:167], v[148:151], v[112:127]
 v_dot2c_f32_bf16 v176, v160, v180
 v_dot2c_f32_bf16 v178, v160, v160
 v_dot2c_f32_bf16 v176, v161, v180
 v_dot2c_f32_bf16 v178, v161, v161
 v_dot2c_f32_bf16 v176, v162, v180
 v_dot2c_f32_bf16 v178, v162, v162
 v_dot2c_f32_bf16 v176, v163, v180
 v_dot2c_f32_bf16 v178, v163, v163
 v_dot2c_f32_bf16 v177, v164, v180
 v_dot2c_f32_bf16 v179, v164, v164
 v_dot2c_f32_bf16 v177, v165, v180
 v_dot2c_f32_bf16 v179, v165, v165
 v_dot2c_f32_bf16 v177, v166, v180
 v_dot2c_f32_bf16 v179, v166, v166
 v_dot2c_f32_bf16 v177, v167, v180
 v_dot2c_f32_bf16 v179, v167, v167
 buffer_load_dwordx4 v[144:147], v4, s[12:15], s42 offen
 buffer_load_dwordx4 v[148:151], v4, s[12:15], s43 offen
 s_add_u32 s42, s42, 1024
 s_add_u32 s43, s43, 1024
 ds_read_b128 v[160:163], v5 offset:512
 ds_read_b128 v[164:167], v7 offset:512
 s_waitcnt vmcnt(6) lgkmcnt(2)
 v_mfma_f32_32x32x16_bf16 v[64:79], v[168:171], v[152:155], v[64:79]
 v_mfma_f32_32x32x16_bf16 v[80:95], v[172:175], v[152:155], v[80:95]
 v_mfma_f32_32x32x16_bf16 v[96:111], v[168:171], v[156:159], v[96:111]
 v_mfma_f32_32x32x16_bf16 v[112:127], v[172:175], v[156:159], v[112:127]
 v_dot2c_f32_bf16 v176, v168, v180
 v_dot2c_f32_bf16 v178, v168, v168
 v_dot2c_f32_bf16 v176, v169, v180
 v_dot2c_f32_bf16 v178, v169, v169
 v_dot2c_f32_bf16 v176, v170, v180
 v_dot2c_f32_bf16 v178, v170, v170
 v_dot2c_f32_bf16 v176, v171, v180
 v_dot2c_f32_bf16 v178, v171, v171
 v_dot2c_f32_bf16 v177, v172, v180
 v_dot2c_f32_bf16 v179, v172, v172
 v_dot2c_f32_bf16 v177, v173, v180
 v_dot2c_f32_bf16 v179, v173, v173
 v_dot2c_f32_bf16 v177, v174, v180
 v_dot2c_f32_bf16 v179, v174, v174
 v_dot2c_f32_bf16 v177, v175, v180
 v_dot2c_f32_bf16 v179, v175, v175
 buffer_load_dwordx4 v[152:155], v4, s[12:15], s42 offen
 buffer_load_dwordx4 v[156:159], v4, s[12:15], s43 offen
 s_add_u32 s42, s42, 1024
 s_add_u32 s43, s43, 1024
 ds_read_b128 v[168:171], v5 offset:544
 ds_read_b128 v[172:175], v7 offset:544
 s_waitcnt vmcnt(6) lgkmcnt(2)
 v_mfma_f32_32x32x16_bf16 v[64:79], v[160:163], v[128:131], v[64:79]
 v_mfma_f32_32x32x16_bf16 v[80:95], v[164:167], v[128:131], v[80:95]
 v_mfma_f32_32x32x16_bf16 v[96:111], v[160:163], v[132:135], v[96:111]
 v_mfma_f32_32x32x16_bf16 v[112:127], v[164:167], v[132:135], v[112:127]
 v_dot2c_f32_bf16 v176, v160, v180
 v_dot2c_f32_bf16 v178, v160, v160
 v_dot2c_f32_bf16 v176, v161, v180
 v_dot2c_f32_bf16 v178, v161, v161
 v_dot2c_f32_bf16 v176, v162, v180
 v_dot2c_f32_bf16 v178, v162, v162
 v_dot2c_f32_bf16 v176, v163, v180
 v_dot2c_f32_bf16 v178, v163, v163
 v_dot2c_f32_bf16 v177, v164, v180
 v_dot2c_f32_bf16 v179, v164, v164
 v_dot2c_f32_bf16 v177, v165, v180
 v_dot2c_f32_bf16 v179, v165, v165
 v_dot2c_f32_bf16 v177, v166, v180
 v_dot2c_f32_bf16 v179, v166, v166
 v_dot2c_f32_bf16 v177, v167, v180
 v_dot2c_f32_bf16 v179, v167, v167
 buffer_load_dwordx4 v[128:131], v4, s[12:15], s42 offen
 buffer_load_dwordx4 v[132:135], v4, s[12:15], s43 offen
 s_add_u32 s42, s42, 1024
 s_add_u32 s43, s43, 1024
 ds_read_b128 v[160:163], v5 offset:576
 ds_read_b128 v[164:167], v7 offset:576
 s_waitcnt vmcnt(6) lgkmcnt(2)
 v_mfma_f32_32x32x16_bf16 v[64:79], v[168:171], v[136:139], v[64:79]
 v_mfma_f32_32x32x16_bf16 v[80:95], v[172:175], v[136:139], v[80:95]
 v_mfma_f32_32x32x16_bf16 v[96:111], v[168:171], v[140:143], v[96:111]
 v_mfma_f32_32x32x16_bf16 v[112:127], v[172:175], v[140:143], v[112:127]
 v_dot2c_f32_bf16 v176, v168, v180
 v_dot2c_f32_bf16 v178, v168, v168
 v_dot2c_f32_bf16 v176, v169, v180
 v_dot2c_f32_bf16 v178, v169, v169
 v_dot2c_f32_bf16 v176, v170, v180
 v_dot2c_f32_bf16 v178, v170, v170
 v_dot2c_f32_bf16 v176, v171, v180
 v_dot2c_f32_bf16 v178, v171, v171
 v_dot2c_f32_bf16 v177, v172, v180
 v_dot2c_f32_bf16 v179, v172, v172
 v_dot2c_f32_bf16 v177, v173, v180
 v_dot2c_f32_bf16 v179, v173, v173
 v_dot2c_f32_bf16 v177, v174, v180
 v_dot2c_f32_bf16 v179, v174, v174
 v_dot2c_f32_bf16 v177, v175, v180
 v_dot2c_f32_bf16 v179, v175, v175
 buffer_load_dwordx4 v[136:139], v4, s[12:15], s42 offen
 buffer_load_dwordx4 v[140:143], v4, s[12:15], s43 offen
 s_add_u32 s42, s42, 1024
 s_add_u32 s43, s43, 1024
 ds_read_b128 v[168:171], v5 offset:608
 ds_read_b128 v[172:175], v7 offset:608
 s_waitcnt vmcnt(6) lgkmcnt(2)
 v_mfma_f32_32x32x16_bf16 v[64:79], v[160:163], v[144:147], v[64:79]
 v_mfma_f32_32x32x16_bf16 v[80:95], v[164:167], v[144:147], v[80:95]
 v_mfma_f32_32x32x16_bf16 v[96:111], v[160:163], v[148:151], v[96:111]
 v_mfma_f32_32x32x16_bf16 v[112:127], v[164:167], v[148:151], v[112:127]
 v_dot2c_f32_bf16 v176, v160, v180
 v_dot2c_f32_bf16 v178, v160, v160
 v_dot2c_f32_bf16 v176, v161, v180
 v_dot2c_f32_bf16 v178, v161, v161
 v_dot2c_f32_bf16 v176, v162, v180
 v_dot2c_f32_bf16 v178, v162, v162
 v_dot2c_f32_bf16 v176, v163, v180
 v_dot2c_f32_bf16 v178, v163, v163
 v_dot2c_f32_bf16 v177, v164, v180
 v_dot2c_f32_bf16 v179, v164, v164
 v_dot2c_f32_bf16 v177, v165, v180
 v_dot2c_f32_bf16 v179, v165, v165
 v_dot2c_f32_bf16 v177, v166, v180
 v_dot2c_f32_bf16 v179, v166, v166
 v_dot2c_f32_bf16 v177, v167, v180
 v_dot2c_f32_bf16 v179, v167, v167
 buffer_load_dwordx4 v[144:147], v4, s[12:15], s42 offen
 buffer_load_dwordx4 v[148:151], v4, s[12:15], s43 offen
 s_add_u32 s42, s42, 1024
 s_add_u32 s43, s43, 1024
 ds_read_b128 v[160:163], v5 offset:640
 ds_read_b128 v[164:167], v7 offset:640
 s_waitcnt vmcnt(6) lgkmcnt(2)
 v_mfma_f32_32x32x16_bf16 v[64:79], v[168:171], v[152:155], v[64:79]
 v_mfma_f32_32x32x16_bf16 v[80:95], v[172:175], v[152:155], v[80:95]
 v_mfma_f32_32x32x16_bf16 v[96:111], v[168:171], v[156:159], v[96:111]
 v_mfma_f32_32x32x16_bf16 v[112:127], v[172:175], v[156:159], v[112:127]
 v_dot2c_f32_bf16 v176, v168, v180
 v_dot2c_f32_bf16 v178, v168, v168
 v_dot2c_f32_bf16 v176, v169, v180
 v_dot2c_f32_bf16 v178, v169, v169
 v_dot2c_f32_bf16 v176, v170, v180
 v_dot2c_f32_bf16 v178, v170, v170
 v_dot2c_f32_bf16 v176, v171, v180
 v_dot2c_f32_bf16 v178, v171, v171
 v_dot2c_f32_bf16 v177, v172, v180
 v_dot2c_f32_bf16 v179, v172, v172
 v_dot2c_f32_bf16 v177, v173, v180
 v_dot2c_f32_bf16 v179, v173, v173
 v_dot2c_f32_bf16 v177, v174, v180
 v_dot2c_f32_bf16 v179, v174, v174
 v_dot2c_f32_bf16 v177, v175, v180
 v_dot2c_f32_bf16 v179, v175, v175
 buffer_load_dwordx4 v[152:155], v4, s[12:15], s42 offen
 buffer_load_dwordx4 v[156:159], v4, s[12:15], s43 offen
 s_add_u32 s42, s42, 1024
 s_add_u32 s43, s43, 1024
 ds_read_b128 v[168:171], v5 offset:672
 ds_read_b128 v[172:175], v7 offset:672
 s_waitcnt vmcnt(6) lgkmcnt(2)
 v_mfma_f32_32x32x16_bf16 v[64:79], v[160:163], v[128:131], v[64:79]
 v_mfma_f32_32x32x16_bf16 v[80:95], v[164:167], v[128:131], v[80:95]
 v_mfma_f32_32x32x16_bf16 v[96:111], v[160:163], v[132:135], v[96:111]
 v_mfma_f32_32x32x16_bf16 v[112:127], v[164:167], v[132:135], v[112:127]
 v_dot2c_f32_bf16 v176, v160, v180
 v_dot2c_f32_bf16 v178, v160, v160
 v_dot2c_f32_bf16 v176, v161, v180
 v_dot2c_f32_bf16 v178, v161, v161
 v_dot2c_f32_bf16 v176, v162, v180
 v_dot2c_f32_bf16 v178, v162, v162
 v_dot2c_f32_bf16 v176, v163, v180
 v_dot2c_f32_bf16 v178, v163, v163
 v_dot2c_f32_bf16 v177, v164, v180
 v_dot2c_f32_bf16 v179, v164, v164
 v_dot2c_f32_bf16 v177, v165, v180
 v_dot2c_f32_bf16 v179, v165, v165
 v_dot2c_f32_bf16 v177, v166, v180
 v_dot2c_f32_bf16 v179, v166, v166
 v_dot2c_f32_bf16 v177, v167, v180
 v_dot2c_f32_bf16 v179, v167, v167
 buffer_load_dwordx4 v[128:131], v4, s[12:15], s42 offen
 buffer_load_dwordx4 v[132:135], v4, s[12:15], s43 offen
 s_add_u32 s42, s42, 1024
 s_add_u32 s43, s43, 1024
 ds_read_b128 v[160:163], v5 offset:704
 ds_read_b128 v[164:167], v7 offset:704
 s_waitcnt vmcnt(6) lgkmcnt(2)
 v_mfma_f32_32x32x16_bf16 v[64:79], v[168:171], v[136:139], v[64:79]
 v_mfma_f32_32x32x16_bf16 v[80:95], v[172:175], v[136:139], v[80:95]
 v_mfma_f32_32x32x16_bf16 v[96:111], v[168:171], v[140:143], v[96:111]
 v_mfma_f32_32x32x16_bf16 v[112:127], v[172:175], v[140:143], v[112:127]
 v_dot2c_f32_bf16 v176, v168, v180
 v_dot2c_f32_bf16 v178, v168, v168
 v_dot2c_f32_bf16 v176, v169, v180
 v_dot2c_f32_bf16 v178, v169, v169
 v_dot2c_f32_bf16 v176, v170, v180
 v_dot2c_f32_bf16 v178, v170, v170
 v_dot2c_f32_bf16 v176, v171, v180
 v_dot2c_f32_bf16 v178, v171, v171
 v_dot2c_f32_bf16 v177, v172, v180
 v_dot2c_f32_bf16 v179, v172, v172
 v_dot2c_f32_bf16 v177, v173, v180
 v_dot2c_f32_bf16 v179, v173, v173
 v_dot2c_f32_bf16 v177, v174, v180
 v_dot2c_f32_bf16 v179, v174, v174
 v_dot2c_f32_bf16 v177, v175, v180
 v_dot2c_f32_bf16 v179, v175, v175
 buffer_load_dwordx4 v[136:139], v4, s[12:15], s42 offen
 buffer_load_dwordx4 v[140:143], v4, s[12:15], s43 offen
 s_add_u32 s42, s42, 1024
 s_add_u32 s43, s43, 1024
 ds_read_b128 v[168:171], v5 offset:736
 ds_read_b128 v[172:175], v7 offset:736
 s_waitcnt vmcnt(6) lgkmcnt(2)
 v_mfma_f32_32x32x16_bf16 v[64:79], v[160:163], v[144:147], v[64:79]
 v_mfma_f32_32x32x16_bf16 v[80:95], v[164:167], v[144:147], v[80:95]
 v_mfma_f32_32x32x16_bf16 v[96:111], v[160:163], v[148:151], v[96:111]
 v_mfma_f32_32x32x16_bf16 v[112:127], v[164:167], v[148:151], v[112:127]
 v_dot2c_f32_bf16 v176, v160, v180
 v_dot2c_f32_bf16 v178, v160, v160
 v_dot2c_f32_bf16 v176, v161, v180
 v_dot2c_f32_bf16 v178, v161, v161
 v_dot2c_f32_bf16 v176, v162, v180
 v_dot2c_f32_bf16 v178, v162, v162
 v_dot2c_f32_bf16 v176, v163, v180
 v_dot2c_f32_bf16 v178, v163, v163
 v_dot2c_f32_bf16 v177, v164, v180
 v_dot2c_f32_bf16 v179, v164, v164
 v_dot2c_f32_bf16 v177, v165, v180
 v_dot2c_f32_bf16 v179, v165, v165
 v_dot2c_f32_bf16 v177, v166, v180
 v_dot2c_f32_bf16 v179, v166, v166
 v_dot2c_f32_bf16 v177, v167, v180
 v_dot2c_f32_bf16 v179, v167, v167
 buffer_load_dwordx4 v[144:147], v4, s[12:15], s42 offen
 buffer_load_dwordx4 v[148:151], v4, s[12:15], s43 offen
 s_add_u32 s42, s42, 1024
 s_add_u32 s43, s43, 1024
 ds_read_b128 v[160:163], v5 offset:768
 ds_read_b128 v[164:167], v7 offset:768
 s_waitcnt vmcnt(6) lgkmcnt(2)
 v_mfma_f32_32x32x16_bf16 v[64:79], v[168:171], v[152:155], v[64:79]
 v_mfma_f32_32x32x16_bf16 v[80:95], v[172:175], v[152:155], v[80:95]
 v_mfma_f32_32x32x16_bf16 v[96:111], v[168:171], v[156:159], v[96:111]
 v_mfma_f32_32x32x16_bf16 v[112:127], v[172:175], v[156:159], v[112:127]
 v_dot2c_f32_bf16 v176, v168, v180
 v_dot2c_f32_bf16 v178, v168, v168
 v_dot2c_f32_bf16 v176, v169, v180
 v_dot2c_f32_bf16 v178, v169, v169
 v_dot2c_f32_bf16 v176, v170, v180
 v_dot2c_f32_bf16 v178, v170, v170
 v_dot2c_f32_bf16 v176, v171, v180
 v_dot2c_f32_bf16 v178, v171, v171
 v_dot2c_f32_bf16 v177, v172, v180
 v_dot2c_f32_bf16 v179, v172, v172
 v_dot2c_f32_bf16 v177, v173, v180
 v_dot2c_f32_bf16 v179, v173, v173
 v_dot2c_f32_bf16 v177, v174, v180
 v_dot2c_f32_bf16 v179, v174, v174
 v_dot2c_f32_bf16 v177, v175, v180
 v_dot2c_f32_bf16 v179, v175, v175
 buffer_load_dwordx4 v[152:155], v4, s[12:15], s42 offen
 buffer_load_dwordx4 v[156:159], v4, s[12:15], s43 offen
 s_add_u32 s42, s42, 1024
 s_add_u32 s43, s43, 1024
 ds_read_b128 v[168:171], v5 offset:800
 ds_read_b128 v[172:175], v7 offset:800
 s_waitcnt vmcnt(6) lgkmcnt(2)
 v_mfma_f32_32x32x16_bf16 v[64:79], v[160:163], v[128:131], v[64:79]
 v_mfma_f32_32x32x16_bf16 v[80:95], v[164:167], v[128:131], v[80:95]
 v_mfma_f32_32x32x16_bf16 v[96:111], v[160:163], v[132:135], v[96:111]
 v_mfma_f32_32x32x16_bf16 v[112:127], v[164:167], v[132:135], v[112:127]
 v_dot2c_f32_bf16 v176, v160, v180
 v_dot2c_f32_bf16 v178, v160, v160
 v_dot2c_f32_bf16 v176, v161, v180
 v_dot2c_f32_bf16 v178, v161, v161
 v_dot2c_f32_bf16 v176, v162, v180
 v_dot2c_f32_bf16 v178, v162, v162
 v_dot2c_f32_bf16 v176, v163, v180
 v_dot2c_f32_bf16 v178, v163, v163
 v_dot2c_f32_bf16 v177, v164, v180
 v_dot2c_f32_bf16 v179, v164, v164
 v_dot2c_f32_bf16 v177, v165, v180
 v_dot2c_f32_bf16 v179, v165, v165
 v_dot2c_f32_bf16 v177, v166, v180
 v_dot2c_f32_bf16 v179, v166, v166
 v_dot2c_f32_bf16 v177, v167, v180
 v_dot2c_f32_bf16 v179, v167, v167
 buffer_load_dwordx4 v[128:131], v4, s[12:15], s42 offen
 buffer_load_dwordx4 v[132:135], v4, s[12:15], s43 offen
 s_add_u32 s42, s42, 1024
 s_add_u32 s43, s43, 1024
 ds_read_b128 v[160:163], v5 offset:832
 ds_read_b128 v[164:167], v7 offset:832
 s_waitcnt vmcnt(6) lgkmcnt(2)
 v_mfma_f32_32x32x16_bf16 v[64:79], v[168:171], v[136:139], v[64:79]
 v_mfma_f32_32x32x16_bf16 v[80:95], v[172:175], v[136:139], v[80:95]
 v_mfma_f32_32x32x16_bf16 v[96:111], v[168:171], v[140:143], v[96:111]
 v_mfma_f32_32x32x16_bf16 v[112:127], v[172:175], v[140:143], v[112:127]
 v_dot2c_f32_bf16 v176, v168, v180
 v_dot2c_f32_bf16 v178, v168, v168
 v_dot2c_f32_bf16 v176, v169, v180
 v_dot2c_f32_bf16 v178, v169, v169
 v_dot2c_f32_bf16 v176, v170, v180
 v_dot2c_f32_bf16 v178, v170, v170
 v_dot2c_f32_bf16 v176, v171, v180
 v_dot2c_f32_bf16 v178, v171, v171
 v_dot2c_f32_bf16 v177, v172, v180
 v_dot2c_f32_bf16 v179, v172, v172
 v_dot2c_f32_bf16 v177, v173, v180
 v_dot2c_f32_bf16 v179, v173, v173
 v_dot2c_f32_bf16 v177, v174, v180
 v_dot2c_f32_bf16 v179, v174, v174
 v_dot2c_f32_bf16 v177, v175, v180
 v_dot2c_f32_bf16 v179, v175, v175
 buffer_load_dwordx4 v[136:139], v4, s[12:15], s42 offen
 buffer_load_dwordx4 v[140:143], v4, s[12:15], s43 offen
 s_add_u32 s42, s42, 1024
 s_add_u32 s43, s43, 1024
 ds_read_b128 v[168:171], v5 offset:864
 ds_read_b128 v[172:175], v7 offset:864
 s_waitcnt vmcnt(6) lgkmcnt(2)
 v_mfma_f32_32x32x16_bf16 v[64:79], v[160:163], v[144:147], v[64:79]
 v_mfma_f32_32x32x16_bf16 v[80:95], v[164:167], v[144:147], v[80:95]
 v_mfma_f32_32x32x16_bf16 v[96:111], v[160:163], v[148:151], v[96:111]
 v_mfma_f32_32x32x16_bf16 v[112:127], v[164:167], v[148:151], v[112:127]
 v_dot2c_f32_bf16 v176, v160, v180
 v_dot2c_f32_bf16 v178, v160, v160
 v_dot2c_f32_bf16 v176, v161, v180
 v_dot2c_f32_bf16 v178, v161, v161
 v_dot2c_f32_bf16 v176, v162, v180
 v_dot2c_f32_bf16 v178, v162, v162
 v_dot2c_f32_bf16 v176, v163, v180
 v_dot2c_f32_bf16 v178, v163, v163
 v_dot2c_f32_bf16 v177, v164, v180
 v_dot2c_f32_bf16 v179, v164, v164
 v_dot2c_f32_bf16 v177, v165, v180
 v_dot2c_f32_bf16 v179, v165, v165
 v_dot2c_f32_bf16 v177, v166, v180
 v_dot2c_f32_bf16 v179, v166, v166
 v_dot2c_f32_bf16 v177, v167, v180
 v_dot2c_f32_bf16 v179, v167, v167
 buffer_load_dwordx4 v[144:147], v4, s[12:15], s42 offen
 buffer_load_dwordx4 v[148:151], v4, s[12:15], s43 offen
 s_add_u32 s42, s42, 1024
 s_add_u32 s43, s43, 1024
 ds_read_b128 v[160:163], v5 offset:896
 ds_read_b128 v[164:167], v7 offset:896
 s_waitcnt vmcnt(6) lgkmcnt(2)
 v_mfma_f32_32x32x16_bf16 v[64:79], v[168:171], v[152:155], v[64:79]
 v_mfma_f32_32x32x16_bf16 v[80:95], v[172:175], v[152:155], v[80:95]
 v_mfma_f32_32x32x16_bf16 v[96:111], v[168:171], v[156:159], v[96:111]
 v_mfma_f32_32x32x16_bf16 v[112:127], v[172:175], v[156:159], v[112:127]
 v_dot2c_f32_bf16 v176, v168, v180
 v_dot2c_f32_bf16 v178, v168, v168
 v_dot2c_f32_bf16 v176, v169, v180
 v_dot2c_f32_bf16 v178, v169, v169
 v_dot2c_f32_bf16 v176, v170, v180
 v_dot2c_f32_bf16 v178, v170, v170
 v_dot2c_f32_bf16 v176, v171, v180
 v_dot2c_f32_bf16 v178, v171, v171
 v_dot2c_f32_bf16 v177, v172, v180
 v_dot2c_f32_bf16 v179, v172, v172
 v_dot2c_f32_bf16 v177, v173, v180
 v_dot2c_f32_bf16 v179, v173, v173
 v_dot2c_f32_bf16 v177, v174, v180
 v_dot2c_f32_bf16 v179, v174, v174
 v_dot2c_f32_bf16 v177, v175, v180
 v_dot2c_f32_bf16 v179, v175, v175
 buffer_load_dwordx4 v[152:155], v4, s[12:15], s42 offen
 buffer_load_dwordx4 v[156:159], v4, s[12:15], s43 offen
 s_add_u32 s42, s42, 1024
 s_add_u32 s43, s43, 1024
 ds_read_b128 v[168:171], v5 offset:928
 ds_read_b128 v[172:175], v7 offset:928
 s_waitcnt vmcnt(6) lgkmcnt(2)
 v_mfma_f32_32x32x16_bf16 v[64:79], v[160:163], v[128:131], v[64:79]
 v_mfma_f32_32x32x16_bf16 v[80:95], v[164:167], v[128:131], v[80:95]
 v_mfma_f32_32x32x16_bf16 v[96:111], v[160:163], v[132:135], v[96:111]
 v_mfma_f32_32x32x16_bf16 v[112:127], v[164:167], v[132:135], v[112:127]
 v_dot2c_f32_bf16 v176, v160, v180
 v_dot2c_f32_bf16 v178, v160, v160
 v_dot2c_f32_bf16 v176, v161, v180
 v_dot2c_f32_bf16 v178, v161, v161
 v_dot2c_f32_bf16 v176, v162, v180
 v_dot2c_f32_bf16 v178, v162, v162
 v_dot2c_f32_bf16 v176, v163, v180
 v_dot2c_f32_bf16 v178, v163, v163
 v_dot2c_f32_bf16 v177, v164, v180
 v_dot2c_f32_bf16 v179, v164, v164
 v_dot2c_f32_bf16 v177, v165, v180
 v_dot2c_f32_bf16 v179, v165, v165
 v_dot2c_f32_bf16 v177, v166, v180
 v_dot2c_f32_bf16 v179, v166, v166
 v_dot2c_f32_bf16 v177, v167, v180
 v_dot2c_f32_bf16 v179, v167, v167
 buffer_load_dwordx4 v[128:131], v4, s[12:15], s42 offen
 buffer_load_dwordx4 v[132:135], v4, s[12:15], s43 offen
 s_add_u32 s42, s42, 1024
 s_add_u32 s43, s43, 1024
 ds_read_b128 v[160:163], v5 offset:960
 ds_read_b128 v[164:167], v7 offset:960
 s_waitcnt vmcnt(6) lgkmcnt(2)
 v_mfma_f32_32x32x16_bf16 v[64:79], v[168:171], v[136:139], v[64:79]
 v_mfma_f32_32x32x16_bf16 v[80:95], v[172:175], v[136:139], v[80:95]
 v_mfma_f32_32x32x16_bf16 v[96:111], v[168:171], v[140:143], v[96:111]
 v_mfma_f32_32x32x16_bf16 v[112:127], v[172:175], v[140:143], v[112:127]
 v_dot2c_f32_bf16 v176, v168, v180
 v_dot2c_f32_bf16 v178, v168, v168
 v_dot2c_f32_bf16 v176, v169, v180
 v_dot2c_f32_bf16 v178, v169, v169
 v_dot2c_f32_bf16 v176, v170, v180
 v_dot2c_f32_bf16 v178, v170, v170
 v_dot2c_f32_bf16 v176, v171, v180
 v_dot2c_f32_bf16 v178, v171, v171
 v_dot2c_f32_bf16 v177, v172, v180
 v_dot2c_f32_bf16 v179, v172, v172
 v_dot2c_f32_bf16 v177, v173, v180
 v_dot2c_f32_bf16 v179, v173, v173
 v_dot2c_f32_bf16 v177, v174, v180
 v_dot2c_f32_bf16 v179, v174, v174
 v_dot2c_f32_bf16 v177, v175, v180
 v_dot2c_f32_bf16 v179, v175, v175
 buffer_load_dwordx4 v[136:139], v4, s[12:15], s42 offen
 buffer_load_dwordx4 v[140:143], v4, s[12:15], s43 offen
 s_add_u32 s42, s42, 1024
 s_add_u32 s43, s43, 1024
 ds_read_b128 v[168:171], v5 offset:992
 ds_read_b128 v[172:175], v7 offset:992
 s_waitcnt vmcnt(6) lgkmcnt(2)
 v_mfma_f32_32x32x16_bf16 v[64:79], v[160:163], v[144:147], v[64:79]
 v_mfma_f32_32x32x16_bf16 v[80:95], v[164:167], v[144:147], v[80:95]
 v_mfma_f32_32x32x16_bf16 v[96:111], v[160:163], v[148:151], v[96:111]
 v_mfma_f32_32x32x16_bf16 v[112:127], v[164:167], v[148:151], v[112:127]
 v_dot2c_f32_bf16 v176, v160, v180
 v_dot2c_f32_bf16 v178, v160, v160
 v_dot2c_f32_bf16 v176, v161, v180
 v_dot2c_f32_bf16 v178, v161, v161
 v_dot2c_f32_bf16 v176, v162, v180
 v_dot2c_f32_bf16 v178, v162, v162
 v_dot2c_f32_bf16 v176, v163, v180
 v_dot2c_f32_bf16 v178, v163, v163
 v_dot2c_f32_bf16 v177, v164, v180
 v_dot2c_f32_bf16 v179, v164, v164
 v_dot2c_f32_bf16 v177, v165, v180
 v_dot2c_f32_bf16 v179, v165, v165
 v_dot2c_f32_bf16 v177, v166, v180
 v_dot2c_f32_bf16 v179, v166, v166
 v_dot2c_f32_bf16 v177, v167, v180
 v_dot2c_f32_bf16 v179, v167, v167
 buffer_load_dwordx4 v[144:147], v4, s[12:15], s42 offen
 buffer_load_dwordx4 v[148:151], v4, s[12:15], s43 offen
 s_add_u32 s42, s42, 1024
 s_add_u32 s43, s43, 1024
 ds_read_b128 v[160:163], v5 offset:1024
 ds_read_b128 v[164:167], v7 offset:1024
 s_waitcnt vmcnt(6) lgkmcnt(2)
 v_mfma_f32_32x32x16_bf16 v[64:79], v[168:171], v[152:155], v[64:79]
 v_mfma_f32_32x32x16_bf16 v[80:95], v[172:175], v[152:155], v[80:95]
 v_mfma_f32_32x32x16_bf16 v[96:111], v[168:171], v[156:159], v[96:111]
 v_mfma_f32_32x32x16_bf16 v[112:127], v[172:175], v[156:159], v[112:127]
 v_dot2c_f32_bf16 v176, v168, v180
 v_dot2c_f32_bf16 v178, v168, v168
 v_dot2c_f32_bf16 v176, v169, v180
 v_dot2c_f32_bf16 v178, v169, v169
 v_dot2c_f32_bf16 v176, v170, v180
 v_dot2c_f32_bf16 v178, v170, v170
 v_dot2c_f32_bf16 v176, v171, v180
 v_dot2c_f32_bf16 v178, v171, v171
 v_dot2c_f32_bf16 v177, v172, v180
 v_dot2c_f32_bf16 v179, v172, v172
 v_dot2c_f32_bf16 v177, v173, v180
 v_dot2c_f32_bf16 v179, v173, v173
 v_dot2c_f32_bf16 v177, v174, v180
 v_dot2c_f32_bf16 v179, v174, v174
 v_dot2c_f32_bf16 v177, v175, v180
 v_dot2c_f32_bf16 v179, v175, v175
 buffer_load_dwordx4 v[152:155], v4, s[12:15], s42 offen
 buffer_load_dwordx4 v[156:159], v4, s[12:15], s43 offen
 s_add_u32 s42, s42, 1024
 s_add_u32 s43, s43, 1024
 ds_read_b128 v[168:171], v5 offset:1056
 ds_read_b128 v[172:175], v7 offset:1056
 s_waitcnt vmcnt(6) lgkmcnt(2)
 v_mfma_f32_32x32x16_bf16 v[64:79], v[160:163], v[128:131], v[64:79]
 v_mfma_f32_32x32x16_bf16 v[80:95], v[164:167], v[128:131], v[80:95]
 v_mfma_f32_32x32x16_bf16 v[96:111], v[160:163], v[132:135], v[96:111]
 v_mfma_f32_32x32x16_bf16 v[112:127], v[164:167], v[132:135], v[112:127]
 v_dot2c_f32_bf16 v176, v160, v180
 v_dot2c_f32_bf16 v178, v160, v160
 v_dot2c_f32_bf16 v176, v161, v180
 v_dot2c_f32_bf16 v178, v161, v161
 v_dot2c_f32_bf16 v176, v162, v180
 v_dot2c_f32_bf16 v178, v162, v162
 v_dot2c_f32_bf16 v176, v163, v180
 v_dot2c_f32_bf16 v178, v163, v163
 v_dot2c_f32_bf16 v177, v164, v180
 v_dot2c_f32_bf16 v179, v164, v164
 v_dot2c_f32_bf16 v177, v165, v180
 v_dot2c_f32_bf16 v179, v165, v165
 v_dot2c_f32_bf16 v177, v166, v180
 v_dot2c_f32_bf16 v179, v166, v166
 v_dot2c_f32_bf16 v177, v167, v180
 v_dot2c_f32_bf16 v179, v167, v167
 buffer_load_dwordx4 v[128:131], v4, s[12:15], s42 offen
 buffer_load_dwordx4 v[132:135], v4, s[12:15], s43 offen
 s_add_u32 s42, s42, 1024
 s_add_u32 s43, s43, 1024
 ds_read_b128 v[160:163], v5 offset:1088
 ds_read_b128 v[164:167], v7 offset:1088
 s_waitcnt vmcnt(6) lgkmcnt(2)
 v_mfma_f32_32x32x16_bf16 v[64:79], v[168:171], v[136:139], v[64:79]
 v_mfma_f32_32x32x16_bf16 v[80:95], v[172:175], v[136:139], v[80:95]
 v_mfma_f32_32x32x16_bf16 v[96:111], v[168:171], v[140:143], v[96:111]
 v_mfma_f32_32x32x16_bf16 v[112:127], v[172:175], v[140:143], v[112:127]
 v_dot2c_f32_bf16 v176, v168, v180
 v_dot2c_f32_bf16 v178, v168, v168
 v_dot2c_f32_bf16 v176, v169, v180
 v_dot2c_f32_bf16 v178, v169, v169
 v_dot2c_f32_bf16 v176, v170, v180
 v_dot2c_f32_bf16 v178, v170, v170
 v_dot2c_f32_bf16 v176, v171, v180
 v_dot2c_f32_bf16 v178, v171, v171
 v_dot2c_f32_bf16 v177, v172, v180
 v_dot2c_f32_bf16 v179, v172, v172
 v_dot2c_f32_bf16 v177, v173, v180
 v_dot2c_f32_bf16 v179, v173, v173
 v_dot2c_f32_bf16 v177, v174, v180
 v_dot2c_f32_bf16 v179, v174, v174
 v_dot2c_f32_bf16 v177, v175, v180
 v_dot2c_f32_bf16 v179, v175, v175
 buffer_load_dwordx4 v[136:139], v4, s[12:15], s42 offen
 buffer_load_dwordx4 v[140:143], v4, s[12:15], s43 offen
 s_add_u32 s42, s42, 1024
 s_add_u32 s43, s43, 1024
 ds_read_b128 v[168:171], v5 offset:1120
 ds_read_b128 v[172:175], v7 offset:1120
 s_waitcnt vmcnt(6) lgkmcnt(2)
 v_mfma_f32_32x32x16_bf16 v[64:79], v[160:163], v[144:147], v[64:79]
 v_mfma_f32_32x32x16_bf16 v[80:95], v[164:167], v[144:147], v[80:95]
 v_mfma_f32_32x32x16_bf16 v[96:111], v[160:163], v[148:151], v[96:111]
 v_mfma_f32_32x32x16_bf16 v[112:127], v[164:167], v[148:151], v[112:127]
 v_dot2c_f32_bf16 v176, v160, v180
 v_dot2c_f32_bf16 v178, v160, v160
 v_dot2c_f32_bf16 v176, v161, v180
 v_dot2c_f32_bf16 v178, v161, v161
 v_dot2c_f32_bf16 v176, v162, v180
 v_dot2c_f32_bf16 v178, v162, v162
 v_dot2c_f32_bf16 v176, v163, v180
 v_dot2c_f32_bf16 v178, v163, v163
 v_dot2c_f32_bf16 v177, v164, v180
 v_dot2c_f32_bf16 v179, v164, v164
 v_dot2c_f32_bf16 v177, v165, v180
 v_dot2c_f32_bf16 v179, v165, v165
 v_dot2c_f32_bf16 v177, v166, v180
 v_dot2c_f32_bf16 v179, v166, v166
 v_dot2c_f32_bf16 v177, v167, v180
 v_dot2c_f32_bf16 v179, v167, v167
 buffer_load_dwordx4 v[144:147], v4, s[12:15], s42 offen
 buffer_load_dwordx4 v[148:151], v4, s[12:15], s43 offen
 s_add_u32 s42, s42, 1024
 s_add_u32 s43, s43, 1024
 ds_read_b128 v[160:163], v5 offset:1152
 ds_read_b128 v[164:167], v7 offset:1152
 s_waitcnt vmcnt(6) lgkmcnt(2)
 v_mfma_f32_32x32x16_bf16 v[64:79], v[168:171], v[152:155], v[64:79]
 v_mfma_f32_32x32x16_bf16 v[80:95], v[172:175], v[152:155], v[80:95]
 v_mfma_f32_32x32x16_bf16 v[96:111], v[168:171], v[156:159], v[96:111]
 v_mfma_f32_32x32x16_bf16 v[112:127], v[172:175], v[156:159], v[112:127]
 v_dot2c_f32_bf16 v176, v168, v180
 v_dot2c_f32_bf16 v178, v168, v168
 v_dot2c_f32_bf16 v176, v169, v180
 v_dot2c_f32_bf16 v178, v169, v169
 v_dot2c_f32_bf16 v176, v170, v180
 v_dot2c_f32_bf16 v178, v170, v170
 v_dot2c_f32_bf16 v176, v171, v180
 v_dot2c_f32_bf16 v178, v171, v171
 v_dot2c_f32_bf16 v177, v172, v180
 v_dot2c_f32_bf16 v179, v172, v172
 v_dot2c_f32_bf16 v177, v173, v180
 v_dot2c_f32_bf16 v179, v173, v173
 v_dot2c_f32_bf16 v177, v174, v180
 v_dot2c_f32_bf16 v179, v174, v174
 v_dot2c_f32_bf16 v177, v175, v180
 v_dot2c_f32_bf16 v179, v175, v175
 buffer_load_dwordx4 v[152:155], v4, s[12:15], s42 offen
 buffer_load_dwordx4 v[156:159], v4, s[12:15], s43 offen
 s_add_u32 s42, s42, 1024
 s_add_u32 s43, s43, 1024
 ds_read_b128 v[168:171], v5 offset:1184
 ds_read_b128 v[172:175], v7 offset:1184
 s_waitcnt vmcnt(6) lgkmcnt(2)
 v_mfma_f32_32x32x16_bf16 v[64:79], v[160:163], v[128:131], v[64:79]
 v_mfma_f32_32x32x16_bf16 v[80:95], v[164:167], v[128:131], v[80:95]
 v_mfma_f32_32x32x16_bf16 v[96:111], v[160:163], v[132:135], v[96:111]
 v_mfma_f32_32x32x16_bf16 v[112:127], v[164:167], v[132:135], v[112:127]
 v_dot2c_f32_bf16 v176, v160, v180
 v_dot2c_f32_bf16 v178, v160, v160
 v_dot2c_f32_bf16 v176, v161, v180
 v_dot2c_f32_bf16 v178, v161, v161
 v_dot2c_f32_bf16 v176, v162, v180
 v_dot2c_f32_bf16 v178, v162, v162
 v_dot2c_f32_bf16 v176, v163, v180
 v_dot2c_f32_bf16 v178, v163, v163
 v_dot2c_f32_bf16 v177, v164, v180
 v_dot2c_f32_bf16 v179, v164, v164
 v_dot2c_f32_bf16 v177, v165, v180
 v_dot2c_f32_bf16 v179, v165, v165
 v_dot2c_f32_bf16 v177, v166, v180
 v_dot2c_f32_bf16 v179, v166, v166
 v_dot2c_f32_bf16 v177, v167, v180
 v_dot2c_f32_bf16 v179, v167, v167
 ds_read_b128 v[160:163], v5 offset:1216
 ds_read_b128 v[164:167], v7 offset:1216
 s_waitcnt vmcnt(4) lgkmcnt(2)
 v_mfma_f32_32x32x16_bf16 v[64:79], v[168:171], v[136:139], v[64:79]
 v_mfma_f32_32x32x16_bf16 v[80:95], v[172:175], v[136:139], v[80:95]
 v_mfma_f32_32x32x16_bf16 v[96:111], v[168:171], v[140:143], v[96:111]
 v_mfma_f32_32x32x16_bf16 v[112:127], v[172:175], v[140:143], v[112:127]
 v_dot2c_f32_bf16 v176, v168, v180
 v_dot2c_f32_bf16 v178, v168, v168
 v_dot2c_f32_bf16 v176, v169, v180
 v_dot2c_f32_bf16 v178, v169, v169
 v_dot2c_f32_bf16 v176, v170, v180
 v_dot2c_f32_bf16 v178, v170, v170
 v_dot2c_f32_bf16 v176, v171, v180
 v_dot2c_f32_bf16 v178, v171, v171
 v_dot2c_f32_bf16 v177, v172, v180
 v_dot2c_f32_bf16 v179, v172, v172
 v_dot2c_f32_bf16 v177, v173, v180
 v_dot2c_f32_bf16 v179, v173, v173
 v_dot2c_f32_bf16 v177, v174, v180
 v_dot2c_f32_bf16 v179, v174, v174
 v_dot2c_f32_bf16 v177, v175, v180
 v_dot2c_f32_bf16 v179, v175, v175
 ds_read_b128 v[168:171], v5 offset:1248
 ds_read_b128 v[172:175], v7 offset:1248
 s_waitcnt vmcnt(2) lgkmcnt(2)
 v_mfma_f32_32x32x16_bf16 v[64:79], v[160:163], v[144:147], v[64:79]
 v_mfma_f32_32x32x16_bf16 v[80:95], v[164:167], v[144:147], v[80:95]
 v_mfma_f32_32x32x16_bf16 v[96:111], v[160:163], v[148:151], v[96:111]
 v_mfma_f32_32x32x16_bf16 v[112:127], v[164:167], v[148:151], v[112:127]
 v_dot2c_f32_bf16 v176, v160, v180
 v_dot2c_f32_bf16 v178, v160, v160
 v_dot2c_f32_bf16 v176, v161, v180
 v_dot2c_f32_bf16 v178, v161, v161
 v_dot2c_f32_bf16 v176, v162, v180
 v_dot2c_f32_bf16 v178, v162, v162
 v_dot2c_f32_bf16 v176, v163, v180
 v_dot2c_f32_bf16 v178, v163, v163
 v_dot2c_f32_bf16 v177, v164, v180
 v_dot2c_f32_bf16 v179, v164, v164
 v_dot2c_f32_bf16 v177, v165, v180
 v_dot2c_f32_bf16 v179, v165, v165
 v_dot2c_f32_bf16 v177, v166, v180
 v_dot2c_f32_bf16 v179, v166, v166
 v_dot2c_f32_bf16 v177, v167, v180
 v_dot2c_f32_bf16 v179, v167, v167
 s_waitcnt vmcnt(0) lgkmcnt(0)
 v_mfma_f32_32x32x16_bf16 v[64:79], v[168:171], v[152:155], v[64:79]
 v_mfma_f32_32x32x16_bf16 v[80:95], v[172:175], v[152:155], v[80:95]
 v_mfma_f32_32x32x16_bf16 v[96:111], v[168:171], v[156:159], v[96:111]
 v_mfma_f32_32x32x16_bf16 v[112:127], v[172:175], v[156:159], v[112:127]
 v_dot2c_f32_bf16 v176, v168, v180
 v_dot2c_f32_bf16 v178, v168, v168
 v_dot2c_f32_bf16 v176, v169, v180
 v_dot2c_f32_bf16 v178, v169, v169
 v_dot2c_f32_bf16 v176, v170, v180
 v_dot2c_f32_bf16 v178, v170, v170
 v_dot2c_f32_bf16 v176, v171, v180
 v_dot2c_f32_bf16 v178, v171, v171
 v_dot2c_f32_bf16 v177, v172, v180
 v_dot2c_f32_bf16 v179, v172, v172
 v_dot2c_f32_bf16 v177, v173, v180
 v_dot2c_f32_bf16 v179, v173, v173
 v_dot2c_f32_bf16 v177, v174, v180
 v_dot2c_f32_bf16 v179, v174, v174
 v_dot2c_f32_bf16 v177, v175, v180
 v_dot2c_f32_bf16 v179, v175, v175
 s_nop 11
 v_mov_b32 v186, v176
 s_nop 1
 v_permlane32_swap_b32 v176, v186
 v_add_f32 v176, v176, v186
 v_mov_b32 v186, v177
 s_nop 1
 v_permlane32_swap_b32 v177, v186
 v_add_f32 v177, v177, v186
 v_mov_b32 v186, v178
 s_nop 1
 v_permlane32_swap_b32 v178, v186
 v_add_f32 v178, v178, v186
 v_mov_b32 v186, v179
 s_nop 1
 v_permlane32_swap_b32 v179, v186
 v_add_f32 v179, v179, v186
 s_mov_b32 s44, 0x3acccccd
 s_mov_b32 s45, 0x3727c5ac
 v_mul_f32 v186, s44, v176
 v_mul_f32 v187, s44, v178
 v_fma_f32 v187, -v186, v186, v187
 v_add_f32 v187, s45, v187
 v_rsq_f32 v181, v187
 s_nop 0
 v_mul_f32 v183, v181, v186
 v_mul_f32 v186, s44, v177
 v_mul_f32 v187, s44, v179
 v_fma_f32 v187, -v186, v186, v187
 v_add_f32 v187, s45, v187
 v_rsq_f32 v182, v187
 s_nop 0
 v_mul_f32 v184, v182, v186
 s_add_u32 s49, s40, -40
 s_lshl_b32 s46, s34, 9
 s_add_u32 s46, s46, 82944
 v_and_b32 v9, 31, v0
 v_lshlrev_b32 v10, 2, v9
 v_add_u32 v10, s46, v10
 ds_write_b32 v10, v181 offset:0
 ds_write_b32 v10, v183 offset:128
 ds_write_b32 v10, v182 offset:256
 ds_write_b32 v10, v184 offset:384
 s_lshl_b32 s47, s49, 5
 v_add_u32 v10, s47, v9
 v_add_u32 v11, 1280, v10
 v_lshlrev_b32 v11, 2, v11
 buffer_load_dword v12, v11, s[16:19], 0 offen
 v_mul_u32_u24 v11, 3277, v10
 v_lshrrev_b32 v11, 16, v11
 v_mul_u32_u24 v13, 20, v11
 v_sub_u32 v13, v10, v13
 v_lshlrev_b32 v11, 17, v11
 v_lshl_add_u32 v11, v13, 4, v11
 v_bfe_u32 v13, v0, 5, 1
 v_lshl_add_u32 v11, v13, 9, v11
 v_lshlrev_b32 v13, 4, v13
 v_add_u32 v13, s46, v13
 s_waitcnt lgkmcnt(0)
 ds_read_b128 v[16:19], v13 offset:0
 ds_read_b128 v[20:23], v13 offset:128
 ds_read_b128 v[24:27], v13 offset:32
 ds_read_b128 v[28:31], v13 offset:160
 ds_read_b128 v[32:35], v13 offset:64
 ds_read_b128 v[36:39], v13 offset:192
 ds_read_b128 v[40:43], v13 offset:96
 ds_read_b128 v[44:47], v13 offset:224
 s_lshl_b32 s48, s32, 1
 s_add_u32 s48, s48, 0
 s_lshl_b32 s48, s48, 11
 s_waitcnt vmcnt(0)
 s_waitcnt lgkmcnt(6)
 v_mul_f32 v48, v20, v12
 v_fma_f32 v64, v16, v64, -v48
 v_mul_f32 v48, v21, v12
 v_fma_f32 v65, v17, v65, -v48
 v_mul_f32 v48, v22, v12
 v_fma_f32 v66, v18, v66, -v48
 v_mul_f32 v48, v23, v12
 v_fma_f32 v67, v19, v67, -v48
 s_waitcnt lgkmcnt(4)
 v_mul_f32 v48, v28, v12
 v_fma_f32 v68, v24, v68, -v48
 v_mul_f32 v48, v29, v12
 v_fma_f32 v69, v25, v69, -v48
 v_mul_f32 v48, v30, v12
 v_fma_f32 v70, v26, v70, -v48
 v_mul_f32 v48, v31, v12
 v_fma_f32 v71, v27, v71, -v48
 s_waitcnt lgkmcnt(2)
 v_mul_f32 v48, v36, v12
 v_fma_f32 v72, v32, v72, -v48
 v_mul_f32 v48, v37, v12
 v_fma_f32 v73, v33, v73, -v48
 v_mul_f32 v48, v38, v12
 v_fma_f32 v74, v34, v74, -v48
 v_mul_f32 v48, v39, v12
 v_fma_f32 v75, v35, v75, -v48
 s_waitcnt lgkmcnt(0)
 v_mul_f32 v48, v44, v12
 v_fma_f32 v76, v40, v76, -v48
 v_mul_f32 v48, v45, v12
 v_fma_f32 v77, v41, v77, -v48
 v_mul_f32 v48, v46, v12
 v_fma_f32 v78, v42, v78, -v48
 v_mul_f32 v48, v47, v12
 v_fma_f32 v79, v43, v79, -v48
 v_cvt_pk_bf16_f32 v50, v64, v65
 v_cvt_pk_bf16_f32 v51, v66, v67
 v_cvt_pk_bf16_f32 v52, v68, v69
 v_cvt_pk_bf16_f32 v53, v70, v71
 v_cvt_pk_bf16_f32 v54, v72, v73
 v_cvt_pk_bf16_f32 v55, v74, v75
 v_cvt_pk_bf16_f32 v56, v76, v77
 v_cvt_pk_bf16_f32 v57, v78, v79
 buffer_store_dwordx4 v[50:53], v11, s[28:31], s48 offen
 buffer_store_dwordx4 v[54:57], v11, s[28:31], s48 offen offset:1024
 ds_read_b128 v[16:19], v13 offset:256
 ds_read_b128 v[20:23], v13 offset:384
 ds_read_b128 v[24:27], v13 offset:288
 ds_read_b128 v[28:31], v13 offset:416
 ds_read_b128 v[32:35], v13 offset:320
 ds_read_b128 v[36:39], v13 offset:448
 ds_read_b128 v[40:43], v13 offset:352
 ds_read_b128 v[44:47], v13 offset:480
 s_lshl_b32 s48, s32, 1
 s_add_u32 s48, s48, 1
 s_lshl_b32 s48, s48, 11
 s_waitcnt lgkmcnt(6)
 v_mul_f32 v48, v20, v12
 v_fma_f32 v80, v16, v80, -v48
 v_mul_f32 v48, v21, v12
 v_fma_f32 v81, v17, v81, -v48
 v_mul_f32 v48, v22, v12
 v_fma_f32 v82, v18, v82, -v48
 v_mul_f32 v48, v23, v12
 v_fma_f32 v83, v19, v83, -v48
 s_waitcnt lgkmcnt(4)
 v_mul_f32 v48, v28, v12
 v_fma_f32 v84, v24, v84, -v48
 v_mul_f32 v48, v29, v12
 v_fma_f32 v85, v25, v85, -v48
 v_mul_f32 v48, v30, v12
 v_fma_f32 v86, v26, v86, -v48
 v_mul_f32 v48, v31, v12
 v_fma_f32 v87, v27, v87, -v48
 s_waitcnt lgkmcnt(2)
 v_mul_f32 v48, v36, v12
 v_fma_f32 v88, v32, v88, -v48
 v_mul_f32 v48, v37, v12
 v_fma_f32 v89, v33, v89, -v48
 v_mul_f32 v48, v38, v12
 v_fma_f32 v90, v34, v90, -v48
 v_mul_f32 v48, v39, v12
 v_fma_f32 v91, v35, v91, -v48
 s_waitcnt lgkmcnt(0)
 v_mul_f32 v48, v44, v12
 v_fma_f32 v92, v40, v92, -v48
 v_mul_f32 v48, v45, v12
 v_fma_f32 v93, v41, v93, -v48
 v_mul_f32 v48, v46, v12
 v_fma_f32 v94, v42, v94, -v48
 v_mul_f32 v48, v47, v12
 v_fma_f32 v95, v43, v95, -v48
 v_cvt_pk_bf16_f32 v50, v80, v81
 v_cvt_pk_bf16_f32 v51, v82, v83
 v_cvt_pk_bf16_f32 v52, v84, v85
 v_cvt_pk_bf16_f32 v53, v86, v87
 v_cvt_pk_bf16_f32 v54, v88, v89
 v_cvt_pk_bf16_f32 v55, v90, v91
 v_cvt_pk_bf16_f32 v56, v92, v93
 v_cvt_pk_bf16_f32 v57, v94, v95
 buffer_store_dwordx4 v[50:53], v11, s[28:31], s48 offen
 buffer_store_dwordx4 v[54:57], v11, s[28:31], s48 offen offset:1024
 s_add_u32 s49, s40, -39
 s_lshl_b32 s46, s34, 9
 s_add_u32 s46, s46, 82944
 v_and_b32 v9, 31, v0
 v_lshlrev_b32 v10, 2, v9
 v_add_u32 v10, s46, v10
 ds_write_b32 v10, v181 offset:0
 ds_write_b32 v10, v183 offset:128
 ds_write_b32 v10, v182 offset:256
 ds_write_b32 v10, v184 offset:384
 s_lshl_b32 s47, s49, 5
 v_add_u32 v10, s47, v9
 v_add_u32 v11, 1280, v10
 v_lshlrev_b32 v11, 2, v11
 buffer_load_dword v12, v11, s[16:19], 0 offen
 v_mul_u32_u24 v11, 3277, v10
 v_lshrrev_b32 v11, 16, v11
 v_mul_u32_u24 v13, 20, v11
 v_sub_u32 v13, v10, v13
 v_lshlrev_b32 v11, 17, v11
 v_lshl_add_u32 v11, v13, 4, v11
 v_bfe_u32 v13, v0, 5, 1
 v_lshl_add_u32 v11, v13, 9, v11
 v_lshlrev_b32 v13, 4, v13
 v_add_u32 v13, s46, v13
 s_waitcnt lgkmcnt(0)
 ds_read_b128 v[16:19], v13 offset:0
 ds_read_b128 v[20:23], v13 offset:128
 ds_read_b128 v[24:27], v13 offset:32
 ds_read_b128 v[28:31], v13 offset:160
 ds_read_b128 v[32:35], v13 offset:64
 ds_read_b128 v[36:39], v13 offset:192
 ds_read_b128 v[40:43], v13 offset:96
 ds_read_b128 v[44:47], v13 offset:224
 s_lshl_b32 s48, s32, 1
 s_add_u32 s48, s48, 0
 s_lshl_b32 s48, s48, 11
 s_waitcnt vmcnt(0)
 s_waitcnt lgkmcnt(6)
 v_mul_f32 v48, v20, v12
 v_fma_f32 v96, v16, v96, -v48
 v_mul_f32 v48, v21, v12
 v_fma_f32 v97, v17, v97, -v48
 v_mul_f32 v48, v22, v12
 v_fma_f32 v98, v18, v98, -v48
 v_mul_f32 v48, v23, v12
 v_fma_f32 v99, v19, v99, -v48
 s_waitcnt lgkmcnt(4)
 v_mul_f32 v48, v28, v12
 v_fma_f32 v100, v24, v100, -v48
 v_mul_f32 v48, v29, v12
 v_fma_f32 v101, v25, v101, -v48
 v_mul_f32 v48, v30, v12
 v_fma_f32 v102, v26, v102, -v48
 v_mul_f32 v48, v31, v12
 v_fma_f32 v103, v27, v103, -v48
 s_waitcnt lgkmcnt(2)
 v_mul_f32 v48, v36, v12
 v_fma_f32 v104, v32, v104, -v48
 v_mul_f32 v48, v37, v12
 v_fma_f32 v105, v33, v105, -v48
 v_mul_f32 v48, v38, v12
 v_fma_f32 v106, v34, v106, -v48
 v_mul_f32 v48, v39, v12
 v_fma_f32 v107, v35, v107, -v48
 s_waitcnt lgkmcnt(0)
 v_mul_f32 v48, v44, v12
 v_fma_f32 v108, v40, v108, -v48
 v_mul_f32 v48, v45, v12
 v_fma_f32 v109, v41, v109, -v48
 v_mul_f32 v48, v46, v12
 v_fma_f32 v110, v42, v110, -v48
 v_mul_f32 v48, v47, v12
 v_fma_f32 v111, v43, v111, -v48
 v_cvt_pk_bf16_f32 v50, v96, v97
 v_cvt_pk_bf16_f32 v51, v98, v99
 v_cvt_pk_bf16_f32 v52, v100, v101
 v_cvt_pk_bf16_f32 v53, v102, v103
 v_cvt_pk_bf16_f32 v54, v104, v105
 v_cvt_pk_bf16_f32 v55, v106, v107
 v_cvt_pk_bf16_f32 v56, v108, v109
 v_cvt_pk_bf16_f32 v57, v110, v111
 buffer_store_dwordx4 v[50:53], v11, s[28:31], s48 offen
 buffer_store_dwordx4 v[54:57], v11, s[28:31], s48 offen offset:1024
 ds_read_b128 v[16:19], v13 offset:256
 ds_read_b128 v[20:23], v13 offset:384
 ds_read_b128 v[24:27], v13 offset:288
 ds_read_b128 v[28:31], v13 offset:416
 ds_read_b128 v[32:35], v13 offset:320
 ds_read_b128 v[36:39], v13 offset:448
 ds_read_b128 v[40:43], v13 offset:352
 ds_read_b128 v[44:47], v13 offset:480
 s_lshl_b32 s48, s32, 1
 s_add_u32 s48, s48, 1
 s_lshl_b32 s48, s48, 11
 s_waitcnt lgkmcnt(6)
 v_mul_f32 v48, v20, v12
 v_fma_f32 v112, v16, v112, -v48
 v_mul_f32 v48, v21, v12
 v_fma_f32 v113, v17, v113, -v48
 v_mul_f32 v48, v22, v12
 v_fma_f32 v114, v18, v114, -v48
 v_mul_f32 v48, v23, v12
 v_fma_f32 v115, v19, v115, -v48
 s_waitcnt lgkmcnt(4)
 v_mul_f32 v48, v28, v12
 v_fma_f32 v116, v24, v116, -v48
 v_mul_f32 v48, v29, v12
 v_fma_f32 v117, v25, v117, -v48
 v_mul_f32 v48, v30, v12
 v_fma_f32 v118, v26, v118, -v48
 v_mul_f32 v48, v31, v12
 v_fma_f32 v119, v27, v119, -v48
 s_waitcnt lgkmcnt(2)
 v_mul_f32 v48, v36, v12
 v_fma_f32 v120, v32, v120, -v48
 v_mul_f32 v48, v37, v12
 v_fma_f32 v121, v33, v121, -v48
 v_mul_f32 v48, v38, v12
 v_fma_f32 v122, v34, v122, -v48
 v_mul_f32 v48, v39, v12
 v_fma_f32 v123, v35, v123, -v48
 s_waitcnt lgkmcnt(0)
 v_mul_f32 v48, v44, v12
 v_fma_f32 v124, v40, v124, -v48
 v_mul_f32 v48, v45, v12
 v_fma_f32 v125, v41, v125, -v48
 v_mul_f32 v48, v46, v12
 v_fma_f32 v126, v42, v126, -v48
 v_mul_f32 v48, v47, v12
 v_fma_f32 v127, v43, v127, -v48
 v_cvt_pk_bf16_f32 v50, v112, v113
 v_cvt_pk_bf16_f32 v51, v114, v115
 v_cvt_pk_bf16_f32 v52, v116, v117
 v_cvt_pk_bf16_f32 v53, v118, v119
 v_cvt_pk_bf16_f32 v54, v120, v121
 v_cvt_pk_bf16_f32 v55, v122, v123
 v_cvt_pk_bf16_f32 v56, v124, v125
 v_cvt_pk_bf16_f32 v57, v126, v127
 buffer_store_dwordx4 v[50:53], v11, s[28:31], s48 offen
 buffer_store_dwordx4 v[54:57], v11, s[28:31], s48 offen offset:1024
L_b1_1_kernel_end:
 s_endpgm
.globl attnb_kernel
.p2align 8
.type attnb_kernel,@function
attnb_kernel:
 s_cmp_ge_u32 s2, 256
 s_cbranch_scc1 L_attnb_kernel_end
 s_load_dwordx2 s[4:5], s[0:1], 80
 v_lshrrev_b32 v1, 6, v0
 s_nop 0
 v_readfirstlane_b32 s23, v1
 s_lshr_b32 s20, s2, 3
 s_and_b32 s30, s2, 7
 s_lshl_b32 s21, s30, 3
 s_add_u32 s21, s21, s23
 s_waitcnt lgkmcnt(0)
 s_add_u32 s8, s4, 16777216
 s_addc_u32 s9, s5, 0
 s_mov_b32 s10, 4194304
 s_mov_b32 s11, 0x00020000
 s_add_u32 s12, s4, 20971520
 s_addc_u32 s13, s5, 0
 s_mov_b32 s14, 8388608
 s_mov_b32 s15, 0x00020000
 s_add_u32 s16, s4, 29360128
 s_addc_u32 s17, s5, 0
 s_mov_b32 s18, 2621440
 s_mov_b32 s19, 0x00020000
 s_lshl_b32 s22, s20, 6
 s_add_u32 s22, s22, s21
 s_lshl_b32 s22, s22, 11
 v_and_b32 v1, 63, v0
 v_lshlrev_b32 v2, 4, v1
 buffer_load_dwordx4 v[8:11], v2, s[8:11], s22 offen
 buffer_load_dwordx2 v[12:13], v2, s[8:11], s22 offen offset:1024
 v_mov_b32 v14, 0
 v_mov_b32 v15, 0
 v_lshlrev_b32 v4, 4, v0
 s_lshl_b32 s28, s20, 17
 s_lshl_b32 s29, s30, 14
 s_add_u32 s28, s28, s29
 v_and_b32 v5, 31, v0
 v_cmp_eq_u32 s[26:27], 20, v5
 v_mov_b32 v5, 0x3f803f80
 s_cmp_eq_u32 s30, 0
 s_cbranch_scc1 L_attnb_kernel_skip0
 s_sub_u32 s29, s28, 16384
 s_add_u32 s31, s29, 4194304
 buffer_load_dwordx4 v[112:115], v4, s[12:15], s29 offen
 v_add_u32 v6, 8192, v4
 buffer_load_dwordx4 v[116:119], v6, s[12:15], s29 offen
 buffer_load_dwordx4 v[120:123], v4, s[12:15], s31 offen
 buffer_load_dwordx4 v[124:127], v6, s[12:15], s31 offen
 s_waitcnt vmcnt(0)
 v_cndmask_b32 v120, v120, v5, s[26:27]
 v_cndmask_b32 v121, v121, v5, s[26:27]
 v_cndmask_b32 v122, v122, v5, s[26:27]
 v_cndmask_b32 v123, v123, v5, s[26:27]
 v_cndmask_b32 v124, v124, v5, s[26:27]
 v_cndmask_b32 v125, v125, v5, s[26:27]
 v_cndmask_b32 v126, v126, v5, s[26:27]
 v_cndmask_b32 v127, v127, v5, s[26:27]
 ds_write_b128 v4, v[112:115] offset:0
 ds_write_b128 v4, v[116:119] offset:8192
 ds_write_b128 v4, v[120:123] offset:32768
 ds_write_b128 v4, v[124:127] offset:40960
 s_waitcnt lgkmcnt(0)
L_attnb_kernel_skip0:
 s_mov_b32 s29, s28
 s_add_u32 s31, s29, 4194304
 buffer_load_dwordx4 v[112:115], v4, s[12:15], s29 offen
 v_add_u32 v6, 8192, v4
 buffer_load_dwordx4 v[116:119], v6, s[12:15], s29 offen
 buffer_load_dwordx4 v[120:123], v4, s[12:15], s31 offen
 buffer_load_dwordx4 v[124:127], v6, s[12:15], s31 offen
 s_waitcnt vmcnt(0)
 v_cndmask_b32 v120, v120, v5, s[26:27]
 v_cndmask_b32 v121, v121, v5, s[26:27]
 v_cndmask_b32 v122, v122, v5, s[26:27]
 v_cndmask_b32 v123, v123, v5, s[26:27]
 v_cndmask_b32 v124, v124, v5, s[26:27]
 v_cndmask_b32 v125, v125, v5, s[26:27]
 v_cndmask_b32 v126, v126, v5, s[26:27]
 v_cndmask_b32 v127, v127, v5, s[26:27]
 ds_write_b128 v4, v[112:115] offset:16384
 ds_write_b128 v4, v[116:119] offset:24576
 ds_write_b128 v4, v[120:123] offset:49152
 ds_write_b128 v4, v[124:127] offset:57344
 s_waitcnt lgkmcnt(0)
 v_cmp_gt_u32 vcc, 32, v1
 s_nop 1
 v_cndmask_b32 v12, 0, v12, vcc
 v_cndmask_b32 v13, 0, v13, vcc
 v_and_b32 v1, 63, v0
 v_lshlrev_b32 v7, 4, v1
 s_lshl_b32 s28, s23, 11
 v_add_u32 v7, s28, v7
 v_and_b32 v3, 31, v0
 v_lshlrev_b32 v3, 4, v3
 v_add_u32 v3, s28, v3
 v_add_u32 v2, 32768, v7
 v_mov_b32 v70, 0
 v_mov_b32 v71, 0
 v_mov_b32 v78, 0
 v_mov_b32 v79, 0
 v_mov_b32 v48, 0
 v_mov_b32 v49, 0
 v_mov_b32 v50, 0
 v_mov_b32 v51, 0
 v_mov_b32 v52, 0
 v_mov_b32 v53, 0
 v_mov_b32 v54, 0
 v_mov_b32 v55, 0
 v_mov_b32 v56, 0
 v_mov_b32 v57, 0
 v_mov_b32 v58, 0
 v_mov_b32 v59, 0
 v_mov_b32 v60, 0
 v_mov_b32 v61, 0
 v_mov_b32 v62, 0
 v_mov_b32 v63, 0
 v_mov_b32 v104, 0xf149f2ca
 v_and_b32 v110, 31, v0
 v_bfe_u32 v111, v0, 5, 1
 v_lshlrev_b32 v111, 2, v111
 v_sub_u32 v110, v110, v111
 v_mov_b32 v111, 0xf149f2ca
 s_barrier
 s_cmp_lt_u32 s21, 8
 s_cbranch_scc1 L_attnb_kernel_t0
 ds_read_b128 v[64:67], v7 offset:0
 ds_read_b64 v[68:69], v3 offset:1024
 ds_read_b128 v[80:83], v2 offset:0
 ds_read_b128 v[84:87], v2 offset:1024
 s_waitcnt lgkmcnt(2)
 v_mfma_f32_32x32x16_bf16 v[16:31], v[64:67], v[8:11], 0
 v_mfma_f32_32x32x16_bf16 v[16:31], v[68:71], v[12:15], v[16:31]
 s_nop 11
 v_cmp_gt_i32 vcc, 0, v110
 s_nop 0
 v_cndmask_b32 v16, v111, v16, vcc
 v_cmp_gt_i32 vcc, 1, v110
 s_nop 0
 v_cndmask_b32 v17, v111, v17, vcc
 v_cmp_gt_i32 vcc, 2, v110
 s_nop 0
 v_cndmask_b32 v18, v111, v18, vcc
 v_cmp_gt_i32 vcc, 3, v110
 s_nop 0
 v_cndmask_b32 v19, v111, v19, vcc
 v_cmp_gt_i32 vcc, 8, v110
 s_nop 0
 v_cndmask_b32 v20, v111, v20, vcc
 v_cmp_gt_i32 vcc, 9, v110
 s_nop 0
 v_cndmask_b32 v21, v111, v21, vcc
 v_cmp_gt_i32 vcc, 10, v110
 s_nop 0
 v_cndmask_b32 v22, v111, v22, vcc
 v_cmp_gt_i32 vcc, 11, v110
 s_nop 0
 v_cndmask_b32 v23, v111, v23, vcc
 v_cmp_gt_i32 vcc, 16, v110
 s_nop 0
 v_cndmask_b32 v24, v111, v24, vcc
 v_cmp_gt_i32 vcc, 17, v110
 s_nop 0
 v_cndmask_b32 v25, v111, v25, vcc
 v_cmp_gt_i32 vcc, 18, v110
 s_nop 0
 v_cndmask_b32 v26, v111, v26, vcc
 v_cmp_gt_i32 vcc, 19, v110
 s_nop 0
 v_cndmask_b32 v27, v111, v27, vcc
 v_cmp_gt_i32 vcc, 24, v110
 s_nop 0
 v_cndmask_b32 v28, v111, v28, vcc
 v_cmp_gt_i32 vcc, 25, v110
 s_nop 0
 v_cndmask_b32 v29, v111, v29, vcc
 v_cmp_gt_i32 vcc, 26, v110
 s_nop 0
 v_cndmask_b32 v30, v111, v30, vcc
 v_cmp_gt_i32 vcc, 27, v110
 s_nop 0
 v_cndmask_b32 v31, v111, v31, vcc
 v_max3_f32 v106, v16, v17, v18
 v_max3_f32 v106, v106, v19, v20
 v_max3_f32 v106, v106, v21, v22
 v_max3_f32 v106, v106, v23, v24
 v_max3_f32 v106, v106, v25, v26
 v_max3_f32 v106, v106, v27, v28
 v_max3_f32 v106, v106, v29, v30
 v_max_f32 v106, v106, v31
 v_mov_b32 v107, v106
 s_nop 1
 v_permlane32_swap_b32 v106, v107
 v_max3_f32 v106, v106, v107, v104
 v_sub_f32 v107, v104, v106
 v_exp_f32 v107, v107
 v_mov_b32 v104, v106
 v_sub_f32 v16, v16, v106
 v_sub_f32 v17, v17, v106
 v_sub_f32 v18, v18, v106
 v_sub_f32 v19, v19, v106
 v_sub_f32 v20, v20, v106
 v_sub_f32 v21, v21, v106
 v_sub_f32 v22, v22, v106
 v_sub_f32 v23, v23, v106
 v_sub_f32 v24, v24, v106
 v_sub_f32 v25, v25, v106
 v_sub_f32 v26, v26, v106
 v_sub_f32 v27, v27, v106
 v_sub_f32 v28, v28, v106
 v_sub_f32 v29, v29, v106
 v_sub_f32 v30, v30, v106
 v_sub_f32 v31, v31, v106
 v_mul_f32 v48, v48, v107
 v_mul_f32 v49, v49, v107
 v_mul_f32 v50, v50, v107
 v_mul_f32 v51, v51, v107
 v_mul_f32 v52, v52, v107
 v_mul_f32 v53, v53, v107
 v_mul_f32 v54, v54, v107
 v_mul_f32 v55, v55, v107
 v_mul_f32 v56, v56, v107
 v_mul_f32 v57, v57, v107
 v_mul_f32 v58, v58, v107
 v_mul_f32 v59, v59, v107
 v_exp_f32 v16, v16
 v_exp_f32 v17, v17
 v_exp_f32 v18, v18
 v_exp_f32 v19, v19
 v_exp_f32 v20, v20
 v_exp_f32 v21, v21
 v_exp_f32 v22, v22
 v_exp_f32 v23, v23
 v_exp_f32 v24, v24
 v_exp_f32 v25, v25
 v_exp_f32 v26, v26
 v_exp_f32 v27, v27
 v_exp_f32 v28, v28
 v_exp_f32 v29, v29
 v_exp_f32 v30, v30
 v_exp_f32 v31, v31
 s_nop 0
 v_cvt_pk_bf16_f32 v96, v16, v17
 v_cvt_pk_bf16_f32 v97, v18, v19
 v_cvt_pk_bf16_f32 v98, v20, v21
 v_cvt_pk_bf16_f32 v99, v22, v23
 v_cvt_pk_bf16_f32 v100, v24, v25
 v_cvt_pk_bf16_f32 v101, v26, v27
 v_cvt_pk_bf16_f32 v102, v28, v29
 v_cvt_pk_bf16_f32 v103, v30, v31
 s_waitcnt lgkmcnt(0)
 s_nop 0
 v_mfma_f32_32x32x16_bf16 v[48:63], v[80:83], v[96:99], v[48:63]
 v_mfma_f32_32x32x16_bf16 v[48:63], v[84:87], v[100:103], v[48:63]
L_attnb_kernel_t0:
 s_cmp_lt_u32 s21, 7
 s_cbranch_scc1 L_attnb_kernel_t1
 ds_read_b128 v[64:67], v7 offset:2048
 ds_read_b64 v[68:69], v3 offset:3072
 ds_read_b128 v[80:83], v2 offset:2048
 ds_read_b128 v[84:87], v2 offset:3072
 s_waitcnt lgkmcnt(2)
 v_mfma_f32_32x32x16_bf16 v[16:31], v[64:67], v[8:11], 0
 v_mfma_f32_32x32x16_bf16 v[16:31], v[68:71], v[12:15], v[16:31]
 s_nop 11
 v_max3_f32 v106, v16, v17, v18
 v_max3_f32 v106, v106, v19, v20
 v_max3_f32 v106, v106, v21, v22
 v_max3_f32 v106, v106, v23, v24
 v_max3_f32 v106, v106, v25, v26
 v_max3_f32 v106, v106, v27, v28
 v_max3_f32 v106, v106, v29, v30
 v_max_f32 v106, v106, v31
 v_mov_b32 v107, v106
 s_nop 1
 v_permlane32_swap_b32 v106, v107
 v_max3_f32 v106, v106, v107, v104
 v_sub_f32 v107, v104, v106
 v_exp_f32 v107, v107
 v_mov_b32 v104, v106
 v_sub_f32 v16, v16, v106
 v_sub_f32 v17, v17, v106
 v_sub_f32 v18, v18, v106
 v_sub_f32 v19, v19, v106
 v_sub_f32 v20, v20, v106
 v_sub_f32 v21, v21, v106
 v_sub_f32 v22, v22, v106
 v_sub_f32 v23, v23, v106
 v_sub_f32 v24, v24, v106
 v_sub_f32 v25, v25, v106
 v_sub_f32 v26, v26, v106
 v_sub_f32 v27, v27, v106
 v_sub_f32 v28, v28, v106
 v_sub_f32 v29, v29, v106
 v_sub_f32 v30, v30, v106
 v_sub_f32 v31, v31, v106
 v_mul_f32 v48, v48, v107
 v_mul_f32 v49, v49, v107
 v_mul_f32 v50, v50, v107
 v_mul_f32 v51, v51, v107
 v_mul_f32 v52, v52, v107
 v_mul_f32 v53, v53, v107
 v_mul_f32 v54, v54, v107
 v_mul_f32 v55, v55, v107
 v_mul_f32 v56, v56, v107
 v_mul_f32 v57, v57, v107
 v_mul_f32 v58, v58, v107
 v_mul_f32 v59, v59, v107
 v_exp_f32 v16, v16
 v_exp_f32 v17, v17
 v_exp_f32 v18, v18
 v_exp_f32 v19, v19
 v_exp_f32 v20, v20
 v_exp_f32 v21, v21
 v_exp_f32 v22, v22
 v_exp_f32 v23, v23
 v_exp_f32 v24, v24
 v_exp_f32 v25, v25
 v_exp_f32 v26, v26
 v_exp_f32 v27, v27
 v_exp_f32 v28, v28
 v_exp_f32 v29, v29
 v_exp_f32 v30, v30
 v_exp_f32 v31, v31
 s_nop 0
 v_cvt_pk_bf16_f32 v96, v16, v17
 v_cvt_pk_bf16_f32 v97, v18, v19
 v_cvt_pk_bf16_f32 v98, v20, v21
 v_cvt_pk_bf16_f32 v99, v22, v23
 v_cvt_pk_bf16_f32 v100, v24, v25
 v_cvt_pk_bf16_f32 v101, v26, v27
 v_cvt_pk_bf16_f32 v102, v28, v29
 v_cvt_pk_bf16_f32 v103, v30, v31
 s_waitcnt lgkmcnt(0)
 s_nop 0
 v_mfma_f32_32x32x16_bf16 v[48:63], v[80:83], v[96:99], v[48:63]
 v_mfma_f32_32x32x16_bf16 v[48:63], v[84:87], v[100:103], v[48:63]
L_attnb_kernel_t1:
 s_cmp_lt_u32 s21, 6
 s_cbranch_scc1 L_attnb_kernel_t2
 ds_read_b128 v[64:67], v7 offset:4096
 ds_read_b64 v[68:69], v3 offset:5120
 ds_read_b128 v[80:83], v2 offset:4096
 ds_read_b128 v[84:87], v2 offset:5120
 s_waitcnt lgkmcnt(2)
 v_mfma_f32_32x32x16_bf16 v[16:31], v[64:67], v[8:11], 0
 v_mfma_f32_32x32x16_bf16 v[16:31], v[68:71], v[12:15], v[16:31]
 s_nop 11
 v_max3_f32 v106, v16, v17, v18
 v_max3_f32 v106, v106, v19, v20
 v_max3_f32 v106, v106, v21, v22
 v_max3_f32 v106, v106, v23, v24
 v_max3_f32 v106, v106, v25, v26
 v_max3_f32 v106, v106, v27, v28
 v_max3_f32 v106, v106, v29, v30
 v_max_f32 v106, v106, v31
 v_mov_b32 v107, v106
 s_nop 1
 v_permlane32_swap_b32 v106, v107
 v_max3_f32 v106, v106, v107, v104
 v_sub_f32 v107, v104, v106
 v_exp_f32 v107, v107
 v_mov_b32 v104, v106
 v_sub_f32 v16, v16, v106
 v_sub_f32 v17, v17, v106
 v_sub_f32 v18, v18, v106
 v_sub_f32 v19, v19, v106
 v_sub_f32 v20, v20, v106
 v_sub_f32 v21, v21, v106
 v_sub_f32 v22, v22, v106
 v_sub_f32 v23, v23, v106
 v_sub_f32 v24, v24, v106
 v_sub_f32 v25, v25, v106
 v_sub_f32 v26, v26, v106
 v_sub_f32 v27, v27, v106
 v_sub_f32 v28, v28, v106
 v_sub_f32 v29, v29, v106
 v_sub_f32 v30, v30, v106
 v_sub_f32 v31, v31, v106
 v_mul_f32 v48, v48, v107
 v_mul_f32 v49, v49, v107
 v_mul_f32 v50, v50, v107
 v_mul_f32 v51, v51, v107
 v_mul_f32 v52, v52, v107
 v_mul_f32 v53, v53, v107
 v_mul_f32 v54, v54, v107
 v_mul_f32 v55, v55, v107
 v_mul_f32 v56, v56, v107
 v_mul_f32 v57, v57, v107
 v_mul_f32 v58, v58, v107
 v_mul_f32 v59, v59, v107
 v_exp_f32 v16, v16
 v_exp_f32 v17, v17
 v_exp_f32 v18, v18
 v_exp_f32 v19, v19
 v_exp_f32 v20, v20
 v_exp_f32 v21, v21
 v_exp_f32 v22, v22
 v_exp_f32 v23, v23
 v_exp_f32 v24, v24
 v_exp_f32 v25, v25
 v_exp_f32 v26, v26
 v_exp_f32 v27, v27
 v_exp_f32 v28, v28
 v_exp_f32 v29, v29
 v_exp_f32 v30, v30
 v_exp_f32 v31, v31
 s_nop 0
 v_cvt_pk_bf16_f32 v96, v16, v17
 v_cvt_pk_bf16_f32 v97, v18, v19
 v_cvt_pk_bf16_f32 v98, v20, v21
 v_cvt_pk_bf16_f32 v99, v22, v23
 v_cvt_pk_bf16_f32 v100, v24, v25
 v_cvt_pk_bf16_f32 v101, v26, v27
 v_cvt_pk_bf16_f32 v102, v28, v29
 v_cvt_pk_bf16_f32 v103, v30, v31
 s_waitcnt lgkmcnt(0)
 s_nop 0
 v_mfma_f32_32x32x16_bf16 v[48:63], v[80:83], v[96:99], v[48:63]
 v_mfma_f32_32x32x16_bf16 v[48:63], v[84:87], v[100:103], v[48:63]
L_attnb_kernel_t2:
 s_cmp_lt_u32 s21, 5
 s_cbranch_scc1 L_attnb_kernel_t3
 ds_read_b128 v[64:67], v7 offset:6144
 ds_read_b64 v[68:69], v3 offset:7168
 ds_read_b128 v[80:83], v2 offset:6144
 ds_read_b128 v[84:87], v2 offset:7168
 s_waitcnt lgkmcnt(2)
 v_mfma_f32_32x32x16_bf16 v[16:31], v[64:67], v[8:11], 0
 v_mfma_f32_32x32x16_bf16 v[16:31], v[68:71], v[12:15], v[16:31]
 s_nop 11
 v_max3_f32 v106, v16, v17, v18
 v_max3_f32 v106, v106, v19, v20
 v_max3_f32 v106, v106, v21, v22
 v_max3_f32 v106, v106, v23, v24
 v_max3_f32 v106, v106, v25, v26
 v_max3_f32 v106, v106, v27, v28
 v_max3_f32 v106, v106, v29, v30
 v_max_f32 v106, v106, v31
 v_mov_b32 v107, v106
 s_nop 1
 v_permlane32_swap_b32 v106, v107
 v_max3_f32 v106, v106, v107, v104
 v_sub_f32 v107, v104, v106
 v_exp_f32 v107, v107
 v_mov_b32 v104, v106
 v_sub_f32 v16, v16, v106
 v_sub_f32 v17, v17, v106
 v_sub_f32 v18, v18, v106
 v_sub_f32 v19, v19, v106
 v_sub_f32 v20, v20, v106
 v_sub_f32 v21, v21, v106
 v_sub_f32 v22, v22, v106
 v_sub_f32 v23, v23, v106
 v_sub_f32 v24, v24, v106
 v_sub_f32 v25, v25, v106
 v_sub_f32 v26, v26, v106
 v_sub_f32 v27, v27, v106
 v_sub_f32 v28, v28, v106
 v_sub_f32 v29, v29, v106
 v_sub_f32 v30, v30, v106
 v_sub_f32 v31, v31, v106
 v_mul_f32 v48, v48, v107
 v_mul_f32 v49, v49, v107
 v_mul_f32 v50, v50, v107
 v_mul_f32 v51, v51, v107
 v_mul_f32 v52, v52, v107
 v_mul_f32 v53, v53, v107
 v_mul_f32 v54, v54, v107
 v_mul_f32 v55, v55, v107
 v_mul_f32 v56, v56, v107
 v_mul_f32 v57, v57, v107
 v_mul_f32 v58, v58, v107
 v_mul_f32 v59, v59, v107
 v_exp_f32 v16, v16
 v_exp_f32 v17, v17
 v_exp_f32 v18, v18
 v_exp_f32 v19, v19
 v_exp_f32 v20, v20
 v_exp_f32 v21, v21
 v_exp_f32 v22, v22
 v_exp_f32 v23, v23
 v_exp_f32 v24, v24
 v_exp_f32 v25, v25
 v_exp_f32 v26, v26
 v_exp_f32 v27, v27
 v_exp_f32 v28, v28
 v_exp_f32 v29, v29
 v_exp_f32 v30, v30
 v_exp_f32 v31, v31
 s_nop 0
 v_cvt_pk_bf16_f32 v96, v16, v17
 v_cvt_pk_bf16_f32 v97, v18, v19
 v_cvt_pk_bf16_f32 v98, v20, v21
 v_cvt_pk_bf16_f32 v99, v22, v23
 v_cvt_pk_bf16_f32 v100, v24, v25
 v_cvt_pk_bf16_f32 v101, v26, v27
 v_cvt_pk_bf16_f32 v102, v28, v29
 v_cvt_pk_bf16_f32 v103, v30, v31
 s_waitcnt lgkmcnt(0)
 s_nop 0
 v_mfma_f32_32x32x16_bf16 v[48:63], v[80:83], v[96:99], v[48:63]
 v_mfma_f32_32x32x16_bf16 v[48:63], v[84:87], v[100:103], v[48:63]
L_attnb_kernel_t3:
 s_cmp_lt_u32 s21, 4
 s_cbranch_scc1 L_attnb_kernel_t4
 ds_read_b128 v[64:67], v7 offset:8192
 ds_read_b64 v[68:69], v3 offset:9216
 ds_read_b128 v[80:83], v2 offset:8192
 ds_read_b128 v[84:87], v2 offset:9216
 s_waitcnt lgkmcnt(2)
 v_mfma_f32_32x32x16_bf16 v[16:31], v[64:67], v[8:11], 0
 v_mfma_f32_32x32x16_bf16 v[16:31], v[68:71], v[12:15], v[16:31]
 s_nop 11
 v_max3_f32 v106, v16, v17, v18
 v_max3_f32 v106, v106, v19, v20
 v_max3_f32 v106, v106, v21, v22
 v_max3_f32 v106, v106, v23, v24
 v_max3_f32 v106, v106, v25, v26
 v_max3_f32 v106, v106, v27, v28
 v_max3_f32 v106, v106, v29, v30
 v_max_f32 v106, v106, v31
 v_mov_b32 v107, v106
 s_nop 1
 v_permlane32_swap_b32 v106, v107
 v_max3_f32 v106, v106, v107, v104
 v_sub_f32 v107, v104, v106
 v_exp_f32 v107, v107
 v_mov_b32 v104, v106
 v_sub_f32 v16, v16, v106
 v_sub_f32 v17, v17, v106
 v_sub_f32 v18, v18, v106
 v_sub_f32 v19, v19, v106
 v_sub_f32 v20, v20, v106
 v_sub_f32 v21, v21, v106
 v_sub_f32 v22, v22, v106
 v_sub_f32 v23, v23, v106
 v_sub_f32 v24, v24, v106
 v_sub_f32 v25, v25, v106
 v_sub_f32 v26, v26, v106
 v_sub_f32 v27, v27, v106
 v_sub_f32 v28, v28, v106
 v_sub_f32 v29, v29, v106
 v_sub_f32 v30, v30, v106
 v_sub_f32 v31, v31, v106
 v_mul_f32 v48, v48, v107
 v_mul_f32 v49, v49, v107
 v_mul_f32 v50, v50, v107
 v_mul_f32 v51, v51, v107
 v_mul_f32 v52, v52, v107
 v_mul_f32 v53, v53, v107
 v_mul_f32 v54, v54, v107
 v_mul_f32 v55, v55, v107
 v_mul_f32 v56, v56, v107
 v_mul_f32 v57, v57, v107
 v_mul_f32 v58, v58, v107
 v_mul_f32 v59, v59, v107
 v_exp_f32 v16, v16
 v_exp_f32 v17, v17
 v_exp_f32 v18, v18
 v_exp_f32 v19, v19
 v_exp_f32 v20, v20
 v_exp_f32 v21, v21
 v_exp_f32 v22, v22
 v_exp_f32 v23, v23
 v_exp_f32 v24, v24
 v_exp_f32 v25, v25
 v_exp_f32 v26, v26
 v_exp_f32 v27, v27
 v_exp_f32 v28, v28
 v_exp_f32 v29, v29
 v_exp_f32 v30, v30
 v_exp_f32 v31, v31
 s_nop 0
 v_cvt_pk_bf16_f32 v96, v16, v17
 v_cvt_pk_bf16_f32 v97, v18, v19
 v_cvt_pk_bf16_f32 v98, v20, v21
 v_cvt_pk_bf16_f32 v99, v22, v23
 v_cvt_pk_bf16_f32 v100, v24, v25
 v_cvt_pk_bf16_f32 v101, v26, v27
 v_cvt_pk_bf16_f32 v102, v28, v29
 v_cvt_pk_bf16_f32 v103, v30, v31
 s_waitcnt lgkmcnt(0)
 s_nop 0
 v_mfma_f32_32x32x16_bf16 v[48:63], v[80:83], v[96:99], v[48:63]
 v_mfma_f32_32x32x16_bf16 v[48:63], v[84:87], v[100:103], v[48:63]
L_attnb_kernel_t4:
 s_cmp_lt_u32 s21, 3
 s_cbranch_scc1 L_attnb_kernel_t5
 ds_read_b128 v[64:67], v7 offset:10240
 ds_read_b64 v[68:69], v3 offset:11264
 ds_read_b128 v[80:83], v2 offset:10240
 ds_read_b128 v[84:87], v2 offset:11264
 s_waitcnt lgkmcnt(2)
 v_mfma_f32_32x32x16_bf16 v[16:31], v[64:67], v[8:11], 0
 v_mfma_f32_32x32x16_bf16 v[16:31], v[68:71], v[12:15], v[16:31]
 s_nop 11
 v_max3_f32 v106, v16, v17, v18
 v_max3_f32 v106, v106, v19, v20
 v_max3_f32 v106, v106, v21, v22
 v_max3_f32 v106, v106, v23, v24
 v_max3_f32 v106, v106, v25, v26
 v_max3_f32 v106, v106, v27, v28
 v_max3_f32 v106, v106, v29, v30
 v_max_f32 v106, v106, v31
 v_mov_b32 v107, v106
 s_nop 1
 v_permlane32_swap_b32 v106, v107
 v_max3_f32 v106, v106, v107, v104
 v_sub_f32 v107, v104, v106
 v_exp_f32 v107, v107
 v_mov_b32 v104, v106
 v_sub_f32 v16, v16, v106
 v_sub_f32 v17, v17, v106
 v_sub_f32 v18, v18, v106
 v_sub_f32 v19, v19, v106
 v_sub_f32 v20, v20, v106
 v_sub_f32 v21, v21, v106
 v_sub_f32 v22, v22, v106
 v_sub_f32 v23, v23, v106
 v_sub_f32 v24, v24, v106
 v_sub_f32 v25, v25, v106
 v_sub_f32 v26, v26, v106
 v_sub_f32 v27, v27, v106
 v_sub_f32 v28, v28, v106
 v_sub_f32 v29, v29, v106
 v_sub_f32 v30, v30, v106
 v_sub_f32 v31, v31, v106
 v_mul_f32 v48, v48, v107
 v_mul_f32 v49, v49, v107
 v_mul_f32 v50, v50, v107
 v_mul_f32 v51, v51, v107
 v_mul_f32 v52, v52, v107
 v_mul_f32 v53, v53, v107
 v_mul_f32 v54, v54, v107
 v_mul_f32 v55, v55, v107
 v_mul_f32 v56, v56, v107
 v_mul_f32 v57, v57, v107
 v_mul_f32 v58, v58, v107
 v_mul_f32 v59, v59, v107
 v_exp_f32 v16, v16
 v_exp_f32 v17, v17
 v_exp_f32 v18, v18
 v_exp_f32 v19, v19
 v_exp_f32 v20, v20
 v_exp_f32 v21, v21
 v_exp_f32 v22, v22
 v_exp_f32 v23, v23
 v_exp_f32 v24, v24
 v_exp_f32 v25, v25
 v_exp_f32 v26, v26
 v_exp_f32 v27, v27
 v_exp_f32 v28, v28
 v_exp_f32 v29, v29
 v_exp_f32 v30, v30
 v_exp_f32 v31, v31
 s_nop 0
 v_cvt_pk_bf16_f32 v96, v16, v17
 v_cvt_pk_bf16_f32 v97, v18, v19
 v_cvt_pk_bf16_f32 v98, v20, v21
 v_cvt_pk_bf16_f32 v99, v22, v23
 v_cvt_pk_bf16_f32 v100, v24, v25
 v_cvt_pk_bf16_f32 v101, v26, v27
 v_cvt_pk_bf16_f32 v102, v28, v29
 v_cvt_pk_bf16_f32 v103, v30, v31
 s_waitcnt lgkmcnt(0)
 s_nop 0
 v_mfma_f32_32x32x16_bf16 v[48:63], v[80:83], v[96:99], v[48:63]
 v_mfma_f32_32x32x16_bf16 v[48:63], v[84:87], v[100:103], v[48:63]
L_attnb_kernel_t5:
 s_cmp_lt_u32 s21, 2
 s_cbranch_scc1 L_attnb_kernel_t6
 ds_read_b128 v[64:67], v7 offset:12288
 ds_read_b64 v[68:69], v3 offset:13312
 ds_read_b128 v[80:83], v2 offset:12288
 ds_read_b128 v[84:87], v2 offset:13312
 s_waitcnt lgkmcnt(2)
 v_mfma_f32_32x32x16_bf16 v[16:31], v[64:67], v[8:11], 0
 v_mfma_f32_32x32x16_bf16 v[16:31], v[68:71], v[12:15], v[16:31]
 s_nop 11
 v_max3_f32 v106, v16, v17, v18
 v_max3_f32 v106, v106, v19, v20
 v_max3_f32 v106, v106, v21, v22
 v_max3_f32 v106, v106, v23, v24
 v_max3_f32 v106, v106, v25, v26
 v_max3_f32 v106, v106, v27, v28
 v_max3_f32 v106, v106, v29, v30
 v_max_f32 v106, v106, v31
 v_mov_b32 v107, v106
 s_nop 1
 v_permlane32_swap_b32 v106, v107
 v_max3_f32 v106, v106, v107, v104
 v_sub_f32 v107, v104, v106
 v_exp_f32 v107, v107
 v_mov_b32 v104, v106
 v_sub_f32 v16, v16, v106
 v_sub_f32 v17, v17, v106
 v_sub_f32 v18, v18, v106
 v_sub_f32 v19, v19, v106
 v_sub_f32 v20, v20, v106
 v_sub_f32 v21, v21, v106
 v_sub_f32 v22, v22, v106
 v_sub_f32 v23, v23, v106
 v_sub_f32 v24, v24, v106
 v_sub_f32 v25, v25, v106
 v_sub_f32 v26, v26, v106
 v_sub_f32 v27, v27, v106
 v_sub_f32 v28, v28, v106
 v_sub_f32 v29, v29, v106
 v_sub_f32 v30, v30, v106
 v_sub_f32 v31, v31, v106
 v_mul_f32 v48, v48, v107
 v_mul_f32 v49, v49, v107
 v_mul_f32 v50, v50, v107
 v_mul_f32 v51, v51, v107
 v_mul_f32 v52, v52, v107
 v_mul_f32 v53, v53, v107
 v_mul_f32 v54, v54, v107
 v_mul_f32 v55, v55, v107
 v_mul_f32 v56, v56, v107
 v_mul_f32 v57, v57, v107
 v_mul_f32 v58, v58, v107
 v_mul_f32 v59, v59, v107
 v_exp_f32 v16, v16
 v_exp_f32 v17, v17
 v_exp_f32 v18, v18
 v_exp_f32 v19, v19
 v_exp_f32 v20, v20
 v_exp_f32 v21, v21
 v_exp_f32 v22, v22
 v_exp_f32 v23, v23
 v_exp_f32 v24, v24
 v_exp_f32 v25, v25
 v_exp_f32 v26, v26
 v_exp_f32 v27, v27
 v_exp_f32 v28, v28
 v_exp_f32 v29, v29
 v_exp_f32 v30, v30
 v_exp_f32 v31, v31
 s_nop 0
 v_cvt_pk_bf16_f32 v96, v16, v17
 v_cvt_pk_bf16_f32 v97, v18, v19
 v_cvt_pk_bf16_f32 v98, v20, v21
 v_cvt_pk_bf16_f32 v99, v22, v23
 v_cvt_pk_bf16_f32 v100, v24, v25
 v_cvt_pk_bf16_f32 v101, v26, v27
 v_cvt_pk_bf16_f32 v102, v28, v29
 v_cvt_pk_bf16_f32 v103, v30, v31
 s_waitcnt lgkmcnt(0)
 s_nop 0
 v_mfma_f32_32x32x16_bf16 v[48:63], v[80:83], v[96:99], v[48:63]
 v_mfma_f32_32x32x16_bf16 v[48:63], v[84:87], v[100:103], v[48:63]
L_attnb_kernel_t6:
 s_cmp_lt_u32 s21, 1
 s_cbranch_scc1 L_attnb_kernel_t7
 ds_read_b128 v[64:67], v7 offset:14336
 ds_read_b64 v[68:69], v3 offset:15360
 ds_read_b128 v[80:83], v2 offset:14336
 ds_read_b128 v[84:87], v2 offset:15360
 s_waitcnt lgkmcnt(2)
 v_mfma_f32_32x32x16_bf16 v[16:31], v[64:67], v[8:11], 0
 v_mfma_f32_32x32x16_bf16 v[16:31], v[68:71], v[12:15], v[16:31]
 s_nop 11
 v_max3_f32 v106, v16, v17, v18
 v_max3_f32 v106, v106, v19, v20
 v_max3_f32 v106, v106, v21, v22
 v_max3_f32 v106, v106, v23, v24
 v_max3_f32 v106, v106, v25, v26
 v_max3_f32 v106, v106, v27, v28
 v_max3_f32 v106, v106, v29, v30
 v_max_f32 v106, v106, v31
 v_mov_b32 v107, v106
 s_nop 1
 v_permlane32_swap_b32 v106, v107
 v_max3_f32 v106, v106, v107, v104
 v_sub_f32 v107, v104, v106
 v_exp_f32 v107, v107
 v_mov_b32 v104, v106
 v_sub_f32 v16, v16, v106
 v_sub_f32 v17, v17, v106
 v_sub_f32 v18, v18, v106
 v_sub_f32 v19, v19, v106
 v_sub_f32 v20, v20, v106
 v_sub_f32 v21, v21, v106
 v_sub_f32 v22, v22, v106
 v_sub_f32 v23, v23, v106
 v_sub_f32 v24, v24, v106
 v_sub_f32 v25, v25, v106
 v_sub_f32 v26, v26, v106
 v_sub_f32 v27, v27, v106
 v_sub_f32 v28, v28, v106
 v_sub_f32 v29, v29, v106
 v_sub_f32 v30, v30, v106
 v_sub_f32 v31, v31, v106
 v_mul_f32 v48, v48, v107
 v_mul_f32 v49, v49, v107
 v_mul_f32 v50, v50, v107
 v_mul_f32 v51, v51, v107
 v_mul_f32 v52, v52, v107
 v_mul_f32 v53, v53, v107
 v_mul_f32 v54, v54, v107
 v_mul_f32 v55, v55, v107
 v_mul_f32 v56, v56, v107
 v_mul_f32 v57, v57, v107
 v_mul_f32 v58, v58, v107
 v_mul_f32 v59, v59, v107
 v_exp_f32 v16, v16
 v_exp_f32 v17, v17
 v_exp_f32 v18, v18
 v_exp_f32 v19, v19
 v_exp_f32 v20, v20
 v_exp_f32 v21, v21
 v_exp_f32 v22, v22
 v_exp_f32 v23, v23
 v_exp_f32 v24, v24
 v_exp_f32 v25, v25
 v_exp_f32 v26, v26
 v_exp_f32 v27, v27
 v_exp_f32 v28, v28
 v_exp_f32 v29, v29
 v_exp_f32 v30, v30
 v_exp_f32 v31, v31
 s_nop 0
 v_cvt_pk_bf16_f32 v96, v16, v17
 v_cvt_pk_bf16_f32 v97, v18, v19
 v_cvt_pk_bf16_f32 v98, v20, v21
 v_cvt_pk_bf16_f32 v99, v22, v23
 v_cvt_pk_bf16_f32 v100, v24, v25
 v_cvt_pk_bf16_f32 v101, v26, v27
 v_cvt_pk_bf16_f32 v102, v28, v29
 v_cvt_pk_bf16_f32 v103, v30, v31
 s_waitcnt lgkmcnt(0)
 s_nop 0
 v_mfma_f32_32x32x16_bf16 v[48:63], v[80:83], v[96:99], v[48:63]
 v_mfma_f32_32x32x16_bf16 v[48:63], v[84:87], v[100:103], v[48:63]
L_attnb_kernel_t7:
 s_cmp_lt_u32 s21, 0
 s_cbranch_scc1 L_attnb_kernel_t8
 ds_read_b128 v[64:67], v7 offset:16384
 ds_read_b64 v[68:69], v3 offset:17408
 ds_read_b128 v[80:83], v2 offset:16384
 ds_read_b128 v[84:87], v2 offset:17408
 s_waitcnt lgkmcnt(2)
 v_mfma_f32_32x32x16_bf16 v[16:31], v[64:67], v[8:11], 0
 v_mfma_f32_32x32x16_bf16 v[16:31], v[68:71], v[12:15], v[16:31]
 s_nop 11
 v_cmp_le_i32 vcc, 0, v110
 s_nop 0
 v_cndmask_b32 v16, v111, v16, vcc
 v_cmp_le_i32 vcc, 1, v110
 s_nop 0
 v_cndmask_b32 v17, v111, v17, vcc
 v_cmp_le_i32 vcc, 2, v110
 s_nop 0
 v_cndmask_b32 v18, v111, v18, vcc
 v_cmp_le_i32 vcc, 3, v110
 s_nop 0
 v_cndmask_b32 v19, v111, v19, vcc
 v_cmp_le_i32 vcc, 8, v110
 s_nop 0
 v_cndmask_b32 v20, v111, v20, vcc
 v_cmp_le_i32 vcc, 9, v110
 s_nop 0
 v_cndmask_b32 v21, v111, v21, vcc
 v_cmp_le_i32 vcc, 10, v110
 s_nop 0
 v_cndmask_b32 v22, v111, v22, vcc
 v_cmp_le_i32 vcc, 11, v110
 s_nop 0
 v_cndmask_b32 v23, v111, v23, vcc
 v_cmp_le_i32 vcc, 16, v110
 s_nop 0
 v_cndmask_b32 v24, v111, v24, vcc
 v_cmp_le_i32 vcc, 17, v110
 s_nop 0
 v_cndmask_b32 v25, v111, v25, vcc
 v_cmp_le_i32 vcc, 18, v110
 s_nop 0
 v_cndmask_b32 v26, v111, v26, vcc
 v_cmp_le_i32 vcc, 19, v110
 s_nop 0
 v_cndmask_b32 v27, v111, v27, vcc
 v_cmp_le_i32 vcc, 24, v110
 s_nop 0
 v_cndmask_b32 v28, v111, v28, vcc
 v_cmp_le_i32 vcc, 25, v110
 s_nop 0
 v_cndmask_b32 v29, v111, v29, vcc
 v_cmp_le_i32 vcc, 26, v110
 s_nop 0
 v_cndmask_b32 v30, v111, v30, vcc
 v_cmp_le_i32 vcc, 27, v110
 s_nop 0
 v_cndmask_b32 v31, v111, v31, vcc
 v_max3_f32 v106, v16, v17, v18
 v_max3_f32 v106, v106, v19, v20
 v_max3_f32 v106, v106, v21, v22
 v_max3_f32 v106, v106, v23, v24
 v_max3_f32 v106, v106, v25, v26
 v_max3_f32 v106, v106, v27, v28
 v_max3_f32 v106, v106, v29, v30
 v_max_f32 v106, v106, v31
 v_mov_b32 v107, v106
 s_nop 1
 v_permlane32_swap_b32 v106, v107
 v_max3_f32 v106, v106, v107, v104
 v_sub_f32 v107, v104, v106
 v_exp_f32 v107, v107
 v_mov_b32 v104, v106
 v_sub_f32 v16, v16, v106
 v_sub_f32 v17, v17, v106
 v_sub_f32 v18, v18, v106
 v_sub_f32 v19, v19, v106
 v_sub_f32 v20, v20, v106
 v_sub_f32 v21, v21, v106
 v_sub_f32 v22, v22, v106
 v_sub_f32 v23, v23, v106
 v_sub_f32 v24, v24, v106
 v_sub_f32 v25, v25, v106
 v_sub_f32 v26, v26, v106
 v_sub_f32 v27, v27, v106
 v_sub_f32 v28, v28, v106
 v_sub_f32 v29, v29, v106
 v_sub_f32 v30, v30, v106
 v_sub_f32 v31, v31, v106
 v_mul_f32 v48, v48, v107
 v_mul_f32 v49, v49, v107
 v_mul_f32 v50, v50, v107
 v_mul_f32 v51, v51, v107
 v_mul_f32 v52, v52, v107
 v_mul_f32 v53, v53, v107
 v_mul_f32 v54, v54, v107
 v_mul_f32 v55, v55, v107
 v_mul_f32 v56, v56, v107
 v_mul_f32 v57, v57, v107
 v_mul_f32 v58, v58, v107
 v_mul_f32 v59, v59, v107
 v_exp_f32 v16, v16
 v_exp_f32 v17, v17
 v_exp_f32 v18, v18
 v_exp_f32 v19, v19
 v_exp_f32 v20, v20
 v_exp_f32 v21, v21
 v_exp_f32 v22, v22
 v_exp_f32 v23, v23
 v_exp_f32 v24, v24
 v_exp_f32 v25, v25
 v_exp_f32 v26, v26
 v_exp_f32 v27, v27
 v_exp_f32 v28, v28
 v_exp_f32 v29, v29
 v_exp_f32 v30, v30
 v_exp_f32 v31, v31
 s_nop 0
 v_cvt_pk_bf16_f32 v96, v16, v17
 v_cvt_pk_bf16_f32 v97, v18, v19
 v_cvt_pk_bf16_f32 v98, v20, v21
 v_cvt_pk_bf16_f32 v99, v22, v23
 v_cvt_pk_bf16_f32 v100, v24, v25
 v_cvt_pk_bf16_f32 v101, v26, v27
 v_cvt_pk_bf16_f32 v102, v28, v29
 v_cvt_pk_bf16_f32 v103, v30, v31
 s_waitcnt lgkmcnt(0)
 s_nop 0
 v_mfma_f32_32x32x16_bf16 v[48:63], v[80:83], v[96:99], v[48:63]
 v_mfma_f32_32x32x16_bf16 v[48:63], v[84:87], v[100:103], v[48:63]
L_attnb_kernel_t8:
 s_nop 11
 v_mov_b32 v106, v56
 v_mov_b32 v107, v56
 s_nop 1
 v_permlane32_swap_b32 v106, v107
 v_rcp_f32 v107, v107
 s_nop 0
 v_mul_f32 v48, v48, v107
 v_mul_f32 v49, v49, v107
 v_mul_f32 v50, v50, v107
 v_mul_f32 v51, v51, v107
 v_mul_f32 v52, v52, v107
 v_mul_f32 v53, v53, v107
 v_mul_f32 v54, v54, v107
 v_mul_f32 v55, v55, v107
 v_mul_f32 v56, v56, v107
 v_mul_f32 v57, v57, v107
 v_mul_f32 v58, v58, v107
 v_mul_f32 v59, v59, v107
 v_and_b32 v2, 31, v0
 s_lshl_b32 s22, s21, 5
 v_add_u32 v2, s22, v2
 v_mul_u32_u24 v2, 1280, v2
 v_bfe_u32 v3, v0, 5, 1
 v_lshl_add_u32 v2, v3, 3, v2
 s_mul_i32 s22, s20, 40
 v_cvt_pk_bf16_f32 v106, v48, v49
 v_cvt_pk_bf16_f32 v107, v50, v51
 buffer_store_dwordx2 v[106:107], v2, s[16:19], s22 offen offset:0
 v_cvt_pk_bf16_f32 v106, v52, v53
 v_cvt_pk_bf16_f32 v107, v54, v55
 buffer_store_dwordx2 v[106:107], v2, s[16:19], s22 offen offset:16
 v_cvt_pk_bf16_f32 v106, v56, v57
 v_cvt_pk_bf16_f32 v107, v58, v59
 v_cmp_gt_u32 vcc, 32, v1
 s_and_saveexec_b64 s[24:25], vcc
 buffer_store_dwordx2 v[106:107], v2, s[16:19], s22 offen offset:32
 s_mov_b64 exec, s[24:25]
L_attnb_kernel_end:
 s_endpgm
.globl outb_1_kernel
.p2align 8
.type outb_1_kernel,@function
outb_1_kernel:
 s_cmp_ge_u32 s2, 160
 s_cbranch_scc1 L_outb_1_kernel_end
 s_load_dwordx2 s[4:5], s[0:1], 80
 s_and_b32 s32, s2, 31
 s_lshr_b32 s33, s2, 5
 v_lshrrev_b32 v1, 6, v0
 s_nop 0
 v_readfirstlane_b32 s34, v1
 s_waitcnt lgkmcnt(0)
 s_add_u32 s8, s4, 29360128
 s_addc_u32 s9, s5, 0
 s_mov_b32 s10, 2621440
 s_mov_b32 s11, 0x00020000
 s_add_u32 s12, s4, 4718592
 s_addc_u32 s13, s5, 0
 s_mov_b32 s14, 819200
 s_mov_b32 s15, 0x00020000
 s_mul_i32 s35, s32, 81920
 v_add_u32 v2, 0, v0
 v_lshlrev_b32 v3, 4, v2
 buffer_load_dwordx4 v[64:67], v3, s[8:11], s35 offen
 v_add_u32 v2, 256, v0
 v_lshlrev_b32 v3, 4, v2
 buffer_load_dwordx4 v[68:71], v3, s[8:11], s35 offen
 v_add_u32 v2, 512, v0
 v_lshlrev_b32 v3, 4, v2
 buffer_load_dwordx4 v[72:75], v3, s[8:11], s35 offen
 v_add_u32 v2, 768, v0
 v_lshlrev_b32 v3, 4, v2
 buffer_load_dwordx4 v[76:79], v3, s[8:11], s35 offen
 v_add_u32 v2, 1024, v0
 v_lshlrev_b32 v3, 4, v2
 buffer_load_dwordx4 v[80:83], v3, s[8:11], s35 offen
 v_add_u32 v2, 1280, v0
 v_lshlrev_b32 v3, 4, v2
 buffer_load_dwordx4 v[84:87], v3, s[8:11], s35 offen
 v_add_u32 v2, 1536, v0
 v_lshlrev_b32 v3, 4, v2
 buffer_load_dwordx4 v[88:91], v3, s[8:11], s35 offen
 v_add_u32 v2, 1792, v0
 v_lshlrev_b32 v3, 4, v2
 buffer_load_dwordx4 v[92:95], v3, s[8:11], s35 offen
 v_add_u32 v2, 2048, v0
 v_lshlrev_b32 v3, 4, v2
 buffer_load_dwordx4 v[96:99], v3, s[8:11], s35 offen
 v_add_u32 v2, 2304, v0
 v_lshlrev_b32 v3, 4, v2
 buffer_load_dwordx4 v[100:103], v3, s[8:11], s35 offen
 v_add_u32 v2, 2560, v0
 v_lshlrev_b32 v3, 4, v2
 buffer_load_dwordx4 v[104:107], v3, s[8:11], s35 offen
 v_add_u32 v2, 2816, v0
 v_lshlrev_b32 v3, 4, v2
 buffer_load_dwordx4 v[108:111], v3, s[8:11], s35 offen
 v_add_u32 v2, 3072, v0
 v_lshlrev_b32 v3, 4, v2
 buffer_load_dwordx4 v[112:115], v3, s[8:11], s35 offen
 v_add_u32 v2, 3328, v0
 v_lshlrev_b32 v3, 4, v2
 buffer_load_dwordx4 v[116:119], v3, s[8:11], s35 offen
 v_add_u32 v2, 3584, v0
 v_lshlrev_b32 v3, 4, v2
 buffer_load_dwordx4 v[120:123], v3, s[8:11], s35 offen
 v_add_u32 v2, 3840, v0
 v_lshlrev_b32 v3, 4, v2
 buffer_load_dwordx4 v[124:127], v3, s[8:11], s35 offen
 v_add_u32 v2, 4096, v0
 v_lshlrev_b32 v3, 4, v2
 buffer_load_dwordx4 v[128:131], v3, s[8:11], s35 offen
 v_add_u32 v2, 4352, v0
 v_lshlrev_b32 v3, 4, v2
 buffer_load_dwordx4 v[132:135], v3, s[8:11], s35 offen
 v_add_u32 v2, 4608, v0
 v_lshlrev_b32 v3, 4, v2
 buffer_load_dwordx4 v[136:139], v3, s[8:11], s35 offen
 v_add_u32 v2, 4864, v0
 v_lshlrev_b32 v3, 4, v2
 buffer_load_dwordx4 v[140:143], v3, s[8:11], s35 offen
 v_add_u32 v2, 0, v0
 v_mul_u32_u24 v3, 52429, v2
 v_lshrrev_b32 v3, 22, v3
 v_add_u32 v3, v3, v2
 v_lshlrev_b32 v3, 4, v3
 s_waitcnt vmcnt(19)
 ds_write_b128 v3, v[64:67]
 v_add_u32 v2, 256, v0
 v_mul_u32_u24 v3, 52429, v2
 v_lshrrev_b32 v3, 22, v3
 v_add_u32 v3, v3, v2
 v_lshlrev_b32 v3, 4, v3
 s_waitcnt vmcnt(18)
 ds_write_b128 v3, v[68:71]
 v_add_u32 v2, 512, v0
 v_mul_u32_u24 v3, 52429, v2
 v_lshrrev_b32 v3, 22, v3
 v_add_u32 v3, v3, v2
 v_lshlrev_b32 v3, 4, v3
 s_waitcnt vmcnt(17)
 ds_write_b128 v3, v[72:75]
 v_add_u32 v2, 768, v0
 v_mul_u32_u24 v3, 52429, v2
 v_lshrrev_b32 v3, 22, v3
 v_add_u32 v3, v3, v2
 v_lshlrev_b32 v3, 4, v3
 s_waitcnt vmcnt(16)
 ds_write_b128 v3, v[76:79]
 v_add_u32 v2, 1024, v0
 v_mul_u32_u24 v3, 52429, v2
 v_lshrrev_b32 v3, 22, v3
 v_add_u32 v3, v3, v2
 v_lshlrev_b32 v3, 4, v3
 s_waitcnt vmcnt(15)
 ds_write_b128 v3, v[80:83]
 v_add_u32 v2, 1280, v0
 v_mul_u32_u24 v3, 52429, v2
 v_lshrrev_b32 v3, 22, v3
 v_add_u32 v3, v3, v2
 v_lshlrev_b32 v3, 4, v3
 s_waitcnt vmcnt(14)
 ds_write_b128 v3, v[84:87]
 v_add_u32 v2, 1536, v0
 v_mul_u32_u24 v3, 52429, v2
 v_lshrrev_b32 v3, 22, v3
 v_add_u32 v3, v3, v2
 v_lshlrev_b32 v3, 4, v3
 s_waitcnt vmcnt(13)
 ds_write_b128 v3, v[88:91]
 v_add_u32 v2, 1792, v0
 v_mul_u32_u24 v3, 52429, v2
 v_lshrrev_b32 v3, 22, v3
 v_add_u32 v3, v3, v2
 v_lshlrev_b32 v3, 4, v3
 s_waitcnt vmcnt(12)
 ds_write_b128 v3, v[92:95]
 v_add_u32 v2, 2048, v0
 v_mul_u32_u24 v3, 52429, v2
 v_lshrrev_b32 v3, 22, v3
 v_add_u32 v3, v3, v2
 v_lshlrev_b32 v3, 4, v3
 s_waitcnt vmcnt(11)
 ds_write_b128 v3, v[96:99]
 v_add_u32 v2, 2304, v0
 v_mul_u32_u24 v3, 52429, v2
 v_lshrrev_b32 v3, 22, v3
 v_add_u32 v3, v3, v2
 v_lshlrev_b32 v3, 4, v3
 s_waitcnt vmcnt(10)
 ds_write_b128 v3, v[100:103]
 v_add_u32 v2, 2560, v0
 v_mul_u32_u24 v3, 52429, v2
 v_lshrrev_b32 v3, 22, v3
 v_add_u32 v3, v3, v2
 v_lshlrev_b32 v3, 4, v3
 s_waitcnt vmcnt(9)
 ds_write_b128 v3, v[104:107]
 v_add_u32 v2, 2816, v0
 v_mul_u32_u24 v3, 52429, v2
 v_lshrrev_b32 v3, 22, v3
 v_add_u32 v3, v3, v2
 v_lshlrev_b32 v3, 4, v3
 s_waitcnt vmcnt(8)
 ds_write_b128 v3, v[108:111]
 v_add_u32 v2, 3072, v0
 v_mul_u32_u24 v3, 52429, v2
 v_lshrrev_b32 v3, 22, v3
 v_add_u32 v3, v3, v2
 v_lshlrev_b32 v3, 4, v3
 s_waitcnt vmcnt(7)
 ds_write_b128 v3, v[112:115]
 v_add_u32 v2, 3328, v0
 v_mul_u32_u24 v3, 52429, v2
 v_lshrrev_b32 v3, 22, v3
 v_add_u32 v3, v3, v2
 v_lshlrev_b32 v3, 4, v3
 s_waitcnt vmcnt(6)
 ds_write_b128 v3, v[116:119]
 v_add_u32 v2, 3584, v0
 v_mul_u32_u24 v3, 52429, v2
 v_lshrrev_b32 v3, 22, v3
 v_add_u32 v3, v3, v2
 v_lshlrev_b32 v3, 4, v3
 s_waitcnt vmcnt(5)
 ds_write_b128 v3, v[120:123]
 v_add_u32 v2, 3840, v0
 v_mul_u32_u24 v3, 52429, v2
 v_lshrrev_b32 v3, 22, v3
 v_add_u32 v3, v3, v2
 v_lshlrev_b32 v3, 4, v3
 s_waitcnt vmcnt(4)
 ds_write_b128 v3, v[124:127]
 v_add_u32 v2, 4096, v0
 v_mul_u32_u24 v3, 52429, v2
 v_lshrrev_b32 v3, 22, v3
 v_add_u32 v3, v3, v2
 v_lshlrev_b32 v3, 4, v3
 s_waitcnt vmcnt(3)
 ds_write_b128 v3, v[128:131]
 v_add_u32 v2, 4352, v0
 v_mul_u32_u24 v3, 52429, v2
 v_lshrrev_b32 v3, 22, v3
 v_add_u32 v3, v3, v2
 v_lshlrev_b32 v3, 4, v3
 s_waitcnt vmcnt(2)
 ds_write_b128 v3, v[132:135]
 v_add_u32 v2, 4608, v0
 v_mul_u32_u24 v3, 52429, v2
 v_lshrrev_b32 v3, 22, v3
 v_add_u32 v3, v3, v2
 v_lshlrev_b32 v3, 4, v3
 s_waitcnt vmcnt(1)
 ds_write_b128 v3, v[136:139]
 v_add_u32 v2, 4864, v0
 v_mul_u32_u24 v3, 52429, v2
 v_lshrrev_b32 v3, 22, v3
 v_add_u32 v3, v3, v2
 v_lshlrev_b32 v3, 4, v3
 s_waitcnt vmcnt(0)
 ds_write_b128 v3, v[140:143]
 s_waitcnt lgkmcnt(0)
 s_barrier
 s_mul_i32 s40, s33, 4
 s_mul_i32 s41, s34, 1
 s_add_u32 s40, s40, s41
 s_cmp_ge_u32 s40, 20
 s_cbranch_scc1 L_outb_1_kernel_end
 s_add_u32 s41, s40, 0
 s_mul_i32 s42, s41, 40960
 v_and_b32 v2, 63, v0
 v_lshlrev_b32 v4, 4, v2
 v_and_b32 v3, 31, v0
 v_mul_u32_u24 v5, 1296, v3
 v_bfe_u32 v6, v0, 5, 1
 v_lshlrev_b32 v6, 4, v6
 v_add_u32 v5, v5, v6
 v_add_u32 v7, 41472, v5
 v_mov_b32 v64, 0
 v_mov_b32 v65, 0
 v_mov_b32 v66, 0
 v_mov_b32 v67, 0
 v_mov_b32 v68, 0
 v_mov_b32 v69, 0
 v_mov_b32 v70, 0
 v_mov_b32 v71, 0
 v_mov_b32 v72, 0
 v_mov_b32 v73, 0
 v_mov_b32 v74, 0
 v_mov_b32 v75, 0
 v_mov_b32 v76, 0
 v_mov_b32 v77, 0
 v_mov_b32 v78, 0
 v_mov_b32 v79, 0
 v_mov_b32 v80, 0
 v_mov_b32 v81, 0
 v_mov_b32 v82, 0
 v_mov_b32 v83, 0
 v_mov_b32 v84, 0
 v_mov_b32 v85, 0
 v_mov_b32 v86, 0
 v_mov_b32 v87, 0
 v_mov_b32 v88, 0
 v_mov_b32 v89, 0
 v_mov_b32 v90, 0
 v_mov_b32 v91, 0
 v_mov_b32 v92, 0
 v_mov_b32 v93, 0
 v_mov_b32 v94, 0
 v_mov_b32 v95, 0
 s_add_u32 s20, s4, 6291456
 s_addc_u32 s21, s5, 0
 s_mov_b32 s22, 2621440
 s_mov_b32 s23, 0x00020000
 s_add_u32 s24, s4, 9437184
 s_addc_u32 s25, s5, 0
 s_mov_b32 s26, 2621440
 s_mov_b32 s27, 0x00020000
 buffer_load_dwordx4 v[128:131], v4, s[12:15], s42 offen
 s_add_u32 s42, s42, 1024
 buffer_load_dwordx4 v[132:135], v4, s[12:15], s42 offen
 s_add_u32 s42, s42, 1024
 buffer_load_dwordx4 v[136:139], v4, s[12:15], s42 offen
 s_add_u32 s42, s42, 1024
 buffer_load_dwordx4 v[140:143], v4, s[12:15], s42 offen
 s_add_u32 s42, s42, 1024
 ds_read_b128 v[160:163], v5 offset:0
 ds_read_b128 v[164:167], v7 offset:0
 ds_read_b128 v[168:171], v5 offset:32
 ds_read_b128 v[172:175], v7 offset:32
 s_waitcnt vmcnt(3) lgkmcnt(2)
 v_mfma_f32_32x32x16_bf16 v[64:79], v[128:131], v[160:163], v[64:79]
 v_mfma_f32_32x32x16_bf16 v[80:95], v[128:131], v[164:167], v[80:95]
 buffer_load_dwordx4 v[128:131], v4, s[12:15], s42 offen
 s_add_u32 s42, s42, 1024
 ds_read_b128 v[160:163], v5 offset:64
 ds_read_b128 v[164:167], v7 offset:64
 s_waitcnt vmcnt(3) lgkmcnt(2)
 v_mfma_f32_32x32x16_bf16 v[64:79], v[132:135], v[168:171], v[64:79]
 v_mfma_f32_32x32x16_bf16 v[80:95], v[132:135], v[172:175], v[80:95]
 buffer_load_dwordx4 v[132:135], v4, s[12:15], s42 offen
 s_add_u32 s42, s42, 1024
 ds_read_b128 v[168:171], v5 offset:96
 ds_read_b128 v[172:175], v7 offset:96
 s_waitcnt vmcnt(3) lgkmcnt(2)
 v_mfma_f32_32x32x16_bf16 v[64:79], v[136:139], v[160:163], v[64:79]
 v_mfma_f32_32x32x16_bf16 v[80:95], v[136:139], v[164:167], v[80:95]
 buffer_load_dwordx4 v[136:139], v4, s[12:15], s42 offen
 s_add_u32 s42, s42, 1024
 ds_read_b128 v[160:163], v5 offset:128
 ds_read_b128 v[164:167], v7 offset:128
 s_waitcnt vmcnt(3) lgkmcnt(2)
 v_mfma_f32_32x32x16_bf16 v[64:79], v[140:143], v[168:171], v[64:79]
 v_mfma_f32_32x32x16_bf16 v[80:95], v[140:143], v[172:175], v[80:95]
 buffer_load_dwordx4 v[140:143], v4, s[12:15], s42 offen
 s_add_u32 s42, s42, 1024
 ds_read_b128 v[168:171], v5 offset:160
 ds_read_b128 v[172:175], v7 offset:160
 s_waitcnt vmcnt(3) lgkmcnt(2)
 v_mfma_f32_32x32x16_bf16 v[64:79], v[128:131], v[160:163], v[64:79]
 v_mfma_f32_32x32x16_bf16 v[80:95], v[128:131], v[164:167], v[80:95]
 buffer_load_dwordx4 v[128:131], v4, s[12:15], s42 offen
 s_add_u32 s42, s42, 1024
 ds_read_b128 v[160:163], v5 offset:192
 ds_read_b128 v[164:167], v7 offset:192
 s_waitcnt vmcnt(3) lgkmcnt(2)
 v_mfma_f32_32x32x16_bf16 v[64:79], v[132:135], v[168:171], v[64:79]
 v_mfma_f32_32x32x16_bf16 v[80:95], v[132:135], v[172:175], v[80:95]
 buffer_load_dwordx4 v[132:135], v4, s[12:15], s42 offen
 s_add_u32 s42, s42, 1024
 ds_read_b128 v[168:171], v5 offset:224
 ds_read_b128 v[172:175], v7 offset:224
 s_waitcnt vmcnt(3) lgkmcnt(2)
 v_mfma_f32_32x32x16_bf16 v[64:79], v[136:139], v[160:163], v[64:79]
 v_mfma_f32_32x32x16_bf16 v[80:95], v[136:139], v[164:167], v[80:95]
 buffer_load_dwordx4 v[136:139], v4, s[12:15], s42 offen
 s_add_u32 s42, s42, 1024
 ds_read_b128 v[160:163], v5 offset:256
 ds_read_b128 v[164:167], v7 offset:256
 s_waitcnt vmcnt(3) lgkmcnt(2)
 v_mfma_f32_32x32x16_bf16 v[64:79], v[140:143], v[168:171], v[64:79]
 v_mfma_f32_32x32x16_bf16 v[80:95], v[140:143], v[172:175], v[80:95]
 buffer_load_dwordx4 v[140:143], v4, s[12:15], s42 offen
 s_add_u32 s42, s42, 1024
 ds_read_b128 v[168:171], v5 offset:288
 ds_read_b128 v[172:175], v7 offset:288
 s_waitcnt vmcnt(3) lgkmcnt(2)
 v_mfma_f32_32x32x16_bf16 v[64:79], v[128:131], v[160:163], v[64:79]
 v_mfma_f32_32x32x16_bf16 v[80:95], v[128:131], v[164:167], v[80:95]
 buffer_load_dwordx4 v[128:131], v4, s[12:15], s42 offen
 s_add_u32 s42, s42, 1024
 ds_read_b128 v[160:163], v5 offset:320
 ds_read_b128 v[164:167], v7 offset:320
 s_waitcnt vmcnt(3) lgkmcnt(2)
 v_mfma_f32_32x32x16_bf16 v[64:79], v[132:135], v[168:171], v[64:79]
 v_mfma_f32_32x32x16_bf16 v[80:95], v[132:135], v[172:175], v[80:95]
 buffer_load_dwordx4 v[132:135], v4, s[12:15], s42 offen
 s_add_u32 s42, s42, 1024
 ds_read_b128 v[168:171], v5 offset:352
 ds_read_b128 v[172:175], v7 offset:352
 s_waitcnt vmcnt(3) lgkmcnt(2)
 v_mfma_f32_32x32x16_bf16 v[64:79], v[136:139], v[160:163], v[64:79]
 v_mfma_f32_32x32x16_bf16 v[80:95], v[136:139], v[164:167], v[80:95]
 buffer_load_dwordx4 v[136:139], v4, s[12:15], s42 offen
 s_add_u32 s42, s42, 1024
 ds_read_b128 v[160:163], v5 offset:384
 ds_read_b128 v[164:167], v7 offset:384
 s_waitcnt vmcnt(3) lgkmcnt(2)
 v_mfma_f32_32x32x16_bf16 v[64:79], v[140:143], v[168:171], v[64:79]
 v_mfma_f32_32x32x16_bf16 v[80:95], v[140:143], v[172:175], v[80:95]
 buffer_load_dwordx4 v[140:143], v4, s[12:15], s42 offen
 s_add_u32 s42, s42, 1024
 ds_read_b128 v[168:171], v5 offset:416
 ds_read_b128 v[172:175], v7 offset:416
 s_waitcnt vmcnt(3) lgkmcnt(2)
 v_mfma_f32_32x32x16_bf16 v[64:79], v[128:131], v[160:163], v[64:79]
 v_mfma_f32_32x32x16_bf16 v[80:95], v[128:131], v[164:167], v[80:95]
 buffer_load_dwordx4 v[128:131], v4, s[12:15], s42 offen
 s_add_u32 s42, s42, 1024
 ds_read_b128 v[160:163], v5 offset:448
 ds_read_b128 v[164:167], v7 offset:448
 s_waitcnt vmcnt(3) lgkmcnt(2)
 v_mfma_f32_32x32x16_bf16 v[64:79], v[132:135], v[168:171], v[64:79]
 v_mfma_f32_32x32x16_bf16 v[80:95], v[132:135], v[172:175], v[80:95]
 buffer_load_dwordx4 v[132:135], v4, s[12:15], s42 offen
 s_add_u32 s42, s42, 1024
 ds_read_b128 v[168:171], v5 offset:480
 ds_read_b128 v[172:175], v7 offset:480
 s_waitcnt vmcnt(3) lgkmcnt(2)
 v_mfma_f32_32x32x16_bf16 v[64:79], v[136:139], v[160:163], v[64:79]
 v_mfma_f32_32x32x16_bf16 v[80:95], v[136:139], v[164:167], v[80:95]
 buffer_load_dwordx4 v[136:139], v4, s[12:15], s42 offen
 s_add_u32 s42, s42, 1024
 ds_read_b128 v[160:163], v5 offset:512
 ds_read_b128 v[164:167], v7 offset:512
 s_waitcnt vmcnt(3) lgkmcnt(2)
 v_mfma_f32_32x32x16_bf16 v[64:79], v[140:143], v[168:171], v[64:79]
 v_mfma_f32_32x32x16_bf16 v[80:95], v[140:143], v[172:175], v[80:95]
 buffer_load_dwordx4 v[140:143], v4, s[12:15], s42 offen
 s_add_u32 s42, s42, 1024
 ds_read_b128 v[168:171], v5 offset:544
 ds_read_b128 v[172:175], v7 offset:544
 s_waitcnt vmcnt(3) lgkmcnt(2)
 v_mfma_f32_32x32x16_bf16 v[64:79], v[128:131], v[160:163], v[64:79]
 v_mfma_f32_32x32x16_bf16 v[80:95], v[128:131], v[164:167], v[80:95]
 buffer_load_dwordx4 v[128:131], v4, s[12:15], s42 offen
 s_add_u32 s42, s42, 1024
 ds_read_b128 v[160:163], v5 offset:576
 ds_read_b128 v[164:167], v7 offset:576
 s_waitcnt vmcnt(3) lgkmcnt(2)
 v_mfma_f32_32x32x16_bf16 v[64:79], v[132:135], v[168:171], v[64:79]
 v_mfma_f32_32x32x16_bf16 v[80:95], v[132:135], v[172:175], v[80:95]
 buffer_load_dwordx4 v[132:135], v4, s[12:15], s42 offen
 s_add_u32 s42, s42, 1024
 ds_read_b128 v[168:171], v5 offset:608
 ds_read_b128 v[172:175], v7 offset:608
 s_waitcnt vmcnt(3) lgkmcnt(2)
 v_mfma_f32_32x32x16_bf16 v[64:79], v[136:139], v[160:163], v[64:79]
 v_mfma_f32_32x32x16_bf16 v[80:95], v[136:139], v[164:167], v[80:95]
 buffer_load_dwordx4 v[136:139], v4, s[12:15], s42 offen
 s_add_u32 s42, s42, 1024
 ds_read_b128 v[160:163], v5 offset:640
 ds_read_b128 v[164:167], v7 offset:640
 s_waitcnt vmcnt(3) lgkmcnt(2)
 v_mfma_f32_32x32x16_bf16 v[64:79], v[140:143], v[168:171], v[64:79]
 v_mfma_f32_32x32x16_bf16 v[80:95], v[140:143], v[172:175], v[80:95]
 buffer_load_dwordx4 v[140:143], v4, s[12:15], s42 offen
 s_add_u32 s42, s42, 1024
 ds_read_b128 v[168:171], v5 offset:672
 ds_read_b128 v[172:175], v7 offset:672
 s_waitcnt vmcnt(3) lgkmcnt(2)
 v_mfma_f32_32x32x16_bf16 v[64:79], v[128:131], v[160:163], v[64:79]
 v_mfma_f32_32x32x16_bf16 v[80:95], v[128:131], v[164:167], v[80:95]
 buffer_load_dwordx4 v[128:131], v4, s[12:15], s42 offen
 s_add_u32 s42, s42, 1024
 ds_read_b128 v[160:163], v5 offset:704
 ds_read_b128 v[164:167], v7 offset:704
 s_waitcnt vmcnt(3) lgkmcnt(2)
 v_mfma_f32_32x32x16_bf16 v[64:79], v[132:135], v[168:171], v[64:79]
 v_mfma_f32_32x32x16_bf16 v[80:95], v[132:135], v[172:175], v[80:95]
 buffer_load_dwordx4 v[132:135], v4, s[12:15], s42 offen
 s_add_u32 s42, s42, 1024
 ds_read_b128 v[168:171], v5 offset:736
 ds_read_b128 v[172:175], v7 offset:736
 s_waitcnt vmcnt(3) lgkmcnt(2)
 v_mfma_f32_32x32x16_bf16 v[64:79], v[136:139], v[160:163], v[64:79]
 v_mfma_f32_32x32x16_bf16 v[80:95], v[136:139], v[164:167], v[80:95]
 buffer_load_dwordx4 v[136:139], v4, s[12:15], s42 offen
 s_add_u32 s42, s42, 1024
 ds_read_b128 v[160:163], v5 offset:768
 ds_read_b128 v[164:167], v7 offset:768
 s_waitcnt vmcnt(3) lgkmcnt(2)
 v_mfma_f32_32x32x16_bf16 v[64:79], v[140:143], v[168:171], v[64:79]
 v_mfma_f32_32x32x16_bf16 v[80:95], v[140:143], v[172:175], v[80:95]
 buffer_load_dwordx4 v[140:143], v4, s[12:15], s42 offen
 s_add_u32 s42, s42, 1024
 ds_read_b128 v[168:171], v5 offset:800
 ds_read_b128 v[172:175], v7 offset:800
 s_waitcnt vmcnt(3) lgkmcnt(2)
 v_mfma_f32_32x32x16_bf16 v[64:79], v[128:131], v[160:163], v[64:79]
 v_mfma_f32_32x32x16_bf16 v[80:95], v[128:131], v[164:167], v[80:95]
 buffer_load_dwordx4 v[128:131], v4, s[12:15], s42 offen
 s_add_u32 s42, s42, 1024
 ds_read_b128 v[160:163], v5 offset:832
 ds_read_b128 v[164:167], v7 offset:832
 s_waitcnt vmcnt(3) lgkmcnt(2)
 v_mfma_f32_32x32x16_bf16 v[64:79], v[132:135], v[168:171], v[64:79]
 v_mfma_f32_32x32x16_bf16 v[80:95], v[132:135], v[172:175], v[80:95]
 buffer_load_dwordx4 v[132:135], v4, s[12:15], s42 offen
 s_add_u32 s42, s42, 1024
 ds_read_b128 v[168:171], v5 offset:864
 ds_read_b128 v[172:175], v7 offset:864
 s_waitcnt vmcnt(3) lgkmcnt(2)
 v_mfma_f32_32x32x16_bf16 v[64:79], v[136:139], v[160:163], v[64:79]
 v_mfma_f32_32x32x16_bf16 v[80:95], v[136:139], v[164:167], v[80:95]
 buffer_load_dwordx4 v[136:139], v4, s[12:15], s42 offen
 s_add_u32 s42, s42, 1024
 ds_read_b128 v[160:163], v5 offset:896
 ds_read_b128 v[164:167], v7 offset:896
 s_waitcnt vmcnt(3) lgkmcnt(2)
 v_mfma_f32_32x32x16_bf16 v[64:79], v[140:143], v[168:171], v[64:79]
 v_mfma_f32_32x32x16_bf16 v[80:95], v[140:143], v[172:175], v[80:95]
 buffer_load_dwordx4 v[140:143], v4, s[12:15], s42 offen
 s_add_u32 s42, s42, 1024
 ds_read_b128 v[168:171], v5 offset:928
 ds_read_b128 v[172:175], v7 offset:928
 s_waitcnt vmcnt(3) lgkmcnt(2)
 v_mfma_f32_32x32x16_bf16 v[64:79], v[128:131], v[160:163], v[64:79]
 v_mfma_f32_32x32x16_bf16 v[80:95], v[128:131], v[164:167], v[80:95]
 buffer_load_dwordx4 v[128:131], v4, s[12:15], s42 offen
 s_add_u32 s42, s42, 1024
 ds_read_b128 v[160:163], v5 offset:960
 ds_read_b128 v[164:167], v7 offset:960
 s_waitcnt vmcnt(3) lgkmcnt(2)
 v_mfma_f32_32x32x16_bf16 v[64:79], v[132:135], v[168:171], v[64:79]
 v_mfma_f32_32x32x16_bf16 v[80:95], v[132:135], v[172:175], v[80:95]
 buffer_load_dwordx4 v[132:135], v4, s[12:15], s42 offen
 s_add_u32 s42, s42, 1024
 ds_read_b128 v[168:171], v5 offset:992
 ds_read_b128 v[172:175], v7 offset:992
 s_waitcnt vmcnt(3) lgkmcnt(2)
 v_mfma_f32_32x32x16_bf16 v[64:79], v[136:139], v[160:163], v[64:79]
 v_mfma_f32_32x32x16_bf16 v[80:95], v[136:139], v[164:167], v[80:95]
 buffer_load_dwordx4 v[136:139], v4, s[12:15], s42 offen
 s_add_u32 s42, s42, 1024
 ds_read_b128 v[160:163], v5 offset:1024
 ds_read_b128 v[164:167], v7 offset:1024
 s_waitcnt vmcnt(3) lgkmcnt(2)
 v_mfma_f32_32x32x16_bf16 v[64:79], v[140:143], v[168:171], v[64:79]
 v_mfma_f32_32x32x16_bf16 v[80:95], v[140:143], v[172:175], v[80:95]
 buffer_load_dwordx4 v[140:143], v4, s[12:15], s42 offen
 s_add_u32 s42, s42, 1024
 ds_read_b128 v[168:171], v5 offset:1056
 ds_read_b128 v[172:175], v7 offset:1056
 s_waitcnt vmcnt(3) lgkmcnt(2)
 v_mfma_f32_32x32x16_bf16 v[64:79], v[128:131], v[160:163], v[64:79]
 v_mfma_f32_32x32x16_bf16 v[80:95], v[128:131], v[164:167], v[80:95]
 buffer_load_dwordx4 v[128:131], v4, s[12:15], s42 offen
 s_add_u32 s42, s42, 1024
 ds_read_b128 v[160:163], v5 offset:1088
 ds_read_b128 v[164:167], v7 offset:1088
 s_waitcnt vmcnt(3) lgkmcnt(2)
 v_mfma_f32_32x32x16_bf16 v[64:79], v[132:135], v[168:171], v[64:79]
 v_mfma_f32_32x32x16_bf16 v[80:95], v[132:135], v[172:175], v[80:95]
 buffer_load_dwordx4 v[132:135], v4, s[12:15], s42 offen
 s_add_u32 s42, s42, 1024
 ds_read_b128 v[168:171], v5 offset:1120
 ds_read_b128 v[172:175], v7 offset:1120
 s_waitcnt vmcnt(3) lgkmcnt(2)
 v_mfma_f32_32x32x16_bf16 v[64:79], v[136:139], v[160:163], v[64:79]
 v_mfma_f32_32x32x16_bf16 v[80:95], v[136:139], v[164:167], v[80:95]
 buffer_load_dwordx4 v[136:139], v4, s[12:15], s42 offen
 s_add_u32 s42, s42, 1024
 ds_read_b128 v[160:163], v5 offset:1152
 ds_read_b128 v[164:167], v7 offset:1152
 s_waitcnt vmcnt(3) lgkmcnt(2)
 v_mfma_f32_32x32x16_bf16 v[64:79], v[140:143], v[168:171], v[64:79]
 v_mfma_f32_32x32x16_bf16 v[80:95], v[140:143], v[172:175], v[80:95]
 buffer_load_dwordx4 v[140:143], v4, s[12:15], s42 offen
 s_add_u32 s42, s42, 1024
 ds_read_b128 v[168:171], v5 offset:1184
 ds_read_b128 v[172:175], v7 offset:1184
 s_waitcnt vmcnt(3) lgkmcnt(2)
 v_mfma_f32_32x32x16_bf16 v[64:79], v[128:131], v[160:163], v[64:79]
 v_mfma_f32_32x32x16_bf16 v[80:95], v[128:131], v[164:167], v[80:95]
 ds_read_b128 v[160:163], v5 offset:1216
 ds_read_b128 v[164:167], v7 offset:1216
 s_waitcnt vmcnt(2) lgkmcnt(2)
 v_mfma_f32_32x32x16_bf16 v[64:79], v[132:135], v[168:171], v[64:79]
 v_mfma_f32_32x32x16_bf16 v[80:95], v[132:135], v[172:175], v[80:95]
 ds_read_b128 v[168:171], v5 offset:1248
 ds_read_b128 v[172:175], v7 offset:1248
 s_waitcnt vmcnt(1) lgkmcnt(2)
 v_mfma_f32_32x32x16_bf16 v[64:79], v[136:139], v[160:163], v[64:79]
 v_mfma_f32_32x32x16_bf16 v[80:95], v[136:139], v[164:167], v[80:95]
 s_waitcnt vmcnt(0) lgkmcnt(0)
 v_mfma_f32_32x32x16_bf16 v[64:79], v[140:143], v[168:171], v[64:79]
 v_mfma_f32_32x32x16_bf16 v[80:95], v[140:143], v[172:175], v[80:95]
 s_nop 11
 v_bfe_u32 v8, v0, 5, 1
 v_lshlrev_b32 v8, 3, v8
 v_and_b32 v9, 31, v0
 v_mul_u32_u24 v9, 1280, v9
 v_add_u32 v8, v8, v9
 s_lshl_b32 s46, s40, 6
 s_add_u32 s46, s46, s35
 v_add_u32 v9, 40960, v8
 buffer_load_dwordx2 v[12:13], v8, s[20:23], s46 offen offset:0
 buffer_load_dwordx2 v[14:15], v8, s[20:23], s46 offen offset:16
 buffer_load_dwordx2 v[16:17], v8, s[20:23], s46 offen offset:32
 buffer_load_dwordx2 v[18:19], v8, s[20:23], s46 offen offset:48
 buffer_load_dwordx2 v[20:21], v9, s[20:23], s46 offen offset:0
 buffer_load_dwordx2 v[22:23], v9, s[20:23], s46 offen offset:16
 buffer_load_dwordx2 v[24:25], v9, s[20:23], s46 offen offset:32
 buffer_load_dwordx2 v[26:27], v9, s[20:23], s46 offen offset:48
 s_waitcnt vmcnt(7)
 v_lshlrev_b32 v32, 16, v12
 v_and_b32 v33, 0xffff0000, v12
 v_lshlrev_b32 v34, 16, v13
 v_and_b32 v35, 0xffff0000, v13
 v_add_f32 v32, v32, v64
 v_add_f32 v33, v33, v65
 v_add_f32 v34, v34, v66
 v_add_f32 v35, v35, v67
 v_cvt_pk_bf16_f32 v36, v32, v33
 v_cvt_pk_bf16_f32 v37, v34, v35
 buffer_store_dwordx2 v[36:37], v8, s[24:27], s46 offen offset:0
 s_waitcnt vmcnt(7)
 v_lshlrev_b32 v32, 16, v14
 v_and_b32 v33, 0xffff0000, v14
 v_lshlrev_b32 v34, 16, v15
 v_and_b32 v35, 0xffff0000, v15
 v_add_f32 v32, v32, v68
 v_add_f32 v33, v33, v69
 v_add_f32 v34, v34, v70
 v_add_f32 v35, v35, v71
 v_cvt_pk_bf16_f32 v36, v32, v33
 v_cvt_pk_bf16_f32 v37, v34, v35
 buffer_store_dwordx2 v[36:37], v8, s[24:27], s46 offen offset:16
 s_waitcnt vmcnt(7)
 v_lshlrev_b32 v32, 16, v16
 v_and_b32 v33, 0xffff0000, v16
 v_lshlrev_b32 v34, 16, v17
 v_and_b32 v35, 0xffff0000, v17
 v_add_f32 v32, v32, v72
 v_add_f32 v33, v33, v73
 v_add_f32 v34, v34, v74
 v_add_f32 v35, v35, v75
 v_cvt_pk_bf16_f32 v36, v32, v33
 v_cvt_pk_bf16_f32 v37, v34, v35
 buffer_store_dwordx2 v[36:37], v8, s[24:27], s46 offen offset:32
 s_waitcnt vmcnt(7)
 v_lshlrev_b32 v32, 16, v18
 v_and_b32 v33, 0xffff0000, v18
 v_lshlrev_b32 v34, 16, v19
 v_and_b32 v35, 0xffff0000, v19
 v_add_f32 v32, v32, v76
 v_add_f32 v33, v33, v77
 v_add_f32 v34, v34, v78
 v_add_f32 v35, v35, v79
 v_cvt_pk_bf16_f32 v36, v32, v33
 v_cvt_pk_bf16_f32 v37, v34, v35
 buffer_store_dwordx2 v[36:37], v8, s[24:27], s46 offen offset:48
 s_waitcnt vmcnt(7)
 v_lshlrev_b32 v32, 16, v20
 v_and_b32 v33, 0xffff0000, v20
 v_lshlrev_b32 v34, 16, v21
 v_and_b32 v35, 0xffff0000, v21
 v_add_f32 v32, v32, v80
 v_add_f32 v33, v33, v81
 v_add_f32 v34, v34, v82
 v_add_f32 v35, v35, v83
 v_cvt_pk_bf16_f32 v36, v32, v33
 v_cvt_pk_bf16_f32 v37, v34, v35
 buffer_store_dwordx2 v[36:37], v9, s[24:27], s46 offen offset:0
 s_waitcnt vmcnt(7)
 v_lshlrev_b32 v32, 16, v22
 v_and_b32 v33, 0xffff0000, v22
 v_lshlrev_b32 v34, 16, v23
 v_and_b32 v35, 0xffff0000, v23
 v_add_f32 v32, v32, v84
 v_add_f32 v33, v33, v85
 v_add_f32 v34, v34, v86
 v_add_f32 v35, v35, v87
 v_cvt_pk_bf16_f32 v36, v32, v33
 v_cvt_pk_bf16_f32 v37, v34, v35
 buffer_store_dwordx2 v[36:37], v9, s[24:27], s46 offen offset:16
 s_waitcnt vmcnt(7)
 v_lshlrev_b32 v32, 16, v24
 v_and_b32 v33, 0xffff0000, v24
 v_lshlrev_b32 v34, 16, v25
 v_and_b32 v35, 0xffff0000, v25
 v_add_f32 v32, v32, v88
 v_add_f32 v33, v33, v89
 v_add_f32 v34, v34, v90
 v_add_f32 v35, v35, v91
 v_cvt_pk_bf16_f32 v36, v32, v33
 v_cvt_pk_bf16_f32 v37, v34, v35
 buffer_store_dwordx2 v[36:37], v9, s[24:27], s46 offen offset:32
 s_waitcnt vmcnt(7)
 v_lshlrev_b32 v32, 16, v26
 v_and_b32 v33, 0xffff0000, v26
 v_lshlrev_b32 v34, 16, v27
 v_and_b32 v35, 0xffff0000, v27
 v_add_f32 v32, v32, v92
 v_add_f32 v33, v33, v93
 v_add_f32 v34, v34, v94
 v_add_f32 v35, v35, v95
 v_cvt_pk_bf16_f32 v36, v32, v33
 v_cvt_pk_bf16_f32 v37, v34, v35
 buffer_store_dwordx2 v[36:37], v9, s[24:27], s46 offen offset:48
L_outb_1_kernel_end:
 s_endpgm
.globl a1_2_kernel
.p2align 8
.type a1_2_kernel,@function
a1_2_kernel:
 s_cmp_ge_u32 s2, 192
 s_cbranch_scc1 L_a1_2_kernel_end
 s_load_dwordx2 s[4:5], s[0:1], 80
 s_and_b32 s32, s2, 31
 s_lshr_b32 s33, s2, 5
 v_lshrrev_b32 v1, 6, v0
 s_nop 0
 v_readfirstlane_b32 s34, v1
 s_waitcnt lgkmcnt(0)
 s_add_u32 s8, s4, 9437184
 s_addc_u32 s9, s5, 0
 s_mov_b32 s10, 2621440
 s_mov_b32 s11, 0x00020000
 s_add_u32 s12, s4, 0
 s_addc_u32 s13, s5, 0
 s_mov_b32 s14, 901120
 s_mov_b32 s15, 0x00020000
 s_mul_i32 s35, s32, 81920
 v_add_u32 v2, 0, v0
 v_lshlrev_b32 v3, 4, v2
 buffer_load_dwordx4 v[64:67], v3, s[8:11], s35 offen
 v_add_u32 v2, 256, v0
 v_lshlrev_b32 v3, 4, v2
 buffer_load_dwordx4 v[68:71], v3, s[8:11], s35 offen
 v_add_u32 v2, 512, v0
 v_lshlrev_b32 v3, 4, v2
 buffer_load_dwordx4 v[72:75], v3, s[8:11], s35 offen
 v_add_u32 v2, 768, v0
 v_lshlrev_b32 v3, 4, v2
 buffer_load_dwordx4 v[76:79], v3, s[8:11], s35 offen
 v_add_u32 v2, 1024, v0
 v_lshlrev_b32 v3, 4, v2
 buffer_load_dwordx4 v[80:83], v3, s[8:11], s35 offen
 v_add_u32 v2, 1280, v0
 v_lshlrev_b32 v3, 4, v2
 buffer_load_dwordx4 v[84:87], v3, s[8:11], s35 offen
 v_add_u32 v2, 1536, v0
 v_lshlrev_b32 v3, 4, v2
 buffer_load_dwordx4 v[88:91], v3, s[8:11], s35 offen
 v_add_u32 v2, 1792, v0
 v_lshlrev_b32 v3, 4, v2
 buffer_load_dwordx4 v[92:95], v3, s[8:11], s35 offen
 v_add_u32 v2, 2048, v0
 v_lshlrev_b32 v3, 4, v2
 buffer_load_dwordx4 v[96:99], v3, s[8:11], s35 offen
 v_add_u32 v2, 2304, v0
 v_lshlrev_b32 v3, 4, v2
 buffer_load_dwordx4 v[100:103], v3, s[8:11], s35 offen
 v_add_u32 v2, 2560, v0
 v_lshlrev_b32 v3, 4, v2
 buffer_load_dwordx4 v[104:107], v3, s[8:11], s35 offen
 v_add_u32 v2, 2816, v0
 v_lshlrev_b32 v3, 4, v2
 buffer_load_dwordx4 v[108:111], v3, s[8:11], s35 offen
 v_add_u32 v2, 3072, v0
 v_lshlrev_b32 v3, 4, v2
 buffer_load_dwordx4 v[112:115], v3, s[8:11], s35 offen
 v_add_u32 v2, 3328, v0
 v_lshlrev_b32 v3, 4, v2
 buffer_load_dwordx4 v[116:119], v3, s[8:11], s35 offen
 v_add_u32 v2, 3584, v0
 v_lshlrev_b32 v3, 4, v2
 buffer_load_dwordx4 v[120:123], v3, s[8:11], s35 offen
 v_add_u32 v2, 3840, v0
 v_lshlrev_b32 v3, 4, v2
 buffer_load_dwordx4 v[124:127], v3, s[8:11], s35 offen
 v_add_u32 v2, 4096, v0
 v_lshlrev_b32 v3, 4, v2
 buffer_load_dwordx4 v[128:131], v3, s[8:11], s35 offen
 v_add_u32 v2, 4352, v0
 v_lshlrev_b32 v3, 4, v2
 buffer_load_dwordx4 v[132:135], v3, s[8:11], s35 offen
 v_add_u32 v2, 4608, v0
 v_lshlrev_b32 v3, 4, v2
 buffer_load_dwordx4 v[136:139], v3, s[8:11], s35 offen
 v_add_u32 v2, 4864, v0
 v_lshlrev_b32 v3, 4, v2
 buffer_load_dwordx4 v[140:143], v3, s[8:11], s35 offen
 v_add_u32 v2, 0, v0
 v_mul_u32_u24 v3, 52429, v2
 v_lshrrev_b32 v3, 22, v3
 v_add_u32 v3, v3, v2
 v_lshlrev_b32 v3, 4, v3
 s_waitcnt vmcnt(19)
 ds_write_b128 v3, v[64:67]
 v_add_u32 v2, 256, v0
 v_mul_u32_u24 v3, 52429, v2
 v_lshrrev_b32 v3, 22, v3
 v_add_u32 v3, v3, v2
 v_lshlrev_b32 v3, 4, v3
 s_waitcnt vmcnt(18)
 ds_write_b128 v3, v[68:71]
 v_add_u32 v2, 512, v0
 v_mul_u32_u24 v3, 52429, v2
 v_lshrrev_b32 v3, 22, v3
 v_add_u32 v3, v3, v2
 v_lshlrev_b32 v3, 4, v3
 s_waitcnt vmcnt(17)
 ds_write_b128 v3, v[72:75]
 v_add_u32 v2, 768, v0
 v_mul_u32_u24 v3, 52429, v2
 v_lshrrev_b32 v3, 22, v3
 v_add_u32 v3, v3, v2
 v_lshlrev_b32 v3, 4, v3
 s_waitcnt vmcnt(16)
 ds_write_b128 v3, v[76:79]
 v_add_u32 v2, 1024, v0
 v_mul_u32_u24 v3, 52429, v2
 v_lshrrev_b32 v3, 22, v3
 v_add_u32 v3, v3, v2
 v_lshlrev_b32 v3, 4, v3
 s_waitcnt vmcnt(15)
 ds_write_b128 v3, v[80:83]
 v_add_u32 v2, 1280, v0
 v_mul_u32_u24 v3, 52429, v2
 v_lshrrev_b32 v3, 22, v3
 v_add_u32 v3, v3, v2
 v_lshlrev_b32 v3, 4, v3
 s_waitcnt vmcnt(14)
 ds_write_b128 v3, v[84:87]
 v_add_u32 v2, 1536, v0
 v_mul_u32_u24 v3, 52429, v2
 v_lshrrev_b32 v3, 22, v3
 v_add_u32 v3, v3, v2
 v_lshlrev_b32 v3, 4, v3
 s_waitcnt vmcnt(13)
 ds_write_b128 v3, v[88:91]
 v_add_u32 v2, 1792, v0
 v_mul_u32_u24 v3, 52429, v2
 v_lshrrev_b32 v3, 22, v3
 v_add_u32 v3, v3, v2
 v_lshlrev_b32 v3, 4, v3
 s_waitcnt vmcnt(12)
 ds_write_b128 v3, v[92:95]
 v_add_u32 v2, 2048, v0
 v_mul_u32_u24 v3, 52429, v2
 v_lshrrev_b32 v3, 22, v3
 v_add_u32 v3, v3, v2
 v_lshlrev_b32 v3, 4, v3
 s_waitcnt vmcnt(11)
 ds_write_b128 v3, v[96:99]
 v_add_u32 v2, 2304, v0
 v_mul_u32_u24 v3, 52429, v2
 v_lshrrev_b32 v3, 22, v3
 v_add_u32 v3, v3, v2
 v_lshlrev_b32 v3, 4, v3
 s_waitcnt vmcnt(10)
 ds_write_b128 v3, v[100:103]
 v_add_u32 v2, 2560, v0
 v_mul_u32_u24 v3, 52429, v2
 v_lshrrev_b32 v3, 22, v3
 v_add_u32 v3, v3, v2
 v_lshlrev_b32 v3, 4, v3
 s_waitcnt vmcnt(9)
 ds_write_b128 v3, v[104:107]
 v_add_u32 v2, 2816, v0
 v_mul_u32_u24 v3, 52429, v2
 v_lshrrev_b32 v3, 22, v3
 v_add_u32 v3, v3, v2
 v_lshlrev_b32 v3, 4, v3
 s_waitcnt vmcnt(8)
 ds_write_b128 v3, v[108:111]
 v_add_u32 v2, 3072, v0
 v_mul_u32_u24 v3, 52429, v2
 v_lshrrev_b32 v3, 22, v3
 v_add_u32 v3, v3, v2
 v_lshlrev_b32 v3, 4, v3
 s_waitcnt vmcnt(7)
 ds_write_b128 v3, v[112:115]
 v_add_u32 v2, 3328, v0
 v_mul_u32_u24 v3, 52429, v2
 v_lshrrev_b32 v3, 22, v3
 v_add_u32 v3, v3, v2
 v_lshlrev_b32 v3, 4, v3
 s_waitcnt vmcnt(6)
 ds_write_b128 v3, v[116:119]
 v_add_u32 v2, 3584, v0
 v_mul_u32_u24 v3, 52429, v2
 v_lshrrev_b32 v3, 22, v3
 v_add_u32 v3, v3, v2
 v_lshlrev_b32 v3, 4, v3
 s_waitcnt vmcnt(5)
 ds_write_b128 v3, v[120:123]
 v_add_u32 v2, 3840, v0
 v_mul_u32_u24 v3, 52429, v2
 v_lshrrev_b32 v3, 22, v3
 v_add_u32 v3, v3, v2
 v_lshlrev_b32 v3, 4, v3
 s_waitcnt vmcnt(4)
 ds_write_b128 v3, v[124:127]
 v_add_u32 v2, 4096, v0
 v_mul_u32_u24 v3, 52429, v2
 v_lshrrev_b32 v3, 22, v3
 v_add_u32 v3, v3, v2
 v_lshlrev_b32 v3, 4, v3
 s_waitcnt vmcnt(3)
 ds_write_b128 v3, v[128:131]
 v_add_u32 v2, 4352, v0
 v_mul_u32_u24 v3, 52429, v2
 v_lshrrev_b32 v3, 22, v3
 v_add_u32 v3, v3, v2
 v_lshlrev_b32 v3, 4, v3
 s_waitcnt vmcnt(2)
 ds_write_b128 v3, v[132:135]
 v_add_u32 v2, 4608, v0
 v_mul_u32_u24 v3, 52429, v2
 v_lshrrev_b32 v3, 22, v3
 v_add_u32 v3, v3, v2
 v_lshlrev_b32 v3, 4, v3
 s_waitcnt vmcnt(1)
 ds_write_b128 v3, v[136:139]
 v_add_u32 v2, 4864, v0
 v_mul_u32_u24 v3, 52429, v2
 v_lshrrev_b32 v3, 22, v3
 v_add_u32 v3, v3, v2
 v_lshlrev_b32 v3, 4, v3
 s_waitcnt vmcnt(0)
 ds_write_b128 v3, v[140:143]
 s_waitcnt lgkmcnt(0)
 s_barrier
 s_mul_i32 s40, s33, 4
 s_mul_i32 s41, s34, 1
 s_add_u32 s40, s40, s41
 s_cmp_ge_u32 s40, 22
 s_cbranch_scc1 L_a1_2_kernel_end
 s_add_u32 s41, s40, 0
 s_mul_i32 s42, s41, 40960
 v_and_b32 v2, 63, v0
 v_lshlrev_b32 v4, 4, v2
 v_and_b32 v3, 31, v0
 v_mul_u32_u24 v5, 1296, v3
 v_bfe_u32 v6, v0, 5, 1
 v_lshlrev_b32 v6, 4, v6
 v_add_u32 v5, v5, v6
 v_add_u32 v7, 41472, v5
 v_mov_b32 v64, 0
 v_mov_b32 v65, 0
 v_mov_b32 v66, 0
 v_mov_b32 v67, 0
 v_mov_b32 v68, 0
 v_mov_b32 v69, 0
 v_mov_b32 v70, 0
 v_mov_b32 v71, 0
 v_mov_b32 v72, 0
 v_mov_b32 v73, 0
 v_mov_b32 v74, 0
 v_mov_b32 v75, 0
 v_mov_b32 v76, 0
 v_mov_b32 v77, 0
 v_mov_b32 v78, 0
 v_mov_b32 v79, 0
 v_mov_b32 v80, 0
 v_mov_b32 v81, 0
 v_mov_b32 v82, 0
 v_mov_b32 v83, 0
 v_mov_b32 v84, 0
 v_mov_b32 v85, 0
 v_mov_b32 v86, 0
 v_mov_b32 v87, 0
 v_mov_b32 v88, 0
 v_mov_b32 v89, 0
 v_mov_b32 v90, 0
 v_mov_b32 v91, 0
 v_mov_b32 v92, 0
 v_mov_b32 v93, 0
 v_mov_b32 v94, 0
 v_mov_b32 v95, 0
 v_mov_b32 v176, 0
 v_mov_b32 v177, 0
 v_mov_b32 v178, 0
 v_mov_b32 v179, 0
 v_mov_b32 v180, 0x3f803f80
 s_add_u32 s16, s4, 5767168
 s_addc_u32 s17, s5, 0
 s_mov_b32 s18, 2816
 s_mov_b32 s19, 0x00020000
 s_add_u32 s20, s4, 16777216
 s_addc_u32 s21, s5, 0
 s_mov_b32 s22, 4194304
 s_mov_b32 s23, 0x00020000
 s_add_u32 s24, s4, 20971520
 s_addc_u32 s25, s5, 0
 s_mov_b32 s26, 4194304
 s_mov_b32 s27, 0x00020000
 s_add_u32 s28, s4, 25165824
 s_addc_u32 s29, s5, 0
 s_mov_b32 s30, 4194304
 s_mov_b32 s31, 0x00020000
 s_cmp_ge_u32 s40, 21
 s_cbranch_scc1 L_a1_2_kernel_vtype
 buffer_load_dwordx4 v[128:131], v4, s[12:15], s42 offen
 s_add_u32 s42, s42, 1024
 buffer_load_dwordx4 v[132:135], v4, s[12:15], s42 offen
 s_add_u32 s42, s42, 1024
 buffer_load_dwordx4 v[136:139], v4, s[12:15], s42 offen
 s_add_u32 s42, s42, 1024
 buffer_load_dwordx4 v[140:143], v4, s[12:15], s42 offen
 s_add_u32 s42, s42, 1024
 ds_read_b128 v[160:163], v5 offset:0
 ds_read_b128 v[164:167], v7 offset:0
 ds_read_b128 v[168:171], v5 offset:32
 ds_read_b128 v[172:175], v7 offset:32
 s_waitcnt vmcnt(3) lgkmcnt(2)
 v_mfma_f32_32x32x16_bf16 v[64:79], v[128:131], v[160:163], v[64:79]
 v_mfma_f32_32x32x16_bf16 v[80:95], v[128:131], v[164:167], v[80:95]
 v_dot2c_f32_bf16 v176, v160, v180
 v_dot2c_f32_bf16 v178, v160, v160
 v_dot2c_f32_bf16 v176, v161, v180
 v_dot2c_f32_bf16 v178, v161, v161
 v_dot2c_f32_bf16 v176, v162, v180
 v_dot2c_f32_bf16 v178, v162, v162
 v_dot2c_f32_bf16 v176, v163, v180
 v_dot2c_f32_bf16 v178, v163, v163
 v_dot2c_f32_bf16 v177, v164, v180
 v_dot2c_f32_bf16 v179, v164, v164
 v_dot2c_f32_bf16 v177, v165, v180
 v_dot2c_f32_bf16 v179, v165, v165
 v_dot2c_f32_bf16 v177, v166, v180
 v_dot2c_f32_bf16 v179, v166, v166
 v_dot2c_f32_bf16 v177, v167, v180
 v_dot2c_f32_bf16 v179, v167, v167
 buffer_load_dwordx4 v[128:131], v4, s[12:15], s42 offen
 s_add_u32 s42, s42, 1024
 ds_read_b128 v[160:163], v5 offset:64
 ds_read_b128 v[164:167], v7 offset:64
 s_waitcnt vmcnt(3) lgkmcnt(2)
 v_mfma_f32_32x32x16_bf16 v[64:79], v[132:135], v[168:171], v[64:79]
 v_mfma_f32_32x32x16_bf16 v[80:95], v[132:135], v[172:175], v[80:95]
 v_dot2c_f32_bf16 v176, v168, v180
 v_dot2c_f32_bf16 v178, v168, v168
 v_dot2c_f32_bf16 v176, v169, v180
 v_dot2c_f32_bf16 v178, v169, v169
 v_dot2c_f32_bf16 v176, v170, v180
 v_dot2c_f32_bf16 v178, v170, v170
 v_dot2c_f32_bf16 v176, v171, v180
 v_dot2c_f32_bf16 v178, v171, v171
 v_dot2c_f32_bf16 v177, v172, v180
 v_dot2c_f32_bf16 v179, v172, v172
 v_dot2c_f32_bf16 v177, v173, v180
 v_dot2c_f32_bf16 v179, v173, v173
 v_dot2c_f32_bf16 v177, v174, v180
 v_dot2c_f32_bf16 v179, v174, v174
 v_dot2c_f32_bf16 v177, v175, v180
 v_dot2c_f32_bf16 v179, v175, v175
 buffer_load_dwordx4 v[132:135], v4, s[12:15], s42 offen
 s_add_u32 s42, s42, 1024
 ds_read_b128 v[168:171], v5 offset:96
 ds_read_b128 v[172:175], v7 offset:96
 s_waitcnt vmcnt(3) lgkmcnt(2)
 v_mfma_f32_32x32x16_bf16 v[64:79], v[136:139], v[160:163], v[64:79]
 v_mfma_f32_32x32x16_bf16 v[80:95], v[136:139], v[164:167], v[80:95]
 v_dot2c_f32_bf16 v176, v160, v180
 v_dot2c_f32_bf16 v178, v160, v160
 v_dot2c_f32_bf16 v176, v161, v180
 v_dot2c_f32_bf16 v178, v161, v161
 v_dot2c_f32_bf16 v176, v162, v180
 v_dot2c_f32_bf16 v178, v162, v162
 v_dot2c_f32_bf16 v176, v163, v180
 v_dot2c_f32_bf16 v178, v163, v163
 v_dot2c_f32_bf16 v177, v164, v180
 v_dot2c_f32_bf16 v179, v164, v164
 v_dot2c_f32_bf16 v177, v165, v180
 v_dot2c_f32_bf16 v179, v165, v165
 v_dot2c_f32_bf16 v177, v166, v180
 v_dot2c_f32_bf16 v179, v166, v166
 v_dot2c_f32_bf16 v177, v167, v180
 v_dot2c_f32_bf16 v179, v167, v167
 buffer_load_dwordx4 v[136:139], v4, s[12:15], s42 offen
 s_add_u32 s42, s42, 1024
 ds_read_b128 v[160:163], v5 offset:128
 ds_read_b128 v[164:167], v7 offset:128
 s_waitcnt vmcnt(3) lgkmcnt(2)
 v_mfma_f32_32x32x16_bf16 v[64:79], v[140:143], v[168:171], v[64:79]
 v_mfma_f32_32x32x16_bf16 v[80:95], v[140:143], v[172:175], v[80:95]
 v_dot2c_f32_bf16 v176, v168, v180
 v_dot2c_f32_bf16 v178, v168, v168
 v_dot2c_f32_bf16 v176, v169, v180
 v_dot2c_f32_bf16 v178, v169, v169
 v_dot2c_f32_bf16 v176, v170, v180
 v_dot2c_f32_bf16 v178, v170, v170
 v_dot2c_f32_bf16 v176, v171, v180
 v_dot2c_f32_bf16 v178, v171, v171
 v_dot2c_f32_bf16 v177, v172, v180
 v_dot2c_f32_bf16 v179, v172, v172
 v_dot2c_f32_bf16 v177, v173, v180
 v_dot2c_f32_bf16 v179, v173, v173
 v_dot2c_f32_bf16 v177, v174, v180
 v_dot2c_f32_bf16 v179, v174, v174
 v_dot2c_f32_bf16 v177, v175, v180
 v_dot2c_f32_bf16 v179, v175, v175
 buffer_load_dwordx4 v[140:143], v4, s[12:15], s42 offen
 s_add_u32 s42, s42, 1024
 ds_read_b128 v[168:171], v5 offset:160
 ds_read_b128 v[172:175], v7 offset:160
 s_waitcnt vmcnt(3) lgkmcnt(2)
 v_mfma_f32_32x32x16_bf16 v[64:79], v[128:131], v[160:163], v[64:79]
 v_mfma_f32_32x32x16_bf16 v[80:95], v[128:131], v[164:167], v[80:95]
 v_dot2c_f32_bf16 v176, v160, v180
 v_dot2c_f32_bf16 v178, v160, v160
 v_dot2c_f32_bf16 v176, v161, v180
 v_dot2c_f32_bf16 v178, v161, v161
 v_dot2c_f32_bf16 v176, v162, v180
 v_dot2c_f32_bf16 v178, v162, v162
 v_dot2c_f32_bf16 v176, v163, v180
 v_dot2c_f32_bf16 v178, v163, v163
 v_dot2c_f32_bf16 v177, v164, v180
 v_dot2c_f32_bf16 v179, v164, v164
 v_dot2c_f32_bf16 v177, v165, v180
 v_dot2c_f32_bf16 v179, v165, v165
 v_dot2c_f32_bf16 v177, v166, v180
 v_dot2c_f32_bf16 v179, v166, v166
 v_dot2c_f32_bf16 v177, v167, v180
 v_dot2c_f32_bf16 v179, v167, v167
 buffer_load_dwordx4 v[128:131], v4, s[12:15], s42 offen
 s_add_u32 s42, s42, 1024
 ds_read_b128 v[160:163], v5 offset:192
 ds_read_b128 v[164:167], v7 offset:192
 s_waitcnt vmcnt(3) lgkmcnt(2)
 v_mfma_f32_32x32x16_bf16 v[64:79], v[132:135], v[168:171], v[64:79]
 v_mfma_f32_32x32x16_bf16 v[80:95], v[132:135], v[172:175], v[80:95]
 v_dot2c_f32_bf16 v176, v168, v180
 v_dot2c_f32_bf16 v178, v168, v168
 v_dot2c_f32_bf16 v176, v169, v180
 v_dot2c_f32_bf16 v178, v169, v169
 v_dot2c_f32_bf16 v176, v170, v180
 v_dot2c_f32_bf16 v178, v170, v170
 v_dot2c_f32_bf16 v176, v171, v180
 v_dot2c_f32_bf16 v178, v171, v171
 v_dot2c_f32_bf16 v177, v172, v180
 v_dot2c_f32_bf16 v179, v172, v172
 v_dot2c_f32_bf16 v177, v173, v180
 v_dot2c_f32_bf16 v179, v173, v173
 v_dot2c_f32_bf16 v177, v174, v180
 v_dot2c_f32_bf16 v179, v174, v174
 v_dot2c_f32_bf16 v177, v175, v180
 v_dot2c_f32_bf16 v179, v175, v175
 buffer_load_dwordx4 v[132:135], v4, s[12:15], s42 offen
 s_add_u32 s42, s42, 1024
 ds_read_b128 v[168:171], v5 offset:224
 ds_read_b128 v[172:175], v7 offset:224
 s_waitcnt vmcnt(3) lgkmcnt(2)
 v_mfma_f32_32x32x16_bf16 v[64:79], v[136:139], v[160:163], v[64:79]
 v_mfma_f32_32x32x16_bf16 v[80:95], v[136:139], v[164:167], v[80:95]
 v_dot2c_f32_bf16 v176, v160, v180
 v_dot2c_f32_bf16 v178, v160, v160
 v_dot2c_f32_bf16 v176, v161, v180
 v_dot2c_f32_bf16 v178, v161, v161
 v_dot2c_f32_bf16 v176, v162, v180
 v_dot2c_f32_bf16 v178, v162, v162
 v_dot2c_f32_bf16 v176, v163, v180
 v_dot2c_f32_bf16 v178, v163, v163
 v_dot2c_f32_bf16 v177, v164, v180
 v_dot2c_f32_bf16 v179, v164, v164
 v_dot2c_f32_bf16 v177, v165, v180
 v_dot2c_f32_bf16 v179, v165, v165
 v_dot2c_f32_bf16 v177, v166, v180
 v_dot2c_f32_bf16 v179, v166, v166
 v_dot2c_f32_bf16 v177, v167, v180
 v_dot2c_f32_bf16 v179, v167, v167
 buffer_load_dwordx4 v[136:139], v4, s[12:15], s42 offen
 s_add_u32 s42, s42, 1024
 ds_read_b128 v[160:163], v5 offset:256
 ds_read_b128 v[164:167], v7 offset:256
 s_waitcnt vmcnt(3) lgkmcnt(2)
 v_mfma_f32_32x32x16_bf16 v[64:79], v[140:143], v[168:171], v[64:79]
 v_mfma_f32_32x32x16_bf16 v[80:95], v[140:143], v[172:175], v[80:95]
 v_dot2c_f32_bf16 v176, v168, v180
 v_dot2c_f32_bf16 v178, v168, v168
 v_dot2c_f32_bf16 v176, v169, v180
 v_dot2c_f32_bf16 v178, v169, v169
 v_dot2c_f32_bf16 v176, v170, v180
 v_dot2c_f32_bf16 v178, v170, v170
 v_dot2c_f32_bf16 v176, v171, v180
 v_dot2c_f32_bf16 v178, v171, v171
 v_dot2c_f32_bf16 v177, v172, v180
 v_dot2c_f32_bf16 v179, v172, v172
 v_dot2c_f32_bf16 v177, v173, v180
 v_dot2c_f32_bf16 v179, v173, v173
 v_dot2c_f32_bf16 v177, v174, v180
 v_dot2c_f32_bf16 v179, v174, v174
 v_dot2c_f32_bf16 v177, v175, v180
 v_dot2c_f32_bf16 v179, v175, v175
 buffer_load_dwordx4 v[140:143], v4, s[12:15], s42 offen
 s_add_u32 s42, s42, 1024
 ds_read_b128 v[168:171], v5 offset:288
 ds_read_b128 v[172:175], v7 offset:288
 s_waitcnt vmcnt(3) lgkmcnt(2)
 v_mfma_f32_32x32x16_bf16 v[64:79], v[128:131], v[160:163], v[64:79]
 v_mfma_f32_32x32x16_bf16 v[80:95], v[128:131], v[164:167], v[80:95]
 v_dot2c_f32_bf16 v176, v160, v180
 v_dot2c_f32_bf16 v178, v160, v160
 v_dot2c_f32_bf16 v176, v161, v180
 v_dot2c_f32_bf16 v178, v161, v161
 v_dot2c_f32_bf16 v176, v162, v180
 v_dot2c_f32_bf16 v178, v162, v162
 v_dot2c_f32_bf16 v176, v163, v180
 v_dot2c_f32_bf16 v178, v163, v163
 v_dot2c_f32_bf16 v177, v164, v180
 v_dot2c_f32_bf16 v179, v164, v164
 v_dot2c_f32_bf16 v177, v165, v180
 v_dot2c_f32_bf16 v179, v165, v165
 v_dot2c_f32_bf16 v177, v166, v180
 v_dot2c_f32_bf16 v179, v166, v166
 v_dot2c_f32_bf16 v177, v167, v180
 v_dot2c_f32_bf16 v179, v167, v167
 buffer_load_dwordx4 v[128:131], v4, s[12:15], s42 offen
 s_add_u32 s42, s42, 1024
 ds_read_b128 v[160:163], v5 offset:320
 ds_read_b128 v[164:167], v7 offset:320
 s_waitcnt vmcnt(3) lgkmcnt(2)
 v_mfma_f32_32x32x16_bf16 v[64:79], v[132:135], v[168:171], v[64:79]
 v_mfma_f32_32x32x16_bf16 v[80:95], v[132:135], v[172:175], v[80:95]
 v_dot2c_f32_bf16 v176, v168, v180
 v_dot2c_f32_bf16 v178, v168, v168
 v_dot2c_f32_bf16 v176, v169, v180
 v_dot2c_f32_bf16 v178, v169, v169
 v_dot2c_f32_bf16 v176, v170, v180
 v_dot2c_f32_bf16 v178, v170, v170
 v_dot2c_f32_bf16 v176, v171, v180
 v_dot2c_f32_bf16 v178, v171, v171
 v_dot2c_f32_bf16 v177, v172, v180
 v_dot2c_f32_bf16 v179, v172, v172
 v_dot2c_f32_bf16 v177, v173, v180
 v_dot2c_f32_bf16 v179, v173, v173
 v_dot2c_f32_bf16 v177, v174, v180
 v_dot2c_f32_bf16 v179, v174, v174
 v_dot2c_f32_bf16 v177, v175, v180
 v_dot2c_f32_bf16 v179, v175, v175
 buffer_load_dwordx4 v[132:135], v4, s[12:15], s42 offen
 s_add_u32 s42, s42, 1024
 ds_read_b128 v[168:171], v5 offset:352
 ds_read_b128 v[172:175], v7 offset:352
 s_waitcnt vmcnt(3) lgkmcnt(2)
 v_mfma_f32_32x32x16_bf16 v[64:79], v[136:139], v[160:163], v[64:79]
 v_mfma_f32_32x32x16_bf16 v[80:95], v[136:139], v[164:167], v[80:95]
 v_dot2c_f32_bf16 v176, v160, v180
 v_dot2c_f32_bf16 v178, v160, v160
 v_dot2c_f32_bf16 v176, v161, v180
 v_dot2c_f32_bf16 v178, v161, v161
 v_dot2c_f32_bf16 v176, v162, v180
 v_dot2c_f32_bf16 v178, v162, v162
 v_dot2c_f32_bf16 v176, v163, v180
 v_dot2c_f32_bf16 v178, v163, v163
 v_dot2c_f32_bf16 v177, v164, v180
 v_dot2c_f32_bf16 v179, v164, v164
 v_dot2c_f32_bf16 v177, v165, v180
 v_dot2c_f32_bf16 v179, v165, v165
 v_dot2c_f32_bf16 v177, v166, v180
 v_dot2c_f32_bf16 v179, v166, v166
 v_dot2c_f32_bf16 v177, v167, v180
 v_dot2c_f32_bf16 v179, v167, v167
 buffer_load_dwordx4 v[136:139], v4, s[12:15], s42 offen
 s_add_u32 s42, s42, 1024
 ds_read_b128 v[160:163], v5 offset:384
 ds_read_b128 v[164:167], v7 offset:384
 s_waitcnt vmcnt(3) lgkmcnt(2)
 v_mfma_f32_32x32x16_bf16 v[64:79], v[140:143], v[168:171], v[64:79]
 v_mfma_f32_32x32x16_bf16 v[80:95], v[140:143], v[172:175], v[80:95]
 v_dot2c_f32_bf16 v176, v168, v180
 v_dot2c_f32_bf16 v178, v168, v168
 v_dot2c_f32_bf16 v176, v169, v180
 v_dot2c_f32_bf16 v178, v169, v169
 v_dot2c_f32_bf16 v176, v170, v180
 v_dot2c_f32_bf16 v178, v170, v170
 v_dot2c_f32_bf16 v176, v171, v180
 v_dot2c_f32_bf16 v178, v171, v171
 v_dot2c_f32_bf16 v177, v172, v180
 v_dot2c_f32_bf16 v179, v172, v172
 v_dot2c_f32_bf16 v177, v173, v180
 v_dot2c_f32_bf16 v179, v173, v173
 v_dot2c_f32_bf16 v177, v174, v180
 v_dot2c_f32_bf16 v179, v174, v174
 v_dot2c_f32_bf16 v177, v175, v180
 v_dot2c_f32_bf16 v179, v175, v175
 buffer_load_dwordx4 v[140:143], v4, s[12:15], s42 offen
 s_add_u32 s42, s42, 1024
 ds_read_b128 v[168:171], v5 offset:416
 ds_read_b128 v[172:175], v7 offset:416
 s_waitcnt vmcnt(3) lgkmcnt(2)
 v_mfma_f32_32x32x16_bf16 v[64:79], v[128:131], v[160:163], v[64:79]
 v_mfma_f32_32x32x16_bf16 v[80:95], v[128:131], v[164:167], v[80:95]
 v_dot2c_f32_bf16 v176, v160, v180
 v_dot2c_f32_bf16 v178, v160, v160
 v_dot2c_f32_bf16 v176, v161, v180
 v_dot2c_f32_bf16 v178, v161, v161
 v_dot2c_f32_bf16 v176, v162, v180
 v_dot2c_f32_bf16 v178, v162, v162
 v_dot2c_f32_bf16 v176, v163, v180
 v_dot2c_f32_bf16 v178, v163, v163
 v_dot2c_f32_bf16 v177, v164, v180
 v_dot2c_f32_bf16 v179, v164, v164
 v_dot2c_f32_bf16 v177, v165, v180
 v_dot2c_f32_bf16 v179, v165, v165
 v_dot2c_f32_bf16 v177, v166, v180
 v_dot2c_f32_bf16 v179, v166, v166
 v_dot2c_f32_bf16 v177, v167, v180
 v_dot2c_f32_bf16 v179, v167, v167
 buffer_load_dwordx4 v[128:131], v4, s[12:15], s42 offen
 s_add_u32 s42, s42, 1024
 ds_read_b128 v[160:163], v5 offset:448
 ds_read_b128 v[164:167], v7 offset:448
 s_waitcnt vmcnt(3) lgkmcnt(2)
 v_mfma_f32_32x32x16_bf16 v[64:79], v[132:135], v[168:171], v[64:79]
 v_mfma_f32_32x32x16_bf16 v[80:95], v[132:135], v[172:175], v[80:95]
 v_dot2c_f32_bf16 v176, v168, v180
 v_dot2c_f32_bf16 v178, v168, v168
 v_dot2c_f32_bf16 v176, v169, v180
 v_dot2c_f32_bf16 v178, v169, v169
 v_dot2c_f32_bf16 v176, v170, v180
 v_dot2c_f32_bf16 v178, v170, v170
 v_dot2c_f32_bf16 v176, v171, v180
 v_dot2c_f32_bf16 v178, v171, v171
 v_dot2c_f32_bf16 v177, v172, v180
 v_dot2c_f32_bf16 v179, v172, v172
 v_dot2c_f32_bf16 v177, v173, v180
 v_dot2c_f32_bf16 v179, v173, v173
 v_dot2c_f32_bf16 v177, v174, v180
 v_dot2c_f32_bf16 v179, v174, v174
 v_dot2c_f32_bf16 v177, v175, v180
 v_dot2c_f32_bf16 v179, v175, v175
 buffer_load_dwordx4 v[132:135], v4, s[12:15], s42 offen
 s_add_u32 s42, s42, 1024
 ds_read_b128 v[168:171], v5 offset:480
 ds_read_b128 v[172:175], v7 offset:480
 s_waitcnt vmcnt(3) lgkmcnt(2)
 v_mfma_f32_32x32x16_bf16 v[64:79], v[136:139], v[160:163], v[64:79]
 v_mfma_f32_32x32x16_bf16 v[80:95], v[136:139], v[164:167], v[80:95]
 v_dot2c_f32_bf16 v176, v160, v180
 v_dot2c_f32_bf16 v178, v160, v160
 v_dot2c_f32_bf16 v176, v161, v180
 v_dot2c_f32_bf16 v178, v161, v161
 v_dot2c_f32_bf16 v176, v162, v180
 v_dot2c_f32_bf16 v178, v162, v162
 v_dot2c_f32_bf16 v176, v163, v180
 v_dot2c_f32_bf16 v178, v163, v163
 v_dot2c_f32_bf16 v177, v164, v180
 v_dot2c_f32_bf16 v179, v164, v164
 v_dot2c_f32_bf16 v177, v165, v180
 v_dot2c_f32_bf16 v179, v165, v165
 v_dot2c_f32_bf16 v177, v166, v180
 v_dot2c_f32_bf16 v179, v166, v166
 v_dot2c_f32_bf16 v177, v167, v180
 v_dot2c_f32_bf16 v179, v167, v167
 buffer_load_dwordx4 v[136:139], v4, s[12:15], s42 offen
 s_add_u32 s42, s42, 1024
 ds_read_b128 v[160:163], v5 offset:512
 ds_read_b128 v[164:167], v7 offset:512
 s_waitcnt vmcnt(3) lgkmcnt(2)
 v_mfma_f32_32x32x16_bf16 v[64:79], v[140:143], v[168:171], v[64:79]
 v_mfma_f32_32x32x16_bf16 v[80:95], v[140:143], v[172:175], v[80:95]
 v_dot2c_f32_bf16 v176, v168, v180
 v_dot2c_f32_bf16 v178, v168, v168
 v_dot2c_f32_bf16 v176, v169, v180
 v_dot2c_f32_bf16 v178, v169, v169
 v_dot2c_f32_bf16 v176, v170, v180
 v_dot2c_f32_bf16 v178, v170, v170
 v_dot2c_f32_bf16 v176, v171, v180
 v_dot2c_f32_bf16 v178, v171, v171
 v_dot2c_f32_bf16 v177, v172, v180
 v_dot2c_f32_bf16 v179, v172, v172
 v_dot2c_f32_bf16 v177, v173, v180
 v_dot2c_f32_bf16 v179, v173, v173
 v_dot2c_f32_bf16 v177, v174, v180
 v_dot2c_f32_bf16 v179, v174, v174
 v_dot2c_f32_bf16 v177, v175, v180
 v_dot2c_f32_bf16 v179, v175, v175
 buffer_load_dwordx4 v[140:143], v4, s[12:15], s42 offen
 s_add_u32 s42, s42, 1024
 ds_read_b128 v[168:171], v5 offset:544
 ds_read_b128 v[172:175], v7 offset:544
 s_waitcnt vmcnt(3) lgkmcnt(2)
 v_mfma_f32_32x32x16_bf16 v[64:79], v[128:131], v[160:163], v[64:79]
 v_mfma_f32_32x32x16_bf16 v[80:95], v[128:131], v[164:167], v[80:95]
 v_dot2c_f32_bf16 v176, v160, v180
 v_dot2c_f32_bf16 v178, v160, v160
 v_dot2c_f32_bf16 v176, v161, v180
 v_dot2c_f32_bf16 v178, v161, v161
 v_dot2c_f32_bf16 v176, v162, v180
 v_dot2c_f32_bf16 v178, v162, v162
 v_dot2c_f32_bf16 v176, v163, v180
 v_dot2c_f32_bf16 v178, v163, v163
 v_dot2c_f32_bf16 v177, v164, v180
 v_dot2c_f32_bf16 v179, v164, v164
 v_dot2c_f32_bf16 v177, v165, v180
 v_dot2c_f32_bf16 v179, v165, v165
 v_dot2c_f32_bf16 v177, v166, v180
 v_dot2c_f32_bf16 v179, v166, v166
 v_dot2c_f32_bf16 v177, v167, v180
 v_dot2c_f32_bf16 v179, v167, v167
 buffer_load_dwordx4 v[128:131], v4, s[12:15], s42 offen
 s_add_u32 s42, s42, 1024
 ds_read_b128 v[160:163], v5 offset:576
 ds_read_b128 v[164:167], v7 offset:576
 s_waitcnt vmcnt(3) lgkmcnt(2)
 v_mfma_f32_32x32x16_bf16 v[64:79], v[132:135], v[168:171], v[64:79]
 v_mfma_f32_32x32x16_bf16 v[80:95], v[132:135], v[172:175], v[80:95]
 v_dot2c_f32_bf16 v176, v168, v180
 v_dot2c_f32_bf16 v178, v168, v168
 v_dot2c_f32_bf16 v176, v169, v180
 v_dot2c_f32_bf16 v178, v169, v169
 v_dot2c_f32_bf16 v176, v170, v180
 v_dot2c_f32_bf16 v178, v170, v170
 v_dot2c_f32_bf16 v176, v171, v180
 v_dot2c_f32_bf16 v178, v171, v171
 v_dot2c_f32_bf16 v177, v172, v180
 v_dot2c_f32_bf16 v179, v172, v172
 v_dot2c_f32_bf16 v177, v173, v180
 v_dot2c_f32_bf16 v179, v173, v173
 v_dot2c_f32_bf16 v177, v174, v180
 v_dot2c_f32_bf16 v179, v174, v174
 v_dot2c_f32_bf16 v177, v175, v180
 v_dot2c_f32_bf16 v179, v175, v175
 buffer_load_dwordx4 v[132:135], v4, s[12:15], s42 offen
 s_add_u32 s42, s42, 1024
 ds_read_b128 v[168:171], v5 offset:608
 ds_read_b128 v[172:175], v7 offset:608
 s_waitcnt vmcnt(3) lgkmcnt(2)
 v_mfma_f32_32x32x16_bf16 v[64:79], v[136:139], v[160:163], v[64:79]
 v_mfma_f32_32x32x16_bf16 v[80:95], v[136:139], v[164:167], v[80:95]
 v_dot2c_f32_bf16 v176, v160, v180
 v_dot2c_f32_bf16 v178, v160, v160
 v_dot2c_f32_bf16 v176, v161, v180
 v_dot2c_f32_bf16 v178, v161, v161
 v_dot2c_f32_bf16 v176, v162, v180
 v_dot2c_f32_bf16 v178, v162, v162
 v_dot2c_f32_bf16 v176, v163, v180
 v_dot2c_f32_bf16 v178, v163, v163
 v_dot2c_f32_bf16 v177, v164, v180
 v_dot2c_f32_bf16 v179, v164, v164
 v_dot2c_f32_bf16 v177, v165, v180
 v_dot2c_f32_bf16 v179, v165, v165
 v_dot2c_f32_bf16 v177, v166, v180
 v_dot2c_f32_bf16 v179, v166, v166
 v_dot2c_f32_bf16 v177, v167, v180
 v_dot2c_f32_bf16 v179, v167, v167
 buffer_load_dwordx4 v[136:139], v4, s[12:15], s42 offen
 s_add_u32 s42, s42, 1024
 ds_read_b128 v[160:163], v5 offset:640
 ds_read_b128 v[164:167], v7 offset:640
 s_waitcnt vmcnt(3) lgkmcnt(2)
 v_mfma_f32_32x32x16_bf16 v[64:79], v[140:143], v[168:171], v[64:79]
 v_mfma_f32_32x32x16_bf16 v[80:95], v[140:143], v[172:175], v[80:95]
 v_dot2c_f32_bf16 v176, v168, v180
 v_dot2c_f32_bf16 v178, v168, v168
 v_dot2c_f32_bf16 v176, v169, v180
 v_dot2c_f32_bf16 v178, v169, v169
 v_dot2c_f32_bf16 v176, v170, v180
 v_dot2c_f32_bf16 v178, v170, v170
 v_dot2c_f32_bf16 v176, v171, v180
 v_dot2c_f32_bf16 v178, v171, v171
 v_dot2c_f32_bf16 v177, v172, v180
 v_dot2c_f32_bf16 v179, v172, v172
 v_dot2c_f32_bf16 v177, v173, v180
 v_dot2c_f32_bf16 v179, v173, v173
 v_dot2c_f32_bf16 v177, v174, v180
 v_dot2c_f32_bf16 v179, v174, v174
 v_dot2c_f32_bf16 v177, v175, v180
 v_dot2c_f32_bf16 v179, v175, v175
 buffer_load_dwordx4 v[140:143], v4, s[12:15], s42 offen
 s_add_u32 s42, s42, 1024
 ds_read_b128 v[168:171], v5 offset:672
 ds_read_b128 v[172:175], v7 offset:672
 s_waitcnt vmcnt(3) lgkmcnt(2)
 v_mfma_f32_32x32x16_bf16 v[64:79], v[128:131], v[160:163], v[64:79]
 v_mfma_f32_32x32x16_bf16 v[80:95], v[128:131], v[164:167], v[80:95]
 v_dot2c_f32_bf16 v176, v160, v180
 v_dot2c_f32_bf16 v178, v160, v160
 v_dot2c_f32_bf16 v176, v161, v180
 v_dot2c_f32_bf16 v178, v161, v161
 v_dot2c_f32_bf16 v176, v162, v180
 v_dot2c_f32_bf16 v178, v162, v162
 v_dot2c_f32_bf16 v176, v163, v180
 v_dot2c_f32_bf16 v178, v163, v163
 v_dot2c_f32_bf16 v177, v164, v180
 v_dot2c_f32_bf16 v179, v164, v164
 v_dot2c_f32_bf16 v177, v165, v180
 v_dot2c_f32_bf16 v179, v165, v165
 v_dot2c_f32_bf16 v177, v166, v180
 v_dot2c_f32_bf16 v179, v166, v166
 v_dot2c_f32_bf16 v177, v167, v180
 v_dot2c_f32_bf16 v179, v167, v167
 buffer_load_dwordx4 v[128:131], v4, s[12:15], s42 offen
 s_add_u32 s42, s42, 1024
 ds_read_b128 v[160:163], v5 offset:704
 ds_read_b128 v[164:167], v7 offset:704
 s_waitcnt vmcnt(3) lgkmcnt(2)
 v_mfma_f32_32x32x16_bf16 v[64:79], v[132:135], v[168:171], v[64:79]
 v_mfma_f32_32x32x16_bf16 v[80:95], v[132:135], v[172:175], v[80:95]
 v_dot2c_f32_bf16 v176, v168, v180
 v_dot2c_f32_bf16 v178, v168, v168
 v_dot2c_f32_bf16 v176, v169, v180
 v_dot2c_f32_bf16 v178, v169, v169
 v_dot2c_f32_bf16 v176, v170, v180
 v_dot2c_f32_bf16 v178, v170, v170
 v_dot2c_f32_bf16 v176, v171, v180
 v_dot2c_f32_bf16 v178, v171, v171
 v_dot2c_f32_bf16 v177, v172, v180
 v_dot2c_f32_bf16 v179, v172, v172
 v_dot2c_f32_bf16 v177, v173, v180
 v_dot2c_f32_bf16 v179, v173, v173
 v_dot2c_f32_bf16 v177, v174, v180
 v_dot2c_f32_bf16 v179, v174, v174
 v_dot2c_f32_bf16 v177, v175, v180
 v_dot2c_f32_bf16 v179, v175, v175
 buffer_load_dwordx4 v[132:135], v4, s[12:15], s42 offen
 s_add_u32 s42, s42, 1024
 ds_read_b128 v[168:171], v5 offset:736
 ds_read_b128 v[172:175], v7 offset:736
 s_waitcnt vmcnt(3) lgkmcnt(2)
 v_mfma_f32_32x32x16_bf16 v[64:79], v[136:139], v[160:163], v[64:79]
 v_mfma_f32_32x32x16_bf16 v[80:95], v[136:139], v[164:167], v[80:95]
 v_dot2c_f32_bf16 v176, v160, v180
 v_dot2c_f32_bf16 v178, v160, v160
 v_dot2c_f32_bf16 v176, v161, v180
 v_dot2c_f32_bf16 v178, v161, v161
 v_dot2c_f32_bf16 v176, v162, v180
 v_dot2c_f32_bf16 v178, v162, v162
 v_dot2c_f32_bf16 v176, v163, v180
 v_dot2c_f32_bf16 v178, v163, v163
 v_dot2c_f32_bf16 v177, v164, v180
 v_dot2c_f32_bf16 v179, v164, v164
 v_dot2c_f32_bf16 v177, v165, v180
 v_dot2c_f32_bf16 v179, v165, v165
 v_dot2c_f32_bf16 v177, v166, v180
 v_dot2c_f32_bf16 v179, v166, v166
 v_dot2c_f32_bf16 v177, v167, v180
 v_dot2c_f32_bf16 v179, v167, v167
 buffer_load_dwordx4 v[136:139], v4, s[12:15], s42 offen
 s_add_u32 s42, s42, 1024
 ds_read_b128 v[160:163], v5 offset:768
 ds_read_b128 v[164:167], v7 offset:768
 s_waitcnt vmcnt(3) lgkmcnt(2)
 v_mfma_f32_32x32x16_bf16 v[64:79], v[140:143], v[168:171], v[64:79]
 v_mfma_f32_32x32x16_bf16 v[80:95], v[140:143], v[172:175], v[80:95]
 v_dot2c_f32_bf16 v176, v168, v180
 v_dot2c_f32_bf16 v178, v168, v168
 v_dot2c_f32_bf16 v176, v169, v180
 v_dot2c_f32_bf16 v178, v169, v169
 v_dot2c_f32_bf16 v176, v170, v180
 v_dot2c_f32_bf16 v178, v170, v170
 v_dot2c_f32_bf16 v176, v171, v180
 v_dot2c_f32_bf16 v178, v171, v171
 v_dot2c_f32_bf16 v177, v172, v180
 v_dot2c_f32_bf16 v179, v172, v172
 v_dot2c_f32_bf16 v177, v173, v180
 v_dot2c_f32_bf16 v179, v173, v173
 v_dot2c_f32_bf16 v177, v174, v180
 v_dot2c_f32_bf16 v179, v174, v174
 v_dot2c_f32_bf16 v177, v175, v180
 v_dot2c_f32_bf16 v179, v175, v175
 buffer_load_dwordx4 v[140:143], v4, s[12:15], s42 offen
 s_add_u32 s42, s42, 1024
 ds_read_b128 v[168:171], v5 offset:800
 ds_read_b128 v[172:175], v7 offset:800
 s_waitcnt vmcnt(3) lgkmcnt(2)
 v_mfma_f32_32x32x16_bf16 v[64:79], v[128:131], v[160:163], v[64:79]
 v_mfma_f32_32x32x16_bf16 v[80:95], v[128:131], v[164:167], v[80:95]
 v_dot2c_f32_bf16 v176, v160, v180
 v_dot2c_f32_bf16 v178, v160, v160
 v_dot2c_f32_bf16 v176, v161, v180
 v_dot2c_f32_bf16 v178, v161, v161
 v_dot2c_f32_bf16 v176, v162, v180
 v_dot2c_f32_bf16 v178, v162, v162
 v_dot2c_f32_bf16 v176, v163, v180
 v_dot2c_f32_bf16 v178, v163, v163
 v_dot2c_f32_bf16 v177, v164, v180
 v_dot2c_f32_bf16 v179, v164, v164
 v_dot2c_f32_bf16 v177, v165, v180
 v_dot2c_f32_bf16 v179, v165, v165
 v_dot2c_f32_bf16 v177, v166, v180
 v_dot2c_f32_bf16 v179, v166, v166
 v_dot2c_f32_bf16 v177, v167, v180
 v_dot2c_f32_bf16 v179, v167, v167
 buffer_load_dwordx4 v[128:131], v4, s[12:15], s42 offen
 s_add_u32 s42, s42, 1024
 ds_read_b128 v[160:163], v5 offset:832
 ds_read_b128 v[164:167], v7 offset:832
 s_waitcnt vmcnt(3) lgkmcnt(2)
 v_mfma_f32_32x32x16_bf16 v[64:79], v[132:135], v[168:171], v[64:79]
 v_mfma_f32_32x32x16_bf16 v[80:95], v[132:135], v[172:175], v[80:95]
 v_dot2c_f32_bf16 v176, v168, v180
 v_dot2c_f32_bf16 v178, v168, v168
 v_dot2c_f32_bf16 v176, v169, v180
 v_dot2c_f32_bf16 v178, v169, v169
 v_dot2c_f32_bf16 v176, v170, v180
 v_dot2c_f32_bf16 v178, v170, v170
 v_dot2c_f32_bf16 v176, v171, v180
 v_dot2c_f32_bf16 v178, v171, v171
 v_dot2c_f32_bf16 v177, v172, v180
 v_dot2c_f32_bf16 v179, v172, v172
 v_dot2c_f32_bf16 v177, v173, v180
 v_dot2c_f32_bf16 v179, v173, v173
 v_dot2c_f32_bf16 v177, v174, v180
 v_dot2c_f32_bf16 v179, v174, v174
 v_dot2c_f32_bf16 v177, v175, v180
 v_dot2c_f32_bf16 v179, v175, v175
 buffer_load_dwordx4 v[132:135], v4, s[12:15], s42 offen
 s_add_u32 s42, s42, 1024
 ds_read_b128 v[168:171], v5 offset:864
 ds_read_b128 v[172:175], v7 offset:864
 s_waitcnt vmcnt(3) lgkmcnt(2)
 v_mfma_f32_32x32x16_bf16 v[64:79], v[136:139], v[160:163], v[64:79]
 v_mfma_f32_32x32x16_bf16 v[80:95], v[136:139], v[164:167], v[80:95]
 v_dot2c_f32_bf16 v176, v160, v180
 v_dot2c_f32_bf16 v178, v160, v160
 v_dot2c_f32_bf16 v176, v161, v180
 v_dot2c_f32_bf16 v178, v161, v161
 v_dot2c_f32_bf16 v176, v162, v180
 v_dot2c_f32_bf16 v178, v162, v162
 v_dot2c_f32_bf16 v176, v163, v180
 v_dot2c_f32_bf16 v178, v163, v163
 v_dot2c_f32_bf16 v177, v164, v180
 v_dot2c_f32_bf16 v179, v164, v164
 v_dot2c_f32_bf16 v177, v165, v180
 v_dot2c_f32_bf16 v179, v165, v165
 v_dot2c_f32_bf16 v177, v166, v180
 v_dot2c_f32_bf16 v179, v166, v166
 v_dot2c_f32_bf16 v177, v167, v180
 v_dot2c_f32_bf16 v179, v167, v167
 buffer_load_dwordx4 v[136:139], v4, s[12:15], s42 offen
 s_add_u32 s42, s42, 1024
 ds_read_b128 v[160:163], v5 offset:896
 ds_read_b128 v[164:167], v7 offset:896
 s_waitcnt vmcnt(3) lgkmcnt(2)
 v_mfma_f32_32x32x16_bf16 v[64:79], v[140:143], v[168:171], v[64:79]
 v_mfma_f32_32x32x16_bf16 v[80:95], v[140:143], v[172:175], v[80:95]
 v_dot2c_f32_bf16 v176, v168, v180
 v_dot2c_f32_bf16 v178, v168, v168
 v_dot2c_f32_bf16 v176, v169, v180
 v_dot2c_f32_bf16 v178, v169, v169
 v_dot2c_f32_bf16 v176, v170, v180
 v_dot2c_f32_bf16 v178, v170, v170
 v_dot2c_f32_bf16 v176, v171, v180
 v_dot2c_f32_bf16 v178, v171, v171
 v_dot2c_f32_bf16 v177, v172, v180
 v_dot2c_f32_bf16 v179, v172, v172
 v_dot2c_f32_bf16 v177, v173, v180
 v_dot2c_f32_bf16 v179, v173, v173
 v_dot2c_f32_bf16 v177, v174, v180
 v_dot2c_f32_bf16 v179, v174, v174
 v_dot2c_f32_bf16 v177, v175, v180
 v_dot2c_f32_bf16 v179, v175, v175
 buffer_load_dwordx4 v[140:143], v4, s[12:15], s42 offen
 s_add_u32 s42, s42, 1024
 ds_read_b128 v[168:171], v5 offset:928
 ds_read_b128 v[172:175], v7 offset:928
 s_waitcnt vmcnt(3) lgkmcnt(2)
 v_mfma_f32_32x32x16_bf16 v[64:79], v[128:131], v[160:163], v[64:79]
 v_mfma_f32_32x32x16_bf16 v[80:95], v[128:131], v[164:167], v[80:95]
 v_dot2c_f32_bf16 v176, v160, v180
 v_dot2c_f32_bf16 v178, v160, v160
 v_dot2c_f32_bf16 v176, v161, v180
 v_dot2c_f32_bf16 v178, v161, v161
 v_dot2c_f32_bf16 v176, v162, v180
 v_dot2c_f32_bf16 v178, v162, v162
 v_dot2c_f32_bf16 v176, v163, v180
 v_dot2c_f32_bf16 v178, v163, v163
 v_dot2c_f32_bf16 v177, v164, v180
 v_dot2c_f32_bf16 v179, v164, v164
 v_dot2c_f32_bf16 v177, v165, v180
 v_dot2c_f32_bf16 v179, v165, v165
 v_dot2c_f32_bf16 v177, v166, v180
 v_dot2c_f32_bf16 v179, v166, v166
 v_dot2c_f32_bf16 v177, v167, v180
 v_dot2c_f32_bf16 v179, v167, v167
 buffer_load_dwordx4 v[128:131], v4, s[12:15], s42 offen
 s_add_u32 s42, s42, 1024
 ds_read_b128 v[160:163], v5 offset:960
 ds_read_b128 v[164:167], v7 offset:960
 s_waitcnt vmcnt(3) lgkmcnt(2)
 v_mfma_f32_32x32x16_bf16 v[64:79], v[132:135], v[168:171], v[64:79]
 v_mfma_f32_32x32x16_bf16 v[80:95], v[132:135], v[172:175], v[80:95]
 v_dot2c_f32_bf16 v176, v168, v180
 v_dot2c_f32_bf16 v178, v168, v168
 v_dot2c_f32_bf16 v176, v169, v180
 v_dot2c_f32_bf16 v178, v169, v169
 v_dot2c_f32_bf16 v176, v170, v180
 v_dot2c_f32_bf16 v178, v170, v170
 v_dot2c_f32_bf16 v176, v171, v180
 v_dot2c_f32_bf16 v178, v171, v171
 v_dot2c_f32_bf16 v177, v172, v180
 v_dot2c_f32_bf16 v179, v172, v172
 v_dot2c_f32_bf16 v177, v173, v180
 v_dot2c_f32_bf16 v179, v173, v173
 v_dot2c_f32_bf16 v177, v174, v180
 v_dot2c_f32_bf16 v179, v174, v174
 v_dot2c_f32_bf16 v177, v175, v180
 v_dot2c_f32_bf16 v179, v175, v175
 buffer_load_dwordx4 v[132:135], v4, s[12:15], s42 offen
 s_add_u32 s42, s42, 1024
 ds_read_b128 v[168:171], v5 offset:992
 ds_read_b128 v[172:175], v7 offset:992
 s_waitcnt vmcnt(3) lgkmcnt(2)
 v_mfma_f32_32x32x16_bf16 v[64:79], v[136:139], v[160:163], v[64:79]
 v_mfma_f32_32x32x16_bf16 v[80:95], v[136:139], v[164:167], v[80:95]
 v_dot2c_f32_bf16 v176, v160, v180
 v_dot2c_f32_bf16 v178, v160, v160
 v_dot2c_f32_bf16 v176, v161, v180
 v_dot2c_f32_bf16 v178, v161, v161
 v_dot2c_f32_bf16 v176, v162, v180
 v_dot2c_f32_bf16 v178, v162, v162
 v_dot2c_f32_bf16 v176, v163, v180
 v_dot2c_f32_bf16 v178, v163, v163
 v_dot2c_f32_bf16 v177, v164, v180
 v_dot2c_f32_bf16 v179, v164, v164
 v_dot2c_f32_bf16 v177, v165, v180
 v_dot2c_f32_bf16 v179, v165, v165
 v_dot2c_f32_bf16 v177, v166, v180
 v_dot2c_f32_bf16 v179, v166, v166
 v_dot2c_f32_bf16 v177, v167, v180
 v_dot2c_f32_bf16 v179, v167, v167
 buffer_load_dwordx4 v[136:139], v4, s[12:15], s42 offen
 s_add_u32 s42, s42, 1024
 ds_read_b128 v[160:163], v5 offset:1024
 ds_read_b128 v[164:167], v7 offset:1024
 s_waitcnt vmcnt(3) lgkmcnt(2)
 v_mfma_f32_32x32x16_bf16 v[64:79], v[140:143], v[168:171], v[64:79]
 v_mfma_f32_32x32x16_bf16 v[80:95], v[140:143], v[172:175], v[80:95]
 v_dot2c_f32_bf16 v176, v168, v180
 v_dot2c_f32_bf16 v178, v168, v168
 v_dot2c_f32_bf16 v176, v169, v180
 v_dot2c_f32_bf16 v178, v169, v169
 v_dot2c_f32_bf16 v176, v170, v180
 v_dot2c_f32_bf16 v178, v170, v170
 v_dot2c_f32_bf16 v176, v171, v180
 v_dot2c_f32_bf16 v178, v171, v171
 v_dot2c_f32_bf16 v177, v172, v180
 v_dot2c_f32_bf16 v179, v172, v172
 v_dot2c_f32_bf16 v177, v173, v180
 v_dot2c_f32_bf16 v179, v173, v173
 v_dot2c_f32_bf16 v177, v174, v180
 v_dot2c_f32_bf16 v179, v174, v174
 v_dot2c_f32_bf16 v177, v175, v180
 v_dot2c_f32_bf16 v179, v175, v175
 buffer_load_dwordx4 v[140:143], v4, s[12:15], s42 offen
 s_add_u32 s42, s42, 1024
 ds_read_b128 v[168:171], v5 offset:1056
 ds_read_b128 v[172:175], v7 offset:1056
 s_waitcnt vmcnt(3) lgkmcnt(2)
 v_mfma_f32_32x32x16_bf16 v[64:79], v[128:131], v[160:163], v[64:79]
 v_mfma_f32_32x32x16_bf16 v[80:95], v[128:131], v[164:167], v[80:95]
 v_dot2c_f32_bf16 v176, v160, v180
 v_dot2c_f32_bf16 v178, v160, v160
 v_dot2c_f32_bf16 v176, v161, v180
 v_dot2c_f32_bf16 v178, v161, v161
 v_dot2c_f32_bf16 v176, v162, v180
 v_dot2c_f32_bf16 v178, v162, v162
 v_dot2c_f32_bf16 v176, v163, v180
 v_dot2c_f32_bf16 v178, v163, v163
 v_dot2c_f32_bf16 v177, v164, v180
 v_dot2c_f32_bf16 v179, v164, v164
 v_dot2c_f32_bf16 v177, v165, v180
 v_dot2c_f32_bf16 v179, v165, v165
 v_dot2c_f32_bf16 v177, v166, v180
 v_dot2c_f32_bf16 v179, v166, v166
 v_dot2c_f32_bf16 v177, v167, v180
 v_dot2c_f32_bf16 v179, v167, v167
 buffer_load_dwordx4 v[128:131], v4, s[12:15], s42 offen
 s_add_u32 s42, s42, 1024
 ds_read_b128 v[160:163], v5 offset:1088
 ds_read_b128 v[164:167], v7 offset:1088
 s_waitcnt vmcnt(3) lgkmcnt(2)
 v_mfma_f32_32x32x16_bf16 v[64:79], v[132:135], v[168:171], v[64:79]
 v_mfma_f32_32x32x16_bf16 v[80:95], v[132:135], v[172:175], v[80:95]
 v_dot2c_f32_bf16 v176, v168, v180
 v_dot2c_f32_bf16 v178, v168, v168
 v_dot2c_f32_bf16 v176, v169, v180
 v_dot2c_f32_bf16 v178, v169, v169
 v_dot2c_f32_bf16 v176, v170, v180
 v_dot2c_f32_bf16 v178, v170, v170
 v_dot2c_f32_bf16 v176, v171, v180
 v_dot2c_f32_bf16 v178, v171, v171
 v_dot2c_f32_bf16 v177, v172, v180
 v_dot2c_f32_bf16 v179, v172, v172
 v_dot2c_f32_bf16 v177, v173, v180
 v_dot2c_f32_bf16 v179, v173, v173
 v_dot2c_f32_bf16 v177, v174, v180
 v_dot2c_f32_bf16 v179, v174, v174
 v_dot2c_f32_bf16 v177, v175, v180
 v_dot2c_f32_bf16 v179, v175, v175
 buffer_load_dwordx4 v[132:135], v4, s[12:15], s42 offen
 s_add_u32 s42, s42, 1024
 ds_read_b128 v[168:171], v5 offset:1120
 ds_read_b128 v[172:175], v7 offset:1120
 s_waitcnt vmcnt(3) lgkmcnt(2)
 v_mfma_f32_32x32x16_bf16 v[64:79], v[136:139], v[160:163], v[64:79]
 v_mfma_f32_32x32x16_bf16 v[80:95], v[136:139], v[164:167], v[80:95]
 v_dot2c_f32_bf16 v176, v160, v180
 v_dot2c_f32_bf16 v178, v160, v160
 v_dot2c_f32_bf16 v176, v161, v180
 v_dot2c_f32_bf16 v178, v161, v161
 v_dot2c_f32_bf16 v176, v162, v180
 v_dot2c_f32_bf16 v178, v162, v162
 v_dot2c_f32_bf16 v176, v163, v180
 v_dot2c_f32_bf16 v178, v163, v163
 v_dot2c_f32_bf16 v177, v164, v180
 v_dot2c_f32_bf16 v179, v164, v164
 v_dot2c_f32_bf16 v177, v165, v180
 v_dot2c_f32_bf16 v179, v165, v165
 v_dot2c_f32_bf16 v177, v166, v180
 v_dot2c_f32_bf16 v179, v166, v166
 v_dot2c_f32_bf16 v177, v167, v180
 v_dot2c_f32_bf16 v179, v167, v167
 buffer_load_dwordx4 v[136:139], v4, s[12:15], s42 offen
 s_add_u32 s42, s42, 1024
 ds_read_b128 v[160:163], v5 offset:1152
 ds_read_b128 v[164:167], v7 offset:1152
 s_waitcnt vmcnt(3) lgkmcnt(2)
 v_mfma_f32_32x32x16_bf16 v[64:79], v[140:143], v[168:171], v[64:79]
 v_mfma_f32_32x32x16_bf16 v[80:95], v[140:143], v[172:175], v[80:95]
 v_dot2c_f32_bf16 v176, v168, v180
 v_dot2c_f32_bf16 v178, v168, v168
 v_dot2c_f32_bf16 v176, v169, v180
 v_dot2c_f32_bf16 v178, v169, v169
 v_dot2c_f32_bf16 v176, v170, v180
 v_dot2c_f32_bf16 v178, v170, v170
 v_dot2c_f32_bf16 v176, v171, v180
 v_dot2c_f32_bf16 v178, v171, v171
 v_dot2c_f32_bf16 v177, v172, v180
 v_dot2c_f32_bf16 v179, v172, v172
 v_dot2c_f32_bf16 v177, v173, v180
 v_dot2c_f32_bf16 v179, v173, v173
 v_dot2c_f32_bf16 v177, v174, v180
 v_dot2c_f32_bf16 v179, v174, v174
 v_dot2c_f32_bf16 v177, v175, v180
 v_dot2c_f32_bf16 v179, v175, v175
 buffer_load_dwordx4 v[140:143], v4, s[12:15], s42 offen
 s_add_u32 s42, s42, 1024
 ds_read_b128 v[168:171], v5 offset:1184
 ds_read_b128 v[172:175], v7 offset:1184
 s_waitcnt vmcnt(3) lgkmcnt(2)
 v_mfma_f32_32x32x16_bf16 v[64:79], v[128:131], v[160:163], v[64:79]
 v_mfma_f32_32x32x16_bf16 v[80:95], v[128:131], v[164:167], v[80:95]
 v_dot2c_f32_bf16 v176, v160, v180
 v_dot2c_f32_bf16 v178, v160, v160
 v_dot2c_f32_bf16 v176, v161, v180
 v_dot2c_f32_bf16 v178, v161, v161
 v_dot2c_f32_bf16 v176, v162, v180
 v_dot2c_f32_bf16 v178, v162, v162
 v_dot2c_f32_bf16 v176, v163, v180
 v_dot2c_f32_bf16 v178, v163, v163
 v_dot2c_f32_bf16 v177, v164, v180
 v_dot2c_f32_bf16 v179, v164, v164
 v_dot2c_f32_bf16 v177, v165, v180
 v_dot2c_f32_bf16 v179, v165, v165
 v_dot2c_f32_bf16 v177, v166, v180
 v_dot2c_f32_bf16 v179, v166, v166
 v_dot2c_f32_bf16 v177, v167, v180
 v_dot2c_f32_bf16 v179, v167, v167
 ds_read_b128 v[160:163], v5 offset:1216
 ds_read_b128 v[164:167], v7 offset:1216
 s_waitcnt vmcnt(2) lgkmcnt(2)
 v_mfma_f32_32x32x16_bf16 v[64:79], v[132:135], v[168:171], v[64:79]
 v_mfma_f32_32x32x16_bf16 v[80:95], v[132:135], v[172:175], v[80:95]
 v_dot2c_f32_bf16 v176, v168, v180
 v_dot2c_f32_bf16 v178, v168, v168
 v_dot2c_f32_bf16 v176, v169, v180
 v_dot2c_f32_bf16 v178, v169, v169
 v_dot2c_f32_bf16 v176, v170, v180
 v_dot2c_f32_bf16 v178, v170, v170
 v_dot2c_f32_bf16 v176, v171, v180
 v_dot2c_f32_bf16 v178, v171, v171
 v_dot2c_f32_bf16 v177, v172, v180
 v_dot2c_f32_bf16 v179, v172, v172
 v_dot2c_f32_bf16 v177, v173, v180
 v_dot2c_f32_bf16 v179, v173, v173
 v_dot2c_f32_bf16 v177, v174, v180
 v_dot2c_f32_bf16 v179, v174, v174
 v_dot2c_f32_bf16 v177, v175, v180
 v_dot2c_f32_bf16 v179, v175, v175
 ds_read_b128 v[168:171], v5 offset:1248
 ds_read_b128 v[172:175], v7 offset:1248
 s_waitcnt vmcnt(1) lgkmcnt(2)
 v_mfma_f32_32x32x16_bf16 v[64:79], v[136:139], v[160:163], v[64:79]
 v_mfma_f32_32x32x16_bf16 v[80:95], v[136:139], v[164:167], v[80:95]
 v_dot2c_f32_bf16 v176, v160, v180
 v_dot2c_f32_bf16 v178, v160, v160
 v_dot2c_f32_bf16 v176, v161, v180
 v_dot2c_f32_bf16 v178, v161, v161
 v_dot2c_f32_bf16 v176, v162, v180
 v_dot2c_f32_bf16 v178, v162, v162
 v_dot2c_f32_bf16 v176, v163, v180
 v_dot2c_f32_bf16 v178, v163, v163
 v_dot2c_f32_bf16 v177, v164, v180
 v_dot2c_f32_bf16 v179, v164, v164
 v_dot2c_f32_bf16 v177, v165, v180
 v_dot2c_f32_bf16 v179, v165, v165
 v_dot2c_f32_bf16 v177, v166, v180
 v_dot2c_f32_bf16 v179, v166, v166
 v_dot2c_f32_bf16 v177, v167, v180
 v_dot2c_f32_bf16 v179, v167, v167
 s_waitcnt vmcnt(0) lgkmcnt(0)
 v_mfma_f32_32x32x16_bf16 v[64:79], v[140:143], v[168:171], v[64:79]
 v_mfma_f32_32x32x16_bf16 v[80:95], v[140:143], v[172:175], v[80:95]
 v_dot2c_f32_bf16 v176, v168, v180
 v_dot2c_f32_bf16 v178, v168, v168
 v_dot2c_f32_bf16 v176, v169, v180
 v_dot2c_f32_bf16 v178, v169, v169
 v_dot2c_f32_bf16 v176, v170, v180
 v_dot2c_f32_bf16 v178, v170, v170
 v_dot2c_f32_bf16 v176, v171, v180
 v_dot2c_f32_bf16 v178, v171, v171
 v_dot2c_f32_bf16 v177, v172, v180
 v_dot2c_f32_bf16 v179, v172, v172
 v_dot2c_f32_bf16 v177, v173, v180
 v_dot2c_f32_bf16 v179, v173, v173
 v_dot2c_f32_bf16 v177, v174, v180
 v_dot2c_f32_bf16 v179, v174, v174
 v_dot2c_f32_bf16 v177, v175, v180
 v_dot2c_f32_bf16 v179, v175, v175
 s_nop 11
 v_mov_b32 v186, v176
 s_nop 1
 v_permlane32_swap_b32 v176, v186
 v_add_f32 v176, v176, v186
 v_mov_b32 v186, v177
 s_nop 1
 v_permlane32_swap_b32 v177, v186
 v_add_f32 v177, v177, v186
 v_mov_b32 v186, v178
 s_nop 1
 v_permlane32_swap_b32 v178, v186
 v_add_f32 v178, v178, v186
 v_mov_b32 v186, v179
 s_nop 1
 v_permlane32_swap_b32 v179, v186
 v_add_f32 v179, v179, v186
 s_mov_b32 s44, 0x3acccccd
 s_mov_b32 s45, 0x3727c5ac
 v_mul_f32 v186, s44, v176
 v_mul_f32 v187, s44, v178
 v_fma_f32 v187, -v186, v186, v187
 v_add_f32 v187, s45, v187
 v_rsq_f32 v181, v187
 s_nop 0
 v_mul_f32 v183, v181, v186
 v_mul_f32 v186, s44, v177
 v_mul_f32 v187, s44, v179
 v_fma_f32 v187, -v186, v186, v187
 v_add_f32 v187, s45, v187
 v_rsq_f32 v182, v187
 s_nop 0
 v_mul_f32 v184, v182, v186
 s_cmp_ge_u32 s40, 20
 s_cbranch_scc1 L_a1_2_kernel_ktype
 s_add_u32 s49, s40, 0
 v_bfe_u32 v8, v0, 5, 1
 v_lshlrev_b32 v8, 2, v8
 v_and_b32 v9, 31, v0
 s_lshl_b32 s46, s49, 5
 v_add_u32 v8, s46, v8
 s_mov_b32 s47, 0x3ea52b5c
 v_add_u32 v10, 0, v8
 v_lshlrev_b32 v11, 2, v10
 buffer_load_dwordx4 v[12:15], v11, s[16:19], 0 offen
 v_add_u32 v10, 8, v8
 v_lshlrev_b32 v11, 2, v10
 buffer_load_dwordx4 v[16:19], v11, s[16:19], 0 offen
 v_add_u32 v10, 16, v8
 v_lshlrev_b32 v11, 2, v10
 buffer_load_dwordx4 v[20:23], v11, s[16:19], 0 offen
 v_add_u32 v10, 24, v8
 v_lshlrev_b32 v11, 2, v10
 buffer_load_dwordx4 v[24:27], v11, s[16:19], 0 offen
 v_mul_f32 v28, s47, v181
 v_mul_f32 v29, s47, v183
 s_lshl_b32 s48, s32, 1
 s_add_u32 s48, s48, 0
 s_lshl_b32 s48, s48, 11
 s_waitcnt vmcnt(3)
 v_add_u32 v10, 0, v8
 v_mul_u32_u24 v11, 3277, v10
 v_lshrrev_b32 v11, 16, v11
 v_mul_u32_u24 v30, 20, v11
 v_sub_u32 v30, v10, v30
 v_lshrrev_b32 v30, 2, v30
 v_lshlrev_b32 v11, 17, v11
 v_lshlrev_b32 v31, 4, v9
 v_add3_u32 v11, v11, v31, s48
 v_lshrrev_b32 v31, 2, v30
 v_lshl_add_u32 v11, v31, 10, v11
 v_bfe_u32 v31, v30, 1, 1
 v_lshl_add_u32 v11, v31, 9, v11
 v_and_b32 v31, 1, v30
 v_lshl_add_u32 v11, v31, 3, v11
 v_mul_f32 v32, v29, v12
 v_fma_f32 v32, v28, v64, -v32
 v_mul_f32 v33, v29, v13
 v_fma_f32 v33, v28, v65, -v33
 v_mul_f32 v34, v29, v14
 v_fma_f32 v34, v28, v66, -v34
 v_mul_f32 v35, v29, v15
 v_fma_f32 v35, v28, v67, -v35
 v_cvt_pk_bf16_f32 v36, v32, v33
 v_cvt_pk_bf16_f32 v37, v34, v35
 buffer_store_dwordx2 v[36:37], v11, s[20:23], 0 offen
 s_waitcnt vmcnt(3)
 v_add_u32 v10, 8, v8
 v_mul_u32_u24 v11, 3277, v10
 v_lshrrev_b32 v11, 16, v11
 v_mul_u32_u24 v30, 20, v11
 v_sub_u32 v30, v10, v30
 v_lshrrev_b32 v30, 2, v30
 v_lshlrev_b32 v11, 17, v11
 v_lshlrev_b32 v31, 4, v9
 v_add3_u32 v11, v11, v31, s48
 v_lshrrev_b32 v31, 2, v30
 v_lshl_add_u32 v11, v31, 10, v11
 v_bfe_u32 v31, v30, 1, 1
 v_lshl_add_u32 v11, v31, 9, v11
 v_and_b32 v31, 1, v30
 v_lshl_add_u32 v11, v31, 3, v11
 v_mul_f32 v32, v29, v16
 v_fma_f32 v32, v28, v68, -v32
 v_mul_f32 v33, v29, v17
 v_fma_f32 v33, v28, v69, -v33
 v_mul_f32 v34, v29, v18
 v_fma_f32 v34, v28, v70, -v34
 v_mul_f32 v35, v29, v19
 v_fma_f32 v35, v28, v71, -v35
 v_cvt_pk_bf16_f32 v36, v32, v33
 v_cvt_pk_bf16_f32 v37, v34, v35
 buffer_store_dwordx2 v[36:37], v11, s[20:23], 0 offen
 s_waitcnt vmcnt(3)
 v_add_u32 v10, 16, v8
 v_mul_u32_u24 v11, 3277, v10
 v_lshrrev_b32 v11, 16, v11
 v_mul_u32_u24 v30, 20, v11
 v_sub_u32 v30, v10, v30
 v_lshrrev_b32 v30, 2, v30
 v_lshlrev_b32 v11, 17, v11
 v_lshlrev_b32 v31, 4, v9
 v_add3_u32 v11, v11, v31, s48
 v_lshrrev_b32 v31, 2, v30
 v_lshl_add_u32 v11, v31, 10, v11
 v_bfe_u32 v31, v30, 1, 1
 v_lshl_add_u32 v11, v31, 9, v11
 v_and_b32 v31, 1, v30
 v_lshl_add_u32 v11, v31, 3, v11
 v_mul_f32 v32, v29, v20
 v_fma_f32 v32, v28, v72, -v32
 v_mul_f32 v33, v29, v21
 v_fma_f32 v33, v28, v73, -v33
 v_mul_f32 v34, v29, v22
 v_fma_f32 v34, v28, v74, -v34
 v_mul_f32 v35, v29, v23
 v_fma_f32 v35, v28, v75, -v35
 v_cvt_pk_bf16_f32 v36, v32, v33
 v_cvt_pk_bf16_f32 v37, v34, v35
 buffer_store_dwordx2 v[36:37], v11, s[20:23], 0 offen
 s_waitcnt vmcnt(3)
 v_add_u32 v10, 24, v8
 v_mul_u32_u24 v11, 3277, v10
 v_lshrrev_b32 v11, 16, v11
 v_mul_u32_u24 v30, 20, v11
 v_sub_u32 v30, v10, v30
 v_lshrrev_b32 v30, 2, v30
 v_lshlrev_b32 v11, 17, v11
 v_lshlrev_b32 v31, 4, v9
 v_add3_u32 v11, v11, v31, s48
 v_lshrrev_b32 v31, 2, v30
 v_lshl_add_u32 v11, v31, 10, v11
 v_bfe_u32 v31, v30, 1, 1
 v_lshl_add_u32 v11, v31, 9, v11
 v_and_b32 v31, 1, v30
 v_lshl_add_u32 v11, v31, 3, v11
 v_mul_f32 v32, v29, v24
 v_fma_f32 v32, v28, v76, -v32
 v_mul_f32 v33, v29, v25
 v_fma_f32 v33, v28, v77, -v33
 v_mul_f32 v34, v29, v26
 v_fma_f32 v34, v28, v78, -v34
 v_mul_f32 v35, v29, v27
 v_fma_f32 v35, v28, v79, -v35
 v_cvt_pk_bf16_f32 v36, v32, v33
 v_cvt_pk_bf16_f32 v37, v34, v35
 buffer_store_dwordx2 v[36:37], v11, s[20:23], 0 offen
 v_mul_f32 v28, s47, v182
 v_mul_f32 v29, s47, v184
 s_lshl_b32 s48, s32, 1
 s_add_u32 s48, s48, 1
 s_lshl_b32 s48, s48, 11
 v_add_u32 v10, 0, v8
 v_mul_u32_u24 v11, 3277, v10
 v_lshrrev_b32 v11, 16, v11
 v_mul_u32_u24 v30, 20, v11
 v_sub_u32 v30, v10, v30
 v_lshrrev_b32 v30, 2, v30
 v_lshlrev_b32 v11, 17, v11
 v_lshlrev_b32 v31, 4, v9
 v_add3_u32 v11, v11, v31, s48
 v_lshrrev_b32 v31, 2, v30
 v_lshl_add_u32 v11, v31, 10, v11
 v_bfe_u32 v31, v30, 1, 1
 v_lshl_add_u32 v11, v31, 9, v11
 v_and_b32 v31, 1, v30
 v_lshl_add_u32 v11, v31, 3, v11
 v_mul_f32 v32, v29, v12
 v_fma_f32 v32, v28, v80, -v32
 v_mul_f32 v33, v29, v13
 v_fma_f32 v33, v28, v81, -v33
 v_mul_f32 v34, v29, v14
 v_fma_f32 v34, v28, v82, -v34
 v_mul_f32 v35, v29, v15
 v_fma_f32 v35, v28, v83, -v35
 v_cvt_pk_bf16_f32 v36, v32, v33
 v_cvt_pk_bf16_f32 v37, v34, v35
 buffer_store_dwordx2 v[36:37], v11, s[20:23], 0 offen
 v_add_u32 v10, 8, v8
 v_mul_u32_u24 v11, 3277, v10
 v_lshrrev_b32 v11, 16, v11
 v_mul_u32_u24 v30, 20, v11
 v_sub_u32 v30, v10, v30
 v_lshrrev_b32 v30, 2, v30
 v_lshlrev_b32 v11, 17, v11
 v_lshlrev_b32 v31, 4, v9
 v_add3_u32 v11, v11, v31, s48
 v_lshrrev_b32 v31, 2, v30
 v_lshl_add_u32 v11, v31, 10, v11
 v_bfe_u32 v31, v30, 1, 1
 v_lshl_add_u32 v11, v31, 9, v11
 v_and_b32 v31, 1, v30
 v_lshl_add_u32 v11, v31, 3, v11
 v_mul_f32 v32, v29, v16
 v_fma_f32 v32, v28, v84, -v32
 v_mul_f32 v33, v29, v17
 v_fma_f32 v33, v28, v85, -v33
 v_mul_f32 v34, v29, v18
 v_fma_f32 v34, v28, v86, -v34
 v_mul_f32 v35, v29, v19
 v_fma_f32 v35, v28, v87, -v35
 v_cvt_pk_bf16_f32 v36, v32, v33
 v_cvt_pk_bf16_f32 v37, v34, v35
 buffer_store_dwordx2 v[36:37], v11, s[20:23], 0 offen
 v_add_u32 v10, 16, v8
 v_mul_u32_u24 v11, 3277, v10
 v_lshrrev_b32 v11, 16, v11
 v_mul_u32_u24 v30, 20, v11
 v_sub_u32 v30, v10, v30
 v_lshrrev_b32 v30, 2, v30
 v_lshlrev_b32 v11, 17, v11
 v_lshlrev_b32 v31, 4, v9
 v_add3_u32 v11, v11, v31, s48
 v_lshrrev_b32 v31, 2, v30
 v_lshl_add_u32 v11, v31, 10, v11
 v_bfe_u32 v31, v30, 1, 1
 v_lshl_add_u32 v11, v31, 9, v11
 v_and_b32 v31, 1, v30
 v_lshl_add_u32 v11, v31, 3, v11
 v_mul_f32 v32, v29, v20
 v_fma_f32 v32, v28, v88, -v32
 v_mul_f32 v33, v29, v21
 v_fma_f32 v33, v28, v89, -v33
 v_mul_f32 v34, v29, v22
 v_fma_f32 v34, v28, v90, -v34
 v_mul_f32 v35, v29, v23
 v_fma_f32 v35, v28, v91, -v35
 v_cvt_pk_bf16_f32 v36, v32, v33
 v_cvt_pk_bf16_f32 v37, v34, v35
 buffer_store_dwordx2 v[36:37], v11, s[20:23], 0 offen
 v_add_u32 v10, 24, v8
 v_mul_u32_u24 v11, 3277, v10
 v_lshrrev_b32 v11, 16, v11
 v_mul_u32_u24 v30, 20, v11
 v_sub_u32 v30, v10, v30
 v_lshrrev_b32 v30, 2, v30
 v_lshlrev_b32 v11, 17, v11
 v_lshlrev_b32 v31, 4, v9
 v_add3_u32 v11, v11, v31, s48
 v_lshrrev_b32 v31, 2, v30
 v_lshl_add_u32 v11, v31, 10, v11
 v_bfe_u32 v31, v30, 1, 1
 v_lshl_add_u32 v11, v31, 9, v11
 v_and_b32 v31, 1, v30
 v_lshl_add_u32 v11, v31, 3, v11
 v_mul_f32 v32, v29, v24
 v_fma_f32 v32, v28, v92, -v32
 v_mul_f32 v33, v29, v25
 v_fma_f32 v33, v28, v93, -v33
 v_mul_f32 v34, v29, v26
 v_fma_f32 v34, v28, v94, -v34
 v_mul_f32 v35, v29, v27
 v_fma_f32 v35, v28, v95, -v35
 v_cvt_pk_bf16_f32 v36, v32, v33
 v_cvt_pk_bf16_f32 v37, v34, v35
 buffer_store_dwordx2 v[36:37], v11, s[20:23], 0 offen
 s_branch L_a1_2_kernel_end
L_a1_2_kernel_ktype:
 s_mov_b32 s49, 20
 s_mov_b32 s52, 0
 v_bfe_u32 v8, v0, 5, 1
 v_lshlrev_b32 v8, 2, v8
 v_and_b32 v9, 31, v0
 v_add_u32 v8, s52, v8
 s_mov_b32 s47, 0x3f800000
 v_add_u32 v10, 640, v8
 v_lshlrev_b32 v11, 2, v10
 buffer_load_dwordx4 v[12:15], v11, s[16:19], 0 offen
 v_add_u32 v10, 648, v8
 v_lshlrev_b32 v11, 2, v10
 buffer_load_dwordx4 v[16:19], v11, s[16:19], 0 offen
 v_add_u32 v10, 656, v8
 v_lshlrev_b32 v11, 2, v10
 buffer_load_dwordx4 v[20:23], v11, s[16:19], 0 offen
 v_add_u32 v10, 664, v8
 v_lshlrev_b32 v11, 2, v10
 buffer_load_dwordx4 v[24:27], v11, s[16:19], 0 offen
 v_mul_f32 v28, s47, v181
 v_mul_f32 v29, s47, v183
 s_lshl_b32 s48, s32, 1
 s_add_u32 s48, s48, 0
 s_lshl_b32 s48, s48, 11
 s_waitcnt vmcnt(3)
 v_add_u32 v10, 0, v8
 v_mul_u32_u24 v11, 3277, v10
 v_lshrrev_b32 v11, 16, v11
 v_mul_u32_u24 v30, 20, v11
 v_sub_u32 v30, v10, v30
 v_lshrrev_b32 v30, 2, v30
 v_lshlrev_b32 v11, 17, v11
 v_lshlrev_b32 v31, 4, v9
 v_add3_u32 v11, v11, v31, s48
 v_lshrrev_b32 v31, 2, v30
 v_lshl_add_u32 v11, v31, 10, v11
 v_bfe_u32 v31, v30, 1, 1
 v_lshl_add_u32 v11, v31, 9, v11
 v_and_b32 v31, 1, v30
 v_lshl_add_u32 v11, v31, 3, v11
 v_mul_f32 v32, v29, v12
 v_fma_f32 v32, v28, v64, -v32
 v_mul_f32 v33, v29, v13
 v_fma_f32 v33, v28, v65, -v33
 v_mul_f32 v34, v29, v14
 v_fma_f32 v34, v28, v66, -v34
 v_mul_f32 v35, v29, v15
 v_fma_f32 v35, v28, v67, -v35
 v_cvt_pk_bf16_f32 v36, v32, v33
 v_cvt_pk_bf16_f32 v37, v34, v35
 v_cmp_gt_u32 vcc, 20, v10
 s_and_saveexec_b64 s[50:51], vcc
 buffer_store_dwordx2 v[36:37], v11, s[24:27], 0 offen
 s_mov_b64 exec, s[50:51]
 s_waitcnt vmcnt(3)
 v_add_u32 v10, 8, v8
 v_mul_u32_u24 v11, 3277, v10
 v_lshrrev_b32 v11, 16, v11
 v_mul_u32_u24 v30, 20, v11
 v_sub_u32 v30, v10, v30
 v_lshrrev_b32 v30, 2, v30
 v_lshlrev_b32 v11, 17, v11
 v_lshlrev_b32 v31, 4, v9
 v_add3_u32 v11, v11, v31, s48
 v_lshrrev_b32 v31, 2, v30
 v_lshl_add_u32 v11, v31, 10, v11
 v_bfe_u32 v31, v30, 1, 1
 v_lshl_add_u32 v11, v31, 9, v11
 v_and_b32 v31, 1, v30
 v_lshl_add_u32 v11, v31, 3, v11
 v_mul_f32 v32, v29, v16
 v_fma_f32 v32, v28, v68, -v32
 v_mul_f32 v33, v29, v17
 v_fma_f32 v33, v28, v69, -v33
 v_mul_f32 v34, v29, v18
 v_fma_f32 v34, v28, v70, -v34
 v_mul_f32 v35, v29, v19
 v_fma_f32 v35, v28, v71, -v35
 v_cvt_pk_bf16_f32 v36, v32, v33
 v_cvt_pk_bf16_f32 v37, v34, v35
 v_cmp_gt_u32 vcc, 20, v10
 s_and_saveexec_b64 s[50:51], vcc
 buffer_store_dwordx2 v[36:37], v11, s[24:27], 0 offen
 s_mov_b64 exec, s[50:51]
 s_waitcnt vmcnt(3)
 v_add_u32 v10, 16, v8
 v_mul_u32_u24 v11, 3277, v10
 v_lshrrev_b32 v11, 16, v11
 v_mul_u32_u24 v30, 20, v11
 v_sub_u32 v30, v10, v30
 v_lshrrev_b32 v30, 2, v30
 v_lshlrev_b32 v11, 17, v11
 v_lshlrev_b32 v31, 4, v9
 v_add3_u32 v11, v11, v31, s48
 v_lshrrev_b32 v31, 2, v30
 v_lshl_add_u32 v11, v31, 10, v11
 v_bfe_u32 v31, v30, 1, 1
 v_lshl_add_u32 v11, v31, 9, v11
 v_and_b32 v31, 1, v30
 v_lshl_add_u32 v11, v31, 3, v11
 v_mul_f32 v32, v29, v20
 v_fma_f32 v32, v28, v72, -v32
 v_mul_f32 v33, v29, v21
 v_fma_f32 v33, v28, v73, -v33
 v_mul_f32 v34, v29, v22
 v_fma_f32 v34, v28, v74, -v34
 v_mul_f32 v35, v29, v23
 v_fma_f32 v35, v28, v75, -v35
 v_cvt_pk_bf16_f32 v36, v32, v33
 v_cvt_pk_bf16_f32 v37, v34, v35
 v_cmp_gt_u32 vcc, 20, v10
 s_and_saveexec_b64 s[50:51], vcc
 buffer_store_dwordx2 v[36:37], v11, s[24:27], 0 offen
 s_mov_b64 exec, s[50:51]
 s_waitcnt vmcnt(3)
 v_add_u32 v10, 24, v8
 v_mul_u32_u24 v11, 3277, v10
 v_lshrrev_b32 v11, 16, v11
 v_mul_u32_u24 v30, 20, v11
 v_sub_u32 v30, v10, v30
 v_lshrrev_b32 v30, 2, v30
 v_lshlrev_b32 v11, 17, v11
 v_lshlrev_b32 v31, 4, v9
 v_add3_u32 v11, v11, v31, s48
 v_lshrrev_b32 v31, 2, v30
 v_lshl_add_u32 v11, v31, 10, v11
 v_bfe_u32 v31, v30, 1, 1
 v_lshl_add_u32 v11, v31, 9, v11
 v_and_b32 v31, 1, v30
 v_lshl_add_u32 v11, v31, 3, v11
 v_mul_f32 v32, v29, v24
 v_fma_f32 v32, v28, v76, -v32
 v_mul_f32 v33, v29, v25
 v_fma_f32 v33, v28, v77, -v33
 v_mul_f32 v34, v29, v26
 v_fma_f32 v34, v28, v78, -v34
 v_mul_f32 v35, v29, v27
 v_fma_f32 v35, v28, v79, -v35
 v_cvt_pk_bf16_f32 v36, v32, v33
 v_cvt_pk_bf16_f32 v37, v34, v35
 v_cmp_gt_u32 vcc, 20, v10
 s_and_saveexec_b64 s[50:51], vcc
 buffer_store_dwordx2 v[36:37], v11, s[24:27], 0 offen
 s_mov_b64 exec, s[50:51]
 v_mul_f32 v28, s47, v182
 v_mul_f32 v29, s47, v184
 s_lshl_b32 s48, s32, 1
 s_add_u32 s48, s48, 1
 s_lshl_b32 s48, s48, 11
 v_add_u32 v10, 0, v8
 v_mul_u32_u24 v11, 3277, v10
 v_lshrrev_b32 v11, 16, v11
 v_mul_u32_u24 v30, 20, v11
 v_sub_u32 v30, v10, v30
 v_lshrrev_b32 v30, 2, v30
 v_lshlrev_b32 v11, 17, v11
 v_lshlrev_b32 v31, 4, v9
 v_add3_u32 v11, v11, v31, s48
 v_lshrrev_b32 v31, 2, v30
 v_lshl_add_u32 v11, v31, 10, v11
 v_bfe_u32 v31, v30, 1, 1
 v_lshl_add_u32 v11, v31, 9, v11
 v_and_b32 v31, 1, v30
 v_lshl_add_u32 v11, v31, 3, v11
 v_mul_f32 v32, v29, v12
 v_fma_f32 v32, v28, v80, -v32
 v_mul_f32 v33, v29, v13
 v_fma_f32 v33, v28, v81, -v33
 v_mul_f32 v34, v29, v14
 v_fma_f32 v34, v28, v82, -v34
 v_mul_f32 v35, v29, v15
 v_fma_f32 v35, v28, v83, -v35
 v_cvt_pk_bf16_f32 v36, v32, v33
 v_cvt_pk_bf16_f32 v37, v34, v35
 v_cmp_gt_u32 vcc, 20, v10
 s_and_saveexec_b64 s[50:51], vcc
 buffer_store_dwordx2 v[36:37], v11, s[24:27], 0 offen
 s_mov_b64 exec, s[50:51]
 v_add_u32 v10, 8, v8
 v_mul_u32_u24 v11, 3277, v10
 v_lshrrev_b32 v11, 16, v11
 v_mul_u32_u24 v30, 20, v11
 v_sub_u32 v30, v10, v30
 v_lshrrev_b32 v30, 2, v30
 v_lshlrev_b32 v11, 17, v11
 v_lshlrev_b32 v31, 4, v9
 v_add3_u32 v11, v11, v31, s48
 v_lshrrev_b32 v31, 2, v30
 v_lshl_add_u32 v11, v31, 10, v11
 v_bfe_u32 v31, v30, 1, 1
 v_lshl_add_u32 v11, v31, 9, v11
 v_and_b32 v31, 1, v30
 v_lshl_add_u32 v11, v31, 3, v11
 v_mul_f32 v32, v29, v16
 v_fma_f32 v32, v28, v84, -v32
 v_mul_f32 v33, v29, v17
 v_fma_f32 v33, v28, v85, -v33
 v_mul_f32 v34, v29, v18
 v_fma_f32 v34, v28, v86, -v34
 v_mul_f32 v35, v29, v19
 v_fma_f32 v35, v28, v87, -v35
 v_cvt_pk_bf16_f32 v36, v32, v33
 v_cvt_pk_bf16_f32 v37, v34, v35
 v_cmp_gt_u32 vcc, 20, v10
 s_and_saveexec_b64 s[50:51], vcc
 buffer_store_dwordx2 v[36:37], v11, s[24:27], 0 offen
 s_mov_b64 exec, s[50:51]
 v_add_u32 v10, 16, v8
 v_mul_u32_u24 v11, 3277, v10
 v_lshrrev_b32 v11, 16, v11
 v_mul_u32_u24 v30, 20, v11
 v_sub_u32 v30, v10, v30
 v_lshrrev_b32 v30, 2, v30
 v_lshlrev_b32 v11, 17, v11
 v_lshlrev_b32 v31, 4, v9
 v_add3_u32 v11, v11, v31, s48
 v_lshrrev_b32 v31, 2, v30
 v_lshl_add_u32 v11, v31, 10, v11
 v_bfe_u32 v31, v30, 1, 1
 v_lshl_add_u32 v11, v31, 9, v11
 v_and_b32 v31, 1, v30
 v_lshl_add_u32 v11, v31, 3, v11
 v_mul_f32 v32, v29, v20
 v_fma_f32 v32, v28, v88, -v32
 v_mul_f32 v33, v29, v21
 v_fma_f32 v33, v28, v89, -v33
 v_mul_f32 v34, v29, v22
 v_fma_f32 v34, v28, v90, -v34
 v_mul_f32 v35, v29, v23
 v_fma_f32 v35, v28, v91, -v35
 v_cvt_pk_bf16_f32 v36, v32, v33
 v_cvt_pk_bf16_f32 v37, v34, v35
 v_cmp_gt_u32 vcc, 20, v10
 s_and_saveexec_b64 s[50:51], vcc
 buffer_store_dwordx2 v[36:37], v11, s[24:27], 0 offen
 s_mov_b64 exec, s[50:51]
 v_add_u32 v10, 24, v8
 v_mul_u32_u24 v11, 3277, v10
 v_lshrrev_b32 v11, 16, v11
 v_mul_u32_u24 v30, 20, v11
 v_sub_u32 v30, v10, v30
 v_lshrrev_b32 v30, 2, v30
 v_lshlrev_b32 v11, 17, v11
 v_lshlrev_b32 v31, 4, v9
 v_add3_u32 v11, v11, v31, s48
 v_lshrrev_b32 v31, 2, v30
 v_lshl_add_u32 v11, v31, 10, v11
 v_bfe_u32 v31, v30, 1, 1
 v_lshl_add_u32 v11, v31, 9, v11
 v_and_b32 v31, 1, v30
 v_lshl_add_u32 v11, v31, 3, v11
 v_mul_f32 v32, v29, v24
 v_fma_f32 v32, v28, v92, -v32
 v_mul_f32 v33, v29, v25
 v_fma_f32 v33, v28, v93, -v33
 v_mul_f32 v34, v29, v26
 v_fma_f32 v34, v28, v94, -v34
 v_mul_f32 v35, v29, v27
 v_fma_f32 v35, v28, v95, -v35
 v_cvt_pk_bf16_f32 v36, v32, v33
 v_cvt_pk_bf16_f32 v37, v34, v35
 v_cmp_gt_u32 vcc, 20, v10
 s_and_saveexec_b64 s[50:51], vcc
 buffer_store_dwordx2 v[36:37], v11, s[24:27], 0 offen
 s_mov_b64 exec, s[50:51]
 s_branch L_a1_2_kernel_end
L_a1_2_kernel_vtype:
 buffer_load_dwordx4 v[128:131], v4, s[12:15], s42 offen
 s_add_u32 s42, s42, 1024
 buffer_load_dwordx4 v[132:135], v4, s[12:15], s42 offen
 s_add_u32 s42, s42, 1024
 buffer_load_dwordx4 v[136:139], v4, s[12:15], s42 offen
 s_add_u32 s42, s42, 1024
 buffer_load_dwordx4 v[140:143], v4, s[12:15], s42 offen
 s_add_u32 s42, s42, 1024
 ds_read_b128 v[160:163], v5 offset:0
 ds_read_b128 v[164:167], v7 offset:0
 ds_read_b128 v[168:171], v5 offset:32
 ds_read_b128 v[172:175], v7 offset:32
 s_waitcnt vmcnt(3) lgkmcnt(2)
 v_mfma_f32_32x32x16_bf16 v[64:79], v[160:163], v[128:131], v[64:79]
 v_mfma_f32_32x32x16_bf16 v[80:95], v[164:167], v[128:131], v[80:95]
 v_dot2c_f32_bf16 v176, v160, v180
 v_dot2c_f32_bf16 v178, v160, v160
 v_dot2c_f32_bf16 v176, v161, v180
 v_dot2c_f32_bf16 v178, v161, v161
 v_dot2c_f32_bf16 v176, v162, v180
 v_dot2c_f32_bf16 v178, v162, v162
 v_dot2c_f32_bf16 v176, v163, v180
 v_dot2c_f32_bf16 v178, v163, v163
 v_dot2c_f32_bf16 v177, v164, v180
 v_dot2c_f32_bf16 v179, v164, v164
 v_dot2c_f32_bf16 v177, v165, v180
 v_dot2c_f32_bf16 v179, v165, v165
 v_dot2c_f32_bf16 v177, v166, v180
 v_dot2c_f32_bf16 v179, v166, v166
 v_dot2c_f32_bf16 v177, v167, v180
 v_dot2c_f32_bf16 v179, v167, v167
 buffer_load_dwordx4 v[128:131], v4, s[12:15], s42 offen
 s_add_u32 s42, s42, 1024
 ds_read_b128 v[160:163], v5 offset:64
 ds_read_b128 v[164:167], v7 offset:64
 s_waitcnt vmcnt(3) lgkmcnt(2)
 v_mfma_f32_32x32x16_bf16 v[64:79], v[168:171], v[132:135], v[64:79]
 v_mfma_f32_32x32x16_bf16 v[80:95], v[172:175], v[132:135], v[80:95]
 v_dot2c_f32_bf16 v176, v168, v180
 v_dot2c_f32_bf16 v178, v168, v168
 v_dot2c_f32_bf16 v176, v169, v180
 v_dot2c_f32_bf16 v178, v169, v169
 v_dot2c_f32_bf16 v176, v170, v180
 v_dot2c_f32_bf16 v178, v170, v170
 v_dot2c_f32_bf16 v176, v171, v180
 v_dot2c_f32_bf16 v178, v171, v171
 v_dot2c_f32_bf16 v177, v172, v180
 v_dot2c_f32_bf16 v179, v172, v172
 v_dot2c_f32_bf16 v177, v173, v180
 v_dot2c_f32_bf16 v179, v173, v173
 v_dot2c_f32_bf16 v177, v174, v180
 v_dot2c_f32_bf16 v179, v174, v174
 v_dot2c_f32_bf16 v177, v175, v180
 v_dot2c_f32_bf16 v179, v175, v175
 buffer_load_dwordx4 v[132:135], v4, s[12:15], s42 offen
 s_add_u32 s42, s42, 1024
 ds_read_b128 v[168:171], v5 offset:96
 ds_read_b128 v[172:175], v7 offset:96
 s_waitcnt vmcnt(3) lgkmcnt(2)
 v_mfma_f32_32x32x16_bf16 v[64:79], v[160:163], v[136:139], v[64:79]
 v_mfma_f32_32x32x16_bf16 v[80:95], v[164:167], v[136:139], v[80:95]
 v_dot2c_f32_bf16 v176, v160, v180
 v_dot2c_f32_bf16 v178, v160, v160
 v_dot2c_f32_bf16 v176, v161, v180
 v_dot2c_f32_bf16 v178, v161, v161
 v_dot2c_f32_bf16 v176, v162, v180
 v_dot2c_f32_bf16 v178, v162, v162
 v_dot2c_f32_bf16 v176, v163, v180
 v_dot2c_f32_bf16 v178, v163, v163
 v_dot2c_f32_bf16 v177, v164, v180
 v_dot2c_f32_bf16 v179, v164, v164
 v_dot2c_f32_bf16 v177, v165, v180
 v_dot2c_f32_bf16 v179, v165, v165
 v_dot2c_f32_bf16 v177, v166, v180
 v_dot2c_f32_bf16 v179, v166, v166
 v_dot2c_f32_bf16 v177, v167, v180
 v_dot2c_f32_bf16 v179, v167, v167
 buffer_load_dwordx4 v[136:139], v4, s[12:15], s42 offen
 s_add_u32 s42, s42, 1024
 ds_read_b128 v[160:163], v5 offset:128
 ds_read_b128 v[164:167], v7 offset:128
 s_waitcnt vmcnt(3) lgkmcnt(2)
 v_mfma_f32_32x32x16_bf16 v[64:79], v[168:171], v[140:143], v[64:79]
 v_mfma_f32_32x32x16_bf16 v[80:95], v[172:175], v[140:143], v[80:95]
 v_dot2c_f32_bf16 v176, v168, v180
 v_dot2c_f32_bf16 v178, v168, v168
 v_dot2c_f32_bf16 v176, v169, v180
 v_dot2c_f32_bf16 v178, v169, v169
 v_dot2c_f32_bf16 v176, v170, v180
 v_dot2c_f32_bf16 v178, v170, v170
 v_dot2c_f32_bf16 v176, v171, v180
 v_dot2c_f32_bf16 v178, v171, v171
 v_dot2c_f32_bf16 v177, v172, v180
 v_dot2c_f32_bf16 v179, v172, v172
 v_dot2c_f32_bf16 v177, v173, v180
 v_dot2c_f32_bf16 v179, v173, v173
 v_dot2c_f32_bf16 v177, v174, v180
 v_dot2c_f32_bf16 v179, v174, v174
 v_dot2c_f32_bf16 v177, v175, v180
 v_dot2c_f32_bf16 v179, v175, v175
 buffer_load_dwordx4 v[140:143], v4, s[12:15], s42 offen
 s_add_u32 s42, s42, 1024
 ds_read_b128 v[168:171], v5 offset:160
 ds_read_b128 v[172:175], v7 offset:160
 s_waitcnt vmcnt(3) lgkmcnt(2)
 v_mfma_f32_32x32x16_bf16 v[64:79], v[160:163], v[128:131], v[64:79]
 v_mfma_f32_32x32x16_bf16 v[80:95], v[164:167], v[128:131], v[80:95]
 v_dot2c_f32_bf16 v176, v160, v180
 v_dot2c_f32_bf16 v178, v160, v160
 v_dot2c_f32_bf16 v176, v161, v180
 v_dot2c_f32_bf16 v178, v161, v161
 v_dot2c_f32_bf16 v176, v162, v180
 v_dot2c_f32_bf16 v178, v162, v162
 v_dot2c_f32_bf16 v176, v163, v180
 v_dot2c_f32_bf16 v178, v163, v163
 v_dot2c_f32_bf16 v177, v164, v180
 v_dot2c_f32_bf16 v179, v164, v164
 v_dot2c_f32_bf16 v177, v165, v180
 v_dot2c_f32_bf16 v179, v165, v165
 v_dot2c_f32_bf16 v177, v166, v180
 v_dot2c_f32_bf16 v179, v166, v166
 v_dot2c_f32_bf16 v177, v167, v180
 v_dot2c_f32_bf16 v179, v167, v167
 buffer_load_dwordx4 v[128:131], v4, s[12:15], s42 offen
 s_add_u32 s42, s42, 1024
 ds_read_b128 v[160:163], v5 offset:192
 ds_read_b128 v[164:167], v7 offset:192
 s_waitcnt vmcnt(3) lgkmcnt(2)
 v_mfma_f32_32x32x16_bf16 v[64:79], v[168:171], v[132:135], v[64:79]
 v_mfma_f32_32x32x16_bf16 v[80:95], v[172:175], v[132:135], v[80:95]
 v_dot2c_f32_bf16 v176, v168, v180
 v_dot2c_f32_bf16 v178, v168, v168
 v_dot2c_f32_bf16 v176, v169, v180
 v_dot2c_f32_bf16 v178, v169, v169
 v_dot2c_f32_bf16 v176, v170, v180
 v_dot2c_f32_bf16 v178, v170, v170
 v_dot2c_f32_bf16 v176, v171, v180
 v_dot2c_f32_bf16 v178, v171, v171
 v_dot2c_f32_bf16 v177, v172, v180
 v_dot2c_f32_bf16 v179, v172, v172
 v_dot2c_f32_bf16 v177, v173, v180
 v_dot2c_f32_bf16 v179, v173, v173
 v_dot2c_f32_bf16 v177, v174, v180
 v_dot2c_f32_bf16 v179, v174, v174
 v_dot2c_f32_bf16 v177, v175, v180
 v_dot2c_f32_bf16 v179, v175, v175
 buffer_load_dwordx4 v[132:135], v4, s[12:15], s42 offen
 s_add_u32 s42, s42, 1024
 ds_read_b128 v[168:171], v5 offset:224
 ds_read_b128 v[172:175], v7 offset:224
 s_waitcnt vmcnt(3) lgkmcnt(2)
 v_mfma_f32_32x32x16_bf16 v[64:79], v[160:163], v[136:139], v[64:79]
 v_mfma_f32_32x32x16_bf16 v[80:95], v[164:167], v[136:139], v[80:95]
 v_dot2c_f32_bf16 v176, v160, v180
 v_dot2c_f32_bf16 v178, v160, v160
 v_dot2c_f32_bf16 v176, v161, v180
 v_dot2c_f32_bf16 v178, v161, v161
 v_dot2c_f32_bf16 v176, v162, v180
 v_dot2c_f32_bf16 v178, v162, v162
 v_dot2c_f32_bf16 v176, v163, v180
 v_dot2c_f32_bf16 v178, v163, v163
 v_dot2c_f32_bf16 v177, v164, v180
 v_dot2c_f32_bf16 v179, v164, v164
 v_dot2c_f32_bf16 v177, v165, v180
 v_dot2c_f32_bf16 v179, v165, v165
 v_dot2c_f32_bf16 v177, v166, v180
 v_dot2c_f32_bf16 v179, v166, v166
 v_dot2c_f32_bf16 v177, v167, v180
 v_dot2c_f32_bf16 v179, v167, v167
 buffer_load_dwordx4 v[136:139], v4, s[12:15], s42 offen
 s_add_u32 s42, s42, 1024
 ds_read_b128 v[160:163], v5 offset:256
 ds_read_b128 v[164:167], v7 offset:256
 s_waitcnt vmcnt(3) lgkmcnt(2)
 v_mfma_f32_32x32x16_bf16 v[64:79], v[168:171], v[140:143], v[64:79]
 v_mfma_f32_32x32x16_bf16 v[80:95], v[172:175], v[140:143], v[80:95]
 v_dot2c_f32_bf16 v176, v168, v180
 v_dot2c_f32_bf16 v178, v168, v168
 v_dot2c_f32_bf16 v176, v169, v180
 v_dot2c_f32_bf16 v178, v169, v169
 v_dot2c_f32_bf16 v176, v170, v180
 v_dot2c_f32_bf16 v178, v170, v170
 v_dot2c_f32_bf16 v176, v171, v180
 v_dot2c_f32_bf16 v178, v171, v171
 v_dot2c_f32_bf16 v177, v172, v180
 v_dot2c_f32_bf16 v179, v172, v172
 v_dot2c_f32_bf16 v177, v173, v180
 v_dot2c_f32_bf16 v179, v173, v173
 v_dot2c_f32_bf16 v177, v174, v180
 v_dot2c_f32_bf16 v179, v174, v174
 v_dot2c_f32_bf16 v177, v175, v180
 v_dot2c_f32_bf16 v179, v175, v175
 buffer_load_dwordx4 v[140:143], v4, s[12:15], s42 offen
 s_add_u32 s42, s42, 1024
 ds_read_b128 v[168:171], v5 offset:288
 ds_read_b128 v[172:175], v7 offset:288
 s_waitcnt vmcnt(3) lgkmcnt(2)
 v_mfma_f32_32x32x16_bf16 v[64:79], v[160:163], v[128:131], v[64:79]
 v_mfma_f32_32x32x16_bf16 v[80:95], v[164:167], v[128:131], v[80:95]
 v_dot2c_f32_bf16 v176, v160, v180
 v_dot2c_f32_bf16 v178, v160, v160
 v_dot2c_f32_bf16 v176, v161, v180
 v_dot2c_f32_bf16 v178, v161, v161
 v_dot2c_f32_bf16 v176, v162, v180
 v_dot2c_f32_bf16 v178, v162, v162
 v_dot2c_f32_bf16 v176, v163, v180
 v_dot2c_f32_bf16 v178, v163, v163
 v_dot2c_f32_bf16 v177, v164, v180
 v_dot2c_f32_bf16 v179, v164, v164
 v_dot2c_f32_bf16 v177, v165, v180
 v_dot2c_f32_bf16 v179, v165, v165
 v_dot2c_f32_bf16 v177, v166, v180
 v_dot2c_f32_bf16 v179, v166, v166
 v_dot2c_f32_bf16 v177, v167, v180
 v_dot2c_f32_bf16 v179, v167, v167
 buffer_load_dwordx4 v[128:131], v4, s[12:15], s42 offen
 s_add_u32 s42, s42, 1024
 ds_read_b128 v[160:163], v5 offset:320
 ds_read_b128 v[164:167], v7 offset:320
 s_waitcnt vmcnt(3) lgkmcnt(2)
 v_mfma_f32_32x32x16_bf16 v[64:79], v[168:171], v[132:135], v[64:79]
 v_mfma_f32_32x32x16_bf16 v[80:95], v[172:175], v[132:135], v[80:95]
 v_dot2c_f32_bf16 v176, v168, v180
 v_dot2c_f32_bf16 v178, v168, v168
 v_dot2c_f32_bf16 v176, v169, v180
 v_dot2c_f32_bf16 v178, v169, v169
 v_dot2c_f32_bf16 v176, v170, v180
 v_dot2c_f32_bf16 v178, v170, v170
 v_dot2c_f32_bf16 v176, v171, v180
 v_dot2c_f32_bf16 v178, v171, v171
 v_dot2c_f32_bf16 v177, v172, v180
 v_dot2c_f32_bf16 v179, v172, v172
 v_dot2c_f32_bf16 v177, v173, v180
 v_dot2c_f32_bf16 v179, v173, v173
 v_dot2c_f32_bf16 v177, v174, v180
 v_dot2c_f32_bf16 v179, v174, v174
 v_dot2c_f32_bf16 v177, v175, v180
 v_dot2c_f32_bf16 v179, v175, v175
 buffer_load_dwordx4 v[132:135], v4, s[12:15], s42 offen
 s_add_u32 s42, s42, 1024
 ds_read_b128 v[168:171], v5 offset:352
 ds_read_b128 v[172:175], v7 offset:352
 s_waitcnt vmcnt(3) lgkmcnt(2)
 v_mfma_f32_32x32x16_bf16 v[64:79], v[160:163], v[136:139], v[64:79]
 v_mfma_f32_32x32x16_bf16 v[80:95], v[164:167], v[136:139], v[80:95]
 v_dot2c_f32_bf16 v176, v160, v180
 v_dot2c_f32_bf16 v178, v160, v160
 v_dot2c_f32_bf16 v176, v161, v180
 v_dot2c_f32_bf16 v178, v161, v161
 v_dot2c_f32_bf16 v176, v162, v180
 v_dot2c_f32_bf16 v178, v162, v162
 v_dot2c_f32_bf16 v176, v163, v180
 v_dot2c_f32_bf16 v178, v163, v163
 v_dot2c_f32_bf16 v177, v164, v180
 v_dot2c_f32_bf16 v179, v164, v164
 v_dot2c_f32_bf16 v177, v165, v180
 v_dot2c_f32_bf16 v179, v165, v165
 v_dot2c_f32_bf16 v177, v166, v180
 v_dot2c_f32_bf16 v179, v166, v166
 v_dot2c_f32_bf16 v177, v167, v180
 v_dot2c_f32_bf16 v179, v167, v167
 buffer_load_dwordx4 v[136:139], v4, s[12:15], s42 offen
 s_add_u32 s42, s42, 1024
 ds_read_b128 v[160:163], v5 offset:384
 ds_read_b128 v[164:167], v7 offset:384
 s_waitcnt vmcnt(3) lgkmcnt(2)
 v_mfma_f32_32x32x16_bf16 v[64:79], v[168:171], v[140:143], v[64:79]
 v_mfma_f32_32x32x16_bf16 v[80:95], v[172:175], v[140:143], v[80:95]
 v_dot2c_f32_bf16 v176, v168, v180
 v_dot2c_f32_bf16 v178, v168, v168
 v_dot2c_f32_bf16 v176, v169, v180
 v_dot2c_f32_bf16 v178, v169, v169
 v_dot2c_f32_bf16 v176, v170, v180
 v_dot2c_f32_bf16 v178, v170, v170
 v_dot2c_f32_bf16 v176, v171, v180
 v_dot2c_f32_bf16 v178, v171, v171
 v_dot2c_f32_bf16 v177, v172, v180
 v_dot2c_f32_bf16 v179, v172, v172
 v_dot2c_f32_bf16 v177, v173, v180
 v_dot2c_f32_bf16 v179, v173, v173
 v_dot2c_f32_bf16 v177, v174, v180
 v_dot2c_f32_bf16 v179, v174, v174
 v_dot2c_f32_bf16 v177, v175, v180
 v_dot2c_f32_bf16 v179, v175, v175
 buffer_load_dwordx4 v[140:143], v4, s[12:15], s42 offen
 s_add_u32 s42, s42, 1024
 ds_read_b128 v[168:171], v5 offset:416
 ds_read_b128 v[172:175], v7 offset:416
 s_waitcnt vmcnt(3) lgkmcnt(2)
 v_mfma_f32_32x32x16_bf16 v[64:79], v[160:163], v[128:131], v[64:79]
 v_mfma_f32_32x32x16_bf16 v[80:95], v[164:167], v[128:131], v[80:95]
 v_dot2c_f32_bf16 v176, v160, v180
 v_dot2c_f32_bf16 v178, v160, v160
 v_dot2c_f32_bf16 v176, v161, v180
 v_dot2c_f32_bf16 v178, v161, v161
 v_dot2c_f32_bf16 v176, v162, v180
 v_dot2c_f32_bf16 v178, v162, v162
 v_dot2c_f32_bf16 v176, v163, v180
 v_dot2c_f32_bf16 v178, v163, v163
 v_dot2c_f32_bf16 v177, v164, v180
 v_dot2c_f32_bf16 v179, v164, v164
 v_dot2c_f32_bf16 v177, v165, v180
 v_dot2c_f32_bf16 v179, v165, v165
 v_dot2c_f32_bf16 v177, v166, v180
 v_dot2c_f32_bf16 v179, v166, v166
 v_dot2c_f32_bf16 v177, v167, v180
 v_dot2c_f32_bf16 v179, v167, v167
 buffer_load_dwordx4 v[128:131], v4, s[12:15], s42 offen
 s_add_u32 s42, s42, 1024
 ds_read_b128 v[160:163], v5 offset:448
 ds_read_b128 v[164:167], v7 offset:448
 s_waitcnt vmcnt(3) lgkmcnt(2)
 v_mfma_f32_32x32x16_bf16 v[64:79], v[168:171], v[132:135], v[64:79]
 v_mfma_f32_32x32x16_bf16 v[80:95], v[172:175], v[132:135], v[80:95]
 v_dot2c_f32_bf16 v176, v168, v180
 v_dot2c_f32_bf16 v178, v168, v168
 v_dot2c_f32_bf16 v176, v169, v180
 v_dot2c_f32_bf16 v178, v169, v169
 v_dot2c_f32_bf16 v176, v170, v180
 v_dot2c_f32_bf16 v178, v170, v170
 v_dot2c_f32_bf16 v176, v171, v180
 v_dot2c_f32_bf16 v178, v171, v171
 v_dot2c_f32_bf16 v177, v172, v180
 v_dot2c_f32_bf16 v179, v172, v172
 v_dot2c_f32_bf16 v177, v173, v180
 v_dot2c_f32_bf16 v179, v173, v173
 v_dot2c_f32_bf16 v177, v174, v180
 v_dot2c_f32_bf16 v179, v174, v174
 v_dot2c_f32_bf16 v177, v175, v180
 v_dot2c_f32_bf16 v179, v175, v175
 buffer_load_dwordx4 v[132:135], v4, s[12:15], s42 offen
 s_add_u32 s42, s42, 1024
 ds_read_b128 v[168:171], v5 offset:480
 ds_read_b128 v[172:175], v7 offset:480
 s_waitcnt vmcnt(3) lgkmcnt(2)
 v_mfma_f32_32x32x16_bf16 v[64:79], v[160:163], v[136:139], v[64:79]
 v_mfma_f32_32x32x16_bf16 v[80:95], v[164:167], v[136:139], v[80:95]
 v_dot2c_f32_bf16 v176, v160, v180
 v_dot2c_f32_bf16 v178, v160, v160
 v_dot2c_f32_bf16 v176, v161, v180
 v_dot2c_f32_bf16 v178, v161, v161
 v_dot2c_f32_bf16 v176, v162, v180
 v_dot2c_f32_bf16 v178, v162, v162
 v_dot2c_f32_bf16 v176, v163, v180
 v_dot2c_f32_bf16 v178, v163, v163
 v_dot2c_f32_bf16 v177, v164, v180
 v_dot2c_f32_bf16 v179, v164, v164
 v_dot2c_f32_bf16 v177, v165, v180
 v_dot2c_f32_bf16 v179, v165, v165
 v_dot2c_f32_bf16 v177, v166, v180
 v_dot2c_f32_bf16 v179, v166, v166
 v_dot2c_f32_bf16 v177, v167, v180
 v_dot2c_f32_bf16 v179, v167, v167
 buffer_load_dwordx4 v[136:139], v4, s[12:15], s42 offen
 s_add_u32 s42, s42, 1024
 ds_read_b128 v[160:163], v5 offset:512
 ds_read_b128 v[164:167], v7 offset:512
 s_waitcnt vmcnt(3) lgkmcnt(2)
 v_mfma_f32_32x32x16_bf16 v[64:79], v[168:171], v[140:143], v[64:79]
 v_mfma_f32_32x32x16_bf16 v[80:95], v[172:175], v[140:143], v[80:95]
 v_dot2c_f32_bf16 v176, v168, v180
 v_dot2c_f32_bf16 v178, v168, v168
 v_dot2c_f32_bf16 v176, v169, v180
 v_dot2c_f32_bf16 v178, v169, v169
 v_dot2c_f32_bf16 v176, v170, v180
 v_dot2c_f32_bf16 v178, v170, v170
 v_dot2c_f32_bf16 v176, v171, v180
 v_dot2c_f32_bf16 v178, v171, v171
 v_dot2c_f32_bf16 v177, v172, v180
 v_dot2c_f32_bf16 v179, v172, v172
 v_dot2c_f32_bf16 v177, v173, v180
 v_dot2c_f32_bf16 v179, v173, v173
 v_dot2c_f32_bf16 v177, v174, v180
 v_dot2c_f32_bf16 v179, v174, v174
 v_dot2c_f32_bf16 v177, v175, v180
 v_dot2c_f32_bf16 v179, v175, v175
 buffer_load_dwordx4 v[140:143], v4, s[12:15], s42 offen
 s_add_u32 s42, s42, 1024
 ds_read_b128 v[168:171], v5 offset:544
 ds_read_b128 v[172:175], v7 offset:544
 s_waitcnt vmcnt(3) lgkmcnt(2)
 v_mfma_f32_32x32x16_bf16 v[64:79], v[160:163], v[128:131], v[64:79]
 v_mfma_f32_32x32x16_bf16 v[80:95], v[164:167], v[128:131], v[80:95]
 v_dot2c_f32_bf16 v176, v160, v180
 v_dot2c_f32_bf16 v178, v160, v160
 v_dot2c_f32_bf16 v176, v161, v180
 v_dot2c_f32_bf16 v178, v161, v161
 v_dot2c_f32_bf16 v176, v162, v180
 v_dot2c_f32_bf16 v178, v162, v162
 v_dot2c_f32_bf16 v176, v163, v180
 v_dot2c_f32_bf16 v178, v163, v163
 v_dot2c_f32_bf16 v177, v164, v180
 v_dot2c_f32_bf16 v179, v164, v164
 v_dot2c_f32_bf16 v177, v165, v180
 v_dot2c_f32_bf16 v179, v165, v165
 v_dot2c_f32_bf16 v177, v166, v180
 v_dot2c_f32_bf16 v179, v166, v166
 v_dot2c_f32_bf16 v177, v167, v180
 v_dot2c_f32_bf16 v179, v167, v167
 buffer_load_dwordx4 v[128:131], v4, s[12:15], s42 offen
 s_add_u32 s42, s42, 1024
 ds_read_b128 v[160:163], v5 offset:576
 ds_read_b128 v[164:167], v7 offset:576
 s_waitcnt vmcnt(3) lgkmcnt(2)
 v_mfma_f32_32x32x16_bf16 v[64:79], v[168:171], v[132:135], v[64:79]
 v_mfma_f32_32x32x16_bf16 v[80:95], v[172:175], v[132:135], v[80:95]
 v_dot2c_f32_bf16 v176, v168, v180
 v_dot2c_f32_bf16 v178, v168, v168
 v_dot2c_f32_bf16 v176, v169, v180
 v_dot2c_f32_bf16 v178, v169, v169
 v_dot2c_f32_bf16 v176, v170, v180
 v_dot2c_f32_bf16 v178, v170, v170
 v_dot2c_f32_bf16 v176, v171, v180
 v_dot2c_f32_bf16 v178, v171, v171
 v_dot2c_f32_bf16 v177, v172, v180
 v_dot2c_f32_bf16 v179, v172, v172
 v_dot2c_f32_bf16 v177, v173, v180
 v_dot2c_f32_bf16 v179, v173, v173
 v_dot2c_f32_bf16 v177, v174, v180
 v_dot2c_f32_bf16 v179, v174, v174
 v_dot2c_f32_bf16 v177, v175, v180
 v_dot2c_f32_bf16 v179, v175, v175
 buffer_load_dwordx4 v[132:135], v4, s[12:15], s42 offen
 s_add_u32 s42, s42, 1024
 ds_read_b128 v[168:171], v5 offset:608
 ds_read_b128 v[172:175], v7 offset:608
 s_waitcnt vmcnt(3) lgkmcnt(2)
 v_mfma_f32_32x32x16_bf16 v[64:79], v[160:163], v[136:139], v[64:79]
 v_mfma_f32_32x32x16_bf16 v[80:95], v[164:167], v[136:139], v[80:95]
 v_dot2c_f32_bf16 v176, v160, v180
 v_dot2c_f32_bf16 v178, v160, v160
 v_dot2c_f32_bf16 v176, v161, v180
 v_dot2c_f32_bf16 v178, v161, v161
 v_dot2c_f32_bf16 v176, v162, v180
 v_dot2c_f32_bf16 v178, v162, v162
 v_dot2c_f32_bf16 v176, v163, v180
 v_dot2c_f32_bf16 v178, v163, v163
 v_dot2c_f32_bf16 v177, v164, v180
 v_dot2c_f32_bf16 v179, v164, v164
 v_dot2c_f32_bf16 v177, v165, v180
 v_dot2c_f32_bf16 v179, v165, v165
 v_dot2c_f32_bf16 v177, v166, v180
 v_dot2c_f32_bf16 v179, v166, v166
 v_dot2c_f32_bf16 v177, v167, v180
 v_dot2c_f32_bf16 v179, v167, v167
 buffer_load_dwordx4 v[136:139], v4, s[12:15], s42 offen
 s_add_u32 s42, s42, 1024
 ds_read_b128 v[160:163], v5 offset:640
 ds_read_b128 v[164:167], v7 offset:640
 s_waitcnt vmcnt(3) lgkmcnt(2)
 v_mfma_f32_32x32x16_bf16 v[64:79], v[168:171], v[140:143], v[64:79]
 v_mfma_f32_32x32x16_bf16 v[80:95], v[172:175], v[140:143], v[80:95]
 v_dot2c_f32_bf16 v176, v168, v180
 v_dot2c_f32_bf16 v178, v168, v168
 v_dot2c_f32_bf16 v176, v169, v180
 v_dot2c_f32_bf16 v178, v169, v169
 v_dot2c_f32_bf16 v176, v170, v180
 v_dot2c_f32_bf16 v178, v170, v170
 v_dot2c_f32_bf16 v176, v171, v180
 v_dot2c_f32_bf16 v178, v171, v171
 v_dot2c_f32_bf16 v177, v172, v180
 v_dot2c_f32_bf16 v179, v172, v172
 v_dot2c_f32_bf16 v177, v173, v180
 v_dot2c_f32_bf16 v179, v173, v173
 v_dot2c_f32_bf16 v177, v174, v180
 v_dot2c_f32_bf16 v179, v174, v174
 v_dot2c_f32_bf16 v177, v175, v180
 v_dot2c_f32_bf16 v179, v175, v175
 buffer_load_dwordx4 v[140:143], v4, s[12:15], s42 offen
 s_add_u32 s42, s42, 1024
 ds_read_b128 v[168:171], v5 offset:672
 ds_read_b128 v[172:175], v7 offset:672
 s_waitcnt vmcnt(3) lgkmcnt(2)
 v_mfma_f32_32x32x16_bf16 v[64:79], v[160:163], v[128:131], v[64:79]
 v_mfma_f32_32x32x16_bf16 v[80:95], v[164:167], v[128:131], v[80:95]
 v_dot2c_f32_bf16 v176, v160, v180
 v_dot2c_f32_bf16 v178, v160, v160
 v_dot2c_f32_bf16 v176, v161, v180
 v_dot2c_f32_bf16 v178, v161, v161
 v_dot2c_f32_bf16 v176, v162, v180
 v_dot2c_f32_bf16 v178, v162, v162
 v_dot2c_f32_bf16 v176, v163, v180
 v_dot2c_f32_bf16 v178, v163, v163
 v_dot2c_f32_bf16 v177, v164, v180
 v_dot2c_f32_bf16 v179, v164, v164
 v_dot2c_f32_bf16 v177, v165, v180
 v_dot2c_f32_bf16 v179, v165, v165
 v_dot2c_f32_bf16 v177, v166, v180
 v_dot2c_f32_bf16 v179, v166, v166
 v_dot2c_f32_bf16 v177, v167, v180
 v_dot2c_f32_bf16 v179, v167, v167
 buffer_load_dwordx4 v[128:131], v4, s[12:15], s42 offen
 s_add_u32 s42, s42, 1024
 ds_read_b128 v[160:163], v5 offset:704
 ds_read_b128 v[164:167], v7 offset:704
 s_waitcnt vmcnt(3) lgkmcnt(2)
 v_mfma_f32_32x32x16_bf16 v[64:79], v[168:171], v[132:135], v[64:79]
 v_mfma_f32_32x32x16_bf16 v[80:95], v[172:175], v[132:135], v[80:95]
 v_dot2c_f32_bf16 v176, v168, v180
 v_dot2c_f32_bf16 v178, v168, v168
 v_dot2c_f32_bf16 v176, v169, v180
 v_dot2c_f32_bf16 v178, v169, v169
 v_dot2c_f32_bf16 v176, v170, v180
 v_dot2c_f32_bf16 v178, v170, v170
 v_dot2c_f32_bf16 v176, v171, v180
 v_dot2c_f32_bf16 v178, v171, v171
 v_dot2c_f32_bf16 v177, v172, v180
 v_dot2c_f32_bf16 v179, v172, v172
 v_dot2c_f32_bf16 v177, v173, v180
 v_dot2c_f32_bf16 v179, v173, v173
 v_dot2c_f32_bf16 v177, v174, v180
 v_dot2c_f32_bf16 v179, v174, v174
 v_dot2c_f32_bf16 v177, v175, v180
 v_dot2c_f32_bf16 v179, v175, v175
 buffer_load_dwordx4 v[132:135], v4, s[12:15], s42 offen
 s_add_u32 s42, s42, 1024
 ds_read_b128 v[168:171], v5 offset:736
 ds_read_b128 v[172:175], v7 offset:736
 s_waitcnt vmcnt(3) lgkmcnt(2)
 v_mfma_f32_32x32x16_bf16 v[64:79], v[160:163], v[136:139], v[64:79]
 v_mfma_f32_32x32x16_bf16 v[80:95], v[164:167], v[136:139], v[80:95]
 v_dot2c_f32_bf16 v176, v160, v180
 v_dot2c_f32_bf16 v178, v160, v160
 v_dot2c_f32_bf16 v176, v161, v180
 v_dot2c_f32_bf16 v178, v161, v161
 v_dot2c_f32_bf16 v176, v162, v180
 v_dot2c_f32_bf16 v178, v162, v162
 v_dot2c_f32_bf16 v176, v163, v180
 v_dot2c_f32_bf16 v178, v163, v163
 v_dot2c_f32_bf16 v177, v164, v180
 v_dot2c_f32_bf16 v179, v164, v164
 v_dot2c_f32_bf16 v177, v165, v180
 v_dot2c_f32_bf16 v179, v165, v165
 v_dot2c_f32_bf16 v177, v166, v180
 v_dot2c_f32_bf16 v179, v166, v166
 v_dot2c_f32_bf16 v177, v167, v180
 v_dot2c_f32_bf16 v179, v167, v167
 buffer_load_dwordx4 v[136:139], v4, s[12:15], s42 offen
 s_add_u32 s42, s42, 1024
 ds_read_b128 v[160:163], v5 offset:768
 ds_read_b128 v[164:167], v7 offset:768
 s_waitcnt vmcnt(3) lgkmcnt(2)
 v_mfma_f32_32x32x16_bf16 v[64:79], v[168:171], v[140:143], v[64:79]
 v_mfma_f32_32x32x16_bf16 v[80:95], v[172:175], v[140:143], v[80:95]
 v_dot2c_f32_bf16 v176, v168, v180
 v_dot2c_f32_bf16 v178, v168, v168
 v_dot2c_f32_bf16 v176, v169, v180
 v_dot2c_f32_bf16 v178, v169, v169
 v_dot2c_f32_bf16 v176, v170, v180
 v_dot2c_f32_bf16 v178, v170, v170
 v_dot2c_f32_bf16 v176, v171, v180
 v_dot2c_f32_bf16 v178, v171, v171
 v_dot2c_f32_bf16 v177, v172, v180
 v_dot2c_f32_bf16 v179, v172, v172
 v_dot2c_f32_bf16 v177, v173, v180
 v_dot2c_f32_bf16 v179, v173, v173
 v_dot2c_f32_bf16 v177, v174, v180
 v_dot2c_f32_bf16 v179, v174, v174
 v_dot2c_f32_bf16 v177, v175, v180
 v_dot2c_f32_bf16 v179, v175, v175
 buffer_load_dwordx4 v[140:143], v4, s[12:15], s42 offen
 s_add_u32 s42, s42, 1024
 ds_read_b128 v[168:171], v5 offset:800
 ds_read_b128 v[172:175], v7 offset:800
 s_waitcnt vmcnt(3) lgkmcnt(2)
 v_mfma_f32_32x32x16_bf16 v[64:79], v[160:163], v[128:131], v[64:79]
 v_mfma_f32_32x32x16_bf16 v[80:95], v[164:167], v[128:131], v[80:95]
 v_dot2c_f32_bf16 v176, v160, v180
 v_dot2c_f32_bf16 v178, v160, v160
 v_dot2c_f32_bf16 v176, v161, v180
 v_dot2c_f32_bf16 v178, v161, v161
 v_dot2c_f32_bf16 v176, v162, v180
 v_dot2c_f32_bf16 v178, v162, v162
 v_dot2c_f32_bf16 v176, v163, v180
 v_dot2c_f32_bf16 v178, v163, v163
 v_dot2c_f32_bf16 v177, v164, v180
 v_dot2c_f32_bf16 v179, v164, v164
 v_dot2c_f32_bf16 v177, v165, v180
 v_dot2c_f32_bf16 v179, v165, v165
 v_dot2c_f32_bf16 v177, v166, v180
 v_dot2c_f32_bf16 v179, v166, v166
 v_dot2c_f32_bf16 v177, v167, v180
 v_dot2c_f32_bf16 v179, v167, v167
 buffer_load_dwordx4 v[128:131], v4, s[12:15], s42 offen
 s_add_u32 s42, s42, 1024
 ds_read_b128 v[160:163], v5 offset:832
 ds_read_b128 v[164:167], v7 offset:832
 s_waitcnt vmcnt(3) lgkmcnt(2)
 v_mfma_f32_32x32x16_bf16 v[64:79], v[168:171], v[132:135], v[64:79]
 v_mfma_f32_32x32x16_bf16 v[80:95], v[172:175], v[132:135], v[80:95]
 v_dot2c_f32_bf16 v176, v168, v180
 v_dot2c_f32_bf16 v178, v168, v168
 v_dot2c_f32_bf16 v176, v169, v180
 v_dot2c_f32_bf16 v178, v169, v169
 v_dot2c_f32_bf16 v176, v170, v180
 v_dot2c_f32_bf16 v178, v170, v170
 v_dot2c_f32_bf16 v176, v171, v180
 v_dot2c_f32_bf16 v178, v171, v171
 v_dot2c_f32_bf16 v177, v172, v180
 v_dot2c_f32_bf16 v179, v172, v172
 v_dot2c_f32_bf16 v177, v173, v180
 v_dot2c_f32_bf16 v179, v173, v173
 v_dot2c_f32_bf16 v177, v174, v180
 v_dot2c_f32_bf16 v179, v174, v174
 v_dot2c_f32_bf16 v177, v175, v180
 v_dot2c_f32_bf16 v179, v175, v175
 buffer_load_dwordx4 v[132:135], v4, s[12:15], s42 offen
 s_add_u32 s42, s42, 1024
 ds_read_b128 v[168:171], v5 offset:864
 ds_read_b128 v[172:175], v7 offset:864
 s_waitcnt vmcnt(3) lgkmcnt(2)
 v_mfma_f32_32x32x16_bf16 v[64:79], v[160:163], v[136:139], v[64:79]
 v_mfma_f32_32x32x16_bf16 v[80:95], v[164:167], v[136:139], v[80:95]
 v_dot2c_f32_bf16 v176, v160, v180
 v_dot2c_f32_bf16 v178, v160, v160
 v_dot2c_f32_bf16 v176, v161, v180
 v_dot2c_f32_bf16 v178, v161, v161
 v_dot2c_f32_bf16 v176, v162, v180
 v_dot2c_f32_bf16 v178, v162, v162
 v_dot2c_f32_bf16 v176, v163, v180
 v_dot2c_f32_bf16 v178, v163, v163
 v_dot2c_f32_bf16 v177, v164, v180
 v_dot2c_f32_bf16 v179, v164, v164
 v_dot2c_f32_bf16 v177, v165, v180
 v_dot2c_f32_bf16 v179, v165, v165
 v_dot2c_f32_bf16 v177, v166, v180
 v_dot2c_f32_bf16 v179, v166, v166
 v_dot2c_f32_bf16 v177, v167, v180
 v_dot2c_f32_bf16 v179, v167, v167
 buffer_load_dwordx4 v[136:139], v4, s[12:15], s42 offen
 s_add_u32 s42, s42, 1024
 ds_read_b128 v[160:163], v5 offset:896
 ds_read_b128 v[164:167], v7 offset:896
 s_waitcnt vmcnt(3) lgkmcnt(2)
 v_mfma_f32_32x32x16_bf16 v[64:79], v[168:171], v[140:143], v[64:79]
 v_mfma_f32_32x32x16_bf16 v[80:95], v[172:175], v[140:143], v[80:95]
 v_dot2c_f32_bf16 v176, v168, v180
 v_dot2c_f32_bf16 v178, v168, v168
 v_dot2c_f32_bf16 v176, v169, v180
 v_dot2c_f32_bf16 v178, v169, v169
 v_dot2c_f32_bf16 v176, v170, v180
 v_dot2c_f32_bf16 v178, v170, v170
 v_dot2c_f32_bf16 v176, v171, v180
 v_dot2c_f32_bf16 v178, v171, v171
 v_dot2c_f32_bf16 v177, v172, v180
 v_dot2c_f32_bf16 v179, v172, v172
 v_dot2c_f32_bf16 v177, v173, v180
 v_dot2c_f32_bf16 v179, v173, v173
 v_dot2c_f32_bf16 v177, v174, v180
 v_dot2c_f32_bf16 v179, v174, v174
 v_dot2c_f32_bf16 v177, v175, v180
 v_dot2c_f32_bf16 v179, v175, v175
 buffer_load_dwordx4 v[140:143], v4, s[12:15], s42 offen
 s_add_u32 s42, s42, 1024
 ds_read_b128 v[168:171], v5 offset:928
 ds_read_b128 v[172:175], v7 offset:928
 s_waitcnt vmcnt(3) lgkmcnt(2)
 v_mfma_f32_32x32x16_bf16 v[64:79], v[160:163], v[128:131], v[64:79]
 v_mfma_f32_32x32x16_bf16 v[80:95], v[164:167], v[128:131], v[80:95]
 v_dot2c_f32_bf16 v176, v160, v180
 v_dot2c_f32_bf16 v178, v160, v160
 v_dot2c_f32_bf16 v176, v161, v180
 v_dot2c_f32_bf16 v178, v161, v161
 v_dot2c_f32_bf16 v176, v162, v180
 v_dot2c_f32_bf16 v178, v162, v162
 v_dot2c_f32_bf16 v176, v163, v180
 v_dot2c_f32_bf16 v178, v163, v163
 v_dot2c_f32_bf16 v177, v164, v180
 v_dot2c_f32_bf16 v179, v164, v164
 v_dot2c_f32_bf16 v177, v165, v180
 v_dot2c_f32_bf16 v179, v165, v165
 v_dot2c_f32_bf16 v177, v166, v180
 v_dot2c_f32_bf16 v179, v166, v166
 v_dot2c_f32_bf16 v177, v167, v180
 v_dot2c_f32_bf16 v179, v167, v167
 buffer_load_dwordx4 v[128:131], v4, s[12:15], s42 offen
 s_add_u32 s42, s42, 1024
 ds_read_b128 v[160:163], v5 offset:960
 ds_read_b128 v[164:167], v7 offset:960
 s_waitcnt vmcnt(3) lgkmcnt(2)
 v_mfma_f32_32x32x16_bf16 v[64:79], v[168:171], v[132:135], v[64:79]
 v_mfma_f32_32x32x16_bf16 v[80:95], v[172:175], v[132:135], v[80:95]
 v_dot2c_f32_bf16 v176, v168, v180
 v_dot2c_f32_bf16 v178, v168, v168
 v_dot2c_f32_bf16 v176, v169, v180
 v_dot2c_f32_bf16 v178, v169, v169
 v_dot2c_f32_bf16 v176, v170, v180
 v_dot2c_f32_bf16 v178, v170, v170
 v_dot2c_f32_bf16 v176, v171, v180
 v_dot2c_f32_bf16 v178, v171, v171
 v_dot2c_f32_bf16 v177, v172, v180
 v_dot2c_f32_bf16 v179, v172, v172
 v_dot2c_f32_bf16 v177, v173, v180
 v_dot2c_f32_bf16 v179, v173, v173
 v_dot2c_f32_bf16 v177, v174, v180
 v_dot2c_f32_bf16 v179, v174, v174
 v_dot2c_f32_bf16 v177, v175, v180
 v_dot2c_f32_bf16 v179, v175, v175
 buffer_load_dwordx4 v[132:135], v4, s[12:15], s42 offen
 s_add_u32 s42, s42, 1024
 ds_read_b128 v[168:171], v5 offset:992
 ds_read_b128 v[172:175], v7 offset:992
 s_waitcnt vmcnt(3) lgkmcnt(2)
 v_mfma_f32_32x32x16_bf16 v[64:79], v[160:163], v[136:139], v[64:79]
 v_mfma_f32_32x32x16_bf16 v[80:95], v[164:167], v[136:139], v[80:95]
 v_dot2c_f32_bf16 v176, v160, v180
 v_dot2c_f32_bf16 v178, v160, v160
 v_dot2c_f32_bf16 v176, v161, v180
 v_dot2c_f32_bf16 v178, v161, v161
 v_dot2c_f32_bf16 v176, v162, v180
 v_dot2c_f32_bf16 v178, v162, v162
 v_dot2c_f32_bf16 v176, v163, v180
 v_dot2c_f32_bf16 v178, v163, v163
 v_dot2c_f32_bf16 v177, v164, v180
 v_dot2c_f32_bf16 v179, v164, v164
 v_dot2c_f32_bf16 v177, v165, v180
 v_dot2c_f32_bf16 v179, v165, v165
 v_dot2c_f32_bf16 v177, v166, v180
 v_dot2c_f32_bf16 v179, v166, v166
 v_dot2c_f32_bf16 v177, v167, v180
 v_dot2c_f32_bf16 v179, v167, v167
 buffer_load_dwordx4 v[136:139], v4, s[12:15], s42 offen
 s_add_u32 s42, s42, 1024
 ds_read_b128 v[160:163], v5 offset:1024
 ds_read_b128 v[164:167], v7 offset:1024
 s_waitcnt vmcnt(3) lgkmcnt(2)
 v_mfma_f32_32x32x16_bf16 v[64:79], v[168:171], v[140:143], v[64:79]
 v_mfma_f32_32x32x16_bf16 v[80:95], v[172:175], v[140:143], v[80:95]
 v_dot2c_f32_bf16 v176, v168, v180
 v_dot2c_f32_bf16 v178, v168, v168
 v_dot2c_f32_bf16 v176, v169, v180
 v_dot2c_f32_bf16 v178, v169, v169
 v_dot2c_f32_bf16 v176, v170, v180
 v_dot2c_f32_bf16 v178, v170, v170
 v_dot2c_f32_bf16 v176, v171, v180
 v_dot2c_f32_bf16 v178, v171, v171
 v_dot2c_f32_bf16 v177, v172, v180
 v_dot2c_f32_bf16 v179, v172, v172
 v_dot2c_f32_bf16 v177, v173, v180
 v_dot2c_f32_bf16 v179, v173, v173
 v_dot2c_f32_bf16 v177, v174, v180
 v_dot2c_f32_bf16 v179, v174, v174
 v_dot2c_f32_bf16 v177, v175, v180
 v_dot2c_f32_bf16 v179, v175, v175
 buffer_load_dwordx4 v[140:143], v4, s[12:15], s42 offen
 s_add_u32 s42, s42, 1024
 ds_read_b128 v[168:171], v5 offset:1056
 ds_read_b128 v[172:175], v7 offset:1056
 s_waitcnt vmcnt(3) lgkmcnt(2)
 v_mfma_f32_32x32x16_bf16 v[64:79], v[160:163], v[128:131], v[64:79]
 v_mfma_f32_32x32x16_bf16 v[80:95], v[164:167], v[128:131], v[80:95]
 v_dot2c_f32_bf16 v176, v160, v180
 v_dot2c_f32_bf16 v178, v160, v160
 v_dot2c_f32_bf16 v176, v161, v180
 v_dot2c_f32_bf16 v178, v161, v161
 v_dot2c_f32_bf16 v176, v162, v180
 v_dot2c_f32_bf16 v178, v162, v162
 v_dot2c_f32_bf16 v176, v163, v180
 v_dot2c_f32_bf16 v178, v163, v163
 v_dot2c_f32_bf16 v177, v164, v180
 v_dot2c_f32_bf16 v179, v164, v164
 v_dot2c_f32_bf16 v177, v165, v180
 v_dot2c_f32_bf16 v179, v165, v165
 v_dot2c_f32_bf16 v177, v166, v180
 v_dot2c_f32_bf16 v179, v166, v166
 v_dot2c_f32_bf16 v177, v167, v180
 v_dot2c_f32_bf16 v179, v167, v167
 buffer_load_dwordx4 v[128:131], v4, s[12:15], s42 offen
 s_add_u32 s42, s42, 1024
 ds_read_b128 v[160:163], v5 offset:1088
 ds_read_b128 v[164:167], v7 offset:1088
 s_waitcnt vmcnt(3) lgkmcnt(2)
 v_mfma_f32_32x32x16_bf16 v[64:79], v[168:171], v[132:135], v[64:79]
 v_mfma_f32_32x32x16_bf16 v[80:95], v[172:175], v[132:135], v[80:95]
 v_dot2c_f32_bf16 v176, v168, v180
 v_dot2c_f32_bf16 v178, v168, v168
 v_dot2c_f32_bf16 v176, v169, v180
 v_dot2c_f32_bf16 v178, v169, v169
 v_dot2c_f32_bf16 v176, v170, v180
 v_dot2c_f32_bf16 v178, v170, v170
 v_dot2c_f32_bf16 v176, v171, v180
 v_dot2c_f32_bf16 v178, v171, v171
 v_dot2c_f32_bf16 v177, v172, v180
 v_dot2c_f32_bf16 v179, v172, v172
 v_dot2c_f32_bf16 v177, v173, v180
 v_dot2c_f32_bf16 v179, v173, v173
 v_dot2c_f32_bf16 v177, v174, v180
 v_dot2c_f32_bf16 v179, v174, v174
 v_dot2c_f32_bf16 v177, v175, v180
 v_dot2c_f32_bf16 v179, v175, v175
 buffer_load_dwordx4 v[132:135], v4, s[12:15], s42 offen
 s_add_u32 s42, s42, 1024
 ds_read_b128 v[168:171], v5 offset:1120
 ds_read_b128 v[172:175], v7 offset:1120
 s_waitcnt vmcnt(3) lgkmcnt(2)
 v_mfma_f32_32x32x16_bf16 v[64:79], v[160:163], v[136:139], v[64:79]
 v_mfma_f32_32x32x16_bf16 v[80:95], v[164:167], v[136:139], v[80:95]
 v_dot2c_f32_bf16 v176, v160, v180
 v_dot2c_f32_bf16 v178, v160, v160
 v_dot2c_f32_bf16 v176, v161, v180
 v_dot2c_f32_bf16 v178, v161, v161
 v_dot2c_f32_bf16 v176, v162, v180
 v_dot2c_f32_bf16 v178, v162, v162
 v_dot2c_f32_bf16 v176, v163, v180
 v_dot2c_f32_bf16 v178, v163, v163
 v_dot2c_f32_bf16 v177, v164, v180
 v_dot2c_f32_bf16 v179, v164, v164
 v_dot2c_f32_bf16 v177, v165, v180
 v_dot2c_f32_bf16 v179, v165, v165
 v_dot2c_f32_bf16 v177, v166, v180
 v_dot2c_f32_bf16 v179, v166, v166
 v_dot2c_f32_bf16 v177, v167, v180
 v_dot2c_f32_bf16 v179, v167, v167
 buffer_load_dwordx4 v[136:139], v4, s[12:15], s42 offen
 s_add_u32 s42, s42, 1024
 ds_read_b128 v[160:163], v5 offset:1152
 ds_read_b128 v[164:167], v7 offset:1152
 s_waitcnt vmcnt(3) lgkmcnt(2)
 v_mfma_f32_32x32x16_bf16 v[64:79], v[168:171], v[140:143], v[64:79]
 v_mfma_f32_32x32x16_bf16 v[80:95], v[172:175], v[140:143], v[80:95]
 v_dot2c_f32_bf16 v176, v168, v180
 v_dot2c_f32_bf16 v178, v168, v168
 v_dot2c_f32_bf16 v176, v169, v180
 v_dot2c_f32_bf16 v178, v169, v169
 v_dot2c_f32_bf16 v176, v170, v180
 v_dot2c_f32_bf16 v178, v170, v170
 v_dot2c_f32_bf16 v176, v171, v180
 v_dot2c_f32_bf16 v178, v171, v171
 v_dot2c_f32_bf16 v177, v172, v180
 v_dot2c_f32_bf16 v179, v172, v172
 v_dot2c_f32_bf16 v177, v173, v180
 v_dot2c_f32_bf16 v179, v173, v173
 v_dot2c_f32_bf16 v177, v174, v180
 v_dot2c_f32_bf16 v179, v174, v174
 v_dot2c_f32_bf16 v177, v175, v180
 v_dot2c_f32_bf16 v179, v175, v175
 buffer_load_dwordx4 v[140:143], v4, s[12:15], s42 offen
 s_add_u32 s42, s42, 1024
 ds_read_b128 v[168:171], v5 offset:1184
 ds_read_b128 v[172:175], v7 offset:1184
 s_waitcnt vmcnt(3) lgkmcnt(2)
 v_mfma_f32_32x32x16_bf16 v[64:79], v[160:163], v[128:131], v[64:79]
 v_mfma_f32_32x32x16_bf16 v[80:95], v[164:167], v[128:131], v[80:95]
 v_dot2c_f32_bf16 v176, v160, v180
 v_dot2c_f32_bf16 v178, v160, v160
 v_dot2c_f32_bf16 v176, v161, v180
 v_dot2c_f32_bf16 v178, v161, v161
 v_dot2c_f32_bf16 v176, v162, v180
 v_dot2c_f32_bf16 v178, v162, v162
 v_dot2c_f32_bf16 v176, v163, v180
 v_dot2c_f32_bf16 v178, v163, v163
 v_dot2c_f32_bf16 v177, v164, v180
 v_dot2c_f32_bf16 v179, v164, v164
 v_dot2c_f32_bf16 v177, v165, v180
 v_dot2c_f32_bf16 v179, v165, v165
 v_dot2c_f32_bf16 v177, v166, v180
 v_dot2c_f32_bf16 v179, v166, v166
 v_dot2c_f32_bf16 v177, v167, v180
 v_dot2c_f32_bf16 v179, v167, v167
 ds_read_b128 v[160:163], v5 offset:1216
 ds_read_b128 v[164:167], v7 offset:1216
 s_waitcnt vmcnt(2) lgkmcnt(2)
 v_mfma_f32_32x32x16_bf16 v[64:79], v[168:171], v[132:135], v[64:79]
 v_mfma_f32_32x32x16_bf16 v[80:95], v[172:175], v[132:135], v[80:95]
 v_dot2c_f32_bf16 v176, v168, v180
 v_dot2c_f32_bf16 v178, v168, v168
 v_dot2c_f32_bf16 v176, v169, v180
 v_dot2c_f32_bf16 v178, v169, v169
 v_dot2c_f32_bf16 v176, v170, v180
 v_dot2c_f32_bf16 v178, v170, v170
 v_dot2c_f32_bf16 v176, v171, v180
 v_dot2c_f32_bf16 v178, v171, v171
 v_dot2c_f32_bf16 v177, v172, v180
 v_dot2c_f32_bf16 v179, v172, v172
 v_dot2c_f32_bf16 v177, v173, v180
 v_dot2c_f32_bf16 v179, v173, v173
 v_dot2c_f32_bf16 v177, v174, v180
 v_dot2c_f32_bf16 v179, v174, v174
 v_dot2c_f32_bf16 v177, v175, v180
 v_dot2c_f32_bf16 v179, v175, v175
 ds_read_b128 v[168:171], v5 offset:1248
 ds_read_b128 v[172:175], v7 offset:1248
 s_waitcnt vmcnt(1) lgkmcnt(2)
 v_mfma_f32_32x32x16_bf16 v[64:79], v[160:163], v[136:139], v[64:79]
 v_mfma_f32_32x32x16_bf16 v[80:95], v[164:167], v[136:139], v[80:95]
 v_dot2c_f32_bf16 v176, v160, v180
 v_dot2c_f32_bf16 v178, v160, v160
 v_dot2c_f32_bf16 v176, v161, v180
 v_dot2c_f32_bf16 v178, v161, v161
 v_dot2c_f32_bf16 v176, v162, v180
 v_dot2c_f32_bf16 v178, v162, v162
 v_dot2c_f32_bf16 v176, v163, v180
 v_dot2c_f32_bf16 v178, v163, v163
 v_dot2c_f32_bf16 v177, v164, v180
 v_dot2c_f32_bf16 v179, v164, v164
 v_dot2c_f32_bf16 v177, v165, v180
 v_dot2c_f32_bf16 v179, v165, v165
 v_dot2c_f32_bf16 v177, v166, v180
 v_dot2c_f32_bf16 v179, v166, v166
 v_dot2c_f32_bf16 v177, v167, v180
 v_dot2c_f32_bf16 v179, v167, v167
 s_waitcnt vmcnt(0) lgkmcnt(0)
 v_mfma_f32_32x32x16_bf16 v[64:79], v[168:171], v[140:143], v[64:79]
 v_mfma_f32_32x32x16_bf16 v[80:95], v[172:175], v[140:143], v[80:95]
 v_dot2c_f32_bf16 v176, v168, v180
 v_dot2c_f32_bf16 v178, v168, v168
 v_dot2c_f32_bf16 v176, v169, v180
 v_dot2c_f32_bf16 v178, v169, v169
 v_dot2c_f32_bf16 v176, v170, v180
 v_dot2c_f32_bf16 v178, v170, v170
 v_dot2c_f32_bf16 v176, v171, v180
 v_dot2c_f32_bf16 v178, v171, v171
 v_dot2c_f32_bf16 v177, v172, v180
 v_dot2c_f32_bf16 v179, v172, v172
 v_dot2c_f32_bf16 v177, v173, v180
 v_dot2c_f32_bf16 v179, v173, v173
 v_dot2c_f32_bf16 v177, v174, v180
 v_dot2c_f32_bf16 v179, v174, v174
 v_dot2c_f32_bf16 v177, v175, v180
 v_dot2c_f32_bf16 v179, v175, v175
 s_nop 11
 v_mov_b32 v186, v176
 s_nop 1
 v_permlane32_swap_b32 v176, v186
 v_add_f32 v176, v176, v186
 v_mov_b32 v186, v177
 s_nop 1
 v_permlane32_swap_b32 v177, v186
 v_add_f32 v177, v177, v186
 v_mov_b32 v186, v178
 s_nop 1
 v_permlane32_swap_b32 v178, v186
 v_add_f32 v178, v178, v186
 v_mov_b32 v186, v179
 s_nop 1
 v_permlane32_swap_b32 v179, v186
 v_add_f32 v179, v179, v186
 s_mov_b32 s44, 0x3acccccd
 s_mov_b32 s45, 0x3727c5ac
 v_mul_f32 v186, s44, v176
 v_mul_f32 v187, s44, v178
 v_fma_f32 v187, -v186, v186, v187
 v_add_f32 v187, s45, v187
 v_rsq_f32 v181, v187
 s_nop 0
 v_mul_f32 v183, v181, v186
 v_mul_f32 v186, s44, v177
 v_mul_f32 v187, s44, v179
 v_fma_f32 v187, -v186, v186, v187
 v_add_f32 v187, s45, v187
 v_rsq_f32 v182, v187
 s_nop 0
 v_mul_f32 v184, v182, v186
 s_lshl_b32 s46, s34, 9
 s_add_u32 s46, s46, 82944
 v_and_b32 v9, 31, v0
 v_lshlrev_b32 v10, 2, v9
 v_add_u32 v10, s46, v10
 ds_write_b32 v10, v181 offset:0
 ds_write_b32 v10, v183 offset:128
 ds_write_b32 v10, v182 offset:256
 ds_write_b32 v10, v184 offset:384
 v_mov_b32 v10, v9
 v_add_u32 v11, 672, v10
 v_lshlrev_b32 v11, 2, v11
 buffer_load_dword v12, v11, s[16:19], 0 offen
 v_mul_u32_u24 v11, 3277, v10
 v_lshrrev_b32 v11, 16, v11
 v_mul_u32_u24 v13, 20, v11
 v_sub_u32 v13, v10, v13
 v_lshlrev_b32 v11, 17, v11
 v_lshl_add_u32 v11, v13, 4, v11
 v_bfe_u32 v13, v0, 5, 1
 v_lshl_add_u32 v11, v13, 9, v11
 v_lshlrev_b32 v13, 4, v13
 v_add_u32 v13, s46, v13
 s_waitcnt lgkmcnt(0)
 ds_read_b128 v[16:19], v13 offset:0
 ds_read_b128 v[20:23], v13 offset:128
 ds_read_b128 v[24:27], v13 offset:32
 ds_read_b128 v[28:31], v13 offset:160
 ds_read_b128 v[32:35], v13 offset:64
 ds_read_b128 v[36:39], v13 offset:192
 ds_read_b128 v[40:43], v13 offset:96
 ds_read_b128 v[44:47], v13 offset:224
 s_lshl_b32 s48, s32, 1
 s_add_u32 s48, s48, 0
 s_lshl_b32 s48, s48, 11
 s_waitcnt vmcnt(0)
 s_waitcnt lgkmcnt(6)
 v_mul_f32 v48, v20, v12
 v_fma_f32 v64, v16, v64, -v48
 v_mul_f32 v48, v21, v12
 v_fma_f32 v65, v17, v65, -v48
 v_mul_f32 v48, v22, v12
 v_fma_f32 v66, v18, v66, -v48
 v_mul_f32 v48, v23, v12
 v_fma_f32 v67, v19, v67, -v48
 s_waitcnt lgkmcnt(4)
 v_mul_f32 v48, v28, v12
 v_fma_f32 v68, v24, v68, -v48
 v_mul_f32 v48, v29, v12
 v_fma_f32 v69, v25, v69, -v48
 v_mul_f32 v48, v30, v12
 v_fma_f32 v70, v26, v70, -v48
 v_mul_f32 v48, v31, v12
 v_fma_f32 v71, v27, v71, -v48
 s_waitcnt lgkmcnt(2)
 v_mul_f32 v48, v36, v12
 v_fma_f32 v72, v32, v72, -v48
 v_mul_f32 v48, v37, v12
 v_fma_f32 v73, v33, v73, -v48
 v_mul_f32 v48, v38, v12
 v_fma_f32 v74, v34, v74, -v48
 v_mul_f32 v48, v39, v12
 v_fma_f32 v75, v35, v75, -v48
 s_waitcnt lgkmcnt(0)
 v_mul_f32 v48, v44, v12
 v_fma_f32 v76, v40, v76, -v48
 v_mul_f32 v48, v45, v12
 v_fma_f32 v77, v41, v77, -v48
 v_mul_f32 v48, v46, v12
 v_fma_f32 v78, v42, v78, -v48
 v_mul_f32 v48, v47, v12
 v_fma_f32 v79, v43, v79, -v48
 v_cvt_pk_bf16_f32 v50, v64, v65
 v_cvt_pk_bf16_f32 v51, v66, v67
 v_cvt_pk_bf16_f32 v52, v68, v69
 v_cvt_pk_bf16_f32 v53, v70, v71
 v_cvt_pk_bf16_f32 v54, v72, v73
 v_cvt_pk_bf16_f32 v55, v74, v75
 v_cvt_pk_bf16_f32 v56, v76, v77
 v_cvt_pk_bf16_f32 v57, v78, v79
 v_cmp_gt_u32 vcc, 20, v9
 s_and_saveexec_b64 s[50:51], vcc
 buffer_store_dwordx4 v[50:53], v11, s[28:31], s48 offen
 buffer_store_dwordx4 v[54:57], v11, s[28:31], s48 offen offset:1024
 s_mov_b64 exec, s[50:51]
 ds_read_b128 v[16:19], v13 offset:256
 ds_read_b128 v[20:23], v13 offset:384
 ds_read_b128 v[24:27], v13 offset:288
 ds_read_b128 v[28:31], v13 offset:416
 ds_read_b128 v[32:35], v13 offset:320
 ds_read_b128 v[36:39], v13 offset:448
 ds_read_b128 v[40:43], v13 offset:352
 ds_read_b128 v[44:47], v13 offset:480
 s_lshl_b32 s48, s32, 1
 s_add_u32 s48, s48, 1
 s_lshl_b32 s48, s48, 11
 s_waitcnt lgkmcnt(6)
 v_mul_f32 v48, v20, v12
 v_fma_f32 v80, v16, v80, -v48
 v_mul_f32 v48, v21, v12
 v_fma_f32 v81, v17, v81, -v48
 v_mul_f32 v48, v22, v12
 v_fma_f32 v82, v18, v82, -v48
 v_mul_f32 v48, v23, v12
 v_fma_f32 v83, v19, v83, -v48
 s_waitcnt lgkmcnt(4)
 v_mul_f32 v48, v28, v12
 v_fma_f32 v84, v24, v84, -v48
 v_mul_f32 v48, v29, v12
 v_fma_f32 v85, v25, v85, -v48
 v_mul_f32 v48, v30, v12
 v_fma_f32 v86, v26, v86, -v48
 v_mul_f32 v48, v31, v12
 v_fma_f32 v87, v27, v87, -v48
 s_waitcnt lgkmcnt(2)
 v_mul_f32 v48, v36, v12
 v_fma_f32 v88, v32, v88, -v48
 v_mul_f32 v48, v37, v12
 v_fma_f32 v89, v33, v89, -v48
 v_mul_f32 v48, v38, v12
 v_fma_f32 v90, v34, v90, -v48
 v_mul_f32 v48, v39, v12
 v_fma_f32 v91, v35, v91, -v48
 s_waitcnt lgkmcnt(0)
 v_mul_f32 v48, v44, v12
 v_fma_f32 v92, v40, v92, -v48
 v_mul_f32 v48, v45, v12
 v_fma_f32 v93, v41, v93, -v48
 v_mul_f32 v48, v46, v12
 v_fma_f32 v94, v42, v94, -v48
 v_mul_f32 v48, v47, v12
 v_fma_f32 v95, v43, v95, -v48
 v_cvt_pk_bf16_f32 v50, v80, v81
 v_cvt_pk_bf16_f32 v51, v82, v83
 v_cvt_pk_bf16_f32 v52, v84, v85
 v_cvt_pk_bf16_f32 v53, v86, v87
 v_cvt_pk_bf16_f32 v54, v88, v89
 v_cvt_pk_bf16_f32 v55, v90, v91
 v_cvt_pk_bf16_f32 v56, v92, v93
 v_cvt_pk_bf16_f32 v57, v94, v95
 v_cmp_gt_u32 vcc, 20, v9
 s_and_saveexec_b64 s[50:51], vcc
 buffer_store_dwordx4 v[50:53], v11, s[28:31], s48 offen
 buffer_store_dwordx4 v[54:57], v11, s[28:31], s48 offen offset:1024
 s_mov_b64 exec, s[50:51]
L_a1_2_kernel_end:
 s_endpgm
.globl outa_2_kernel
.p2align 8
.type outa_2_kernel,@function
outa_2_kernel:
 s_cmp_ge_u32 s2, 160
 s_cbranch_scc1 L_outa_2_kernel_end
 s_load_dwordx2 s[4:5], s[0:1], 80
 s_and_b32 s32, s2, 31
 s_lshr_b32 s33, s2, 5
 v_lshrrev_b32 v1, 6, v0
 s_nop 0
 v_readfirstlane_b32 s34, v1
 s_waitcnt lgkmcnt(0)
 s_add_u32 s8, s4, 29360128
 s_addc_u32 s9, s5, 0
 s_mov_b32 s10, 2621440
 s_mov_b32 s11, 0x00020000
 s_add_u32 s12, s4, 1048576
 s_addc_u32 s13, s5, 0
 s_mov_b32 s14, 819200
 s_mov_b32 s15, 0x00020000
 s_mul_i32 s35, s32, 81920
 v_add_u32 v2, 0, v0
 v_lshlrev_b32 v3, 4, v2
 buffer_load_dwordx4 v[64:67], v3, s[8:11], s35 offen
 v_add_u32 v2, 256, v0
 v_lshlrev_b32 v3, 4, v2
 buffer_load_dwordx4 v[68:71], v3, s[8:11], s35 offen
 v_add_u32 v2, 512, v0
 v_lshlrev_b32 v3, 4, v2
 buffer_load_dwordx4 v[72:75], v3, s[8:11], s35 offen
 v_add_u32 v2, 768, v0
 v_lshlrev_b32 v3, 4, v2
 buffer_load_dwordx4 v[76:79], v3, s[8:11], s35 offen
 v_add_u32 v2, 1024, v0
 v_lshlrev_b32 v3, 4, v2
 buffer_load_dwordx4 v[80:83], v3, s[8:11], s35 offen
 v_add_u32 v2, 1280, v0
 v_lshlrev_b32 v3, 4, v2
 buffer_load_dwordx4 v[84:87], v3, s[8:11], s35 offen
 v_add_u32 v2, 1536, v0
 v_lshlrev_b32 v3, 4, v2
 buffer_load_dwordx4 v[88:91], v3, s[8:11], s35 offen
 v_add_u32 v2, 1792, v0
 v_lshlrev_b32 v3, 4, v2
 buffer_load_dwordx4 v[92:95], v3, s[8:11], s35 offen
 v_add_u32 v2, 2048, v0
 v_lshlrev_b32 v3, 4, v2
 buffer_load_dwordx4 v[96:99], v3, s[8:11], s35 offen
 v_add_u32 v2, 2304, v0
 v_lshlrev_b32 v3, 4, v2
 buffer_load_dwordx4 v[100:103], v3, s[8:11], s35 offen
 v_add_u32 v2, 2560, v0
 v_lshlrev_b32 v3, 4, v2
 buffer_load_dwordx4 v[104:107], v3, s[8:11], s35 offen
 v_add_u32 v2, 2816, v0
 v_lshlrev_b32 v3, 4, v2
 buffer_load_dwordx4 v[108:111], v3, s[8:11], s35 offen
 v_add_u32 v2, 3072, v0
 v_lshlrev_b32 v3, 4, v2
 buffer_load_dwordx4 v[112:115], v3, s[8:11], s35 offen
 v_add_u32 v2, 3328, v0
 v_lshlrev_b32 v3, 4, v2
 buffer_load_dwordx4 v[116:119], v3, s[8:11], s35 offen
 v_add_u32 v2, 3584, v0
 v_lshlrev_b32 v3, 4, v2
 buffer_load_dwordx4 v[120:123], v3, s[8:11], s35 offen
 v_add_u32 v2, 3840, v0
 v_lshlrev_b32 v3, 4, v2
 buffer_load_dwordx4 v[124:127], v3, s[8:11], s35 offen
 v_add_u32 v2, 4096, v0
 v_lshlrev_b32 v3, 4, v2
 buffer_load_dwordx4 v[128:131], v3, s[8:11], s35 offen
 v_add_u32 v2, 4352, v0
 v_lshlrev_b32 v3, 4, v2
 buffer_load_dwordx4 v[132:135], v3, s[8:11], s35 offen
 v_add_u32 v2, 4608, v0
 v_lshlrev_b32 v3, 4, v2
 buffer_load_dwordx4 v[136:139], v3, s[8:11], s35 offen
 v_add_u32 v2, 4864, v0
 v_lshlrev_b32 v3, 4, v2
 buffer_load_dwordx4 v[140:143], v3, s[8:11], s35 offen
 v_add_u32 v2, 0, v0
 v_mul_u32_u24 v3, 52429, v2
 v_lshrrev_b32 v3, 22, v3
 v_add_u32 v3, v3, v2
 v_lshlrev_b32 v3, 4, v3
 s_waitcnt vmcnt(19)
 ds_write_b128 v3, v[64:67]
 v_add_u32 v2, 256, v0
 v_mul_u32_u24 v3, 52429, v2
 v_lshrrev_b32 v3, 22, v3
 v_add_u32 v3, v3, v2
 v_lshlrev_b32 v3, 4, v3
 s_waitcnt vmcnt(18)
 ds_write_b128 v3, v[68:71]
 v_add_u32 v2, 512, v0
 v_mul_u32_u24 v3, 52429, v2
 v_lshrrev_b32 v3, 22, v3
 v_add_u32 v3, v3, v2
 v_lshlrev_b32 v3, 4, v3
 s_waitcnt vmcnt(17)
 ds_write_b128 v3, v[72:75]
 v_add_u32 v2, 768, v0
 v_mul_u32_u24 v3, 52429, v2
 v_lshrrev_b32 v3, 22, v3
 v_add_u32 v3, v3, v2
 v_lshlrev_b32 v3, 4, v3
 s_waitcnt vmcnt(16)
 ds_write_b128 v3, v[76:79]
 v_add_u32 v2, 1024, v0
 v_mul_u32_u24 v3, 52429, v2
 v_lshrrev_b32 v3, 22, v3
 v_add_u32 v3, v3, v2
 v_lshlrev_b32 v3, 4, v3
 s_waitcnt vmcnt(15)
 ds_write_b128 v3, v[80:83]
 v_add_u32 v2, 1280, v0
 v_mul_u32_u24 v3, 52429, v2
 v_lshrrev_b32 v3, 22, v3
 v_add_u32 v3, v3, v2
 v_lshlrev_b32 v3, 4, v3
 s_waitcnt vmcnt(14)
 ds_write_b128 v3, v[84:87]
 v_add_u32 v2, 1536, v0
 v_mul_u32_u24 v3, 52429, v2
 v_lshrrev_b32 v3, 22, v3
 v_add_u32 v3, v3, v2
 v_lshlrev_b32 v3, 4, v3
 s_waitcnt vmcnt(13)
 ds_write_b128 v3, v[88:91]
 v_add_u32 v2, 1792, v0
 v_mul_u32_u24 v3, 52429, v2
 v_lshrrev_b32 v3, 22, v3
 v_add_u32 v3, v3, v2
 v_lshlrev_b32 v3, 4, v3
 s_waitcnt vmcnt(12)
 ds_write_b128 v3, v[92:95]
 v_add_u32 v2, 2048, v0
 v_mul_u32_u24 v3, 52429, v2
 v_lshrrev_b32 v3, 22, v3
 v_add_u32 v3, v3, v2
 v_lshlrev_b32 v3, 4, v3
 s_waitcnt vmcnt(11)
 ds_write_b128 v3, v[96:99]
 v_add_u32 v2, 2304, v0
 v_mul_u32_u24 v3, 52429, v2
 v_lshrrev_b32 v3, 22, v3
 v_add_u32 v3, v3, v2
 v_lshlrev_b32 v3, 4, v3
 s_waitcnt vmcnt(10)
 ds_write_b128 v3, v[100:103]
 v_add_u32 v2, 2560, v0
 v_mul_u32_u24 v3, 52429, v2
 v_lshrrev_b32 v3, 22, v3
 v_add_u32 v3, v3, v2
 v_lshlrev_b32 v3, 4, v3
 s_waitcnt vmcnt(9)
 ds_write_b128 v3, v[104:107]
 v_add_u32 v2, 2816, v0
 v_mul_u32_u24 v3, 52429, v2
 v_lshrrev_b32 v3, 22, v3
 v_add_u32 v3, v3, v2
 v_lshlrev_b32 v3, 4, v3
 s_waitcnt vmcnt(8)
 ds_write_b128 v3, v[108:111]
 v_add_u32 v2, 3072, v0
 v_mul_u32_u24 v3, 52429, v2
 v_lshrrev_b32 v3, 22, v3
 v_add_u32 v3, v3, v2
 v_lshlrev_b32 v3, 4, v3
 s_waitcnt vmcnt(7)
 ds_write_b128 v3, v[112:115]
 v_add_u32 v2, 3328, v0
 v_mul_u32_u24 v3, 52429, v2
 v_lshrrev_b32 v3, 22, v3
 v_add_u32 v3, v3, v2
 v_lshlrev_b32 v3, 4, v3
 s_waitcnt vmcnt(6)
 ds_write_b128 v3, v[116:119]
 v_add_u32 v2, 3584, v0
 v_mul_u32_u24 v3, 52429, v2
 v_lshrrev_b32 v3, 22, v3
 v_add_u32 v3, v3, v2
 v_lshlrev_b32 v3, 4, v3
 s_waitcnt vmcnt(5)
 ds_write_b128 v3, v[120:123]
 v_add_u32 v2, 3840, v0
 v_mul_u32_u24 v3, 52429, v2
 v_lshrrev_b32 v3, 22, v3
 v_add_u32 v3, v3, v2
 v_lshlrev_b32 v3, 4, v3
 s_waitcnt vmcnt(4)
 ds_write_b128 v3, v[124:127]
 v_add_u32 v2, 4096, v0
 v_mul_u32_u24 v3, 52429, v2
 v_lshrrev_b32 v3, 22, v3
 v_add_u32 v3, v3, v2
 v_lshlrev_b32 v3, 4, v3
 s_waitcnt vmcnt(3)
 ds_write_b128 v3, v[128:131]
 v_add_u32 v2, 4352, v0
 v_mul_u32_u24 v3, 52429, v2
 v_lshrrev_b32 v3, 22, v3
 v_add_u32 v3, v3, v2
 v_lshlrev_b32 v3, 4, v3
 s_waitcnt vmcnt(2)
 ds_write_b128 v3, v[132:135]
 v_add_u32 v2, 4608, v0
 v_mul_u32_u24 v3, 52429, v2
 v_lshrrev_b32 v3, 22, v3
 v_add_u32 v3, v3, v2
 v_lshlrev_b32 v3, 4, v3
 s_waitcnt vmcnt(1)
 ds_write_b128 v3, v[136:139]
 v_add_u32 v2, 4864, v0
 v_mul_u32_u24 v3, 52429, v2
 v_lshrrev_b32 v3, 22, v3
 v_add_u32 v3, v3, v2
 v_lshlrev_b32 v3, 4, v3
 s_waitcnt vmcnt(0)
 ds_write_b128 v3, v[140:143]
 s_waitcnt lgkmcnt(0)
 s_barrier
 s_mul_i32 s40, s33, 4
 s_mul_i32 s41, s34, 1
 s_add_u32 s40, s40, s41
 s_cmp_ge_u32 s40, 20
 s_cbranch_scc1 L_outa_2_kernel_end
 s_add_u32 s41, s40, 0
 s_mul_i32 s42, s41, 40960
 v_and_b32 v2, 63, v0
 v_lshlrev_b32 v4, 4, v2
 v_and_b32 v3, 31, v0
 v_mul_u32_u24 v5, 1296, v3
 v_bfe_u32 v6, v0, 5, 1
 v_lshlrev_b32 v6, 4, v6
 v_add_u32 v5, v5, v6
 v_add_u32 v7, 41472, v5
 v_mov_b32 v64, 0
 v_mov_b32 v65, 0
 v_mov_b32 v66, 0
 v_mov_b32 v67, 0
 v_mov_b32 v68, 0
 v_mov_b32 v69, 0
 v_mov_b32 v70, 0
 v_mov_b32 v71, 0
 v_mov_b32 v72, 0
 v_mov_b32 v73, 0
 v_mov_b32 v74, 0
 v_mov_b32 v75, 0
 v_mov_b32 v76, 0
 v_mov_b32 v77, 0
 v_mov_b32 v78, 0
 v_mov_b32 v79, 0
 v_mov_b32 v80, 0
 v_mov_b32 v81, 0
 v_mov_b32 v82, 0
 v_mov_b32 v83, 0
 v_mov_b32 v84, 0
 v_mov_b32 v85, 0
 v_mov_b32 v86, 0
 v_mov_b32 v87, 0
 v_mov_b32 v88, 0
 v_mov_b32 v89, 0
 v_mov_b32 v90, 0
 v_mov_b32 v91, 0
 v_mov_b32 v92, 0
 v_mov_b32 v93, 0
 v_mov_b32 v94, 0
 v_mov_b32 v95, 0
 s_add_u32 s20, s4, 9437184
 s_addc_u32 s21, s5, 0
 s_mov_b32 s22, 2621440
 s_mov_b32 s23, 0x00020000
 s_add_u32 s24, s4, 12582912
 s_addc_u32 s25, s5, 0
 s_mov_b32 s26, 2621440
 s_mov_b32 s27, 0x00020000
 buffer_load_dwordx4 v[128:131], v4, s[12:15], s42 offen
 s_add_u32 s42, s42, 1024
 buffer_load_dwordx4 v[132:135], v4, s[12:15], s42 offen
 s_add_u32 s42, s42, 1024
 buffer_load_dwordx4 v[136:139], v4, s[12:15], s42 offen
 s_add_u32 s42, s42, 1024
 buffer_load_dwordx4 v[140:143], v4, s[12:15], s42 offen
 s_add_u32 s42, s42, 1024
 ds_read_b128 v[160:163], v5 offset:0
 ds_read_b128 v[164:167], v7 offset:0
 ds_read_b128 v[168:171], v5 offset:32
 ds_read_b128 v[172:175], v7 offset:32
 s_waitcnt vmcnt(3) lgkmcnt(2)
 v_mfma_f32_32x32x16_bf16 v[64:79], v[128:131], v[160:163], v[64:79]
 v_mfma_f32_32x32x16_bf16 v[80:95], v[128:131], v[164:167], v[80:95]
 buffer_load_dwordx4 v[128:131], v4, s[12:15], s42 offen
 s_add_u32 s42, s42, 1024
 ds_read_b128 v[160:163], v5 offset:64
 ds_read_b128 v[164:167], v7 offset:64
 s_waitcnt vmcnt(3) lgkmcnt(2)
 v_mfma_f32_32x32x16_bf16 v[64:79], v[132:135], v[168:171], v[64:79]
 v_mfma_f32_32x32x16_bf16 v[80:95], v[132:135], v[172:175], v[80:95]
 buffer_load_dwordx4 v[132:135], v4, s[12:15], s42 offen
 s_add_u32 s42, s42, 1024
 ds_read_b128 v[168:171], v5 offset:96
 ds_read_b128 v[172:175], v7 offset:96
 s_waitcnt vmcnt(3) lgkmcnt(2)
 v_mfma_f32_32x32x16_bf16 v[64:79], v[136:139], v[160:163], v[64:79]
 v_mfma_f32_32x32x16_bf16 v[80:95], v[136:139], v[164:167], v[80:95]
 buffer_load_dwordx4 v[136:139], v4, s[12:15], s42 offen
 s_add_u32 s42, s42, 1024
 ds_read_b128 v[160:163], v5 offset:128
 ds_read_b128 v[164:167], v7 offset:128
 s_waitcnt vmcnt(3) lgkmcnt(2)
 v_mfma_f32_32x32x16_bf16 v[64:79], v[140:143], v[168:171], v[64:79]
 v_mfma_f32_32x32x16_bf16 v[80:95], v[140:143], v[172:175], v[80:95]
 buffer_load_dwordx4 v[140:143], v4, s[12:15], s42 offen
 s_add_u32 s42, s42, 1024
 ds_read_b128 v[168:171], v5 offset:160
 ds_read_b128 v[172:175], v7 offset:160
 s_waitcnt vmcnt(3) lgkmcnt(2)
 v_mfma_f32_32x32x16_bf16 v[64:79], v[128:131], v[160:163], v[64:79]
 v_mfma_f32_32x32x16_bf16 v[80:95], v[128:131], v[164:167], v[80:95]
 buffer_load_dwordx4 v[128:131], v4, s[12:15], s42 offen
 s_add_u32 s42, s42, 1024
 ds_read_b128 v[160:163], v5 offset:192
 ds_read_b128 v[164:167], v7 offset:192
 s_waitcnt vmcnt(3) lgkmcnt(2)
 v_mfma_f32_32x32x16_bf16 v[64:79], v[132:135], v[168:171], v[64:79]
 v_mfma_f32_32x32x16_bf16 v[80:95], v[132:135], v[172:175], v[80:95]
 buffer_load_dwordx4 v[132:135], v4, s[12:15], s42 offen
 s_add_u32 s42, s42, 1024
 ds_read_b128 v[168:171], v5 offset:224
 ds_read_b128 v[172:175], v7 offset:224
 s_waitcnt vmcnt(3) lgkmcnt(2)
 v_mfma_f32_32x32x16_bf16 v[64:79], v[136:139], v[160:163], v[64:79]
 v_mfma_f32_32x32x16_bf16 v[80:95], v[136:139], v[164:167], v[80:95]
 buffer_load_dwordx4 v[136:139], v4, s[12:15], s42 offen
 s_add_u32 s42, s42, 1024
 ds_read_b128 v[160:163], v5 offset:256
 ds_read_b128 v[164:167], v7 offset:256
 s_waitcnt vmcnt(3) lgkmcnt(2)
 v_mfma_f32_32x32x16_bf16 v[64:79], v[140:143], v[168:171], v[64:79]
 v_mfma_f32_32x32x16_bf16 v[80:95], v[140:143], v[172:175], v[80:95]
 buffer_load_dwordx4 v[140:143], v4, s[12:15], s42 offen
 s_add_u32 s42, s42, 1024
 ds_read_b128 v[168:171], v5 offset:288
 ds_read_b128 v[172:175], v7 offset:288
 s_waitcnt vmcnt(3) lgkmcnt(2)
 v_mfma_f32_32x32x16_bf16 v[64:79], v[128:131], v[160:163], v[64:79]
 v_mfma_f32_32x32x16_bf16 v[80:95], v[128:131], v[164:167], v[80:95]
 buffer_load_dwordx4 v[128:131], v4, s[12:15], s42 offen
 s_add_u32 s42, s42, 1024
 ds_read_b128 v[160:163], v5 offset:320
 ds_read_b128 v[164:167], v7 offset:320
 s_waitcnt vmcnt(3) lgkmcnt(2)
 v_mfma_f32_32x32x16_bf16 v[64:79], v[132:135], v[168:171], v[64:79]
 v_mfma_f32_32x32x16_bf16 v[80:95], v[132:135], v[172:175], v[80:95]
 buffer_load_dwordx4 v[132:135], v4, s[12:15], s42 offen
 s_add_u32 s42, s42, 1024
 ds_read_b128 v[168:171], v5 offset:352
 ds_read_b128 v[172:175], v7 offset:352
 s_waitcnt vmcnt(3) lgkmcnt(2)
 v_mfma_f32_32x32x16_bf16 v[64:79], v[136:139], v[160:163], v[64:79]
 v_mfma_f32_32x32x16_bf16 v[80:95], v[136:139], v[164:167], v[80:95]
 buffer_load_dwordx4 v[136:139], v4, s[12:15], s42 offen
 s_add_u32 s42, s42, 1024
 ds_read_b128 v[160:163], v5 offset:384
 ds_read_b128 v[164:167], v7 offset:384
 s_waitcnt vmcnt(3) lgkmcnt(2)
 v_mfma_f32_32x32x16_bf16 v[64:79], v[140:143], v[168:171], v[64:79]
 v_mfma_f32_32x32x16_bf16 v[80:95], v[140:143], v[172:175], v[80:95]
 buffer_load_dwordx4 v[140:143], v4, s[12:15], s42 offen
 s_add_u32 s42, s42, 1024
 ds_read_b128 v[168:171], v5 offset:416
 ds_read_b128 v[172:175], v7 offset:416
 s_waitcnt vmcnt(3) lgkmcnt(2)
 v_mfma_f32_32x32x16_bf16 v[64:79], v[128:131], v[160:163], v[64:79]
 v_mfma_f32_32x32x16_bf16 v[80:95], v[128:131], v[164:167], v[80:95]
 buffer_load_dwordx4 v[128:131], v4, s[12:15], s42 offen
 s_add_u32 s42, s42, 1024
 ds_read_b128 v[160:163], v5 offset:448
 ds_read_b128 v[164:167], v7 offset:448
 s_waitcnt vmcnt(3) lgkmcnt(2)
 v_mfma_f32_32x32x16_bf16 v[64:79], v[132:135], v[168:171], v[64:79]
 v_mfma_f32_32x32x16_bf16 v[80:95], v[132:135], v[172:175], v[80:95]
 buffer_load_dwordx4 v[132:135], v4, s[12:15], s42 offen
 s_add_u32 s42, s42, 1024
 ds_read_b128 v[168:171], v5 offset:480
 ds_read_b128 v[172:175], v7 offset:480
 s_waitcnt vmcnt(3) lgkmcnt(2)
 v_mfma_f32_32x32x16_bf16 v[64:79], v[136:139], v[160:163], v[64:79]
 v_mfma_f32_32x32x16_bf16 v[80:95], v[136:139], v[164:167], v[80:95]
 buffer_load_dwordx4 v[136:139], v4, s[12:15], s42 offen
 s_add_u32 s42, s42, 1024
 ds_read_b128 v[160:163], v5 offset:512
 ds_read_b128 v[164:167], v7 offset:512
 s_waitcnt vmcnt(3) lgkmcnt(2)
 v_mfma_f32_32x32x16_bf16 v[64:79], v[140:143], v[168:171], v[64:79]
 v_mfma_f32_32x32x16_bf16 v[80:95], v[140:143], v[172:175], v[80:95]
 buffer_load_dwordx4 v[140:143], v4, s[12:15], s42 offen
 s_add_u32 s42, s42, 1024
 ds_read_b128 v[168:171], v5 offset:544
 ds_read_b128 v[172:175], v7 offset:544
 s_waitcnt vmcnt(3) lgkmcnt(2)
 v_mfma_f32_32x32x16_bf16 v[64:79], v[128:131], v[160:163], v[64:79]
 v_mfma_f32_32x32x16_bf16 v[80:95], v[128:131], v[164:167], v[80:95]
 buffer_load_dwordx4 v[128:131], v4, s[12:15], s42 offen
 s_add_u32 s42, s42, 1024
 ds_read_b128 v[160:163], v5 offset:576
 ds_read_b128 v[164:167], v7 offset:576
 s_waitcnt vmcnt(3) lgkmcnt(2)
 v_mfma_f32_32x32x16_bf16 v[64:79], v[132:135], v[168:171], v[64:79]
 v_mfma_f32_32x32x16_bf16 v[80:95], v[132:135], v[172:175], v[80:95]
 buffer_load_dwordx4 v[132:135], v4, s[12:15], s42 offen
 s_add_u32 s42, s42, 1024
 ds_read_b128 v[168:171], v5 offset:608
 ds_read_b128 v[172:175], v7 offset:608
 s_waitcnt vmcnt(3) lgkmcnt(2)
 v_mfma_f32_32x32x16_bf16 v[64:79], v[136:139], v[160:163], v[64:79]
 v_mfma_f32_32x32x16_bf16 v[80:95], v[136:139], v[164:167], v[80:95]
 buffer_load_dwordx4 v[136:139], v4, s[12:15], s42 offen
 s_add_u32 s42, s42, 1024
 ds_read_b128 v[160:163], v5 offset:640
 ds_read_b128 v[164:167], v7 offset:640
 s_waitcnt vmcnt(3) lgkmcnt(2)
 v_mfma_f32_32x32x16_bf16 v[64:79], v[140:143], v[168:171], v[64:79]
 v_mfma_f32_32x32x16_bf16 v[80:95], v[140:143], v[172:175], v[80:95]
 buffer_load_dwordx4 v[140:143], v4, s[12:15], s42 offen
 s_add_u32 s42, s42, 1024
 ds_read_b128 v[168:171], v5 offset:672
 ds_read_b128 v[172:175], v7 offset:672
 s_waitcnt vmcnt(3) lgkmcnt(2)
 v_mfma_f32_32x32x16_bf16 v[64:79], v[128:131], v[160:163], v[64:79]
 v_mfma_f32_32x32x16_bf16 v[80:95], v[128:131], v[164:167], v[80:95]
 buffer_load_dwordx4 v[128:131], v4, s[12:15], s42 offen
 s_add_u32 s42, s42, 1024
 ds_read_b128 v[160:163], v5 offset:704
 ds_read_b128 v[164:167], v7 offset:704
 s_waitcnt vmcnt(3) lgkmcnt(2)
 v_mfma_f32_32x32x16_bf16 v[64:79], v[132:135], v[168:171], v[64:79]
 v_mfma_f32_32x32x16_bf16 v[80:95], v[132:135], v[172:175], v[80:95]
 buffer_load_dwordx4 v[132:135], v4, s[12:15], s42 offen
 s_add_u32 s42, s42, 1024
 ds_read_b128 v[168:171], v5 offset:736
 ds_read_b128 v[172:175], v7 offset:736
 s_waitcnt vmcnt(3) lgkmcnt(2)
 v_mfma_f32_32x32x16_bf16 v[64:79], v[136:139], v[160:163], v[64:79]
 v_mfma_f32_32x32x16_bf16 v[80:95], v[136:139], v[164:167], v[80:95]
 buffer_load_dwordx4 v[136:139], v4, s[12:15], s42 offen
 s_add_u32 s42, s42, 1024
 ds_read_b128 v[160:163], v5 offset:768
 ds_read_b128 v[164:167], v7 offset:768
 s_waitcnt vmcnt(3) lgkmcnt(2)
 v_mfma_f32_32x32x16_bf16 v[64:79], v[140:143], v[168:171], v[64:79]
 v_mfma_f32_32x32x16_bf16 v[80:95], v[140:143], v[172:175], v[80:95]
 buffer_load_dwordx4 v[140:143], v4, s[12:15], s42 offen
 s_add_u32 s42, s42, 1024
 ds_read_b128 v[168:171], v5 offset:800
 ds_read_b128 v[172:175], v7 offset:800
 s_waitcnt vmcnt(3) lgkmcnt(2)
 v_mfma_f32_32x32x16_bf16 v[64:79], v[128:131], v[160:163], v[64:79]
 v_mfma_f32_32x32x16_bf16 v[80:95], v[128:131], v[164:167], v[80:95]
 buffer_load_dwordx4 v[128:131], v4, s[12:15], s42 offen
 s_add_u32 s42, s42, 1024
 ds_read_b128 v[160:163], v5 offset:832
 ds_read_b128 v[164:167], v7 offset:832
 s_waitcnt vmcnt(3) lgkmcnt(2)
 v_mfma_f32_32x32x16_bf16 v[64:79], v[132:135], v[168:171], v[64:79]
 v_mfma_f32_32x32x16_bf16 v[80:95], v[132:135], v[172:175], v[80:95]
 buffer_load_dwordx4 v[132:135], v4, s[12:15], s42 offen
 s_add_u32 s42, s42, 1024
 ds_read_b128 v[168:171], v5 offset:864
 ds_read_b128 v[172:175], v7 offset:864
 s_waitcnt vmcnt(3) lgkmcnt(2)
 v_mfma_f32_32x32x16_bf16 v[64:79], v[136:139], v[160:163], v[64:79]
 v_mfma_f32_32x32x16_bf16 v[80:95], v[136:139], v[164:167], v[80:95]
 buffer_load_dwordx4 v[136:139], v4, s[12:15], s42 offen
 s_add_u32 s42, s42, 1024
 ds_read_b128 v[160:163], v5 offset:896
 ds_read_b128 v[164:167], v7 offset:896
 s_waitcnt vmcnt(3) lgkmcnt(2)
 v_mfma_f32_32x32x16_bf16 v[64:79], v[140:143], v[168:171], v[64:79]
 v_mfma_f32_32x32x16_bf16 v[80:95], v[140:143], v[172:175], v[80:95]
 buffer_load_dwordx4 v[140:143], v4, s[12:15], s42 offen
 s_add_u32 s42, s42, 1024
 ds_read_b128 v[168:171], v5 offset:928
 ds_read_b128 v[172:175], v7 offset:928
 s_waitcnt vmcnt(3) lgkmcnt(2)
 v_mfma_f32_32x32x16_bf16 v[64:79], v[128:131], v[160:163], v[64:79]
 v_mfma_f32_32x32x16_bf16 v[80:95], v[128:131], v[164:167], v[80:95]
 buffer_load_dwordx4 v[128:131], v4, s[12:15], s42 offen
 s_add_u32 s42, s42, 1024
 ds_read_b128 v[160:163], v5 offset:960
 ds_read_b128 v[164:167], v7 offset:960
 s_waitcnt vmcnt(3) lgkmcnt(2)
 v_mfma_f32_32x32x16_bf16 v[64:79], v[132:135], v[168:171], v[64:79]
 v_mfma_f32_32x32x16_bf16 v[80:95], v[132:135], v[172:175], v[80:95]
 buffer_load_dwordx4 v[132:135], v4, s[12:15], s42 offen
 s_add_u32 s42, s42, 1024
 ds_read_b128 v[168:171], v5 offset:992
 ds_read_b128 v[172:175], v7 offset:992
 s_waitcnt vmcnt(3) lgkmcnt(2)
 v_mfma_f32_32x32x16_bf16 v[64:79], v[136:139], v[160:163], v[64:79]
 v_mfma_f32_32x32x16_bf16 v[80:95], v[136:139], v[164:167], v[80:95]
 buffer_load_dwordx4 v[136:139], v4, s[12:15], s42 offen
 s_add_u32 s42, s42, 1024
 ds_read_b128 v[160:163], v5 offset:1024
 ds_read_b128 v[164:167], v7 offset:1024
 s_waitcnt vmcnt(3) lgkmcnt(2)
 v_mfma_f32_32x32x16_bf16 v[64:79], v[140:143], v[168:171], v[64:79]
 v_mfma_f32_32x32x16_bf16 v[80:95], v[140:143], v[172:175], v[80:95]
 buffer_load_dwordx4 v[140:143], v4, s[12:15], s42 offen
 s_add_u32 s42, s42, 1024
 ds_read_b128 v[168:171], v5 offset:1056
 ds_read_b128 v[172:175], v7 offset:1056
 s_waitcnt vmcnt(3) lgkmcnt(2)
 v_mfma_f32_32x32x16_bf16 v[64:79], v[128:131], v[160:163], v[64:79]
 v_mfma_f32_32x32x16_bf16 v[80:95], v[128:131], v[164:167], v[80:95]
 buffer_load_dwordx4 v[128:131], v4, s[12:15], s42 offen
 s_add_u32 s42, s42, 1024
 ds_read_b128 v[160:163], v5 offset:1088
 ds_read_b128 v[164:167], v7 offset:1088
 s_waitcnt vmcnt(3) lgkmcnt(2)
 v_mfma_f32_32x32x16_bf16 v[64:79], v[132:135], v[168:171], v[64:79]
 v_mfma_f32_32x32x16_bf16 v[80:95], v[132:135], v[172:175], v[80:95]
 buffer_load_dwordx4 v[132:135], v4, s[12:15], s42 offen
 s_add_u32 s42, s42, 1024
 ds_read_b128 v[168:171], v5 offset:1120
 ds_read_b128 v[172:175], v7 offset:1120
 s_waitcnt vmcnt(3) lgkmcnt(2)
 v_mfma_f32_32x32x16_bf16 v[64:79], v[136:139], v[160:163], v[64:79]
 v_mfma_f32_32x32x16_bf16 v[80:95], v[136:139], v[164:167], v[80:95]
 buffer_load_dwordx4 v[136:139], v4, s[12:15], s42 offen
 s_add_u32 s42, s42, 1024
 ds_read_b128 v[160:163], v5 offset:1152
 ds_read_b128 v[164:167], v7 offset:1152
 s_waitcnt vmcnt(3) lgkmcnt(2)
 v_mfma_f32_32x32x16_bf16 v[64:79], v[140:143], v[168:171], v[64:79]
 v_mfma_f32_32x32x16_bf16 v[80:95], v[140:143], v[172:175], v[80:95]
 buffer_load_dwordx4 v[140:143], v4, s[12:15], s42 offen
 s_add_u32 s42, s42, 1024
 ds_read_b128 v[168:171], v5 offset:1184
 ds_read_b128 v[172:175], v7 offset:1184
 s_waitcnt vmcnt(3) lgkmcnt(2)
 v_mfma_f32_32x32x16_bf16 v[64:79], v[128:131], v[160:163], v[64:79]
 v_mfma_f32_32x32x16_bf16 v[80:95], v[128:131], v[164:167], v[80:95]
 ds_read_b128 v[160:163], v5 offset:1216
 ds_read_b128 v[164:167], v7 offset:1216
 s_waitcnt vmcnt(2) lgkmcnt(2)
 v_mfma_f32_32x32x16_bf16 v[64:79], v[132:135], v[168:171], v[64:79]
 v_mfma_f32_32x32x16_bf16 v[80:95], v[132:135], v[172:175], v[80:95]
 ds_read_b128 v[168:171], v5 offset:1248
 ds_read_b128 v[172:175], v7 offset:1248
 s_waitcnt vmcnt(1) lgkmcnt(2)
 v_mfma_f32_32x32x16_bf16 v[64:79], v[136:139], v[160:163], v[64:79]
 v_mfma_f32_32x32x16_bf16 v[80:95], v[136:139], v[164:167], v[80:95]
 s_waitcnt vmcnt(0) lgkmcnt(0)
 v_mfma_f32_32x32x16_bf16 v[64:79], v[140:143], v[168:171], v[64:79]
 v_mfma_f32_32x32x16_bf16 v[80:95], v[140:143], v[172:175], v[80:95]
 s_nop 11
 v_bfe_u32 v8, v0, 5, 1
 v_lshlrev_b32 v8, 3, v8
 v_and_b32 v9, 31, v0
 v_mul_u32_u24 v9, 1280, v9
 v_add_u32 v8, v8, v9
 s_lshl_b32 s46, s40, 6
 s_add_u32 s46, s46, s35
 v_add_u32 v9, 40960, v8
 buffer_load_dwordx2 v[12:13], v8, s[20:23], s46 offen offset:0
 buffer_load_dwordx2 v[14:15], v8, s[20:23], s46 offen offset:16
 buffer_load_dwordx2 v[16:17], v8, s[20:23], s46 offen offset:32
 buffer_load_dwordx2 v[18:19], v8, s[20:23], s46 offen offset:48
 buffer_load_dwordx2 v[20:21], v9, s[20:23], s46 offen offset:0
 buffer_load_dwordx2 v[22:23], v9, s[20:23], s46 offen offset:16
 buffer_load_dwordx2 v[24:25], v9, s[20:23], s46 offen offset:32
 buffer_load_dwordx2 v[26:27], v9, s[20:23], s46 offen offset:48
 s_waitcnt vmcnt(7)
 v_lshlrev_b32 v32, 16, v12
 v_and_b32 v33, 0xffff0000, v12
 v_lshlrev_b32 v34, 16, v13
 v_and_b32 v35, 0xffff0000, v13
 v_add_f32 v32, v32, v64
 v_add_f32 v33, v33, v65
 v_add_f32 v34, v34, v66
 v_add_f32 v35, v35, v67
 v_cvt_pk_bf16_f32 v36, v32, v33
 v_cvt_pk_bf16_f32 v37, v34, v35
 buffer_store_dwordx2 v[36:37], v8, s[24:27], s46 offen offset:0
 s_waitcnt vmcnt(7)
 v_lshlrev_b32 v32, 16, v14
 v_and_b32 v33, 0xffff0000, v14
 v_lshlrev_b32 v34, 16, v15
 v_and_b32 v35, 0xffff0000, v15
 v_add_f32 v32, v32, v68
 v_add_f32 v33, v33, v69
 v_add_f32 v34, v34, v70
 v_add_f32 v35, v35, v71
 v_cvt_pk_bf16_f32 v36, v32, v33
 v_cvt_pk_bf16_f32 v37, v34, v35
 buffer_store_dwordx2 v[36:37], v8, s[24:27], s46 offen offset:16
 s_waitcnt vmcnt(7)
 v_lshlrev_b32 v32, 16, v16
 v_and_b32 v33, 0xffff0000, v16
 v_lshlrev_b32 v34, 16, v17
 v_and_b32 v35, 0xffff0000, v17
 v_add_f32 v32, v32, v72
 v_add_f32 v33, v33, v73
 v_add_f32 v34, v34, v74
 v_add_f32 v35, v35, v75
 v_cvt_pk_bf16_f32 v36, v32, v33
 v_cvt_pk_bf16_f32 v37, v34, v35
 buffer_store_dwordx2 v[36:37], v8, s[24:27], s46 offen offset:32
 s_waitcnt vmcnt(7)
 v_lshlrev_b32 v32, 16, v18
 v_and_b32 v33, 0xffff0000, v18
 v_lshlrev_b32 v34, 16, v19
 v_and_b32 v35, 0xffff0000, v19
 v_add_f32 v32, v32, v76
 v_add_f32 v33, v33, v77
 v_add_f32 v34, v34, v78
 v_add_f32 v35, v35, v79
 v_cvt_pk_bf16_f32 v36, v32, v33
 v_cvt_pk_bf16_f32 v37, v34, v35
 buffer_store_dwordx2 v[36:37], v8, s[24:27], s46 offen offset:48
 s_waitcnt vmcnt(7)
 v_lshlrev_b32 v32, 16, v20
 v_and_b32 v33, 0xffff0000, v20
 v_lshlrev_b32 v34, 16, v21
 v_and_b32 v35, 0xffff0000, v21
 v_add_f32 v32, v32, v80
 v_add_f32 v33, v33, v81
 v_add_f32 v34, v34, v82
 v_add_f32 v35, v35, v83
 v_cvt_pk_bf16_f32 v36, v32, v33
 v_cvt_pk_bf16_f32 v37, v34, v35
 buffer_store_dwordx2 v[36:37], v9, s[24:27], s46 offen offset:0
 s_waitcnt vmcnt(7)
 v_lshlrev_b32 v32, 16, v22
 v_and_b32 v33, 0xffff0000, v22
 v_lshlrev_b32 v34, 16, v23
 v_and_b32 v35, 0xffff0000, v23
 v_add_f32 v32, v32, v84
 v_add_f32 v33, v33, v85
 v_add_f32 v34, v34, v86
 v_add_f32 v35, v35, v87
 v_cvt_pk_bf16_f32 v36, v32, v33
 v_cvt_pk_bf16_f32 v37, v34, v35
 buffer_store_dwordx2 v[36:37], v9, s[24:27], s46 offen offset:16
 s_waitcnt vmcnt(7)
 v_lshlrev_b32 v32, 16, v24
 v_and_b32 v33, 0xffff0000, v24
 v_lshlrev_b32 v34, 16, v25
 v_and_b32 v35, 0xffff0000, v25
 v_add_f32 v32, v32, v88
 v_add_f32 v33, v33, v89
 v_add_f32 v34, v34, v90
 v_add_f32 v35, v35, v91
 v_cvt_pk_bf16_f32 v36, v32, v33
 v_cvt_pk_bf16_f32 v37, v34, v35
 buffer_store_dwordx2 v[36:37], v9, s[24:27], s46 offen offset:32
 s_waitcnt vmcnt(7)
 v_lshlrev_b32 v32, 16, v26
 v_and_b32 v33, 0xffff0000, v26
 v_lshlrev_b32 v34, 16, v27
 v_and_b32 v35, 0xffff0000, v27
 v_add_f32 v32, v32, v92
 v_add_f32 v33, v33, v93
 v_add_f32 v34, v34, v94
 v_add_f32 v35, v35, v95
 v_cvt_pk_bf16_f32 v36, v32, v33
 v_cvt_pk_bf16_f32 v37, v34, v35
 buffer_store_dwordx2 v[36:37], v9, s[24:27], s46 offen offset:48
L_outa_2_kernel_end:
 s_endpgm
.globl b1_3_kernel
.p2align 8
.type b1_3_kernel,@function
b1_3_kernel:
 s_cmp_ge_u32 s2, 256
 s_cbranch_scc1 L_b1_3_kernel_end
 s_load_dwordx2 s[4:5], s[0:1], 80
 s_and_b32 s32, s2, 31
 s_lshr_b32 s33, s2, 5
 v_lshrrev_b32 v1, 6, v0
 s_nop 0
 v_readfirstlane_b32 s34, v1
 s_waitcnt lgkmcnt(0)
 s_add_u32 s8, s4, 12582912
 s_addc_u32 s9, s5, 0
 s_mov_b32 s10, 2621440
 s_mov_b32 s11, 0x00020000
 s_add_u32 s12, s4, 2097152
 s_addc_u32 s13, s5, 0
 s_mov_b32 s14, 2457600
 s_mov_b32 s15, 0x00020000
 s_mul_i32 s35, s32, 81920
 v_add_u32 v2, 0, v0
 v_lshlrev_b32 v3, 4, v2
 buffer_load_dwordx4 v[64:67], v3, s[8:11], s35 offen
 v_add_u32 v2, 256, v0
 v_lshlrev_b32 v3, 4, v2
 buffer_load_dwordx4 v[68:71], v3, s[8:11], s35 offen
 v_add_u32 v2, 512, v0
 v_lshlrev_b32 v3, 4, v2
 buffer_load_dwordx4 v[72:75], v3, s[8:11], s35 offen
 v_add_u32 v2, 768, v0
 v_lshlrev_b32 v3, 4, v2
 buffer_load_dwordx4 v[76:79], v3, s[8:11], s35 offen
 v_add_u32 v2, 1024, v0
 v_lshlrev_b32 v3, 4, v2
 buffer_load_dwordx4 v[80:83], v3, s[8:11], s35 offen
 v_add_u32 v2, 1280, v0
 v_lshlrev_b32 v3, 4, v2
 buffer_load_dwordx4 v[84:87], v3, s[8:11], s35 offen
 v_add_u32 v2, 1536, v0
 v_lshlrev_b32 v3, 4, v2
 buffer_load_dwordx4 v[88:91], v3, s[8:11], s35 offen
 v_add_u32 v2, 1792, v0
 v_lshlrev_b32 v3, 4, v2
 buffer_load_dwordx4 v[92:95], v3, s[8:11], s35 offen
 v_add_u32 v2, 2048, v0
 v_lshlrev_b32 v3, 4, v2
 buffer_load_dwordx4 v[96:99], v3, s[8:11], s35 offen
 v_add_u32 v2, 2304, v0
 v_lshlrev_b32 v3, 4, v2
 buffer_load_dwordx4 v[100:103], v3, s[8:11], s35 offen
 v_add_u32 v2, 2560, v0
 v_lshlrev_b32 v3, 4, v2
 buffer_load_dwordx4 v[104:107], v3, s[8:11], s35 offen
 v_add_u32 v2, 2816, v0
 v_lshlrev_b32 v3, 4, v2
 buffer_load_dwordx4 v[108:111], v3, s[8:11], s35 offen
 v_add_u32 v2, 3072, v0
 v_lshlrev_b32 v3, 4, v2
 buffer_load_dwordx4 v[112:115], v3, s[8:11], s35 offen
 v_add_u32 v2, 3328, v0
 v_lshlrev_b32 v3, 4, v2
 buffer_load_dwordx4 v[116:119], v3, s[8:11], s35 offen
 v_add_u32 v2, 3584, v0
 v_lshlrev_b32 v3, 4, v2
 buffer_load_dwordx4 v[120:123], v3, s[8:11], s35 offen
 v_add_u32 v2, 3840, v0
 v_lshlrev_b32 v3, 4, v2
 buffer_load_dwordx4 v[124:127], v3, s[8:11], s35 offen
 v_add_u32 v2, 4096, v0
 v_lshlrev_b32 v3, 4, v2
 buffer_load_dwordx4 v[128:131], v3, s[8:11], s35 offen
 v_add_u32 v2, 4352, v0
 v_lshlrev_b32 v3, 4, v2
 buffer_load_dwordx4 v[132:135], v3, s[8:11], s35 offen
 v_add_u32 v2, 4608, v0
 v_lshlrev_b32 v3, 4, v2
 buffer_load_dwordx4 v[136:139], v3, s[8:11], s35 offen
 v_add_u32 v2, 4864, v0
 v_lshlrev_b32 v3, 4, v2
 buffer_load_dwordx4 v[140:143], v3, s[8:11], s35 offen
 v_add_u32 v2, 0, v0
 v_mul_u32_u24 v3, 52429, v2
 v_lshrrev_b32 v3, 22, v3
 v_add_u32 v3, v3, v2
 v_lshlrev_b32 v3, 4, v3
 s_waitcnt vmcnt(19)
 ds_write_b128 v3, v[64:67]
 v_add_u32 v2, 256, v0
 v_mul_u32_u24 v3, 52429, v2
 v_lshrrev_b32 v3, 22, v3
 v_add_u32 v3, v3, v2
 v_lshlrev_b32 v3, 4, v3
 s_waitcnt vmcnt(18)
 ds_write_b128 v3, v[68:71]
 v_add_u32 v2, 512, v0
 v_mul_u32_u24 v3, 52429, v2
 v_lshrrev_b32 v3, 22, v3
 v_add_u32 v3, v3, v2
 v_lshlrev_b32 v3, 4, v3
 s_waitcnt vmcnt(17)
 ds_write_b128 v3, v[72:75]
 v_add_u32 v2, 768, v0
 v_mul_u32_u24 v3, 52429, v2
 v_lshrrev_b32 v3, 22, v3
 v_add_u32 v3, v3, v2
 v_lshlrev_b32 v3, 4, v3
 s_waitcnt vmcnt(16)
 ds_write_b128 v3, v[76:79]
 v_add_u32 v2, 1024, v0
 v_mul_u32_u24 v3, 52429, v2
 v_lshrrev_b32 v3, 22, v3
 v_add_u32 v3, v3, v2
 v_lshlrev_b32 v3, 4, v3
 s_waitcnt vmcnt(15)
 ds_write_b128 v3, v[80:83]
 v_add_u32 v2, 1280, v0
 v_mul_u32_u24 v3, 52429, v2
 v_lshrrev_b32 v3, 22, v3
 v_add_u32 v3, v3, v2
 v_lshlrev_b32 v3, 4, v3
 s_waitcnt vmcnt(14)
 ds_write_b128 v3, v[84:87]
 v_add_u32 v2, 1536, v0
 v_mul_u32_u24 v3, 52429, v2
 v_lshrrev_b32 v3, 22, v3
 v_add_u32 v3, v3, v2
 v_lshlrev_b32 v3, 4, v3
 s_waitcnt vmcnt(13)
 ds_write_b128 v3, v[88:91]
 v_add_u32 v2, 1792, v0
 v_mul_u32_u24 v3, 52429, v2
 v_lshrrev_b32 v3, 22, v3
 v_add_u32 v3, v3, v2
 v_lshlrev_b32 v3, 4, v3
 s_waitcnt vmcnt(12)
 ds_write_b128 v3, v[92:95]
 v_add_u32 v2, 2048, v0
 v_mul_u32_u24 v3, 52429, v2
 v_lshrrev_b32 v3, 22, v3
 v_add_u32 v3, v3, v2
 v_lshlrev_b32 v3, 4, v3
 s_waitcnt vmcnt(11)
 ds_write_b128 v3, v[96:99]
 v_add_u32 v2, 2304, v0
 v_mul_u32_u24 v3, 52429, v2
 v_lshrrev_b32 v3, 22, v3
 v_add_u32 v3, v3, v2
 v_lshlrev_b32 v3, 4, v3
 s_waitcnt vmcnt(10)
 ds_write_b128 v3, v[100:103]
 v_add_u32 v2, 2560, v0
 v_mul_u32_u24 v3, 52429, v2
 v_lshrrev_b32 v3, 22, v3
 v_add_u32 v3, v3, v2
 v_lshlrev_b32 v3, 4, v3
 s_waitcnt vmcnt(9)
 ds_write_b128 v3, v[104:107]
 v_add_u32 v2, 2816, v0
 v_mul_u32_u24 v3, 52429, v2
 v_lshrrev_b32 v3, 22, v3
 v_add_u32 v3, v3, v2
 v_lshlrev_b32 v3, 4, v3
 s_waitcnt vmcnt(8)
 ds_write_b128 v3, v[108:111]
 v_add_u32 v2, 3072, v0
 v_mul_u32_u24 v3, 52429, v2
 v_lshrrev_b32 v3, 22, v3
 v_add_u32 v3, v3, v2
 v_lshlrev_b32 v3, 4, v3
 s_waitcnt vmcnt(7)
 ds_write_b128 v3, v[112:115]
 v_add_u32 v2, 3328, v0
 v_mul_u32_u24 v3, 52429, v2
 v_lshrrev_b32 v3, 22, v3
 v_add_u32 v3, v3, v2
 v_lshlrev_b32 v3, 4, v3
 s_waitcnt vmcnt(6)
 ds_write_b128 v3, v[116:119]
 v_add_u32 v2, 3584, v0
 v_mul_u32_u24 v3, 52429, v2
 v_lshrrev_b32 v3, 22, v3
 v_add_u32 v3, v3, v2
 v_lshlrev_b32 v3, 4, v3
 s_waitcnt vmcnt(5)
 ds_write_b128 v3, v[120:123]
 v_add_u32 v2, 3840, v0
 v_mul_u32_u24 v3, 52429, v2
 v_lshrrev_b32 v3, 22, v3
 v_add_u32 v3, v3, v2
 v_lshlrev_b32 v3, 4, v3
 s_waitcnt vmcnt(4)
 ds_write_b128 v3, v[124:127]
 v_add_u32 v2, 4096, v0
 v_mul_u32_u24 v3, 52429, v2
 v_lshrrev_b32 v3, 22, v3
 v_add_u32 v3, v3, v2
 v_lshlrev_b32 v3, 4, v3
 s_waitcnt vmcnt(3)
 ds_write_b128 v3, v[128:131]
 v_add_u32 v2, 4352, v0
 v_mul_u32_u24 v3, 52429, v2
 v_lshrrev_b32 v3, 22, v3
 v_add_u32 v3, v3, v2
 v_lshlrev_b32 v3, 4, v3
 s_waitcnt vmcnt(2)
 ds_write_b128 v3, v[132:135]
 v_add_u32 v2, 4608, v0
 v_mul_u32_u24 v3, 52429, v2
 v_lshrrev_b32 v3, 22, v3
 v_add_u32 v3, v3, v2
 v_lshlrev_b32 v3, 4, v3
 s_waitcnt vmcnt(1)
 ds_write_b128 v3, v[136:139]
 v_add_u32 v2, 4864, v0
 v_mul_u32_u24 v3, 52429, v2
 v_lshrrev_b32 v3, 22, v3
 v_add_u32 v3, v3, v2
 v_lshlrev_b32 v3, 4, v3
 s_waitcnt vmcnt(0)
 ds_write_b128 v3, v[140:143]
 s_waitcnt lgkmcnt(0)
 s_barrier
 s_mul_i32 s40, s33, 8
 s_mul_i32 s41, s34, 2
 s_add_u32 s40, s40, s41
 s_cmp_ge_u32 s40, 60
 s_cbranch_scc1 L_b1_3_kernel_end
 s_add_u32 s41, s40, 0
 s_mul_i32 s42, s41, 40960
 s_add_u32 s41, s40, 1
 s_mul_i32 s43, s41, 40960
 v_and_b32 v2, 63, v0
 v_lshlrev_b32 v4, 4, v2
 v_and_b32 v3, 31, v0
 v_mul_u32_u24 v5, 1296, v3
 v_bfe_u32 v6, v0, 5, 1
 v_lshlrev_b32 v6, 4, v6
 v_add_u32 v5, v5, v6
 v_add_u32 v7, 41472, v5
 v_mov_b32 v64, 0
 v_mov_b32 v65, 0
 v_mov_b32 v66, 0
 v_mov_b32 v67, 0
 v_mov_b32 v68, 0
 v_mov_b32 v69, 0
 v_mov_b32 v70, 0
 v_mov_b32 v71, 0
 v_mov_b32 v72, 0
 v_mov_b32 v73, 0
 v_mov_b32 v74, 0
 v_mov_b32 v75, 0
 v_mov_b32 v76, 0
 v_mov_b32 v77, 0
 v_mov_b32 v78, 0
 v_mov_b32 v79, 0
 v_mov_b32 v80, 0
 v_mov_b32 v81, 0
 v_mov_b32 v82, 0
 v_mov_b32 v83, 0
 v_mov_b32 v84, 0
 v_mov_b32 v85, 0
 v_mov_b32 v86, 0
 v_mov_b32 v87, 0
 v_mov_b32 v88, 0
 v_mov_b32 v89, 0
 v_mov_b32 v90, 0
 v_mov_b32 v91, 0
 v_mov_b32 v92, 0
 v_mov_b32 v93, 0
 v_mov_b32 v94, 0
 v_mov_b32 v95, 0
 v_mov_b32 v96, 0
 v_mov_b32 v97, 0
 v_mov_b32 v98, 0
 v_mov_b32 v99, 0
 v_mov_b32 v100, 0
 v_mov_b32 v101, 0
 v_mov_b32 v102, 0
 v_mov_b32 v103, 0
 v_mov_b32 v104, 0
 v_mov_b32 v105, 0
 v_mov_b32 v106, 0
 v_mov_b32 v107, 0
 v_mov_b32 v108, 0
 v_mov_b32 v109, 0
 v_mov_b32 v110, 0
 v_mov_b32 v111, 0
 v_mov_b32 v112, 0
 v_mov_b32 v113, 0
 v_mov_b32 v114, 0
 v_mov_b32 v115, 0
 v_mov_b32 v116, 0
 v_mov_b32 v117, 0
 v_mov_b32 v118, 0
 v_mov_b32 v119, 0
 v_mov_b32 v120, 0
 v_mov_b32 v121, 0
 v_mov_b32 v122, 0
 v_mov_b32 v123, 0
 v_mov_b32 v124, 0
 v_mov_b32 v125, 0
 v_mov_b32 v126, 0
 v_mov_b32 v127, 0
 v_mov_b32 v176, 0
 v_mov_b32 v177, 0
 v_mov_b32 v178, 0
 v_mov_b32 v179, 0
 v_mov_b32 v180, 0x3f803f80
 s_add_u32 s16, s4, 5771264
 s_addc_u32 s17, s5, 0
 s_mov_b32 s18, 7680
 s_mov_b32 s19, 0x00020000
 s_add_u32 s20, s4, 16777216
 s_addc_u32 s21, s5, 0
 s_mov_b32 s22, 4194304
 s_mov_b32 s23, 0x00020000
 s_add_u32 s24, s4, 20971520
 s_addc_u32 s25, s5, 0
 s_mov_b32 s26, 4194304
 s_mov_b32 s27, 0x00020000
 s_add_u32 s28, s4, 25165824
 s_addc_u32 s29, s5, 0
 s_mov_b32 s30, 4194304
 s_mov_b32 s31, 0x00020000
 s_cmp_ge_u32 s40, 40
 s_cbranch_scc1 L_b1_3_kernel_vtype
 buffer_load_dwordx4 v[128:131], v4, s[12:15], s42 offen
 buffer_load_dwordx4 v[132:135], v4, s[12:15], s43 offen
 s_add_u32 s42, s42, 1024
 s_add_u32 s43, s43, 1024
 buffer_load_dwordx4 v[136:139], v4, s[12:15], s42 offen
 buffer_load_dwordx4 v[140:143], v4, s[12:15], s43 offen
 s_add_u32 s42, s42, 1024
 s_add_u32 s43, s43, 1024
 buffer_load_dwordx4 v[144:147], v4, s[12:15], s42 offen
 buffer_load_dwordx4 v[148:151], v4, s[12:15], s43 offen
 s_add_u32 s42, s42, 1024
 s_add_u32 s43, s43, 1024
 buffer_load_dwordx4 v[152:155], v4, s[12:15], s42 offen
 buffer_load_dwordx4 v[156:159], v4, s[12:15], s43 offen
 s_add_u32 s42, s42, 1024
 s_add_u32 s43, s43, 1024
 ds_read_b128 v[160:163], v5 offset:0
 ds_read_b128 v[164:167], v7 offset:0
 ds_read_b128 v[168:171], v5 offset:32
 ds_read_b128 v[172:175], v7 offset:32
 s_waitcnt vmcnt(6) lgkmcnt(2)
 v_mfma_f32_32x32x16_bf16 v[64:79], v[128:131], v[160:163], v[64:79]
 v_mfma_f32_32x32x16_bf16 v[80:95], v[128:131], v[164:167], v[80:95]
 v_mfma_f32_32x32x16_bf16 v[96:111], v[132:135], v[160:163], v[96:111]
 v_mfma_f32_32x32x16_bf16 v[112:127], v[132:135], v[164:167], v[112:127]
 v_dot2c_f32_bf16 v176, v160, v180
 v_dot2c_f32_bf16 v178, v160, v160
 v_dot2c_f32_bf16 v176, v161, v180
 v_dot2c_f32_bf16 v178, v161, v161
 v_dot2c_f32_bf16 v176, v162, v180
 v_dot2c_f32_bf16 v178, v162, v162
 v_dot2c_f32_bf16 v176, v163, v180
 v_dot2c_f32_bf16 v178, v163, v163
 v_dot2c_f32_bf16 v177, v164, v180
 v_dot2c_f32_bf16 v179, v164, v164
 v_dot2c_f32_bf16 v177, v165, v180
 v_dot2c_f32_bf16 v179, v165, v165
 v_dot2c_f32_bf16 v177, v166, v180
 v_dot2c_f32_bf16 v179, v166, v166
 v_dot2c_f32_bf16 v177, v167, v180
 v_dot2c_f32_bf16 v179, v167, v167
 buffer_load_dwordx4 v[128:131], v4, s[12:15], s42 offen
 buffer_load_dwordx4 v[132:135], v4, s[12:15], s43 offen
 s_add_u32 s42, s42, 1024
 s_add_u32 s43, s43, 1024
 ds_read_b128 v[160:163], v5 offset:64
 ds_read_b128 v[164:167], v7 offset:64
 s_waitcnt vmcnt(6) lgkmcnt(2)
 v_mfma_f32_32x32x16_bf16 v[64:79], v[136:139], v[168:171], v[64:79]
 v_mfma_f32_32x32x16_bf16 v[80:95], v[136:139], v[172:175], v[80:95]
 v_mfma_f32_32x32x16_bf16 v[96:111], v[140:143], v[168:171], v[96:111]
 v_mfma_f32_32x32x16_bf16 v[112:127], v[140:143], v[172:175], v[112:127]
 v_dot2c_f32_bf16 v176, v168, v180
 v_dot2c_f32_bf16 v178, v168, v168
 v_dot2c_f32_bf16 v176, v169, v180
 v_dot2c_f32_bf16 v178, v169, v169
 v_dot2c_f32_bf16 v176, v170, v180
 v_dot2c_f32_bf16 v178, v170, v170
 v_dot2c_f32_bf16 v176, v171, v180
 v_dot2c_f32_bf16 v178, v171, v171
 v_dot2c_f32_bf16 v177, v172, v180
 v_dot2c_f32_bf16 v179, v172, v172
 v_dot2c_f32_bf16 v177, v173, v180
 v_dot2c_f32_bf16 v179, v173, v173
 v_dot2c_f32_bf16 v177, v174, v180
 v_dot2c_f32_bf16 v179, v174, v174
 v_dot2c_f32_bf16 v177, v175, v180
 v_dot2c_f32_bf16 v179, v175, v175
 buffer_load_dwordx4 v[136:139], v4, s[12:15], s42 offen
 buffer_load_dwordx4 v[140:143], v4, s[12:15], s43 offen
 s_add_u32 s42, s42, 1024
 s_add_u32 s43, s43, 1024
 ds_read_b128 v[168:171], v5 offset:96
 ds_read_b128 v[172:175], v7 offset:96
 s_waitcnt vmcnt(6) lgkmcnt(2)
 v_mfma_f32_32x32x16_bf16 v[64:79], v[144:147], v[160:163], v[64:79]
 v_mfma_f32_32x32x16_bf16 v[80:95], v[144:147], v[164:167], v[80:95]
 v_mfma_f32_32x32x16_bf16 v[96:111], v[148:151], v[160:163], v[96:111]
 v_mfma_f32_32x32x16_bf16 v[112:127], v[148:151], v[164:167], v[112:127]
 v_dot2c_f32_bf16 v176, v160, v180
 v_dot2c_f32_bf16 v178, v160, v160
 v_dot2c_f32_bf16 v176, v161, v180
 v_dot2c_f32_bf16 v178, v161, v161
 v_dot2c_f32_bf16 v176, v162, v180
 v_dot2c_f32_bf16 v178, v162, v162
 v_dot2c_f32_bf16 v176, v163, v180
 v_dot2c_f32_bf16 v178, v163, v163
 v_dot2c_f32_bf16 v177, v164, v180
 v_dot2c_f32_bf16 v179, v164, v164
 v_dot2c_f32_bf16 v177, v165, v180
 v_dot2c_f32_bf16 v179, v165, v165
 v_dot2c_f32_bf16 v177, v166, v180
 v_dot2c_f32_bf16 v179, v166, v166
 v_dot2c_f32_bf16 v177, v167, v180
 v_dot2c_f32_bf16 v179, v167, v167
 buffer_load_dwordx4 v[144:147], v4, s[12:15], s42 offen
 buffer_load_dwordx4 v[148:151], v4, s[12:15], s43 offen
 s_add_u32 s42, s42, 1024
 s_add_u32 s43, s43, 1024
 ds_read_b128 v[160:163], v5 offset:128
 ds_read_b128 v[164:167], v7 offset:128
 s_waitcnt vmcnt(6) lgkmcnt(2)
 v_mfma_f32_32x32x16_bf16 v[64:79], v[152:155], v[168:171], v[64:79]
 v_mfma_f32_32x32x16_bf16 v[80:95], v[152:155], v[172:175], v[80:95]
 v_mfma_f32_32x32x16_bf16 v[96:111], v[156:159], v[168:171], v[96:111]
 v_mfma_f32_32x32x16_bf16 v[112:127], v[156:159], v[172:175], v[112:127]
 v_dot2c_f32_bf16 v176, v168, v180
 v_dot2c_f32_bf16 v178, v168, v168
 v_dot2c_f32_bf16 v176, v169, v180
 v_dot2c_f32_bf16 v178, v169, v169
 v_dot2c_f32_bf16 v176, v170, v180
 v_dot2c_f32_bf16 v178, v170, v170
 v_dot2c_f32_bf16 v176, v171, v180
 v_dot2c_f32_bf16 v178, v171, v171
 v_dot2c_f32_bf16 v177, v172, v180
 v_dot2c_f32_bf16 v179, v172, v172
 v_dot2c_f32_bf16 v177, v173, v180
 v_dot2c_f32_bf16 v179, v173, v173
 v_dot2c_f32_bf16 v177, v174, v180
 v_dot2c_f32_bf16 v179, v174, v174
 v_dot2c_f32_bf16 v177, v175, v180
 v_dot2c_f32_bf16 v179, v175, v175
 buffer_load_dwordx4 v[152:155], v4, s[12:15], s42 offen
 buffer_load_dwordx4 v[156:159], v4, s[12:15], s43 offen
 s_add_u32 s42, s42, 1024
 s_add_u32 s43, s43, 1024
 ds_read_b128 v[168:171], v5 offset:160
 ds_read_b128 v[172:175], v7 offset:160
 s_waitcnt vmcnt(6) lgkmcnt(2)
 v_mfma_f32_32x32x16_bf16 v[64:79], v[128:131], v[160:163], v[64:79]
 v_mfma_f32_32x32x16_bf16 v[80:95], v[128:131], v[164:167], v[80:95]
 v_mfma_f32_32x32x16_bf16 v[96:111], v[132:135], v[160:163], v[96:111]
 v_mfma_f32_32x32x16_bf16 v[112:127], v[132:135], v[164:167], v[112:127]
 v_dot2c_f32_bf16 v176, v160, v180
 v_dot2c_f32_bf16 v178, v160, v160
 v_dot2c_f32_bf16 v176, v161, v180
 v_dot2c_f32_bf16 v178, v161, v161
 v_dot2c_f32_bf16 v176, v162, v180
 v_dot2c_f32_bf16 v178, v162, v162
 v_dot2c_f32_bf16 v176, v163, v180
 v_dot2c_f32_bf16 v178, v163, v163
 v_dot2c_f32_bf16 v177, v164, v180
 v_dot2c_f32_bf16 v179, v164, v164
 v_dot2c_f32_bf16 v177, v165, v180
 v_dot2c_f32_bf16 v179, v165, v165
 v_dot2c_f32_bf16 v177, v166, v180
 v_dot2c_f32_bf16 v179, v166, v166
 v_dot2c_f32_bf16 v177, v167, v180
 v_dot2c_f32_bf16 v179, v167, v167
 buffer_load_dwordx4 v[128:131], v4, s[12:15], s42 offen
 buffer_load_dwordx4 v[132:135], v4, s[12:15], s43 offen
 s_add_u32 s42, s42, 1024
 s_add_u32 s43, s43, 1024
 ds_read_b128 v[160:163], v5 offset:192
 ds_read_b128 v[164:167], v7 offset:192
 s_waitcnt vmcnt(6) lgkmcnt(2)
 v_mfma_f32_32x32x16_bf16 v[64:79], v[136:139], v[168:171], v[64:79]
 v_mfma_f32_32x32x16_bf16 v[80:95], v[136:139], v[172:175], v[80:95]
 v_mfma_f32_32x32x16_bf16 v[96:111], v[140:143], v[168:171], v[96:111]
 v_mfma_f32_32x32x16_bf16 v[112:127], v[140:143], v[172:175], v[112:127]
 v_dot2c_f32_bf16 v176, v168, v180
 v_dot2c_f32_bf16 v178, v168, v168
 v_dot2c_f32_bf16 v176, v169, v180
 v_dot2c_f32_bf16 v178, v169, v169
 v_dot2c_f32_bf16 v176, v170, v180
 v_dot2c_f32_bf16 v178, v170, v170
 v_dot2c_f32_bf16 v176, v171, v180
 v_dot2c_f32_bf16 v178, v171, v171
 v_dot2c_f32_bf16 v177, v172, v180
 v_dot2c_f32_bf16 v179, v172, v172
 v_dot2c_f32_bf16 v177, v173, v180
 v_dot2c_f32_bf16 v179, v173, v173
 v_dot2c_f32_bf16 v177, v174, v180
 v_dot2c_f32_bf16 v179, v174, v174
 v_dot2c_f32_bf16 v177, v175, v180
 v_dot2c_f32_bf16 v179, v175, v175
 buffer_load_dwordx4 v[136:139], v4, s[12:15], s42 offen
 buffer_load_dwordx4 v[140:143], v4, s[12:15], s43 offen
 s_add_u32 s42, s42, 1024
 s_add_u32 s43, s43, 1024
 ds_read_b128 v[168:171], v5 offset:224
 ds_read_b128 v[172:175], v7 offset:224
 s_waitcnt vmcnt(6) lgkmcnt(2)
 v_mfma_f32_32x32x16_bf16 v[64:79], v[144:147], v[160:163], v[64:79]
 v_mfma_f32_32x32x16_bf16 v[80:95], v[144:147], v[164:167], v[80:95]
 v_mfma_f32_32x32x16_bf16 v[96:111], v[148:151], v[160:163], v[96:111]
 v_mfma_f32_32x32x16_bf16 v[112:127], v[148:151], v[164:167], v[112:127]
 v_dot2c_f32_bf16 v176, v160, v180
 v_dot2c_f32_bf16 v178, v160, v160
 v_dot2c_f32_bf16 v176, v161, v180
 v_dot2c_f32_bf16 v178, v161, v161
 v_dot2c_f32_bf16 v176, v162, v180
 v_dot2c_f32_bf16 v178, v162, v162
 v_dot2c_f32_bf16 v176, v163, v180
 v_dot2c_f32_bf16 v178, v163, v163
 v_dot2c_f32_bf16 v177, v164, v180
 v_dot2c_f32_bf16 v179, v164, v164
 v_dot2c_f32_bf16 v177, v165, v180
 v_dot2c_f32_bf16 v179, v165, v165
 v_dot2c_f32_bf16 v177, v166, v180
 v_dot2c_f32_bf16 v179, v166, v166
 v_dot2c_f32_bf16 v177, v167, v180
 v_dot2c_f32_bf16 v179, v167, v167
 buffer_load_dwordx4 v[144:147], v4, s[12:15], s42 offen
 buffer_load_dwordx4 v[148:151], v4, s[12:15], s43 offen
 s_add_u32 s42, s42, 1024
 s_add_u32 s43, s43, 1024
 ds_read_b128 v[160:163], v5 offset:256
 ds_read_b128 v[164:167], v7 offset:256
 s_waitcnt vmcnt(6) lgkmcnt(2)
 v_mfma_f32_32x32x16_bf16 v[64:79], v[152:155], v[168:171], v[64:79]
 v_mfma_f32_32x32x16_bf16 v[80:95], v[152:155], v[172:175], v[80:95]
 v_mfma_f32_32x32x16_bf16 v[96:111], v[156:159], v[168:171], v[96:111]
 v_mfma_f32_32x32x16_bf16 v[112:127], v[156:159], v[172:175], v[112:127]
 v_dot2c_f32_bf16 v176, v168, v180
 v_dot2c_f32_bf16 v178, v168, v168
 v_dot2c_f32_bf16 v176, v169, v180
 v_dot2c_f32_bf16 v178, v169, v169
 v_dot2c_f32_bf16 v176, v170, v180
 v_dot2c_f32_bf16 v178, v170, v170
 v_dot2c_f32_bf16 v176, v171, v180
 v_dot2c_f32_bf16 v178, v171, v171
 v_dot2c_f32_bf16 v177, v172, v180
 v_dot2c_f32_bf16 v179, v172, v172
 v_dot2c_f32_bf16 v177, v173, v180
 v_dot2c_f32_bf16 v179, v173, v173
 v_dot2c_f32_bf16 v177, v174, v180
 v_dot2c_f32_bf16 v179, v174, v174
 v_dot2c_f32_bf16 v177, v175, v180
 v_dot2c_f32_bf16 v179, v175, v175
 buffer_load_dwordx4 v[152:155], v4, s[12:15], s42 offen
 buffer_load_dwordx4 v[156:159], v4, s[12:15], s43 offen
 s_add_u32 s42, s42, 1024
 s_add_u32 s43, s43, 1024
 ds_read_b128 v[168:171], v5 offset:288
 ds_read_b128 v[172:175], v7 offset:288
 s_waitcnt vmcnt(6) lgkmcnt(2)
 v_mfma_f32_32x32x16_bf16 v[64:79], v[128:131], v[160:163], v[64:79]
 v_mfma_f32_32x32x16_bf16 v[80:95], v[128:131], v[164:167], v[80:95]
 v_mfma_f32_32x32x16_bf16 v[96:111], v[132:135], v[160:163], v[96:111]
 v_mfma_f32_32x32x16_bf16 v[112:127], v[132:135], v[164:167], v[112:127]
 v_dot2c_f32_bf16 v176, v160, v180
 v_dot2c_f32_bf16 v178, v160, v160
 v_dot2c_f32_bf16 v176, v161, v180
 v_dot2c_f32_bf16 v178, v161, v161
 v_dot2c_f32_bf16 v176, v162, v180
 v_dot2c_f32_bf16 v178, v162, v162
 v_dot2c_f32_bf16 v176, v163, v180
 v_dot2c_f32_bf16 v178, v163, v163
 v_dot2c_f32_bf16 v177, v164, v180
 v_dot2c_f32_bf16 v179, v164, v164
 v_dot2c_f32_bf16 v177, v165, v180
 v_dot2c_f32_bf16 v179, v165, v165
 v_dot2c_f32_bf16 v177, v166, v180
 v_dot2c_f32_bf16 v179, v166, v166
 v_dot2c_f32_bf16 v177, v167, v180
 v_dot2c_f32_bf16 v179, v167, v167
 buffer_load_dwordx4 v[128:131], v4, s[12:15], s42 offen
 buffer_load_dwordx4 v[132:135], v4, s[12:15], s43 offen
 s_add_u32 s42, s42, 1024
 s_add_u32 s43, s43, 1024
 ds_read_b128 v[160:163], v5 offset:320
 ds_read_b128 v[164:167], v7 offset:320
 s_waitcnt vmcnt(6) lgkmcnt(2)
 v_mfma_f32_32x32x16_bf16 v[64:79], v[136:139], v[168:171], v[64:79]
 v_mfma_f32_32x32x16_bf16 v[80:95], v[136:139], v[172:175], v[80:95]
 v_mfma_f32_32x32x16_bf16 v[96:111], v[140:143], v[168:171], v[96:111]
 v_mfma_f32_32x32x16_bf16 v[112:127], v[140:143], v[172:175], v[112:127]
 v_dot2c_f32_bf16 v176, v168, v180
 v_dot2c_f32_bf16 v178, v168, v168
 v_dot2c_f32_bf16 v176, v169, v180
 v_dot2c_f32_bf16 v178, v169, v169
 v_dot2c_f32_bf16 v176, v170, v180
 v_dot2c_f32_bf16 v178, v170, v170
 v_dot2c_f32_bf16 v176, v171, v180
 v_dot2c_f32_bf16 v178, v171, v171
 v_dot2c_f32_bf16 v177, v172, v180
 v_dot2c_f32_bf16 v179, v172, v172
 v_dot2c_f32_bf16 v177, v173, v180
 v_dot2c_f32_bf16 v179, v173, v173
 v_dot2c_f32_bf16 v177, v174, v180
 v_dot2c_f32_bf16 v179, v174, v174
 v_dot2c_f32_bf16 v177, v175, v180
 v_dot2c_f32_bf16 v179, v175, v175
 buffer_load_dwordx4 v[136:139], v4, s[12:15], s42 offen
 buffer_load_dwordx4 v[140:143], v4, s[12:15], s43 offen
 s_add_u32 s42, s42, 1024
 s_add_u32 s43, s43, 1024
 ds_read_b128 v[168:171], v5 offset:352
 ds_read_b128 v[172:175], v7 offset:352
 s_waitcnt vmcnt(6) lgkmcnt(2)
 v_mfma_f32_32x32x16_bf16 v[64:79], v[144:147], v[160:163], v[64:79]
 v_mfma_f32_32x32x16_bf16 v[80:95], v[144:147], v[164:167], v[80:95]
 v_mfma_f32_32x32x16_bf16 v[96:111], v[148:151], v[160:163], v[96:111]
 v_mfma_f32_32x32x16_bf16 v[112:127], v[148:151], v[164:167], v[112:127]
 v_dot2c_f32_bf16 v176, v160, v180
 v_dot2c_f32_bf16 v178, v160, v160
 v_dot2c_f32_bf16 v176, v161, v180
 v_dot2c_f32_bf16 v178, v161, v161
 v_dot2c_f32_bf16 v176, v162, v180
 v_dot2c_f32_bf16 v178, v162, v162
 v_dot2c_f32_bf16 v176, v163, v180
 v_dot2c_f32_bf16 v178, v163, v163
 v_dot2c_f32_bf16 v177, v164, v180
 v_dot2c_f32_bf16 v179, v164, v164
 v_dot2c_f32_bf16 v177, v165, v180
 v_dot2c_f32_bf16 v179, v165, v165
 v_dot2c_f32_bf16 v177, v166, v180
 v_dot2c_f32_bf16 v179, v166, v166
 v_dot2c_f32_bf16 v177, v167, v180
 v_dot2c_f32_bf16 v179, v167, v167
 buffer_load_dwordx4 v[144:147], v4, s[12:15], s42 offen
 buffer_load_dwordx4 v[148:151], v4, s[12:15], s43 offen
 s_add_u32 s42, s42, 1024
 s_add_u32 s43, s43, 1024
 ds_read_b128 v[160:163], v5 offset:384
 ds_read_b128 v[164:167], v7 offset:384
 s_waitcnt vmcnt(6) lgkmcnt(2)
 v_mfma_f32_32x32x16_bf16 v[64:79], v[152:155], v[168:171], v[64:79]
 v_mfma_f32_32x32x16_bf16 v[80:95], v[152:155], v[172:175], v[80:95]
 v_mfma_f32_32x32x16_bf16 v[96:111], v[156:159], v[168:171], v[96:111]
 v_mfma_f32_32x32x16_bf16 v[112:127], v[156:159], v[172:175], v[112:127]
 v_dot2c_f32_bf16 v176, v168, v180
 v_dot2c_f32_bf16 v178, v168, v168
 v_dot2c_f32_bf16 v176, v169, v180
 v_dot2c_f32_bf16 v178, v169, v169
 v_dot2c_f32_bf16 v176, v170, v180
 v_dot2c_f32_bf16 v178, v170, v170
 v_dot2c_f32_bf16 v176, v171, v180
 v_dot2c_f32_bf16 v178, v171, v171
 v_dot2c_f32_bf16 v177, v172, v180
 v_dot2c_f32_bf16 v179, v172, v172
 v_dot2c_f32_bf16 v177, v173, v180
 v_dot2c_f32_bf16 v179, v173, v173
 v_dot2c_f32_bf16 v177, v174, v180
 v_dot2c_f32_bf16 v179, v174, v174
 v_dot2c_f32_bf16 v177, v175, v180
 v_dot2c_f32_bf16 v179, v175, v175
 buffer_load_dwordx4 v[152:155], v4, s[12:15], s42 offen
 buffer_load_dwordx4 v[156:159], v4, s[12:15], s43 offen
 s_add_u32 s42, s42, 1024
 s_add_u32 s43, s43, 1024
 ds_read_b128 v[168:171], v5 offset:416
 ds_read_b128 v[172:175], v7 offset:416
 s_waitcnt vmcnt(6) lgkmcnt(2)
 v_mfma_f32_32x32x16_bf16 v[64:79], v[128:131], v[160:163], v[64:79]
 v_mfma_f32_32x32x16_bf16 v[80:95], v[128:131], v[164:167], v[80:95]
 v_mfma_f32_32x32x16_bf16 v[96:111], v[132:135], v[160:163], v[96:111]
 v_mfma_f32_32x32x16_bf16 v[112:127], v[132:135], v[164:167], v[112:127]
 v_dot2c_f32_bf16 v176, v160, v180
 v_dot2c_f32_bf16 v178, v160, v160
 v_dot2c_f32_bf16 v176, v161, v180
 v_dot2c_f32_bf16 v178, v161, v161
 v_dot2c_f32_bf16 v176, v162, v180
 v_dot2c_f32_bf16 v178, v162, v162
 v_dot2c_f32_bf16 v176, v163, v180
 v_dot2c_f32_bf16 v178, v163, v163
 v_dot2c_f32_bf16 v177, v164, v180
 v_dot2c_f32_bf16 v179, v164, v164
 v_dot2c_f32_bf16 v177, v165, v180
 v_dot2c_f32_bf16 v179, v165, v165
 v_dot2c_f32_bf16 v177, v166, v180
 v_dot2c_f32_bf16 v179, v166, v166
 v_dot2c_f32_bf16 v177, v167, v180
 v_dot2c_f32_bf16 v179, v167, v167
 buffer_load_dwordx4 v[128:131], v4, s[12:15], s42 offen
 buffer_load_dwordx4 v[132:135], v4, s[12:15], s43 offen
 s_add_u32 s42, s42, 1024
 s_add_u32 s43, s43, 1024
 ds_read_b128 v[160:163], v5 offset:448
 ds_read_b128 v[164:167], v7 offset:448
 s_waitcnt vmcnt(6) lgkmcnt(2)
 v_mfma_f32_32x32x16_bf16 v[64:79], v[136:139], v[168:171], v[64:79]
 v_mfma_f32_32x32x16_bf16 v[80:95], v[136:139], v[172:175], v[80:95]
 v_mfma_f32_32x32x16_bf16 v[96:111], v[140:143], v[168:171], v[96:111]
 v_mfma_f32_32x32x16_bf16 v[112:127], v[140:143], v[172:175], v[112:127]
 v_dot2c_f32_bf16 v176, v168, v180
 v_dot2c_f32_bf16 v178, v168, v168
 v_dot2c_f32_bf16 v176, v169, v180
 v_dot2c_f32_bf16 v178, v169, v169
 v_dot2c_f32_bf16 v176, v170, v180
 v_dot2c_f32_bf16 v178, v170, v170
 v_dot2c_f32_bf16 v176, v171, v180
 v_dot2c_f32_bf16 v178, v171, v171
 v_dot2c_f32_bf16 v177, v172, v180
 v_dot2c_f32_bf16 v179, v172, v172
 v_dot2c_f32_bf16 v177, v173, v180
 v_dot2c_f32_bf16 v179, v173, v173
 v_dot2c_f32_bf16 v177, v174, v180
 v_dot2c_f32_bf16 v179, v174, v174
 v_dot2c_f32_bf16 v177, v175, v180
 v_dot2c_f32_bf16 v179, v175, v175
 buffer_load_dwordx4 v[136:139], v4, s[12:15], s42 offen
 buffer_load_dwordx4 v[140:143], v4, s[12:15], s43 offen
 s_add_u32 s42, s42, 1024
 s_add_u32 s43, s43, 1024
 ds_read_b128 v[168:171], v5 offset:480
 ds_read_b128 v[172:175], v7 offset:480
 s_waitcnt vmcnt(6) lgkmcnt(2)
 v_mfma_f32_32x32x16_bf16 v[64:79], v[144:147], v[160:163], v[64:79]
 v_mfma_f32_32x32x16_bf16 v[80:95], v[144:147], v[164:167], v[80:95]
 v_mfma_f32_32x32x16_bf16 v[96:111], v[148:151], v[160:163], v[96:111]
 v_mfma_f32_32x32x16_bf16 v[112:127], v[148:151], v[164:167], v[112:127]
 v_dot2c_f32_bf16 v176, v160, v180
 v_dot2c_f32_bf16 v178, v160, v160
 v_dot2c_f32_bf16 v176, v161, v180
 v_dot2c_f32_bf16 v178, v161, v161
 v_dot2c_f32_bf16 v176, v162, v180
 v_dot2c_f32_bf16 v178, v162, v162
 v_dot2c_f32_bf16 v176, v163, v180
 v_dot2c_f32_bf16 v178, v163, v163
 v_dot2c_f32_bf16 v177, v164, v180
 v_dot2c_f32_bf16 v179, v164, v164
 v_dot2c_f32_bf16 v177, v165, v180
 v_dot2c_f32_bf16 v179, v165, v165
 v_dot2c_f32_bf16 v177, v166, v180
 v_dot2c_f32_bf16 v179, v166, v166
 v_dot2c_f32_bf16 v177, v167, v180
 v_dot2c_f32_bf16 v179, v167, v167
 buffer_load_dwordx4 v[144:147], v4, s[12:15], s42 offen
 buffer_load_dwordx4 v[148:151], v4, s[12:15], s43 offen
 s_add_u32 s42, s42, 1024
 s_add_u32 s43, s43, 1024
 ds_read_b128 v[160:163], v5 offset:512
 ds_read_b128 v[164:167], v7 offset:512
 s_waitcnt vmcnt(6) lgkmcnt(2)
 v_mfma_f32_32x32x16_bf16 v[64:79], v[152:155], v[168:171], v[64:79]
 v_mfma_f32_32x32x16_bf16 v[80:95], v[152:155], v[172:175], v[80:95]
 v_mfma_f32_32x32x16_bf16 v[96:111], v[156:159], v[168:171], v[96:111]
 v_mfma_f32_32x32x16_bf16 v[112:127], v[156:159], v[172:175], v[112:127]
 v_dot2c_f32_bf16 v176, v168, v180
 v_dot2c_f32_bf16 v178, v168, v168
 v_dot2c_f32_bf16 v176, v169, v180
 v_dot2c_f32_bf16 v178, v169, v169
 v_dot2c_f32_bf16 v176, v170, v180
 v_dot2c_f32_bf16 v178, v170, v170
 v_dot2c_f32_bf16 v176, v171, v180
 v_dot2c_f32_bf16 v178, v171, v171
 v_dot2c_f32_bf16 v177, v172, v180
 v_dot2c_f32_bf16 v179, v172, v172
 v_dot2c_f32_bf16 v177, v173, v180
 v_dot2c_f32_bf16 v179, v173, v173
 v_dot2c_f32_bf16 v177, v174, v180
 v_dot2c_f32_bf16 v179, v174, v174
 v_dot2c_f32_bf16 v177, v175, v180
 v_dot2c_f32_bf16 v179, v175, v175
 buffer_load_dwordx4 v[152:155], v4, s[12:15], s42 offen
 buffer_load_dwordx4 v[156:159], v4, s[12:15], s43 offen
 s_add_u32 s42, s42, 1024
 s_add_u32 s43, s43, 1024
 ds_read_b128 v[168:171], v5 offset:544
 ds_read_b128 v[172:175], v7 offset:544
 s_waitcnt vmcnt(6) lgkmcnt(2)
 v_mfma_f32_32x32x16_bf16 v[64:79], v[128:131], v[160:163], v[64:79]
 v_mfma_f32_32x32x16_bf16 v[80:95], v[128:131], v[164:167], v[80:95]
 v_mfma_f32_32x32x16_bf16 v[96:111], v[132:135], v[160:163], v[96:111]
 v_mfma_f32_32x32x16_bf16 v[112:127], v[132:135], v[164:167], v[112:127]
 v_dot2c_f32_bf16 v176, v160, v180
 v_dot2c_f32_bf16 v178, v160, v160
 v_dot2c_f32_bf16 v176, v161, v180
 v_dot2c_f32_bf16 v178, v161, v161
 v_dot2c_f32_bf16 v176, v162, v180
 v_dot2c_f32_bf16 v178, v162, v162
 v_dot2c_f32_bf16 v176, v163, v180
 v_dot2c_f32_bf16 v178, v163, v163
 v_dot2c_f32_bf16 v177, v164, v180
 v_dot2c_f32_bf16 v179, v164, v164
 v_dot2c_f32_bf16 v177, v165, v180
 v_dot2c_f32_bf16 v179, v165, v165
 v_dot2c_f32_bf16 v177, v166, v180
 v_dot2c_f32_bf16 v179, v166, v166
 v_dot2c_f32_bf16 v177, v167, v180
 v_dot2c_f32_bf16 v179, v167, v167
 buffer_load_dwordx4 v[128:131], v4, s[12:15], s42 offen
 buffer_load_dwordx4 v[132:135], v4, s[12:15], s43 offen
 s_add_u32 s42, s42, 1024
 s_add_u32 s43, s43, 1024
 ds_read_b128 v[160:163], v5 offset:576
 ds_read_b128 v[164:167], v7 offset:576
 s_waitcnt vmcnt(6) lgkmcnt(2)
 v_mfma_f32_32x32x16_bf16 v[64:79], v[136:139], v[168:171], v[64:79]
 v_mfma_f32_32x32x16_bf16 v[80:95], v[136:139], v[172:175], v[80:95]
 v_mfma_f32_32x32x16_bf16 v[96:111], v[140:143], v[168:171], v[96:111]
 v_mfma_f32_32x32x16_bf16 v[112:127], v[140:143], v[172:175], v[112:127]
 v_dot2c_f32_bf16 v176, v168, v180
 v_dot2c_f32_bf16 v178, v168, v168
 v_dot2c_f32_bf16 v176, v169, v180
 v_dot2c_f32_bf16 v178, v169, v169
 v_dot2c_f32_bf16 v176, v170, v180
 v_dot2c_f32_bf16 v178, v170, v170
 v_dot2c_f32_bf16 v176, v171, v180
 v_dot2c_f32_bf16 v178, v171, v171
 v_dot2c_f32_bf16 v177, v172, v180
 v_dot2c_f32_bf16 v179, v172, v172
 v_dot2c_f32_bf16 v177, v173, v180
 v_dot2c_f32_bf16 v179, v173, v173
 v_dot2c_f32_bf16 v177, v174, v180
 v_dot2c_f32_bf16 v179, v174, v174
 v_dot2c_f32_bf16 v177, v175, v180
 v_dot2c_f32_bf16 v179, v175, v175
 buffer_load_dwordx4 v[136:139], v4, s[12:15], s42 offen
 buffer_load_dwordx4 v[140:143], v4, s[12:15], s43 offen
 s_add_u32 s42, s42, 1024
 s_add_u32 s43, s43, 1024
 ds_read_b128 v[168:171], v5 offset:608
 ds_read_b128 v[172:175], v7 offset:608
 s_waitcnt vmcnt(6) lgkmcnt(2)
 v_mfma_f32_32x32x16_bf16 v[64:79], v[144:147], v[160:163], v[64:79]
 v_mfma_f32_32x32x16_bf16 v[80:95], v[144:147], v[164:167], v[80:95]
 v_mfma_f32_32x32x16_bf16 v[96:111], v[148:151], v[160:163], v[96:111]
 v_mfma_f32_32x32x16_bf16 v[112:127], v[148:151], v[164:167], v[112:127]
 v_dot2c_f32_bf16 v176, v160, v180
 v_dot2c_f32_bf16 v178, v160, v160
 v_dot2c_f32_bf16 v176, v161, v180
 v_dot2c_f32_bf16 v178, v161, v161
 v_dot2c_f32_bf16 v176, v162, v180
 v_dot2c_f32_bf16 v178, v162, v162
 v_dot2c_f32_bf16 v176, v163, v180
 v_dot2c_f32_bf16 v178, v163, v163
 v_dot2c_f32_bf16 v177, v164, v180
 v_dot2c_f32_bf16 v179, v164, v164
 v_dot2c_f32_bf16 v177, v165, v180
 v_dot2c_f32_bf16 v179, v165, v165
 v_dot2c_f32_bf16 v177, v166, v180
 v_dot2c_f32_bf16 v179, v166, v166
 v_dot2c_f32_bf16 v177, v167, v180
 v_dot2c_f32_bf16 v179, v167, v167
 buffer_load_dwordx4 v[144:147], v4, s[12:15], s42 offen
 buffer_load_dwordx4 v[148:151], v4, s[12:15], s43 offen
 s_add_u32 s42, s42, 1024
 s_add_u32 s43, s43, 1024
 ds_read_b128 v[160:163], v5 offset:640
 ds_read_b128 v[164:167], v7 offset:640
 s_waitcnt vmcnt(6) lgkmcnt(2)
 v_mfma_f32_32x32x16_bf16 v[64:79], v[152:155], v[168:171], v[64:79]
 v_mfma_f32_32x32x16_bf16 v[80:95], v[152:155], v[172:175], v[80:95]
 v_mfma_f32_32x32x16_bf16 v[96:111], v[156:159], v[168:171], v[96:111]
 v_mfma_f32_32x32x16_bf16 v[112:127], v[156:159], v[172:175], v[112:127]
 v_dot2c_f32_bf16 v176, v168, v180
 v_dot2c_f32_bf16 v178, v168, v168
 v_dot2c_f32_bf16 v176, v169, v180
 v_dot2c_f32_bf16 v178, v169, v169
 v_dot2c_f32_bf16 v176, v170, v180
 v_dot2c_f32_bf16 v178, v170, v170
 v_dot2c_f32_bf16 v176, v171, v180
 v_dot2c_f32_bf16 v178, v171, v171
 v_dot2c_f32_bf16 v177, v172, v180
 v_dot2c_f32_bf16 v179, v172, v172
 v_dot2c_f32_bf16 v177, v173, v180
 v_dot2c_f32_bf16 v179, v173, v173
 v_dot2c_f32_bf16 v177, v174, v180
 v_dot2c_f32_bf16 v179, v174, v174
 v_dot2c_f32_bf16 v177, v175, v180
 v_dot2c_f32_bf16 v179, v175, v175
 buffer_load_dwordx4 v[152:155], v4, s[12:15], s42 offen
 buffer_load_dwordx4 v[156:159], v4, s[12:15], s43 offen
 s_add_u32 s42, s42, 1024
 s_add_u32 s43, s43, 1024
 ds_read_b128 v[168:171], v5 offset:672
 ds_read_b128 v[172:175], v7 offset:672
 s_waitcnt vmcnt(6) lgkmcnt(2)
 v_mfma_f32_32x32x16_bf16 v[64:79], v[128:131], v[160:163], v[64:79]
 v_mfma_f32_32x32x16_bf16 v[80:95], v[128:131], v[164:167], v[80:95]
 v_mfma_f32_32x32x16_bf16 v[96:111], v[132:135], v[160:163], v[96:111]
 v_mfma_f32_32x32x16_bf16 v[112:127], v[132:135], v[164:167], v[112:127]
 v_dot2c_f32_bf16 v176, v160, v180
 v_dot2c_f32_bf16 v178, v160, v160
 v_dot2c_f32_bf16 v176, v161, v180
 v_dot2c_f32_bf16 v178, v161, v161
 v_dot2c_f32_bf16 v176, v162, v180
 v_dot2c_f32_bf16 v178, v162, v162
 v_dot2c_f32_bf16 v176, v163, v180
 v_dot2c_f32_bf16 v178, v163, v163
 v_dot2c_f32_bf16 v177, v164, v180
 v_dot2c_f32_bf16 v179, v164, v164
 v_dot2c_f32_bf16 v177, v165, v180
 v_dot2c_f32_bf16 v179, v165, v165
 v_dot2c_f32_bf16 v177, v166, v180
 v_dot2c_f32_bf16 v179, v166, v166
 v_dot2c_f32_bf16 v177, v167, v180
 v_dot2c_f32_bf16 v179, v167, v167
 buffer_load_dwordx4 v[128:131], v4, s[12:15], s42 offen
 buffer_load_dwordx4 v[132:135], v4, s[12:15], s43 offen
 s_add_u32 s42, s42, 1024
 s_add_u32 s43, s43, 1024
 ds_read_b128 v[160:163], v5 offset:704
 ds_read_b128 v[164:167], v7 offset:704
 s_waitcnt vmcnt(6) lgkmcnt(2)
 v_mfma_f32_32x32x16_bf16 v[64:79], v[136:139], v[168:171], v[64:79]
 v_mfma_f32_32x32x16_bf16 v[80:95], v[136:139], v[172:175], v[80:95]
 v_mfma_f32_32x32x16_bf16 v[96:111], v[140:143], v[168:171], v[96:111]
 v_mfma_f32_32x32x16_bf16 v[112:127], v[140:143], v[172:175], v[112:127]
 v_dot2c_f32_bf16 v176, v168, v180
 v_dot2c_f32_bf16 v178, v168, v168
 v_dot2c_f32_bf16 v176, v169, v180
 v_dot2c_f32_bf16 v178, v169, v169
 v_dot2c_f32_bf16 v176, v170, v180
 v_dot2c_f32_bf16 v178, v170, v170
 v_dot2c_f32_bf16 v176, v171, v180
 v_dot2c_f32_bf16 v178, v171, v171
 v_dot2c_f32_bf16 v177, v172, v180
 v_dot2c_f32_bf16 v179, v172, v172
 v_dot2c_f32_bf16 v177, v173, v180
 v_dot2c_f32_bf16 v179, v173, v173
 v_dot2c_f32_bf16 v177, v174, v180
 v_dot2c_f32_bf16 v179, v174, v174
 v_dot2c_f32_bf16 v177, v175, v180
 v_dot2c_f32_bf16 v179, v175, v175
 buffer_load_dwordx4 v[136:139], v4, s[12:15], s42 offen
 buffer_load_dwordx4 v[140:143], v4, s[12:15], s43 offen
 s_add_u32 s42, s42, 1024
 s_add_u32 s43, s43, 1024
 ds_read_b128 v[168:171], v5 offset:736
 ds_read_b128 v[172:175], v7 offset:736
 s_waitcnt vmcnt(6) lgkmcnt(2)
 v_mfma_f32_32x32x16_bf16 v[64:79], v[144:147], v[160:163], v[64:79]
 v_mfma_f32_32x32x16_bf16 v[80:95], v[144:147], v[164:167], v[80:95]
 v_mfma_f32_32x32x16_bf16 v[96:111], v[148:151], v[160:163], v[96:111]
 v_mfma_f32_32x32x16_bf16 v[112:127], v[148:151], v[164:167], v[112:127]
 v_dot2c_f32_bf16 v176, v160, v180
 v_dot2c_f32_bf16 v178, v160, v160
 v_dot2c_f32_bf16 v176, v161, v180
 v_dot2c_f32_bf16 v178, v161, v161
 v_dot2c_f32_bf16 v176, v162, v180
 v_dot2c_f32_bf16 v178, v162, v162
 v_dot2c_f32_bf16 v176, v163, v180
 v_dot2c_f32_bf16 v178, v163, v163
 v_dot2c_f32_bf16 v177, v164, v180
 v_dot2c_f32_bf16 v179, v164, v164
 v_dot2c_f32_bf16 v177, v165, v180
 v_dot2c_f32_bf16 v179, v165, v165
 v_dot2c_f32_bf16 v177, v166, v180
 v_dot2c_f32_bf16 v179, v166, v166
 v_dot2c_f32_bf16 v177, v167, v180
 v_dot2c_f32_bf16 v179, v167, v167
 buffer_load_dwordx4 v[144:147], v4, s[12:15], s42 offen
 buffer_load_dwordx4 v[148:151], v4, s[12:15], s43 offen
 s_add_u32 s42, s42, 1024
 s_add_u32 s43, s43, 1024
 ds_read_b128 v[160:163], v5 offset:768
 ds_read_b128 v[164:167], v7 offset:768
 s_waitcnt vmcnt(6) lgkmcnt(2)
 v_mfma_f32_32x32x16_bf16 v[64:79], v[152:155], v[168:171], v[64:79]
 v_mfma_f32_32x32x16_bf16 v[80:95], v[152:155], v[172:175], v[80:95]
 v_mfma_f32_32x32x16_bf16 v[96:111], v[156:159], v[168:171], v[96:111]
 v_mfma_f32_32x32x16_bf16 v[112:127], v[156:159], v[172:175], v[112:127]
 v_dot2c_f32_bf16 v176, v168, v180
 v_dot2c_f32_bf16 v178, v168, v168
 v_dot2c_f32_bf16 v176, v169, v180
 v_dot2c_f32_bf16 v178, v169, v169
 v_dot2c_f32_bf16 v176, v170, v180
 v_dot2c_f32_bf16 v178, v170, v170
 v_dot2c_f32_bf16 v176, v171, v180
 v_dot2c_f32_bf16 v178, v171, v171
 v_dot2c_f32_bf16 v177, v172, v180
 v_dot2c_f32_bf16 v179, v172, v172
 v_dot2c_f32_bf16 v177, v173, v180
 v_dot2c_f32_bf16 v179, v173, v173
 v_dot2c_f32_bf16 v177, v174, v180
 v_dot2c_f32_bf16 v179, v174, v174
 v_dot2c_f32_bf16 v177, v175, v180
 v_dot2c_f32_bf16 v179, v175, v175
 buffer_load_dwordx4 v[152:155], v4, s[12:15], s42 offen
 buffer_load_dwordx4 v[156:159], v4, s[12:15], s43 offen
 s_add_u32 s42, s42, 1024
 s_add_u32 s43, s43, 1024
 ds_read_b128 v[168:171], v5 offset:800
 ds_read_b128 v[172:175], v7 offset:800
 s_waitcnt vmcnt(6) lgkmcnt(2)
 v_mfma_f32_32x32x16_bf16 v[64:79], v[128:131], v[160:163], v[64:79]
 v_mfma_f32_32x32x16_bf16 v[80:95], v[128:131], v[164:167], v[80:95]
 v_mfma_f32_32x32x16_bf16 v[96:111], v[132:135], v[160:163], v[96:111]
 v_mfma_f32_32x32x16_bf16 v[112:127], v[132:135], v[164:167], v[112:127]
 v_dot2c_f32_bf16 v176, v160, v180
 v_dot2c_f32_bf16 v178, v160, v160
 v_dot2c_f32_bf16 v176, v161, v180
 v_dot2c_f32_bf16 v178, v161, v161
 v_dot2c_f32_bf16 v176, v162, v180
 v_dot2c_f32_bf16 v178, v162, v162
 v_dot2c_f32_bf16 v176, v163, v180
 v_dot2c_f32_bf16 v178, v163, v163
 v_dot2c_f32_bf16 v177, v164, v180
 v_dot2c_f32_bf16 v179, v164, v164
 v_dot2c_f32_bf16 v177, v165, v180
 v_dot2c_f32_bf16 v179, v165, v165
 v_dot2c_f32_bf16 v177, v166, v180
 v_dot2c_f32_bf16 v179, v166, v166
 v_dot2c_f32_bf16 v177, v167, v180
 v_dot2c_f32_bf16 v179, v167, v167
 buffer_load_dwordx4 v[128:131], v4, s[12:15], s42 offen
 buffer_load_dwordx4 v[132:135], v4, s[12:15], s43 offen
 s_add_u32 s42, s42, 1024
 s_add_u32 s43, s43, 1024
 ds_read_b128 v[160:163], v5 offset:832
 ds_read_b128 v[164:167], v7 offset:832
 s_waitcnt vmcnt(6) lgkmcnt(2)
 v_mfma_f32_32x32x16_bf16 v[64:79], v[136:139], v[168:171], v[64:79]
 v_mfma_f32_32x32x16_bf16 v[80:95], v[136:139], v[172:175], v[80:95]
 v_mfma_f32_32x32x16_bf16 v[96:111], v[140:143], v[168:171], v[96:111]
 v_mfma_f32_32x32x16_bf16 v[112:127], v[140:143], v[172:175], v[112:127]
 v_dot2c_f32_bf16 v176, v168, v180
 v_dot2c_f32_bf16 v178, v168, v168
 v_dot2c_f32_bf16 v176, v169, v180
 v_dot2c_f32_bf16 v178, v169, v169
 v_dot2c_f32_bf16 v176, v170, v180
 v_dot2c_f32_bf16 v178, v170, v170
 v_dot2c_f32_bf16 v176, v171, v180
 v_dot2c_f32_bf16 v178, v171, v171
 v_dot2c_f32_bf16 v177, v172, v180
 v_dot2c_f32_bf16 v179, v172, v172
 v_dot2c_f32_bf16 v177, v173, v180
 v_dot2c_f32_bf16 v179, v173, v173
 v_dot2c_f32_bf16 v177, v174, v180
 v_dot2c_f32_bf16 v179, v174, v174
 v_dot2c_f32_bf16 v177, v175, v180
 v_dot2c_f32_bf16 v179, v175, v175
 buffer_load_dwordx4 v[136:139], v4, s[12:15], s42 offen
 buffer_load_dwordx4 v[140:143], v4, s[12:15], s43 offen
 s_add_u32 s42, s42, 1024
 s_add_u32 s43, s43, 1024
 ds_read_b128 v[168:171], v5 offset:864
 ds_read_b128 v[172:175], v7 offset:864
 s_waitcnt vmcnt(6) lgkmcnt(2)
 v_mfma_f32_32x32x16_bf16 v[64:79], v[144:147], v[160:163], v[64:79]
 v_mfma_f32_32x32x16_bf16 v[80:95], v[144:147], v[164:167], v[80:95]
 v_mfma_f32_32x32x16_bf16 v[96:111], v[148:151], v[160:163], v[96:111]
 v_mfma_f32_32x32x16_bf16 v[112:127], v[148:151], v[164:167], v[112:127]
 v_dot2c_f32_bf16 v176, v160, v180
 v_dot2c_f32_bf16 v178, v160, v160
 v_dot2c_f32_bf16 v176, v161, v180
 v_dot2c_f32_bf16 v178, v161, v161
 v_dot2c_f32_bf16 v176, v162, v180
 v_dot2c_f32_bf16 v178, v162, v162
 v_dot2c_f32_bf16 v176, v163, v180
 v_dot2c_f32_bf16 v178, v163, v163
 v_dot2c_f32_bf16 v177, v164, v180
 v_dot2c_f32_bf16 v179, v164, v164
 v_dot2c_f32_bf16 v177, v165, v180
 v_dot2c_f32_bf16 v179, v165, v165
 v_dot2c_f32_bf16 v177, v166, v180
 v_dot2c_f32_bf16 v179, v166, v166
 v_dot2c_f32_bf16 v177, v167, v180
 v_dot2c_f32_bf16 v179, v167, v167
 buffer_load_dwordx4 v[144:147], v4, s[12:15], s42 offen
 buffer_load_dwordx4 v[148:151], v4, s[12:15], s43 offen
 s_add_u32 s42, s42, 1024
 s_add_u32 s43, s43, 1024
 ds_read_b128 v[160:163], v5 offset:896
 ds_read_b128 v[164:167], v7 offset:896
 s_waitcnt vmcnt(6) lgkmcnt(2)
 v_mfma_f32_32x32x16_bf16 v[64:79], v[152:155], v[168:171], v[64:79]
 v_mfma_f32_32x32x16_bf16 v[80:95], v[152:155], v[172:175], v[80:95]
 v_mfma_f32_32x32x16_bf16 v[96:111], v[156:159], v[168:171], v[96:111]
 v_mfma_f32_32x32x16_bf16 v[112:127], v[156:159], v[172:175], v[112:127]
 v_dot2c_f32_bf16 v176, v168, v180
 v_dot2c_f32_bf16 v178, v168, v168
 v_dot2c_f32_bf16 v176, v169, v180
 v_dot2c_f32_bf16 v178, v169, v169
 v_dot2c_f32_bf16 v176, v170, v180
 v_dot2c_f32_bf16 v178, v170, v170
 v_dot2c_f32_bf16 v176, v171, v180
 v_dot2c_f32_bf16 v178, v171, v171
 v_dot2c_f32_bf16 v177, v172, v180
 v_dot2c_f32_bf16 v179, v172, v172
 v_dot2c_f32_bf16 v177, v173, v180
 v_dot2c_f32_bf16 v179, v173, v173
 v_dot2c_f32_bf16 v177, v174, v180
 v_dot2c_f32_bf16 v179, v174, v174
 v_dot2c_f32_bf16 v177, v175, v180
 v_dot2c_f32_bf16 v179, v175, v175
 buffer_load_dwordx4 v[152:155], v4, s[12:15], s42 offen
 buffer_load_dwordx4 v[156:159], v4, s[12:15], s43 offen
 s_add_u32 s42, s42, 1024
 s_add_u32 s43, s43, 1024
 ds_read_b128 v[168:171], v5 offset:928
 ds_read_b128 v[172:175], v7 offset:928
 s_waitcnt vmcnt(6) lgkmcnt(2)
 v_mfma_f32_32x32x16_bf16 v[64:79], v[128:131], v[160:163], v[64:79]
 v_mfma_f32_32x32x16_bf16 v[80:95], v[128:131], v[164:167], v[80:95]
 v_mfma_f32_32x32x16_bf16 v[96:111], v[132:135], v[160:163], v[96:111]
 v_mfma_f32_32x32x16_bf16 v[112:127], v[132:135], v[164:167], v[112:127]
 v_dot2c_f32_bf16 v176, v160, v180
 v_dot2c_f32_bf16 v178, v160, v160
 v_dot2c_f32_bf16 v176, v161, v180
 v_dot2c_f32_bf16 v178, v161, v161
 v_dot2c_f32_bf16 v176, v162, v180
 v_dot2c_f32_bf16 v178, v162, v162
 v_dot2c_f32_bf16 v176, v163, v180
 v_dot2c_f32_bf16 v178, v163, v163
 v_dot2c_f32_bf16 v177, v164, v180
 v_dot2c_f32_bf16 v179, v164, v164
 v_dot2c_f32_bf16 v177, v165, v180
 v_dot2c_f32_bf16 v179, v165, v165
 v_dot2c_f32_bf16 v177, v166, v180
 v_dot2c_f32_bf16 v179, v166, v166
 v_dot2c_f32_bf16 v177, v167, v180
 v_dot2c_f32_bf16 v179, v167, v167
 buffer_load_dwordx4 v[128:131], v4, s[12:15], s42 offen
 buffer_load_dwordx4 v[132:135], v4, s[12:15], s43 offen
 s_add_u32 s42, s42, 1024
 s_add_u32 s43, s43, 1024
 ds_read_b128 v[160:163], v5 offset:960
 ds_read_b128 v[164:167], v7 offset:960
 s_waitcnt vmcnt(6) lgkmcnt(2)
 v_mfma_f32_32x32x16_bf16 v[64:79], v[136:139], v[168:171], v[64:79]
 v_mfma_f32_32x32x16_bf16 v[80:95], v[136:139], v[172:175], v[80:95]
 v_mfma_f32_32x32x16_bf16 v[96:111], v[140:143], v[168:171], v[96:111]
 v_mfma_f32_32x32x16_bf16 v[112:127], v[140:143], v[172:175], v[112:127]
 v_dot2c_f32_bf16 v176, v168, v180
 v_dot2c_f32_bf16 v178, v168, v168
 v_dot2c_f32_bf16 v176, v169, v180
 v_dot2c_f32_bf16 v178, v169, v169
 v_dot2c_f32_bf16 v176, v170, v180
 v_dot2c_f32_bf16 v178, v170, v170
 v_dot2c_f32_bf16 v176, v171, v180
 v_dot2c_f32_bf16 v178, v171, v171
 v_dot2c_f32_bf16 v177, v172, v180
 v_dot2c_f32_bf16 v179, v172, v172
 v_dot2c_f32_bf16 v177, v173, v180
 v_dot2c_f32_bf16 v179, v173, v173
 v_dot2c_f32_bf16 v177, v174, v180
 v_dot2c_f32_bf16 v179, v174, v174
 v_dot2c_f32_bf16 v177, v175, v180
 v_dot2c_f32_bf16 v179, v175, v175
 buffer_load_dwordx4 v[136:139], v4, s[12:15], s42 offen
 buffer_load_dwordx4 v[140:143], v4, s[12:15], s43 offen
 s_add_u32 s42, s42, 1024
 s_add_u32 s43, s43, 1024
 ds_read_b128 v[168:171], v5 offset:992
 ds_read_b128 v[172:175], v7 offset:992
 s_waitcnt vmcnt(6) lgkmcnt(2)
 v_mfma_f32_32x32x16_bf16 v[64:79], v[144:147], v[160:163], v[64:79]
 v_mfma_f32_32x32x16_bf16 v[80:95], v[144:147], v[164:167], v[80:95]
 v_mfma_f32_32x32x16_bf16 v[96:111], v[148:151], v[160:163], v[96:111]
 v_mfma_f32_32x32x16_bf16 v[112:127], v[148:151], v[164:167], v[112:127]
 v_dot2c_f32_bf16 v176, v160, v180
 v_dot2c_f32_bf16 v178, v160, v160
 v_dot2c_f32_bf16 v176, v161, v180
 v_dot2c_f32_bf16 v178, v161, v161
 v_dot2c_f32_bf16 v176, v162, v180
 v_dot2c_f32_bf16 v178, v162, v162
 v_dot2c_f32_bf16 v176, v163, v180
 v_dot2c_f32_bf16 v178, v163, v163
 v_dot2c_f32_bf16 v177, v164, v180
 v_dot2c_f32_bf16 v179, v164, v164
 v_dot2c_f32_bf16 v177, v165, v180
 v_dot2c_f32_bf16 v179, v165, v165
 v_dot2c_f32_bf16 v177, v166, v180
 v_dot2c_f32_bf16 v179, v166, v166
 v_dot2c_f32_bf16 v177, v167, v180
 v_dot2c_f32_bf16 v179, v167, v167
 buffer_load_dwordx4 v[144:147], v4, s[12:15], s42 offen
 buffer_load_dwordx4 v[148:151], v4, s[12:15], s43 offen
 s_add_u32 s42, s42, 1024
 s_add_u32 s43, s43, 1024
 ds_read_b128 v[160:163], v5 offset:1024
 ds_read_b128 v[164:167], v7 offset:1024
 s_waitcnt vmcnt(6) lgkmcnt(2)
 v_mfma_f32_32x32x16_bf16 v[64:79], v[152:155], v[168:171], v[64:79]
 v_mfma_f32_32x32x16_bf16 v[80:95], v[152:155], v[172:175], v[80:95]
 v_mfma_f32_32x32x16_bf16 v[96:111], v[156:159], v[168:171], v[96:111]
 v_mfma_f32_32x32x16_bf16 v[112:127], v[156:159], v[172:175], v[112:127]
 v_dot2c_f32_bf16 v176, v168, v180
 v_dot2c_f32_bf16 v178, v168, v168
 v_dot2c_f32_bf16 v176, v169, v180
 v_dot2c_f32_bf16 v178, v169, v169
 v_dot2c_f32_bf16 v176, v170, v180
 v_dot2c_f32_bf16 v178, v170, v170
 v_dot2c_f32_bf16 v176, v171, v180
 v_dot2c_f32_bf16 v178, v171, v171
 v_dot2c_f32_bf16 v177, v172, v180
 v_dot2c_f32_bf16 v179, v172, v172
 v_dot2c_f32_bf16 v177, v173, v180
 v_dot2c_f32_bf16 v179, v173, v173
 v_dot2c_f32_bf16 v177, v174, v180
 v_dot2c_f32_bf16 v179, v174, v174
 v_dot2c_f32_bf16 v177, v175, v180
 v_dot2c_f32_bf16 v179, v175, v175
 buffer_load_dwordx4 v[152:155], v4, s[12:15], s42 offen
 buffer_load_dwordx4 v[156:159], v4, s[12:15], s43 offen
 s_add_u32 s42, s42, 1024
 s_add_u32 s43, s43, 1024
 ds_read_b128 v[168:171], v5 offset:1056
 ds_read_b128 v[172:175], v7 offset:1056
 s_waitcnt vmcnt(6) lgkmcnt(2)
 v_mfma_f32_32x32x16_bf16 v[64:79], v[128:131], v[160:163], v[64:79]
 v_mfma_f32_32x32x16_bf16 v[80:95], v[128:131], v[164:167], v[80:95]
 v_mfma_f32_32x32x16_bf16 v[96:111], v[132:135], v[160:163], v[96:111]
 v_mfma_f32_32x32x16_bf16 v[112:127], v[132:135], v[164:167], v[112:127]
 v_dot2c_f32_bf16 v176, v160, v180
 v_dot2c_f32_bf16 v178, v160, v160
 v_dot2c_f32_bf16 v176, v161, v180
 v_dot2c_f32_bf16 v178, v161, v161
 v_dot2c_f32_bf16 v176, v162, v180
 v_dot2c_f32_bf16 v178, v162, v162
 v_dot2c_f32_bf16 v176, v163, v180
 v_dot2c_f32_bf16 v178, v163, v163
 v_dot2c_f32_bf16 v177, v164, v180
 v_dot2c_f32_bf16 v179, v164, v164
 v_dot2c_f32_bf16 v177, v165, v180
 v_dot2c_f32_bf16 v179, v165, v165
 v_dot2c_f32_bf16 v177, v166, v180
 v_dot2c_f32_bf16 v179, v166, v166
 v_dot2c_f32_bf16 v177, v167, v180
 v_dot2c_f32_bf16 v179, v167, v167
 buffer_load_dwordx4 v[128:131], v4, s[12:15], s42 offen
 buffer_load_dwordx4 v[132:135], v4, s[12:15], s43 offen
 s_add_u32 s42, s42, 1024
 s_add_u32 s43, s43, 1024
 ds_read_b128 v[160:163], v5 offset:1088
 ds_read_b128 v[164:167], v7 offset:1088
 s_waitcnt vmcnt(6) lgkmcnt(2)
 v_mfma_f32_32x32x16_bf16 v[64:79], v[136:139], v[168:171], v[64:79]
 v_mfma_f32_32x32x16_bf16 v[80:95], v[136:139], v[172:175], v[80:95]
 v_mfma_f32_32x32x16_bf16 v[96:111], v[140:143], v[168:171], v[96:111]
 v_mfma_f32_32x32x16_bf16 v[112:127], v[140:143], v[172:175], v[112:127]
 v_dot2c_f32_bf16 v176, v168, v180
 v_dot2c_f32_bf16 v178, v168, v168
 v_dot2c_f32_bf16 v176, v169, v180
 v_dot2c_f32_bf16 v178, v169, v169
 v_dot2c_f32_bf16 v176, v170, v180
 v_dot2c_f32_bf16 v178, v170, v170
 v_dot2c_f32_bf16 v176, v171, v180
 v_dot2c_f32_bf16 v178, v171, v171
 v_dot2c_f32_bf16 v177, v172, v180
 v_dot2c_f32_bf16 v179, v172, v172
 v_dot2c_f32_bf16 v177, v173, v180
 v_dot2c_f32_bf16 v179, v173, v173
 v_dot2c_f32_bf16 v177, v174, v180
 v_dot2c_f32_bf16 v179, v174, v174
 v_dot2c_f32_bf16 v177, v175, v180
 v_dot2c_f32_bf16 v179, v175, v175
 buffer_load_dwordx4 v[136:139], v4, s[12:15], s42 offen
 buffer_load_dwordx4 v[140:143], v4, s[12:15], s43 offen
 s_add_u32 s42, s42, 1024
 s_add_u32 s43, s43, 1024
 ds_read_b128 v[168:171], v5 offset:1120
 ds_read_b128 v[172:175], v7 offset:1120
 s_waitcnt vmcnt(6) lgkmcnt(2)
 v_mfma_f32_32x32x16_bf16 v[64:79], v[144:147], v[160:163], v[64:79]
 v_mfma_f32_32x32x16_bf16 v[80:95], v[144:147], v[164:167], v[80:95]
 v_mfma_f32_32x32x16_bf16 v[96:111], v[148:151], v[160:163], v[96:111]
 v_mfma_f32_32x32x16_bf16 v[112:127], v[148:151], v[164:167], v[112:127]
 v_dot2c_f32_bf16 v176, v160, v180
 v_dot2c_f32_bf16 v178, v160, v160
 v_dot2c_f32_bf16 v176, v161, v180
 v_dot2c_f32_bf16 v178, v161, v161
 v_dot2c_f32_bf16 v176, v162, v180
 v_dot2c_f32_bf16 v178, v162, v162
 v_dot2c_f32_bf16 v176, v163, v180
 v_dot2c_f32_bf16 v178, v163, v163
 v_dot2c_f32_bf16 v177, v164, v180
 v_dot2c_f32_bf16 v179, v164, v164
 v_dot2c_f32_bf16 v177, v165, v180
 v_dot2c_f32_bf16 v179, v165, v165
 v_dot2c_f32_bf16 v177, v166, v180
 v_dot2c_f32_bf16 v179, v166, v166
 v_dot2c_f32_bf16 v177, v167, v180
 v_dot2c_f32_bf16 v179, v167, v167
 buffer_load_dwordx4 v[144:147], v4, s[12:15], s42 offen
 buffer_load_dwordx4 v[148:151], v4, s[12:15], s43 offen
 s_add_u32 s42, s42, 1024
 s_add_u32 s43, s43, 1024
 ds_read_b128 v[160:163], v5 offset:1152
 ds_read_b128 v[164:167], v7 offset:1152
 s_waitcnt vmcnt(6) lgkmcnt(2)
 v_mfma_f32_32x32x16_bf16 v[64:79], v[152:155], v[168:171], v[64:79]
 v_mfma_f32_32x32x16_bf16 v[80:95], v[152:155], v[172:175], v[80:95]
 v_mfma_f32_32x32x16_bf16 v[96:111], v[156:159], v[168:171], v[96:111]
 v_mfma_f32_32x32x16_bf16 v[112:127], v[156:159], v[172:175], v[112:127]
 v_dot2c_f32_bf16 v176, v168, v180
 v_dot2c_f32_bf16 v178, v168, v168
 v_dot2c_f32_bf16 v176, v169, v180
 v_dot2c_f32_bf16 v178, v169, v169
 v_dot2c_f32_bf16 v176, v170, v180
 v_dot2c_f32_bf16 v178, v170, v170
 v_dot2c_f32_bf16 v176, v171, v180
 v_dot2c_f32_bf16 v178, v171, v171
 v_dot2c_f32_bf16 v177, v172, v180
 v_dot2c_f32_bf16 v179, v172, v172
 v_dot2c_f32_bf16 v177, v173, v180
 v_dot2c_f32_bf16 v179, v173, v173
 v_dot2c_f32_bf16 v177, v174, v180
 v_dot2c_f32_bf16 v179, v174, v174
 v_dot2c_f32_bf16 v177, v175, v180
 v_dot2c_f32_bf16 v179, v175, v175
 buffer_load_dwordx4 v[152:155], v4, s[12:15], s42 offen
 buffer_load_dwordx4 v[156:159], v4, s[12:15], s43 offen
 s_add_u32 s42, s42, 1024
 s_add_u32 s43, s43, 1024
 ds_read_b128 v[168:171], v5 offset:1184
 ds_read_b128 v[172:175], v7 offset:1184
 s_waitcnt vmcnt(6) lgkmcnt(2)
 v_mfma_f32_32x32x16_bf16 v[64:79], v[128:131], v[160:163], v[64:79]
 v_mfma_f32_32x32x16_bf16 v[80:95], v[128:131], v[164:167], v[80:95]
 v_mfma_f32_32x32x16_bf16 v[96:111], v[132:135], v[160:163], v[96:111]
 v_mfma_f32_32x32x16_bf16 v[112:127], v[132:135], v[164:167], v[112:127]
 v_dot2c_f32_bf16 v176, v160, v180
 v_dot2c_f32_bf16 v178, v160, v160
 v_dot2c_f32_bf16 v176, v161, v180
 v_dot2c_f32_bf16 v178, v161, v161
 v_dot2c_f32_bf16 v176, v162, v180
 v_dot2c_f32_bf16 v178, v162, v162
 v_dot2c_f32_bf16 v176, v163, v180
 v_dot2c_f32_bf16 v178, v163, v163
 v_dot2c_f32_bf16 v177, v164, v180
 v_dot2c_f32_bf16 v179, v164, v164
 v_dot2c_f32_bf16 v177, v165, v180
 v_dot2c_f32_bf16 v179, v165, v165
 v_dot2c_f32_bf16 v177, v166, v180
 v_dot2c_f32_bf16 v179, v166, v166
 v_dot2c_f32_bf16 v177, v167, v180
 v_dot2c_f32_bf16 v179, v167, v167
 ds_read_b128 v[160:163], v5 offset:1216
 ds_read_b128 v[164:167], v7 offset:1216
 s_waitcnt vmcnt(4) lgkmcnt(2)
 v_mfma_f32_32x32x16_bf16 v[64:79], v[136:139], v[168:171], v[64:79]
 v_mfma_f32_32x32x16_bf16 v[80:95], v[136:139], v[172:175], v[80:95]
 v_mfma_f32_32x32x16_bf16 v[96:111], v[140:143], v[168:171], v[96:111]
 v_mfma_f32_32x32x16_bf16 v[112:127], v[140:143], v[172:175], v[112:127]
 v_dot2c_f32_bf16 v176, v168, v180
 v_dot2c_f32_bf16 v178, v168, v168
 v_dot2c_f32_bf16 v176, v169, v180
 v_dot2c_f32_bf16 v178, v169, v169
 v_dot2c_f32_bf16 v176, v170, v180
 v_dot2c_f32_bf16 v178, v170, v170
 v_dot2c_f32_bf16 v176, v171, v180
 v_dot2c_f32_bf16 v178, v171, v171
 v_dot2c_f32_bf16 v177, v172, v180
 v_dot2c_f32_bf16 v179, v172, v172
 v_dot2c_f32_bf16 v177, v173, v180
 v_dot2c_f32_bf16 v179, v173, v173
 v_dot2c_f32_bf16 v177, v174, v180
 v_dot2c_f32_bf16 v179, v174, v174
 v_dot2c_f32_bf16 v177, v175, v180
 v_dot2c_f32_bf16 v179, v175, v175
 ds_read_b128 v[168:171], v5 offset:1248
 ds_read_b128 v[172:175], v7 offset:1248
 s_waitcnt vmcnt(2) lgkmcnt(2)
 v_mfma_f32_32x32x16_bf16 v[64:79], v[144:147], v[160:163], v[64:79]
 v_mfma_f32_32x32x16_bf16 v[80:95], v[144:147], v[164:167], v[80:95]
 v_mfma_f32_32x32x16_bf16 v[96:111], v[148:151], v[160:163], v[96:111]
 v_mfma_f32_32x32x16_bf16 v[112:127], v[148:151], v[164:167], v[112:127]
 v_dot2c_f32_bf16 v176, v160, v180
 v_dot2c_f32_bf16 v178, v160, v160
 v_dot2c_f32_bf16 v176, v161, v180
 v_dot2c_f32_bf16 v178, v161, v161
 v_dot2c_f32_bf16 v176, v162, v180
 v_dot2c_f32_bf16 v178, v162, v162
 v_dot2c_f32_bf16 v176, v163, v180
 v_dot2c_f32_bf16 v178, v163, v163
 v_dot2c_f32_bf16 v177, v164, v180
 v_dot2c_f32_bf16 v179, v164, v164
 v_dot2c_f32_bf16 v177, v165, v180
 v_dot2c_f32_bf16 v179, v165, v165
 v_dot2c_f32_bf16 v177, v166, v180
 v_dot2c_f32_bf16 v179, v166, v166
 v_dot2c_f32_bf16 v177, v167, v180
 v_dot2c_f32_bf16 v179, v167, v167
 s_waitcnt vmcnt(0) lgkmcnt(0)
 v_mfma_f32_32x32x16_bf16 v[64:79], v[152:155], v[168:171], v[64:79]
 v_mfma_f32_32x32x16_bf16 v[80:95], v[152:155], v[172:175], v[80:95]
 v_mfma_f32_32x32x16_bf16 v[96:111], v[156:159], v[168:171], v[96:111]
 v_mfma_f32_32x32x16_bf16 v[112:127], v[156:159], v[172:175], v[112:127]
 v_dot2c_f32_bf16 v176, v168, v180
 v_dot2c_f32_bf16 v178, v168, v168
 v_dot2c_f32_bf16 v176, v169, v180
 v_dot2c_f32_bf16 v178, v169, v169
 v_dot2c_f32_bf16 v176, v170, v180
 v_dot2c_f32_bf16 v178, v170, v170
 v_dot2c_f32_bf16 v176, v171, v180
 v_dot2c_f32_bf16 v178, v171, v171
 v_dot2c_f32_bf16 v177, v172, v180
 v_dot2c_f32_bf16 v179, v172, v172
 v_dot2c_f32_bf16 v177, v173, v180
 v_dot2c_f32_bf16 v179, v173, v173
 v_dot2c_f32_bf16 v177, v174, v180
 v_dot2c_f32_bf16 v179, v174, v174
 v_dot2c_f32_bf16 v177, v175, v180
 v_dot2c_f32_bf16 v179, v175, v175
 s_nop 11
 v_mov_b32 v186, v176
 s_nop 1
 v_permlane32_swap_b32 v176, v186
 v_add_f32 v176, v176, v186
 v_mov_b32 v186, v177
 s_nop 1
 v_permlane32_swap_b32 v177, v186
 v_add_f32 v177, v177, v186
 v_mov_b32 v186, v178
 s_nop 1
 v_permlane32_swap_b32 v178, v186
 v_add_f32 v178, v178, v186
 v_mov_b32 v186, v179
 s_nop 1
 v_permlane32_swap_b32 v179, v186
 v_add_f32 v179, v179, v186
 s_mov_b32 s44, 0x3acccccd
 s_mov_b32 s45, 0x3727c5ac
 v_mul_f32 v186, s44, v176
 v_mul_f32 v187, s44, v178
 v_fma_f32 v187, -v186, v186, v187
 v_add_f32 v187, s45, v187
 v_rsq_f32 v181, v187
 s_nop 0
 v_mul_f32 v183, v181, v186
 v_mul_f32 v186, s44, v177
 v_mul_f32 v187, s44, v179
 v_fma_f32 v187, -v186, v186, v187
 v_add_f32 v187, s45, v187
 v_rsq_f32 v182, v187
 s_nop 0
 v_mul_f32 v184, v182, v186
 s_cmp_ge_u32 s40, 20
 s_cbranch_scc1 L_b1_3_kernel_ktype
 s_add_u32 s49, s40, 0
 v_bfe_u32 v8, v0, 5, 1
 v_lshlrev_b32 v8, 2, v8
 v_and_b32 v9, 31, v0
 s_lshl_b32 s46, s49, 5
 v_add_u32 v8, s46, v8
 s_mov_b32 s47, 0x3ea52b5c
 v_add_u32 v10, 0, v8
 v_lshlrev_b32 v11, 2, v10
 buffer_load_dwordx4 v[12:15], v11, s[16:19], 0 offen
 v_add_u32 v10, 8, v8
 v_lshlrev_b32 v11, 2, v10
 buffer_load_dwordx4 v[16:19], v11, s[16:19], 0 offen
 v_add_u32 v10, 16, v8
 v_lshlrev_b32 v11, 2, v10
 buffer_load_dwordx4 v[20:23], v11, s[16:19], 0 offen
 v_add_u32 v10, 24, v8
 v_lshlrev_b32 v11, 2, v10
 buffer_load_dwordx4 v[24:27], v11, s[16:19], 0 offen
 v_mul_f32 v28, s47, v181
 v_mul_f32 v29, s47, v183
 s_lshl_b32 s48, s32, 1
 s_add_u32 s48, s48, 0
 s_lshl_b32 s48, s48, 11
 s_waitcnt vmcnt(3)
 v_add_u32 v10, 0, v8
 v_mul_u32_u24 v11, 3277, v10
 v_lshrrev_b32 v11, 16, v11
 v_mul_u32_u24 v30, 20, v11
 v_sub_u32 v30, v10, v30
 v_lshrrev_b32 v30, 2, v30
 v_lshlrev_b32 v11, 17, v11
 v_lshlrev_b32 v31, 4, v9
 v_add3_u32 v11, v11, v31, s48
 v_lshrrev_b32 v31, 2, v30
 v_lshl_add_u32 v11, v31, 10, v11
 v_bfe_u32 v31, v30, 1, 1
 v_lshl_add_u32 v11, v31, 9, v11
 v_and_b32 v31, 1, v30
 v_lshl_add_u32 v11, v31, 3, v11
 v_mul_f32 v32, v29, v12
 v_fma_f32 v32, v28, v64, -v32
 v_mul_f32 v33, v29, v13
 v_fma_f32 v33, v28, v65, -v33
 v_mul_f32 v34, v29, v14
 v_fma_f32 v34, v28, v66, -v34
 v_mul_f32 v35, v29, v15
 v_fma_f32 v35, v28, v67, -v35
 v_cvt_pk_bf16_f32 v36, v32, v33
 v_cvt_pk_bf16_f32 v37, v34, v35
 buffer_store_dwordx2 v[36:37], v11, s[20:23], 0 offen
 s_waitcnt vmcnt(3)
 v_add_u32 v10, 8, v8
 v_mul_u32_u24 v11, 3277, v10
 v_lshrrev_b32 v11, 16, v11
 v_mul_u32_u24 v30, 20, v11
 v_sub_u32 v30, v10, v30
 v_lshrrev_b32 v30, 2, v30
 v_lshlrev_b32 v11, 17, v11
 v_lshlrev_b32 v31, 4, v9
 v_add3_u32 v11, v11, v31, s48
 v_lshrrev_b32 v31, 2, v30
 v_lshl_add_u32 v11, v31, 10, v11
 v_bfe_u32 v31, v30, 1, 1
 v_lshl_add_u32 v11, v31, 9, v11
 v_and_b32 v31, 1, v30
 v_lshl_add_u32 v11, v31, 3, v11
 v_mul_f32 v32, v29, v16
 v_fma_f32 v32, v28, v68, -v32
 v_mul_f32 v33, v29, v17
 v_fma_f32 v33, v28, v69, -v33
 v_mul_f32 v34, v29, v18
 v_fma_f32 v34, v28, v70, -v34
 v_mul_f32 v35, v29, v19
 v_fma_f32 v35, v28, v71, -v35
 v_cvt_pk_bf16_f32 v36, v32, v33
 v_cvt_pk_bf16_f32 v37, v34, v35
 buffer_store_dwordx2 v[36:37], v11, s[20:23], 0 offen
 s_waitcnt vmcnt(3)
 v_add_u32 v10, 16, v8
 v_mul_u32_u24 v11, 3277, v10
 v_lshrrev_b32 v11, 16, v11
 v_mul_u32_u24 v30, 20, v11
 v_sub_u32 v30, v10, v30
 v_lshrrev_b32 v30, 2, v30
 v_lshlrev_b32 v11, 17, v11
 v_lshlrev_b32 v31, 4, v9
 v_add3_u32 v11, v11, v31, s48
 v_lshrrev_b32 v31, 2, v30
 v_lshl_add_u32 v11, v31, 10, v11
 v_bfe_u32 v31, v30, 1, 1
 v_lshl_add_u32 v11, v31, 9, v11
 v_and_b32 v31, 1, v30
 v_lshl_add_u32 v11, v31, 3, v11
 v_mul_f32 v32, v29, v20
 v_fma_f32 v32, v28, v72, -v32
 v_mul_f32 v33, v29, v21
 v_fma_f32 v33, v28, v73, -v33
 v_mul_f32 v34, v29, v22
 v_fma_f32 v34, v28, v74, -v34
 v_mul_f32 v35, v29, v23
 v_fma_f32 v35, v28, v75, -v35
 v_cvt_pk_bf16_f32 v36, v32, v33
 v_cvt_pk_bf16_f32 v37, v34, v35
 buffer_store_dwordx2 v[36:37], v11, s[20:23], 0 offen
 s_waitcnt vmcnt(3)
 v_add_u32 v10, 24, v8
 v_mul_u32_u24 v11, 3277, v10
 v_lshrrev_b32 v11, 16, v11
 v_mul_u32_u24 v30, 20, v11
 v_sub_u32 v30, v10, v30
 v_lshrrev_b32 v30, 2, v30
 v_lshlrev_b32 v11, 17, v11
 v_lshlrev_b32 v31, 4, v9
 v_add3_u32 v11, v11, v31, s48
 v_lshrrev_b32 v31, 2, v30
 v_lshl_add_u32 v11, v31, 10, v11
 v_bfe_u32 v31, v30, 1, 1
 v_lshl_add_u32 v11, v31, 9, v11
 v_and_b32 v31, 1, v30
 v_lshl_add_u32 v11, v31, 3, v11
 v_mul_f32 v32, v29, v24
 v_fma_f32 v32, v28, v76, -v32
 v_mul_f32 v33, v29, v25
 v_fma_f32 v33, v28, v77, -v33
 v_mul_f32 v34, v29, v26
 v_fma_f32 v34, v28, v78, -v34
 v_mul_f32 v35, v29, v27
 v_fma_f32 v35, v28, v79, -v35
 v_cvt_pk_bf16_f32 v36, v32, v33
 v_cvt_pk_bf16_f32 v37, v34, v35
 buffer_store_dwordx2 v[36:37], v11, s[20:23], 0 offen
 v_mul_f32 v28, s47, v182
 v_mul_f32 v29, s47, v184
 s_lshl_b32 s48, s32, 1
 s_add_u32 s48, s48, 1
 s_lshl_b32 s48, s48, 11
 v_add_u32 v10, 0, v8
 v_mul_u32_u24 v11, 3277, v10
 v_lshrrev_b32 v11, 16, v11
 v_mul_u32_u24 v30, 20, v11
 v_sub_u32 v30, v10, v30
 v_lshrrev_b32 v30, 2, v30
 v_lshlrev_b32 v11, 17, v11
 v_lshlrev_b32 v31, 4, v9
 v_add3_u32 v11, v11, v31, s48
 v_lshrrev_b32 v31, 2, v30
 v_lshl_add_u32 v11, v31, 10, v11
 v_bfe_u32 v31, v30, 1, 1
 v_lshl_add_u32 v11, v31, 9, v11
 v_and_b32 v31, 1, v30
 v_lshl_add_u32 v11, v31, 3, v11
 v_mul_f32 v32, v29, v12
 v_fma_f32 v32, v28, v80, -v32
 v_mul_f32 v33, v29, v13
 v_fma_f32 v33, v28, v81, -v33
 v_mul_f32 v34, v29, v14
 v_fma_f32 v34, v28, v82, -v34
 v_mul_f32 v35, v29, v15
 v_fma_f32 v35, v28, v83, -v35
 v_cvt_pk_bf16_f32 v36, v32, v33
 v_cvt_pk_bf16_f32 v37, v34, v35
 buffer_store_dwordx2 v[36:37], v11, s[20:23], 0 offen
 v_add_u32 v10, 8, v8
 v_mul_u32_u24 v11, 3277, v10
 v_lshrrev_b32 v11, 16, v11
 v_mul_u32_u24 v30, 20, v11
 v_sub_u32 v30, v10, v30
 v_lshrrev_b32 v30, 2, v30
 v_lshlrev_b32 v11, 17, v11
 v_lshlrev_b32 v31, 4, v9
 v_add3_u32 v11, v11, v31, s48
 v_lshrrev_b32 v31, 2, v30
 v_lshl_add_u32 v11, v31, 10, v11
 v_bfe_u32 v31, v30, 1, 1
 v_lshl_add_u32 v11, v31, 9, v11
 v_and_b32 v31, 1, v30
 v_lshl_add_u32 v11, v31, 3, v11
 v_mul_f32 v32, v29, v16
 v_fma_f32 v32, v28, v84, -v32
 v_mul_f32 v33, v29, v17
 v_fma_f32 v33, v28, v85, -v33
 v_mul_f32 v34, v29, v18
 v_fma_f32 v34, v28, v86, -v34
 v_mul_f32 v35, v29, v19
 v_fma_f32 v35, v28, v87, -v35
 v_cvt_pk_bf16_f32 v36, v32, v33
 v_cvt_pk_bf16_f32 v37, v34, v35
 buffer_store_dwordx2 v[36:37], v11, s[20:23], 0 offen
 v_add_u32 v10, 16, v8
 v_mul_u32_u24 v11, 3277, v10
 v_lshrrev_b32 v11, 16, v11
 v_mul_u32_u24 v30, 20, v11
 v_sub_u32 v30, v10, v30
 v_lshrrev_b32 v30, 2, v30
 v_lshlrev_b32 v11, 17, v11
 v_lshlrev_b32 v31, 4, v9
 v_add3_u32 v11, v11, v31, s48
 v_lshrrev_b32 v31, 2, v30
 v_lshl_add_u32 v11, v31, 10, v11
 v_bfe_u32 v31, v30, 1, 1
 v_lshl_add_u32 v11, v31, 9, v11
 v_and_b32 v31, 1, v30
 v_lshl_add_u32 v11, v31, 3, v11
 v_mul_f32 v32, v29, v20
 v_fma_f32 v32, v28, v88, -v32
 v_mul_f32 v33, v29, v21
 v_fma_f32 v33, v28, v89, -v33
 v_mul_f32 v34, v29, v22
 v_fma_f32 v34, v28, v90, -v34
 v_mul_f32 v35, v29, v23
 v_fma_f32 v35, v28, v91, -v35
 v_cvt_pk_bf16_f32 v36, v32, v33
 v_cvt_pk_bf16_f32 v37, v34, v35
 buffer_store_dwordx2 v[36:37], v11, s[20:23], 0 offen
 v_add_u32 v10, 24, v8
 v_mul_u32_u24 v11, 3277, v10
 v_lshrrev_b32 v11, 16, v11
 v_mul_u32_u24 v30, 20, v11
 v_sub_u32 v30, v10, v30
 v_lshrrev_b32 v30, 2, v30
 v_lshlrev_b32 v11, 17, v11
 v_lshlrev_b32 v31, 4, v9
 v_add3_u32 v11, v11, v31, s48
 v_lshrrev_b32 v31, 2, v30
 v_lshl_add_u32 v11, v31, 10, v11
 v_bfe_u32 v31, v30, 1, 1
 v_lshl_add_u32 v11, v31, 9, v11
 v_and_b32 v31, 1, v30
 v_lshl_add_u32 v11, v31, 3, v11
 v_mul_f32 v32, v29, v24
 v_fma_f32 v32, v28, v92, -v32
 v_mul_f32 v33, v29, v25
 v_fma_f32 v33, v28, v93, -v33
 v_mul_f32 v34, v29, v26
 v_fma_f32 v34, v28, v94, -v34
 v_mul_f32 v35, v29, v27
 v_fma_f32 v35, v28, v95, -v35
 v_cvt_pk_bf16_f32 v36, v32, v33
 v_cvt_pk_bf16_f32 v37, v34, v35
 buffer_store_dwordx2 v[36:37], v11, s[20:23], 0 offen
 s_add_u32 s49, s40, 1
 v_bfe_u32 v8, v0, 5, 1
 v_lshlrev_b32 v8, 2, v8
 v_and_b32 v9, 31, v0
 s_lshl_b32 s46, s49, 5
 v_add_u32 v8, s46, v8
 s_mov_b32 s47, 0x3ea52b5c
 v_add_u32 v10, 0, v8
 v_lshlrev_b32 v11, 2, v10
 buffer_load_dwordx4 v[12:15], v11, s[16:19], 0 offen
 v_add_u32 v10, 8, v8
 v_lshlrev_b32 v11, 2, v10
 buffer_load_dwordx4 v[16:19], v11, s[16:19], 0 offen
 v_add_u32 v10, 16, v8
 v_lshlrev_b32 v11, 2, v10
 buffer_load_dwordx4 v[20:23], v11, s[16:19], 0 offen
 v_add_u32 v10, 24, v8
 v_lshlrev_b32 v11, 2, v10
 buffer_load_dwordx4 v[24:27], v11, s[16:19], 0 offen
 v_mul_f32 v28, s47, v181
 v_mul_f32 v29, s47, v183
 s_lshl_b32 s48, s32, 1
 s_add_u32 s48, s48, 0
 s_lshl_b32 s48, s48, 11
 s_waitcnt vmcnt(3)
 v_add_u32 v10, 0, v8
 v_mul_u32_u24 v11, 3277, v10
 v_lshrrev_b32 v11, 16, v11
 v_mul_u32_u24 v30, 20, v11
 v_sub_u32 v30, v10, v30
 v_lshrrev_b32 v30, 2, v30
 v_lshlrev_b32 v11, 17, v11
 v_lshlrev_b32 v31, 4, v9
 v_add3_u32 v11, v11, v31, s48
 v_lshrrev_b32 v31, 2, v30
 v_lshl_add_u32 v11, v31, 10, v11
 v_bfe_u32 v31, v30, 1, 1
 v_lshl_add_u32 v11, v31, 9, v11
 v_and_b32 v31, 1, v30
 v_lshl_add_u32 v11, v31, 3, v11
 v_mul_f32 v32, v29, v12
 v_fma_f32 v32, v28, v96, -v32
 v_mul_f32 v33, v29, v13
 v_fma_f32 v33, v28, v97, -v33
 v_mul_f32 v34, v29, v14
 v_fma_f32 v34, v28, v98, -v34
 v_mul_f32 v35, v29, v15
 v_fma_f32 v35, v28, v99, -v35
 v_cvt_pk_bf16_f32 v36, v32, v33
 v_cvt_pk_bf16_f32 v37, v34, v35
 buffer_store_dwordx2 v[36:37], v11, s[20:23], 0 offen
 s_waitcnt vmcnt(3)
 v_add_u32 v10, 8, v8
 v_mul_u32_u24 v11, 3277, v10
 v_lshrrev_b32 v11, 16, v11
 v_mul_u32_u24 v30, 20, v11
 v_sub_u32 v30, v10, v30
 v_lshrrev_b32 v30, 2, v30
 v_lshlrev_b32 v11, 17, v11
 v_lshlrev_b32 v31, 4, v9
 v_add3_u32 v11, v11, v31, s48
 v_lshrrev_b32 v31, 2, v30
 v_lshl_add_u32 v11, v31, 10, v11
 v_bfe_u32 v31, v30, 1, 1
 v_lshl_add_u32 v11, v31, 9, v11
 v_and_b32 v31, 1, v30
 v_lshl_add_u32 v11, v31, 3, v11
 v_mul_f32 v32, v29, v16
 v_fma_f32 v32, v28, v100, -v32
 v_mul_f32 v33, v29, v17
 v_fma_f32 v33, v28, v101, -v33
 v_mul_f32 v34, v29, v18
 v_fma_f32 v34, v28, v102, -v34
 v_mul_f32 v35, v29, v19
 v_fma_f32 v35, v28, v103, -v35
 v_cvt_pk_bf16_f32 v36, v32, v33
 v_cvt_pk_bf16_f32 v37, v34, v35
 buffer_store_dwordx2 v[36:37], v11, s[20:23], 0 offen
 s_waitcnt vmcnt(3)
 v_add_u32 v10, 16, v8
 v_mul_u32_u24 v11, 3277, v10
 v_lshrrev_b32 v11, 16, v11
 v_mul_u32_u24 v30, 20, v11
 v_sub_u32 v30, v10, v30
 v_lshrrev_b32 v30, 2, v30
 v_lshlrev_b32 v11, 17, v11
 v_lshlrev_b32 v31, 4, v9
 v_add3_u32 v11, v11, v31, s48
 v_lshrrev_b32 v31, 2, v30
 v_lshl_add_u32 v11, v31, 10, v11
 v_bfe_u32 v31, v30, 1, 1
 v_lshl_add_u32 v11, v31, 9, v11
 v_and_b32 v31, 1, v30
 v_lshl_add_u32 v11, v31, 3, v11
 v_mul_f32 v32, v29, v20
 v_fma_f32 v32, v28, v104, -v32
 v_mul_f32 v33, v29, v21
 v_fma_f32 v33, v28, v105, -v33
 v_mul_f32 v34, v29, v22
 v_fma_f32 v34, v28, v106, -v34
 v_mul_f32 v35, v29, v23
 v_fma_f32 v35, v28, v107, -v35
 v_cvt_pk_bf16_f32 v36, v32, v33
 v_cvt_pk_bf16_f32 v37, v34, v35
 buffer_store_dwordx2 v[36:37], v11, s[20:23], 0 offen
 s_waitcnt vmcnt(3)
 v_add_u32 v10, 24, v8
 v_mul_u32_u24 v11, 3277, v10
 v_lshrrev_b32 v11, 16, v11
 v_mul_u32_u24 v30, 20, v11
 v_sub_u32 v30, v10, v30
 v_lshrrev_b32 v30, 2, v30
 v_lshlrev_b32 v11, 17, v11
 v_lshlrev_b32 v31, 4, v9
 v_add3_u32 v11, v11, v31, s48
 v_lshrrev_b32 v31, 2, v30
 v_lshl_add_u32 v11, v31, 10, v11
 v_bfe_u32 v31, v30, 1, 1
 v_lshl_add_u32 v11, v31, 9, v11
 v_and_b32 v31, 1, v30
 v_lshl_add_u32 v11, v31, 3, v11
 v_mul_f32 v32, v29, v24
 v_fma_f32 v32, v28, v108, -v32
 v_mul_f32 v33, v29, v25
 v_fma_f32 v33, v28, v109, -v33
 v_mul_f32 v34, v29, v26
 v_fma_f32 v34, v28, v110, -v34
 v_mul_f32 v35, v29, v27
 v_fma_f32 v35, v28, v111, -v35
 v_cvt_pk_bf16_f32 v36, v32, v33
 v_cvt_pk_bf16_f32 v37, v34, v35
 buffer_store_dwordx2 v[36:37], v11, s[20:23], 0 offen
 v_mul_f32 v28, s47, v182
 v_mul_f32 v29, s47, v184
 s_lshl_b32 s48, s32, 1
 s_add_u32 s48, s48, 1
 s_lshl_b32 s48, s48, 11
 v_add_u32 v10, 0, v8
 v_mul_u32_u24 v11, 3277, v10
 v_lshrrev_b32 v11, 16, v11
 v_mul_u32_u24 v30, 20, v11
 v_sub_u32 v30, v10, v30
 v_lshrrev_b32 v30, 2, v30
 v_lshlrev_b32 v11, 17, v11
 v_lshlrev_b32 v31, 4, v9
 v_add3_u32 v11, v11, v31, s48
 v_lshrrev_b32 v31, 2, v30
 v_lshl_add_u32 v11, v31, 10, v11
 v_bfe_u32 v31, v30, 1, 1
 v_lshl_add_u32 v11, v31, 9, v11
 v_and_b32 v31, 1, v30
 v_lshl_add_u32 v11, v31, 3, v11
 v_mul_f32 v32, v29, v12
 v_fma_f32 v32, v28, v112, -v32
 v_mul_f32 v33, v29, v13
 v_fma_f32 v33, v28, v113, -v33
 v_mul_f32 v34, v29, v14
 v_fma_f32 v34, v28, v114, -v34
 v_mul_f32 v35, v29, v15
 v_fma_f32 v35, v28, v115, -v35
 v_cvt_pk_bf16_f32 v36, v32, v33
 v_cvt_pk_bf16_f32 v37, v34, v35
 buffer_store_dwordx2 v[36:37], v11, s[20:23], 0 offen
 v_add_u32 v10, 8, v8
 v_mul_u32_u24 v11, 3277, v10
 v_lshrrev_b32 v11, 16, v11
 v_mul_u32_u24 v30, 20, v11
 v_sub_u32 v30, v10, v30
 v_lshrrev_b32 v30, 2, v30
 v_lshlrev_b32 v11, 17, v11
 v_lshlrev_b32 v31, 4, v9
 v_add3_u32 v11, v11, v31, s48
 v_lshrrev_b32 v31, 2, v30
 v_lshl_add_u32 v11, v31, 10, v11
 v_bfe_u32 v31, v30, 1, 1
 v_lshl_add_u32 v11, v31, 9, v11
 v_and_b32 v31, 1, v30
 v_lshl_add_u32 v11, v31, 3, v11
 v_mul_f32 v32, v29, v16
 v_fma_f32 v32, v28, v116, -v32
 v_mul_f32 v33, v29, v17
 v_fma_f32 v33, v28, v117, -v33
 v_mul_f32 v34, v29, v18
 v_fma_f32 v34, v28, v118, -v34
 v_mul_f32 v35, v29, v19
 v_fma_f32 v35, v28, v119, -v35
 v_cvt_pk_bf16_f32 v36, v32, v33
 v_cvt_pk_bf16_f32 v37, v34, v35
 buffer_store_dwordx2 v[36:37], v11, s[20:23], 0 offen
 v_add_u32 v10, 16, v8
 v_mul_u32_u24 v11, 3277, v10
 v_lshrrev_b32 v11, 16, v11
 v_mul_u32_u24 v30, 20, v11
 v_sub_u32 v30, v10, v30
 v_lshrrev_b32 v30, 2, v30
 v_lshlrev_b32 v11, 17, v11
 v_lshlrev_b32 v31, 4, v9
 v_add3_u32 v11, v11, v31, s48
 v_lshrrev_b32 v31, 2, v30
 v_lshl_add_u32 v11, v31, 10, v11
 v_bfe_u32 v31, v30, 1, 1
 v_lshl_add_u32 v11, v31, 9, v11
 v_and_b32 v31, 1, v30
 v_lshl_add_u32 v11, v31, 3, v11
 v_mul_f32 v32, v29, v20
 v_fma_f32 v32, v28, v120, -v32
 v_mul_f32 v33, v29, v21
 v_fma_f32 v33, v28, v121, -v33
 v_mul_f32 v34, v29, v22
 v_fma_f32 v34, v28, v122, -v34
 v_mul_f32 v35, v29, v23
 v_fma_f32 v35, v28, v123, -v35
 v_cvt_pk_bf16_f32 v36, v32, v33
 v_cvt_pk_bf16_f32 v37, v34, v35
 buffer_store_dwordx2 v[36:37], v11, s[20:23], 0 offen
 v_add_u32 v10, 24, v8
 v_mul_u32_u24 v11, 3277, v10
 v_lshrrev_b32 v11, 16, v11
 v_mul_u32_u24 v30, 20, v11
 v_sub_u32 v30, v10, v30
 v_lshrrev_b32 v30, 2, v30
 v_lshlrev_b32 v11, 17, v11
 v_lshlrev_b32 v31, 4, v9
 v_add3_u32 v11, v11, v31, s48
 v_lshrrev_b32 v31, 2, v30
 v_lshl_add_u32 v11, v31, 10, v11
 v_bfe_u32 v31, v30, 1, 1
 v_lshl_add_u32 v11, v31, 9, v11
 v_and_b32 v31, 1, v30
 v_lshl_add_u32 v11, v31, 3, v11
 v_mul_f32 v32, v29, v24
 v_fma_f32 v32, v28, v124, -v32
 v_mul_f32 v33, v29, v25
 v_fma_f32 v33, v28, v125, -v33
 v_mul_f32 v34, v29, v26
 v_fma_f32 v34, v28, v126, -v34
 v_mul_f32 v35, v29, v27
 v_fma_f32 v35, v28, v127, -v35
 v_cvt_pk_bf16_f32 v36, v32, v33
 v_cvt_pk_bf16_f32 v37, v34, v35
 buffer_store_dwordx2 v[36:37], v11, s[20:23], 0 offen
 s_branch L_b1_3_kernel_end
L_b1_3_kernel_ktype:
 s_add_u32 s49, s40, -20
 s_lshl_b32 s52, s49, 5
 v_bfe_u32 v8, v0, 5, 1
 v_lshlrev_b32 v8, 2, v8
 v_and_b32 v9, 31, v0
 v_add_u32 v8, s52, v8
 s_mov_b32 s47, 0x3f800000
 v_add_u32 v10, 640, v8
 v_lshlrev_b32 v11, 2, v10
 buffer_load_dwordx4 v[12:15], v11, s[16:19], 0 offen
 v_add_u32 v10, 648, v8
 v_lshlrev_b32 v11, 2, v10
 buffer_load_dwordx4 v[16:19], v11, s[16:19], 0 offen
 v_add_u32 v10, 656, v8
 v_lshlrev_b32 v11, 2, v10
 buffer_load_dwordx4 v[20:23], v11, s[16:19], 0 offen
 v_add_u32 v10, 664, v8
 v_lshlrev_b32 v11, 2, v10
 buffer_load_dwordx4 v[24:27], v11, s[16:19], 0 offen
 v_mul_f32 v28, s47, v181
 v_mul_f32 v29, s47, v183
 s_lshl_b32 s48, s32, 1
 s_add_u32 s48, s48, 0
 s_lshl_b32 s48, s48, 11
 s_waitcnt vmcnt(3)
 v_add_u32 v10, 0, v8
 v_mul_u32_u24 v11, 3277, v10
 v_lshrrev_b32 v11, 16, v11
 v_mul_u32_u24 v30, 20, v11
 v_sub_u32 v30, v10, v30
 v_lshrrev_b32 v30, 2, v30
 v_lshlrev_b32 v11, 17, v11
 v_lshlrev_b32 v31, 4, v9
 v_add3_u32 v11, v11, v31, s48
 v_lshrrev_b32 v31, 2, v30
 v_lshl_add_u32 v11, v31, 10, v11
 v_bfe_u32 v31, v30, 1, 1
 v_lshl_add_u32 v11, v31, 9, v11
 v_and_b32 v31, 1, v30
 v_lshl_add_u32 v11, v31, 3, v11
 v_mul_f32 v32, v29, v12
 v_fma_f32 v32, v28, v64, -v32
 v_mul_f32 v33, v29, v13
 v_fma_f32 v33, v28, v65, -v33
 v_mul_f32 v34, v29, v14
 v_fma_f32 v34, v28, v66, -v34
 v_mul_f32 v35, v29, v15
 v_fma_f32 v35, v28, v67, -v35
 v_cvt_pk_bf16_f32 v36, v32, v33
 v_cvt_pk_bf16_f32 v37, v34, v35
 buffer_store_dwordx2 v[36:37], v11, s[24:27], 0 offen
 s_waitcnt vmcnt(3)
 v_add_u32 v10, 8, v8
 v_mul_u32_u24 v11, 3277, v10
 v_lshrrev_b32 v11, 16, v11
 v_mul_u32_u24 v30, 20, v11
 v_sub_u32 v30, v10, v30
 v_lshrrev_b32 v30, 2, v30
 v_lshlrev_b32 v11, 17, v11
 v_lshlrev_b32 v31, 4, v9
 v_add3_u32 v11, v11, v31, s48
 v_lshrrev_b32 v31, 2, v30
 v_lshl_add_u32 v11, v31, 10, v11
 v_bfe_u32 v31, v30, 1, 1
 v_lshl_add_u32 v11, v31, 9, v11
 v_and_b32 v31, 1, v30
 v_lshl_add_u32 v11, v31, 3, v11
 v_mul_f32 v32, v29, v16
 v_fma_f32 v32, v28, v68, -v32
 v_mul_f32 v33, v29, v17
 v_fma_f32 v33, v28, v69, -v33
 v_mul_f32 v34, v29, v18
 v_fma_f32 v34, v28, v70, -v34
 v_mul_f32 v35, v29, v19
 v_fma_f32 v35, v28, v71, -v35
 v_cvt_pk_bf16_f32 v36, v32, v33
 v_cvt_pk_bf16_f32 v37, v34, v35
 buffer_store_dwordx2 v[36:37], v11, s[24:27], 0 offen
 s_waitcnt vmcnt(3)
 v_add_u32 v10, 16, v8
 v_mul_u32_u24 v11, 3277, v10
 v_lshrrev_b32 v11, 16, v11
 v_mul_u32_u24 v30, 20, v11
 v_sub_u32 v30, v10, v30
 v_lshrrev_b32 v30, 2, v30
 v_lshlrev_b32 v11, 17, v11
 v_lshlrev_b32 v31, 4, v9
 v_add3_u32 v11, v11, v31, s48
 v_lshrrev_b32 v31, 2, v30
 v_lshl_add_u32 v11, v31, 10, v11
 v_bfe_u32 v31, v30, 1, 1
 v_lshl_add_u32 v11, v31, 9, v11
 v_and_b32 v31, 1, v30
 v_lshl_add_u32 v11, v31, 3, v11
 v_mul_f32 v32, v29, v20
 v_fma_f32 v32, v28, v72, -v32
 v_mul_f32 v33, v29, v21
 v_fma_f32 v33, v28, v73, -v33
 v_mul_f32 v34, v29, v22
 v_fma_f32 v34, v28, v74, -v34
 v_mul_f32 v35, v29, v23
 v_fma_f32 v35, v28, v75, -v35
 v_cvt_pk_bf16_f32 v36, v32, v33
 v_cvt_pk_bf16_f32 v37, v34, v35
 buffer_store_dwordx2 v[36:37], v11, s[24:27], 0 offen
 s_waitcnt vmcnt(3)
 v_add_u32 v10, 24, v8
 v_mul_u32_u24 v11, 3277, v10
 v_lshrrev_b32 v11, 16, v11
 v_mul_u32_u24 v30, 20, v11
 v_sub_u32 v30, v10, v30
 v_lshrrev_b32 v30, 2, v30
 v_lshlrev_b32 v11, 17, v11
 v_lshlrev_b32 v31, 4, v9
 v_add3_u32 v11, v11, v31, s48
 v_lshrrev_b32 v31, 2, v30
 v_lshl_add_u32 v11, v31, 10, v11
 v_bfe_u32 v31, v30, 1, 1
 v_lshl_add_u32 v11, v31, 9, v11
 v_and_b32 v31, 1, v30
 v_lshl_add_u32 v11, v31, 3, v11
 v_mul_f32 v32, v29, v24
 v_fma_f32 v32, v28, v76, -v32
 v_mul_f32 v33, v29, v25
 v_fma_f32 v33, v28, v77, -v33
 v_mul_f32 v34, v29, v26
 v_fma_f32 v34, v28, v78, -v34
 v_mul_f32 v35, v29, v27
 v_fma_f32 v35, v28, v79, -v35
 v_cvt_pk_bf16_f32 v36, v32, v33
 v_cvt_pk_bf16_f32 v37, v34, v35
 buffer_store_dwordx2 v[36:37], v11, s[24:27], 0 offen
 v_mul_f32 v28, s47, v182
 v_mul_f32 v29, s47, v184
 s_lshl_b32 s48, s32, 1
 s_add_u32 s48, s48, 1
 s_lshl_b32 s48, s48, 11
 v_add_u32 v10, 0, v8
 v_mul_u32_u24 v11, 3277, v10
 v_lshrrev_b32 v11, 16, v11
 v_mul_u32_u24 v30, 20, v11
 v_sub_u32 v30, v10, v30
 v_lshrrev_b32 v30, 2, v30
 v_lshlrev_b32 v11, 17, v11
 v_lshlrev_b32 v31, 4, v9
 v_add3_u32 v11, v11, v31, s48
 v_lshrrev_b32 v31, 2, v30
 v_lshl_add_u32 v11, v31, 10, v11
 v_bfe_u32 v31, v30, 1, 1
 v_lshl_add_u32 v11, v31, 9, v11
 v_and_b32 v31, 1, v30
 v_lshl_add_u32 v11, v31, 3, v11
 v_mul_f32 v32, v29, v12
 v_fma_f32 v32, v28, v80, -v32
 v_mul_f32 v33, v29, v13
 v_fma_f32 v33, v28, v81, -v33
 v_mul_f32 v34, v29, v14
 v_fma_f32 v34, v28, v82, -v34
 v_mul_f32 v35, v29, v15
 v_fma_f32 v35, v28, v83, -v35
 v_cvt_pk_bf16_f32 v36, v32, v33
 v_cvt_pk_bf16_f32 v37, v34, v35
 buffer_store_dwordx2 v[36:37], v11, s[24:27], 0 offen
 v_add_u32 v10, 8, v8
 v_mul_u32_u24 v11, 3277, v10
 v_lshrrev_b32 v11, 16, v11
 v_mul_u32_u24 v30, 20, v11
 v_sub_u32 v30, v10, v30
 v_lshrrev_b32 v30, 2, v30
 v_lshlrev_b32 v11, 17, v11
 v_lshlrev_b32 v31, 4, v9
 v_add3_u32 v11, v11, v31, s48
 v_lshrrev_b32 v31, 2, v30
 v_lshl_add_u32 v11, v31, 10, v11
 v_bfe_u32 v31, v30, 1, 1
 v_lshl_add_u32 v11, v31, 9, v11
 v_and_b32 v31, 1, v30
 v_lshl_add_u32 v11, v31, 3, v11
 v_mul_f32 v32, v29, v16
 v_fma_f32 v32, v28, v84, -v32
 v_mul_f32 v33, v29, v17
 v_fma_f32 v33, v28, v85, -v33
 v_mul_f32 v34, v29, v18
 v_fma_f32 v34, v28, v86, -v34
 v_mul_f32 v35, v29, v19
 v_fma_f32 v35, v28, v87, -v35
 v_cvt_pk_bf16_f32 v36, v32, v33
 v_cvt_pk_bf16_f32 v37, v34, v35
 buffer_store_dwordx2 v[36:37], v11, s[24:27], 0 offen
 v_add_u32 v10, 16, v8
 v_mul_u32_u24 v11, 3277, v10
 v_lshrrev_b32 v11, 16, v11
 v_mul_u32_u24 v30, 20, v11
 v_sub_u32 v30, v10, v30
 v_lshrrev_b32 v30, 2, v30
 v_lshlrev_b32 v11, 17, v11
 v_lshlrev_b32 v31, 4, v9
 v_add3_u32 v11, v11, v31, s48
 v_lshrrev_b32 v31, 2, v30
 v_lshl_add_u32 v11, v31, 10, v11
 v_bfe_u32 v31, v30, 1, 1
 v_lshl_add_u32 v11, v31, 9, v11
 v_and_b32 v31, 1, v30
 v_lshl_add_u32 v11, v31, 3, v11
 v_mul_f32 v32, v29, v20
 v_fma_f32 v32, v28, v88, -v32
 v_mul_f32 v33, v29, v21
 v_fma_f32 v33, v28, v89, -v33
 v_mul_f32 v34, v29, v22
 v_fma_f32 v34, v28, v90, -v34
 v_mul_f32 v35, v29, v23
 v_fma_f32 v35, v28, v91, -v35
 v_cvt_pk_bf16_f32 v36, v32, v33
 v_cvt_pk_bf16_f32 v37, v34, v35
 buffer_store_dwordx2 v[36:37], v11, s[24:27], 0 offen
 v_add_u32 v10, 24, v8
 v_mul_u32_u24 v11, 3277, v10
 v_lshrrev_b32 v11, 16, v11
 v_mul_u32_u24 v30, 20, v11
 v_sub_u32 v30, v10, v30
 v_lshrrev_b32 v30, 2, v30
 v_lshlrev_b32 v11, 17, v11
 v_lshlrev_b32 v31, 4, v9
 v_add3_u32 v11, v11, v31, s48
 v_lshrrev_b32 v31, 2, v30
 v_lshl_add_u32 v11, v31, 10, v11
 v_bfe_u32 v31, v30, 1, 1
 v_lshl_add_u32 v11, v31, 9, v11
 v_and_b32 v31, 1, v30
 v_lshl_add_u32 v11, v31, 3, v11
 v_mul_f32 v32, v29, v24
 v_fma_f32 v32, v28, v92, -v32
 v_mul_f32 v33, v29, v25
 v_fma_f32 v33, v28, v93, -v33
 v_mul_f32 v34, v29, v26
 v_fma_f32 v34, v28, v94, -v34
 v_mul_f32 v35, v29, v27
 v_fma_f32 v35, v28, v95, -v35
 v_cvt_pk_bf16_f32 v36, v32, v33
 v_cvt_pk_bf16_f32 v37, v34, v35
 buffer_store_dwordx2 v[36:37], v11, s[24:27], 0 offen
 s_add_u32 s49, s40, -19
 s_lshl_b32 s52, s49, 5
 v_bfe_u32 v8, v0, 5, 1
 v_lshlrev_b32 v8, 2, v8
 v_and_b32 v9, 31, v0
 v_add_u32 v8, s52, v8
 s_mov_b32 s47, 0x3f800000
 v_add_u32 v10, 640, v8
 v_lshlrev_b32 v11, 2, v10
 buffer_load_dwordx4 v[12:15], v11, s[16:19], 0 offen
 v_add_u32 v10, 648, v8
 v_lshlrev_b32 v11, 2, v10
 buffer_load_dwordx4 v[16:19], v11, s[16:19], 0 offen
 v_add_u32 v10, 656, v8
 v_lshlrev_b32 v11, 2, v10
 buffer_load_dwordx4 v[20:23], v11, s[16:19], 0 offen
 v_add_u32 v10, 664, v8
 v_lshlrev_b32 v11, 2, v10
 buffer_load_dwordx4 v[24:27], v11, s[16:19], 0 offen
 v_mul_f32 v28, s47, v181
 v_mul_f32 v29, s47, v183
 s_lshl_b32 s48, s32, 1
 s_add_u32 s48, s48, 0
 s_lshl_b32 s48, s48, 11
 s_waitcnt vmcnt(3)
 v_add_u32 v10, 0, v8
 v_mul_u32_u24 v11, 3277, v10
 v_lshrrev_b32 v11, 16, v11
 v_mul_u32_u24 v30, 20, v11
 v_sub_u32 v30, v10, v30
 v_lshrrev_b32 v30, 2, v30
 v_lshlrev_b32 v11, 17, v11
 v_lshlrev_b32 v31, 4, v9
 v_add3_u32 v11, v11, v31, s48
 v_lshrrev_b32 v31, 2, v30
 v_lshl_add_u32 v11, v31, 10, v11
 v_bfe_u32 v31, v30, 1, 1
 v_lshl_add_u32 v11, v31, 9, v11
 v_and_b32 v31, 1, v30
 v_lshl_add_u32 v11, v31, 3, v11
 v_mul_f32 v32, v29, v12
 v_fma_f32 v32, v28, v96, -v32
 v_mul_f32 v33, v29, v13
 v_fma_f32 v33, v28, v97, -v33
 v_mul_f32 v34, v29, v14
 v_fma_f32 v34, v28, v98, -v34
 v_mul_f32 v35, v29, v15
 v_fma_f32 v35, v28, v99, -v35
 v_cvt_pk_bf16_f32 v36, v32, v33
 v_cvt_pk_bf16_f32 v37, v34, v35
 buffer_store_dwordx2 v[36:37], v11, s[24:27], 0 offen
 s_waitcnt vmcnt(3)
 v_add_u32 v10, 8, v8
 v_mul_u32_u24 v11, 3277, v10
 v_lshrrev_b32 v11, 16, v11
 v_mul_u32_u24 v30, 20, v11
 v_sub_u32 v30, v10, v30
 v_lshrrev_b32 v30, 2, v30
 v_lshlrev_b32 v11, 17, v11
 v_lshlrev_b32 v31, 4, v9
 v_add3_u32 v11, v11, v31, s48
 v_lshrrev_b32 v31, 2, v30
 v_lshl_add_u32 v11, v31, 10, v11
 v_bfe_u32 v31, v30, 1, 1
 v_lshl_add_u32 v11, v31, 9, v11
 v_and_b32 v31, 1, v30
 v_lshl_add_u32 v11, v31, 3, v11
 v_mul_f32 v32, v29, v16
 v_fma_f32 v32, v28, v100, -v32
 v_mul_f32 v33, v29, v17
 v_fma_f32 v33, v28, v101, -v33
 v_mul_f32 v34, v29, v18
 v_fma_f32 v34, v28, v102, -v34
 v_mul_f32 v35, v29, v19
 v_fma_f32 v35, v28, v103, -v35
 v_cvt_pk_bf16_f32 v36, v32, v33
 v_cvt_pk_bf16_f32 v37, v34, v35
 buffer_store_dwordx2 v[36:37], v11, s[24:27], 0 offen
 s_waitcnt vmcnt(3)
 v_add_u32 v10, 16, v8
 v_mul_u32_u24 v11, 3277, v10
 v_lshrrev_b32 v11, 16, v11
 v_mul_u32_u24 v30, 20, v11
 v_sub_u32 v30, v10, v30
 v_lshrrev_b32 v30, 2, v30
 v_lshlrev_b32 v11, 17, v11
 v_lshlrev_b32 v31, 4, v9
 v_add3_u32 v11, v11, v31, s48
 v_lshrrev_b32 v31, 2, v30
 v_lshl_add_u32 v11, v31, 10, v11
 v_bfe_u32 v31, v30, 1, 1
 v_lshl_add_u32 v11, v31, 9, v11
 v_and_b32 v31, 1, v30
 v_lshl_add_u32 v11, v31, 3, v11
 v_mul_f32 v32, v29, v20
 v_fma_f32 v32, v28, v104, -v32
 v_mul_f32 v33, v29, v21
 v_fma_f32 v33, v28, v105, -v33
 v_mul_f32 v34, v29, v22
 v_fma_f32 v34, v28, v106, -v34
 v_mul_f32 v35, v29, v23
 v_fma_f32 v35, v28, v107, -v35
 v_cvt_pk_bf16_f32 v36, v32, v33
 v_cvt_pk_bf16_f32 v37, v34, v35
 buffer_store_dwordx2 v[36:37], v11, s[24:27], 0 offen
 s_waitcnt vmcnt(3)
 v_add_u32 v10, 24, v8
 v_mul_u32_u24 v11, 3277, v10
 v_lshrrev_b32 v11, 16, v11
 v_mul_u32_u24 v30, 20, v11
 v_sub_u32 v30, v10, v30
 v_lshrrev_b32 v30, 2, v30
 v_lshlrev_b32 v11, 17, v11
 v_lshlrev_b32 v31, 4, v9
 v_add3_u32 v11, v11, v31, s48
 v_lshrrev_b32 v31, 2, v30
 v_lshl_add_u32 v11, v31, 10, v11
 v_bfe_u32 v31, v30, 1, 1
 v_lshl_add_u32 v11, v31, 9, v11
 v_and_b32 v31, 1, v30
 v_lshl_add_u32 v11, v31, 3, v11
 v_mul_f32 v32, v29, v24
 v_fma_f32 v32, v28, v108, -v32
 v_mul_f32 v33, v29, v25
 v_fma_f32 v33, v28, v109, -v33
 v_mul_f32 v34, v29, v26
 v_fma_f32 v34, v28, v110, -v34
 v_mul_f32 v35, v29, v27
 v_fma_f32 v35, v28, v111, -v35
 v_cvt_pk_bf16_f32 v36, v32, v33
 v_cvt_pk_bf16_f32 v37, v34, v35
 buffer_store_dwordx2 v[36:37], v11, s[24:27], 0 offen
 v_mul_f32 v28, s47, v182
 v_mul_f32 v29, s47, v184
 s_lshl_b32 s48, s32, 1
 s_add_u32 s48, s48, 1
 s_lshl_b32 s48, s48, 11
 v_add_u32 v10, 0, v8
 v_mul_u32_u24 v11, 3277, v10
 v_lshrrev_b32 v11, 16, v11
 v_mul_u32_u24 v30, 20, v11
 v_sub_u32 v30, v10, v30
 v_lshrrev_b32 v30, 2, v30
 v_lshlrev_b32 v11, 17, v11
 v_lshlrev_b32 v31, 4, v9
 v_add3_u32 v11, v11, v31, s48
 v_lshrrev_b32 v31, 2, v30
 v_lshl_add_u32 v11, v31, 10, v11
 v_bfe_u32 v31, v30, 1, 1
 v_lshl_add_u32 v11, v31, 9, v11
 v_and_b32 v31, 1, v30
 v_lshl_add_u32 v11, v31, 3, v11
 v_mul_f32 v32, v29, v12
 v_fma_f32 v32, v28, v112, -v32
 v_mul_f32 v33, v29, v13
 v_fma_f32 v33, v28, v113, -v33
 v_mul_f32 v34, v29, v14
 v_fma_f32 v34, v28, v114, -v34
 v_mul_f32 v35, v29, v15
 v_fma_f32 v35, v28, v115, -v35
 v_cvt_pk_bf16_f32 v36, v32, v33
 v_cvt_pk_bf16_f32 v37, v34, v35
 buffer_store_dwordx2 v[36:37], v11, s[24:27], 0 offen
 v_add_u32 v10, 8, v8
 v_mul_u32_u24 v11, 3277, v10
 v_lshrrev_b32 v11, 16, v11
 v_mul_u32_u24 v30, 20, v11
 v_sub_u32 v30, v10, v30
 v_lshrrev_b32 v30, 2, v30
 v_lshlrev_b32 v11, 17, v11
 v_lshlrev_b32 v31, 4, v9
 v_add3_u32 v11, v11, v31, s48
 v_lshrrev_b32 v31, 2, v30
 v_lshl_add_u32 v11, v31, 10, v11
 v_bfe_u32 v31, v30, 1, 1
 v_lshl_add_u32 v11, v31, 9, v11
 v_and_b32 v31, 1, v30
 v_lshl_add_u32 v11, v31, 3, v11
 v_mul_f32 v32, v29, v16
 v_fma_f32 v32, v28, v116, -v32
 v_mul_f32 v33, v29, v17
 v_fma_f32 v33, v28, v117, -v33
 v_mul_f32 v34, v29, v18
 v_fma_f32 v34, v28, v118, -v34
 v_mul_f32 v35, v29, v19
 v_fma_f32 v35, v28, v119, -v35
 v_cvt_pk_bf16_f32 v36, v32, v33
 v_cvt_pk_bf16_f32 v37, v34, v35
 buffer_store_dwordx2 v[36:37], v11, s[24:27], 0 offen
 v_add_u32 v10, 16, v8
 v_mul_u32_u24 v11, 3277, v10
 v_lshrrev_b32 v11, 16, v11
 v_mul_u32_u24 v30, 20, v11
 v_sub_u32 v30, v10, v30
 v_lshrrev_b32 v30, 2, v30
 v_lshlrev_b32 v11, 17, v11
 v_lshlrev_b32 v31, 4, v9
 v_add3_u32 v11, v11, v31, s48
 v_lshrrev_b32 v31, 2, v30
 v_lshl_add_u32 v11, v31, 10, v11
 v_bfe_u32 v31, v30, 1, 1
 v_lshl_add_u32 v11, v31, 9, v11
 v_and_b32 v31, 1, v30
 v_lshl_add_u32 v11, v31, 3, v11
 v_mul_f32 v32, v29, v20
 v_fma_f32 v32, v28, v120, -v32
 v_mul_f32 v33, v29, v21
 v_fma_f32 v33, v28, v121, -v33
 v_mul_f32 v34, v29, v22
 v_fma_f32 v34, v28, v122, -v34
 v_mul_f32 v35, v29, v23
 v_fma_f32 v35, v28, v123, -v35
 v_cvt_pk_bf16_f32 v36, v32, v33
 v_cvt_pk_bf16_f32 v37, v34, v35
 buffer_store_dwordx2 v[36:37], v11, s[24:27], 0 offen
 v_add_u32 v10, 24, v8
 v_mul_u32_u24 v11, 3277, v10
 v_lshrrev_b32 v11, 16, v11
 v_mul_u32_u24 v30, 20, v11
 v_sub_u32 v30, v10, v30
 v_lshrrev_b32 v30, 2, v30
 v_lshlrev_b32 v11, 17, v11
 v_lshlrev_b32 v31, 4, v9
 v_add3_u32 v11, v11, v31, s48
 v_lshrrev_b32 v31, 2, v30
 v_lshl_add_u32 v11, v31, 10, v11
 v_bfe_u32 v31, v30, 1, 1
 v_lshl_add_u32 v11, v31, 9, v11
 v_and_b32 v31, 1, v30
 v_lshl_add_u32 v11, v31, 3, v11
 v_mul_f32 v32, v29, v24
 v_fma_f32 v32, v28, v124, -v32
 v_mul_f32 v33, v29, v25
 v_fma_f32 v33, v28, v125, -v33
 v_mul_f32 v34, v29, v26
 v_fma_f32 v34, v28, v126, -v34
 v_mul_f32 v35, v29, v27
 v_fma_f32 v35, v28, v127, -v35
 v_cvt_pk_bf16_f32 v36, v32, v33
 v_cvt_pk_bf16_f32 v37, v34, v35
 buffer_store_dwordx2 v[36:37], v11, s[24:27], 0 offen
 s_branch L_b1_3_kernel_end
L_b1_3_kernel_vtype:
 buffer_load_dwordx4 v[128:131], v4, s[12:15], s42 offen
 buffer_load_dwordx4 v[132:135], v4, s[12:15], s43 offen
 s_add_u32 s42, s42, 1024
 s_add_u32 s43, s43, 1024
 buffer_load_dwordx4 v[136:139], v4, s[12:15], s42 offen
 buffer_load_dwordx4 v[140:143], v4, s[12:15], s43 offen
 s_add_u32 s42, s42, 1024
 s_add_u32 s43, s43, 1024
 buffer_load_dwordx4 v[144:147], v4, s[12:15], s42 offen
 buffer_load_dwordx4 v[148:151], v4, s[12:15], s43 offen
 s_add_u32 s42, s42, 1024
 s_add_u32 s43, s43, 1024
 buffer_load_dwordx4 v[152:155], v4, s[12:15], s42 offen
 buffer_load_dwordx4 v[156:159], v4, s[12:15], s43 offen
 s_add_u32 s42, s42, 1024
 s_add_u32 s43, s43, 1024
 ds_read_b128 v[160:163], v5 offset:0
 ds_read_b128 v[164:167], v7 offset:0
 ds_read_b128 v[168:171], v5 offset:32
 ds_read_b128 v[172:175], v7 offset:32
 s_waitcnt vmcnt(6) lgkmcnt(2)
 v_mfma_f32_32x32x16_bf16 v[64:79], v[160:163], v[128:131], v[64:79]
 v_mfma_f32_32x32x16_bf16 v[80:95], v[164:167], v[128:131], v[80:95]
 v_mfma_f32_32x32x16_bf16 v[96:111], v[160:163], v[132:135], v[96:111]
 v_mfma_f32_32x32x16_bf16 v[112:127], v[164:167], v[132:135], v[112:127]
 v_dot2c_f32_bf16 v176, v160, v180
 v_dot2c_f32_bf16 v178, v160, v160
 v_dot2c_f32_bf16 v176, v161, v180
 v_dot2c_f32_bf16 v178, v161, v161
 v_dot2c_f32_bf16 v176, v162, v180
 v_dot2c_f32_bf16 v178, v162, v162
 v_dot2c_f32_bf16 v176, v163, v180
 v_dot2c_f32_bf16 v178, v163, v163
 v_dot2c_f32_bf16 v177, v164, v180
 v_dot2c_f32_bf16 v179, v164, v164
 v_dot2c_f32_bf16 v177, v165, v180
 v_dot2c_f32_bf16 v179, v165, v165
 v_dot2c_f32_bf16 v177, v166, v180
 v_dot2c_f32_bf16 v179, v166, v166
 v_dot2c_f32_bf16 v177, v167, v180
 v_dot2c_f32_bf16 v179, v167, v167
 buffer_load_dwordx4 v[128:131], v4, s[12:15], s42 offen
 buffer_load_dwordx4 v[132:135], v4, s[12:15], s43 offen
 s_add_u32 s42, s42, 1024
 s_add_u32 s43, s43, 1024
 ds_read_b128 v[160:163], v5 offset:64
 ds_read_b128 v[164:167], v7 offset:64
 s_waitcnt vmcnt(6) lgkmcnt(2)
 v_mfma_f32_32x32x16_bf16 v[64:79], v[168:171], v[136:139], v[64:79]
 v_mfma_f32_32x32x16_bf16 v[80:95], v[172:175], v[136:139], v[80:95]
 v_mfma_f32_32x32x16_bf16 v[96:111], v[168:171], v[140:143], v[96:111]
 v_mfma_f32_32x32x16_bf16 v[112:127], v[172:175], v[140:143], v[112:127]
 v_dot2c_f32_bf16 v176, v168, v180
 v_dot2c_f32_bf16 v178, v168, v168
 v_dot2c_f32_bf16 v176, v169, v180
 v_dot2c_f32_bf16 v178, v169, v169
 v_dot2c_f32_bf16 v176, v170, v180
 v_dot2c_f32_bf16 v178, v170, v170
 v_dot2c_f32_bf16 v176, v171, v180
 v_dot2c_f32_bf16 v178, v171, v171
 v_dot2c_f32_bf16 v177, v172, v180
 v_dot2c_f32_bf16 v179, v172, v172
 v_dot2c_f32_bf16 v177, v173, v180
 v_dot2c_f32_bf16 v179, v173, v173
 v_dot2c_f32_bf16 v177, v174, v180
 v_dot2c_f32_bf16 v179, v174, v174
 v_dot2c_f32_bf16 v177, v175, v180
 v_dot2c_f32_bf16 v179, v175, v175
 buffer_load_dwordx4 v[136:139], v4, s[12:15], s42 offen
 buffer_load_dwordx4 v[140:143], v4, s[12:15], s43 offen
 s_add_u32 s42, s42, 1024
 s_add_u32 s43, s43, 1024
 ds_read_b128 v[168:171], v5 offset:96
 ds_read_b128 v[172:175], v7 offset:96
 s_waitcnt vmcnt(6) lgkmcnt(2)
 v_mfma_f32_32x32x16_bf16 v[64:79], v[160:163], v[144:147], v[64:79]
 v_mfma_f32_32x32x16_bf16 v[80:95], v[164:167], v[144:147], v[80:95]
 v_mfma_f32_32x32x16_bf16 v[96:111], v[160:163], v[148:151], v[96:111]
 v_mfma_f32_32x32x16_bf16 v[112:127], v[164:167], v[148:151], v[112:127]
 v_dot2c_f32_bf16 v176, v160, v180
 v_dot2c_f32_bf16 v178, v160, v160
 v_dot2c_f32_bf16 v176, v161, v180
 v_dot2c_f32_bf16 v178, v161, v161
 v_dot2c_f32_bf16 v176, v162, v180
 v_dot2c_f32_bf16 v178, v162, v162
 v_dot2c_f32_bf16 v176, v163, v180
 v_dot2c_f32_bf16 v178, v163, v163
 v_dot2c_f32_bf16 v177, v164, v180
 v_dot2c_f32_bf16 v179, v164, v164
 v_dot2c_f32_bf16 v177, v165, v180
 v_dot2c_f32_bf16 v179, v165, v165
 v_dot2c_f32_bf16 v177, v166, v180
 v_dot2c_f32_bf16 v179, v166, v166
 v_dot2c_f32_bf16 v177, v167, v180
 v_dot2c_f32_bf16 v179, v167, v167
 buffer_load_dwordx4 v[144:147], v4, s[12:15], s42 offen
 buffer_load_dwordx4 v[148:151], v4, s[12:15], s43 offen
 s_add_u32 s42, s42, 1024
 s_add_u32 s43, s43, 1024
 ds_read_b128 v[160:163], v5 offset:128
 ds_read_b128 v[164:167], v7 offset:128
 s_waitcnt vmcnt(6) lgkmcnt(2)
 v_mfma_f32_32x32x16_bf16 v[64:79], v[168:171], v[152:155], v[64:79]
 v_mfma_f32_32x32x16_bf16 v[80:95], v[172:175], v[152:155], v[80:95]
 v_mfma_f32_32x32x16_bf16 v[96:111], v[168:171], v[156:159], v[96:111]
 v_mfma_f32_32x32x16_bf16 v[112:127], v[172:175], v[156:159], v[112:127]
 v_dot2c_f32_bf16 v176, v168, v180
 v_dot2c_f32_bf16 v178, v168, v168
 v_dot2c_f32_bf16 v176, v169, v180
 v_dot2c_f32_bf16 v178, v169, v169
 v_dot2c_f32_bf16 v176, v170, v180
 v_dot2c_f32_bf16 v178, v170, v170
 v_dot2c_f32_bf16 v176, v171, v180
 v_dot2c_f32_bf16 v178, v171, v171
 v_dot2c_f32_bf16 v177, v172, v180
 v_dot2c_f32_bf16 v179, v172, v172
 v_dot2c_f32_bf16 v177, v173, v180
 v_dot2c_f32_bf16 v179, v173, v173
 v_dot2c_f32_bf16 v177, v174, v180
 v_dot2c_f32_bf16 v179, v174, v174
 v_dot2c_f32_bf16 v177, v175, v180
 v_dot2c_f32_bf16 v179, v175, v175
 buffer_load_dwordx4 v[152:155], v4, s[12:15], s42 offen
 buffer_load_dwordx4 v[156:159], v4, s[12:15], s43 offen
 s_add_u32 s42, s42, 1024
 s_add_u32 s43, s43, 1024
 ds_read_b128 v[168:171], v5 offset:160
 ds_read_b128 v[172:175], v7 offset:160
 s_waitcnt vmcnt(6) lgkmcnt(2)
 v_mfma_f32_32x32x16_bf16 v[64:79], v[160:163], v[128:131], v[64:79]
 v_mfma_f32_32x32x16_bf16 v[80:95], v[164:167], v[128:131], v[80:95]
 v_mfma_f32_32x32x16_bf16 v[96:111], v[160:163], v[132:135], v[96:111]
 v_mfma_f32_32x32x16_bf16 v[112:127], v[164:167], v[132:135], v[112:127]
 v_dot2c_f32_bf16 v176, v160, v180
 v_dot2c_f32_bf16 v178, v160, v160
 v_dot2c_f32_bf16 v176, v161, v180
 v_dot2c_f32_bf16 v178, v161, v161
 v_dot2c_f32_bf16 v176, v162, v180
 v_dot2c_f32_bf16 v178, v162, v162
 v_dot2c_f32_bf16 v176, v163, v180
 v_dot2c_f32_bf16 v178, v163, v163
 v_dot2c_f32_bf16 v177, v164, v180
 v_dot2c_f32_bf16 v179, v164, v164
 v_dot2c_f32_bf16 v177, v165, v180
 v_dot2c_f32_bf16 v179, v165, v165
 v_dot2c_f32_bf16 v177, v166, v180
 v_dot2c_f32_bf16 v179, v166, v166
 v_dot2c_f32_bf16 v177, v167, v180
 v_dot2c_f32_bf16 v179, v167, v167
 buffer_load_dwordx4 v[128:131], v4, s[12:15], s42 offen
 buffer_load_dwordx4 v[132:135], v4, s[12:15], s43 offen
 s_add_u32 s42, s42, 1024
 s_add_u32 s43, s43, 1024
 ds_read_b128 v[160:163], v5 offset:192
 ds_read_b128 v[164:167], v7 offset:192
 s_waitcnt vmcnt(6) lgkmcnt(2)
 v_mfma_f32_32x32x16_bf16 v[64:79], v[168:171], v[136:139], v[64:79]
 v_mfma_f32_32x32x16_bf16 v[80:95], v[172:175], v[136:139], v[80:95]
 v_mfma_f32_32x32x16_bf16 v[96:111], v[168:171], v[140:143], v[96:111]
 v_mfma_f32_32x32x16_bf16 v[112:127], v[172:175], v[140:143], v[112:127]
 v_dot2c_f32_bf16 v176, v168, v180
 v_dot2c_f32_bf16 v178, v168, v168
 v_dot2c_f32_bf16 v176, v169, v180
 v_dot2c_f32_bf16 v178, v169, v169
 v_dot2c_f32_bf16 v176, v170, v180
 v_dot2c_f32_bf16 v178, v170, v170
 v_dot2c_f32_bf16 v176, v171, v180
 v_dot2c_f32_bf16 v178, v171, v171
 v_dot2c_f32_bf16 v177, v172, v180
 v_dot2c_f32_bf16 v179, v172, v172
 v_dot2c_f32_bf16 v177, v173, v180
 v_dot2c_f32_bf16 v179, v173, v173
 v_dot2c_f32_bf16 v177, v174, v180
 v_dot2c_f32_bf16 v179, v174, v174
 v_dot2c_f32_bf16 v177, v175, v180
 v_dot2c_f32_bf16 v179, v175, v175
 buffer_load_dwordx4 v[136:139], v4, s[12:15], s42 offen
 buffer_load_dwordx4 v[140:143], v4, s[12:15], s43 offen
 s_add_u32 s42, s42, 1024
 s_add_u32 s43, s43, 1024
 ds_read_b128 v[168:171], v5 offset:224
 ds_read_b128 v[172:175], v7 offset:224
 s_waitcnt vmcnt(6) lgkmcnt(2)
 v_mfma_f32_32x32x16_bf16 v[64:79], v[160:163], v[144:147], v[64:79]
 v_mfma_f32_32x32x16_bf16 v[80:95], v[164:167], v[144:147], v[80:95]
 v_mfma_f32_32x32x16_bf16 v[96:111], v[160:163], v[148:151], v[96:111]
 v_mfma_f32_32x32x16_bf16 v[112:127], v[164:167], v[148:151], v[112:127]
 v_dot2c_f32_bf16 v176, v160, v180
 v_dot2c_f32_bf16 v178, v160, v160
 v_dot2c_f32_bf16 v176, v161, v180
 v_dot2c_f32_bf16 v178, v161, v161
 v_dot2c_f32_bf16 v176, v162, v180
 v_dot2c_f32_bf16 v178, v162, v162
 v_dot2c_f32_bf16 v176, v163, v180
 v_dot2c_f32_bf16 v178, v163, v163
 v_dot2c_f32_bf16 v177, v164, v180
 v_dot2c_f32_bf16 v179, v164, v164
 v_dot2c_f32_bf16 v177, v165, v180
 v_dot2c_f32_bf16 v179, v165, v165
 v_dot2c_f32_bf16 v177, v166, v180
 v_dot2c_f32_bf16 v179, v166, v166
 v_dot2c_f32_bf16 v177, v167, v180
 v_dot2c_f32_bf16 v179, v167, v167
 buffer_load_dwordx4 v[144:147], v4, s[12:15], s42 offen
 buffer_load_dwordx4 v[148:151], v4, s[12:15], s43 offen
 s_add_u32 s42, s42, 1024
 s_add_u32 s43, s43, 1024
 ds_read_b128 v[160:163], v5 offset:256
 ds_read_b128 v[164:167], v7 offset:256
 s_waitcnt vmcnt(6) lgkmcnt(2)
 v_mfma_f32_32x32x16_bf16 v[64:79], v[168:171], v[152:155], v[64:79]
 v_mfma_f32_32x32x16_bf16 v[80:95], v[172:175], v[152:155], v[80:95]
 v_mfma_f32_32x32x16_bf16 v[96:111], v[168:171], v[156:159], v[96:111]
 v_mfma_f32_32x32x16_bf16 v[112:127], v[172:175], v[156:159], v[112:127]
 v_dot2c_f32_bf16 v176, v168, v180
 v_dot2c_f32_bf16 v178, v168, v168
 v_dot2c_f32_bf16 v176, v169, v180
 v_dot2c_f32_bf16 v178, v169, v169
 v_dot2c_f32_bf16 v176, v170, v180
 v_dot2c_f32_bf16 v178, v170, v170
 v_dot2c_f32_bf16 v176, v171, v180
 v_dot2c_f32_bf16 v178, v171, v171
 v_dot2c_f32_bf16 v177, v172, v180
 v_dot2c_f32_bf16 v179, v172, v172
 v_dot2c_f32_bf16 v177, v173, v180
 v_dot2c_f32_bf16 v179, v173, v173
 v_dot2c_f32_bf16 v177, v174, v180
 v_dot2c_f32_bf16 v179, v174, v174
 v_dot2c_f32_bf16 v177, v175, v180
 v_dot2c_f32_bf16 v179, v175, v175
 buffer_load_dwordx4 v[152:155], v4, s[12:15], s42 offen
 buffer_load_dwordx4 v[156:159], v4, s[12:15], s43 offen
 s_add_u32 s42, s42, 1024
 s_add_u32 s43, s43, 1024
 ds_read_b128 v[168:171], v5 offset:288
 ds_read_b128 v[172:175], v7 offset:288
 s_waitcnt vmcnt(6) lgkmcnt(2)
 v_mfma_f32_32x32x16_bf16 v[64:79], v[160:163], v[128:131], v[64:79]
 v_mfma_f32_32x32x16_bf16 v[80:95], v[164:167], v[128:131], v[80:95]
 v_mfma_f32_32x32x16_bf16 v[96:111], v[160:163], v[132:135], v[96:111]
 v_mfma_f32_32x32x16_bf16 v[112:127], v[164:167], v[132:135], v[112:127]
 v_dot2c_f32_bf16 v176, v160, v180
 v_dot2c_f32_bf16 v178, v160, v160
 v_dot2c_f32_bf16 v176, v161, v180
 v_dot2c_f32_bf16 v178, v161, v161
 v_dot2c_f32_bf16 v176, v162, v180
 v_dot2c_f32_bf16 v178, v162, v162
 v_dot2c_f32_bf16 v176, v163, v180
 v_dot2c_f32_bf16 v178, v163, v163
 v_dot2c_f32_bf16 v177, v164, v180
 v_dot2c_f32_bf16 v179, v164, v164
 v_dot2c_f32_bf16 v177, v165, v180
 v_dot2c_f32_bf16 v179, v165, v165
 v_dot2c_f32_bf16 v177, v166, v180
 v_dot2c_f32_bf16 v179, v166, v166
 v_dot2c_f32_bf16 v177, v167, v180
 v_dot2c_f32_bf16 v179, v167, v167
 buffer_load_dwordx4 v[128:131], v4, s[12:15], s42 offen
 buffer_load_dwordx4 v[132:135], v4, s[12:15], s43 offen
 s_add_u32 s42, s42, 1024
 s_add_u32 s43, s43, 1024
 ds_read_b128 v[160:163], v5 offset:320
 ds_read_b128 v[164:167], v7 offset:320
 s_waitcnt vmcnt(6) lgkmcnt(2)
 v_mfma_f32_32x32x16_bf16 v[64:79], v[168:171], v[136:139], v[64:79]
 v_mfma_f32_32x32x16_bf16 v[80:95], v[172:175], v[136:139], v[80:95]
 v_mfma_f32_32x32x16_bf16 v[96:111], v[168:171], v[140:143], v[96:111]
 v_mfma_f32_32x32x16_bf16 v[112:127], v[172:175], v[140:143], v[112:127]
 v_dot2c_f32_bf16 v176, v168, v180
 v_dot2c_f32_bf16 v178, v168, v168
 v_dot2c_f32_bf16 v176, v169, v180
 v_dot2c_f32_bf16 v178, v169, v169
 v_dot2c_f32_bf16 v176, v170, v180
 v_dot2c_f32_bf16 v178, v170, v170
 v_dot2c_f32_bf16 v176, v171, v180
 v_dot2c_f32_bf16 v178, v171, v171
 v_dot2c_f32_bf16 v177, v172, v180
 v_dot2c_f32_bf16 v179, v172, v172
 v_dot2c_f32_bf16 v177, v173, v180
 v_dot2c_f32_bf16 v179, v173, v173
 v_dot2c_f32_bf16 v177, v174, v180
 v_dot2c_f32_bf16 v179, v174, v174
 v_dot2c_f32_bf16 v177, v175, v180
 v_dot2c_f32_bf16 v179, v175, v175
 buffer_load_dwordx4 v[136:139], v4, s[12:15], s42 offen
 buffer_load_dwordx4 v[140:143], v4, s[12:15], s43 offen
 s_add_u32 s42, s42, 1024
 s_add_u32 s43, s43, 1024
 ds_read_b128 v[168:171], v5 offset:352
 ds_read_b128 v[172:175], v7 offset:352
 s_waitcnt vmcnt(6) lgkmcnt(2)
 v_mfma_f32_32x32x16_bf16 v[64:79], v[160:163], v[144:147], v[64:79]
 v_mfma_f32_32x32x16_bf16 v[80:95], v[164:167], v[144:147], v[80:95]
 v_mfma_f32_32x32x16_bf16 v[96:111], v[160:163], v[148:151], v[96:111]
 v_mfma_f32_32x32x16_bf16 v[112:127], v[164:167], v[148:151], v[112:127]
 v_dot2c_f32_bf16 v176, v160, v180
 v_dot2c_f32_bf16 v178, v160, v160
 v_dot2c_f32_bf16 v176, v161, v180
 v_dot2c_f32_bf16 v178, v161, v161
 v_dot2c_f32_bf16 v176, v162, v180
 v_dot2c_f32_bf16 v178, v162, v162
 v_dot2c_f32_bf16 v176, v163, v180
 v_dot2c_f32_bf16 v178, v163, v163
 v_dot2c_f32_bf16 v177, v164, v180
 v_dot2c_f32_bf16 v179, v164, v164
 v_dot2c_f32_bf16 v177, v165, v180
 v_dot2c_f32_bf16 v179, v165, v165
 v_dot2c_f32_bf16 v177, v166, v180
 v_dot2c_f32_bf16 v179, v166, v166
 v_dot2c_f32_bf16 v177, v167, v180
 v_dot2c_f32_bf16 v179, v167, v167
 buffer_load_dwordx4 v[144:147], v4, s[12:15], s42 offen
 buffer_load_dwordx4 v[148:151], v4, s[12:15], s43 offen
 s_add_u32 s42, s42, 1024
 s_add_u32 s43, s43, 1024
 ds_read_b128 v[160:163], v5 offset:384
 ds_read_b128 v[164:167], v7 offset:384
 s_waitcnt vmcnt(6) lgkmcnt(2)
 v_mfma_f32_32x32x16_bf16 v[64:79], v[168:171], v[152:155], v[64:79]
 v_mfma_f32_32x32x16_bf16 v[80:95], v[172:175], v[152:155], v[80:95]
 v_mfma_f32_32x32x16_bf16 v[96:111], v[168:171], v[156:159], v[96:111]
 v_mfma_f32_32x32x16_bf16 v[112:127], v[172:175], v[156:159], v[112:127]
 v_dot2c_f32_bf16 v176, v168, v180
 v_dot2c_f32_bf16 v178, v168, v168
 v_dot2c_f32_bf16 v176, v169, v180
 v_dot2c_f32_bf16 v178, v169, v169
 v_dot2c_f32_bf16 v176, v170, v180
 v_dot2c_f32_bf16 v178, v170, v170
 v_dot2c_f32_bf16 v176, v171, v180
 v_dot2c_f32_bf16 v178, v171, v171
 v_dot2c_f32_bf16 v177, v172, v180
 v_dot2c_f32_bf16 v179, v172, v172
 v_dot2c_f32_bf16 v177, v173, v180
 v_dot2c_f32_bf16 v179, v173, v173
 v_dot2c_f32_bf16 v177, v174, v180
 v_dot2c_f32_bf16 v179, v174, v174
 v_dot2c_f32_bf16 v177, v175, v180
 v_dot2c_f32_bf16 v179, v175, v175
 buffer_load_dwordx4 v[152:155], v4, s[12:15], s42 offen
 buffer_load_dwordx4 v[156:159], v4, s[12:15], s43 offen
 s_add_u32 s42, s42, 1024
 s_add_u32 s43, s43, 1024
 ds_read_b128 v[168:171], v5 offset:416
 ds_read_b128 v[172:175], v7 offset:416
 s_waitcnt vmcnt(6) lgkmcnt(2)
 v_mfma_f32_32x32x16_bf16 v[64:79], v[160:163], v[128:131], v[64:79]
 v_mfma_f32_32x32x16_bf16 v[80:95], v[164:167], v[128:131], v[80:95]
 v_mfma_f32_32x32x16_bf16 v[96:111], v[160:163], v[132:135], v[96:111]
 v_mfma_f32_32x32x16_bf16 v[112:127], v[164:167], v[132:135], v[112:127]
 v_dot2c_f32_bf16 v176, v160, v180
 v_dot2c_f32_bf16 v178, v160, v160
 v_dot2c_f32_bf16 v176, v161, v180
 v_dot2c_f32_bf16 v178, v161, v161
 v_dot2c_f32_bf16 v176, v162, v180
 v_dot2c_f32_bf16 v178, v162, v162
 v_dot2c_f32_bf16 v176, v163, v180
 v_dot2c_f32_bf16 v178, v163, v163
 v_dot2c_f32_bf16 v177, v164, v180
 v_dot2c_f32_bf16 v179, v164, v164
 v_dot2c_f32_bf16 v177, v165, v180
 v_dot2c_f32_bf16 v179, v165, v165
 v_dot2c_f32_bf16 v177, v166, v180
 v_dot2c_f32_bf16 v179, v166, v166
 v_dot2c_f32_bf16 v177, v167, v180
 v_dot2c_f32_bf16 v179, v167, v167
 buffer_load_dwordx4 v[128:131], v4, s[12:15], s42 offen
 buffer_load_dwordx4 v[132:135], v4, s[12:15], s43 offen
 s_add_u32 s42, s42, 1024
 s_add_u32 s43, s43, 1024
 ds_read_b128 v[160:163], v5 offset:448
 ds_read_b128 v[164:167], v7 offset:448
 s_waitcnt vmcnt(6) lgkmcnt(2)
 v_mfma_f32_32x32x16_bf16 v[64:79], v[168:171], v[136:139], v[64:79]
 v_mfma_f32_32x32x16_bf16 v[80:95], v[172:175], v[136:139], v[80:95]
 v_mfma_f32_32x32x16_bf16 v[96:111], v[168:171], v[140:143], v[96:111]
 v_mfma_f32_32x32x16_bf16 v[112:127], v[172:175], v[140:143], v[112:127]
 v_dot2c_f32_bf16 v176, v168, v180
 v_dot2c_f32_bf16 v178, v168, v168
 v_dot2c_f32_bf16 v176, v169, v180
 v_dot2c_f32_bf16 v178, v169, v169
 v_dot2c_f32_bf16 v176, v170, v180
 v_dot2c_f32_bf16 v178, v170, v170
 v_dot2c_f32_bf16 v176, v171, v180
 v_dot2c_f32_bf16 v178, v171, v171
 v_dot2c_f32_bf16 v177, v172, v180
 v_dot2c_f32_bf16 v179, v172, v172
 v_dot2c_f32_bf16 v177, v173, v180
 v_dot2c_f32_bf16 v179, v173, v173
 v_dot2c_f32_bf16 v177, v174, v180
 v_dot2c_f32_bf16 v179, v174, v174
 v_dot2c_f32_bf16 v177, v175, v180
 v_dot2c_f32_bf16 v179, v175, v175
 buffer_load_dwordx4 v[136:139], v4, s[12:15], s42 offen
 buffer_load_dwordx4 v[140:143], v4, s[12:15], s43 offen
 s_add_u32 s42, s42, 1024
 s_add_u32 s43, s43, 1024
 ds_read_b128 v[168:171], v5 offset:480
 ds_read_b128 v[172:175], v7 offset:480
 s_waitcnt vmcnt(6) lgkmcnt(2)
 v_mfma_f32_32x32x16_bf16 v[64:79], v[160:163], v[144:147], v[64:79]
 v_mfma_f32_32x32x16_bf16 v[80:95], v[164:167], v[144:147], v[80:95]
 v_mfma_f32_32x32x16_bf16 v[96:111], v[160:163], v[148:151], v[96:111]
 v_mfma_f32_32x32x16_bf16 v[112:127], v[164:167], v[148:151], v[112:127]
 v_dot2c_f32_bf16 v176, v160, v180
 v_dot2c_f32_bf16 v178, v160, v160
 v_dot2c_f32_bf16 v176, v161, v180
 v_dot2c_f32_bf16 v178, v161, v161
 v_dot2c_f32_bf16 v176, v162, v180
 v_dot2c_f32_bf16 v178, v162, v162
 v_dot2c_f32_bf16 v176, v163, v180
 v_dot2c_f32_bf16 v178, v163, v163
 v_dot2c_f32_bf16 v177, v164, v180
 v_dot2c_f32_bf16 v179, v164, v164
 v_dot2c_f32_bf16 v177, v165, v180
 v_dot2c_f32_bf16 v179, v165, v165
 v_dot2c_f32_bf16 v177, v166, v180
 v_dot2c_f32_bf16 v179, v166, v166
 v_dot2c_f32_bf16 v177, v167, v180
 v_dot2c_f32_bf16 v179, v167, v167
 buffer_load_dwordx4 v[144:147], v4, s[12:15], s42 offen
 buffer_load_dwordx4 v[148:151], v4, s[12:15], s43 offen
 s_add_u32 s42, s42, 1024
 s_add_u32 s43, s43, 1024
 ds_read_b128 v[160:163], v5 offset:512
 ds_read_b128 v[164:167], v7 offset:512
 s_waitcnt vmcnt(6) lgkmcnt(2)
 v_mfma_f32_32x32x16_bf16 v[64:79], v[168:171], v[152:155], v[64:79]
 v_mfma_f32_32x32x16_bf16 v[80:95], v[172:175], v[152:155], v[80:95]
 v_mfma_f32_32x32x16_bf16 v[96:111], v[168:171], v[156:159], v[96:111]
 v_mfma_f32_32x32x16_bf16 v[112:127], v[172:175], v[156:159], v[112:127]
 v_dot2c_f32_bf16 v176, v168, v180
 v_dot2c_f32_bf16 v178, v168, v168
 v_dot2c_f32_bf16 v176, v169, v180
 v_dot2c_f32_bf16 v178, v169, v169
 v_dot2c_f32_bf16 v176, v170, v180
 v_dot2c_f32_bf16 v178, v170, v170
 v_dot2c_f32_bf16 v176, v171, v180
 v_dot2c_f32_bf16 v178, v171, v171
 v_dot2c_f32_bf16 v177, v172, v180
 v_dot2c_f32_bf16 v179, v172, v172
 v_dot2c_f32_bf16 v177, v173, v180
 v_dot2c_f32_bf16 v179, v173, v173
 v_dot2c_f32_bf16 v177, v174, v180
 v_dot2c_f32_bf16 v179, v174, v174
 v_dot2c_f32_bf16 v177, v175, v180
 v_dot2c_f32_bf16 v179, v175, v175
 buffer_load_dwordx4 v[152:155], v4, s[12:15], s42 offen
 buffer_load_dwordx4 v[156:159], v4, s[12:15], s43 offen
 s_add_u32 s42, s42, 1024
 s_add_u32 s43, s43, 1024
 ds_read_b128 v[168:171], v5 offset:544
 ds_read_b128 v[172:175], v7 offset:544
 s_waitcnt vmcnt(6) lgkmcnt(2)
 v_mfma_f32_32x32x16_bf16 v[64:79], v[160:163], v[128:131], v[64:79]
 v_mfma_f32_32x32x16_bf16 v[80:95], v[164:167], v[128:131], v[80:95]
 v_mfma_f32_32x32x16_bf16 v[96:111], v[160:163], v[132:135], v[96:111]
 v_mfma_f32_32x32x16_bf16 v[112:127], v[164:167], v[132:135], v[112:127]
 v_dot2c_f32_bf16 v176, v160, v180
 v_dot2c_f32_bf16 v178, v160, v160
 v_dot2c_f32_bf16 v176, v161, v180
 v_dot2c_f32_bf16 v178, v161, v161
 v_dot2c_f32_bf16 v176, v162, v180
 v_dot2c_f32_bf16 v178, v162, v162
 v_dot2c_f32_bf16 v176, v163, v180
 v_dot2c_f32_bf16 v178, v163, v163
 v_dot2c_f32_bf16 v177, v164, v180
 v_dot2c_f32_bf16 v179, v164, v164
 v_dot2c_f32_bf16 v177, v165, v180
 v_dot2c_f32_bf16 v179, v165, v165
 v_dot2c_f32_bf16 v177, v166, v180
 v_dot2c_f32_bf16 v179, v166, v166
 v_dot2c_f32_bf16 v177, v167, v180
 v_dot2c_f32_bf16 v179, v167, v167
 buffer_load_dwordx4 v[128:131], v4, s[12:15], s42 offen
 buffer_load_dwordx4 v[132:135], v4, s[12:15], s43 offen
 s_add_u32 s42, s42, 1024
 s_add_u32 s43, s43, 1024
 ds_read_b128 v[160:163], v5 offset:576
 ds_read_b128 v[164:167], v7 offset:576
 s_waitcnt vmcnt(6) lgkmcnt(2)
 v_mfma_f32_32x32x16_bf16 v[64:79], v[168:171], v[136:139], v[64:79]
 v_mfma_f32_32x32x16_bf16 v[80:95], v[172:175], v[136:139], v[80:95]
 v_mfma_f32_32x32x16_bf16 v[96:111], v[168:171], v[140:143], v[96:111]
 v_mfma_f32_32x32x16_bf16 v[112:127], v[172:175], v[140:143], v[112:127]
 v_dot2c_f32_bf16 v176, v168, v180
 v_dot2c_f32_bf16 v178, v168, v168
 v_dot2c_f32_bf16 v176, v169, v180
 v_dot2c_f32_bf16 v178, v169, v169
 v_dot2c_f32_bf16 v176, v170, v180
 v_dot2c_f32_bf16 v178, v170, v170
 v_dot2c_f32_bf16 v176, v171, v180
 v_dot2c_f32_bf16 v178, v171, v171
 v_dot2c_f32_bf16 v177, v172, v180
 v_dot2c_f32_bf16 v179, v172, v172
 v_dot2c_f32_bf16 v177, v173, v180
 v_dot2c_f32_bf16 v179, v173, v173
 v_dot2c_f32_bf16 v177, v174, v180
 v_dot2c_f32_bf16 v179, v174, v174
 v_dot2c_f32_bf16 v177, v175, v180
 v_dot2c_f32_bf16 v179, v175, v175
 buffer_load_dwordx4 v[136:139], v4, s[12:15], s42 offen
 buffer_load_dwordx4 v[140:143], v4, s[12:15], s43 offen
 s_add_u32 s42, s42, 1024
 s_add_u32 s43, s43, 1024
 ds_read_b128 v[168:171], v5 offset:608
 ds_read_b128 v[172:175], v7 offset:608
 s_waitcnt vmcnt(6) lgkmcnt(2)
 v_mfma_f32_32x32x16_bf16 v[64:79], v[160:163], v[144:147], v[64:79]
 v_mfma_f32_32x32x16_bf16 v[80:95], v[164:167], v[144:147], v[80:95]
 v_mfma_f32_32x32x16_bf16 v[96:111], v[160:163], v[148:151], v[96:111]
 v_mfma_f32_32x32x16_bf16 v[112:127], v[164:167], v[148:151], v[112:127]
 v_dot2c_f32_bf16 v176, v160, v180
 v_dot2c_f32_bf16 v178, v160, v160
 v_dot2c_f32_bf16 v176, v161, v180
 v_dot2c_f32_bf16 v178, v161, v161
 v_dot2c_f32_bf16 v176, v162, v180
 v_dot2c_f32_bf16 v178, v162, v162
 v_dot2c_f32_bf16 v176, v163, v180
 v_dot2c_f32_bf16 v178, v163, v163
 v_dot2c_f32_bf16 v177, v164, v180
 v_dot2c_f32_bf16 v179, v164, v164
 v_dot2c_f32_bf16 v177, v165, v180
 v_dot2c_f32_bf16 v179, v165, v165
 v_dot2c_f32_bf16 v177, v166, v180
 v_dot2c_f32_bf16 v179, v166, v166
 v_dot2c_f32_bf16 v177, v167, v180
 v_dot2c_f32_bf16 v179, v167, v167
 buffer_load_dwordx4 v[144:147], v4, s[12:15], s42 offen
 buffer_load_dwordx4 v[148:151], v4, s[12:15], s43 offen
 s_add_u32 s42, s42, 1024
 s_add_u32 s43, s43, 1024
 ds_read_b128 v[160:163], v5 offset:640
 ds_read_b128 v[164:167], v7 offset:640
 s_waitcnt vmcnt(6) lgkmcnt(2)
 v_mfma_f32_32x32x16_bf16 v[64:79], v[168:171], v[152:155], v[64:79]
 v_mfma_f32_32x32x16_bf16 v[80:95], v[172:175], v[152:155], v[80:95]
 v_mfma_f32_32x32x16_bf16 v[96:111], v[168:171], v[156:159], v[96:111]
 v_mfma_f32_32x32x16_bf16 v[112:127], v[172:175], v[156:159], v[112:127]
 v_dot2c_f32_bf16 v176, v168, v180
 v_dot2c_f32_bf16 v178, v168, v168
 v_dot2c_f32_bf16 v176, v169, v180
 v_dot2c_f32_bf16 v178, v169, v169
 v_dot2c_f32_bf16 v176, v170, v180
 v_dot2c_f32_bf16 v178, v170, v170
 v_dot2c_f32_bf16 v176, v171, v180
 v_dot2c_f32_bf16 v178, v171, v171
 v_dot2c_f32_bf16 v177, v172, v180
 v_dot2c_f32_bf16 v179, v172, v172
 v_dot2c_f32_bf16 v177, v173, v180
 v_dot2c_f32_bf16 v179, v173, v173
 v_dot2c_f32_bf16 v177, v174, v180
 v_dot2c_f32_bf16 v179, v174, v174
 v_dot2c_f32_bf16 v177, v175, v180
 v_dot2c_f32_bf16 v179, v175, v175
 buffer_load_dwordx4 v[152:155], v4, s[12:15], s42 offen
 buffer_load_dwordx4 v[156:159], v4, s[12:15], s43 offen
 s_add_u32 s42, s42, 1024
 s_add_u32 s43, s43, 1024
 ds_read_b128 v[168:171], v5 offset:672
 ds_read_b128 v[172:175], v7 offset:672
 s_waitcnt vmcnt(6) lgkmcnt(2)
 v_mfma_f32_32x32x16_bf16 v[64:79], v[160:163], v[128:131], v[64:79]
 v_mfma_f32_32x32x16_bf16 v[80:95], v[164:167], v[128:131], v[80:95]
 v_mfma_f32_32x32x16_bf16 v[96:111], v[160:163], v[132:135], v[96:111]
 v_mfma_f32_32x32x16_bf16 v[112:127], v[164:167], v[132:135], v[112:127]
 v_dot2c_f32_bf16 v176, v160, v180
 v_dot2c_f32_bf16 v178, v160, v160
 v_dot2c_f32_bf16 v176, v161, v180
 v_dot2c_f32_bf16 v178, v161, v161
 v_dot2c_f32_bf16 v176, v162, v180
 v_dot2c_f32_bf16 v178, v162, v162
 v_dot2c_f32_bf16 v176, v163, v180
 v_dot2c_f32_bf16 v178, v163, v163
 v_dot2c_f32_bf16 v177, v164, v180
 v_dot2c_f32_bf16 v179, v164, v164
 v_dot2c_f32_bf16 v177, v165, v180
 v_dot2c_f32_bf16 v179, v165, v165
 v_dot2c_f32_bf16 v177, v166, v180
 v_dot2c_f32_bf16 v179, v166, v166
 v_dot2c_f32_bf16 v177, v167, v180
 v_dot2c_f32_bf16 v179, v167, v167
 buffer_load_dwordx4 v[128:131], v4, s[12:15], s42 offen
 buffer_load_dwordx4 v[132:135], v4, s[12:15], s43 offen
 s_add_u32 s42, s42, 1024
 s_add_u32 s43, s43, 1024
 ds_read_b128 v[160:163], v5 offset:704
 ds_read_b128 v[164:167], v7 offset:704
 s_waitcnt vmcnt(6) lgkmcnt(2)
 v_mfma_f32_32x32x16_bf16 v[64:79], v[168:171], v[136:139], v[64:79]
 v_mfma_f32_32x32x16_bf16 v[80:95], v[172:175], v[136:139], v[80:95]
 v_mfma_f32_32x32x16_bf16 v[96:111], v[168:171], v[140:143], v[96:111]
 v_mfma_f32_32x32x16_bf16 v[112:127], v[172:175], v[140:143], v[112:127]
 v_dot2c_f32_bf16 v176, v168, v180
 v_dot2c_f32_bf16 v178, v168, v168
 v_dot2c_f32_bf16 v176, v169, v180
 v_dot2c_f32_bf16 v178, v169, v169
 v_dot2c_f32_bf16 v176, v170, v180
 v_dot2c_f32_bf16 v178, v170, v170
 v_dot2c_f32_bf16 v176, v171, v180
 v_dot2c_f32_bf16 v178, v171, v171
 v_dot2c_f32_bf16 v177, v172, v180
 v_dot2c_f32_bf16 v179, v172, v172
 v_dot2c_f32_bf16 v177, v173, v180
 v_dot2c_f32_bf16 v179, v173, v173
 v_dot2c_f32_bf16 v177, v174, v180
 v_dot2c_f32_bf16 v179, v174, v174
 v_dot2c_f32_bf16 v177, v175, v180
 v_dot2c_f32_bf16 v179, v175, v175
 buffer_load_dwordx4 v[136:139], v4, s[12:15], s42 offen
 buffer_load_dwordx4 v[140:143], v4, s[12:15], s43 offen
 s_add_u32 s42, s42, 1024
 s_add_u32 s43, s43, 1024
 ds_read_b128 v[168:171], v5 offset:736
 ds_read_b128 v[172:175], v7 offset:736
 s_waitcnt vmcnt(6) lgkmcnt(2)
 v_mfma_f32_32x32x16_bf16 v[64:79], v[160:163], v[144:147], v[64:79]
 v_mfma_f32_32x32x16_bf16 v[80:95], v[164:167], v[144:147], v[80:95]
 v_mfma_f32_32x32x16_bf16 v[96:111], v[160:163], v[148:151], v[96:111]
 v_mfma_f32_32x32x16_bf16 v[112:127], v[164:167], v[148:151], v[112:127]
 v_dot2c_f32_bf16 v176, v160, v180
 v_dot2c_f32_bf16 v178, v160, v160
 v_dot2c_f32_bf16 v176, v161, v180
 v_dot2c_f32_bf16 v178, v161, v161
 v_dot2c_f32_bf16 v176, v162, v180
 v_dot2c_f32_bf16 v178, v162, v162
 v_dot2c_f32_bf16 v176, v163, v180
 v_dot2c_f32_bf16 v178, v163, v163
 v_dot2c_f32_bf16 v177, v164, v180
 v_dot2c_f32_bf16 v179, v164, v164
 v_dot2c_f32_bf16 v177, v165, v180
 v_dot2c_f32_bf16 v179, v165, v165
 v_dot2c_f32_bf16 v177, v166, v180
 v_dot2c_f32_bf16 v179, v166, v166
 v_dot2c_f32_bf16 v177, v167, v180
 v_dot2c_f32_bf16 v179, v167, v167
 buffer_load_dwordx4 v[144:147], v4, s[12:15], s42 offen
 buffer_load_dwordx4 v[148:151], v4, s[12:15], s43 offen
 s_add_u32 s42, s42, 1024
 s_add_u32 s43, s43, 1024
 ds_read_b128 v[160:163], v5 offset:768
 ds_read_b128 v[164:167], v7 offset:768
 s_waitcnt vmcnt(6) lgkmcnt(2)
 v_mfma_f32_32x32x16_bf16 v[64:79], v[168:171], v[152:155], v[64:79]
 v_mfma_f32_32x32x16_bf16 v[80:95], v[172:175], v[152:155], v[80:95]
 v_mfma_f32_32x32x16_bf16 v[96:111], v[168:171], v[156:159], v[96:111]
 v_mfma_f32_32x32x16_bf16 v[112:127], v[172:175], v[156:159], v[112:127]
 v_dot2c_f32_bf16 v176, v168, v180
 v_dot2c_f32_bf16 v178, v168, v168
 v_dot2c_f32_bf16 v176, v169, v180
 v_dot2c_f32_bf16 v178, v169, v169
 v_dot2c_f32_bf16 v176, v170, v180
 v_dot2c_f32_bf16 v178, v170, v170
 v_dot2c_f32_bf16 v176, v171, v180
 v_dot2c_f32_bf16 v178, v171, v171
 v_dot2c_f32_bf16 v177, v172, v180
 v_dot2c_f32_bf16 v179, v172, v172
 v_dot2c_f32_bf16 v177, v173, v180
 v_dot2c_f32_bf16 v179, v173, v173
 v_dot2c_f32_bf16 v177, v174, v180
 v_dot2c_f32_bf16 v179, v174, v174
 v_dot2c_f32_bf16 v177, v175, v180
 v_dot2c_f32_bf16 v179, v175, v175
 buffer_load_dwordx4 v[152:155], v4, s[12:15], s42 offen
 buffer_load_dwordx4 v[156:159], v4, s[12:15], s43 offen
 s_add_u32 s42, s42, 1024
 s_add_u32 s43, s43, 1024
 ds_read_b128 v[168:171], v5 offset:800
 ds_read_b128 v[172:175], v7 offset:800
 s_waitcnt vmcnt(6) lgkmcnt(2)
 v_mfma_f32_32x32x16_bf16 v[64:79], v[160:163], v[128:131], v[64:79]
 v_mfma_f32_32x32x16_bf16 v[80:95], v[164:167], v[128:131], v[80:95]
 v_mfma_f32_32x32x16_bf16 v[96:111], v[160:163], v[132:135], v[96:111]
 v_mfma_f32_32x32x16_bf16 v[112:127], v[164:167], v[132:135], v[112:127]
 v_dot2c_f32_bf16 v176, v160, v180
 v_dot2c_f32_bf16 v178, v160, v160
 v_dot2c_f32_bf16 v176, v161, v180
 v_dot2c_f32_bf16 v178, v161, v161
 v_dot2c_f32_bf16 v176, v162, v180
 v_dot2c_f32_bf16 v178, v162, v162
 v_dot2c_f32_bf16 v176, v163, v180
 v_dot2c_f32_bf16 v178, v163, v163
 v_dot2c_f32_bf16 v177, v164, v180
 v_dot2c_f32_bf16 v179, v164, v164
 v_dot2c_f32_bf16 v177, v165, v180
 v_dot2c_f32_bf16 v179, v165, v165
 v_dot2c_f32_bf16 v177, v166, v180
 v_dot2c_f32_bf16 v179, v166, v166
 v_dot2c_f32_bf16 v177, v167, v180
 v_dot2c_f32_bf16 v179, v167, v167
 buffer_load_dwordx4 v[128:131], v4, s[12:15], s42 offen
 buffer_load_dwordx4 v[132:135], v4, s[12:15], s43 offen
 s_add_u32 s42, s42, 1024
 s_add_u32 s43, s43, 1024
 ds_read_b128 v[160:163], v5 offset:832
 ds_read_b128 v[164:167], v7 offset:832
 s_waitcnt vmcnt(6) lgkmcnt(2)
 v_mfma_f32_32x32x16_bf16 v[64:79], v[168:171], v[136:139], v[64:79]
 v_mfma_f32_32x32x16_bf16 v[80:95], v[172:175], v[136:139], v[80:95]
 v_mfma_f32_32x32x16_bf16 v[96:111], v[168:171], v[140:143], v[96:111]
 v_mfma_f32_32x32x16_bf16 v[112:127], v[172:175], v[140:143], v[112:127]
 v_dot2c_f32_bf16 v176, v168, v180
 v_dot2c_f32_bf16 v178, v168, v168
 v_dot2c_f32_bf16 v176, v169, v180
 v_dot2c_f32_bf16 v178, v169, v169
 v_dot2c_f32_bf16 v176, v170, v180
 v_dot2c_f32_bf16 v178, v170, v170
 v_dot2c_f32_bf16 v176, v171, v180
 v_dot2c_f32_bf16 v178, v171, v171
 v_dot2c_f32_bf16 v177, v172, v180
 v_dot2c_f32_bf16 v179, v172, v172
 v_dot2c_f32_bf16 v177, v173, v180
 v_dot2c_f32_bf16 v179, v173, v173
 v_dot2c_f32_bf16 v177, v174, v180
 v_dot2c_f32_bf16 v179, v174, v174
 v_dot2c_f32_bf16 v177, v175, v180
 v_dot2c_f32_bf16 v179, v175, v175
 buffer_load_dwordx4 v[136:139], v4, s[12:15], s42 offen
 buffer_load_dwordx4 v[140:143], v4, s[12:15], s43 offen
 s_add_u32 s42, s42, 1024
 s_add_u32 s43, s43, 1024
 ds_read_b128 v[168:171], v5 offset:864
 ds_read_b128 v[172:175], v7 offset:864
 s_waitcnt vmcnt(6) lgkmcnt(2)
 v_mfma_f32_32x32x16_bf16 v[64:79], v[160:163], v[144:147], v[64:79]
 v_mfma_f32_32x32x16_bf16 v[80:95], v[164:167], v[144:147], v[80:95]
 v_mfma_f32_32x32x16_bf16 v[96:111], v[160:163], v[148:151], v[96:111]
 v_mfma_f32_32x32x16_bf16 v[112:127], v[164:167], v[148:151], v[112:127]
 v_dot2c_f32_bf16 v176, v160, v180
 v_dot2c_f32_bf16 v178, v160, v160
 v_dot2c_f32_bf16 v176, v161, v180
 v_dot2c_f32_bf16 v178, v161, v161
 v_dot2c_f32_bf16 v176, v162, v180
 v_dot2c_f32_bf16 v178, v162, v162
 v_dot2c_f32_bf16 v176, v163, v180
 v_dot2c_f32_bf16 v178, v163, v163
 v_dot2c_f32_bf16 v177, v164, v180
 v_dot2c_f32_bf16 v179, v164, v164
 v_dot2c_f32_bf16 v177, v165, v180
 v_dot2c_f32_bf16 v179, v165, v165
 v_dot2c_f32_bf16 v177, v166, v180
 v_dot2c_f32_bf16 v179, v166, v166
 v_dot2c_f32_bf16 v177, v167, v180
 v_dot2c_f32_bf16 v179, v167, v167
 buffer_load_dwordx4 v[144:147], v4, s[12:15], s42 offen
 buffer_load_dwordx4 v[148:151], v4, s[12:15], s43 offen
 s_add_u32 s42, s42, 1024
 s_add_u32 s43, s43, 1024
 ds_read_b128 v[160:163], v5 offset:896
 ds_read_b128 v[164:167], v7 offset:896
 s_waitcnt vmcnt(6) lgkmcnt(2)
 v_mfma_f32_32x32x16_bf16 v[64:79], v[168:171], v[152:155], v[64:79]
 v_mfma_f32_32x32x16_bf16 v[80:95], v[172:175], v[152:155], v[80:95]
 v_mfma_f32_32x32x16_bf16 v[96:111], v[168:171], v[156:159], v[96:111]
 v_mfma_f32_32x32x16_bf16 v[112:127], v[172:175], v[156:159], v[112:127]
 v_dot2c_f32_bf16 v176, v168, v180
 v_dot2c_f32_bf16 v178, v168, v168
 v_dot2c_f32_bf16 v176, v169, v180
 v_dot2c_f32_bf16 v178, v169, v169
 v_dot2c_f32_bf16 v176, v170, v180
 v_dot2c_f32_bf16 v178, v170, v170
 v_dot2c_f32_bf16 v176, v171, v180
 v_dot2c_f32_bf16 v178, v171, v171
 v_dot2c_f32_bf16 v177, v172, v180
 v_dot2c_f32_bf16 v179, v172, v172
 v_dot2c_f32_bf16 v177, v173, v180
 v_dot2c_f32_bf16 v179, v173, v173
 v_dot2c_f32_bf16 v177, v174, v180
 v_dot2c_f32_bf16 v179, v174, v174
 v_dot2c_f32_bf16 v177, v175, v180
 v_dot2c_f32_bf16 v179, v175, v175
 buffer_load_dwordx4 v[152:155], v4, s[12:15], s42 offen
 buffer_load_dwordx4 v[156:159], v4, s[12:15], s43 offen
 s_add_u32 s42, s42, 1024
 s_add_u32 s43, s43, 1024
 ds_read_b128 v[168:171], v5 offset:928
 ds_read_b128 v[172:175], v7 offset:928
 s_waitcnt vmcnt(6) lgkmcnt(2)
 v_mfma_f32_32x32x16_bf16 v[64:79], v[160:163], v[128:131], v[64:79]
 v_mfma_f32_32x32x16_bf16 v[80:95], v[164:167], v[128:131], v[80:95]
 v_mfma_f32_32x32x16_bf16 v[96:111], v[160:163], v[132:135], v[96:111]
 v_mfma_f32_32x32x16_bf16 v[112:127], v[164:167], v[132:135], v[112:127]
 v_dot2c_f32_bf16 v176, v160, v180
 v_dot2c_f32_bf16 v178, v160, v160
 v_dot2c_f32_bf16 v176, v161, v180
 v_dot2c_f32_bf16 v178, v161, v161
 v_dot2c_f32_bf16 v176, v162, v180
 v_dot2c_f32_bf16 v178, v162, v162
 v_dot2c_f32_bf16 v176, v163, v180
 v_dot2c_f32_bf16 v178, v163, v163
 v_dot2c_f32_bf16 v177, v164, v180
 v_dot2c_f32_bf16 v179, v164, v164
 v_dot2c_f32_bf16 v177, v165, v180
 v_dot2c_f32_bf16 v179, v165, v165
 v_dot2c_f32_bf16 v177, v166, v180
 v_dot2c_f32_bf16 v179, v166, v166
 v_dot2c_f32_bf16 v177, v167, v180
 v_dot2c_f32_bf16 v179, v167, v167
 buffer_load_dwordx4 v[128:131], v4, s[12:15], s42 offen
 buffer_load_dwordx4 v[132:135], v4, s[12:15], s43 offen
 s_add_u32 s42, s42, 1024
 s_add_u32 s43, s43, 1024
 ds_read_b128 v[160:163], v5 offset:960
 ds_read_b128 v[164:167], v7 offset:960
 s_waitcnt vmcnt(6) lgkmcnt(2)
 v_mfma_f32_32x32x16_bf16 v[64:79], v[168:171], v[136:139], v[64:79]
 v_mfma_f32_32x32x16_bf16 v[80:95], v[172:175], v[136:139], v[80:95]
 v_mfma_f32_32x32x16_bf16 v[96:111], v[168:171], v[140:143], v[96:111]
 v_mfma_f32_32x32x16_bf16 v[112:127], v[172:175], v[140:143], v[112:127]
 v_dot2c_f32_bf16 v176, v168, v180
 v_dot2c_f32_bf16 v178, v168, v168
 v_dot2c_f32_bf16 v176, v169, v180
 v_dot2c_f32_bf16 v178, v169, v169
 v_dot2c_f32_bf16 v176, v170, v180
 v_dot2c_f32_bf16 v178, v170, v170
 v_dot2c_f32_bf16 v176, v171, v180
 v_dot2c_f32_bf16 v178, v171, v171
 v_dot2c_f32_bf16 v177, v172, v180
 v_dot2c_f32_bf16 v179, v172, v172
 v_dot2c_f32_bf16 v177, v173, v180
 v_dot2c_f32_bf16 v179, v173, v173
 v_dot2c_f32_bf16 v177, v174, v180
 v_dot2c_f32_bf16 v179, v174, v174
 v_dot2c_f32_bf16 v177, v175, v180
 v_dot2c_f32_bf16 v179, v175, v175
 buffer_load_dwordx4 v[136:139], v4, s[12:15], s42 offen
 buffer_load_dwordx4 v[140:143], v4, s[12:15], s43 offen
 s_add_u32 s42, s42, 1024
 s_add_u32 s43, s43, 1024
 ds_read_b128 v[168:171], v5 offset:992
 ds_read_b128 v[172:175], v7 offset:992
 s_waitcnt vmcnt(6) lgkmcnt(2)
 v_mfma_f32_32x32x16_bf16 v[64:79], v[160:163], v[144:147], v[64:79]
 v_mfma_f32_32x32x16_bf16 v[80:95], v[164:167], v[144:147], v[80:95]
 v_mfma_f32_32x32x16_bf16 v[96:111], v[160:163], v[148:151], v[96:111]
 v_mfma_f32_32x32x16_bf16 v[112:127], v[164:167], v[148:151], v[112:127]
 v_dot2c_f32_bf16 v176, v160, v180
 v_dot2c_f32_bf16 v178, v160, v160
 v_dot2c_f32_bf16 v176, v161, v180
 v_dot2c_f32_bf16 v178, v161, v161
 v_dot2c_f32_bf16 v176, v162, v180
 v_dot2c_f32_bf16 v178, v162, v162
 v_dot2c_f32_bf16 v176, v163, v180
 v_dot2c_f32_bf16 v178, v163, v163
 v_dot2c_f32_bf16 v177, v164, v180
 v_dot2c_f32_bf16 v179, v164, v164
 v_dot2c_f32_bf16 v177, v165, v180
 v_dot2c_f32_bf16 v179, v165, v165
 v_dot2c_f32_bf16 v177, v166, v180
 v_dot2c_f32_bf16 v179, v166, v166
 v_dot2c_f32_bf16 v177, v167, v180
 v_dot2c_f32_bf16 v179, v167, v167
 buffer_load_dwordx4 v[144:147], v4, s[12:15], s42 offen
 buffer_load_dwordx4 v[148:151], v4, s[12:15], s43 offen
 s_add_u32 s42, s42, 1024
 s_add_u32 s43, s43, 1024
 ds_read_b128 v[160:163], v5 offset:1024
 ds_read_b128 v[164:167], v7 offset:1024
 s_waitcnt vmcnt(6) lgkmcnt(2)
 v_mfma_f32_32x32x16_bf16 v[64:79], v[168:171], v[152:155], v[64:79]
 v_mfma_f32_32x32x16_bf16 v[80:95], v[172:175], v[152:155], v[80:95]
 v_mfma_f32_32x32x16_bf16 v[96:111], v[168:171], v[156:159], v[96:111]
 v_mfma_f32_32x32x16_bf16 v[112:127], v[172:175], v[156:159], v[112:127]
 v_dot2c_f32_bf16 v176, v168, v180
 v_dot2c_f32_bf16 v178, v168, v168
 v_dot2c_f32_bf16 v176, v169, v180
 v_dot2c_f32_bf16 v178, v169, v169
 v_dot2c_f32_bf16 v176, v170, v180
 v_dot2c_f32_bf16 v178, v170, v170
 v_dot2c_f32_bf16 v176, v171, v180
 v_dot2c_f32_bf16 v178, v171, v171
 v_dot2c_f32_bf16 v177, v172, v180
 v_dot2c_f32_bf16 v179, v172, v172
 v_dot2c_f32_bf16 v177, v173, v180
 v_dot2c_f32_bf16 v179, v173, v173
 v_dot2c_f32_bf16 v177, v174, v180
 v_dot2c_f32_bf16 v179, v174, v174
 v_dot2c_f32_bf16 v177, v175, v180
 v_dot2c_f32_bf16 v179, v175, v175
 buffer_load_dwordx4 v[152:155], v4, s[12:15], s42 offen
 buffer_load_dwordx4 v[156:159], v4, s[12:15], s43 offen
 s_add_u32 s42, s42, 1024
 s_add_u32 s43, s43, 1024
 ds_read_b128 v[168:171], v5 offset:1056
 ds_read_b128 v[172:175], v7 offset:1056
 s_waitcnt vmcnt(6) lgkmcnt(2)
 v_mfma_f32_32x32x16_bf16 v[64:79], v[160:163], v[128:131], v[64:79]
 v_mfma_f32_32x32x16_bf16 v[80:95], v[164:167], v[128:131], v[80:95]
 v_mfma_f32_32x32x16_bf16 v[96:111], v[160:163], v[132:135], v[96:111]
 v_mfma_f32_32x32x16_bf16 v[112:127], v[164:167], v[132:135], v[112:127]
 v_dot2c_f32_bf16 v176, v160, v180
 v_dot2c_f32_bf16 v178, v160, v160
 v_dot2c_f32_bf16 v176, v161, v180
 v_dot2c_f32_bf16 v178, v161, v161
 v_dot2c_f32_bf16 v176, v162, v180
 v_dot2c_f32_bf16 v178, v162, v162
 v_dot2c_f32_bf16 v176, v163, v180
 v_dot2c_f32_bf16 v178, v163, v163
 v_dot2c_f32_bf16 v177, v164, v180
 v_dot2c_f32_bf16 v179, v164, v164
 v_dot2c_f32_bf16 v177, v165, v180
 v_dot2c_f32_bf16 v179, v165, v165
 v_dot2c_f32_bf16 v177, v166, v180
 v_dot2c_f32_bf16 v179, v166, v166
 v_dot2c_f32_bf16 v177, v167, v180
 v_dot2c_f32_bf16 v179, v167, v167
 buffer_load_dwordx4 v[128:131], v4, s[12:15], s42 offen
 buffer_load_dwordx4 v[132:135], v4, s[12:15], s43 offen
 s_add_u32 s42, s42, 1024
 s_add_u32 s43, s43, 1024
 ds_read_b128 v[160:163], v5 offset:1088
 ds_read_b128 v[164:167], v7 offset:1088
 s_waitcnt vmcnt(6) lgkmcnt(2)
 v_mfma_f32_32x32x16_bf16 v[64:79], v[168:171], v[136:139], v[64:79]
 v_mfma_f32_32x32x16_bf16 v[80:95], v[172:175], v[136:139], v[80:95]
 v_mfma_f32_32x32x16_bf16 v[96:111], v[168:171], v[140:143], v[96:111]
 v_mfma_f32_32x32x16_bf16 v[112:127], v[172:175], v[140:143], v[112:127]
 v_dot2c_f32_bf16 v176, v168, v180
 v_dot2c_f32_bf16 v178, v168, v168
 v_dot2c_f32_bf16 v176, v169, v180
 v_dot2c_f32_bf16 v178, v169, v169
 v_dot2c_f32_bf16 v176, v170, v180
 v_dot2c_f32_bf16 v178, v170, v170
 v_dot2c_f32_bf16 v176, v171, v180
 v_dot2c_f32_bf16 v178, v171, v171
 v_dot2c_f32_bf16 v177, v172, v180
 v_dot2c_f32_bf16 v179, v172, v172
 v_dot2c_f32_bf16 v177, v173, v180
 v_dot2c_f32_bf16 v179, v173, v173
 v_dot2c_f32_bf16 v177, v174, v180
 v_dot2c_f32_bf16 v179, v174, v174
 v_dot2c_f32_bf16 v177, v175, v180
 v_dot2c_f32_bf16 v179, v175, v175
 buffer_load_dwordx4 v[136:139], v4, s[12:15], s42 offen
 buffer_load_dwordx4 v[140:143], v4, s[12:15], s43 offen
 s_add_u32 s42, s42, 1024
 s_add_u32 s43, s43, 1024
 ds_read_b128 v[168:171], v5 offset:1120
 ds_read_b128 v[172:175], v7 offset:1120
 s_waitcnt vmcnt(6) lgkmcnt(2)
 v_mfma_f32_32x32x16_bf16 v[64:79], v[160:163], v[144:147], v[64:79]
 v_mfma_f32_32x32x16_bf16 v[80:95], v[164:167], v[144:147], v[80:95]
 v_mfma_f32_32x32x16_bf16 v[96:111], v[160:163], v[148:151], v[96:111]
 v_mfma_f32_32x32x16_bf16 v[112:127], v[164:167], v[148:151], v[112:127]
 v_dot2c_f32_bf16 v176, v160, v180
 v_dot2c_f32_bf16 v178, v160, v160
 v_dot2c_f32_bf16 v176, v161, v180
 v_dot2c_f32_bf16 v178, v161, v161
 v_dot2c_f32_bf16 v176, v162, v180
 v_dot2c_f32_bf16 v178, v162, v162
 v_dot2c_f32_bf16 v176, v163, v180
 v_dot2c_f32_bf16 v178, v163, v163
 v_dot2c_f32_bf16 v177, v164, v180
 v_dot2c_f32_bf16 v179, v164, v164
 v_dot2c_f32_bf16 v177, v165, v180
 v_dot2c_f32_bf16 v179, v165, v165
 v_dot2c_f32_bf16 v177, v166, v180
 v_dot2c_f32_bf16 v179, v166, v166
 v_dot2c_f32_bf16 v177, v167, v180
 v_dot2c_f32_bf16 v179, v167, v167
 buffer_load_dwordx4 v[144:147], v4, s[12:15], s42 offen
 buffer_load_dwordx4 v[148:151], v4, s[12:15], s43 offen
 s_add_u32 s42, s42, 1024
 s_add_u32 s43, s43, 1024
 ds_read_b128 v[160:163], v5 offset:1152
 ds_read_b128 v[164:167], v7 offset:1152
 s_waitcnt vmcnt(6) lgkmcnt(2)
 v_mfma_f32_32x32x16_bf16 v[64:79], v[168:171], v[152:155], v[64:79]
 v_mfma_f32_32x32x16_bf16 v[80:95], v[172:175], v[152:155], v[80:95]
 v_mfma_f32_32x32x16_bf16 v[96:111], v[168:171], v[156:159], v[96:111]
 v_mfma_f32_32x32x16_bf16 v[112:127], v[172:175], v[156:159], v[112:127]
 v_dot2c_f32_bf16 v176, v168, v180
 v_dot2c_f32_bf16 v178, v168, v168
 v_dot2c_f32_bf16 v176, v169, v180
 v_dot2c_f32_bf16 v178, v169, v169
 v_dot2c_f32_bf16 v176, v170, v180
 v_dot2c_f32_bf16 v178, v170, v170
 v_dot2c_f32_bf16 v176, v171, v180
 v_dot2c_f32_bf16 v178, v171, v171
 v_dot2c_f32_bf16 v177, v172, v180
 v_dot2c_f32_bf16 v179, v172, v172
 v_dot2c_f32_bf16 v177, v173, v180
 v_dot2c_f32_bf16 v179, v173, v173
 v_dot2c_f32_bf16 v177, v174, v180
 v_dot2c_f32_bf16 v179, v174, v174
 v_dot2c_f32_bf16 v177, v175, v180
 v_dot2c_f32_bf16 v179, v175, v175
 buffer_load_dwordx4 v[152:155], v4, s[12:15], s42 offen
 buffer_load_dwordx4 v[156:159], v4, s[12:15], s43 offen
 s_add_u32 s42, s42, 1024
 s_add_u32 s43, s43, 1024
 ds_read_b128 v[168:171], v5 offset:1184
 ds_read_b128 v[172:175], v7 offset:1184
 s_waitcnt vmcnt(6) lgkmcnt(2)
 v_mfma_f32_32x32x16_bf16 v[64:79], v[160:163], v[128:131], v[64:79]
 v_mfma_f32_32x32x16_bf16 v[80:95], v[164:167], v[128:131], v[80:95]
 v_mfma_f32_32x32x16_bf16 v[96:111], v[160:163], v[132:135], v[96:111]
 v_mfma_f32_32x32x16_bf16 v[112:127], v[164:167], v[132:135], v[112:127]
 v_dot2c_f32_bf16 v176, v160, v180
 v_dot2c_f32_bf16 v178, v160, v160
 v_dot2c_f32_bf16 v176, v161, v180
 v_dot2c_f32_bf16 v178, v161, v161
 v_dot2c_f32_bf16 v176, v162, v180
 v_dot2c_f32_bf16 v178, v162, v162
 v_dot2c_f32_bf16 v176, v163, v180
 v_dot2c_f32_bf16 v178, v163, v163
 v_dot2c_f32_bf16 v177, v164, v180
 v_dot2c_f32_bf16 v179, v164, v164
 v_dot2c_f32_bf16 v177, v165, v180
 v_dot2c_f32_bf16 v179, v165, v165
 v_dot2c_f32_bf16 v177, v166, v180
 v_dot2c_f32_bf16 v179, v166, v166
 v_dot2c_f32_bf16 v177, v167, v180
 v_dot2c_f32_bf16 v179, v167, v167
 ds_read_b128 v[160:163], v5 offset:1216
 ds_read_b128 v[164:167], v7 offset:1216
 s_waitcnt vmcnt(4) lgkmcnt(2)
 v_mfma_f32_32x32x16_bf16 v[64:79], v[168:171], v[136:139], v[64:79]
 v_mfma_f32_32x32x16_bf16 v[80:95], v[172:175], v[136:139], v[80:95]
 v_mfma_f32_32x32x16_bf16 v[96:111], v[168:171], v[140:143], v[96:111]
 v_mfma_f32_32x32x16_bf16 v[112:127], v[172:175], v[140:143], v[112:127]
 v_dot2c_f32_bf16 v176, v168, v180
 v_dot2c_f32_bf16 v178, v168, v168
 v_dot2c_f32_bf16 v176, v169, v180
 v_dot2c_f32_bf16 v178, v169, v169
 v_dot2c_f32_bf16 v176, v170, v180
 v_dot2c_f32_bf16 v178, v170, v170
 v_dot2c_f32_bf16 v176, v171, v180
 v_dot2c_f32_bf16 v178, v171, v171
 v_dot2c_f32_bf16 v177, v172, v180
 v_dot2c_f32_bf16 v179, v172, v172
 v_dot2c_f32_bf16 v177, v173, v180
 v_dot2c_f32_bf16 v179, v173, v173
 v_dot2c_f32_bf16 v177, v174, v180
 v_dot2c_f32_bf16 v179, v174, v174
 v_dot2c_f32_bf16 v177, v175, v180
 v_dot2c_f32_bf16 v179, v175, v175
 ds_read_b128 v[168:171], v5 offset:1248
 ds_read_b128 v[172:175], v7 offset:1248
 s_waitcnt vmcnt(2) lgkmcnt(2)
 v_mfma_f32_32x32x16_bf16 v[64:79], v[160:163], v[144:147], v[64:79]
 v_mfma_f32_32x32x16_bf16 v[80:95], v[164:167], v[144:147], v[80:95]
 v_mfma_f32_32x32x16_bf16 v[96:111], v[160:163], v[148:151], v[96:111]
 v_mfma_f32_32x32x16_bf16 v[112:127], v[164:167], v[148:151], v[112:127]
 v_dot2c_f32_bf16 v176, v160, v180
 v_dot2c_f32_bf16 v178, v160, v160
 v_dot2c_f32_bf16 v176, v161, v180
 v_dot2c_f32_bf16 v178, v161, v161
 v_dot2c_f32_bf16 v176, v162, v180
 v_dot2c_f32_bf16 v178, v162, v162
 v_dot2c_f32_bf16 v176, v163, v180
 v_dot2c_f32_bf16 v178, v163, v163
 v_dot2c_f32_bf16 v177, v164, v180
 v_dot2c_f32_bf16 v179, v164, v164
 v_dot2c_f32_bf16 v177, v165, v180
 v_dot2c_f32_bf16 v179, v165, v165
 v_dot2c_f32_bf16 v177, v166, v180
 v_dot2c_f32_bf16 v179, v166, v166
 v_dot2c_f32_bf16 v177, v167, v180
 v_dot2c_f32_bf16 v179, v167, v167
 s_waitcnt vmcnt(0) lgkmcnt(0)
 v_mfma_f32_32x32x16_bf16 v[64:79], v[168:171], v[152:155], v[64:79]
 v_mfma_f32_32x32x16_bf16 v[80:95], v[172:175], v[152:155], v[80:95]
 v_mfma_f32_32x32x16_bf16 v[96:111], v[168:171], v[156:159], v[96:111]
 v_mfma_f32_32x32x16_bf16 v[112:127], v[172:175], v[156:159], v[112:127]
 v_dot2c_f32_bf16 v176, v168, v180
 v_dot2c_f32_bf16 v178, v168, v168
 v_dot2c_f32_bf16 v176, v169, v180
 v_dot2c_f32_bf16 v178, v169, v169
 v_dot2c_f32_bf16 v176, v170, v180
 v_dot2c_f32_bf16 v178, v170, v170
 v_dot2c_f32_bf16 v176, v171, v180
 v_dot2c_f32_bf16 v178, v171, v171
 v_dot2c_f32_bf16 v177, v172, v180
 v_dot2c_f32_bf16 v179, v172, v172
 v_dot2c_f32_bf16 v177, v173, v180
 v_dot2c_f32_bf16 v179, v173, v173
 v_dot2c_f32_bf16 v177, v174, v180
 v_dot2c_f32_bf16 v179, v174, v174
 v_dot2c_f32_bf16 v177, v175, v180
 v_dot2c_f32_bf16 v179, v175, v175
 s_nop 11
 v_mov_b32 v186, v176
 s_nop 1
 v_permlane32_swap_b32 v176, v186
 v_add_f32 v176, v176, v186
 v_mov_b32 v186, v177
 s_nop 1
 v_permlane32_swap_b32 v177, v186
 v_add_f32 v177, v177, v186
 v_mov_b32 v186, v178
 s_nop 1
 v_permlane32_swap_b32 v178, v186
 v_add_f32 v178, v178, v186
 v_mov_b32 v186, v179
 s_nop 1
 v_permlane32_swap_b32 v179, v186
 v_add_f32 v179, v179, v186
 s_mov_b32 s44, 0x3acccccd
 s_mov_b32 s45, 0x3727c5ac
 v_mul_f32 v186, s44, v176
 v_mul_f32 v187, s44, v178
 v_fma_f32 v187, -v186, v186, v187
 v_add_f32 v187, s45, v187
 v_rsq_f32 v181, v187
 s_nop 0
 v_mul_f32 v183, v181, v186
 v_mul_f32 v186, s44, v177
 v_mul_f32 v187, s44, v179
 v_fma_f32 v187, -v186, v186, v187
 v_add_f32 v187, s45, v187
 v_rsq_f32 v182, v187
 s_nop 0
 v_mul_f32 v184, v182, v186
 s_add_u32 s49, s40, -40
 s_lshl_b32 s46, s34, 9
 s_add_u32 s46, s46, 82944
 v_and_b32 v9, 31, v0
 v_lshlrev_b32 v10, 2, v9
 v_add_u32 v10, s46, v10
 ds_write_b32 v10, v181 offset:0
 ds_write_b32 v10, v183 offset:128
 ds_write_b32 v10, v182 offset:256
 ds_write_b32 v10, v184 offset:384
 s_lshl_b32 s47, s49, 5
 v_add_u32 v10, s47, v9
 v_add_u32 v11, 1280, v10
 v_lshlrev_b32 v11, 2, v11
 buffer_load_dword v12, v11, s[16:19], 0 offen
 v_mul_u32_u24 v11, 3277, v10
 v_lshrrev_b32 v11, 16, v11
 v_mul_u32_u24 v13, 20, v11
 v_sub_u32 v13, v10, v13
 v_lshlrev_b32 v11, 17, v11
 v_lshl_add_u32 v11, v13, 4, v11
 v_bfe_u32 v13, v0, 5, 1
 v_lshl_add_u32 v11, v13, 9, v11
 v_lshlrev_b32 v13, 4, v13
 v_add_u32 v13, s46, v13
 s_waitcnt lgkmcnt(0)
 ds_read_b128 v[16:19], v13 offset:0
 ds_read_b128 v[20:23], v13 offset:128
 ds_read_b128 v[24:27], v13 offset:32
 ds_read_b128 v[28:31], v13 offset:160
 ds_read_b128 v[32:35], v13 offset:64
 ds_read_b128 v[36:39], v13 offset:192
 ds_read_b128 v[40:43], v13 offset:96
 ds_read_b128 v[44:47], v13 offset:224
 s_lshl_b32 s48, s32, 1
 s_add_u32 s48, s48, 0
 s_lshl_b32 s48, s48, 11
 s_waitcnt vmcnt(0)
 s_waitcnt lgkmcnt(6)
 v_mul_f32 v48, v20, v12
 v_fma_f32 v64, v16, v64, -v48
 v_mul_f32 v48, v21, v12
 v_fma_f32 v65, v17, v65, -v48
 v_mul_f32 v48, v22, v12
 v_fma_f32 v66, v18, v66, -v48
 v_mul_f32 v48, v23, v12
 v_fma_f32 v67, v19, v67, -v48
 s_waitcnt lgkmcnt(4)
 v_mul_f32 v48, v28, v12
 v_fma_f32 v68, v24, v68, -v48
 v_mul_f32 v48, v29, v12
 v_fma_f32 v69, v25, v69, -v48
 v_mul_f32 v48, v30, v12
 v_fma_f32 v70, v26, v70, -v48
 v_mul_f32 v48, v31, v12
 v_fma_f32 v71, v27, v71, -v48
 s_waitcnt lgkmcnt(2)
 v_mul_f32 v48, v36, v12
 v_fma_f32 v72, v32, v72, -v48
 v_mul_f32 v48, v37, v12
 v_fma_f32 v73, v33, v73, -v48
 v_mul_f32 v48, v38, v12
 v_fma_f32 v74, v34, v74, -v48
 v_mul_f32 v48, v39, v12
 v_fma_f32 v75, v35, v75, -v48
 s_waitcnt lgkmcnt(0)
 v_mul_f32 v48, v44, v12
 v_fma_f32 v76, v40, v76, -v48
 v_mul_f32 v48, v45, v12
 v_fma_f32 v77, v41, v77, -v48
 v_mul_f32 v48, v46, v12
 v_fma_f32 v78, v42, v78, -v48
 v_mul_f32 v48, v47, v12
 v_fma_f32 v79, v43, v79, -v48
 v_cvt_pk_bf16_f32 v50, v64, v65
 v_cvt_pk_bf16_f32 v51, v66, v67
 v_cvt_pk_bf16_f32 v52, v68, v69
 v_cvt_pk_bf16_f32 v53, v70, v71
 v_cvt_pk_bf16_f32 v54, v72, v73
 v_cvt_pk_bf16_f32 v55, v74, v75
 v_cvt_pk_bf16_f32 v56, v76, v77
 v_cvt_pk_bf16_f32 v57, v78, v79
 buffer_store_dwordx4 v[50:53], v11, s[28:31], s48 offen
 buffer_store_dwordx4 v[54:57], v11, s[28:31], s48 offen offset:1024
 ds_read_b128 v[16:19], v13 offset:256
 ds_read_b128 v[20:23], v13 offset:384
 ds_read_b128 v[24:27], v13 offset:288
 ds_read_b128 v[28:31], v13 offset:416
 ds_read_b128 v[32:35], v13 offset:320
 ds_read_b128 v[36:39], v13 offset:448
 ds_read_b128 v[40:43], v13 offset:352
 ds_read_b128 v[44:47], v13 offset:480
 s_lshl_b32 s48, s32, 1
 s_add_u32 s48, s48, 1
 s_lshl_b32 s48, s48, 11
 s_waitcnt lgkmcnt(6)
 v_mul_f32 v48, v20, v12
 v_fma_f32 v80, v16, v80, -v48
 v_mul_f32 v48, v21, v12
 v_fma_f32 v81, v17, v81, -v48
 v_mul_f32 v48, v22, v12
 v_fma_f32 v82, v18, v82, -v48
 v_mul_f32 v48, v23, v12
 v_fma_f32 v83, v19, v83, -v48
 s_waitcnt lgkmcnt(4)
 v_mul_f32 v48, v28, v12
 v_fma_f32 v84, v24, v84, -v48
 v_mul_f32 v48, v29, v12
 v_fma_f32 v85, v25, v85, -v48
 v_mul_f32 v48, v30, v12
 v_fma_f32 v86, v26, v86, -v48
 v_mul_f32 v48, v31, v12
 v_fma_f32 v87, v27, v87, -v48
 s_waitcnt lgkmcnt(2)
 v_mul_f32 v48, v36, v12
 v_fma_f32 v88, v32, v88, -v48
 v_mul_f32 v48, v37, v12
 v_fma_f32 v89, v33, v89, -v48
 v_mul_f32 v48, v38, v12
 v_fma_f32 v90, v34, v90, -v48
 v_mul_f32 v48, v39, v12
 v_fma_f32 v91, v35, v91, -v48
 s_waitcnt lgkmcnt(0)
 v_mul_f32 v48, v44, v12
 v_fma_f32 v92, v40, v92, -v48
 v_mul_f32 v48, v45, v12
 v_fma_f32 v93, v41, v93, -v48
 v_mul_f32 v48, v46, v12
 v_fma_f32 v94, v42, v94, -v48
 v_mul_f32 v48, v47, v12
 v_fma_f32 v95, v43, v95, -v48
 v_cvt_pk_bf16_f32 v50, v80, v81
 v_cvt_pk_bf16_f32 v51, v82, v83
 v_cvt_pk_bf16_f32 v52, v84, v85
 v_cvt_pk_bf16_f32 v53, v86, v87
 v_cvt_pk_bf16_f32 v54, v88, v89
 v_cvt_pk_bf16_f32 v55, v90, v91
 v_cvt_pk_bf16_f32 v56, v92, v93
 v_cvt_pk_bf16_f32 v57, v94, v95
 buffer_store_dwordx4 v[50:53], v11, s[28:31], s48 offen
 buffer_store_dwordx4 v[54:57], v11, s[28:31], s48 offen offset:1024
 s_add_u32 s49, s40, -39
 s_lshl_b32 s46, s34, 9
 s_add_u32 s46, s46, 82944
 v_and_b32 v9, 31, v0
 v_lshlrev_b32 v10, 2, v9
 v_add_u32 v10, s46, v10
 ds_write_b32 v10, v181 offset:0
 ds_write_b32 v10, v183 offset:128
 ds_write_b32 v10, v182 offset:256
 ds_write_b32 v10, v184 offset:384
 s_lshl_b32 s47, s49, 5
 v_add_u32 v10, s47, v9
 v_add_u32 v11, 1280, v10
 v_lshlrev_b32 v11, 2, v11
 buffer_load_dword v12, v11, s[16:19], 0 offen
 v_mul_u32_u24 v11, 3277, v10
 v_lshrrev_b32 v11, 16, v11
 v_mul_u32_u24 v13, 20, v11
 v_sub_u32 v13, v10, v13
 v_lshlrev_b32 v11, 17, v11
 v_lshl_add_u32 v11, v13, 4, v11
 v_bfe_u32 v13, v0, 5, 1
 v_lshl_add_u32 v11, v13, 9, v11
 v_lshlrev_b32 v13, 4, v13
 v_add_u32 v13, s46, v13
 s_waitcnt lgkmcnt(0)
 ds_read_b128 v[16:19], v13 offset:0
 ds_read_b128 v[20:23], v13 offset:128
 ds_read_b128 v[24:27], v13 offset:32
 ds_read_b128 v[28:31], v13 offset:160
 ds_read_b128 v[32:35], v13 offset:64
 ds_read_b128 v[36:39], v13 offset:192
 ds_read_b128 v[40:43], v13 offset:96
 ds_read_b128 v[44:47], v13 offset:224
 s_lshl_b32 s48, s32, 1
 s_add_u32 s48, s48, 0
 s_lshl_b32 s48, s48, 11
 s_waitcnt vmcnt(0)
 s_waitcnt lgkmcnt(6)
 v_mul_f32 v48, v20, v12
 v_fma_f32 v96, v16, v96, -v48
 v_mul_f32 v48, v21, v12
 v_fma_f32 v97, v17, v97, -v48
 v_mul_f32 v48, v22, v12
 v_fma_f32 v98, v18, v98, -v48
 v_mul_f32 v48, v23, v12
 v_fma_f32 v99, v19, v99, -v48
 s_waitcnt lgkmcnt(4)
 v_mul_f32 v48, v28, v12
 v_fma_f32 v100, v24, v100, -v48
 v_mul_f32 v48, v29, v12
 v_fma_f32 v101, v25, v101, -v48
 v_mul_f32 v48, v30, v12
 v_fma_f32 v102, v26, v102, -v48
 v_mul_f32 v48, v31, v12
 v_fma_f32 v103, v27, v103, -v48
 s_waitcnt lgkmcnt(2)
 v_mul_f32 v48, v36, v12
 v_fma_f32 v104, v32, v104, -v48
 v_mul_f32 v48, v37, v12
 v_fma_f32 v105, v33, v105, -v48
 v_mul_f32 v48, v38, v12
 v_fma_f32 v106, v34, v106, -v48
 v_mul_f32 v48, v39, v12
 v_fma_f32 v107, v35, v107, -v48
 s_waitcnt lgkmcnt(0)
 v_mul_f32 v48, v44, v12
 v_fma_f32 v108, v40, v108, -v48
 v_mul_f32 v48, v45, v12
 v_fma_f32 v109, v41, v109, -v48
 v_mul_f32 v48, v46, v12
 v_fma_f32 v110, v42, v110, -v48
 v_mul_f32 v48, v47, v12
 v_fma_f32 v111, v43, v111, -v48
 v_cvt_pk_bf16_f32 v50, v96, v97
 v_cvt_pk_bf16_f32 v51, v98, v99
 v_cvt_pk_bf16_f32 v52, v100, v101
 v_cvt_pk_bf16_f32 v53, v102, v103
 v_cvt_pk_bf16_f32 v54, v104, v105
 v_cvt_pk_bf16_f32 v55, v106, v107
 v_cvt_pk_bf16_f32 v56, v108, v109
 v_cvt_pk_bf16_f32 v57, v110, v111
 buffer_store_dwordx4 v[50:53], v11, s[28:31], s48 offen
 buffer_store_dwordx4 v[54:57], v11, s[28:31], s48 offen offset:1024
 ds_read_b128 v[16:19], v13 offset:256
 ds_read_b128 v[20:23], v13 offset:384
 ds_read_b128 v[24:27], v13 offset:288
 ds_read_b128 v[28:31], v13 offset:416
 ds_read_b128 v[32:35], v13 offset:320
 ds_read_b128 v[36:39], v13 offset:448
 ds_read_b128 v[40:43], v13 offset:352
 ds_read_b128 v[44:47], v13 offset:480
 s_lshl_b32 s48, s32, 1
 s_add_u32 s48, s48, 1
 s_lshl_b32 s48, s48, 11
 s_waitcnt lgkmcnt(6)
 v_mul_f32 v48, v20, v12
 v_fma_f32 v112, v16, v112, -v48
 v_mul_f32 v48, v21, v12
 v_fma_f32 v113, v17, v113, -v48
 v_mul_f32 v48, v22, v12
 v_fma_f32 v114, v18, v114, -v48
 v_mul_f32 v48, v23, v12
 v_fma_f32 v115, v19, v115, -v48
 s_waitcnt lgkmcnt(4)
 v_mul_f32 v48, v28, v12
 v_fma_f32 v116, v24, v116, -v48
 v_mul_f32 v48, v29, v12
 v_fma_f32 v117, v25, v117, -v48
 v_mul_f32 v48, v30, v12
 v_fma_f32 v118, v26, v118, -v48
 v_mul_f32 v48, v31, v12
 v_fma_f32 v119, v27, v119, -v48
 s_waitcnt lgkmcnt(2)
 v_mul_f32 v48, v36, v12
 v_fma_f32 v120, v32, v120, -v48
 v_mul_f32 v48, v37, v12
 v_fma_f32 v121, v33, v121, -v48
 v_mul_f32 v48, v38, v12
 v_fma_f32 v122, v34, v122, -v48
 v_mul_f32 v48, v39, v12
 v_fma_f32 v123, v35, v123, -v48
 s_waitcnt lgkmcnt(0)
 v_mul_f32 v48, v44, v12
 v_fma_f32 v124, v40, v124, -v48
 v_mul_f32 v48, v45, v12
 v_fma_f32 v125, v41, v125, -v48
 v_mul_f32 v48, v46, v12
 v_fma_f32 v126, v42, v126, -v48
 v_mul_f32 v48, v47, v12
 v_fma_f32 v127, v43, v127, -v48
 v_cvt_pk_bf16_f32 v50, v112, v113
 v_cvt_pk_bf16_f32 v51, v114, v115
 v_cvt_pk_bf16_f32 v52, v116, v117
 v_cvt_pk_bf16_f32 v53, v118, v119
 v_cvt_pk_bf16_f32 v54, v120, v121
 v_cvt_pk_bf16_f32 v55, v122, v123
 v_cvt_pk_bf16_f32 v56, v124, v125
 v_cvt_pk_bf16_f32 v57, v126, v127
 buffer_store_dwordx4 v[50:53], v11, s[28:31], s48 offen
 buffer_store_dwordx4 v[54:57], v11, s[28:31], s48 offen offset:1024
L_b1_3_kernel_end:
 s_endpgm
.globl outb_3_kernel
.p2align 8
.type outb_3_kernel,@function
outb_3_kernel:
 s_cmp_ge_u32 s2, 160
 s_cbranch_scc1 L_outb_3_kernel_end
 s_load_dwordx2 s[4:5], s[0:1], 80
 s_load_dwordx2 s[38:39], s[0:1], 64
 s_and_b32 s32, s2, 31
 s_lshr_b32 s33, s2, 5
 v_lshrrev_b32 v1, 6, v0
 s_nop 0
 v_readfirstlane_b32 s34, v1
 s_waitcnt lgkmcnt(0)
 s_add_u32 s8, s4, 29360128
 s_addc_u32 s9, s5, 0
 s_mov_b32 s10, 2621440
 s_mov_b32 s11, 0x00020000
 s_add_u32 s12, s4, 4718592
 s_addc_u32 s13, s5, 0
 s_mov_b32 s14, 819200
 s_mov_b32 s15, 0x00020000
 s_mul_i32 s35, s32, 81920
 v_add_u32 v2, 0, v0
 v_lshlrev_b32 v3, 4, v2
 buffer_load_dwordx4 v[64:67], v3, s[8:11], s35 offen
 v_add_u32 v2, 256, v0
 v_lshlrev_b32 v3, 4, v2
 buffer_load_dwordx4 v[68:71], v3, s[8:11], s35 offen
 v_add_u32 v2, 512, v0
 v_lshlrev_b32 v3, 4, v2
 buffer_load_dwordx4 v[72:75], v3, s[8:11], s35 offen
 v_add_u32 v2, 768, v0
 v_lshlrev_b32 v3, 4, v2
 buffer_load_dwordx4 v[76:79], v3, s[8:11], s35 offen
 v_add_u32 v2, 1024, v0
 v_lshlrev_b32 v3, 4, v2
 buffer_load_dwordx4 v[80:83], v3, s[8:11], s35 offen
 v_add_u32 v2, 1280, v0
 v_lshlrev_b32 v3, 4, v2
 buffer_load_dwordx4 v[84:87], v3, s[8:11], s35 offen
 v_add_u32 v2, 1536, v0
 v_lshlrev_b32 v3, 4, v2
 buffer_load_dwordx4 v[88:91], v3, s[8:11], s35 offen
 v_add_u32 v2, 1792, v0
 v_lshlrev_b32 v3, 4, v2
 buffer_load_dwordx4 v[92:95], v3, s[8:11], s35 offen
 v_add_u32 v2, 2048, v0
 v_lshlrev_b32 v3, 4, v2
 buffer_load_dwordx4 v[96:99], v3, s[8:11], s35 offen
 v_add_u32 v2, 2304, v0
 v_lshlrev_b32 v3, 4, v2
 buffer_load_dwordx4 v[100:103], v3, s[8:11], s35 offen
 v_add_u32 v2, 2560, v0
 v_lshlrev_b32 v3, 4, v2
 buffer_load_dwordx4 v[104:107], v3, s[8:11], s35 offen
 v_add_u32 v2, 2816, v0
 v_lshlrev_b32 v3, 4, v2
 buffer_load_dwordx4 v[108:111], v3, s[8:11], s35 offen
 v_add_u32 v2, 3072, v0
 v_lshlrev_b32 v3, 4, v2
 buffer_load_dwordx4 v[112:115], v3, s[8:11], s35 offen
 v_add_u32 v2, 3328, v0
 v_lshlrev_b32 v3, 4, v2
 buffer_load_dwordx4 v[116:119], v3, s[8:11], s35 offen
 v_add_u32 v2, 3584, v0
 v_lshlrev_b32 v3, 4, v2
 buffer_load_dwordx4 v[120:123], v3, s[8:11], s35 offen
 v_add_u32 v2, 3840, v0
 v_lshlrev_b32 v3, 4, v2
 buffer_load_dwordx4 v[124:127], v3, s[8:11], s35 offen
 v_add_u32 v2, 4096, v0
 v_lshlrev_b32 v3, 4, v2
 buffer_load_dwordx4 v[128:131], v3, s[8:11], s35 offen
 v_add_u32 v2, 4352, v0
 v_lshlrev_b32 v3, 4, v2
 buffer_load_dwordx4 v[132:135], v3, s[8:11], s35 offen
 v_add_u32 v2, 4608, v0
 v_lshlrev_b32 v3, 4, v2
 buffer_load_dwordx4 v[136:139], v3, s[8:11], s35 offen
 v_add_u32 v2, 4864, v0
 v_lshlrev_b32 v3, 4, v2
 buffer_load_dwordx4 v[140:143], v3, s[8:11], s35 offen
 v_add_u32 v2, 0, v0
 v_mul_u32_u24 v3, 52429, v2
 v_lshrrev_b32 v3, 22, v3
 v_add_u32 v3, v3, v2
 v_lshlrev_b32 v3, 4, v3
 s_waitcnt vmcnt(19)
 ds_write_b128 v3, v[64:67]
 v_add_u32 v2, 256, v0
 v_mul_u32_u24 v3, 52429, v2
 v_lshrrev_b32 v3, 22, v3
 v_add_u32 v3, v3, v2
 v_lshlrev_b32 v3, 4, v3
 s_waitcnt vmcnt(18)
 ds_write_b128 v3, v[68:71]
 v_add_u32 v2, 512, v0
 v_mul_u32_u24 v3, 52429, v2
 v_lshrrev_b32 v3, 22, v3
 v_add_u32 v3, v3, v2
 v_lshlrev_b32 v3, 4, v3
 s_waitcnt vmcnt(17)
 ds_write_b128 v3, v[72:75]
 v_add_u32 v2, 768, v0
 v_mul_u32_u24 v3, 52429, v2
 v_lshrrev_b32 v3, 22, v3
 v_add_u32 v3, v3, v2
 v_lshlrev_b32 v3, 4, v3
 s_waitcnt vmcnt(16)
 ds_write_b128 v3, v[76:79]
 v_add_u32 v2, 1024, v0
 v_mul_u32_u24 v3, 52429, v2
 v_lshrrev_b32 v3, 22, v3
 v_add_u32 v3, v3, v2
 v_lshlrev_b32 v3, 4, v3
 s_waitcnt vmcnt(15)
 ds_write_b128 v3, v[80:83]
 v_add_u32 v2, 1280, v0
 v_mul_u32_u24 v3, 52429, v2
 v_lshrrev_b32 v3, 22, v3
 v_add_u32 v3, v3, v2
 v_lshlrev_b32 v3, 4, v3
 s_waitcnt vmcnt(14)
 ds_write_b128 v3, v[84:87]
 v_add_u32 v2, 1536, v0
 v_mul_u32_u24 v3, 52429, v2
 v_lshrrev_b32 v3, 22, v3
 v_add_u32 v3, v3, v2
 v_lshlrev_b32 v3, 4, v3
 s_waitcnt vmcnt(13)
 ds_write_b128 v3, v[88:91]
 v_add_u32 v2, 1792, v0
 v_mul_u32_u24 v3, 52429, v2
 v_lshrrev_b32 v3, 22, v3
 v_add_u32 v3, v3, v2
 v_lshlrev_b32 v3, 4, v3
 s_waitcnt vmcnt(12)
 ds_write_b128 v3, v[92:95]
 v_add_u32 v2, 2048, v0
 v_mul_u32_u24 v3, 52429, v2
 v_lshrrev_b32 v3, 22, v3
 v_add_u32 v3, v3, v2
 v_lshlrev_b32 v3, 4, v3
 s_waitcnt vmcnt(11)
 ds_write_b128 v3, v[96:99]
 v_add_u32 v2, 2304, v0
 v_mul_u32_u24 v3, 52429, v2
 v_lshrrev_b32 v3, 22, v3
 v_add_u32 v3, v3, v2
 v_lshlrev_b32 v3, 4, v3
 s_waitcnt vmcnt(10)
 ds_write_b128 v3, v[100:103]
 v_add_u32 v2, 2560, v0
 v_mul_u32_u24 v3, 52429, v2
 v_lshrrev_b32 v3, 22, v3
 v_add_u32 v3, v3, v2
 v_lshlrev_b32 v3, 4, v3
 s_waitcnt vmcnt(9)
 ds_write_b128 v3, v[104:107]
 v_add_u32 v2, 2816, v0
 v_mul_u32_u24 v3, 52429, v2
 v_lshrrev_b32 v3, 22, v3
 v_add_u32 v3, v3, v2
 v_lshlrev_b32 v3, 4, v3
 s_waitcnt vmcnt(8)
 ds_write_b128 v3, v[108:111]
 v_add_u32 v2, 3072, v0
 v_mul_u32_u24 v3, 52429, v2
 v_lshrrev_b32 v3, 22, v3
 v_add_u32 v3, v3, v2
 v_lshlrev_b32 v3, 4, v3
 s_waitcnt vmcnt(7)
 ds_write_b128 v3, v[112:115]
 v_add_u32 v2, 3328, v0
 v_mul_u32_u24 v3, 52429, v2
 v_lshrrev_b32 v3, 22, v3
 v_add_u32 v3, v3, v2
 v_lshlrev_b32 v3, 4, v3
 s_waitcnt vmcnt(6)
 ds_write_b128 v3, v[116:119]
 v_add_u32 v2, 3584, v0
 v_mul_u32_u24 v3, 52429, v2
 v_lshrrev_b32 v3, 22, v3
 v_add_u32 v3, v3, v2
 v_lshlrev_b32 v3, 4, v3
 s_waitcnt vmcnt(5)
 ds_write_b128 v3, v[120:123]
 v_add_u32 v2, 3840, v0
 v_mul_u32_u24 v3, 52429, v2
 v_lshrrev_b32 v3, 22, v3
 v_add_u32 v3, v3, v2
 v_lshlrev_b32 v3, 4, v3
 s_waitcnt vmcnt(4)
 ds_write_b128 v3, v[124:127]
 v_add_u32 v2, 4096, v0
 v_mul_u32_u24 v3, 52429, v2
 v_lshrrev_b32 v3, 22, v3
 v_add_u32 v3, v3, v2
 v_lshlrev_b32 v3, 4, v3
 s_waitcnt vmcnt(3)
 ds_write_b128 v3, v[128:131]
 v_add_u32 v2, 4352, v0
 v_mul_u32_u24 v3, 52429, v2
 v_lshrrev_b32 v3, 22, v3
 v_add_u32 v3, v3, v2
 v_lshlrev_b32 v3, 4, v3
 s_waitcnt vmcnt(2)
 ds_write_b128 v3, v[132:135]
 v_add_u32 v2, 4608, v0
 v_mul_u32_u24 v3, 52429, v2
 v_lshrrev_b32 v3, 22, v3
 v_add_u32 v3, v3, v2
 v_lshlrev_b32 v3, 4, v3
 s_waitcnt vmcnt(1)
 ds_write_b128 v3, v[136:139]
 v_add_u32 v2, 4864, v0
 v_mul_u32_u24 v3, 52429, v2
 v_lshrrev_b32 v3, 22, v3
 v_add_u32 v3, v3, v2
 v_lshlrev_b32 v3, 4, v3
 s_waitcnt vmcnt(0)
 ds_write_b128 v3, v[140:143]
 s_waitcnt lgkmcnt(0)
 s_barrier
 s_mul_i32 s40, s33, 4
 s_mul_i32 s41, s34, 1
 s_add_u32 s40, s40, s41
 s_cmp_ge_u32 s40, 20
 s_cbranch_scc1 L_outb_3_kernel_end
 s_add_u32 s41, s40, 0
 s_mul_i32 s42, s41, 40960
 v_and_b32 v2, 63, v0
 v_lshlrev_b32 v4, 4, v2
 v_and_b32 v3, 31, v0
 v_mul_u32_u24 v5, 1296, v3
 v_bfe_u32 v6, v0, 5, 1
 v_lshlrev_b32 v6, 4, v6
 v_add_u32 v5, v5, v6
 v_add_u32 v7, 41472, v5
 v_mov_b32 v64, 0
 v_mov_b32 v65, 0
 v_mov_b32 v66, 0
 v_mov_b32 v67, 0
 v_mov_b32 v68, 0
 v_mov_b32 v69, 0
 v_mov_b32 v70, 0
 v_mov_b32 v71, 0
 v_mov_b32 v72, 0
 v_mov_b32 v73, 0
 v_mov_b32 v74, 0
 v_mov_b32 v75, 0
 v_mov_b32 v76, 0
 v_mov_b32 v77, 0
 v_mov_b32 v78, 0
 v_mov_b32 v79, 0
 v_mov_b32 v80, 0
 v_mov_b32 v81, 0
 v_mov_b32 v82, 0
 v_mov_b32 v83, 0
 v_mov_b32 v84, 0
 v_mov_b32 v85, 0
 v_mov_b32 v86, 0
 v_mov_b32 v87, 0
 v_mov_b32 v88, 0
 v_mov_b32 v89, 0
 v_mov_b32 v90, 0
 v_mov_b32 v91, 0
 v_mov_b32 v92, 0
 v_mov_b32 v93, 0
 v_mov_b32 v94, 0
 v_mov_b32 v95, 0
 s_add_u32 s20, s4, 12582912
 s_addc_u32 s21, s5, 0
 s_mov_b32 s22, 2621440
 s_mov_b32 s23, 0x00020000
 s_add_u32 s24, s38, 0
 s_addc_u32 s25, s39, 0
 s_mov_b32 s26, 2621440
 s_mov_b32 s27, 0x00020000
 buffer_load_dwordx4 v[128:131], v4, s[12:15], s42 offen
 s_add_u32 s42, s42, 1024
 buffer_load_dwordx4 v[132:135], v4, s[12:15], s42 offen
 s_add_u32 s42, s42, 1024
 buffer_load_dwordx4 v[136:139], v4, s[12:15], s42 offen
 s_add_u32 s42, s42, 1024
 buffer_load_dwordx4 v[140:143], v4, s[12:15], s42 offen
 s_add_u32 s42, s42, 1024
 ds_read_b128 v[160:163], v5 offset:0
 ds_read_b128 v[164:167], v7 offset:0
 ds_read_b128 v[168:171], v5 offset:32
 ds_read_b128 v[172:175], v7 offset:32
 s_waitcnt vmcnt(3) lgkmcnt(2)
 v_mfma_f32_32x32x16_bf16 v[64:79], v[128:131], v[160:163], v[64:79]
 v_mfma_f32_32x32x16_bf16 v[80:95], v[128:131], v[164:167], v[80:95]
 buffer_load_dwordx4 v[128:131], v4, s[12:15], s42 offen
 s_add_u32 s42, s42, 1024
 ds_read_b128 v[160:163], v5 offset:64
 ds_read_b128 v[164:167], v7 offset:64
 s_waitcnt vmcnt(3) lgkmcnt(2)
 v_mfma_f32_32x32x16_bf16 v[64:79], v[132:135], v[168:171], v[64:79]
 v_mfma_f32_32x32x16_bf16 v[80:95], v[132:135], v[172:175], v[80:95]
 buffer_load_dwordx4 v[132:135], v4, s[12:15], s42 offen
 s_add_u32 s42, s42, 1024
 ds_read_b128 v[168:171], v5 offset:96
 ds_read_b128 v[172:175], v7 offset:96
 s_waitcnt vmcnt(3) lgkmcnt(2)
 v_mfma_f32_32x32x16_bf16 v[64:79], v[136:139], v[160:163], v[64:79]
 v_mfma_f32_32x32x16_bf16 v[80:95], v[136:139], v[164:167], v[80:95]
 buffer_load_dwordx4 v[136:139], v4, s[12:15], s42 offen
 s_add_u32 s42, s42, 1024
 ds_read_b128 v[160:163], v5 offset:128
 ds_read_b128 v[164:167], v7 offset:128
 s_waitcnt vmcnt(3) lgkmcnt(2)
 v_mfma_f32_32x32x16_bf16 v[64:79], v[140:143], v[168:171], v[64:79]
 v_mfma_f32_32x32x16_bf16 v[80:95], v[140:143], v[172:175], v[80:95]
 buffer_load_dwordx4 v[140:143], v4, s[12:15], s42 offen
 s_add_u32 s42, s42, 1024
 ds_read_b128 v[168:171], v5 offset:160
 ds_read_b128 v[172:175], v7 offset:160
 s_waitcnt vmcnt(3) lgkmcnt(2)
 v_mfma_f32_32x32x16_bf16 v[64:79], v[128:131], v[160:163], v[64:79]
 v_mfma_f32_32x32x16_bf16 v[80:95], v[128:131], v[164:167], v[80:95]
 buffer_load_dwordx4 v[128:131], v4, s[12:15], s42 offen
 s_add_u32 s42, s42, 1024
 ds_read_b128 v[160:163], v5 offset:192
 ds_read_b128 v[164:167], v7 offset:192
 s_waitcnt vmcnt(3) lgkmcnt(2)
 v_mfma_f32_32x32x16_bf16 v[64:79], v[132:135], v[168:171], v[64:79]
 v_mfma_f32_32x32x16_bf16 v[80:95], v[132:135], v[172:175], v[80:95]
 buffer_load_dwordx4 v[132:135], v4, s[12:15], s42 offen
 s_add_u32 s42, s42, 1024
 ds_read_b128 v[168:171], v5 offset:224
 ds_read_b128 v[172:175], v7 offset:224
 s_waitcnt vmcnt(3) lgkmcnt(2)
 v_mfma_f32_32x32x16_bf16 v[64:79], v[136:139], v[160:163], v[64:79]
 v_mfma_f32_32x32x16_bf16 v[80:95], v[136:139], v[164:167], v[80:95]
 buffer_load_dwordx4 v[136:139], v4, s[12:15], s42 offen
 s_add_u32 s42, s42, 1024
 ds_read_b128 v[160:163], v5 offset:256
 ds_read_b128 v[164:167], v7 offset:256
 s_waitcnt vmcnt(3) lgkmcnt(2)
 v_mfma_f32_32x32x16_bf16 v[64:79], v[140:143], v[168:171], v[64:79]
 v_mfma_f32_32x32x16_bf16 v[80:95], v[140:143], v[172:175], v[80:95]
 buffer_load_dwordx4 v[140:143], v4, s[12:15], s42 offen
 s_add_u32 s42, s42, 1024
 ds_read_b128 v[168:171], v5 offset:288
 ds_read_b128 v[172:175], v7 offset:288
 s_waitcnt vmcnt(3) lgkmcnt(2)
 v_mfma_f32_32x32x16_bf16 v[64:79], v[128:131], v[160:163], v[64:79]
 v_mfma_f32_32x32x16_bf16 v[80:95], v[128:131], v[164:167], v[80:95]
 buffer_load_dwordx4 v[128:131], v4, s[12:15], s42 offen
 s_add_u32 s42, s42, 1024
 ds_read_b128 v[160:163], v5 offset:320
 ds_read_b128 v[164:167], v7 offset:320
 s_waitcnt vmcnt(3) lgkmcnt(2)
 v_mfma_f32_32x32x16_bf16 v[64:79], v[132:135], v[168:171], v[64:79]
 v_mfma_f32_32x32x16_bf16 v[80:95], v[132:135], v[172:175], v[80:95]
 buffer_load_dwordx4 v[132:135], v4, s[12:15], s42 offen
 s_add_u32 s42, s42, 1024
 ds_read_b128 v[168:171], v5 offset:352
 ds_read_b128 v[172:175], v7 offset:352
 s_waitcnt vmcnt(3) lgkmcnt(2)
 v_mfma_f32_32x32x16_bf16 v[64:79], v[136:139], v[160:163], v[64:79]
 v_mfma_f32_32x32x16_bf16 v[80:95], v[136:139], v[164:167], v[80:95]
 buffer_load_dwordx4 v[136:139], v4, s[12:15], s42 offen
 s_add_u32 s42, s42, 1024
 ds_read_b128 v[160:163], v5 offset:384
 ds_read_b128 v[164:167], v7 offset:384
 s_waitcnt vmcnt(3) lgkmcnt(2)
 v_mfma_f32_32x32x16_bf16 v[64:79], v[140:143], v[168:171], v[64:79]
 v_mfma_f32_32x32x16_bf16 v[80:95], v[140:143], v[172:175], v[80:95]
 buffer_load_dwordx4 v[140:143], v4, s[12:15], s42 offen
 s_add_u32 s42, s42, 1024
 ds_read_b128 v[168:171], v5 offset:416
 ds_read_b128 v[172:175], v7 offset:416
 s_waitcnt vmcnt(3) lgkmcnt(2)
 v_mfma_f32_32x32x16_bf16 v[64:79], v[128:131], v[160:163], v[64:79]
 v_mfma_f32_32x32x16_bf16 v[80:95], v[128:131], v[164:167], v[80:95]
 buffer_load_dwordx4 v[128:131], v4, s[12:15], s42 offen
 s_add_u32 s42, s42, 1024
 ds_read_b128 v[160:163], v5 offset:448
 ds_read_b128 v[164:167], v7 offset:448
 s_waitcnt vmcnt(3) lgkmcnt(2)
 v_mfma_f32_32x32x16_bf16 v[64:79], v[132:135], v[168:171], v[64:79]
 v_mfma_f32_32x32x16_bf16 v[80:95], v[132:135], v[172:175], v[80:95]
 buffer_load_dwordx4 v[132:135], v4, s[12:15], s42 offen
 s_add_u32 s42, s42, 1024
 ds_read_b128 v[168:171], v5 offset:480
 ds_read_b128 v[172:175], v7 offset:480
 s_waitcnt vmcnt(3) lgkmcnt(2)
 v_mfma_f32_32x32x16_bf16 v[64:79], v[136:139], v[160:163], v[64:79]
 v_mfma_f32_32x32x16_bf16 v[80:95], v[136:139], v[164:167], v[80:95]
 buffer_load_dwordx4 v[136:139], v4, s[12:15], s42 offen
 s_add_u32 s42, s42, 1024
 ds_read_b128 v[160:163], v5 offset:512
 ds_read_b128 v[164:167], v7 offset:512
 s_waitcnt vmcnt(3) lgkmcnt(2)
 v_mfma_f32_32x32x16_bf16 v[64:79], v[140:143], v[168:171], v[64:79]
 v_mfma_f32_32x32x16_bf16 v[80:95], v[140:143], v[172:175], v[80:95]
 buffer_load_dwordx4 v[140:143], v4, s[12:15], s42 offen
 s_add_u32 s42, s42, 1024
 ds_read_b128 v[168:171], v5 offset:544
 ds_read_b128 v[172:175], v7 offset:544
 s_waitcnt vmcnt(3) lgkmcnt(2)
 v_mfma_f32_32x32x16_bf16 v[64:79], v[128:131], v[160:163], v[64:79]
 v_mfma_f32_32x32x16_bf16 v[80:95], v[128:131], v[164:167], v[80:95]
 buffer_load_dwordx4 v[128:131], v4, s[12:15], s42 offen
 s_add_u32 s42, s42, 1024
 ds_read_b128 v[160:163], v5 offset:576
 ds_read_b128 v[164:167], v7 offset:576
 s_waitcnt vmcnt(3) lgkmcnt(2)
 v_mfma_f32_32x32x16_bf16 v[64:79], v[132:135], v[168:171], v[64:79]
 v_mfma_f32_32x32x16_bf16 v[80:95], v[132:135], v[172:175], v[80:95]
 buffer_load_dwordx4 v[132:135], v4, s[12:15], s42 offen
 s_add_u32 s42, s42, 1024
 ds_read_b128 v[168:171], v5 offset:608
 ds_read_b128 v[172:175], v7 offset:608
 s_waitcnt vmcnt(3) lgkmcnt(2)
 v_mfma_f32_32x32x16_bf16 v[64:79], v[136:139], v[160:163], v[64:79]
 v_mfma_f32_32x32x16_bf16 v[80:95], v[136:139], v[164:167], v[80:95]
 buffer_load_dwordx4 v[136:139], v4, s[12:15], s42 offen
 s_add_u32 s42, s42, 1024
 ds_read_b128 v[160:163], v5 offset:640
 ds_read_b128 v[164:167], v7 offset:640
 s_waitcnt vmcnt(3) lgkmcnt(2)
 v_mfma_f32_32x32x16_bf16 v[64:79], v[140:143], v[168:171], v[64:79]
 v_mfma_f32_32x32x16_bf16 v[80:95], v[140:143], v[172:175], v[80:95]
 buffer_load_dwordx4 v[140:143], v4, s[12:15], s42 offen
 s_add_u32 s42, s42, 1024
 ds_read_b128 v[168:171], v5 offset:672
 ds_read_b128 v[172:175], v7 offset:672
 s_waitcnt vmcnt(3) lgkmcnt(2)
 v_mfma_f32_32x32x16_bf16 v[64:79], v[128:131], v[160:163], v[64:79]
 v_mfma_f32_32x32x16_bf16 v[80:95], v[128:131], v[164:167], v[80:95]
 buffer_load_dwordx4 v[128:131], v4, s[12:15], s42 offen
 s_add_u32 s42, s42, 1024
 ds_read_b128 v[160:163], v5 offset:704
 ds_read_b128 v[164:167], v7 offset:704
 s_waitcnt vmcnt(3) lgkmcnt(2)
 v_mfma_f32_32x32x16_bf16 v[64:79], v[132:135], v[168:171], v[64:79]
 v_mfma_f32_32x32x16_bf16 v[80:95], v[132:135], v[172:175], v[80:95]
 buffer_load_dwordx4 v[132:135], v4, s[12:15], s42 offen
 s_add_u32 s42, s42, 1024
 ds_read_b128 v[168:171], v5 offset:736
 ds_read_b128 v[172:175], v7 offset:736
 s_waitcnt vmcnt(3) lgkmcnt(2)
 v_mfma_f32_32x32x16_bf16 v[64:79], v[136:139], v[160:163], v[64:79]
 v_mfma_f32_32x32x16_bf16 v[80:95], v[136:139], v[164:167], v[80:95]
 buffer_load_dwordx4 v[136:139], v4, s[12:15], s42 offen
 s_add_u32 s42, s42, 1024
 ds_read_b128 v[160:163], v5 offset:768
 ds_read_b128 v[164:167], v7 offset:768
 s_waitcnt vmcnt(3) lgkmcnt(2)
 v_mfma_f32_32x32x16_bf16 v[64:79], v[140:143], v[168:171], v[64:79]
 v_mfma_f32_32x32x16_bf16 v[80:95], v[140:143], v[172:175], v[80:95]
 buffer_load_dwordx4 v[140:143], v4, s[12:15], s42 offen
 s_add_u32 s42, s42, 1024
 ds_read_b128 v[168:171], v5 offset:800
 ds_read_b128 v[172:175], v7 offset:800
 s_waitcnt vmcnt(3) lgkmcnt(2)
 v_mfma_f32_32x32x16_bf16 v[64:79], v[128:131], v[160:163], v[64:79]
 v_mfma_f32_32x32x16_bf16 v[80:95], v[128:131], v[164:167], v[80:95]
 buffer_load_dwordx4 v[128:131], v4, s[12:15], s42 offen
 s_add_u32 s42, s42, 1024
 ds_read_b128 v[160:163], v5 offset:832
 ds_read_b128 v[164:167], v7 offset:832
 s_waitcnt vmcnt(3) lgkmcnt(2)
 v_mfma_f32_32x32x16_bf16 v[64:79], v[132:135], v[168:171], v[64:79]
 v_mfma_f32_32x32x16_bf16 v[80:95], v[132:135], v[172:175], v[80:95]
 buffer_load_dwordx4 v[132:135], v4, s[12:15], s42 offen
 s_add_u32 s42, s42, 1024
 ds_read_b128 v[168:171], v5 offset:864
 ds_read_b128 v[172:175], v7 offset:864
 s_waitcnt vmcnt(3) lgkmcnt(2)
 v_mfma_f32_32x32x16_bf16 v[64:79], v[136:139], v[160:163], v[64:79]
 v_mfma_f32_32x32x16_bf16 v[80:95], v[136:139], v[164:167], v[80:95]
 buffer_load_dwordx4 v[136:139], v4, s[12:15], s42 offen
 s_add_u32 s42, s42, 1024
 ds_read_b128 v[160:163], v5 offset:896
 ds_read_b128 v[164:167], v7 offset:896
 s_waitcnt vmcnt(3) lgkmcnt(2)
 v_mfma_f32_32x32x16_bf16 v[64:79], v[140:143], v[168:171], v[64:79]
 v_mfma_f32_32x32x16_bf16 v[80:95], v[140:143], v[172:175], v[80:95]
 buffer_load_dwordx4 v[140:143], v4, s[12:15], s42 offen
 s_add_u32 s42, s42, 1024
 ds_read_b128 v[168:171], v5 offset:928
 ds_read_b128 v[172:175], v7 offset:928
 s_waitcnt vmcnt(3) lgkmcnt(2)
 v_mfma_f32_32x32x16_bf16 v[64:79], v[128:131], v[160:163], v[64:79]
 v_mfma_f32_32x32x16_bf16 v[80:95], v[128:131], v[164:167], v[80:95]
 buffer_load_dwordx4 v[128:131], v4, s[12:15], s42 offen
 s_add_u32 s42, s42, 1024
 ds_read_b128 v[160:163], v5 offset:960
 ds_read_b128 v[164:167], v7 offset:960
 s_waitcnt vmcnt(3) lgkmcnt(2)
 v_mfma_f32_32x32x16_bf16 v[64:79], v[132:135], v[168:171], v[64:79]
 v_mfma_f32_32x32x16_bf16 v[80:95], v[132:135], v[172:175], v[80:95]
 buffer_load_dwordx4 v[132:135], v4, s[12:15], s42 offen
 s_add_u32 s42, s42, 1024
 ds_read_b128 v[168:171], v5 offset:992
 ds_read_b128 v[172:175], v7 offset:992
 s_waitcnt vmcnt(3) lgkmcnt(2)
 v_mfma_f32_32x32x16_bf16 v[64:79], v[136:139], v[160:163], v[64:79]
 v_mfma_f32_32x32x16_bf16 v[80:95], v[136:139], v[164:167], v[80:95]
 buffer_load_dwordx4 v[136:139], v4, s[12:15], s42 offen
 s_add_u32 s42, s42, 1024
 ds_read_b128 v[160:163], v5 offset:1024
 ds_read_b128 v[164:167], v7 offset:1024
 s_waitcnt vmcnt(3) lgkmcnt(2)
 v_mfma_f32_32x32x16_bf16 v[64:79], v[140:143], v[168:171], v[64:79]
 v_mfma_f32_32x32x16_bf16 v[80:95], v[140:143], v[172:175], v[80:95]
 buffer_load_dwordx4 v[140:143], v4, s[12:15], s42 offen
 s_add_u32 s42, s42, 1024
 ds_read_b128 v[168:171], v5 offset:1056
 ds_read_b128 v[172:175], v7 offset:1056
 s_waitcnt vmcnt(3) lgkmcnt(2)
 v_mfma_f32_32x32x16_bf16 v[64:79], v[128:131], v[160:163], v[64:79]
 v_mfma_f32_32x32x16_bf16 v[80:95], v[128:131], v[164:167], v[80:95]
 buffer_load_dwordx4 v[128:131], v4, s[12:15], s42 offen
 s_add_u32 s42, s42, 1024
 ds_read_b128 v[160:163], v5 offset:1088
 ds_read_b128 v[164:167], v7 offset:1088
 s_waitcnt vmcnt(3) lgkmcnt(2)
 v_mfma_f32_32x32x16_bf16 v[64:79], v[132:135], v[168:171], v[64:79]
 v_mfma_f32_32x32x16_bf16 v[80:95], v[132:135], v[172:175], v[80:95]
 buffer_load_dwordx4 v[132:135], v4, s[12:15], s42 offen
 s_add_u32 s42, s42, 1024
 ds_read_b128 v[168:171], v5 offset:1120
 ds_read_b128 v[172:175], v7 offset:1120
 s_waitcnt vmcnt(3) lgkmcnt(2)
 v_mfma_f32_32x32x16_bf16 v[64:79], v[136:139], v[160:163], v[64:79]
 v_mfma_f32_32x32x16_bf16 v[80:95], v[136:139], v[164:167], v[80:95]
 buffer_load_dwordx4 v[136:139], v4, s[12:15], s42 offen
 s_add_u32 s42, s42, 1024
 ds_read_b128 v[160:163], v5 offset:1152
 ds_read_b128 v[164:167], v7 offset:1152
 s_waitcnt vmcnt(3) lgkmcnt(2)
 v_mfma_f32_32x32x16_bf16 v[64:79], v[140:143], v[168:171], v[64:79]
 v_mfma_f32_32x32x16_bf16 v[80:95], v[140:143], v[172:175], v[80:95]
 buffer_load_dwordx4 v[140:143], v4, s[12:15], s42 offen
 s_add_u32 s42, s42, 1024
 ds_read_b128 v[168:171], v5 offset:1184
 ds_read_b128 v[172:175], v7 offset:1184
 s_waitcnt vmcnt(3) lgkmcnt(2)
 v_mfma_f32_32x32x16_bf16 v[64:79], v[128:131], v[160:163], v[64:79]
 v_mfma_f32_32x32x16_bf16 v[80:95], v[128:131], v[164:167], v[80:95]
 ds_read_b128 v[160:163], v5 offset:1216
 ds_read_b128 v[164:167], v7 offset:1216
 s_waitcnt vmcnt(2) lgkmcnt(2)
 v_mfma_f32_32x32x16_bf16 v[64:79], v[132:135], v[168:171], v[64:79]
 v_mfma_f32_32x32x16_bf16 v[80:95], v[132:135], v[172:175], v[80:95]
 ds_read_b128 v[168:171], v5 offset:1248
 ds_read_b128 v[172:175], v7 offset:1248
 s_waitcnt vmcnt(1) lgkmcnt(2)
 v_mfma_f32_32x32x16_bf16 v[64:79], v[136:139], v[160:163], v[64:79]
 v_mfma_f32_32x32x16_bf16 v[80:95], v[136:139], v[164:167], v[80:95]
 s_waitcnt vmcnt(0) lgkmcnt(0)
 v_mfma_f32_32x32x16_bf16 v[64:79], v[140:143], v[168:171], v[64:79]
 v_mfma_f32_32x32x16_bf16 v[80:95], v[140:143], v[172:175], v[80:95]
 s_nop 11
 v_bfe_u32 v8, v0, 5, 1
 v_lshlrev_b32 v8, 3, v8
 v_and_b32 v9, 31, v0
 v_mul_u32_u24 v9, 1280, v9
 v_add_u32 v8, v8, v9
 s_lshl_b32 s46, s40, 6
 s_add_u32 s46, s46, s35
 v_add_u32 v9, 40960, v8
 buffer_load_dwordx2 v[12:13], v8, s[20:23], s46 offen offset:0
 buffer_load_dwordx2 v[14:15], v8, s[20:23], s46 offen offset:16
 buffer_load_dwordx2 v[16:17], v8, s[20:23], s46 offen offset:32
 buffer_load_dwordx2 v[18:19], v8, s[20:23], s46 offen offset:48
 buffer_load_dwordx2 v[20:21], v9, s[20:23], s46 offen offset:0
 buffer_load_dwordx2 v[22:23], v9, s[20:23], s46 offen offset:16
 buffer_load_dwordx2 v[24:25], v9, s[20:23], s46 offen offset:32
 buffer_load_dwordx2 v[26:27], v9, s[20:23], s46 offen offset:48
 s_waitcnt vmcnt(7)
 v_lshlrev_b32 v32, 16, v12
 v_and_b32 v33, 0xffff0000, v12
 v_lshlrev_b32 v34, 16, v13
 v_and_b32 v35, 0xffff0000, v13
 v_add_f32 v32, v32, v64
 v_add_f32 v33, v33, v65
 v_add_f32 v34, v34, v66
 v_add_f32 v35, v35, v67
 v_cvt_pk_bf16_f32 v36, v32, v33
 v_cvt_pk_bf16_f32 v37, v34, v35
 buffer_store_dwordx2 v[36:37], v8, s[24:27], s46 offen offset:0
 s_waitcnt vmcnt(7)
 v_lshlrev_b32 v32, 16, v14
 v_and_b32 v33, 0xffff0000, v14
 v_lshlrev_b32 v34, 16, v15
 v_and_b32 v35, 0xffff0000, v15
 v_add_f32 v32, v32, v68
 v_add_f32 v33, v33, v69
 v_add_f32 v34, v34, v70
 v_add_f32 v35, v35, v71
 v_cvt_pk_bf16_f32 v36, v32, v33
 v_cvt_pk_bf16_f32 v37, v34, v35
 buffer_store_dwordx2 v[36:37], v8, s[24:27], s46 offen offset:16
 s_waitcnt vmcnt(7)
 v_lshlrev_b32 v32, 16, v16
 v_and_b32 v33, 0xffff0000, v16
 v_lshlrev_b32 v34, 16, v17
 v_and_b32 v35, 0xffff0000, v17
 v_add_f32 v32, v32, v72
 v_add_f32 v33, v33, v73
 v_add_f32 v34, v34, v74
 v_add_f32 v35, v35, v75
 v_cvt_pk_bf16_f32 v36, v32, v33
 v_cvt_pk_bf16_f32 v37, v34, v35
 buffer_store_dwordx2 v[36:37], v8, s[24:27], s46 offen offset:32
 s_waitcnt vmcnt(7)
 v_lshlrev_b32 v32, 16, v18
 v_and_b32 v33, 0xffff0000, v18
 v_lshlrev_b32 v34, 16, v19
 v_and_b32 v35, 0xffff0000, v19
 v_add_f32 v32, v32, v76
 v_add_f32 v33, v33, v77
 v_add_f32 v34, v34, v78
 v_add_f32 v35, v35, v79
 v_cvt_pk_bf16_f32 v36, v32, v33
 v_cvt_pk_bf16_f32 v37, v34, v35
 buffer_store_dwordx2 v[36:37], v8, s[24:27], s46 offen offset:48
 s_waitcnt vmcnt(7)
 v_lshlrev_b32 v32, 16, v20
 v_and_b32 v33, 0xffff0000, v20
 v_lshlrev_b32 v34, 16, v21
 v_and_b32 v35, 0xffff0000, v21
 v_add_f32 v32, v32, v80
 v_add_f32 v33, v33, v81
 v_add_f32 v34, v34, v82
 v_add_f32 v35, v35, v83
 v_cvt_pk_bf16_f32 v36, v32, v33
 v_cvt_pk_bf16_f32 v37, v34, v35
 buffer_store_dwordx2 v[36:37], v9, s[24:27], s46 offen offset:0
 s_waitcnt vmcnt(7)
 v_lshlrev_b32 v32, 16, v22
 v_and_b32 v33, 0xffff0000, v22
 v_lshlrev_b32 v34, 16, v23
 v_and_b32 v35, 0xffff0000, v23
 v_add_f32 v32, v32, v84
 v_add_f32 v33, v33, v85
 v_add_f32 v34, v34, v86
 v_add_f32 v35, v35, v87
 v_cvt_pk_bf16_f32 v36, v32, v33
 v_cvt_pk_bf16_f32 v37, v34, v35
 buffer_store_dwordx2 v[36:37], v9, s[24:27], s46 offen offset:16
 s_waitcnt vmcnt(7)
 v_lshlrev_b32 v32, 16, v24
 v_and_b32 v33, 0xffff0000, v24
 v_lshlrev_b32 v34, 16, v25
 v_and_b32 v35, 0xffff0000, v25
 v_add_f32 v32, v32, v88
 v_add_f32 v33, v33, v89
 v_add_f32 v34, v34, v90
 v_add_f32 v35, v35, v91
 v_cvt_pk_bf16_f32 v36, v32, v33
 v_cvt_pk_bf16_f32 v37, v34, v35
 buffer_store_dwordx2 v[36:37], v9, s[24:27], s46 offen offset:32
 s_waitcnt vmcnt(7)
 v_lshlrev_b32 v32, 16, v26
 v_and_b32 v33, 0xffff0000, v26
 v_lshlrev_b32 v34, 16, v27
 v_and_b32 v35, 0xffff0000, v27
 v_add_f32 v32, v32, v92
 v_add_f32 v33, v33, v93
 v_add_f32 v34, v34, v94
 v_add_f32 v35, v35, v95
 v_cvt_pk_bf16_f32 v36, v32, v33
 v_cvt_pk_bf16_f32 v37, v34, v35
 buffer_store_dwordx2 v[36:37], v9, s[24:27], s46 offen offset:48
L_outb_3_kernel_end:
 s_endpgm
.section .rodata,"a"
.p2align 6
.amdhsa_kernel prep_kernel
  .amdhsa_next_free_vgpr 256
  .amdhsa_next_free_sgpr 102
  .amdhsa_accum_offset 256
  .amdhsa_group_segment_fixed_size 0
  .amdhsa_kernarg_size 88
  .amdhsa_user_sgpr_count 2
  .amdhsa_user_sgpr_kernarg_segment_ptr 1
  .amdhsa_system_sgpr_workgroup_id_x 1
.end_amdhsa_kernel
.p2align 6
.amdhsa_kernel a1_0_kernel
  .amdhsa_next_free_vgpr 256
  .amdhsa_next_free_sgpr 102
  .amdhsa_accum_offset 256
  .amdhsa_group_segment_fixed_size 0
  .amdhsa_kernarg_size 88
  .amdhsa_user_sgpr_count 2
  .amdhsa_user_sgpr_kernarg_segment_ptr 1
  .amdhsa_system_sgpr_workgroup_id_x 1
.end_amdhsa_kernel
.p2align 6
.amdhsa_kernel attna_kernel
  .amdhsa_next_free_vgpr 256
  .amdhsa_next_free_sgpr 102
  .amdhsa_accum_offset 256
  .amdhsa_group_segment_fixed_size 0
  .amdhsa_kernarg_size 88
  .amdhsa_user_sgpr_count 2
  .amdhsa_user_sgpr_kernarg_segment_ptr 1
  .amdhsa_system_sgpr_workgroup_id_x 1
.end_amdhsa_kernel
.p2align 6
.amdhsa_kernel outa_0_kernel
  .amdhsa_next_free_vgpr 256
  .amdhsa_next_free_sgpr 102
  .amdhsa_accum_offset 256
  .amdhsa_group_segment_fixed_size 0
  .amdhsa_kernarg_size 88
  .amdhsa_user_sgpr_count 2
  .amdhsa_user_sgpr_kernarg_segment_ptr 1
  .amdhsa_system_sgpr_workgroup_id_x 1
.end_amdhsa_kernel
.p2align 6
.amdhsa_kernel b1_1_kernel
  .amdhsa_next_free_vgpr 256
  .amdhsa_next_free_sgpr 102
  .amdhsa_accum_offset 256
  .amdhsa_group_segment_fixed_size 0
  .amdhsa_kernarg_size 88
  .amdhsa_user_sgpr_count 2
  .amdhsa_user_sgpr_kernarg_segment_ptr 1
  .amdhsa_system_sgpr_workgroup_id_x 1
.end_amdhsa_kernel
.p2align 6
.amdhsa_kernel attnb_kernel
  .amdhsa_next_free_vgpr 256
  .amdhsa_next_free_sgpr 102
  .amdhsa_accum_offset 256
  .amdhsa_group_segment_fixed_size 0
  .amdhsa_kernarg_size 88
  .amdhsa_user_sgpr_count 2
  .amdhsa_user_sgpr_kernarg_segment_ptr 1
  .amdhsa_system_sgpr_workgroup_id_x 1
.end_amdhsa_kernel
.p2align 6
.amdhsa_kernel outb_1_kernel
  .amdhsa_next_free_vgpr 256
  .amdhsa_next_free_sgpr 102
  .amdhsa_accum_offset 256
  .amdhsa_group_segment_fixed_size 0
  .amdhsa_kernarg_size 88
  .amdhsa_user_sgpr_count 2
  .amdhsa_user_sgpr_kernarg_segment_ptr 1
  .amdhsa_system_sgpr_workgroup_id_x 1
.end_amdhsa_kernel
.p2align 6
.amdhsa_kernel a1_2_kernel
  .amdhsa_next_free_vgpr 256
  .amdhsa_next_free_sgpr 102
  .amdhsa_accum_offset 256
  .amdhsa_group_segment_fixed_size 0
  .amdhsa_kernarg_size 88
  .amdhsa_user_sgpr_count 2
  .amdhsa_user_sgpr_kernarg_segment_ptr 1
  .amdhsa_system_sgpr_workgroup_id_x 1
.end_amdhsa_kernel
.p2align 6
.amdhsa_kernel outa_2_kernel
  .amdhsa_next_free_vgpr 256
  .amdhsa_next_free_sgpr 102
  .amdhsa_accum_offset 256
  .amdhsa_group_segment_fixed_size 0
  .amdhsa_kernarg_size 88
  .amdhsa_user_sgpr_count 2
  .amdhsa_user_sgpr_kernarg_segment_ptr 1
  .amdhsa_system_sgpr_workgroup_id_x 1
.end_amdhsa_kernel
.p2align 6
.amdhsa_kernel b1_3_kernel
  .amdhsa_next_free_vgpr 256
  .amdhsa_next_free_sgpr 102
  .amdhsa_accum_offset 256
  .amdhsa_group_segment_fixed_size 0
  .amdhsa_kernarg_size 88
  .amdhsa_user_sgpr_count 2
  .amdhsa_user_sgpr_kernarg_segment_ptr 1
  .amdhsa_system_sgpr_workgroup_id_x 1
.end_amdhsa_kernel
.p2align 6
.amdhsa_kernel outb_3_kernel
  .amdhsa_next_free_vgpr 256
  .amdhsa_next_free_sgpr 102
  .amdhsa_accum_offset 256
  .amdhsa_group_segment_fixed_size 0
  .amdhsa_kernarg_size 88
  .amdhsa_user_sgpr_count 2
  .amdhsa_user_sgpr_kernarg_segment_ptr 1
  .amdhsa_system_sgpr_workgroup_id_x 1
.end_amdhsa_kernel
```
